```python
import torch

def _softmax(x, axis=-1):
    return torch.softmax(x, dim=axis)
def _gelu(x):
    return torch.nn.functional.gelu(x, approximate="tanh")
def _silu(x):
    return torch.nn.functional.silu(x)
def _sigmoid(x):
    return torch.sigmoid(x)
def _layernorm(x, axis=-1, eps=1e-5):
    m = x.mean(dim=axis, keepdim=True)
    v = x.var(dim=axis, keepdim=True, unbiased=False)
    return (x - m) / torch.sqrt(v + eps)
def _scatter_add(tgt, idx, src, axis=0):
    return tgt.clone().index_add_(axis, idx, src)
def _segment_sum(src, seg, n):
    out = torch.zeros((n,) + src.shape[1:], dtype=src.dtype)
    return out.index_add_(0, seg, src)
def _pad(x, pw):
    flat = tuple(v for pair in reversed(pw) for v in pair)
    return torch.nn.functional.pad(x, flat)

kernel_name = 'interleave_layers__linear_kernel_hedgehog__spectral_fnet__prompt'

def setup_inputs():

    _w = (lambda a: (lambda t: t.to(torch.bfloat16) if t.is_floating_point() else t)(torch.as_tensor(a)))
    def _A_setup():
        B, S, D, H = 1, 2048, 640, 32
        Dh = D // H
        return {
            "x": _w((lambda *s: torch.randn(*s, dtype=torch.bfloat16) * 0.4)(B, S, D)),
            "wqkv": _w((lambda *s: torch.randn(*s, dtype=torch.bfloat16) * 1.6)(D, 3 * D)),
            "w_phi": _w((lambda *s: torch.randn(*s, dtype=torch.bfloat16) * 1.6)(H, Dh, Dh) * (Dh ** -0.5)),
            "wo": _w((lambda *s: torch.randn(*s, dtype=torch.bfloat16) * 1.6)(D, D)),
        }
    _A_in = _A_setup()

    def _B_setup():
        B, S, D = 1, 2048, 640
        ns = torch.arange(S)[:, None] * torch.arange(S)[None, :]
        nd = torch.arange(D)[:, None] * torch.arange(D)[None, :]
        Ws_re = torch.cos(-2.0 * torch.pi * ns / S).to(float)
        Ws_im = torch.sin(-2.0 * torch.pi * ns / S).to(float)
        Wd_re = torch.cos(-2.0 * torch.pi * nd / D).to(float)
        Wd_im = torch.sin(-2.0 * torch.pi * nd / D).to(float)
        return {
            "x": _w((lambda *s: torch.randn(*s, dtype=torch.bfloat16) * 0.4)(B, S, D)),
            "dft_seq_re": _w(Ws_re),
            "dft_seq_im": _w(Ws_im),
            "dft_hid_re": _w(Wd_re),
            "dft_hid_im": _w(Wd_im),
        }
    _B_in = _B_setup()

    return {
        "A_x": _A_in["x"],
        "A_wqkv": _A_in["wqkv"],
        "A_w_phi": _A_in["w_phi"],
        "A_wo": _A_in["wo"],
        "B_x": _B_in["x"],
        "B_dft_seq_re": _B_in["dft_seq_re"],
        "B_dft_seq_im": _B_in["dft_seq_im"],
        "B_dft_hid_re": _B_in["dft_hid_re"],
        "B_dft_hid_im": _B_in["dft_hid_im"],
    }

def reference(A_x, A_wqkv, A_w_phi, A_wo, B_x, B_dft_seq_re, B_dft_seq_im, B_dft_hid_re, B_dft_hid_im):
    def _A_ref(x, wqkv, w_phi, wo):
        B, S, D = x.shape
        H = 32; Dh = D // H
        qkv = (lambda x, *d: x.permute(*d))((x @ wqkv).reshape(B, S, 3, H, Dh), 2, 0, 3, 1, 4)
        q, k, v = qkv[0], qkv[1], qkv[2]
        pq = torch.einsum("bhsd,hdf->bhsf", q, w_phi)
        pk = torch.einsum("bhsd,hdf->bhsf", k, w_phi)
        phi_q = torch.concatenate([_softmax(pq, axis=-1), _softmax(-pq, axis=-1)], axis=-1)
        phi_k = torch.concatenate([_softmax(pk, axis=-1), _softmax(-pk, axis=-1)], axis=-1)
        kv = torch.einsum("bhsf,bhsd->bhfd", phi_k, v)
        z  = torch.einsum("bhsf->bhf", phi_k)
        num = torch.einsum("bhqf,bhfd->bhqd", phi_q, kv)
        den = torch.einsum("bhqf,bhf->bhq", phi_q, z)[..., None] + 1e-6
        o = num / den
        return (lambda x, *d: x.permute(*d))(o, 0, 2, 1, 3).reshape(B, S, D) @ wo

    def _B_ref(x, dft_seq_re, dft_seq_im, dft_hid_re, dft_hid_im):
        a = torch.einsum("bsd,ed->bse", x, dft_hid_re)
        b = torch.einsum("bsd,ed->bse", x, dft_hid_im)
        y = torch.einsum("ts,bse->bte", dft_seq_re, a) - torch.einsum("ts,bse->bte", dft_seq_im, b)
        return y

    x = A_x
    x = x + _A_ref(_layernorm(x, axis=-1), A_wqkv, A_w_phi, A_wo)
    x = x + _B_ref(_layernorm(x, axis=-1), B_dft_seq_re, B_dft_seq_im, B_dft_hid_re, B_dft_hid_im)
    x = x + _A_ref(_layernorm(x, axis=-1), A_wqkv, A_w_phi, A_wo)
    x = x + _B_ref(_layernorm(x, axis=-1), B_dft_seq_re, B_dft_seq_im, B_dft_hid_re, B_dft_hid_im)
    return x
```

```asm
; @launch grid=(256,1,1) block=(256,1,1) lds=155904
.amdgcn_target "amdgcn-amd-amdhsa--gfx950"
.text
.globl interleave_layers__linear_kernel_hedgehog__spectral_fnet__prompt_kernel
.p2align 8
.type interleave_layers__linear_kernel_hedgehog__spectral_fnet__prompt_kernel,@function
interleave_layers__linear_kernel_hedgehog__spectral_fnet__prompt_kernel:
 s_cmp_ge_u32 s2, 256
 s_cbranch_scc1 Lexit_near
 s_branch Lstart
Lexit_near:
 s_endpgm
Lstart:
 s_load_dwordx4 s[16:19], s[0:1], 0
 s_load_dwordx4 s[20:23], s[0:1], 16
 s_load_dwordx4 s[24:27], s[0:1], 72
 s_load_dwordx2 s[28:29], s[0:1], 88
 s_and_b32 s3, s2, 7
 s_lshr_b32 s4, s2, 3
 v_and_b32 v1, 63, v0
 v_lshrrev_b32 v2, 6, v0
 s_nop 0
 v_readfirstlane_b32 s5, v2
 s_mov_b32 s40, 0
 s_mov_b32 s42, 0
 s_lshl_b32 s44, s3, 7
 s_lshl_b32 s45, s4, 2
 s_add_u32 s45, s45, s44
 v_mov_b32 v4, s45
 v_and_b32 v5, 31, v1
 v_lshlrev_b32_e64 v5, 2, v5
 v_add_u32 v5, s44, v5
 s_waitcnt lgkmcnt(0)
 s_mov_b32 s8, s28
 s_and_b32 s9, s29, 0xffff
 s_mov_b32 s10, 268435456
 s_mov_b32 s11, 0x20000
 s_getpc_b64 s[32:33]
Lpc:
 s_and_b32 s33, s33, 0xffff
 s_mov_b32 s34, fnet_tab_end-Lpc
 s_mov_b32 s35, 0x20000
 v_and_b32 v6, 31, v1
 s_cmp_lg_u32 s5, 0
 s_cbranch_scc1 Lph_1
 s_mov_b32 s12, s20
 s_and_b32 s13, s21, 0xffff
 s_mov_b32 s14, 25600
 s_mov_b32 s15, 0x20000
 v_lshlrev_b32_e64 v2, 4, v1
 s_mul_i32 s48, s4, 800
 s_mov_b32 m0, 154880
 s_nop 0
 buffer_load_dwordx4 v2, s[12:15], s48 offen lds
Lph_1:
 s_mov_b32 s12, s16
 s_and_b32 s13, s17, 0xffff
 s_mov_b32 s14, 2621440
 s_mov_b32 s15, 0x20000
 s_lshl_b32 s48, s4, 3
 s_lshl_b32 s49, s5, 1
 s_add_u32 s48, s48, s49
 v_lshrrev_b32 v7, 5, v1
 v_add_u32 v7, s48, v7
 v_lshrrev_b32 v2, 4, v7
 v_lshlrev_b32 v2, 3, v2
 v_and_b32 v3, 15, v7
 v_lshl_add_u32 v2, v3, 7, v2
 v_add_u32_e64 v2, s3, v2
 v_mul_u32_u24 v144, 1280, v2
 v_lshl_add_u32 v144, v6, 3, v144
 v_cmp_gt_u32_e64 vcc, 20, v6
 v_mov_b32 v3, 2146435072
 s_nop 0
 v_cndmask_b32 v144, v3, v144, vcc
 buffer_load_dwordx2 v[148:149], v144, s[12:15], 0 offen offset:0
 buffer_load_dwordx2 v[150:151], v144, s[12:15], 0 offen offset:160
 buffer_load_dwordx2 v[152:153], v144, s[12:15], 0 offen offset:320
 buffer_load_dwordx2 v[154:155], v144, s[12:15], 0 offen offset:480
 buffer_load_dwordx2 v[156:157], v144, s[12:15], 0 offen offset:640
 buffer_load_dwordx2 v[158:159], v144, s[12:15], 0 offen offset:800
 buffer_load_dwordx2 v[160:161], v144, s[12:15], 0 offen offset:960
 buffer_load_dwordx2 v[162:163], v144, s[12:15], 0 offen offset:1120
 s_lshl_b32 s48, 1, s4
 s_sub_u32 s49, s48, 1
 s_and_b32 s49, s49, 28827648
 s_bcnt1_i32_b32 s49, s49
 s_lshl_b32 s49, s49, 3
 s_add_u32 s49, s49, s3
 s_and_b32 s48, s48, 28827648
 s_cselect_b32 s38, s49, 99
 s_mov_b32 s60, s18
 s_and_b32 s61, s19, 0xffff
 s_mov_b32 s62, 2457600
 s_mov_b32 s63, 0x20000
 s_mov_b32 s56, s26
 s_and_b32 s57, s27, 0xffff
 s_mov_b32 s58, 256
 s_mov_b32 s59, 0x20000
 s_mov_b32 s41, 0
 s_cmp_eq_u32 s5, 0
 s_cbranch_scc1 Lw0_2
 s_mul_i32 s44, s4, 3
 s_add_u32 s44, s44, s5
 s_sub_u32 s44, s44, 1
 s_lshl_b32 s44, s44, 10
 v_lshlrev_b32_e64 v2, 4, v1
 buffer_load_dwordx4 v[132:135], v2, s[32:35], s44 offen
 v_lshlrev_b32_e64 v2, 4, v1
 s_mul_i32 s44, s5, 5120
 s_add_u32 s45, s44, 76800
 s_add_u32 s44, s44, fnet_tab-Lpc+-5120
 s_add_u32 m0, s45, 0
 s_add_u32 s46, s44, 0
 buffer_load_dwordx4 v2, s[32:35], s46 offen lds
 s_add_u32 m0, s45, 1024
 s_add_u32 s46, s44, 1024
 buffer_load_dwordx4 v2, s[32:35], s46 offen lds
 s_add_u32 m0, s45, 2048
 s_add_u32 s46, s44, 2048
 buffer_load_dwordx4 v2, s[32:35], s46 offen lds
 s_add_u32 m0, s45, 3072
 s_add_u32 s46, s44, 3072
 buffer_load_dwordx4 v2, s[32:35], s46 offen lds
 s_add_u32 m0, s45, 4096
 s_add_u32 s46, s44, 4096
 buffer_load_dwordx4 v2, s[32:35], s46 offen lds
 s_lshl_b32 s46, 1, s4
 s_sub_u32 s47, s46, 1
 s_and_b32 s47, s47, 3959426067
 s_bcnt1_i32_b32 s47, s47
 s_lshl_b32 s44, s47, 13
 s_lshl_b32 s45, s3, 14
 s_add_u32 s45, s45, -2048
 s_add_u32 s45, s45, s44
 s_cmp_lt_u32 s47, 8
 s_cselect_b32 s44, s44, s45
 s_add_u32 s44, s44, fnet_tab-Lpc
 s_min_u32 s44, s44, fnet_tab_end-Lpc-8192
 s_and_b32 s46, s46, 3959426067
 s_cselect_b32 s45, 1, 0
 s_cmp_eq_u32 s5, 3
 s_cselect_b32 s45, s45, 0
 s_cmp_eq_u32 s45, 1
 s_cselect_b32 s45, 0, 2146435072
 v_lshlrev_b32 v2, 7, v1
 v_add_u32 v2, s45, v2
 buffer_load_dword v131, v2, s[32:35], s44 offen
 s_branch Llx_3
Lw0_2:
 s_mov_b32 s41, 1
 s_cmp_ge_u32 s38, 80
 s_cbranch_scc1 Lwz_4
 s_mov_b32 s12, s22
 s_and_b32 s13, s23, 0xffff
 s_mov_b32 s14, 819200
 s_mov_b32 s15, 0x20000
 s_mul_i32 s48, s38, 12800
 s_sub_u32 s49, s38, 64
 s_mul_i32 s49, s49, 51200
 s_add_u32 s49, s49, 10240
 s_cmp_lt_u32 s38, 64
 s_cselect_b32 s48, s48, s49
 s_mov_b32 s50, 12800
 s_cselect_b32 s49, 2560, s50
 v_cmp_lt_u32 vcc, 19, v1
 s_nop 1
 v_cndmask_b32_e64 v2, 0, 1, vcc
 v_mul_u32_u24 v3, 20, v2
 v_sub_u32 v3, v1, v3
 v_lshlrev_b32 v3, 7, v3
 v_mul_u32_u24 v184, s49, v2
 v_add_u32 v184, v184, v3
 v_cmp_gt_u32_e64 vcc, 40, v1
 v_mov_b32 v3, 2146435072
 s_nop 0
 v_cndmask_b32 v184, v3, v184, vcc
 buffer_load_dword v128, v184, s[12:15], s48 offen
 s_lshl_b32 s49, s49, 1
 s_add_u32 s48, s48, s49
 buffer_load_dword v129, v184, s[12:15], s48 offen
 s_mov_b32 s41, 2
Lwz_4:
 v_mov_b32 v8, -1
 v_mov_b32 v9, -1
 v_mov_b32 v10, -1
 v_mov_b32 v11, -1
 s_lshl_b32 s48, s4, 14
 s_lshl_b32 s49, s3, 11
 s_add_u32 s48, s48, s49
 v_lshlrev_b32_e64 v2, 4, v1
 s_add_u32 s49, s48, 14548992
 buffer_store_dwordx4 v[8:11], v2, s[8:11], s49 offen sc1
 buffer_store_dwordx4 v[8:11], v2, s[8:11], s49 offen offset:1024 sc1
 s_add_u32 s49, s48, 15073280
 buffer_store_dwordx4 v[8:11], v2, s[8:11], s49 offen sc1
 buffer_store_dwordx4 v[8:11], v2, s[8:11], s49 offen offset:1024 sc1
Llx_3:
 s_mul_i32 s43, s4, 76800
 s_mul_i32 s45, s5, 20480
 s_sub_u32 s45, s45, 4096
 s_max_i32 s45, s45, 0
 s_add_u32 s43, s43, s45
 v_lshlrev_b32_e64 v183, 4, v1
 buffer_load_dwordx4 v[132:135], v183, s[60:63], s43 offen offset:0
 buffer_load_dwordx4 v[132:135], v183, s[60:63], s43 offen offset:1024
 buffer_load_dwordx4 v[132:135], v183, s[60:63], s43 offen offset:2048
 buffer_load_dwordx4 v[132:135], v183, s[60:63], s43 offen offset:3072
 s_add_u32 s43, s43, 4096
 buffer_load_dwordx4 v[132:135], v183, s[60:63], s43 offen offset:0
 buffer_load_dwordx4 v[132:135], v183, s[60:63], s43 offen offset:1024
 buffer_load_dwordx4 v[132:135], v183, s[60:63], s43 offen offset:2048
 buffer_load_dwordx4 v[132:135], v183, s[60:63], s43 offen offset:3072
 s_add_u32 s43, s43, 4096
 buffer_load_dwordx4 v[132:135], v183, s[60:63], s43 offen offset:0
 buffer_load_dwordx4 v[132:135], v183, s[60:63], s43 offen offset:1024
 v_bfe_u32 v185, v1, 3, 1
 v_and_b32 v186, 7, v1
 v_lshrrev_b32 v187, 4, v1
 v_mul_u32_u24 v184, 1280, v185
 v_lshl_add_u32 v184, v186, 3, v184
 v_lshlrev_b32_e64 v3, 4, v185
 v_lshl_add_u32 v3, v186, 3, v3
 v_add_u32 v3, 2520, v3
 v_cmp_lt_u32 vcc, 4, v186
 s_nop 1
 v_cndmask_b32 v184, v184, v3, vcc
 s_mul_i32 s44, s4, 40
 v_add_u32 v184, s44, v184
 s_sub_u32 s46, s5, 1
 s_mul_i32 s46, s46, 28
 v_add_u32 v188, s46, v187
 v_subrev_u32_e64 v189, 2, v188
 v_sub_u32 v2, 120, v188
 v_cmp_lt_u32 vcc, 41, v188
 s_nop 1
 v_cndmask_b32_e64 v189, v189, v2, vcc
 v_cmp_eq_u32 vcc, 0, v188
 s_nop 1
 v_cndmask_b32_e64 v189, v189, 0, vcc
 v_cmp_eq_u32 vcc, 1, v188
 s_nop 1
 v_cndmask_b32_e64 v189, v189, 40, vcc
 v_cmp_eq_u32 vcc, 2, v188
 s_nop 1
 v_cndmask_b32_e64 v189, v189, 1, vcc
 v_mov_b32 v2, 79
 v_cmp_eq_u32 vcc, 3, v188
 s_nop 1
 v_cndmask_b32_e64 v189, v189, v2, vcc
 v_mul_u32_u24 v176, 3840, v189
 v_add_u32_e64 v176, v176, v184
 v_mul_u32_u24 v2, 3840, v188
 v_add_u32 v190, v2, v184
 v_sub_u32 v191, v184, v2
 v_add_u32 v190, 4294959616, v190
 v_add_u32 v191, 460800, v191
 v_add_u32 v190, 15360, v190
 v_subrev_u32 v191, 15360, v191
 v_cmp_lt_u32 vcc, 37, v188
 s_nop 1
 v_cndmask_b32_e64 v177, v190, v191, vcc
 v_add_u32 v190, 15360, v190
 v_subrev_u32 v191, 15360, v191
 v_cmp_lt_u32 vcc, 33, v188
 s_nop 1
 v_cndmask_b32_e64 v178, v190, v191, vcc
 v_add_u32 v190, 15360, v190
 v_subrev_u32 v191, 15360, v191
 v_cmp_lt_u32 vcc, 29, v188
 s_nop 1
 v_cndmask_b32_e64 v179, v190, v191, vcc
 v_add_u32 v190, 15360, v190
 v_subrev_u32 v191, 15360, v191
 v_cmp_lt_u32 vcc, 25, v188
 s_nop 1
 v_cndmask_b32_e64 v180, v190, v191, vcc
 v_add_u32 v190, 15360, v190
 v_subrev_u32 v191, 15360, v191
 v_cmp_lt_u32 vcc, 21, v188
 s_nop 1
 v_cndmask_b32_e64 v181, v190, v191, vcc
 v_add_u32 v190, 15360, v190
 v_subrev_u32 v191, 15360, v191
 v_cmp_lt_u32 vcc, 17, v188
 s_nop 1
 v_cndmask_b32 v182, v190, v191, vcc
 v_lshlrev_b32 v2, 10, v188
 v_lshl_add_u32 v2, v186, 3, v2
 v_lshl_add_u32 v174, v185, 6, v2
 v_xor_b32 v175, 64, v174
 s_mov_b32 s64, 0
 s_mov_b32 s65, 307200
 s_mov_b32 s66, 614400
 s_mov_b32 s67, 921600
 s_mov_b32 s68, 1228800
 s_mov_b32 s69, 1536000
 s_mov_b32 s70, 1843200
 s_mov_b32 s71, 2150400
 v_bfe_u32 v184, v1, 2, 2
 v_and_b32 v185, 3, v1
 v_lshrrev_b32 v186, 5, v1
 v_bfe_u32 v187, v1, 4, 1
 v_lshl_add_u32 v2, v186, 3, v184
 v_lshlrev_b32_e64 v3, 5, v187
 v_lshl_add_u32 v3, v185, 3, v3
 v_lshl_add_u32 v144, v2, 7, v3
 v_mul_u32_u24 v167, 208, v2
 v_add_u32_e64 v167, v167, v3
 v_bfe_u32 v2, v1, 3, 1
 v_lshl_add_u32 v144, v2, 6, v144
 v_xor_b32_e64 v146, 64, v144
 v_add_u32 v145, 0x10000, v144
 v_add_u32 v147, 0x10000, v146
 s_mul_i32 s44, s5, 13312
 s_add_u32 s44, s44, 97280
 v_add_u32 v167, s44, v167
 v_lshlrev_b32 v7, 4, v1
 v_and_b32_e64 v2, 31, v1
 v_mul_u32_u24 v3, 208, v2
 v_add_u32_e64 v3, s44, v3
 v_lshl_add_u32 v164, v186, 5, v3
 v_lshl_add_u32 v165, v186, 3, v3
 v_add_u32 v165, 136, v165
 v_cmp_eq_u32 vcc, 0, v186
 s_nop 1
 v_cndmask_b32_e64 v166, 0, 40, vcc
 v_add_u32_e64 v166, v166, v3
 v_add_u32 v166, 128, v166
 s_mul_i32 s45, s5, 13312
 s_add_u32 s45, s45, 97280
 v_mul_u32_u24 v168, 384, v186
 v_lshl_add_u32 v168, v2, 2, v168
 v_add_u32 v168, s45, v168
 v_mov_b32 v184, 0
 v_mov_b32 v185, 0
 v_mov_b32 v186, 0
 v_mov_b32 v187, 0
 v_lshlrev_b32 v2, 4, v0
 v_add_u32 v2, 150784, v2
 v_cmp_gt_u32 vcc, 192, v0
 v_mov_b32 v3, 154368
 s_nop 0
 v_cndmask_b32 v2, v3, v2, vcc
 ds_write_b128 v2, v[184:187]
 s_mov_b32 s52, 0x3fb8aa3b
 s_mov_b32 s53, 0x3fb8aa3b
 s_mov_b32 s54, 0
 s_mov_b32 s55, -1
 v_mov_b32 v169, 0x3f80
 s_getreg_b32 s48, hwreg(HW_REG_XCC_ID, 0, 4)
 s_add_u32 s48, s48, 1
 s_lshl_b32 s49, s3, 5
 s_add_u32 s50, s49, s4
 v_mov_b32 v170, s48
 v_mov_b32 v171, s50
 v_and_b32 v172, 7, v1
 v_lshlrev_b32 v172, 2, v172
 v_add_u32 v172, s49, v172
 v_mov_b32 v173, 153856
 s_lshl_b32 s48, s5, 5
 s_add_u32 s48, s48, 109568
 v_lshrrev_b32 v189, 5, v1
 v_lshlrev_b32 v189, 4, v189
 v_add_u32_e64 v189, s48, v189
 v_lshl_add_u32 v188, v6, 2, 0
 v_add_u32_e64 v184, 2, v188
 v_sub_u32 v2, 120, v188
 v_cmp_lt_u32 vcc, 39, v188
 s_nop 1
 v_cndmask_b32_e64 v184, v184, v2, vcc
 v_cmp_eq_u32 vcc, 0, v188
 s_nop 1
 v_cndmask_b32_e64 v184, v184, 0, vcc
 v_cmp_eq_u32 vcc, 40, v188
 s_nop 1
 v_cndmask_b32_e64 v184, v184, 1, vcc
 v_cmp_eq_u32_e64 vcc, 1, v188
 s_nop 1
 v_cndmask_b32_e64 v184, v184, 2, vcc
 v_cmp_eq_u32 vcc, 79, v188
 s_nop 1
 v_cndmask_b32_e64 v184, v184, 3, vcc
 v_lshl_add_u32 v184, v184, 7, v189
 v_lshl_add_u32 v188, v6, 2, 1
 v_add_u32_e64 v185, 2, v188
 v_sub_u32 v2, 120, v188
 v_cmp_lt_u32 vcc, 39, v188
 s_nop 1
 v_cndmask_b32_e64 v185, v185, v2, vcc
 v_cmp_eq_u32 vcc, 0, v188
 s_nop 1
 v_cndmask_b32_e64 v185, v185, 0, vcc
 v_cmp_eq_u32 vcc, 40, v188
 s_nop 1
 v_cndmask_b32_e64 v185, v185, 1, vcc
 v_cmp_eq_u32_e64 vcc, 1, v188
 s_nop 1
 v_cndmask_b32_e64 v185, v185, 2, vcc
 v_cmp_eq_u32 vcc, 79, v188
 s_nop 1
 v_cndmask_b32_e64 v185, v185, 3, vcc
 v_lshl_add_u32 v185, v185, 7, v189
 v_lshl_add_u32 v188, v6, 2, 2
 v_add_u32_e64 v186, 2, v188
 v_sub_u32 v2, 120, v188
 v_cmp_lt_u32 vcc, 39, v188
 s_nop 1
 v_cndmask_b32_e64 v186, v186, v2, vcc
 v_cmp_eq_u32 vcc, 0, v188
 s_nop 1
 v_cndmask_b32_e64 v186, v186, 0, vcc
 v_cmp_eq_u32 vcc, 40, v188
 s_nop 1
 v_cndmask_b32_e64 v186, v186, 1, vcc
 v_cmp_eq_u32_e64 vcc, 1, v188
 s_nop 1
 v_cndmask_b32_e64 v186, v186, 2, vcc
 v_cmp_eq_u32 vcc, 79, v188
 s_nop 1
 v_cndmask_b32_e64 v186, v186, 3, vcc
 v_lshl_add_u32 v186, v186, 7, v189
 v_lshl_add_u32 v188, v6, 2, 3
 v_add_u32_e64 v187, 2, v188
 v_sub_u32 v2, 120, v188
 v_cmp_lt_u32 vcc, 39, v188
 s_nop 1
 v_cndmask_b32_e64 v187, v187, v2, vcc
 v_cmp_eq_u32 vcc, 0, v188
 s_nop 1
 v_cndmask_b32_e64 v187, v187, 0, vcc
 v_cmp_eq_u32 vcc, 40, v188
 s_nop 1
 v_cndmask_b32_e64 v187, v187, 1, vcc
 v_cmp_eq_u32 vcc, 1, v188
 s_nop 1
 v_cndmask_b32_e64 v187, v187, 2, vcc
 v_cmp_eq_u32 vcc, 79, v188
 s_nop 1
 v_cndmask_b32_e64 v187, v187, 3, vcc
 v_lshl_add_u32 v187, v187, 7, v189
 v_cmp_gt_u32 vcc, 20, v6
 v_mov_b32 v2, 130048
 s_nop 0
 v_cndmask_b32 v184, v2, v184, vcc
 v_cndmask_b32 v185, v2, v185, vcc
 v_cndmask_b32 v186, v2, v186, vcc
 v_cndmask_b32 v187, v2, v187, vcc
 s_cmp_eq_u32 s41, 0
 s_cbranch_scc1 Lxa_5
 s_cmp_eq_u32 s41, 1
 s_cbranch_scc1 Lxb_6
 s_waitcnt vmcnt(16)
 s_branch Lxc_7
Lxb_6:
 s_waitcnt vmcnt(14)
 s_branch Lxc_7
Lxa_5:
 s_waitcnt vmcnt(17)
Lxc_7:
 v_lshlrev_b32_e64 v188, 16, v148
 v_and_b32 v196, 0xffff0000, v148
 v_lshlrev_b32_e64 v204, 16, v149
 v_and_b32 v212, 0xffff0000, v149
 v_lshlrev_b32_e64 v189, 16, v150
 v_and_b32 v197, 0xffff0000, v150
 v_lshlrev_b32_e64 v205, 16, v151
 v_and_b32 v213, 0xffff0000, v151
 v_lshlrev_b32_e64 v190, 16, v152
 v_and_b32 v198, 0xffff0000, v152
 v_lshlrev_b32_e64 v206, 16, v153
 v_and_b32 v214, 0xffff0000, v153
 v_lshlrev_b32_e64 v191, 16, v154
 buffer_load_dwordx4 v[132:135], v183, s[60:63], s43 offen offset:2048
 v_and_b32 v199, 0xffff0000, v154
 v_lshlrev_b32_e64 v207, 16, v155
 v_and_b32 v215, 0xffff0000, v155
 v_lshlrev_b32_e64 v192, 16, v156
 v_and_b32 v200, 0xffff0000, v156
 v_lshlrev_b32_e64 v208, 16, v157
 v_and_b32 v216, 0xffff0000, v157
 v_lshlrev_b32_e64 v193, 16, v158
 v_and_b32 v201, 0xffff0000, v158
 v_lshlrev_b32_e64 v209, 16, v159
 v_and_b32 v217, 0xffff0000, v159
 v_lshlrev_b32_e64 v194, 16, v160
 v_and_b32 v202, 0xffff0000, v160
 buffer_load_dwordx4 v[132:135], v183, s[60:63], s43 offen offset:3072
 s_add_u32 s43, s43, 4096
 v_lshlrev_b32_e64 v210, 16, v161
 v_and_b32 v218, 0xffff0000, v161
 v_lshlrev_b32_e64 v195, 16, v162
 v_and_b32 v203, 0xffff0000, v162
 v_lshlrev_b32_e64 v211, 16, v163
 v_and_b32 v219, 0xffff0000, v163
 v_pk_add_f32 v[220:221], v[188:189], v[190:191]
 v_pk_mul_f32 v[222:223], v[188:189], v[188:189]
 v_pk_fma_f32 v[222:223], v[190:191], v[190:191], v[222:223]
 v_pk_add_f32 v[220:221], v[220:221], v[192:193]
 v_pk_fma_f32 v[222:223], v[192:193], v[192:193], v[222:223]
 v_pk_add_f32 v[220:221], v[220:221], v[194:195]
 v_pk_fma_f32 v[222:223], v[194:195], v[194:195], v[222:223]
 buffer_load_dwordx4 v[132:135], v183, s[60:63], s43 offen offset:0
 v_pk_add_f32 v[220:221], v[220:221], v[196:197]
 v_pk_fma_f32 v[222:223], v[196:197], v[196:197], v[222:223]
 v_pk_add_f32 v[220:221], v[220:221], v[198:199]
 v_pk_fma_f32 v[222:223], v[198:199], v[198:199], v[222:223]
 v_pk_add_f32 v[220:221], v[220:221], v[200:201]
 v_pk_fma_f32 v[222:223], v[200:201], v[200:201], v[222:223]
 v_pk_add_f32 v[220:221], v[220:221], v[202:203]
 v_pk_fma_f32 v[222:223], v[202:203], v[202:203], v[222:223]
 v_pk_add_f32 v[220:221], v[220:221], v[204:205]
 v_pk_fma_f32 v[222:223], v[204:205], v[204:205], v[222:223]
 v_pk_add_f32 v[220:221], v[220:221], v[206:207]
 v_pk_fma_f32 v[222:223], v[206:207], v[206:207], v[222:223]
 v_pk_add_f32 v[220:221], v[220:221], v[208:209]
 buffer_load_dwordx4 v[132:135], v183, s[60:63], s43 offen offset:1024
 v_pk_fma_f32 v[222:223], v[208:209], v[208:209], v[222:223]
 v_pk_add_f32 v[220:221], v[220:221], v[210:211]
 v_pk_fma_f32 v[222:223], v[210:211], v[210:211], v[222:223]
 v_pk_add_f32 v[220:221], v[220:221], v[212:213]
 v_pk_fma_f32 v[222:223], v[212:213], v[212:213], v[222:223]
 v_pk_add_f32 v[220:221], v[220:221], v[214:215]
 v_pk_fma_f32 v[222:223], v[214:215], v[214:215], v[222:223]
 v_pk_add_f32 v[220:221], v[220:221], v[216:217]
 v_pk_fma_f32 v[222:223], v[216:217], v[216:217], v[222:223]
 v_pk_add_f32 v[220:221], v[220:221], v[218:219]
 v_pk_fma_f32 v[222:223], v[218:219], v[218:219], v[222:223]
 v_add_f32 v220, v220, v221
 v_add_f32 v222, v222, v223
 buffer_load_dwordx4 v[132:135], v183, s[60:63], s43 offen offset:2048
 v_add_f32_dpp v220, v220, v220 row_ror:8 row_mask:0xf bank_mask:0xf
 s_nop 1
 v_add_f32_dpp v220, v220, v220 row_ror:4 row_mask:0xf bank_mask:0xf
 s_nop 1
 v_add_f32_dpp v220, v220, v220 row_ror:2 row_mask:0xf bank_mask:0xf
 s_nop 1
 v_add_f32_dpp v220, v220, v220 row_ror:1 row_mask:0xf bank_mask:0xf
 v_mov_b32 v2, v220
 s_nop 1
 v_permlane16_swap_b32 v2, v220
 v_add_f32 v220, v220, v2
 v_add_f32_dpp v222, v222, v222 row_ror:8 row_mask:0xf bank_mask:0xf
 s_nop 1
 v_add_f32_dpp v222, v222, v222 row_ror:4 row_mask:0xf bank_mask:0xf
 s_nop 1
 v_add_f32_dpp v222, v222, v222 row_ror:2 row_mask:0xf bank_mask:0xf
 s_nop 1
 v_add_f32_dpp v222, v222, v222 row_ror:1 row_mask:0xf bank_mask:0xf
 v_mov_b32_e64 v3, v222
 s_nop 1
 v_permlane16_swap_b32 v3, v222
 buffer_load_dwordx4 v[132:135], v183, s[60:63], s43 offen offset:3072
 s_add_u32 s43, s43, 4096
 v_add_f32_e64 v222, v222, v3
 v_mul_f32 v220, 0x3acccccd, v220
 v_mul_f32 v222, 0x3acccccd, v222
 v_fma_f32 v222, -v220, v220, v222
 v_add_f32 v222, 0x3727c5ac, v222
 v_rsq_f32 v222, v222
 s_nop 0
 v_mul_f32_e64 v220, -v220, v222
 v_pk_fma_f32 v[188:189], v[188:189], v[222:223], v[220:221] op_sel_hi:[1,0,0]
 v_pk_fma_f32 v[190:191], v[190:191], v[222:223], v[220:221] op_sel_hi:[1,0,0]
 v_pk_fma_f32 v[192:193], v[192:193], v[222:223], v[220:221] op_sel_hi:[1,0,0]
 v_pk_fma_f32 v[194:195], v[194:195], v[222:223], v[220:221] op_sel_hi:[1,0,0]
 v_pk_fma_f32 v[196:197], v[196:197], v[222:223], v[220:221] op_sel_hi:[1,0,0]
 v_pk_fma_f32 v[198:199], v[198:199], v[222:223], v[220:221] op_sel_hi:[1,0,0]
 buffer_load_dwordx4 v[132:135], v183, s[60:63], s43 offen offset:0
 v_pk_fma_f32 v[200:201], v[200:201], v[222:223], v[220:221] op_sel_hi:[1,0,0]
 v_pk_fma_f32 v[202:203], v[202:203], v[222:223], v[220:221] op_sel_hi:[1,0,0]
 v_pk_fma_f32 v[204:205], v[204:205], v[222:223], v[220:221] op_sel_hi:[1,0,0]
 v_pk_fma_f32 v[206:207], v[206:207], v[222:223], v[220:221] op_sel_hi:[1,0,0]
 v_pk_fma_f32 v[208:209], v[208:209], v[222:223], v[220:221] op_sel_hi:[1,0,0]
 v_pk_fma_f32 v[210:211], v[210:211], v[222:223], v[220:221] op_sel_hi:[1,0,0]
 v_pk_fma_f32 v[212:213], v[212:213], v[222:223], v[220:221] op_sel_hi:[1,0,0]
 v_pk_fma_f32 v[214:215], v[214:215], v[222:223], v[220:221] op_sel_hi:[1,0,0]
 v_pk_fma_f32 v[216:217], v[216:217], v[222:223], v[220:221] op_sel_hi:[1,0,0]
 v_pk_fma_f32 v[218:219], v[218:219], v[222:223], v[220:221] op_sel_hi:[1,0,0]
 v_cvt_pk_bf16_f32 v224, v188, v189
 v_cvt_pk_bf16_f32 v225, v190, v191
 v_cvt_pk_bf16_f32 v226, v192, v193
 buffer_load_dwordx4 v[132:135], v183, s[60:63], s43 offen offset:1024
 v_cvt_pk_bf16_f32 v227, v194, v195
 ds_write_b128 v184, v[224:227]
 v_cvt_pk_bf16_f32 v228, v196, v197
 v_cvt_pk_bf16_f32 v229, v198, v199
 v_cvt_pk_bf16_f32 v230, v200, v201
 v_cvt_pk_bf16_f32 v231, v202, v203
 ds_write_b128 v185, v[228:231]
 v_cvt_pk_bf16_f32 v232, v204, v205
 v_cvt_pk_bf16_f32 v233, v206, v207
 v_cvt_pk_bf16_f32 v234, v208, v209
 v_cvt_pk_bf16_f32 v235, v210, v211
 ds_write_b128 v186, v[232:235]
 v_cvt_pk_bf16_f32 v236, v212, v213
 v_cvt_pk_bf16_f32 v237, v214, v215
 v_cvt_pk_bf16_f32 v238, v216, v217
 v_cvt_pk_bf16_f32 v239, v218, v219
 ds_write_b128 v187, v[236:239]
 s_waitcnt lgkmcnt(0)
 s_cmp_eq_u32 s5, 0
 s_cbranch_scc1 Lw0b_8
 s_barrier
 buffer_load_dwordx4 v[132:135], v183, s[60:63], s43 offen offset:2048
 buffer_load_dwordx4 v[132:135], v183, s[60:63], s43 offen offset:3072
 s_add_u32 s43, s43, 4096
 s_call_b64 s[36:37], Lsub_raw
 s_call_b64 s[36:37], Lsub_phi
 s_waitcnt vmcnt(0)
 s_barrier
 buffer_load_dwordx2 v[8:9], v176, s[60:63], s64 offen
 buffer_load_dwordx2 v[10:11], v176, s[60:63], s65 offen
 buffer_load_dwordx2 v[12:13], v176, s[60:63], s66 offen
 buffer_load_dwordx2 v[14:15], v176, s[60:63], s67 offen
 buffer_load_dwordx2 v[16:17], v176, s[60:63], s68 offen
 buffer_load_dwordx2 v[18:19], v176, s[60:63], s69 offen
 buffer_load_dwordx2 v[20:21], v176, s[60:63], s70 offen
 buffer_load_dwordx2 v[22:23], v176, s[60:63], s71 offen
 buffer_load_dwordx2 v[24:25], v177, s[60:63], s64 offen
 buffer_load_dwordx2 v[26:27], v177, s[60:63], s65 offen
 buffer_load_dwordx2 v[28:29], v177, s[60:63], s66 offen
 buffer_load_dwordx2 v[30:31], v177, s[60:63], s67 offen
 buffer_load_dwordx2 v[32:33], v177, s[60:63], s68 offen
 buffer_load_dwordx2 v[34:35], v177, s[60:63], s69 offen
 buffer_load_dwordx2 v[36:37], v177, s[60:63], s70 offen
 buffer_load_dwordx2 v[38:39], v177, s[60:63], s71 offen
 buffer_load_dwordx2 v[40:41], v178, s[60:63], s64 offen
 buffer_load_dwordx2 v[42:43], v178, s[60:63], s65 offen
 buffer_load_dwordx2 v[44:45], v178, s[60:63], s66 offen
 buffer_load_dwordx2 v[46:47], v178, s[60:63], s67 offen
 buffer_load_dwordx2 v[48:49], v178, s[60:63], s68 offen
 buffer_load_dwordx2 v[50:51], v178, s[60:63], s69 offen
 buffer_load_dwordx2 v[52:53], v178, s[60:63], s70 offen
 buffer_load_dwordx2 v[54:55], v178, s[60:63], s71 offen
 buffer_load_dwordx2 v[56:57], v179, s[60:63], s64 offen
 s_waitcnt vmcnt(24)
 ds_write_b64 v174, v[8:9] offset:0
 buffer_load_dwordx2 v[58:59], v179, s[60:63], s65 offen
 s_waitcnt vmcnt(24)
 ds_write_b64 v174, v[10:11] offset:128
 buffer_load_dwordx2 v[60:61], v179, s[60:63], s66 offen
 s_waitcnt vmcnt(24)
 ds_write_b64 v175, v[12:13] offset:256
 buffer_load_dwordx2 v[62:63], v179, s[60:63], s67 offen
 s_waitcnt vmcnt(24)
 ds_write_b64 v175, v[14:15] offset:384
 buffer_load_dwordx2 v[64:65], v179, s[60:63], s68 offen
 s_waitcnt vmcnt(24)
 ds_write_b64 v174, v[16:17] offset:512
 buffer_load_dwordx2 v[66:67], v179, s[60:63], s69 offen
 s_waitcnt vmcnt(24)
 ds_write_b64 v174, v[18:19] offset:640
 buffer_load_dwordx2 v[68:69], v179, s[60:63], s70 offen
 s_waitcnt vmcnt(24)
 ds_write_b64 v175, v[20:21] offset:768
 buffer_load_dwordx2 v[70:71], v179, s[60:63], s71 offen
 s_waitcnt vmcnt(24)
 ds_write_b64 v175, v[22:23] offset:896
 buffer_load_dwordx2 v[72:73], v180, s[60:63], s64 offen
 s_waitcnt vmcnt(24)
 ds_write_b64 v174, v[24:25] offset:4096
 buffer_load_dwordx2 v[74:75], v180, s[60:63], s65 offen
 s_waitcnt vmcnt(24)
 ds_write_b64 v174, v[26:27] offset:4224
 buffer_load_dwordx2 v[76:77], v180, s[60:63], s66 offen
 s_waitcnt vmcnt(24)
 ds_write_b64 v175, v[28:29] offset:4352
 buffer_load_dwordx2 v[78:79], v180, s[60:63], s67 offen
 s_waitcnt vmcnt(24)
 ds_write_b64 v175, v[30:31] offset:4480
 buffer_load_dwordx2 v[80:81], v180, s[60:63], s68 offen
 s_waitcnt vmcnt(24)
 ds_write_b64 v174, v[32:33] offset:4608
 buffer_load_dwordx2 v[82:83], v180, s[60:63], s69 offen
 s_waitcnt vmcnt(24)
 ds_write_b64 v174, v[34:35] offset:4736
 buffer_load_dwordx2 v[84:85], v180, s[60:63], s70 offen
 s_waitcnt vmcnt(24)
 ds_write_b64 v175, v[36:37] offset:4864
 buffer_load_dwordx2 v[86:87], v180, s[60:63], s71 offen
 s_waitcnt vmcnt(24)
 ds_write_b64 v175, v[38:39] offset:4992
 buffer_load_dwordx2 v[88:89], v181, s[60:63], s64 offen
 s_waitcnt vmcnt(24)
 ds_write_b64 v174, v[40:41] offset:8192
 buffer_load_dwordx2 v[90:91], v181, s[60:63], s65 offen
 s_waitcnt vmcnt(24)
 ds_write_b64 v174, v[42:43] offset:8320
 buffer_load_dwordx2 v[92:93], v181, s[60:63], s66 offen
 s_waitcnt vmcnt(24)
 ds_write_b64 v175, v[44:45] offset:8448
 buffer_load_dwordx2 v[94:95], v181, s[60:63], s67 offen
 s_waitcnt vmcnt(24)
 ds_write_b64 v175, v[46:47] offset:8576
 buffer_load_dwordx2 v[96:97], v181, s[60:63], s68 offen
 s_waitcnt vmcnt(24)
 ds_write_b64 v174, v[48:49] offset:8704
 buffer_load_dwordx2 v[98:99], v181, s[60:63], s69 offen
 s_waitcnt vmcnt(24)
 ds_write_b64 v174, v[50:51] offset:8832
 buffer_load_dwordx2 v[100:101], v181, s[60:63], s70 offen
 s_waitcnt vmcnt(24)
 ds_write_b64 v175, v[52:53] offset:8960
 buffer_load_dwordx2 v[102:103], v181, s[60:63], s71 offen
 s_waitcnt vmcnt(24)
 ds_write_b64 v175, v[54:55] offset:9088
 s_cmp_eq_u32 s5, 3
 s_cbranch_scc1 Lwg3_9
 buffer_load_dwordx2 v[104:105], v182, s[60:63], s64 offen
 s_waitcnt vmcnt(24)
 ds_write_b64 v174, v[56:57] offset:12288
 buffer_load_dwordx2 v[106:107], v182, s[60:63], s65 offen
 s_waitcnt vmcnt(24)
 ds_write_b64 v174, v[58:59] offset:12416
 buffer_load_dwordx2 v[108:109], v182, s[60:63], s66 offen
 s_waitcnt vmcnt(24)
 ds_write_b64 v175, v[60:61] offset:12544
 buffer_load_dwordx2 v[110:111], v182, s[60:63], s67 offen
 s_waitcnt vmcnt(24)
 ds_write_b64 v175, v[62:63] offset:12672
 buffer_load_dwordx2 v[112:113], v182, s[60:63], s68 offen
 s_waitcnt vmcnt(24)
 ds_write_b64 v174, v[64:65] offset:12800
 buffer_load_dwordx2 v[114:115], v182, s[60:63], s69 offen
 s_waitcnt vmcnt(24)
 ds_write_b64 v174, v[66:67] offset:12928
 buffer_load_dwordx2 v[116:117], v182, s[60:63], s70 offen
 s_waitcnt vmcnt(24)
 ds_write_b64 v175, v[68:69] offset:13056
 buffer_load_dwordx2 v[118:119], v182, s[60:63], s71 offen
 s_waitcnt vmcnt(24)
 ds_write_b64 v175, v[70:71] offset:13184
 s_barrier
 s_waitcnt vmcnt(20)
 ds_write_b64 v174, v[72:73] offset:16384
 ds_write_b64 v174, v[74:75] offset:16512
 ds_write_b64 v175, v[76:77] offset:16640
 ds_write_b64 v175, v[78:79] offset:16768
 s_waitcnt vmcnt(16)
 ds_write_b64 v174, v[80:81] offset:16896
 ds_write_b64 v174, v[82:83] offset:17024
 ds_write_b64 v175, v[84:85] offset:17152
 ds_write_b64 v175, v[86:87] offset:17280
 s_waitcnt vmcnt(12)
 ds_write_b64 v174, v[88:89] offset:20480
 ds_write_b64 v174, v[90:91] offset:20608
 ds_write_b64 v175, v[92:93] offset:20736
 ds_write_b64 v175, v[94:95] offset:20864
 s_waitcnt vmcnt(8)
 ds_write_b64 v174, v[96:97] offset:20992
 ds_write_b64 v174, v[98:99] offset:21120
 ds_write_b64 v175, v[100:101] offset:21248
 ds_write_b64 v175, v[102:103] offset:21376
 s_waitcnt vmcnt(4)
 ds_write_b64 v174, v[104:105] offset:24576
 ds_write_b64 v174, v[106:107] offset:24704
 ds_write_b64 v175, v[108:109] offset:24832
 ds_write_b64 v175, v[110:111] offset:24960
 s_waitcnt vmcnt(0)
 ds_write_b64 v174, v[112:113] offset:25088
 ds_write_b64 v174, v[114:115] offset:25216
 ds_write_b64 v175, v[116:117] offset:25344
 ds_write_b64 v175, v[118:119] offset:25472
 s_branch Lwgj_10
Lwg3_9:
 s_barrier
 s_waitcnt vmcnt(20)
 ds_write_b64 v174, v[56:57] offset:12288
 ds_write_b64 v174, v[58:59] offset:12416
 ds_write_b64 v175, v[60:61] offset:12544
 ds_write_b64 v175, v[62:63] offset:12672
 s_waitcnt vmcnt(16)
 ds_write_b64 v174, v[64:65] offset:12800
 ds_write_b64 v174, v[66:67] offset:12928
 ds_write_b64 v175, v[68:69] offset:13056
 ds_write_b64 v175, v[70:71] offset:13184
 s_waitcnt vmcnt(12)
 ds_write_b64 v174, v[72:73] offset:16384
 ds_write_b64 v174, v[74:75] offset:16512
 ds_write_b64 v175, v[76:77] offset:16640
 ds_write_b64 v175, v[78:79] offset:16768
 s_waitcnt vmcnt(8)
 ds_write_b64 v174, v[80:81] offset:16896
 ds_write_b64 v174, v[82:83] offset:17024
 ds_write_b64 v175, v[84:85] offset:17152
 ds_write_b64 v175, v[86:87] offset:17280
 s_waitcnt vmcnt(4)
 ds_write_b64 v174, v[88:89] offset:20480
 ds_write_b64 v174, v[90:91] offset:20608
 ds_write_b64 v175, v[92:93] offset:20736
 ds_write_b64 v175, v[94:95] offset:20864
 s_waitcnt vmcnt(0)
 ds_write_b64 v174, v[96:97] offset:20992
 ds_write_b64 v174, v[98:99] offset:21120
 ds_write_b64 v175, v[100:101] offset:21248
 ds_write_b64 v175, v[102:103] offset:21376
Lwgj_10:
 s_waitcnt vmcnt(0) lgkmcnt(0)
 s_barrier
 v_mov_b32 v3, 153856
 ds_read_b32 v2, v3
 s_waitcnt lgkmcnt(0)
 v_readfirstlane_b32 s41, v2
 s_nop 0
 s_cmp_eq_u32 s41, 0
 s_cbranch_scc1 Lgp_11
 s_branch Lentry_fast
Lgp_11:
 s_branch Lentry_slow
Lw0b_8:
 s_barrier
 v_mov_b32 v2, 0
 s_cmp_lg_u32 s4, 0
 s_cbranch_scc1 Lz0_12
 buffer_store_dword v2, v5, s[8:11], 0 offen sc1
Lz0_12:
 s_cmp_ge_u32 s38, 80
 s_cbranch_scc1 Lnp_14
 s_mov_b32 s12, s22
 s_and_b32 s13, s23, 0xffff
 s_mov_b32 s14, 819200
 s_mov_b32 s15, 0x20000
 v_lshlrev_b32 v188, 4, v1
 s_mul_i32 s48, s38, 10
 s_sub_u32 s49, s38, 64
 s_mul_i32 s49, s49, 40
 s_cmp_lt_u32 s38, 64
 s_cselect_b32 s48, s48, s49
 s_cselect_b32 s49, 1, 0
 s_cmp_eq_u32 s49, 1
 s_cselect_b32 s72, 0, 8
 s_add_u32 s72, s72, s48
 s_mul_i32 s72, s72, 1280
 s_cmp_eq_u32 s49, 1
 s_cselect_b32 s73, 1, 9
 s_add_u32 s73, s73, s48
 s_mul_i32 s73, s73, 1280
 s_cmp_eq_u32 s49, 1
 s_cselect_b32 s74, 2, 18
 s_add_u32 s74, s74, s48
 s_mul_i32 s74, s74, 1280
 s_cmp_eq_u32 s49, 1
 s_cselect_b32 s75, 3, 19
 s_add_u32 s75, s75, s48
 s_mul_i32 s75, s75, 1280
 s_cmp_eq_u32 s49, 1
 s_cselect_b32 s76, 4, 28
 s_add_u32 s76, s76, s48
 s_mul_i32 s76, s76, 1280
 s_cmp_eq_u32 s49, 1
 s_cselect_b32 s77, 5, 29
 s_add_u32 s77, s77, s48
 s_mul_i32 s77, s77, 1280
 s_cmp_eq_u32 s49, 1
 s_cselect_b32 s78, 6, 38
 s_add_u32 s78, s78, s48
 s_mul_i32 s78, s78, 1280
 s_cmp_eq_u32 s49, 1
 s_cselect_b32 s79, 7, 39
 s_add_u32 s79, s79, s48
 s_mul_i32 s79, s79, 1280
 s_mov_b32 m0, 97280
 s_nop 0
 buffer_load_dwordx4 v188, s[12:15], s72 offen lds
 s_mov_b32 m0, 98576
 s_nop 0
 buffer_load_dwordx4 v188, s[12:15], s73 offen lds
 s_mov_b32 m0, 99872
 s_nop 0
 buffer_load_dwordx4 v188, s[12:15], s74 offen lds
 s_mov_b32 m0, 101168
 s_nop 0
 buffer_load_dwordx4 v188, s[12:15], s75 offen lds
 s_mov_b32 m0, 102464
 s_nop 0
 buffer_load_dwordx4 v188, s[12:15], s76 offen lds
 s_mov_b32 m0, 103760
 s_nop 0
 buffer_load_dwordx4 v188, s[12:15], s77 offen lds
 s_mov_b32 m0, 105056
 s_nop 0
 buffer_load_dwordx4 v188, s[12:15], s78 offen lds
 s_mov_b32 m0, 106352
 s_nop 0
 buffer_load_dwordx4 v188, s[12:15], s79 offen lds
 s_mov_b64 s[6:7], exec
 s_mov_b64 exec, 0xffff
 s_mov_b32 m0, 98304
 s_add_u32 s72, s72, 1024
 buffer_load_dwordx4 v188, s[12:15], s72 offen lds
 s_mov_b32 m0, 99600
 s_add_u32 s73, s73, 1024
 buffer_load_dwordx4 v188, s[12:15], s73 offen lds
 s_mov_b32 m0, 100896
 s_add_u32 s74, s74, 1024
 buffer_load_dwordx4 v188, s[12:15], s74 offen lds
 s_mov_b32 m0, 102192
 s_add_u32 s75, s75, 1024
 buffer_load_dwordx4 v188, s[12:15], s75 offen lds
 s_mov_b32 m0, 103488
 s_add_u32 s76, s76, 1024
 buffer_load_dwordx4 v188, s[12:15], s76 offen lds
 s_mov_b32 m0, 104784
 s_add_u32 s77, s77, 1024
 buffer_load_dwordx4 v188, s[12:15], s77 offen lds
 s_mov_b32 m0, 106080
 s_add_u32 s78, s78, 1024
 buffer_load_dwordx4 v188, s[12:15], s78 offen lds
 s_mov_b32 m0, 107376
 s_add_u32 s79, s79, 1024
 buffer_load_dwordx4 v188, s[12:15], s79 offen lds
 s_mov_b64 exec, s[6:7]
 v_mov_b32 v2, 0
 s_lshl_b32 s48, s38, 6
 s_add_u32 s48, s48, 12288
 v_mov_b32 v3, s48
 s_mov_b64 s[6:7], exec
 s_mov_b64 exec, 1
 buffer_store_dword v2, v3, s[8:11], 0 offen sc1
 s_mov_b64 exec, s[6:7]
Lnp_14:
 v_lshlrev_b32 v188, 4, v1
 v_add_u32 v188, 109568, v188
 v_lshrrev_b32 v189, 3, v1
 v_lshlrev_b32 v189, 9, v189
 v_and_b32_e64 v2, 7, v1
 v_lshl_add_u32 v189, v2, 4, v189
 s_mul_i32 s44, s3, 327680
 s_lshr_b32 s45, s4, 2
 s_mul_i32 s45, s45, 40960
 s_add_u32 s44, s44, s45
 s_and_b32 s45, s4, 3
 s_lshl_b32 s45, s45, 7
 s_add_u32 s44, s44, s45
 s_waitcnt lgkmcnt(0)
 ds_read_b128 v[8:11], v188 offset:0
 ds_read_b128 v[12:15], v188 offset:1024
 ds_read_b128 v[16:19], v188 offset:2048
 ds_read_b128 v[20:23], v188 offset:3072
 ds_read_b128 v[24:27], v188 offset:4096
 ds_read_b128 v[28:31], v188 offset:5120
 ds_read_b128 v[32:35], v188 offset:6144
 ds_read_b128 v[36:39], v188 offset:7168
 ds_read_b128 v[40:43], v188 offset:8192
 ds_read_b128 v[44:47], v188 offset:9216
 s_waitcnt lgkmcnt(9)
 s_add_u32 s45, s44, 3670016
 buffer_store_dwordx4 v[8:11], v189, s[8:11], s45 offen sc1
 s_waitcnt lgkmcnt(8)
 s_add_u32 s45, s44, 3674112
 buffer_store_dwordx4 v[12:15], v189, s[8:11], s45 offen sc1
 s_waitcnt lgkmcnt(7)
 s_add_u32 s45, s44, 3678208
 buffer_store_dwordx4 v[16:19], v189, s[8:11], s45 offen sc1
 s_waitcnt lgkmcnt(6)
 s_add_u32 s45, s44, 3682304
 buffer_store_dwordx4 v[20:23], v189, s[8:11], s45 offen sc1
 s_waitcnt lgkmcnt(5)
 s_add_u32 s45, s44, 3686400
 buffer_store_dwordx4 v[24:27], v189, s[8:11], s45 offen sc1
 s_waitcnt lgkmcnt(4)
 s_add_u32 s45, s44, 3690496
 buffer_store_dwordx4 v[28:31], v189, s[8:11], s45 offen sc1
 s_waitcnt lgkmcnt(3)
 s_add_u32 s45, s44, 3694592
 buffer_store_dwordx4 v[32:35], v189, s[8:11], s45 offen sc1
 s_waitcnt lgkmcnt(2)
 s_add_u32 s45, s44, 3698688
 buffer_store_dwordx4 v[36:39], v189, s[8:11], s45 offen sc1
 s_waitcnt lgkmcnt(1)
 s_add_u32 s45, s44, 3702784
 buffer_store_dwordx4 v[40:43], v189, s[8:11], s45 offen sc1
 s_waitcnt lgkmcnt(0)
 s_add_u32 s45, s44, 3706880
 buffer_store_dwordx4 v[44:47], v189, s[8:11], s45 offen sc1
 s_cmp_ge_u32 s38, 80
 s_cbranch_scc1 Ln2_16
 s_waitcnt vmcnt(11)
 v_lshrrev_b32 v2, 4, v1
 v_lshlrev_b32 v188, 2, v2
 v_mul_u32_u24 v189, 204800, v2
 v_and_b32_e64 v3, 15, v1
 v_lshl_add_u32 v189, v3, 4, v189
 v_bfe_u32 v2, v1, 3, 1
 v_lshl_add_u32 v188, v2, 4, v188
 v_and_b32_e64 v2, 7, v1
 v_mul_u32_u24 v2, 160, v2
 v_add_u32 v188, v188, v2
 v_add_u32 v188, 97280, v188
 s_mov_b32 s47, 0x05040100
 s_mov_b32 s48, 0x07060302
 ds_read_b32 v190, v188 offset:0
 ds_read_b32 v191, v188 offset:1296
 ds_read_b32 v192, v188 offset:2592
 ds_read_b32 v193, v188 offset:3888
 ds_read_b32 v194, v188 offset:5184
 ds_read_b32 v195, v188 offset:6480
 ds_read_b32 v196, v188 offset:7776
 ds_read_b32 v197, v188 offset:9072
 s_waitcnt lgkmcnt(0)
 v_perm_b32 v72, v191, v190, s47
 v_perm_b32 v76, v191, v190, s48
 v_perm_b32 v73, v193, v192, s47
 v_perm_b32 v77, v193, v192, s48
 v_perm_b32 v74, v195, v194, s47
 v_perm_b32 v78, v195, v194, s48
 v_perm_b32 v75, v197, v196, s47
 v_perm_b32 v79, v197, v196, s48
 ds_read_b32 v190, v188 offset:32
 ds_read_b32 v191, v188 offset:1328
 ds_read_b32 v192, v188 offset:2624
 ds_read_b32 v193, v188 offset:3920
 ds_read_b32 v194, v188 offset:5216
 ds_read_b32 v195, v188 offset:6512
 ds_read_b32 v196, v188 offset:7808
 ds_read_b32 v197, v188 offset:9104
 s_waitcnt lgkmcnt(0)
 v_perm_b32 v80, v191, v190, s47
 v_perm_b32 v84, v191, v190, s48
 v_perm_b32 v81, v193, v192, s47
 v_perm_b32 v85, v193, v192, s48
 v_perm_b32 v82, v195, v194, s47
 v_perm_b32 v86, v195, v194, s48
 v_perm_b32 v83, v197, v196, s47
 v_perm_b32 v87, v197, v196, s48
 ds_read_b32 v190, v188 offset:64
 ds_read_b32 v191, v188 offset:1360
 ds_read_b32 v192, v188 offset:2656
 ds_read_b32 v193, v188 offset:3952
 ds_read_b32 v194, v188 offset:5248
 ds_read_b32 v195, v188 offset:6544
 ds_read_b32 v196, v188 offset:7840
 ds_read_b32 v197, v188 offset:9136
 s_waitcnt lgkmcnt(0)
 v_perm_b32 v88, v191, v190, s47
 v_perm_b32 v92, v191, v190, s48
 v_perm_b32 v89, v193, v192, s47
 v_perm_b32 v93, v193, v192, s48
 v_perm_b32 v90, v195, v194, s47
 v_perm_b32 v94, v195, v194, s48
 v_perm_b32 v91, v197, v196, s47
 v_perm_b32 v95, v197, v196, s48
 ds_read_b32 v190, v188 offset:96
 ds_read_b32 v191, v188 offset:1392
 ds_read_b32 v192, v188 offset:2688
 ds_read_b32 v193, v188 offset:3984
 ds_read_b32 v194, v188 offset:5280
 ds_read_b32 v195, v188 offset:6576
 ds_read_b32 v196, v188 offset:7872
 ds_read_b32 v197, v188 offset:9168
 s_waitcnt lgkmcnt(0)
 v_perm_b32 v96, v191, v190, s47
 v_perm_b32 v100, v191, v190, s48
 v_perm_b32 v97, v193, v192, s47
 v_perm_b32 v101, v193, v192, s48
 v_perm_b32 v98, v195, v194, s47
 v_perm_b32 v102, v195, v194, s48
 v_perm_b32 v99, v197, v196, s47
 v_perm_b32 v103, v197, v196, s48
 ds_read_b32 v190, v188 offset:128
 ds_read_b32 v191, v188 offset:1424
 ds_read_b32 v192, v188 offset:2720
 ds_read_b32 v193, v188 offset:4016
 ds_read_b32 v194, v188 offset:5312
 ds_read_b32 v195, v188 offset:6608
 ds_read_b32 v196, v188 offset:7904
 ds_read_b32 v197, v188 offset:9200
 s_waitcnt lgkmcnt(0)
 v_perm_b32 v104, v191, v190, s47
 v_perm_b32 v108, v191, v190, s48
 v_perm_b32 v105, v193, v192, s47
 v_perm_b32 v109, v193, v192, s48
 v_perm_b32 v106, v195, v194, s47
 v_perm_b32 v110, v195, v194, s48
 v_perm_b32 v107, v197, v196, s47
 v_perm_b32 v111, v197, v196, s48
Lwog_17:
 s_lshr_b32 s44, s38, 2
 s_lshl_b32 s44, s44, 10
 s_and_b32 s45, s38, 3
 s_lshl_b32 s45, s45, 8
 s_add_u32 s44, s44, s45
 s_add_u32 s44, s44, 15597568
 s_add_u32 s45, s44, 0
 s_add_u32 s46, s45, 102400
 buffer_store_dwordx4 v[72:75], v189, s[8:11], s45 offen sc1
 buffer_store_dwordx4 v[76:79], v189, s[8:11], s46 offen sc1
 s_add_u32 s45, s44, 20480
 s_add_u32 s46, s45, 102400
 buffer_store_dwordx4 v[80:83], v189, s[8:11], s45 offen sc1
 buffer_store_dwordx4 v[84:87], v189, s[8:11], s46 offen sc1
 s_add_u32 s45, s44, 40960
 s_add_u32 s46, s45, 102400
 buffer_store_dwordx4 v[88:91], v189, s[8:11], s45 offen sc1
 buffer_store_dwordx4 v[92:95], v189, s[8:11], s46 offen sc1
 s_add_u32 s45, s44, 61440
 s_add_u32 s46, s45, 102400
 buffer_store_dwordx4 v[96:99], v189, s[8:11], s45 offen sc1
 buffer_store_dwordx4 v[100:103], v189, s[8:11], s46 offen sc1
 s_add_u32 s45, s44, 81920
 s_add_u32 s46, s45, 102400
 buffer_store_dwordx4 v[104:107], v189, s[8:11], s45 offen sc1
 buffer_store_dwordx4 v[108:111], v189, s[8:11], s46 offen sc1
Lwog_18:
 s_waitcnt vmcnt(10)
 s_branch Lnk_15
Ln2_16:
 s_waitcnt vmcnt(0)
Lnk_15:
 s_mov_b64 s[6:7], exec
 s_mov_b64 exec, 1
 buffer_store_byte v170, v171, s[56:59], 0 offen sc1
 s_mov_b64 exec, s[6:7]
 s_barrier
 s_call_b64 s[36:37], Lsub_raw
 s_call_b64 s[36:37], Lsub_phi
 v_lshlrev_b32 v188, 4, v1
 v_add_u32 v188, 119808, v188
 v_lshrrev_b32 v189, 3, v1
 v_lshlrev_b32 v189, 9, v189
 v_and_b32_e64 v2, 7, v1
 v_lshl_add_u32 v189, v2, 4, v189
 s_mul_i32 s44, s3, 327680
 s_lshr_b32 s45, s4, 2
 s_mul_i32 s45, s45, 40960
 s_add_u32 s44, s44, s45
 s_and_b32 s45, s4, 3
 s_lshl_b32 s45, s45, 7
 s_add_u32 s44, s44, s45
 s_waitcnt lgkmcnt(0)
 ds_read_b128 v[8:11], v188 offset:0
 ds_read_b128 v[12:15], v188 offset:1024
 ds_read_b128 v[16:19], v188 offset:2048
 ds_read_b128 v[20:23], v188 offset:3072
 ds_read_b128 v[24:27], v188 offset:4096
 ds_read_b128 v[28:31], v188 offset:5120
 ds_read_b128 v[32:35], v188 offset:6144
 ds_read_b128 v[36:39], v188 offset:7168
 ds_read_b128 v[40:43], v188 offset:8192
 ds_read_b128 v[44:47], v188 offset:9216
 s_waitcnt lgkmcnt(9)
 s_add_u32 s45, s44, 1048576
 buffer_store_dwordx4 v[8:11], v189, s[8:11], s45 offen sc1
 s_waitcnt lgkmcnt(8)
 s_add_u32 s45, s44, 1052672
 buffer_store_dwordx4 v[12:15], v189, s[8:11], s45 offen sc1
 s_waitcnt lgkmcnt(7)
 s_add_u32 s45, s44, 1056768
 buffer_store_dwordx4 v[16:19], v189, s[8:11], s45 offen sc1
 s_waitcnt lgkmcnt(6)
 s_add_u32 s45, s44, 1060864
 buffer_store_dwordx4 v[20:23], v189, s[8:11], s45 offen sc1
 s_waitcnt lgkmcnt(5)
 s_add_u32 s45, s44, 1064960
 buffer_store_dwordx4 v[24:27], v189, s[8:11], s45 offen sc1
 s_waitcnt lgkmcnt(4)
 s_add_u32 s45, s44, 1069056
 buffer_store_dwordx4 v[28:31], v189, s[8:11], s45 offen sc1
 s_waitcnt lgkmcnt(3)
 s_add_u32 s45, s44, 1073152
 buffer_store_dwordx4 v[32:35], v189, s[8:11], s45 offen sc1
 s_waitcnt lgkmcnt(2)
 s_add_u32 s45, s44, 1077248
 buffer_store_dwordx4 v[36:39], v189, s[8:11], s45 offen sc1
 s_waitcnt lgkmcnt(1)
 s_add_u32 s45, s44, 1081344
 buffer_store_dwordx4 v[40:43], v189, s[8:11], s45 offen sc1
 s_waitcnt lgkmcnt(0)
 s_add_u32 s45, s44, 1085440
 buffer_store_dwordx4 v[44:47], v189, s[8:11], s45 offen sc1
 s_barrier
 s_cmp_ge_u32 s38, 80
 s_cbranch_scc1 Lwf_19
 s_lshl_b32 s44, s38, 6
 s_add_u32 s44, s44, 12288
 v_mov_b32 v2, s44
 v_mov_b32 v3, 1
 s_waitcnt vmcnt(0)
 s_mov_b64 s[6:7], exec
 s_mov_b64 exec, 1
 buffer_store_dword v3, v2, s[8:11], 0 offen sc1
 s_mov_b64 exec, s[6:7]
Lwf_19:
 s_mov_b32 s39, 1048576
Lpp_20:
 buffer_load_dword v170, v172, s[56:59], 0 offen sc1
 s_waitcnt vmcnt(0)
 v_subrev_u32 v2, 0x01010101, v170
 v_bfi_b32 v2, v170, 0, v2
 v_and_b32 v2, 0x80808080, v2
 v_cmp_ne_u32_e64 vcc, 0, v2
 s_cbranch_vccz Lppd_21
 s_sub_u32 s39, s39, 1
 s_cmp_lg_u32 s39, 0
 s_cbranch_scc1 Lpp_20
Lppd_21:
 v_readfirstlane_b32 s49, v170
 s_nop 0
 s_and_b32 s49, s49, 0xff
 s_mul_i32 s49, s49, 0x01010101
 v_cmp_ne_u32 vcc, s49, v170
 s_nop 0
 s_cmp_eq_u64 vcc, 0
 s_cselect_b32 s41, 1, 0
 v_mov_b32_e64 v2, s41
 ds_write_b32 v173, v2
 s_waitcnt lgkmcnt(0)
 s_barrier
 s_cmp_eq_u32 s41, 0
 s_cbranch_scc1 Lgp_22
 s_branch Lentry_fast
Lgp_22:
 s_branch Lentry_slow
Lentry_fast:
 s_mov_b32 s42, 0
Llayer_23:
 s_mul_i32 s43, s42, 0
 s_add_u32 s43, s43, 3670016
 s_mul_i32 s56, s42, 0
 s_add_u32 s56, s56, 1048576
 s_mul_i32 s57, s42, 524288
 s_add_u32 s57, s57, 14548992
 s_mul_i32 s58, s42, 0
 s_add_u32 s58, s58, 6291456
 s_mul_i32 s59, s42, 0
 s_add_u32 s59, s59, 1048576
 s_mul_i32 s60, s42, 0
 s_add_u32 s60, s60, 3670016
 s_mul_i32 s61, s42, 0
 s_add_u32 s61, s61, 6619136
 s_mul_i32 s62, s42, 2752512
 s_add_u32 s62, s62, 9043968
 s_mov_b32 s64, s26
 s_and_b32 s65, s27, 0xffff
 s_mov_b32 s66, 256
 s_mov_b32 s67, 0x20000
 s_mul_i32 s63, s3, 327680
 s_mul_i32 s44, s5, 81920
 s_add_u32 s63, s63, s44
 s_add_u32 s63, s63, s43
 ds_read_b64_tr_b16 v[112:113], v144 offset:0
 ds_read_b64_tr_b16 v[114:115], v144 offset:512
 ds_read_b64_tr_b16 v[116:117], v146 offset:0
 ds_read_b64_tr_b16 v[118:119], v146 offset:512
 ds_read_b64_tr_b16 v[120:121], v144 offset:2048
 ds_read_b64_tr_b16 v[122:123], v144 offset:2560
 ds_read_b64_tr_b16 v[124:125], v146 offset:2048
 ds_read_b64_tr_b16 v[126:127], v146 offset:2560
 buffer_load_dwordx4 v[8:11], v7, s[8:11], s63 offen offset:0 sc1
 buffer_load_dwordx4 v[12:15], v7, s[8:11], s63 offen offset:1024 sc1
 buffer_load_dwordx4 v[16:19], v7, s[8:11], s63 offen offset:2048 sc1
 buffer_load_dwordx4 v[20:23], v7, s[8:11], s63 offen offset:3072 sc1
 s_add_u32 s63, s63, 4096
 buffer_load_dwordx4 v[24:27], v7, s[8:11], s63 offen offset:0 sc1
 buffer_load_dwordx4 v[28:31], v7, s[8:11], s63 offen offset:1024 sc1
 buffer_load_dwordx4 v[32:35], v7, s[8:11], s63 offen offset:2048 sc1
 buffer_load_dwordx4 v[36:39], v7, s[8:11], s63 offen offset:3072 sc1
 s_add_u32 s63, s63, 4096
 buffer_load_dwordx4 v[40:43], v7, s[8:11], s63 offen offset:0 sc1
 buffer_load_dwordx4 v[44:47], v7, s[8:11], s63 offen offset:1024 sc1
 s_waitcnt vmcnt(9) lgkmcnt(4)
 v_mfma_f32_32x32x16_bf16 v[48:63], v[112:115], v[8:11], 0
 ds_read_b64_tr_b16 v[128:129], v144 offset:4096
 ds_read_b64_tr_b16 v[130:131], v144 offset:4608
 v_mfma_f32_32x32x16_bf16 v[64:79], v[116:119], v[8:11], 0
 ds_read_b64_tr_b16 v[132:133], v146 offset:4096
 ds_read_b64_tr_b16 v[134:135], v146 offset:4608
 s_waitcnt vmcnt(8) lgkmcnt(4)
 v_mfma_f32_32x32x16_bf16 v[48:63], v[120:123], v[12:15], v[48:63]
 ds_read_b64_tr_b16 v[112:113], v144 offset:6144
 ds_read_b64_tr_b16 v[114:115], v144 offset:6656
 buffer_load_dwordx4 v[8:11], v7, s[8:11], s63 offen offset:2048 sc1
 v_mfma_f32_32x32x16_bf16 v[64:79], v[124:127], v[12:15], v[64:79]
 ds_read_b64_tr_b16 v[116:117], v146 offset:6144
 ds_read_b64_tr_b16 v[118:119], v146 offset:6656
 s_waitcnt vmcnt(8) lgkmcnt(4)
 v_mfma_f32_32x32x16_bf16 v[48:63], v[128:131], v[16:19], v[48:63]
 ds_read_b64_tr_b16 v[120:121], v144 offset:8192
 ds_read_b64_tr_b16 v[122:123], v144 offset:8704
 buffer_load_dwordx4 v[12:15], v7, s[8:11], s63 offen offset:3072 sc1
 v_mfma_f32_32x32x16_bf16 v[64:79], v[132:135], v[16:19], v[64:79]
 ds_read_b64_tr_b16 v[124:125], v146 offset:8192
 ds_read_b64_tr_b16 v[126:127], v146 offset:8704
 s_waitcnt vmcnt(8) lgkmcnt(4)
 v_mfma_f32_32x32x16_bf16 v[48:63], v[112:115], v[20:23], v[48:63]
 ds_read_b64_tr_b16 v[128:129], v144 offset:10240
 ds_read_b64_tr_b16 v[130:131], v144 offset:10752
 s_add_u32 s63, s63, 4096
 buffer_load_dwordx4 v[16:19], v7, s[8:11], s63 offen offset:0 sc1
 v_mfma_f32_32x32x16_bf16 v[64:79], v[116:119], v[20:23], v[64:79]
 ds_read_b64_tr_b16 v[132:133], v146 offset:10240
 ds_read_b64_tr_b16 v[134:135], v146 offset:10752
 s_waitcnt vmcnt(8) lgkmcnt(4)
 v_mfma_f32_32x32x16_bf16 v[48:63], v[120:123], v[24:27], v[48:63]
 ds_read_b64_tr_b16 v[112:113], v144 offset:12288
 ds_read_b64_tr_b16 v[114:115], v144 offset:12800
 buffer_load_dwordx4 v[20:23], v7, s[8:11], s63 offen offset:1024 sc1
 v_mfma_f32_32x32x16_bf16 v[64:79], v[124:127], v[24:27], v[64:79]
 ds_read_b64_tr_b16 v[116:117], v146 offset:12288
 ds_read_b64_tr_b16 v[118:119], v146 offset:12800
 s_waitcnt vmcnt(8) lgkmcnt(4)
 v_mfma_f32_32x32x16_bf16 v[48:63], v[128:131], v[28:31], v[48:63]
 ds_read_b64_tr_b16 v[120:121], v144 offset:14336
 ds_read_b64_tr_b16 v[122:123], v144 offset:14848
 buffer_load_dwordx4 v[24:27], v7, s[8:11], s63 offen offset:2048 sc1
 v_mfma_f32_32x32x16_bf16 v[64:79], v[132:135], v[28:31], v[64:79]
 ds_read_b64_tr_b16 v[124:125], v146 offset:14336
 ds_read_b64_tr_b16 v[126:127], v146 offset:14848
 s_waitcnt vmcnt(8) lgkmcnt(4)
 v_mfma_f32_32x32x16_bf16 v[48:63], v[112:115], v[32:35], v[48:63]
 ds_read_b64_tr_b16 v[128:129], v144 offset:16384
 ds_read_b64_tr_b16 v[130:131], v144 offset:16896
 buffer_load_dwordx4 v[28:31], v7, s[8:11], s63 offen offset:3072 sc1
 v_mfma_f32_32x32x16_bf16 v[64:79], v[116:119], v[32:35], v[64:79]
 ds_read_b64_tr_b16 v[132:133], v146 offset:16384
 ds_read_b64_tr_b16 v[134:135], v146 offset:16896
 s_waitcnt vmcnt(8) lgkmcnt(4)
 v_mfma_f32_32x32x16_bf16 v[48:63], v[120:123], v[36:39], v[48:63]
 ds_read_b64_tr_b16 v[112:113], v144 offset:18432
 ds_read_b64_tr_b16 v[114:115], v144 offset:18944
 s_add_u32 s63, s63, 4096
 buffer_load_dwordx4 v[32:35], v7, s[8:11], s63 offen offset:0 sc1
 v_mfma_f32_32x32x16_bf16 v[64:79], v[124:127], v[36:39], v[64:79]
 ds_read_b64_tr_b16 v[116:117], v146 offset:18432
 ds_read_b64_tr_b16 v[118:119], v146 offset:18944
 s_waitcnt vmcnt(8) lgkmcnt(4)
 v_mfma_f32_32x32x16_bf16 v[48:63], v[128:131], v[40:43], v[48:63]
 ds_read_b64_tr_b16 v[120:121], v144 offset:20480
 ds_read_b64_tr_b16 v[122:123], v144 offset:20992
 buffer_load_dwordx4 v[36:39], v7, s[8:11], s63 offen offset:1024 sc1
 v_mfma_f32_32x32x16_bf16 v[64:79], v[132:135], v[40:43], v[64:79]
 ds_read_b64_tr_b16 v[124:125], v146 offset:20480
 ds_read_b64_tr_b16 v[126:127], v146 offset:20992
 s_waitcnt vmcnt(8) lgkmcnt(4)
 v_mfma_f32_32x32x16_bf16 v[48:63], v[112:115], v[44:47], v[48:63]
 ds_read_b64_tr_b16 v[128:129], v144 offset:22528
 ds_read_b64_tr_b16 v[130:131], v144 offset:23040
 buffer_load_dwordx4 v[40:43], v7, s[8:11], s63 offen offset:2048 sc1
 v_mfma_f32_32x32x16_bf16 v[64:79], v[116:119], v[44:47], v[64:79]
 ds_read_b64_tr_b16 v[132:133], v146 offset:22528
 ds_read_b64_tr_b16 v[134:135], v146 offset:23040
 s_waitcnt vmcnt(8) lgkmcnt(4)
 v_mfma_f32_32x32x16_bf16 v[48:63], v[120:123], v[8:11], v[48:63]
 ds_read_b64_tr_b16 v[112:113], v144 offset:24576
 ds_read_b64_tr_b16 v[114:115], v144 offset:25088
 buffer_load_dwordx4 v[44:47], v7, s[8:11], s63 offen offset:3072 sc1
 v_mfma_f32_32x32x16_bf16 v[64:79], v[124:127], v[8:11], v[64:79]
 ds_read_b64_tr_b16 v[116:117], v146 offset:24576
 ds_read_b64_tr_b16 v[118:119], v146 offset:25088
 s_waitcnt vmcnt(8) lgkmcnt(4)
 v_mfma_f32_32x32x16_bf16 v[48:63], v[128:131], v[12:15], v[48:63]
 ds_read_b64_tr_b16 v[120:121], v144 offset:26624
 ds_read_b64_tr_b16 v[122:123], v144 offset:27136
 s_add_u32 s63, s63, 4096
 buffer_load_dwordx4 v[8:11], v7, s[8:11], s63 offen offset:0 sc1
 v_mfma_f32_32x32x16_bf16 v[64:79], v[132:135], v[12:15], v[64:79]
 ds_read_b64_tr_b16 v[124:125], v146 offset:26624
 ds_read_b64_tr_b16 v[126:127], v146 offset:27136
 s_waitcnt vmcnt(8) lgkmcnt(4)
 v_mfma_f32_32x32x16_bf16 v[48:63], v[112:115], v[16:19], v[48:63]
 ds_read_b64_tr_b16 v[128:129], v144 offset:28672
 ds_read_b64_tr_b16 v[130:131], v144 offset:29184
 buffer_load_dwordx4 v[12:15], v7, s[8:11], s63 offen offset:1024 sc1
 v_mfma_f32_32x32x16_bf16 v[64:79], v[116:119], v[16:19], v[64:79]
 ds_read_b64_tr_b16 v[132:133], v146 offset:28672
 ds_read_b64_tr_b16 v[134:135], v146 offset:29184
 s_waitcnt vmcnt(8) lgkmcnt(4)
 v_mfma_f32_32x32x16_bf16 v[48:63], v[120:123], v[20:23], v[48:63]
 ds_read_b64_tr_b16 v[112:113], v144 offset:30720
 ds_read_b64_tr_b16 v[114:115], v144 offset:31232
 buffer_load_dwordx4 v[16:19], v7, s[8:11], s63 offen offset:2048 sc1
 v_mfma_f32_32x32x16_bf16 v[64:79], v[124:127], v[20:23], v[64:79]
 ds_read_b64_tr_b16 v[116:117], v146 offset:30720
 ds_read_b64_tr_b16 v[118:119], v146 offset:31232
 s_waitcnt vmcnt(8) lgkmcnt(4)
 v_mfma_f32_32x32x16_bf16 v[48:63], v[128:131], v[24:27], v[48:63]
 ds_read_b64_tr_b16 v[120:121], v144 offset:32768
 ds_read_b64_tr_b16 v[122:123], v144 offset:33280
 buffer_load_dwordx4 v[20:23], v7, s[8:11], s63 offen offset:3072 sc1
 v_mfma_f32_32x32x16_bf16 v[64:79], v[132:135], v[24:27], v[64:79]
 ds_read_b64_tr_b16 v[124:125], v146 offset:32768
 ds_read_b64_tr_b16 v[126:127], v146 offset:33280
 s_waitcnt vmcnt(8) lgkmcnt(4)
 v_mfma_f32_32x32x16_bf16 v[48:63], v[112:115], v[28:31], v[48:63]
 ds_read_b64_tr_b16 v[128:129], v144 offset:34816
 ds_read_b64_tr_b16 v[130:131], v144 offset:35328
 s_add_u32 s63, s63, 4096
 buffer_load_dwordx4 v[24:27], v7, s[8:11], s63 offen offset:0 sc1
 v_mfma_f32_32x32x16_bf16 v[64:79], v[116:119], v[28:31], v[64:79]
 ds_read_b64_tr_b16 v[132:133], v146 offset:34816
 ds_read_b64_tr_b16 v[134:135], v146 offset:35328
 s_waitcnt vmcnt(8) lgkmcnt(4)
 v_mfma_f32_32x32x16_bf16 v[48:63], v[120:123], v[32:35], v[48:63]
 ds_read_b64_tr_b16 v[112:113], v144 offset:36864
 ds_read_b64_tr_b16 v[114:115], v144 offset:37376
 buffer_load_dwordx4 v[28:31], v7, s[8:11], s63 offen offset:1024 sc1
 v_mfma_f32_32x32x16_bf16 v[64:79], v[124:127], v[32:35], v[64:79]
 ds_read_b64_tr_b16 v[116:117], v146 offset:36864
 ds_read_b64_tr_b16 v[118:119], v146 offset:37376
 s_waitcnt vmcnt(8) lgkmcnt(4)
 v_mfma_f32_32x32x16_bf16 v[48:63], v[128:131], v[36:39], v[48:63]
 ds_read_b64_tr_b16 v[120:121], v144 offset:38912
 ds_read_b64_tr_b16 v[122:123], v144 offset:39424
 buffer_load_dwordx4 v[32:35], v7, s[8:11], s63 offen offset:2048 sc1
 v_mfma_f32_32x32x16_bf16 v[64:79], v[132:135], v[36:39], v[64:79]
 ds_read_b64_tr_b16 v[124:125], v146 offset:38912
 ds_read_b64_tr_b16 v[126:127], v146 offset:39424
 s_waitcnt vmcnt(8) lgkmcnt(4)
 v_mfma_f32_32x32x16_bf16 v[48:63], v[112:115], v[40:43], v[48:63]
 ds_read_b64_tr_b16 v[128:129], v144 offset:40960
 ds_read_b64_tr_b16 v[130:131], v144 offset:41472
 buffer_load_dwordx4 v[36:39], v7, s[8:11], s63 offen offset:3072 sc1
 v_mfma_f32_32x32x16_bf16 v[64:79], v[116:119], v[40:43], v[64:79]
 ds_read_b64_tr_b16 v[132:133], v146 offset:40960
 ds_read_b64_tr_b16 v[134:135], v146 offset:41472
 s_waitcnt vmcnt(8) lgkmcnt(4)
 v_mfma_f32_32x32x16_bf16 v[48:63], v[120:123], v[44:47], v[48:63]
 ds_read_b64_tr_b16 v[112:113], v144 offset:43008
 ds_read_b64_tr_b16 v[114:115], v144 offset:43520
 s_add_u32 s63, s63, 4096
 buffer_load_dwordx4 v[40:43], v7, s[8:11], s63 offen offset:0 sc1
 v_mfma_f32_32x32x16_bf16 v[64:79], v[124:127], v[44:47], v[64:79]
 ds_read_b64_tr_b16 v[116:117], v146 offset:43008
 ds_read_b64_tr_b16 v[118:119], v146 offset:43520
 s_waitcnt vmcnt(8) lgkmcnt(4)
 v_mfma_f32_32x32x16_bf16 v[48:63], v[128:131], v[8:11], v[48:63]
 ds_read_b64_tr_b16 v[120:121], v144 offset:45056
 ds_read_b64_tr_b16 v[122:123], v144 offset:45568
 buffer_load_dwordx4 v[44:47], v7, s[8:11], s63 offen offset:1024 sc1
 v_mfma_f32_32x32x16_bf16 v[64:79], v[132:135], v[8:11], v[64:79]
 ds_read_b64_tr_b16 v[124:125], v146 offset:45056
 ds_read_b64_tr_b16 v[126:127], v146 offset:45568
 s_waitcnt vmcnt(8) lgkmcnt(4)
 v_mfma_f32_32x32x16_bf16 v[48:63], v[112:115], v[12:15], v[48:63]
 ds_read_b64_tr_b16 v[128:129], v144 offset:47104
 ds_read_b64_tr_b16 v[130:131], v144 offset:47616
 buffer_load_dwordx4 v[8:11], v7, s[8:11], s63 offen offset:2048 sc1
 v_mfma_f32_32x32x16_bf16 v[64:79], v[116:119], v[12:15], v[64:79]
 ds_read_b64_tr_b16 v[132:133], v146 offset:47104
 ds_read_b64_tr_b16 v[134:135], v146 offset:47616
 s_waitcnt vmcnt(8) lgkmcnt(4)
 v_mfma_f32_32x32x16_bf16 v[48:63], v[120:123], v[16:19], v[48:63]
 ds_read_b64_tr_b16 v[112:113], v144 offset:49152
 ds_read_b64_tr_b16 v[114:115], v144 offset:49664
 buffer_load_dwordx4 v[12:15], v7, s[8:11], s63 offen offset:3072 sc1
 v_mfma_f32_32x32x16_bf16 v[64:79], v[124:127], v[16:19], v[64:79]
 ds_read_b64_tr_b16 v[116:117], v146 offset:49152
 ds_read_b64_tr_b16 v[118:119], v146 offset:49664
 s_waitcnt vmcnt(8) lgkmcnt(4)
 v_mfma_f32_32x32x16_bf16 v[48:63], v[128:131], v[20:23], v[48:63]
 ds_read_b64_tr_b16 v[120:121], v144 offset:51200
 ds_read_b64_tr_b16 v[122:123], v144 offset:51712
 s_add_u32 s63, s63, 4096
 buffer_load_dwordx4 v[16:19], v7, s[8:11], s63 offen offset:0 sc1
 v_mfma_f32_32x32x16_bf16 v[64:79], v[132:135], v[20:23], v[64:79]
 ds_read_b64_tr_b16 v[124:125], v146 offset:51200
 ds_read_b64_tr_b16 v[126:127], v146 offset:51712
 s_waitcnt vmcnt(8) lgkmcnt(4)
 v_mfma_f32_32x32x16_bf16 v[48:63], v[112:115], v[24:27], v[48:63]
 ds_read_b64_tr_b16 v[128:129], v144 offset:53248
 ds_read_b64_tr_b16 v[130:131], v144 offset:53760
 buffer_load_dwordx4 v[20:23], v7, s[8:11], s63 offen offset:1024 sc1
 v_mfma_f32_32x32x16_bf16 v[64:79], v[116:119], v[24:27], v[64:79]
 ds_read_b64_tr_b16 v[132:133], v146 offset:53248
 ds_read_b64_tr_b16 v[134:135], v146 offset:53760
 s_waitcnt vmcnt(8) lgkmcnt(4)
 v_mfma_f32_32x32x16_bf16 v[48:63], v[120:123], v[28:31], v[48:63]
 ds_read_b64_tr_b16 v[112:113], v144 offset:55296
 ds_read_b64_tr_b16 v[114:115], v144 offset:55808
 buffer_load_dwordx4 v[24:27], v7, s[8:11], s63 offen offset:2048 sc1
 v_mfma_f32_32x32x16_bf16 v[64:79], v[124:127], v[28:31], v[64:79]
 ds_read_b64_tr_b16 v[116:117], v146 offset:55296
 ds_read_b64_tr_b16 v[118:119], v146 offset:55808
 s_waitcnt vmcnt(8) lgkmcnt(4)
 v_mfma_f32_32x32x16_bf16 v[48:63], v[128:131], v[32:35], v[48:63]
 ds_read_b64_tr_b16 v[120:121], v144 offset:57344
 ds_read_b64_tr_b16 v[122:123], v144 offset:57856
 buffer_load_dwordx4 v[28:31], v7, s[8:11], s63 offen offset:3072 sc1
 v_mfma_f32_32x32x16_bf16 v[64:79], v[132:135], v[32:35], v[64:79]
 ds_read_b64_tr_b16 v[124:125], v146 offset:57344
 ds_read_b64_tr_b16 v[126:127], v146 offset:57856
 s_waitcnt vmcnt(8) lgkmcnt(4)
 v_mfma_f32_32x32x16_bf16 v[48:63], v[112:115], v[36:39], v[48:63]
 ds_read_b64_tr_b16 v[128:129], v144 offset:59392
 ds_read_b64_tr_b16 v[130:131], v144 offset:59904
 s_add_u32 s63, s63, 4096
 buffer_load_dwordx4 v[32:35], v7, s[8:11], s63 offen offset:0 sc1
 v_mfma_f32_32x32x16_bf16 v[64:79], v[116:119], v[36:39], v[64:79]
 ds_read_b64_tr_b16 v[132:133], v146 offset:59392
 ds_read_b64_tr_b16 v[134:135], v146 offset:59904
 s_waitcnt vmcnt(8) lgkmcnt(4)
 v_mfma_f32_32x32x16_bf16 v[48:63], v[120:123], v[40:43], v[48:63]
 ds_read_b64_tr_b16 v[112:113], v144 offset:61440
 ds_read_b64_tr_b16 v[114:115], v144 offset:61952
 buffer_load_dwordx4 v[36:39], v7, s[8:11], s63 offen offset:1024 sc1
 v_mfma_f32_32x32x16_bf16 v[64:79], v[124:127], v[40:43], v[64:79]
 ds_read_b64_tr_b16 v[116:117], v146 offset:61440
 ds_read_b64_tr_b16 v[118:119], v146 offset:61952
 s_waitcnt vmcnt(8) lgkmcnt(4)
 v_mfma_f32_32x32x16_bf16 v[48:63], v[128:131], v[44:47], v[48:63]
 ds_read_b64_tr_b16 v[120:121], v144 offset:63488
 ds_read_b64_tr_b16 v[122:123], v144 offset:64000
 buffer_load_dwordx4 v[40:43], v7, s[8:11], s63 offen offset:2048 sc1
 v_mfma_f32_32x32x16_bf16 v[64:79], v[132:135], v[44:47], v[64:79]
 ds_read_b64_tr_b16 v[124:125], v146 offset:63488
 ds_read_b64_tr_b16 v[126:127], v146 offset:64000
 s_waitcnt vmcnt(8) lgkmcnt(4)
 v_mfma_f32_32x32x16_bf16 v[48:63], v[112:115], v[8:11], v[48:63]
 ds_read_b64_tr_b16 v[128:129], v145 offset:0
 ds_read_b64_tr_b16 v[130:131], v145 offset:512
 buffer_load_dwordx4 v[44:47], v7, s[8:11], s63 offen offset:3072 sc1
 v_mfma_f32_32x32x16_bf16 v[64:79], v[116:119], v[8:11], v[64:79]
 ds_read_b64_tr_b16 v[132:133], v147 offset:0
 ds_read_b64_tr_b16 v[134:135], v147 offset:512
 s_waitcnt vmcnt(8) lgkmcnt(4)
 v_mfma_f32_32x32x16_bf16 v[48:63], v[120:123], v[12:15], v[48:63]
 ds_read_b64_tr_b16 v[112:113], v145 offset:2048
 ds_read_b64_tr_b16 v[114:115], v145 offset:2560
 s_add_u32 s63, s63, 4096
 buffer_load_dwordx4 v[8:11], v7, s[8:11], s63 offen offset:0 sc1
 v_mfma_f32_32x32x16_bf16 v[64:79], v[124:127], v[12:15], v[64:79]
 ds_read_b64_tr_b16 v[116:117], v147 offset:2048
 ds_read_b64_tr_b16 v[118:119], v147 offset:2560
 s_waitcnt vmcnt(8) lgkmcnt(4)
 v_mfma_f32_32x32x16_bf16 v[48:63], v[128:131], v[16:19], v[48:63]
 ds_read_b64_tr_b16 v[120:121], v145 offset:4096
 ds_read_b64_tr_b16 v[122:123], v145 offset:4608
 buffer_load_dwordx4 v[12:15], v7, s[8:11], s63 offen offset:1024 sc1
 v_mfma_f32_32x32x16_bf16 v[64:79], v[132:135], v[16:19], v[64:79]
 ds_read_b64_tr_b16 v[124:125], v147 offset:4096
 ds_read_b64_tr_b16 v[126:127], v147 offset:4608
 s_waitcnt vmcnt(8) lgkmcnt(4)
 v_mfma_f32_32x32x16_bf16 v[48:63], v[112:115], v[20:23], v[48:63]
 ds_read_b64_tr_b16 v[128:129], v145 offset:6144
 ds_read_b64_tr_b16 v[130:131], v145 offset:6656
 buffer_load_dwordx4 v[16:19], v7, s[8:11], s63 offen offset:2048 sc1
 v_mfma_f32_32x32x16_bf16 v[64:79], v[116:119], v[20:23], v[64:79]
 ds_read_b64_tr_b16 v[132:133], v147 offset:6144
 ds_read_b64_tr_b16 v[134:135], v147 offset:6656
 s_waitcnt vmcnt(8) lgkmcnt(4)
 v_mfma_f32_32x32x16_bf16 v[48:63], v[120:123], v[24:27], v[48:63]
 ds_read_b64_tr_b16 v[112:113], v145 offset:8192
 ds_read_b64_tr_b16 v[114:115], v145 offset:8704
 buffer_load_dwordx4 v[20:23], v7, s[8:11], s63 offen offset:3072 sc1
 v_mfma_f32_32x32x16_bf16 v[64:79], v[124:127], v[24:27], v[64:79]
 ds_read_b64_tr_b16 v[116:117], v147 offset:8192
 ds_read_b64_tr_b16 v[118:119], v147 offset:8704
 s_waitcnt vmcnt(8) lgkmcnt(4)
 v_mfma_f32_32x32x16_bf16 v[48:63], v[128:131], v[28:31], v[48:63]
 ds_read_b64_tr_b16 v[120:121], v145 offset:10240
 ds_read_b64_tr_b16 v[122:123], v145 offset:10752
 s_add_u32 s63, s63, 4096
 buffer_load_dwordx4 v[24:27], v7, s[8:11], s63 offen offset:0 sc1
 v_mfma_f32_32x32x16_bf16 v[64:79], v[132:135], v[28:31], v[64:79]
 ds_read_b64_tr_b16 v[124:125], v147 offset:10240
 ds_read_b64_tr_b16 v[126:127], v147 offset:10752
 s_waitcnt vmcnt(8) lgkmcnt(4)
 v_mfma_f32_32x32x16_bf16 v[48:63], v[112:115], v[32:35], v[48:63]
 ds_read_b64_tr_b16 v[128:129], v145 offset:12288
 ds_read_b64_tr_b16 v[130:131], v145 offset:12800
 buffer_load_dwordx4 v[28:31], v7, s[8:11], s63 offen offset:1024 sc1
 v_mfma_f32_32x32x16_bf16 v[64:79], v[116:119], v[32:35], v[64:79]
 ds_read_b64_tr_b16 v[132:133], v147 offset:12288
 ds_read_b64_tr_b16 v[134:135], v147 offset:12800
 s_waitcnt vmcnt(8) lgkmcnt(4)
 v_mfma_f32_32x32x16_bf16 v[48:63], v[120:123], v[36:39], v[48:63]
 ds_read_b64_tr_b16 v[112:113], v145 offset:14336
 ds_read_b64_tr_b16 v[114:115], v145 offset:14848
 buffer_load_dwordx4 v[32:35], v7, s[8:11], s63 offen offset:2048 sc1
 v_mfma_f32_32x32x16_bf16 v[64:79], v[124:127], v[36:39], v[64:79]
 ds_read_b64_tr_b16 v[116:117], v147 offset:14336
 ds_read_b64_tr_b16 v[118:119], v147 offset:14848
 s_waitcnt vmcnt(8) lgkmcnt(4)
 v_mfma_f32_32x32x16_bf16 v[48:63], v[128:131], v[40:43], v[48:63]
 ds_read_b64_tr_b16 v[120:121], v144 offset:0
 ds_read_b64_tr_b16 v[122:123], v144 offset:512
 buffer_load_dwordx4 v[36:39], v7, s[8:11], s63 offen offset:3072 sc1
 v_mfma_f32_32x32x16_bf16 v[64:79], v[132:135], v[40:43], v[64:79]
 ds_read_b64_tr_b16 v[124:125], v146 offset:0
 ds_read_b64_tr_b16 v[126:127], v146 offset:512
 s_waitcnt vmcnt(8) lgkmcnt(4)
 v_mfma_f32_32x32x16_bf16 v[48:63], v[112:115], v[44:47], v[48:63]
 ds_read_b64_tr_b16 v[128:129], v144 offset:2048
 ds_read_b64_tr_b16 v[130:131], v144 offset:2560
 s_add_u32 s63, s63, 4096
 buffer_load_dwordx4 v[40:43], v7, s[8:11], s63 offen offset:0 sc1
 v_mfma_f32_32x32x16_bf16 v[64:79], v[116:119], v[44:47], v[64:79]
 ds_read_b64_tr_b16 v[132:133], v146 offset:2048
 ds_read_b64_tr_b16 v[134:135], v146 offset:2560
 s_waitcnt vmcnt(8) lgkmcnt(4)
 v_mfma_f32_32x32x16_bf16 v[80:95], v[120:123], v[8:11], 0
 ds_read_b64_tr_b16 v[112:113], v144 offset:4096
 ds_read_b64_tr_b16 v[114:115], v144 offset:4608
 buffer_load_dwordx4 v[44:47], v7, s[8:11], s63 offen offset:1024 sc1
 v_mfma_f32_32x32x16_bf16 v[96:111], v[124:127], v[8:11], 0
 ds_read_b64_tr_b16 v[116:117], v146 offset:4096
 ds_read_b64_tr_b16 v[118:119], v146 offset:4608
 s_waitcnt vmcnt(8) lgkmcnt(4)
 v_mfma_f32_32x32x16_bf16 v[80:95], v[128:131], v[12:15], v[80:95]
 ds_read_b64_tr_b16 v[120:121], v144 offset:6144
 ds_read_b64_tr_b16 v[122:123], v144 offset:6656
 buffer_load_dwordx4 v[8:11], v7, s[8:11], s63 offen offset:2048 sc1
 v_cvt_pk_bf16_f32 v208, v64, v65
 v_cvt_pk_bf16_f32 v209, v66, v67
 v_mfma_f32_32x32x16_bf16 v[96:111], v[132:135], v[12:15], v[96:111]
 ds_read_b64_tr_b16 v[124:125], v146 offset:6144
 ds_read_b64_tr_b16 v[126:127], v146 offset:6656
 v_cvt_pk_bf16_f32 v210, v68, v69
 v_cvt_pk_bf16_f32 v211, v70, v71
 v_cvt_pk_bf16_f32 v212, v72, v73
 s_waitcnt vmcnt(8) lgkmcnt(4)
 v_mfma_f32_32x32x16_bf16 v[80:95], v[112:115], v[16:19], v[80:95]
 ds_read_b64_tr_b16 v[128:129], v144 offset:8192
 ds_read_b64_tr_b16 v[130:131], v144 offset:8704
 buffer_load_dwordx4 v[12:15], v7, s[8:11], s63 offen offset:3072 sc1
 v_cvt_pk_bf16_f32 v213, v74, v75
 v_cvt_pk_bf16_f32 v214, v76, v77
 v_mfma_f32_32x32x16_bf16 v[96:111], v[116:119], v[16:19], v[96:111]
 ds_read_b64_tr_b16 v[132:133], v146 offset:8192
 ds_read_b64_tr_b16 v[134:135], v146 offset:8704
 v_cvt_pk_bf16_f32 v215, v78, v79
 v_mfma_f32_32x32x16_bf16 v[172:187], v[136:139], v[208:211], 0
 s_waitcnt vmcnt(8) lgkmcnt(4)
 v_mfma_f32_32x32x16_bf16 v[80:95], v[120:123], v[20:23], v[80:95]
 ds_read_b64_tr_b16 v[112:113], v144 offset:10240
 ds_read_b64_tr_b16 v[114:115], v144 offset:10752
 s_add_u32 s63, s63, 4096
 buffer_load_dwordx4 v[16:19], v7, s[8:11], s63 offen offset:0 sc1
 v_mfma_f32_32x32x16_bf16 v[172:187], v[140:143], v[212:215], v[172:187]
 v_mfma_f32_32x32x16_bf16 v[96:111], v[124:127], v[20:23], v[96:111]
 ds_read_b64_tr_b16 v[116:117], v146 offset:10240
 ds_read_b64_tr_b16 v[118:119], v146 offset:10752
 v_cvt_pk_bf16_f32 v148, v48, v49
 v_cvt_pk_bf16_f32 v149, v50, v51
 v_cvt_pk_bf16_f32 v150, v52, v53
 s_waitcnt vmcnt(8) lgkmcnt(4)
 v_mfma_f32_32x32x16_bf16 v[80:95], v[128:131], v[24:27], v[80:95]
 ds_read_b64_tr_b16 v[120:121], v144 offset:12288
 ds_read_b64_tr_b16 v[122:123], v144 offset:12800
 buffer_load_dwordx4 v[20:23], v7, s[8:11], s63 offen offset:1024 sc1
 v_cvt_pk_bf16_f32 v151, v54, v55
 v_cvt_pk_bf16_f32 v152, v56, v57
 v_mfma_f32_32x32x16_bf16 v[96:111], v[132:135], v[24:27], v[96:111]
 ds_read_b64_tr_b16 v[124:125], v146 offset:12288
 ds_read_b64_tr_b16 v[126:127], v146 offset:12800
 v_cvt_pk_bf16_f32 v153, v58, v59
 v_cvt_pk_bf16_f32 v154, v60, v61
 v_cvt_pk_bf16_f32 v155, v62, v63
 s_waitcnt vmcnt(8) lgkmcnt(4)
 v_mfma_f32_32x32x16_bf16 v[80:95], v[112:115], v[28:31], v[80:95]
 ds_read_b64_tr_b16 v[128:129], v144 offset:14336
 ds_read_b64_tr_b16 v[130:131], v144 offset:14848
 buffer_load_dwordx4 v[24:27], v7, s[8:11], s63 offen offset:2048 sc1
 v_cndmask_b32_e64 v228, v169, v152, s[54:55]
 v_cndmask_b32_e64 v229, 0, v153, s[54:55]
 v_mfma_f32_32x32x16_bf16 v[96:111], v[116:119], v[28:31], v[96:111]
 ds_read_b64_tr_b16 v[132:133], v146 offset:14336
 ds_read_b64_tr_b16 v[134:135], v146 offset:14848
 ds_write_b64 v165, v[154:155] offset:0
 ds_write_b64 v165, v[214:215] offset:16
 ds_write_b64 v166, v[228:229] offset:0
 s_waitcnt vmcnt(8) lgkmcnt(7)
 v_mfma_f32_32x32x16_bf16 v[80:95], v[120:123], v[32:35], v[80:95]
 ds_read_b64_tr_b16 v[112:113], v144 offset:16384
 ds_read_b64_tr_b16 v[114:115], v144 offset:16896
 buffer_load_dwordx4 v[28:31], v7, s[8:11], s63 offen offset:3072 sc1
 v_max3_f32 v170, v172, v173, v174
 v_min3_f32 v171, v172, v173, v174
 v_mfma_f32_32x32x16_bf16 v[96:111], v[124:127], v[32:35], v[96:111]
 ds_read_b64_tr_b16 v[116:117], v146 offset:16384
 ds_read_b64_tr_b16 v[118:119], v146 offset:16896
 v_max3_f32 v170, v170, v175, v176
 v_min3_f32 v171, v171, v175, v176
 v_max3_f32 v170, v170, v177, v178
 s_waitcnt vmcnt(8) lgkmcnt(7)
 v_mfma_f32_32x32x16_bf16 v[80:95], v[128:131], v[36:39], v[80:95]
 ds_read_b64_tr_b16 v[120:121], v144 offset:18432
 ds_read_b64_tr_b16 v[122:123], v144 offset:18944
 s_add_u32 s63, s63, 4096
 buffer_load_dwordx4 v[32:35], v7, s[8:11], s63 offen offset:0 sc1
 v_min3_f32 v171, v171, v177, v178
 v_max3_f32 v170, v170, v179, v180
 v_mfma_f32_32x32x16_bf16 v[96:111], v[132:135], v[36:39], v[96:111]
 ds_read_b64_tr_b16 v[124:125], v146 offset:18432
 ds_read_b64_tr_b16 v[126:127], v146 offset:18944
 v_min3_f32 v171, v171, v179, v180
 v_max_f32_e64 v170, v170, v181
 v_min_f32 v171, v171, v181
 s_waitcnt vmcnt(8) lgkmcnt(4)
 v_mfma_f32_32x32x16_bf16 v[80:95], v[112:115], v[40:43], v[80:95]
 ds_read_b64_tr_b16 v[128:129], v144 offset:20480
 ds_read_b64_tr_b16 v[130:131], v144 offset:20992
 buffer_load_dwordx4 v[36:39], v7, s[8:11], s63 offen offset:1024 sc1
 v_mov_b32 v241, v170
 v_mov_b32 v6, v171
 v_mfma_f32_32x32x16_bf16 v[96:111], v[116:119], v[40:43], v[96:111]
 ds_read_b64_tr_b16 v[132:133], v146 offset:20480
 ds_read_b64_tr_b16 v[134:135], v146 offset:20992
 s_nop 0
 v_permlane32_swap_b32 v241, v170
 v_permlane32_swap_b32 v6, v171
 s_waitcnt vmcnt(8) lgkmcnt(4)
 v_mfma_f32_32x32x16_bf16 v[80:95], v[120:123], v[44:47], v[80:95]
 ds_read_b64_tr_b16 v[112:113], v144 offset:22528
 ds_read_b64_tr_b16 v[114:115], v144 offset:23040
 buffer_load_dwordx4 v[40:43], v7, s[8:11], s63 offen offset:2048 sc1
 v_max_f32 v170, v170, v241
 v_min_f32 v171, v171, v6
 v_mfma_f32_32x32x16_bf16 v[96:111], v[124:127], v[44:47], v[96:111]
 ds_read_b64_tr_b16 v[116:117], v146 offset:22528
 ds_read_b64_tr_b16 v[118:119], v146 offset:23040
 v_mul_f32 v170, 0xbfb8aa3b, v170
 v_mul_f32 v171, 0x3fb8aa3b, v171
 v_fma_f32 v188, v172, s52, v170
 s_waitcnt vmcnt(8) lgkmcnt(4)
 v_mfma_f32_32x32x16_bf16 v[80:95], v[128:131], v[8:11], v[80:95]
 ds_read_b64_tr_b16 v[120:121], v144 offset:24576
 ds_read_b64_tr_b16 v[122:123], v144 offset:25088
 buffer_load_dwordx4 v[44:47], v7, s[8:11], s63 offen offset:3072 sc1
 v_fma_f32 v198, v172, -s52, v171
 v_fma_f32 v189, v173, s52, v170
 v_mfma_f32_32x32x16_bf16 v[96:111], v[132:135], v[8:11], v[96:111]
 ds_read_b64_tr_b16 v[124:125], v146 offset:24576
 ds_read_b64_tr_b16 v[126:127], v146 offset:25088
 v_fma_f32 v199, v173, -s52, v171
 v_fma_f32 v190, v174, s52, v170
 v_fma_f32 v200, v174, -s52, v171
 s_waitcnt vmcnt(8) lgkmcnt(4)
 v_mfma_f32_32x32x16_bf16 v[80:95], v[112:115], v[12:15], v[80:95]
 ds_read_b64_tr_b16 v[128:129], v144 offset:26624
 ds_read_b64_tr_b16 v[130:131], v144 offset:27136
 s_add_u32 s63, s63, 4096
 buffer_load_dwordx4 v[8:11], v7, s[8:11], s63 offen offset:0 sc1
 v_fma_f32 v191, v175, s52, v170
 v_fma_f32 v201, v175, -s52, v171
 v_mfma_f32_32x32x16_bf16 v[96:111], v[116:119], v[12:15], v[96:111]
 ds_read_b64_tr_b16 v[132:133], v146 offset:26624
 ds_read_b64_tr_b16 v[134:135], v146 offset:27136
 v_fma_f32 v192, v176, s52, v170
 v_fma_f32 v202, v176, -s52, v171
 v_fma_f32 v193, v177, s52, v170
 s_waitcnt vmcnt(8) lgkmcnt(4)
 v_mfma_f32_32x32x16_bf16 v[80:95], v[120:123], v[16:19], v[80:95]
 ds_read_b64_tr_b16 v[112:113], v144 offset:28672
 ds_read_b64_tr_b16 v[114:115], v144 offset:29184
 buffer_load_dwordx4 v[12:15], v7, s[8:11], s63 offen offset:1024 sc1
 v_fma_f32 v203, v177, -s52, v171
 v_fma_f32 v194, v178, s52, v170
 v_mfma_f32_32x32x16_bf16 v[96:111], v[124:127], v[16:19], v[96:111]
 ds_read_b64_tr_b16 v[116:117], v146 offset:28672
 ds_read_b64_tr_b16 v[118:119], v146 offset:29184
 v_fma_f32 v204, v178, -s52, v171
 v_fma_f32 v195, v179, s52, v170
 v_fma_f32 v205, v179, -s52, v171
 s_waitcnt vmcnt(8) lgkmcnt(4)
 v_mfma_f32_32x32x16_bf16 v[80:95], v[128:131], v[20:23], v[80:95]
 ds_read_b64_tr_b16 v[120:121], v144 offset:30720
 ds_read_b64_tr_b16 v[122:123], v144 offset:31232
 buffer_load_dwordx4 v[16:19], v7, s[8:11], s63 offen offset:2048 sc1
 v_fma_f32 v196, v180, s52, v170
 v_fma_f32 v206, v180, -s52, v171
 v_mfma_f32_32x32x16_bf16 v[96:111], v[132:135], v[20:23], v[96:111]
 ds_read_b64_tr_b16 v[124:125], v146 offset:30720
 ds_read_b64_tr_b16 v[126:127], v146 offset:31232
 v_fma_f32 v197, v181, s52, v170
 v_fma_f32 v207, v181, -s52, v171
 v_exp_f32 v188, v188
 s_waitcnt vmcnt(8) lgkmcnt(4)
 v_mfma_f32_32x32x16_bf16 v[80:95], v[112:115], v[24:27], v[80:95]
 ds_read_b64_tr_b16 v[128:129], v144 offset:32768
 ds_read_b64_tr_b16 v[130:131], v144 offset:33280
 buffer_load_dwordx4 v[20:23], v7, s[8:11], s63 offen offset:3072 sc1
 v_exp_f32_e64 v198, v198
 v_mfma_f32_32x32x16_bf16 v[96:111], v[116:119], v[24:27], v[96:111]
 ds_read_b64_tr_b16 v[132:133], v146 offset:32768
 ds_read_b64_tr_b16 v[134:135], v146 offset:33280
 v_exp_f32 v189, v189
 v_exp_f32 v199, v199
 v_lshlrev_b32 v2, 2, v1
 buffer_load_dword v242, v2, s[64:67], 0 offen sc1
 s_waitcnt vmcnt(9) lgkmcnt(4)
 v_mfma_f32_32x32x16_bf16 v[80:95], v[120:123], v[28:31], v[80:95]
 ds_read_b64_tr_b16 v[112:113], v144 offset:34816
 ds_read_b64_tr_b16 v[114:115], v144 offset:35328
 s_add_u32 s63, s63, 4096
 buffer_load_dwordx4 v[24:27], v7, s[8:11], s63 offen offset:0 sc1
 v_exp_f32_e64 v190, v190
 v_mfma_f32_32x32x16_bf16 v[96:111], v[124:127], v[28:31], v[96:111]
 ds_read_b64_tr_b16 v[116:117], v146 offset:34816
 ds_read_b64_tr_b16 v[118:119], v146 offset:35328
 v_exp_f32_e64 v200, v200
 v_exp_f32 v191, v191
 s_waitcnt vmcnt(9) lgkmcnt(4)
 v_mfma_f32_32x32x16_bf16 v[80:95], v[128:131], v[32:35], v[80:95]
 ds_read_b64_tr_b16 v[120:121], v144 offset:36864
 ds_read_b64_tr_b16 v[122:123], v144 offset:37376
 buffer_load_dwordx4 v[28:31], v7, s[8:11], s63 offen offset:1024 sc1
 v_exp_f32_e64 v201, v201
 v_mfma_f32_32x32x16_bf16 v[96:111], v[132:135], v[32:35], v[96:111]
 ds_read_b64_tr_b16 v[124:125], v146 offset:36864
 ds_read_b64_tr_b16 v[126:127], v146 offset:37376
 v_exp_f32_e64 v192, v192
 v_exp_f32 v202, v202
 s_waitcnt vmcnt(9) lgkmcnt(4)
 v_mfma_f32_32x32x16_bf16 v[80:95], v[112:115], v[36:39], v[80:95]
 ds_read_b64_tr_b16 v[128:129], v144 offset:38912
 ds_read_b64_tr_b16 v[130:131], v144 offset:39424
 buffer_load_dwordx4 v[32:35], v7, s[8:11], s63 offen offset:2048 sc1
 v_exp_f32_e64 v193, v193
 v_mfma_f32_32x32x16_bf16 v[96:111], v[116:119], v[36:39], v[96:111]
 ds_read_b64_tr_b16 v[132:133], v146 offset:38912
 ds_read_b64_tr_b16 v[134:135], v146 offset:39424
 v_exp_f32_e64 v203, v203
 v_exp_f32 v194, v194
 s_waitcnt vmcnt(9) lgkmcnt(4)
 v_mfma_f32_32x32x16_bf16 v[80:95], v[120:123], v[40:43], v[80:95]
 ds_read_b64_tr_b16 v[112:113], v144 offset:40960
 ds_read_b64_tr_b16 v[114:115], v144 offset:41472
 buffer_load_dwordx4 v[36:39], v7, s[8:11], s63 offen offset:3072 sc1
 v_exp_f32_e64 v204, v204
 v_mfma_f32_32x32x16_bf16 v[96:111], v[124:127], v[40:43], v[96:111]
 ds_read_b64_tr_b16 v[116:117], v146 offset:40960
 ds_read_b64_tr_b16 v[118:119], v146 offset:41472
 v_exp_f32_e64 v195, v195
 v_exp_f32 v205, v205
 s_waitcnt vmcnt(9) lgkmcnt(4)
 v_mfma_f32_32x32x16_bf16 v[80:95], v[128:131], v[44:47], v[80:95]
 ds_read_b64_tr_b16 v[120:121], v144 offset:43008
 ds_read_b64_tr_b16 v[122:123], v144 offset:43520
 s_add_u32 s63, s63, 4096
 buffer_load_dwordx4 v[40:43], v7, s[8:11], s63 offen offset:0 sc1
 v_exp_f32_e64 v196, v196
 v_mfma_f32_32x32x16_bf16 v[96:111], v[132:135], v[44:47], v[96:111]
 ds_read_b64_tr_b16 v[124:125], v146 offset:43008
 ds_read_b64_tr_b16 v[126:127], v146 offset:43520
 v_exp_f32_e64 v206, v206
 v_exp_f32 v197, v197
 s_waitcnt vmcnt(9) lgkmcnt(4)
 v_mfma_f32_32x32x16_bf16 v[80:95], v[112:115], v[8:11], v[80:95]
 ds_read_b64_tr_b16 v[128:129], v144 offset:45056
 ds_read_b64_tr_b16 v[130:131], v144 offset:45568
 buffer_load_dwordx4 v[44:47], v7, s[8:11], s63 offen offset:1024 sc1
 v_exp_f32_e64 v207, v207
 v_mfma_f32_32x32x16_bf16 v[96:111], v[116:119], v[8:11], v[96:111]
 ds_read_b64_tr_b16 v[132:133], v146 offset:45056
 ds_read_b64_tr_b16 v[134:135], v146 offset:45568
 v_add_f32 v6, v188, v189
 v_add_f32 v240, v198, v199
 v_add_f32 v6, v6, v190
 s_waitcnt vmcnt(9) lgkmcnt(4)
 v_mfma_f32_32x32x16_bf16 v[80:95], v[120:123], v[12:15], v[80:95]
 ds_read_b64_tr_b16 v[112:113], v144 offset:47104
 ds_read_b64_tr_b16 v[114:115], v144 offset:47616
 buffer_load_dwordx4 v[8:11], v7, s[8:11], s63 offen offset:2048 sc1
 v_add_f32 v240, v240, v200
 v_add_f32 v6, v6, v191
 v_mfma_f32_32x32x16_bf16 v[96:111], v[124:127], v[12:15], v[96:111]
 ds_read_b64_tr_b16 v[116:117], v146 offset:47104
 ds_read_b64_tr_b16 v[118:119], v146 offset:47616
 v_add_f32 v240, v240, v201
 v_add_f32 v6, v6, v192
 v_add_f32 v240, v240, v202
 s_waitcnt vmcnt(9) lgkmcnt(4)
 v_mfma_f32_32x32x16_bf16 v[80:95], v[128:131], v[16:19], v[80:95]
 ds_read_b64_tr_b16 v[120:121], v144 offset:49152
 ds_read_b64_tr_b16 v[122:123], v144 offset:49664
 buffer_load_dwordx4 v[12:15], v7, s[8:11], s63 offen offset:3072 sc1
 v_add_f32 v6, v6, v193
 v_add_f32 v240, v240, v203
 v_mfma_f32_32x32x16_bf16 v[96:111], v[132:135], v[16:19], v[96:111]
 ds_read_b64_tr_b16 v[124:125], v146 offset:49152
 ds_read_b64_tr_b16 v[126:127], v146 offset:49664
 v_add_f32 v6, v6, v194
 v_add_f32 v240, v240, v204
 v_add_f32 v6, v6, v195
 s_waitcnt vmcnt(9) lgkmcnt(4)
 v_mfma_f32_32x32x16_bf16 v[80:95], v[112:115], v[20:23], v[80:95]
 ds_read_b64_tr_b16 v[128:129], v144 offset:51200
 ds_read_b64_tr_b16 v[130:131], v144 offset:51712
 s_add_u32 s63, s63, 4096
 buffer_load_dwordx4 v[16:19], v7, s[8:11], s63 offen offset:0 sc1
 v_add_f32 v240, v240, v205
 v_add_f32 v6, v6, v196
 v_mfma_f32_32x32x16_bf16 v[96:111], v[116:119], v[20:23], v[96:111]
 ds_read_b64_tr_b16 v[132:133], v146 offset:51200
 ds_read_b64_tr_b16 v[134:135], v146 offset:51712
 v_add_f32 v240, v240, v206
 v_add_f32 v6, v6, v197
 v_add_f32 v240, v240, v207
 s_waitcnt vmcnt(8) lgkmcnt(4)
 v_mfma_f32_32x32x16_bf16 v[80:95], v[120:123], v[24:27], v[80:95]
 ds_read_b64_tr_b16 v[112:113], v144 offset:53248
 ds_read_b64_tr_b16 v[114:115], v144 offset:53760
 buffer_load_dwordx4 v[20:23], v7, s[8:11], s63 offen offset:1024 sc1
 v_mov_b32 v241, v6
 v_mov_b32 v170, v240
 v_mfma_f32_32x32x16_bf16 v[96:111], v[124:127], v[24:27], v[96:111]
 ds_read_b64_tr_b16 v[116:117], v146 offset:53248
 ds_read_b64_tr_b16 v[118:119], v146 offset:53760
 s_nop 0
 v_permlane32_swap_b32 v241, v6
 v_permlane32_swap_b32 v170, v240
 s_waitcnt vmcnt(8) lgkmcnt(4)
 v_mfma_f32_32x32x16_bf16 v[80:95], v[128:131], v[28:31], v[80:95]
 ds_read_b64_tr_b16 v[120:121], v144 offset:55296
 ds_read_b64_tr_b16 v[122:123], v144 offset:55808
 buffer_load_dwordx4 v[24:27], v7, s[8:11], s63 offen offset:2048 sc1
 v_add_f32 v6, v6, v241
 v_add_f32 v240, v240, v170
 v_mfma_f32_32x32x16_bf16 v[96:111], v[132:135], v[28:31], v[96:111]
 ds_read_b64_tr_b16 v[124:125], v146 offset:55296
 ds_read_b64_tr_b16 v[126:127], v146 offset:55808
 v_rcp_f32_e64 v172, v6
 v_rcp_f32 v174, v240
 s_waitcnt vmcnt(8) lgkmcnt(4)
 v_mfma_f32_32x32x16_bf16 v[80:95], v[112:115], v[32:35], v[80:95]
 ds_read_b64_tr_b16 v[128:129], v144 offset:57344
 ds_read_b64_tr_b16 v[130:131], v144 offset:57856
 buffer_load_dwordx4 v[28:31], v7, s[8:11], s63 offen offset:3072 sc1
 v_mul_f32 v188, v188, v172
 v_mul_f32 v198, v198, v174
 v_mfma_f32_32x32x16_bf16 v[96:111], v[116:119], v[32:35], v[96:111]
 ds_read_b64_tr_b16 v[132:133], v146 offset:57344
 ds_read_b64_tr_b16 v[134:135], v146 offset:57856
 v_mul_f32 v189, v189, v172
 v_mul_f32 v199, v199, v174
 v_mul_f32 v190, v190, v172
 s_waitcnt vmcnt(8) lgkmcnt(4)
 v_mfma_f32_32x32x16_bf16 v[80:95], v[120:123], v[36:39], v[80:95]
 ds_read_b64_tr_b16 v[112:113], v144 offset:59392
 ds_read_b64_tr_b16 v[114:115], v144 offset:59904
 s_add_u32 s63, s63, 4096
 buffer_load_dwordx4 v[32:35], v7, s[8:11], s63 offen offset:0 sc1
 v_mul_f32 v200, v200, v174
 v_mul_f32 v191, v191, v172
 v_mfma_f32_32x32x16_bf16 v[96:111], v[124:127], v[36:39], v[96:111]
 ds_read_b64_tr_b16 v[116:117], v146 offset:59392
 ds_read_b64_tr_b16 v[118:119], v146 offset:59904
 v_mul_f32 v201, v201, v174
 v_mul_f32 v192, v192, v172
 v_mul_f32 v202, v202, v174
 s_waitcnt vmcnt(8) lgkmcnt(4)
 v_mfma_f32_32x32x16_bf16 v[80:95], v[128:131], v[40:43], v[80:95]
 ds_read_b64_tr_b16 v[120:121], v144 offset:61440
 ds_read_b64_tr_b16 v[122:123], v144 offset:61952
 buffer_load_dwordx4 v[36:39], v7, s[8:11], s63 offen offset:1024 sc1
 v_mul_f32 v193, v193, v172
 v_mul_f32 v203, v203, v174
 v_mfma_f32_32x32x16_bf16 v[96:111], v[132:135], v[40:43], v[96:111]
 ds_read_b64_tr_b16 v[124:125], v146 offset:61440
 ds_read_b64_tr_b16 v[126:127], v146 offset:61952
 v_mul_f32 v194, v194, v172
 v_mul_f32 v204, v204, v174
 v_mul_f32 v195, v195, v172
 s_waitcnt vmcnt(8) lgkmcnt(4)
 v_mfma_f32_32x32x16_bf16 v[80:95], v[112:115], v[44:47], v[80:95]
 ds_read_b64_tr_b16 v[128:129], v144 offset:63488
 ds_read_b64_tr_b16 v[130:131], v144 offset:64000
 buffer_load_dwordx4 v[40:43], v7, s[8:11], s63 offen offset:2048 sc1
 v_mul_f32 v205, v205, v174
 v_mul_f32 v196, v196, v172
 v_mfma_f32_32x32x16_bf16 v[96:111], v[116:119], v[44:47], v[96:111]
 ds_read_b64_tr_b16 v[132:133], v146 offset:63488
 ds_read_b64_tr_b16 v[134:135], v146 offset:64000
 v_mul_f32 v206, v206, v174
 v_mul_f32 v197, v197, v172
 v_mul_f32 v207, v207, v174
 s_waitcnt vmcnt(8) lgkmcnt(4)
 v_mfma_f32_32x32x16_bf16 v[80:95], v[120:123], v[8:11], v[80:95]
 ds_read_b64_tr_b16 v[112:113], v145 offset:0
 ds_read_b64_tr_b16 v[114:115], v145 offset:512
 buffer_load_dwordx4 v[44:47], v7, s[8:11], s63 offen offset:3072 sc1
 v_cvt_pk_bf16_f32 v216, v188, v189
 v_cvt_pk_bf16_f32 v222, v198, v199
 v_mfma_f32_32x32x16_bf16 v[96:111], v[124:127], v[8:11], v[96:111]
 ds_read_b64_tr_b16 v[116:117], v147 offset:0
 ds_read_b64_tr_b16 v[118:119], v147 offset:512
 v_cvt_pk_bf16_f32 v217, v190, v191
 v_cvt_pk_bf16_f32 v223, v200, v201
 v_cvt_pk_bf16_f32 v218, v192, v193
 s_waitcnt vmcnt(8) lgkmcnt(4)
 v_mfma_f32_32x32x16_bf16 v[80:95], v[128:131], v[12:15], v[80:95]
 ds_read_b64_tr_b16 v[120:121], v145 offset:2048
 ds_read_b64_tr_b16 v[122:123], v145 offset:2560
 v_cvt_pk_bf16_f32 v224, v202, v203
 v_cvt_pk_bf16_f32 v219, v194, v195
 v_cvt_pk_bf16_f32 v225, v204, v205
 v_mfma_f32_32x32x16_bf16 v[96:111], v[132:135], v[12:15], v[96:111]
 ds_read_b64_tr_b16 v[124:125], v147 offset:2048
 ds_read_b64_tr_b16 v[126:127], v147 offset:2560
 v_cvt_pk_bf16_f32 v220, v196, v197
 v_cvt_pk_bf16_f32 v226, v206, v207
 ds_write_b128 v164, v[216:219] offset:0
 v_lshlrev_b32 v2, 6, v1
 v_add_u32 v2, 12288, v2
 buffer_load_dword v243, v2, s[8:11], 0 offen sc1
 v_min_u32_e64 v2, 15, v1
 v_lshlrev_b32 v2, 6, v2
 v_add_u32 v2, 16384, v2
 buffer_load_dword v244, v2, s[8:11], 0 offen sc1
 s_waitcnt vmcnt(9) lgkmcnt(5)
 v_mfma_f32_32x32x16_bf16 v[80:95], v[112:115], v[16:19], v[80:95]
 ds_read_b64_tr_b16 v[128:129], v145 offset:4096
 ds_read_b64_tr_b16 v[130:131], v145 offset:4608
 ds_write_b32 v164, v220 offset:16
 ds_write_b128 v164, v[222:225] offset:64
 ds_write_b32 v164, v226 offset:80
 v_mfma_f32_32x32x16_bf16 v[96:111], v[116:119], v[16:19], v[96:111]
 ds_read_b64_tr_b16 v[132:133], v147 offset:4096
 ds_read_b64_tr_b16 v[134:135], v147 offset:4608
 s_waitcnt vmcnt(8) lgkmcnt(8)
 v_mfma_f32_32x32x16_bf16 v[80:95], v[120:123], v[20:23], v[80:95]
 ds_read_b64_tr_b16 v[112:113], v145 offset:6144
 ds_read_b64_tr_b16 v[114:115], v145 offset:6656
 v_mfma_f32_32x32x16_bf16 v[96:111], v[124:127], v[20:23], v[96:111]
 ds_read_b64_tr_b16 v[116:117], v147 offset:6144
 ds_read_b64_tr_b16 v[118:119], v147 offset:6656
 s_waitcnt vmcnt(7) lgkmcnt(4)
 v_mfma_f32_32x32x16_bf16 v[80:95], v[128:131], v[24:27], v[80:95]
 ds_read_b64_tr_b16 v[120:121], v145 offset:8192
 ds_read_b64_tr_b16 v[122:123], v145 offset:8704
 s_waitcnt lgkmcnt(6)
 ds_read_b64_tr_b16 v[228:229], v167 offset:0
 ds_read_b64_tr_b16 v[230:231], v167 offset:832
 v_mfma_f32_32x32x16_bf16 v[96:111], v[132:135], v[24:27], v[96:111]
 ds_read_b64_tr_b16 v[124:125], v147 offset:8192
 ds_read_b64_tr_b16 v[126:127], v147 offset:8704
 ds_read_b64_tr_b16 v[232:233], v167 offset:64
 ds_read_b64_tr_b16 v[234:235], v167 offset:896
 ds_read_b64_tr_b16 v[236:237], v167 offset:128
 s_waitcnt vmcnt(6) lgkmcnt(9)
 v_mfma_f32_32x32x16_bf16 v[80:95], v[112:115], v[28:31], v[80:95]
 ds_read_b64_tr_b16 v[128:129], v145 offset:10240
 ds_read_b64_tr_b16 v[130:131], v145 offset:10752
 ds_read_b64_tr_b16 v[238:239], v167 offset:960
 ds_read_b64_tr_b16 v[172:173], v167 offset:3328
 ds_read_b64_tr_b16 v[174:175], v167 offset:4160
 v_mfma_f32_32x32x16_bf16 v[96:111], v[116:119], v[28:31], v[96:111]
 ds_read_b64_tr_b16 v[132:133], v147 offset:10240
 ds_read_b64_tr_b16 v[134:135], v147 offset:10752
 ds_read_b64_tr_b16 v[176:177], v167 offset:3392
 ds_read_b64_tr_b16 v[178:179], v167 offset:4224
 ds_read_b64_tr_b16 v[180:181], v167 offset:3456
 s_waitcnt vmcnt(5) lgkmcnt(13)
 v_mfma_f32_32x32x16_bf16 v[80:95], v[120:123], v[32:35], v[80:95]
 ds_read_b64_tr_b16 v[112:113], v145 offset:12288
 ds_read_b64_tr_b16 v[114:115], v145 offset:12800
 ds_read_b64_tr_b16 v[182:183], v167 offset:4288
 s_waitcnt lgkmcnt(10)
 v_mfma_f32_32x32x16_bf16 v[48:63], v[228:231], v[236:239], 0
 v_mfma_f32_32x32x16_bf16 v[96:111], v[124:127], v[32:35], v[96:111]
 ds_read_b64_tr_b16 v[116:117], v147 offset:12288
 ds_read_b64_tr_b16 v[118:119], v147 offset:12800
 v_mfma_f32_32x32x16_bf16 v[64:79], v[232:235], v[236:239], 0
 s_waitcnt vmcnt(4) lgkmcnt(8)
 v_mfma_f32_32x32x16_bf16 v[80:95], v[128:131], v[36:39], v[80:95]
 ds_read_b64_tr_b16 v[120:121], v145 offset:14336
 ds_read_b64_tr_b16 v[122:123], v145 offset:14848
 s_waitcnt lgkmcnt(4)
 v_mfma_f32_32x32x16_bf16 v[48:63], v[172:175], v[180:183], v[48:63]
 v_mfma_f32_32x32x16_bf16 v[96:111], v[132:135], v[36:39], v[96:111]
 ds_read_b64_tr_b16 v[124:125], v147 offset:14336
 ds_read_b64_tr_b16 v[126:127], v147 offset:14848
 v_mfma_f32_32x32x16_bf16 v[64:79], v[176:179], v[180:183], v[64:79]
 s_waitcnt vmcnt(3) lgkmcnt(4)
 v_mfma_f32_32x32x16_bf16 v[80:95], v[112:115], v[40:43], v[80:95]
 v_mfma_f32_32x32x16_bf16 v[96:111], v[116:119], v[40:43], v[96:111]
 s_waitcnt vmcnt(2) lgkmcnt(0)
 v_mfma_f32_32x32x16_bf16 v[80:95], v[120:123], v[44:47], v[80:95]
 v_mfma_f32_32x32x16_bf16 v[96:111], v[124:127], v[44:47], v[96:111]
 s_cmp_lg_u32 s42, 0
 s_cbranch_scc1 Lwo_24
 s_waitcnt vmcnt(0)
 v_subrev_u32 v2, 0x01010101, v242
 v_bfi_b32 v2, v242, 0, v2
 v_and_b32 v2, 0x80808080, v2
 v_cmp_ne_u32 vcc, 0, v2
 s_cbranch_vccnz Lwsl_26
 v_and_b32 v2, v243, v244
 v_cmp_ne_u32_e64 vcc, 1, v2
 s_cbranch_vccz Lwok_25
Lwsl_26:
 s_mov_b32 s72, s26
 s_and_b32 s73, s27, 0xffff
 s_mov_b32 s74, 256
 s_mov_b32 s75, 0x20000
 v_lshlrev_b32 v246, 2, v1
 s_mov_b32 s39, 1048576
Liwp_28:
 buffer_load_dword v245, v246, s[72:75], 0 offen sc1
 s_waitcnt vmcnt(0)
 v_subrev_u32 v2, 0x01010101, v245
 v_bfi_b32 v2, v245, 0, v2
 v_and_b32 v2, 0x80808080, v2
 v_cmp_ne_u32 vcc, 0, v2
 s_cbranch_vccz Liwd_29
 s_sub_u32 s39, s39, 1
 s_cmp_lg_u32 s39, 0
 s_cbranch_scc1 Liwp_28
Liwd_29:
Liw_27:
 v_lshlrev_b32 v245, 6, v1
 v_add_u32 v245, 12288, v245
 v_min_u32 v246, 15, v1
 v_lshlrev_b32 v246, 6, v246
 v_add_u32 v246, 16384, v246
 s_mov_b32 s39, 1048576
Lwrp_30:
 buffer_load_dword v243, v245, s[8:11], 0 offen sc1
 buffer_load_dword v244, v246, s[8:11], 0 offen sc1
 s_waitcnt vmcnt(0)
 v_and_b32 v2, v243, v244
 v_cmp_ne_u32 vcc, 1, v2
 s_cbranch_vccz Lwrd_31
 s_sub_u32 s39, s39, 1
 s_cmp_lg_u32 s39, 0
 s_cbranch_scc1 Lwrp_30
Lwrd_31:
Lwok_25:
 s_lshr_b32 s69, s4, 2
 s_mul_i32 s69, s69, 102400
 s_add_u32 s69, s69, 15597568
 s_lshr_b32 s70, s5, 1
 s_lshl_b32 s68, s70, 13
 s_add_u32 s68, s69, s68
 s_lshl_b32 s70, s70, 11
 s_add_u32 s69, s69, s70
 s_add_u32 s69, s69, 16384
Lwo_24:
 s_cmp_gt_u32 s4, 20
 s_cbranch_scc1 Lzp_32
 v_mov_b32 v248, -1
 v_mov_b32 v249, -1
 v_mov_b32 v250, -1
 v_mov_b32_e64 v251, -1
 s_mul_i32 s44, s3, 344064
 s_add_u32 s44, s44, s62
 s_lshl_b32 s45, s4, 14
 s_add_u32 s44, s44, s45
 s_lshl_b32 s45, s5, 12
 s_add_u32 s44, s44, s45
 buffer_store_dwordx4 v[248:251], v7, s[8:11], s44 offen offset:0 sc1
 buffer_store_dwordx4 v[248:251], v7, s[8:11], s44 offen offset:1024 sc1
 buffer_store_dwordx4 v[248:251], v7, s[8:11], s44 offen offset:2048 sc1
 buffer_store_dwordx4 v[248:251], v7, s[8:11], s44 offen offset:3072 sc1
Lzp_32:
 s_cmp_lg_u32 s42, 0
 s_cbranch_scc1 Ld1_33
 s_nop 5
 v_cvt_pk_bf16_f32 v208, v96, v97
 v_cvt_pk_bf16_f32 v209, v98, v99
 v_cvt_pk_bf16_f32 v210, v100, v101
 v_cvt_pk_bf16_f32 v211, v102, v103
 v_cvt_pk_bf16_f32 v212, v104, v105
 v_cvt_pk_bf16_f32 v213, v106, v107
 s_add_u32 s70, s68, 0
 buffer_load_dwordx4 a[0:3], v7, s[8:11], s70 offen
 v_cvt_pk_bf16_f32 v214, v108, v109
 v_cvt_pk_bf16_f32 v215, v110, v111
 v_mfma_f32_32x32x16_bf16 v[172:187], v[136:139], v[208:211], 0
 s_nop 0
 v_mfma_f32_32x32x16_bf16 v[172:187], v[140:143], v[212:215], v[172:187]
 v_cvt_pk_bf16_f32 v156, v80, v81
 s_add_u32 s70, s68, 20480
 buffer_load_dwordx4 a[4:7], v7, s[8:11], s70 offen
 v_cvt_pk_bf16_f32 v157, v82, v83
 v_cvt_pk_bf16_f32 v158, v84, v85
 v_cvt_pk_bf16_f32 v159, v86, v87
 v_cvt_pk_bf16_f32 v160, v88, v89
 v_cvt_pk_bf16_f32 v161, v90, v91
 v_cvt_pk_bf16_f32 v162, v92, v93
 s_add_u32 s70, s68, 40960
 buffer_load_dwordx4 a[8:11], v7, s[8:11], s70 offen
 v_cvt_pk_bf16_f32 v163, v94, v95
 v_cndmask_b32_e64 v228, v169, v160, s[54:55]
 v_cndmask_b32_e64 v229, 0, v161, s[54:55]
 ds_write_b64 v165, v[162:163] offset:6656
 ds_write_b64 v165, v[214:215] offset:6672
 s_add_u32 s70, s68, 61440
 buffer_load_dwordx4 a[12:15], v7, s[8:11], s70 offen
 ds_write_b64 v166, v[228:229] offset:6656
 v_max3_f32 v170, v172, v173, v174
 v_min3_f32 v171, v172, v173, v174
 v_max3_f32 v170, v170, v175, v176
 v_min3_f32 v171, v171, v175, v176
 s_add_u32 s70, s68, 81920
 buffer_load_dwordx4 a[16:19], v7, s[8:11], s70 offen
 v_max3_f32 v170, v170, v177, v178
 v_min3_f32 v171, v171, v177, v178
 v_max3_f32 v170, v170, v179, v180
 v_min3_f32 v171, v171, v179, v180
 v_max_f32 v170, v170, v181
 v_min_f32 v171, v171, v181
 s_add_u32 s70, s68, 1024
 buffer_load_dwordx4 a[20:23], v7, s[8:11], s70 offen
 v_mov_b32_e64 v241, v170
 v_mov_b32 v6, v171
 s_nop 0
 v_permlane32_swap_b32 v241, v170
 v_permlane32_swap_b32 v6, v171
 s_add_u32 s70, s68, 21504
 buffer_load_dwordx4 a[24:27], v7, s[8:11], s70 offen
 v_max_f32 v170, v170, v241
 v_min_f32 v171, v171, v6
 v_mul_f32 v170, 0xbfb8aa3b, v170
 v_mul_f32 v171, 0x3fb8aa3b, v171
 v_pk_fma_f32 v[188:189], v[172:173], s[52:53], v[170:171] op_sel_hi:[1,1,0]
 s_add_u32 s70, s68, 41984
 buffer_load_dwordx4 a[28:31], v7, s[8:11], s70 offen
 v_pk_fma_f32 v[198:199], v[172:173], s[52:53], v[170:171] op_sel:[0,0,1] op_sel_hi:[1,1,1] neg_lo:[1,0,0] neg_hi:[1,0,0]
 v_pk_fma_f32 v[190:191], v[174:175], s[52:53], v[170:171] op_sel_hi:[1,1,0]
 v_pk_fma_f32 v[200:201], v[174:175], s[52:53], v[170:171] op_sel:[0,0,1] op_sel_hi:[1,1,1] neg_lo:[1,0,0] neg_hi:[1,0,0]
 v_pk_fma_f32 v[192:193], v[176:177], s[52:53], v[170:171] op_sel_hi:[1,1,0]
 v_pk_fma_f32 v[202:203], v[176:177], s[52:53], v[170:171] op_sel:[0,0,1] op_sel_hi:[1,1,1] neg_lo:[1,0,0] neg_hi:[1,0,0]
 v_pk_fma_f32 v[194:195], v[178:179], s[52:53], v[170:171] op_sel_hi:[1,1,0]
 s_add_u32 s70, s68, 62464
 buffer_load_dwordx4 a[32:35], v7, s[8:11], s70 offen
 v_pk_fma_f32 v[204:205], v[178:179], s[52:53], v[170:171] op_sel:[0,0,1] op_sel_hi:[1,1,1] neg_lo:[1,0,0] neg_hi:[1,0,0]
 v_pk_fma_f32 v[196:197], v[180:181], s[52:53], v[170:171] op_sel_hi:[1,1,0]
 v_pk_fma_f32 v[206:207], v[180:181], s[52:53], v[170:171] op_sel:[0,0,1] op_sel_hi:[1,1,1] neg_lo:[1,0,0] neg_hi:[1,0,0]
 v_exp_f32 v188, v188
 v_exp_f32 v198, v198
 s_add_u32 s70, s68, 82944
 buffer_load_dwordx4 a[36:39], v7, s[8:11], s70 offen
 v_exp_f32 v189, v189
 v_exp_f32 v199, v199
 v_exp_f32 v190, v190
 v_exp_f32 v200, v200
 v_exp_f32_e64 v191, v191
 s_add_u32 s70, s68, 2048
 buffer_load_dwordx4 a[40:43], v7, s[8:11], s70 offen
 v_exp_f32 v201, v201
 v_exp_f32 v192, v192
 v_exp_f32 v202, v202
 v_exp_f32 v193, v193
 v_exp_f32 v203, v203
 v_exp_f32 v194, v194
 s_add_u32 s70, s68, 22528
 buffer_load_dwordx4 a[44:47], v7, s[8:11], s70 offen
 v_exp_f32 v204, v204
 v_exp_f32 v195, v195
 v_exp_f32 v205, v205
 v_exp_f32 v196, v196
 v_exp_f32_e64 v206, v206
 s_add_u32 s70, s68, 43008
 buffer_load_dwordx4 a[48:51], v7, s[8:11], s70 offen
 v_exp_f32 v197, v197
 v_exp_f32 v207, v207
 v_pk_add_f32 v[172:173], v[188:189], v[190:191]
 v_pk_add_f32 v[174:175], v[192:193], v[194:195]
 v_pk_add_f32 v[176:177], v[198:199], v[200:201]
 v_pk_add_f32 v[178:179], v[202:203], v[204:205]
 s_add_u32 s70, s68, 63488
 buffer_load_dwordx4 a[52:55], v7, s[8:11], s70 offen
 v_pk_add_f32 v[172:173], v[172:173], v[196:197]
 v_pk_add_f32 v[176:177], v[176:177], v[206:207]
 v_pk_add_f32 v[172:173], v[172:173], v[174:175]
 v_pk_add_f32 v[176:177], v[176:177], v[178:179]
 v_add_f32_e64 v6, v172, v173
 s_add_u32 s70, s68, 83968
 buffer_load_dwordx4 a[56:59], v7, s[8:11], s70 offen
 v_add_f32 v240, v176, v177
 v_mov_b32 v241, v6
 v_mov_b32_e64 v170, v240
 s_nop 0
 v_permlane32_swap_b32 v241, v6
 s_add_u32 s70, s68, 3072
 buffer_load_dwordx4 a[60:63], v7, s[8:11], s70 offen
 v_permlane32_swap_b32 v170, v240
 v_add_f32 v6, v6, v241
 v_add_f32 v240, v240, v170
 v_rcp_f32 v172, v6
 v_rcp_f32_e64 v174, v240
 v_pk_mul_f32 v[188:189], v[188:189], v[172:173] op_sel_hi:[1,0]
 s_add_u32 s70, s68, 23552
 buffer_load_dwordx4 a[64:67], v7, s[8:11], s70 offen
 v_pk_mul_f32 v[198:199], v[198:199], v[174:175] op_sel_hi:[1,0]
 v_pk_mul_f32 v[190:191], v[190:191], v[172:173] op_sel_hi:[1,0]
 v_pk_mul_f32 v[200:201], v[200:201], v[174:175] op_sel_hi:[1,0]
 v_pk_mul_f32 v[192:193], v[192:193], v[172:173] op_sel_hi:[1,0]
 v_pk_mul_f32 v[202:203], v[202:203], v[174:175] op_sel_hi:[1,0]
 s_add_u32 s70, s68, 44032
 buffer_load_dwordx4 a[68:71], v7, s[8:11], s70 offen
 v_pk_mul_f32 v[194:195], v[194:195], v[172:173] op_sel_hi:[1,0]
 v_pk_mul_f32 v[204:205], v[204:205], v[174:175] op_sel_hi:[1,0]
 v_pk_mul_f32 v[196:197], v[196:197], v[172:173] op_sel_hi:[1,0]
 v_pk_mul_f32 v[206:207], v[206:207], v[174:175] op_sel_hi:[1,0]
 v_cvt_pk_bf16_f32 v216, v188, v189
 s_add_u32 s70, s68, 64512
 buffer_load_dwordx4 a[72:75], v7, s[8:11], s70 offen
 v_cvt_pk_bf16_f32 v222, v198, v199
 v_cvt_pk_bf16_f32 v217, v190, v191
 v_cvt_pk_bf16_f32 v223, v200, v201
 v_cvt_pk_bf16_f32 v218, v192, v193
 v_cvt_pk_bf16_f32 v224, v202, v203
 v_cvt_pk_bf16_f32 v219, v194, v195
 s_add_u32 s70, s68, 84992
 buffer_load_dwordx4 a[76:79], v7, s[8:11], s70 offen
 v_cvt_pk_bf16_f32 v225, v204, v205
 v_cvt_pk_bf16_f32 v220, v196, v197
 v_cvt_pk_bf16_f32 v226, v206, v207
 ds_write_b128 v164, v[216:219] offset:6656
 ds_write_b32 v164, v220 offset:6672
 s_add_u32 s70, s68, 4096
 buffer_load_dwordx4 a[80:83], v7, s[8:11], s70 offen
 ds_write_b128 v164, v[222:225] offset:6720
 ds_write_b32 v164, v226 offset:6736
 s_waitcnt lgkmcnt(0)
 ds_read_b64_tr_b16 v[228:229], v167 offset:6656
 ds_read_b64_tr_b16 v[230:231], v167 offset:7488
 s_add_u32 s70, s68, 24576
 buffer_load_dwordx4 a[84:87], v7, s[8:11], s70 offen
 ds_read_b64_tr_b16 v[232:233], v167 offset:6720
 ds_read_b64_tr_b16 v[234:235], v167 offset:7552
 ds_read_b64_tr_b16 v[236:237], v167 offset:6784
 ds_read_b64_tr_b16 v[238:239], v167 offset:7616
 ds_read_b64_tr_b16 v[172:173], v167 offset:9984
 ds_read_b64_tr_b16 v[174:175], v167 offset:10816
 s_add_u32 s70, s68, 45056
 buffer_load_dwordx4 a[88:91], v7, s[8:11], s70 offen
 ds_read_b64_tr_b16 v[176:177], v167 offset:10048
 ds_read_b64_tr_b16 v[178:179], v167 offset:10880
 ds_read_b64_tr_b16 v[180:181], v167 offset:10112
 ds_read_b64_tr_b16 v[182:183], v167 offset:10944
 s_waitcnt lgkmcnt(6)
 s_add_u32 s70, s68, 65536
 buffer_load_dwordx4 a[92:95], v7, s[8:11], s70 offen
 v_mfma_f32_32x32x16_bf16 v[48:63], v[228:231], v[236:239], v[48:63]
 v_mfma_f32_32x32x16_bf16 v[64:79], v[232:235], v[236:239], v[64:79]
 s_waitcnt lgkmcnt(0)
 v_mfma_f32_32x32x16_bf16 v[48:63], v[172:175], v[180:183], v[48:63]
 v_mfma_f32_32x32x16_bf16 v[64:79], v[176:179], v[180:183], v[64:79]
 s_branch Ld2_34
Ld1_33:
 s_nop 5
 v_cvt_pk_bf16_f32 v208, v96, v97
 v_cvt_pk_bf16_f32 v209, v98, v99
 v_cvt_pk_bf16_f32 v210, v100, v101
 v_cvt_pk_bf16_f32 v211, v102, v103
 v_cvt_pk_bf16_f32 v212, v104, v105
 v_cvt_pk_bf16_f32 v213, v106, v107
 v_cvt_pk_bf16_f32 v214, v108, v109
 v_cvt_pk_bf16_f32 v215, v110, v111
 v_mfma_f32_32x32x16_bf16 v[172:187], v[136:139], v[208:211], 0
 s_nop 0
 v_mfma_f32_32x32x16_bf16 v[172:187], v[140:143], v[212:215], v[172:187]
 v_cvt_pk_bf16_f32 v156, v80, v81
 v_cvt_pk_bf16_f32 v157, v82, v83
 v_cvt_pk_bf16_f32 v158, v84, v85
 v_cvt_pk_bf16_f32 v159, v86, v87
 v_cvt_pk_bf16_f32 v160, v88, v89
 v_cvt_pk_bf16_f32 v161, v90, v91
 v_cvt_pk_bf16_f32 v162, v92, v93
 v_cvt_pk_bf16_f32 v163, v94, v95
 v_cndmask_b32_e64 v228, v169, v160, s[54:55]
 v_cndmask_b32_e64 v229, 0, v161, s[54:55]
 ds_write_b64 v165, v[162:163] offset:6656
 ds_write_b64 v165, v[214:215] offset:6672
 ds_write_b64 v166, v[228:229] offset:6656
 v_max3_f32 v170, v172, v173, v174
 v_min3_f32 v171, v172, v173, v174
 v_max3_f32 v170, v170, v175, v176
 v_min3_f32 v171, v171, v175, v176
 v_max3_f32 v170, v170, v177, v178
 v_min3_f32 v171, v171, v177, v178
 v_max3_f32 v170, v170, v179, v180
 v_min3_f32 v171, v171, v179, v180
 v_max_f32 v170, v170, v181
 v_min_f32 v171, v171, v181
 v_mov_b32 v241, v170
 v_mov_b32 v6, v171
 s_nop 0
 v_permlane32_swap_b32 v241, v170
 v_permlane32_swap_b32 v6, v171
 v_max_f32 v170, v170, v241
 v_min_f32_e64 v171, v171, v6
 v_mul_f32 v170, 0xbfb8aa3b, v170
 v_mul_f32 v171, 0x3fb8aa3b, v171
 v_pk_fma_f32 v[188:189], v[172:173], s[52:53], v[170:171] op_sel_hi:[1,1,0]
 v_pk_fma_f32 v[198:199], v[172:173], s[52:53], v[170:171] op_sel:[0,0,1] op_sel_hi:[1,1,1] neg_lo:[1,0,0] neg_hi:[1,0,0]
 v_pk_fma_f32 v[190:191], v[174:175], s[52:53], v[170:171] op_sel_hi:[1,1,0]
 v_pk_fma_f32 v[200:201], v[174:175], s[52:53], v[170:171] op_sel:[0,0,1] op_sel_hi:[1,1,1] neg_lo:[1,0,0] neg_hi:[1,0,0]
 v_pk_fma_f32 v[192:193], v[176:177], s[52:53], v[170:171] op_sel_hi:[1,1,0]
 v_pk_fma_f32 v[202:203], v[176:177], s[52:53], v[170:171] op_sel:[0,0,1] op_sel_hi:[1,1,1] neg_lo:[1,0,0] neg_hi:[1,0,0]
 v_pk_fma_f32 v[194:195], v[178:179], s[52:53], v[170:171] op_sel_hi:[1,1,0]
 v_pk_fma_f32 v[204:205], v[178:179], s[52:53], v[170:171] op_sel:[0,0,1] op_sel_hi:[1,1,1] neg_lo:[1,0,0] neg_hi:[1,0,0]
 v_pk_fma_f32 v[196:197], v[180:181], s[52:53], v[170:171] op_sel_hi:[1,1,0]
 v_pk_fma_f32 v[206:207], v[180:181], s[52:53], v[170:171] op_sel:[0,0,1] op_sel_hi:[1,1,1] neg_lo:[1,0,0] neg_hi:[1,0,0]
 v_exp_f32 v188, v188
 v_exp_f32 v198, v198
 v_exp_f32 v189, v189
 v_exp_f32 v199, v199
 v_exp_f32 v190, v190
 v_exp_f32 v200, v200
 v_exp_f32 v191, v191
 v_exp_f32 v201, v201
 v_exp_f32 v192, v192
 v_exp_f32 v202, v202
 v_exp_f32 v193, v193
 v_exp_f32 v203, v203
 v_exp_f32 v194, v194
 v_exp_f32 v204, v204
 v_exp_f32 v195, v195
 v_exp_f32 v205, v205
 v_exp_f32 v196, v196
 v_exp_f32 v206, v206
 v_exp_f32 v197, v197
 v_exp_f32 v207, v207
 v_pk_add_f32 v[172:173], v[188:189], v[190:191]
 v_pk_add_f32 v[174:175], v[192:193], v[194:195]
 v_pk_add_f32 v[176:177], v[198:199], v[200:201]
 v_pk_add_f32 v[178:179], v[202:203], v[204:205]
 v_pk_add_f32 v[172:173], v[172:173], v[196:197]
 v_pk_add_f32 v[176:177], v[176:177], v[206:207]
 v_pk_add_f32 v[172:173], v[172:173], v[174:175]
 v_pk_add_f32 v[176:177], v[176:177], v[178:179]
 v_add_f32 v6, v172, v173
 v_add_f32 v240, v176, v177
 v_mov_b32 v241, v6
 v_mov_b32 v170, v240
 s_nop 0
 v_permlane32_swap_b32 v241, v6
 v_permlane32_swap_b32 v170, v240
 v_add_f32 v6, v6, v241
 v_add_f32 v240, v240, v170
 v_rcp_f32 v172, v6
 v_rcp_f32_e64 v174, v240
 v_pk_mul_f32 v[188:189], v[188:189], v[172:173] op_sel_hi:[1,0]
 v_pk_mul_f32 v[198:199], v[198:199], v[174:175] op_sel_hi:[1,0]
 v_pk_mul_f32 v[190:191], v[190:191], v[172:173] op_sel_hi:[1,0]
 v_pk_mul_f32 v[200:201], v[200:201], v[174:175] op_sel_hi:[1,0]
 v_pk_mul_f32 v[192:193], v[192:193], v[172:173] op_sel_hi:[1,0]
 v_pk_mul_f32 v[202:203], v[202:203], v[174:175] op_sel_hi:[1,0]
 v_pk_mul_f32 v[194:195], v[194:195], v[172:173] op_sel_hi:[1,0]
 v_pk_mul_f32 v[204:205], v[204:205], v[174:175] op_sel_hi:[1,0]
 v_pk_mul_f32 v[196:197], v[196:197], v[172:173] op_sel_hi:[1,0]
 v_pk_mul_f32 v[206:207], v[206:207], v[174:175] op_sel_hi:[1,0]
 v_cvt_pk_bf16_f32 v216, v188, v189
 v_cvt_pk_bf16_f32 v222, v198, v199
 v_cvt_pk_bf16_f32 v217, v190, v191
 v_cvt_pk_bf16_f32 v223, v200, v201
 v_cvt_pk_bf16_f32 v218, v192, v193
 v_cvt_pk_bf16_f32 v224, v202, v203
 v_cvt_pk_bf16_f32 v219, v194, v195
 v_cvt_pk_bf16_f32 v225, v204, v205
 v_cvt_pk_bf16_f32 v220, v196, v197
 v_cvt_pk_bf16_f32 v226, v206, v207
 ds_write_b128 v164, v[216:219] offset:6656
 ds_write_b32 v164, v220 offset:6672
 ds_write_b128 v164, v[222:225] offset:6720
 ds_write_b32 v164, v226 offset:6736
 s_waitcnt lgkmcnt(0)
 ds_read_b64_tr_b16 v[228:229], v167 offset:6656
 ds_read_b64_tr_b16 v[230:231], v167 offset:7488
 ds_read_b64_tr_b16 v[232:233], v167 offset:6720
 ds_read_b64_tr_b16 v[234:235], v167 offset:7552
 ds_read_b64_tr_b16 v[236:237], v167 offset:6784
 ds_read_b64_tr_b16 v[238:239], v167 offset:7616
 ds_read_b64_tr_b16 v[172:173], v167 offset:9984
 ds_read_b64_tr_b16 v[174:175], v167 offset:10816
 ds_read_b64_tr_b16 v[176:177], v167 offset:10048
 ds_read_b64_tr_b16 v[178:179], v167 offset:10880
 ds_read_b64_tr_b16 v[180:181], v167 offset:10112
 ds_read_b64_tr_b16 v[182:183], v167 offset:10944
 s_waitcnt lgkmcnt(6)
 v_mfma_f32_32x32x16_bf16 v[48:63], v[228:231], v[236:239], v[48:63]
 v_mfma_f32_32x32x16_bf16 v[64:79], v[232:235], v[236:239], v[64:79]
 s_waitcnt lgkmcnt(0)
 v_mfma_f32_32x32x16_bf16 v[48:63], v[172:175], v[180:183], v[48:63]
 v_mfma_f32_32x32x16_bf16 v[64:79], v[176:179], v[180:183], v[64:79]
Ld2_34:
 s_mov_b64 s[6:7], exec
 s_mov_b32 exec_lo, 0x00ffffff
 s_mov_b32 exec_hi, 0x00ffffff
 s_nop 7
 ds_write_b32 v168, v48 offset:0
 ds_write_b32 v168, v49 offset:96
 ds_write_b32 v168, v50 offset:192
 ds_write_b32 v168, v51 offset:288
 ds_write_b32 v168, v56 offset:1920
 ds_write_b32 v168, v57 offset:2016
 ds_write_b32 v168, v58 offset:2112
 ds_write_b32 v168, v59 offset:2208
 ds_write_b32 v168, v64 offset:960
 ds_write_b32 v168, v65 offset:1056
 ds_write_b32 v168, v66 offset:1152
 ds_write_b32 v168, v67 offset:1248
 ds_write_b32 v168, v72 offset:2880
 ds_write_b32 v168, v73 offset:2976
 ds_write_b32 v168, v74 offset:3072
 ds_write_b32 v168, v75 offset:3168
 s_mov_b32 exec_hi, 0
 ds_write_b32 v168, v52 offset:768
 ds_write_b32 v168, v53 offset:864
 ds_write_b32 v168, v60 offset:2688
 ds_write_b32 v168, v61 offset:2784
 ds_write_b32 v168, v68 offset:1728
 ds_write_b32 v168, v69 offset:1824
 ds_write_b32 v168, v76 offset:3648
 ds_write_b32 v168, v77 offset:3744
 s_mov_b64 exec, s[6:7]
 s_waitcnt lgkmcnt(0)
 s_barrier
 v_lshlrev_b32 v2, 4, v0
 v_add_u32 v3, 97280, v2
 ds_read_b128 v[172:175], v3 offset:0
 ds_read_b128 v[176:179], v3 offset:13312
 ds_read_b128 v[180:183], v3 offset:26624
 ds_read_b128 v[184:187], v3 offset:39936
 s_lshl_b32 s71, s4, 14
 s_add_u32 s71, s71, s57
 s_lshl_b32 s44, s3, 11
 s_add_u32 s44, s44, s71
 v_lshrrev_b32_e64 v245, 1, v2
 v_cmp_gt_u32 vcc, 240, v0
 v_mov_b32 v3, 2146435072
 s_nop 0
 v_cndmask_b32_e64 v245, v3, v245, vcc
 s_waitcnt lgkmcnt(0)
 v_pk_add_f32 v[172:173], v[172:173], v[176:177]
 v_pk_add_f32 v[174:175], v[174:175], v[178:179]
 v_pk_add_f32 v[172:173], v[172:173], v[180:181]
 v_pk_add_f32 v[174:175], v[174:175], v[182:183]
 v_pk_add_f32 v[172:173], v[172:173], v[184:185]
 v_pk_add_f32 v[174:175], v[174:175], v[186:187]
 v_cvt_pk_bf16_f32 v176, v172, v173
 v_cvt_pk_bf16_f32 v177, v174, v175
 s_cmp_lg_u32 s42, 0
 s_cbranch_scc1 Lzw_35
 s_waitcnt vmcnt(24)
 s_branch Lzw_36
Lzw_35:
 s_waitcnt vmcnt(0)
Lzw_36:
 buffer_store_dwordx2 v[176:177], v245, s[8:11], s44 offen sc1
 s_cmp_lg_u32 s42, 0
 s_cbranch_scc1 Ld1_37
 v_mov_b32 v90, 0
 v_mov_b32 v91, 0
 v_mfma_f32_32x32x16_bf16 v[172:187], v[136:139], v[148:151], 0
 v_mfma_f32_32x32x16_bf16 v[172:187], v[140:143], v[152:155], v[172:187]
 s_nop 11
 v_max3_f32 v170, v172, v173, v174
 v_min3_f32 v171, v172, v173, v174
 s_mov_b32 s70, fnet_tab-Lpc+15360
 buffer_load_dwordx4 a[240:243], v7, s[32:35], s70 offen
 v_max3_f32 v170, v170, v175, v176
 v_min3_f32 v171, v171, v175, v176
 v_max3_f32 v170, v170, v177, v178
 v_min3_f32 v171, v171, v177, v178
 v_max3_f32 v170, v170, v179, v180
 v_min3_f32 v171, v171, v179, v180
 s_mov_b32 s70, fnet_tab-Lpc+16384
 buffer_load_dwordx4 a[244:247], v7, s[32:35], s70 offen
 v_max_f32 v170, v170, v181
 v_min_f32 v171, v171, v181
 v_mov_b32 v241, v170
 v_mov_b32 v6, v171
 s_nop 0
 v_permlane32_swap_b32 v241, v170
 s_min_u32 s70, s4, 20
 s_lshl_b32 s70, s70, 11
 s_add_u32 s70, s70, fnet_tab-Lpc+20480
 buffer_load_dwordx4 a[232:235], v7, s[32:35], s70 offen
 v_permlane32_swap_b32 v6, v171
 v_max_f32 v170, v170, v241
 v_min_f32_e64 v171, v171, v6
 v_mul_f32 v170, 0xbfb8aa3b, v170
 v_mul_f32 v171, 0x3fb8aa3b, v171
 s_min_u32 s70, s4, 20
 s_lshl_b32 s70, s70, 11
 s_add_u32 s70, s70, fnet_tab-Lpc+21504
 buffer_load_dwordx4 a[236:239], v7, s[32:35], s70 offen
 v_pk_fma_f32 v[188:189], v[172:173], s[52:53], v[170:171] op_sel_hi:[1,1,0]
 v_pk_fma_f32 v[198:199], v[172:173], s[52:53], v[170:171] op_sel:[0,0,1] op_sel_hi:[1,1,1] neg_lo:[1,0,0] neg_hi:[1,0,0]
 v_pk_fma_f32 v[190:191], v[174:175], s[52:53], v[170:171] op_sel_hi:[1,1,0]
 v_pk_fma_f32 v[200:201], v[174:175], s[52:53], v[170:171] op_sel:[0,0,1] op_sel_hi:[1,1,1] neg_lo:[1,0,0] neg_hi:[1,0,0]
 v_pk_fma_f32 v[192:193], v[176:177], s[52:53], v[170:171] op_sel_hi:[1,1,0]
 v_pk_fma_f32 v[202:203], v[176:177], s[52:53], v[170:171] op_sel:[0,0,1] op_sel_hi:[1,1,1] neg_lo:[1,0,0] neg_hi:[1,0,0]
 s_mov_b32 s70, fnet_tab-Lpc+17408
 buffer_load_dwordx4 a[248:251], v7, s[32:35], s70 offen
 v_pk_fma_f32 v[194:195], v[178:179], s[52:53], v[170:171] op_sel_hi:[1,1,0]
 v_pk_fma_f32 v[204:205], v[178:179], s[52:53], v[170:171] op_sel:[0,0,1] op_sel_hi:[1,1,1] neg_lo:[1,0,0] neg_hi:[1,0,0]
 v_pk_fma_f32 v[196:197], v[180:181], s[52:53], v[170:171] op_sel_hi:[1,1,0]
 v_pk_fma_f32 v[206:207], v[180:181], s[52:53], v[170:171] op_sel:[0,0,1] op_sel_hi:[1,1,1] neg_lo:[1,0,0] neg_hi:[1,0,0]
 v_exp_f32_e64 v188, v188
 v_exp_f32 v198, v198
 s_or_b32 s70, s3, s4
 s_min_u32 s70, s70, 1
 s_lshl_b32 s70, s70, 10
 s_sub_u32 s70, fnet_tab-Lpc+19456, s70
 buffer_load_dwordx4 a[252:255], v7, s[32:35], s70 offen
 v_exp_f32 v189, v189
 v_exp_f32 v199, v199
 v_exp_f32 v190, v190
 v_exp_f32 v200, v200
 v_exp_f32_e64 v191, v191
 v_exp_f32 v201, v201
 s_lshl_b32 s70, s3, 2
 s_add_u32 s70, s70, s5
 s_lshl_b32 s70, s70, 12
 s_add_u32 s70, s70, fnet_tab-Lpc+63488
 buffer_load_dwordx4 a[200:203], v7, s[32:35], s70 offen
 v_exp_f32 v192, v192
 v_exp_f32 v202, v202
 v_exp_f32 v193, v193
 v_exp_f32 v203, v203
 v_exp_f32 v194, v194
 s_lshl_b32 s70, s3, 2
 s_add_u32 s70, s70, s5
 s_lshl_b32 s70, s70, 12
 s_add_u32 s70, s70, fnet_tab-Lpc+64512
 buffer_load_dwordx4 a[208:211], v7, s[32:35], s70 offen
 v_exp_f32 v204, v204
 v_exp_f32 v195, v195
 v_exp_f32 v205, v205
 v_exp_f32 v196, v196
 v_exp_f32_e64 v206, v206
 v_exp_f32 v197, v197
 s_lshl_b32 s70, s3, 2
 s_add_u32 s70, s70, s5
 s_lshl_b32 s70, s70, 12
 s_add_u32 s70, s70, fnet_tab-Lpc+65536
 buffer_load_dwordx4 a[216:219], v7, s[32:35], s70 offen
 v_exp_f32 v207, v207
 v_pk_add_f32 v[172:173], v[188:189], v[190:191]
 v_pk_add_f32 v[174:175], v[192:193], v[194:195]
 v_pk_add_f32 v[176:177], v[198:199], v[200:201]
 v_pk_add_f32 v[178:179], v[202:203], v[204:205]
 v_pk_add_f32 v[172:173], v[172:173], v[196:197]
 s_lshl_b32 s70, s3, 2
 s_add_u32 s70, s70, s5
 s_lshl_b32 s70, s70, 12
 s_add_u32 s70, s70, fnet_tab-Lpc+66560
 buffer_load_dwordx4 a[224:227], v7, s[32:35], s70 offen
 v_pk_add_f32 v[176:177], v[176:177], v[206:207]
 v_pk_add_f32 v[172:173], v[172:173], v[174:175]
 v_pk_add_f32 v[176:177], v[176:177], v[178:179]
 v_add_f32 v6, v172, v173
 v_add_f32 v240, v176, v177
 v_mov_b32_e64 v241, v6
 s_add_u32 s70, s68, 86016
 buffer_load_dwordx4 a[96:99], v7, s[8:11], s70 offen
 v_mov_b32 v170, v240
 s_nop 0
 v_permlane32_swap_b32 v241, v6
 v_permlane32_swap_b32 v170, v240
 v_add_f32_e64 v6, v6, v241
 s_add_u32 s70, s68, 5120
 buffer_load_dwordx4 a[100:103], v7, s[8:11], s70 offen
 v_add_f32 v240, v240, v170
 v_rcp_f32 v172, v6
 v_rcp_f32_e64 v174, v240
 v_pk_mul_f32 v[188:189], v[188:189], v[172:173] op_sel_hi:[1,0]
 v_pk_mul_f32 v[198:199], v[198:199], v[174:175] op_sel_hi:[1,0]
 v_pk_mul_f32 v[190:191], v[190:191], v[172:173] op_sel_hi:[1,0]
 s_add_u32 s70, s68, 25600
 buffer_load_dwordx4 a[104:107], v7, s[8:11], s70 offen
 v_pk_mul_f32 v[200:201], v[200:201], v[174:175] op_sel_hi:[1,0]
 v_pk_mul_f32 v[192:193], v[192:193], v[172:173] op_sel_hi:[1,0]
 v_pk_mul_f32 v[202:203], v[202:203], v[174:175] op_sel_hi:[1,0]
 v_pk_mul_f32 v[194:195], v[194:195], v[172:173] op_sel_hi:[1,0]
 v_pk_mul_f32 v[204:205], v[204:205], v[174:175] op_sel_hi:[1,0]
 v_pk_mul_f32 v[196:197], v[196:197], v[172:173] op_sel_hi:[1,0]
 s_add_u32 s70, s68, 46080
 buffer_load_dwordx4 a[108:111], v7, s[8:11], s70 offen
 v_pk_mul_f32 v[206:207], v[206:207], v[174:175] op_sel_hi:[1,0]
 v_cvt_pk_bf16_f32 v80, v188, v189
 v_cvt_pk_bf16_f32 v85, v198, v199
 v_cvt_pk_bf16_f32 v81, v190, v191
 v_cvt_pk_bf16_f32 v86, v200, v201
 v_cvt_pk_bf16_f32 v82, v192, v193
 s_add_u32 s70, s68, 66560
 buffer_load_dwordx4 a[112:115], v7, s[8:11], s70 offen
 v_cvt_pk_bf16_f32 v87, v202, v203
 v_cvt_pk_bf16_f32 v83, v194, v195
 v_cvt_pk_bf16_f32 v88, v204, v205
 v_cvt_pk_bf16_f32 v84, v196, v197
 v_cvt_pk_bf16_f32 v89, v206, v207
 s_branch Ld2_38
Ld1_37:
 v_mov_b32 v90, 0
 v_mov_b32 v91, 0
 v_mfma_f32_32x32x16_bf16 v[172:187], v[136:139], v[148:151], 0
 v_mfma_f32_32x32x16_bf16 v[172:187], v[140:143], v[152:155], v[172:187]
 s_nop 11
 v_max3_f32 v170, v172, v173, v174
 v_min3_f32 v171, v172, v173, v174
 v_max3_f32 v170, v170, v175, v176
 v_min3_f32 v171, v171, v175, v176
 v_max3_f32 v170, v170, v177, v178
 v_min3_f32 v171, v171, v177, v178
 v_max3_f32 v170, v170, v179, v180
 v_min3_f32 v171, v171, v179, v180
 v_max_f32 v170, v170, v181
 v_min_f32 v171, v171, v181
 v_mov_b32 v241, v170
 v_mov_b32 v6, v171
 s_nop 0
 v_permlane32_swap_b32 v241, v170
 v_permlane32_swap_b32 v6, v171
 v_max_f32 v170, v170, v241
 v_min_f32_e64 v171, v171, v6
 v_mul_f32 v170, 0xbfb8aa3b, v170
 v_mul_f32 v171, 0x3fb8aa3b, v171
 v_pk_fma_f32 v[188:189], v[172:173], s[52:53], v[170:171] op_sel_hi:[1,1,0]
 v_pk_fma_f32 v[198:199], v[172:173], s[52:53], v[170:171] op_sel:[0,0,1] op_sel_hi:[1,1,1] neg_lo:[1,0,0] neg_hi:[1,0,0]
 v_pk_fma_f32 v[190:191], v[174:175], s[52:53], v[170:171] op_sel_hi:[1,1,0]
 v_pk_fma_f32 v[200:201], v[174:175], s[52:53], v[170:171] op_sel:[0,0,1] op_sel_hi:[1,1,1] neg_lo:[1,0,0] neg_hi:[1,0,0]
 v_pk_fma_f32 v[192:193], v[176:177], s[52:53], v[170:171] op_sel_hi:[1,1,0]
 v_pk_fma_f32 v[202:203], v[176:177], s[52:53], v[170:171] op_sel:[0,0,1] op_sel_hi:[1,1,1] neg_lo:[1,0,0] neg_hi:[1,0,0]
 v_pk_fma_f32 v[194:195], v[178:179], s[52:53], v[170:171] op_sel_hi:[1,1,0]
 v_pk_fma_f32 v[204:205], v[178:179], s[52:53], v[170:171] op_sel:[0,0,1] op_sel_hi:[1,1,1] neg_lo:[1,0,0] neg_hi:[1,0,0]
 v_pk_fma_f32 v[196:197], v[180:181], s[52:53], v[170:171] op_sel_hi:[1,1,0]
 v_pk_fma_f32 v[206:207], v[180:181], s[52:53], v[170:171] op_sel:[0,0,1] op_sel_hi:[1,1,1] neg_lo:[1,0,0] neg_hi:[1,0,0]
 v_exp_f32 v188, v188
 v_exp_f32 v198, v198
 v_exp_f32 v189, v189
 v_exp_f32 v199, v199
 v_exp_f32 v190, v190
 v_exp_f32 v200, v200
 v_exp_f32 v191, v191
 v_exp_f32 v201, v201
 v_exp_f32 v192, v192
 v_exp_f32 v202, v202
 v_exp_f32 v193, v193
 v_exp_f32 v203, v203
 v_exp_f32 v194, v194
 v_exp_f32 v204, v204
 v_exp_f32 v195, v195
 v_exp_f32 v205, v205
 v_exp_f32 v196, v196
 v_exp_f32 v206, v206
 v_exp_f32 v197, v197
 v_exp_f32 v207, v207
 v_pk_add_f32 v[172:173], v[188:189], v[190:191]
 v_pk_add_f32 v[174:175], v[192:193], v[194:195]
 v_pk_add_f32 v[176:177], v[198:199], v[200:201]
 v_pk_add_f32 v[178:179], v[202:203], v[204:205]
 v_pk_add_f32 v[172:173], v[172:173], v[196:197]
 v_pk_add_f32 v[176:177], v[176:177], v[206:207]
 v_pk_add_f32 v[172:173], v[172:173], v[174:175]
 v_pk_add_f32 v[176:177], v[176:177], v[178:179]
 v_add_f32 v6, v172, v173
 v_add_f32 v240, v176, v177
 v_mov_b32 v241, v6
 v_mov_b32 v170, v240
 s_nop 0
 v_permlane32_swap_b32 v241, v6
 v_permlane32_swap_b32 v170, v240
 v_add_f32 v6, v6, v241
 v_add_f32 v240, v240, v170
 v_rcp_f32 v172, v6
 v_rcp_f32_e64 v174, v240
 v_pk_mul_f32 v[188:189], v[188:189], v[172:173] op_sel_hi:[1,0]
 v_pk_mul_f32 v[198:199], v[198:199], v[174:175] op_sel_hi:[1,0]
 v_pk_mul_f32 v[190:191], v[190:191], v[172:173] op_sel_hi:[1,0]
 v_pk_mul_f32 v[200:201], v[200:201], v[174:175] op_sel_hi:[1,0]
 v_pk_mul_f32 v[192:193], v[192:193], v[172:173] op_sel_hi:[1,0]
 v_pk_mul_f32 v[202:203], v[202:203], v[174:175] op_sel_hi:[1,0]
 v_pk_mul_f32 v[194:195], v[194:195], v[172:173] op_sel_hi:[1,0]
 v_pk_mul_f32 v[204:205], v[204:205], v[174:175] op_sel_hi:[1,0]
 v_pk_mul_f32 v[196:197], v[196:197], v[172:173] op_sel_hi:[1,0]
 v_pk_mul_f32 v[206:207], v[206:207], v[174:175] op_sel_hi:[1,0]
 v_cvt_pk_bf16_f32 v80, v188, v189
 v_cvt_pk_bf16_f32 v85, v198, v199
 v_cvt_pk_bf16_f32 v81, v190, v191
 v_cvt_pk_bf16_f32 v86, v200, v201
 v_cvt_pk_bf16_f32 v82, v192, v193
 v_cvt_pk_bf16_f32 v87, v202, v203
 v_cvt_pk_bf16_f32 v83, v194, v195
 v_cvt_pk_bf16_f32 v88, v204, v205
 v_cvt_pk_bf16_f32 v84, v196, v197
 v_cvt_pk_bf16_f32 v89, v206, v207
Ld2_38:
 s_mov_b32 s48, s71
 buffer_load_dwordx2 v[8:9], v245, s[8:11], s48 offen sc1
 s_add_u32 s48, s48, 2048
 buffer_load_dwordx2 v[10:11], v245, s[8:11], s48 offen sc1
 s_add_u32 s48, s48, 2048
 buffer_load_dwordx2 v[12:13], v245, s[8:11], s48 offen sc1
 s_add_u32 s48, s48, 2048
 buffer_load_dwordx2 v[14:15], v245, s[8:11], s48 offen sc1
 s_add_u32 s48, s48, 2048
 buffer_load_dwordx2 v[16:17], v245, s[8:11], s48 offen sc1
 s_add_u32 s48, s48, 2048
 buffer_load_dwordx2 v[18:19], v245, s[8:11], s48 offen sc1
 s_add_u32 s48, s48, 2048
 buffer_load_dwordx2 v[20:21], v245, s[8:11], s48 offen sc1
 s_add_u32 s48, s48, 2048
 buffer_load_dwordx2 v[22:23], v245, s[8:11], s48 offen sc1
 s_cmp_lg_u32 s42, 0
 s_cbranch_scc1 Ld1_39
 v_mov_b32 v106, 0
 v_mov_b32 v107, 0
 v_mfma_f32_32x32x16_bf16 v[172:187], v[136:139], v[156:159], 0
 v_mfma_f32_32x32x16_bf16 v[172:187], v[140:143], v[160:163], v[172:187]
 s_nop 11
 v_max3_f32 v170, v172, v173, v174
 v_min3_f32 v171, v172, v173, v174
 v_max3_f32 v170, v170, v175, v176
 v_min3_f32 v171, v171, v175, v176
 s_add_u32 s70, s68, 87040
 buffer_load_dwordx4 a[116:119], v7, s[8:11], s70 offen
 v_max3_f32 v170, v170, v177, v178
 v_min3_f32 v171, v171, v177, v178
 v_max3_f32 v170, v170, v179, v180
 v_min3_f32 v171, v171, v179, v180
 v_max_f32 v170, v170, v181
 v_min_f32 v171, v171, v181
 v_mov_b32 v241, v170
 v_mov_b32 v6, v171
 s_add_u32 s70, s68, 6144
 buffer_load_dwordx4 a[120:123], v7, s[8:11], s70 offen
 s_nop 0
 v_permlane32_swap_b32 v241, v170
 v_permlane32_swap_b32 v6, v171
 v_max_f32 v170, v170, v241
 v_min_f32_e64 v171, v171, v6
 v_mul_f32 v170, 0xbfb8aa3b, v170
 v_mul_f32 v171, 0x3fb8aa3b, v171
 s_add_u32 s70, s68, 26624
 buffer_load_dwordx4 a[124:127], v7, s[8:11], s70 offen
 v_pk_fma_f32 v[188:189], v[172:173], s[52:53], v[170:171] op_sel_hi:[1,1,0]
 v_pk_fma_f32 v[198:199], v[172:173], s[52:53], v[170:171] op_sel:[0,0,1] op_sel_hi:[1,1,1] neg_lo:[1,0,0] neg_hi:[1,0,0]
 v_pk_fma_f32 v[190:191], v[174:175], s[52:53], v[170:171] op_sel_hi:[1,1,0]
 v_pk_fma_f32 v[200:201], v[174:175], s[52:53], v[170:171] op_sel:[0,0,1] op_sel_hi:[1,1,1] neg_lo:[1,0,0] neg_hi:[1,0,0]
 v_pk_fma_f32 v[192:193], v[176:177], s[52:53], v[170:171] op_sel_hi:[1,1,0]
 v_pk_fma_f32 v[202:203], v[176:177], s[52:53], v[170:171] op_sel:[0,0,1] op_sel_hi:[1,1,1] neg_lo:[1,0,0] neg_hi:[1,0,0]
 v_pk_fma_f32 v[194:195], v[178:179], s[52:53], v[170:171] op_sel_hi:[1,1,0]
 v_pk_fma_f32 v[204:205], v[178:179], s[52:53], v[170:171] op_sel:[0,0,1] op_sel_hi:[1,1,1] neg_lo:[1,0,0] neg_hi:[1,0,0]
 s_add_u32 s70, s68, 47104
 buffer_load_dwordx4 a[128:131], v7, s[8:11], s70 offen
 v_pk_fma_f32 v[196:197], v[180:181], s[52:53], v[170:171] op_sel_hi:[1,1,0]
 v_pk_fma_f32 v[206:207], v[180:181], s[52:53], v[170:171] op_sel:[0,0,1] op_sel_hi:[1,1,1] neg_lo:[1,0,0] neg_hi:[1,0,0]
 v_exp_f32 v188, v188
 v_exp_f32 v198, v198
 v_exp_f32 v189, v189
 v_exp_f32 v199, v199
 v_exp_f32 v190, v190
 v_exp_f32 v200, v200
 s_add_u32 s70, s68, 67584
 buffer_load_dwordx4 a[132:135], v7, s[8:11], s70 offen
 v_exp_f32 v191, v191
 v_exp_f32 v201, v201
 v_exp_f32 v192, v192
 v_exp_f32 v202, v202
 v_exp_f32 v193, v193
 v_exp_f32 v203, v203
 v_exp_f32_e64 v194, v194
 s_add_u32 s70, s68, 88064
 buffer_load_dwordx4 a[136:139], v7, s[8:11], s70 offen
 v_exp_f32 v204, v204
 v_exp_f32 v195, v195
 v_exp_f32 v205, v205
 v_exp_f32 v196, v196
 v_exp_f32 v206, v206
 v_exp_f32 v197, v197
 v_exp_f32_e64 v207, v207
 v_pk_add_f32 v[172:173], v[188:189], v[190:191]
 s_add_u32 s70, s68, 7168
 buffer_load_dwordx4 a[140:143], v7, s[8:11], s70 offen
 v_pk_add_f32 v[174:175], v[192:193], v[194:195]
 v_pk_add_f32 v[176:177], v[198:199], v[200:201]
 v_pk_add_f32 v[178:179], v[202:203], v[204:205]
 v_pk_add_f32 v[172:173], v[172:173], v[196:197]
 v_pk_add_f32 v[176:177], v[176:177], v[206:207]
 v_pk_add_f32 v[172:173], v[172:173], v[174:175]
 v_pk_add_f32 v[176:177], v[176:177], v[178:179]
 v_add_f32_e64 v6, v172, v173
 s_add_u32 s70, s68, 27648
 buffer_load_dwordx4 a[144:147], v7, s[8:11], s70 offen
 v_add_f32 v240, v176, v177
 v_mov_b32 v241, v6
 v_mov_b32 v170, v240
 s_nop 0
 v_permlane32_swap_b32 v241, v6
 v_permlane32_swap_b32 v170, v240
 v_add_f32_e64 v6, v6, v241
 s_add_u32 s70, s68, 48128
 buffer_load_dwordx4 a[148:151], v7, s[8:11], s70 offen
 v_add_f32 v240, v240, v170
 v_rcp_f32 v172, v6
 v_rcp_f32_e64 v174, v240
 v_pk_mul_f32 v[188:189], v[188:189], v[172:173] op_sel_hi:[1,0]
 v_pk_mul_f32 v[198:199], v[198:199], v[174:175] op_sel_hi:[1,0]
 v_pk_mul_f32 v[190:191], v[190:191], v[172:173] op_sel_hi:[1,0]
 v_pk_mul_f32 v[200:201], v[200:201], v[174:175] op_sel_hi:[1,0]
 v_pk_mul_f32 v[192:193], v[192:193], v[172:173] op_sel_hi:[1,0]
 s_add_u32 s70, s68, 68608
 buffer_load_dwordx4 a[152:155], v7, s[8:11], s70 offen
 v_pk_mul_f32 v[202:203], v[202:203], v[174:175] op_sel_hi:[1,0]
 v_pk_mul_f32 v[194:195], v[194:195], v[172:173] op_sel_hi:[1,0]
 v_pk_mul_f32 v[204:205], v[204:205], v[174:175] op_sel_hi:[1,0]
 v_pk_mul_f32 v[196:197], v[196:197], v[172:173] op_sel_hi:[1,0]
 v_pk_mul_f32 v[206:207], v[206:207], v[174:175] op_sel_hi:[1,0]
 v_cvt_pk_bf16_f32 v96, v188, v189
 v_cvt_pk_bf16_f32 v101, v198, v199
 v_cvt_pk_bf16_f32 v97, v190, v191
 s_add_u32 s70, s68, 89088
 buffer_load_dwordx4 a[156:159], v7, s[8:11], s70 offen
 v_cvt_pk_bf16_f32 v102, v200, v201
 v_cvt_pk_bf16_f32 v98, v192, v193
 v_cvt_pk_bf16_f32 v103, v202, v203
 v_cvt_pk_bf16_f32 v99, v194, v195
 v_cvt_pk_bf16_f32 v104, v204, v205
 v_cvt_pk_bf16_f32 v100, v196, v197
 v_cvt_pk_bf16_f32 v105, v206, v207
 s_branch Ld2_40
Ld1_39:
 v_mov_b32 v106, 0
 v_mov_b32 v107, 0
 v_mfma_f32_32x32x16_bf16 v[172:187], v[136:139], v[156:159], 0
 v_mfma_f32_32x32x16_bf16 v[172:187], v[140:143], v[160:163], v[172:187]
 s_nop 11
 v_max3_f32 v170, v172, v173, v174
 v_min3_f32 v171, v172, v173, v174
 v_max3_f32 v170, v170, v175, v176
 v_min3_f32 v171, v171, v175, v176
 v_max3_f32 v170, v170, v177, v178
 v_min3_f32 v171, v171, v177, v178
 v_max3_f32 v170, v170, v179, v180
 v_min3_f32 v171, v171, v179, v180
 v_max_f32 v170, v170, v181
 v_min_f32 v171, v171, v181
 v_mov_b32 v241, v170
 v_mov_b32 v6, v171
 s_nop 0
 v_permlane32_swap_b32 v241, v170
 v_permlane32_swap_b32 v6, v171
 v_max_f32 v170, v170, v241
 v_min_f32_e64 v171, v171, v6
 v_mul_f32 v170, 0xbfb8aa3b, v170
 v_mul_f32 v171, 0x3fb8aa3b, v171
 v_pk_fma_f32 v[188:189], v[172:173], s[52:53], v[170:171] op_sel_hi:[1,1,0]
 v_pk_fma_f32 v[198:199], v[172:173], s[52:53], v[170:171] op_sel:[0,0,1] op_sel_hi:[1,1,1] neg_lo:[1,0,0] neg_hi:[1,0,0]
 v_pk_fma_f32 v[190:191], v[174:175], s[52:53], v[170:171] op_sel_hi:[1,1,0]
 v_pk_fma_f32 v[200:201], v[174:175], s[52:53], v[170:171] op_sel:[0,0,1] op_sel_hi:[1,1,1] neg_lo:[1,0,0] neg_hi:[1,0,0]
 v_pk_fma_f32 v[192:193], v[176:177], s[52:53], v[170:171] op_sel_hi:[1,1,0]
 v_pk_fma_f32 v[202:203], v[176:177], s[52:53], v[170:171] op_sel:[0,0,1] op_sel_hi:[1,1,1] neg_lo:[1,0,0] neg_hi:[1,0,0]
 v_pk_fma_f32 v[194:195], v[178:179], s[52:53], v[170:171] op_sel_hi:[1,1,0]
 v_pk_fma_f32 v[204:205], v[178:179], s[52:53], v[170:171] op_sel:[0,0,1] op_sel_hi:[1,1,1] neg_lo:[1,0,0] neg_hi:[1,0,0]
 v_pk_fma_f32 v[196:197], v[180:181], s[52:53], v[170:171] op_sel_hi:[1,1,0]
 v_pk_fma_f32 v[206:207], v[180:181], s[52:53], v[170:171] op_sel:[0,0,1] op_sel_hi:[1,1,1] neg_lo:[1,0,0] neg_hi:[1,0,0]
 v_exp_f32 v188, v188
 v_exp_f32 v198, v198
 v_exp_f32 v189, v189
 v_exp_f32 v199, v199
 v_exp_f32 v190, v190
 v_exp_f32 v200, v200
 v_exp_f32 v191, v191
 v_exp_f32 v201, v201
 v_exp_f32 v192, v192
 v_exp_f32 v202, v202
 v_exp_f32 v193, v193
 v_exp_f32 v203, v203
 v_exp_f32 v194, v194
 v_exp_f32 v204, v204
 v_exp_f32 v195, v195
 v_exp_f32 v205, v205
 v_exp_f32 v196, v196
 v_exp_f32 v206, v206
 v_exp_f32 v197, v197
 v_exp_f32 v207, v207
 v_pk_add_f32 v[172:173], v[188:189], v[190:191]
 v_pk_add_f32 v[174:175], v[192:193], v[194:195]
 v_pk_add_f32 v[176:177], v[198:199], v[200:201]
 v_pk_add_f32 v[178:179], v[202:203], v[204:205]
 v_pk_add_f32 v[172:173], v[172:173], v[196:197]
 v_pk_add_f32 v[176:177], v[176:177], v[206:207]
 v_pk_add_f32 v[172:173], v[172:173], v[174:175]
 v_pk_add_f32 v[176:177], v[176:177], v[178:179]
 v_add_f32 v6, v172, v173
 v_add_f32 v240, v176, v177
 v_mov_b32 v241, v6
 v_mov_b32 v170, v240
 s_nop 0
 v_permlane32_swap_b32 v241, v6
 v_permlane32_swap_b32 v170, v240
 v_add_f32 v6, v6, v241
 v_add_f32 v240, v240, v170
 v_rcp_f32 v172, v6
 v_rcp_f32_e64 v174, v240
 v_pk_mul_f32 v[188:189], v[188:189], v[172:173] op_sel_hi:[1,0]
 v_pk_mul_f32 v[198:199], v[198:199], v[174:175] op_sel_hi:[1,0]
 v_pk_mul_f32 v[190:191], v[190:191], v[172:173] op_sel_hi:[1,0]
 v_pk_mul_f32 v[200:201], v[200:201], v[174:175] op_sel_hi:[1,0]
 v_pk_mul_f32 v[192:193], v[192:193], v[172:173] op_sel_hi:[1,0]
 v_pk_mul_f32 v[202:203], v[202:203], v[174:175] op_sel_hi:[1,0]
 v_pk_mul_f32 v[194:195], v[194:195], v[172:173] op_sel_hi:[1,0]
 v_pk_mul_f32 v[204:205], v[204:205], v[174:175] op_sel_hi:[1,0]
 v_pk_mul_f32 v[196:197], v[196:197], v[172:173] op_sel_hi:[1,0]
 v_pk_mul_f32 v[206:207], v[206:207], v[174:175] op_sel_hi:[1,0]
 v_cvt_pk_bf16_f32 v96, v188, v189
 v_cvt_pk_bf16_f32 v101, v198, v199
 v_cvt_pk_bf16_f32 v97, v190, v191
 v_cvt_pk_bf16_f32 v102, v200, v201
 v_cvt_pk_bf16_f32 v98, v192, v193
 v_cvt_pk_bf16_f32 v103, v202, v203
 v_cvt_pk_bf16_f32 v99, v194, v195
 v_cvt_pk_bf16_f32 v104, v204, v205
 v_cvt_pk_bf16_f32 v100, v196, v197
 v_cvt_pk_bf16_f32 v105, v206, v207
Ld2_40:
 v_mul_u32_u24 v117, 10923, v0
 v_lshrrev_b32 v117, 16, v117
 v_mul_u32_u24 v2, 6, v117
 v_sub_u32_e64 v118, v0, v2
 v_cmp_lt_u32 vcc, 19, v117
 s_nop 1
 v_cndmask_b32_e64 v119, 0, 1, vcc
 v_mul_u32_u24 v2, 20, v119
 v_sub_u32 v120, v117, v2
 v_mul_u32_u24_e64 v119, 48, v119
 v_lshl_add_u32 v119, v120, 1, v119
 v_add_u32 v119, 150784, v119
 v_lshl_add_u32 v121, v118, 2, 0
 v_cmp_lt_u32 vcc, 9, v121
 s_nop 1
 v_cndmask_b32_e64 v2, 0, 1, vcc
 v_mul_u32_u24 v3, 10, v2
 v_sub_u32 v3, v121, v3
 v_lshrrev_b32 v122, 2, v3
 v_lshlrev_b32 v122, 3, v122
 v_lshl_add_u32 v122, v2, 2, v122
 v_and_b32 v3, 3, v3
 v_add_u32 v122, v122, v3
 v_cmp_eq_u32 vcc, 20, v121
 s_nop 1
 v_cndmask_b32_e64 v122, v122, 18, vcc
 v_mul_u32_u24 v112, 96, v122
 v_add_u32_e64 v112, v112, v119
 v_mov_b32 v3, 154368
 v_cmp_lt_u32 vcc, 20, v121
 s_nop 1
 v_cndmask_b32_e64 v112, v112, v3, vcc
 v_cmp_lt_u32 vcc, 239, v0
 s_nop 1
 v_cndmask_b32 v112, v112, v3, vcc
 v_lshl_add_u32 v121, v118, 2, 1
 v_cmp_lt_u32 vcc, 9, v121
 s_nop 1
 v_cndmask_b32_e64 v2, 0, 1, vcc
 v_mul_u32_u24 v3, 10, v2
 v_sub_u32 v3, v121, v3
 v_lshrrev_b32 v122, 2, v3
 v_lshlrev_b32 v122, 3, v122
 v_lshl_add_u32 v122, v2, 2, v122
 v_and_b32 v3, 3, v3
 v_add_u32 v122, v122, v3
 v_cmp_eq_u32 vcc, 20, v121
 s_nop 1
 v_cndmask_b32_e64 v122, v122, 18, vcc
 v_mul_u32_u24 v113, 96, v122
 v_add_u32_e64 v113, v113, v119
 v_mov_b32 v3, 154368
 v_cmp_lt_u32 vcc, 20, v121
 s_nop 1
 v_cndmask_b32_e64 v113, v113, v3, vcc
 v_cmp_lt_u32 vcc, 239, v0
 s_nop 1
 v_cndmask_b32 v113, v113, v3, vcc
 v_lshl_add_u32 v121, v118, 2, 2
 v_cmp_lt_u32 vcc, 9, v121
 s_nop 1
 v_cndmask_b32_e64 v2, 0, 1, vcc
 v_mul_u32_u24 v3, 10, v2
 v_sub_u32 v3, v121, v3
 v_lshrrev_b32 v122, 2, v3
 v_lshlrev_b32 v122, 3, v122
 v_lshl_add_u32 v122, v2, 2, v122
 v_and_b32 v3, 3, v3
 v_add_u32 v122, v122, v3
 v_cmp_eq_u32 vcc, 20, v121
 s_nop 1
 v_cndmask_b32_e64 v122, v122, 18, vcc
 v_mul_u32_u24 v114, 96, v122
 v_add_u32_e64 v114, v114, v119
 v_mov_b32 v3, 154368
 v_cmp_lt_u32 vcc, 20, v121
 s_nop 1
 v_cndmask_b32_e64 v114, v114, v3, vcc
 v_cmp_lt_u32 vcc, 239, v0
 s_nop 1
 v_cndmask_b32 v114, v114, v3, vcc
 v_lshl_add_u32 v121, v118, 2, 3
 v_cmp_lt_u32 vcc, 9, v121
 s_nop 1
 v_cndmask_b32_e64 v2, 0, 1, vcc
 v_mul_u32_u24 v3, 10, v2
 v_sub_u32 v3, v121, v3
 v_lshrrev_b32 v122, 2, v3
 v_lshlrev_b32 v122, 3, v122
 v_lshl_add_u32 v122, v2, 2, v122
 v_and_b32 v3, 3, v3
 v_add_u32 v122, v122, v3
 v_cmp_eq_u32 vcc, 20, v121
 s_nop 1
 v_cndmask_b32_e64 v122, v122, 18, vcc
 v_mul_u32_u24 v115, 96, v122
 v_add_u32_e64 v115, v115, v119
 v_mov_b32 v3, 154368
 v_cmp_lt_u32 vcc, 20, v121
 s_nop 1
 v_cndmask_b32_e64 v115, v115, v3, vcc
 v_cmp_lt_u32 vcc, 239, v0
 s_nop 1
 v_cndmask_b32 v115, v115, v3, vcc
 v_add_u32 v116, 384, v112
 v_mov_b32 v3, 154368
 v_cmp_ne_u32 vcc, 5, v118
 s_nop 1
 v_cndmask_b32_e64 v116, v116, v3, vcc
 v_cmp_lt_u32 vcc, 239, v0
 s_nop 1
 v_cndmask_b32 v116, v116, v3, vcc
 s_mov_b32 s39, 262144
 s_cmp_lg_u32 s42, 0
 s_cbranch_scc1 Lkvp_41
 s_lshl_b32 s44, s4, 2
 s_add_u32 s44, s44, s5
 s_mul_i32 s44, s44, 2688
 s_mul_i32 s45, s3, 344064
 s_add_u32 s44, s44, s45
 s_add_u32 s44, s44, 6291456
 v_lshlrev_b32 v2, 7, v1
 v_cmp_gt_u32 vcc, 21, v1
 v_mov_b32 v3, 2146435072
 s_nop 0
 v_cndmask_b32 v2, v3, v2, vcc
 buffer_load_dword v242, v2, s[8:11], s44 offen
Lpt_44:
 s_waitcnt vmcnt(12)
 s_branch Lkvc_43
Lkvp_41:
 s_waitcnt vmcnt(0)
Lkvc_43:
 v_max3_u32 v24, v8, v9, v10
 v_max3_u32 v24, v24, v11, v12
 v_max3_u32 v24, v24, v13, v14
 v_max3_u32 v24, v24, v15, v16
 v_max3_u32 v24, v24, v17, v18
 v_max3_u32 v24, v24, v19, v20
 v_max3_u32 v24, v24, v21, v22
 v_max_u32 v24, v24, v23
 v_cmp_eq_u32 vcc, -1, v24
 s_cbranch_vccz Lkvd_42
 s_mov_b32 s48, s71
 buffer_load_dwordx2 v[8:9], v245, s[8:11], s48 offen sc1
 s_add_u32 s48, s48, 2048
 buffer_load_dwordx2 v[10:11], v245, s[8:11], s48 offen sc1
 s_add_u32 s48, s48, 2048
 buffer_load_dwordx2 v[12:13], v245, s[8:11], s48 offen sc1
 s_add_u32 s48, s48, 2048
 buffer_load_dwordx2 v[14:15], v245, s[8:11], s48 offen sc1
 s_add_u32 s48, s48, 2048
 buffer_load_dwordx2 v[16:17], v245, s[8:11], s48 offen sc1
 s_add_u32 s48, s48, 2048
 buffer_load_dwordx2 v[18:19], v245, s[8:11], s48 offen sc1
 s_add_u32 s48, s48, 2048
 buffer_load_dwordx2 v[20:21], v245, s[8:11], s48 offen sc1
 s_add_u32 s48, s48, 2048
 buffer_load_dwordx2 v[22:23], v245, s[8:11], s48 offen sc1
 s_sub_u32 s39, s39, 1
 s_cmp_lg_u32 s39, 0
 s_cbranch_scc1 Lkvp_41
 s_waitcnt vmcnt(0)
Lkvd_42:
 v_lshlrev_b32_e64 v28, 16, v8
 v_and_b32 v29, 0xffff0000, v8
 v_lshlrev_b32_e64 v30, 16, v9
 v_and_b32 v31, 0xffff0000, v9
 v_lshlrev_b32_e64 v36, 16, v10
 v_and_b32 v37, 0xffff0000, v10
 v_lshlrev_b32_e64 v38, 16, v11
 v_and_b32 v39, 0xffff0000, v11
 v_pk_add_f32 v[28:29], v[28:29], v[36:37]
 v_pk_add_f32 v[30:31], v[30:31], v[38:39]
 v_lshlrev_b32_e64 v36, 16, v12
 v_and_b32 v37, 0xffff0000, v12
 v_lshlrev_b32_e64 v38, 16, v13
 v_and_b32 v39, 0xffff0000, v13
 v_pk_add_f32 v[28:29], v[28:29], v[36:37]
 v_pk_add_f32 v[30:31], v[30:31], v[38:39]
 v_lshlrev_b32_e64 v36, 16, v14
 v_and_b32 v37, 0xffff0000, v14
 v_lshlrev_b32_e64 v38, 16, v15
 v_and_b32 v39, 0xffff0000, v15
 v_pk_add_f32 v[28:29], v[28:29], v[36:37]
 v_pk_add_f32 v[30:31], v[30:31], v[38:39]
 v_lshlrev_b32_e64 v36, 16, v16
 v_and_b32 v37, 0xffff0000, v16
 v_lshlrev_b32_e64 v38, 16, v17
 v_and_b32 v39, 0xffff0000, v17
 v_pk_add_f32 v[28:29], v[28:29], v[36:37]
 v_pk_add_f32 v[30:31], v[30:31], v[38:39]
 v_lshlrev_b32_e64 v36, 16, v18
 v_and_b32 v37, 0xffff0000, v18
 v_lshlrev_b32_e64 v38, 16, v19
 v_and_b32 v39, 0xffff0000, v19
 v_pk_add_f32 v[28:29], v[28:29], v[36:37]
 v_pk_add_f32 v[30:31], v[30:31], v[38:39]
 v_lshlrev_b32_e64 v36, 16, v20
 v_and_b32 v37, 0xffff0000, v20
 v_lshlrev_b32_e64 v38, 16, v21
 v_and_b32 v39, 0xffff0000, v21
 v_pk_add_f32 v[28:29], v[28:29], v[36:37]
 v_pk_add_f32 v[30:31], v[30:31], v[38:39]
 v_lshlrev_b32_e64 v36, 16, v22
 v_and_b32 v37, 0xffff0000, v22
 v_lshlrev_b32_e64 v38, 16, v23
 v_and_b32 v39, 0xffff0000, v23
 v_pk_add_f32 v[28:29], v[28:29], v[36:37]
 v_pk_add_f32 v[30:31], v[30:31], v[38:39]
 v_cvt_pk_bf16_f32 v44, v28, v29
 v_cvt_pk_bf16_f32 v45, v30, v31
 ds_write_b16 v112, v44
 ds_write_b16_d16_hi v113, v44
 ds_write_b16 v114, v45
 ds_write_b16_d16_hi v115, v45
 ds_write_b16 v116, v44
 s_waitcnt lgkmcnt(0)
 s_barrier
 v_and_b32_e64 v2, 31, v1
 v_mul_u32_u24 v2, 96, v2
 v_lshrrev_b32 v3, 5, v1
 v_mul_u32_u24 v3, 48, v3
 v_add_u32_e64 v2, v2, v3
 v_add_u32 v2, 150784, v2
 ds_read_b128 v[228:231], v2 offset:0
 ds_read_b128 v[232:235], v2 offset:16
 ds_read_b128 v[236:239], v2 offset:32
 v_bfe_u32 v2, v1, 4, 1
 v_mul_u32_u24 v241, 20480, v2
 v_and_b32_e64 v2, 15, v1
 v_lshl_add_u32 v240, v2, 3, v241
 v_lshl_add_u32 v241, v2, 4, v241
 v_lshrrev_b32 v3, 5, v1
 v_lshl_add_u32 v241, v3, 8, v241
 s_mul_i32 s44, s3, 344064
 s_add_u32 s44, s44, s58
 s_mul_i32 s45, s5, 81920
 s_add_u32 s44, s44, s45
 s_lshl_b32 s45, s4, 7
 s_add_u32 s45, s45, s44
 s_add_u32 s45, s45, 16384
 s_lshr_b32 s46, s4, 1
 s_lshl_b32 s46, s46, 10
 s_add_u32 s44, s44, s46
 s_and_b32 s46, s4, 1
 s_lshl_b32 s46, s46, 9
 s_add_u32 s44, s44, s46
 s_waitcnt lgkmcnt(0)
 v_mfma_f32_32x32x16_bf16 v[48:63], v[228:231], v[80:83], 0
 v_mfma_f32_32x32x16_bf16 v[48:63], v[232:235], v[84:87], v[48:63]
 v_mfma_f32_32x32x16_bf16 v[48:63], v[236:239], v[88:91], v[48:63]
 v_mfma_f32_32x32x16_bf16 v[64:79], v[228:231], v[96:99], 0
 v_mfma_f32_32x32x16_bf16 v[64:79], v[232:235], v[100:103], v[64:79]
 v_mfma_f32_32x32x16_bf16 v[64:79], v[236:239], v[104:107], v[64:79]
 s_nop 8
 v_add_f32 v170, 0x358637bd, v58
 v_rcp_f32_e64 v170, v170
 s_nop 0
 v_pk_mul_f32 v[48:49], v[48:49], v[170:171] op_sel_hi:[1,0]
 v_pk_mul_f32 v[50:51], v[50:51], v[170:171] op_sel_hi:[1,0]
 v_pk_mul_f32 v[52:53], v[52:53], v[170:171] op_sel_hi:[1,0]
 v_pk_mul_f32 v[54:55], v[54:55], v[170:171] op_sel_hi:[1,0]
 v_pk_mul_f32 v[56:57], v[56:57], v[170:171] op_sel_hi:[1,0]
 v_cvt_pk_bf16_f32 v80, v48, v49
 v_cvt_pk_bf16_f32 v81, v50, v51
 v_cvt_pk_bf16_f32 v82, v52, v53
 v_cvt_pk_bf16_f32 v83, v54, v55
 v_cvt_pk_bf16_f32 v84, v56, v57
 buffer_store_dwordx4 v[80:83], v241, s[8:11], s44 offen
 v_mov_b32_e64 v86, v84
 v_mov_b32 v87, v84
 s_nop 1
 v_permlane32_swap_b32 v86, v87
 s_mov_b64 s[6:7], exec
 s_mov_b32 exec_hi, 0
 buffer_store_dwordx2 v[86:87], v240, s[8:11], s45 offen
 s_mov_b64 exec, s[6:7]
 v_add_f32 v170, 0x358637bd, v74
 v_rcp_f32 v170, v170
 s_nop 0
 v_pk_mul_f32 v[64:65], v[64:65], v[170:171] op_sel_hi:[1,0]
 v_pk_mul_f32 v[66:67], v[66:67], v[170:171] op_sel_hi:[1,0]
 v_pk_mul_f32 v[68:69], v[68:69], v[170:171] op_sel_hi:[1,0]
 v_pk_mul_f32 v[70:71], v[70:71], v[170:171] op_sel_hi:[1,0]
 v_pk_mul_f32 v[72:73], v[72:73], v[170:171] op_sel_hi:[1,0]
 v_cvt_pk_bf16_f32 v96, v64, v65
 v_cvt_pk_bf16_f32 v97, v66, v67
 v_cvt_pk_bf16_f32 v98, v68, v69
 v_cvt_pk_bf16_f32 v99, v70, v71
 v_cvt_pk_bf16_f32 v100, v72, v73
 s_add_u32 s44, s44, 40960
 s_add_u32 s45, s45, 40960
 buffer_store_dwordx4 v[96:99], v241, s[8:11], s44 offen
 v_mov_b32 v102, v100
 v_mov_b32 v103, v100
 s_nop 1
 v_permlane32_swap_b32 v102, v103
 s_mov_b64 s[6:7], exec
 s_mov_b32 exec_hi, 0
 buffer_store_dwordx2 v[102:103], v240, s[8:11], s45 offen
 s_mov_b64 exec, s[6:7]
 s_waitcnt vmcnt(0) lgkmcnt(0)
 s_barrier
 s_add_u32 s40, s40, 1
 s_cmp_lg_u32 s5, 0
 s_cbranch_scc1 Llb_45
 v_mov_b32_e64 v3, s40
 s_mov_b64 s[6:7], exec
 s_mov_b64 exec, 1
 buffer_store_dword v3, v4, s[8:11], 0 offen
 s_mov_b64 exec, s[6:7]
Llb_45:
 s_cmp_lg_u32 s42, 0
 s_cbranch_scc1 Lcst_46
 s_add_u32 s70, s69, 0
 buffer_load_dwordx4 a[160:163], v7, s[8:11], s70 offen
 s_add_u32 s70, s69, 20480
 buffer_load_dwordx4 a[164:167], v7, s[8:11], s70 offen
 s_add_u32 s70, s69, 40960
 buffer_load_dwordx4 a[168:171], v7, s[8:11], s70 offen
 s_add_u32 s70, s69, 61440
 buffer_load_dwordx4 a[172:175], v7, s[8:11], s70 offen
 s_add_u32 s70, s69, 81920
 buffer_load_dwordx4 a[176:179], v7, s[8:11], s70 offen
 s_add_u32 s70, s69, 1024
 buffer_load_dwordx4 a[180:183], v7, s[8:11], s70 offen
 s_add_u32 s70, s69, 21504
 buffer_load_dwordx4 a[184:187], v7, s[8:11], s70 offen
 s_add_u32 s70, s69, 41984
 buffer_load_dwordx4 a[188:191], v7, s[8:11], s70 offen
 s_add_u32 s70, s69, 62464
 buffer_load_dwordx4 a[192:195], v7, s[8:11], s70 offen
 s_add_u32 s70, s69, 82944
 buffer_load_dwordx4 a[196:199], v7, s[8:11], s70 offen
Lcst_46:
 s_and_b32 s44, s4, 3
 s_lshl_b32 s44, s44, 6
 s_and_b32 s45, s5, 1
 s_lshl_b32 s45, s45, 5
 s_add_u32 s44, s44, s45
 s_lshr_b32 s45, s5, 1
 s_lshl_b32 s45, s45, 4
 s_add_u32 s44, s44, s45
 v_and_b32 v2, 15, v1
 v_add_u32 v6, s44, v2
 v_lshrrev_b32_e64 v2, 5, v6
 v_mul_u32_u24 v26, 40960, v2
 v_and_b32_e64 v2, 31, v6
 v_lshl_add_u32 v26, v2, 4, v26
 v_lshrrev_b32 v27, 4, v1
 s_lshr_b32 s45, s4, 2
 v_lshrrev_b32 v2, 1, v27
 v_lshlrev_b32 v25, 3, v2
 v_add_u32 v25, s45, v25
 v_and_b32 v2, 1, v27
 v_lshl_add_u32 v25, v2, 4, v25
 v_add_u32_e64 v8, 2, v25
 v_sub_u32 v2, 120, v25
 v_cmp_lt_u32 vcc, 39, v25
 s_nop 1
 v_cndmask_b32_e64 v8, v8, v2, vcc
 v_cmp_eq_u32 vcc, 0, v25
 s_nop 1
 v_cndmask_b32_e64 v8, v8, 0, vcc
 v_cmp_eq_u32 vcc, 40, v25
 s_nop 1
 v_cndmask_b32_e64 v8, v8, 1, vcc
 v_cmp_eq_u32 vcc, 1, v25
 s_nop 1
 v_cndmask_b32_e64 v8, v8, 2, vcc
 v_cmp_eq_u32 vcc, 79, v25
 s_nop 1
 v_cndmask_b32_e64 v8, v8, 3, vcc
 v_lshl_add_u32 v8, v8, 9, v26
 v_lshrrev_b32 v2, 1, v27
 v_lshlrev_b32 v25, 3, v2
 v_add_u32 v25, s45, v25
 v_and_b32_e64 v2, 1, v27
 v_lshl_add_u32 v25, v2, 4, v25
 v_add_u32 v25, 32, v25
 v_add_u32 v9, 2, v25
 v_sub_u32 v2, 120, v25
 v_cmp_lt_u32 vcc, 39, v25
 s_nop 1
 v_cndmask_b32_e64 v9, v9, v2, vcc
 v_cmp_eq_u32 vcc, 0, v25
 s_nop 1
 v_cndmask_b32_e64 v9, v9, 0, vcc
 v_cmp_eq_u32 vcc, 40, v25
 s_nop 1
 v_cndmask_b32_e64 v9, v9, 1, vcc
 v_cmp_eq_u32 vcc, 1, v25
 s_nop 1
 v_cndmask_b32_e64 v9, v9, 2, vcc
 v_cmp_eq_u32 vcc, 79, v25
 s_nop 1
 v_cndmask_b32_e64 v9, v9, 3, vcc
 v_lshl_add_u32 v9, v9, 9, v26
 v_lshrrev_b32 v2, 1, v27
 v_lshlrev_b32 v25, 3, v2
 v_add_u32 v25, s45, v25
 v_add_u32 v25, 64, v25
 v_add_u32 v10, 2, v25
 v_sub_u32 v2, 120, v25
 v_cmp_lt_u32 vcc, 39, v25
 s_nop 1
 v_cndmask_b32_e64 v10, v10, v2, vcc
 v_cmp_eq_u32 vcc, 0, v25
 s_nop 1
 v_cndmask_b32_e64 v10, v10, 0, vcc
 v_cmp_eq_u32 vcc, 40, v25
 s_nop 1
 v_cndmask_b32_e64 v10, v10, 1, vcc
 v_cmp_eq_u32_e64 vcc, 1, v25
 s_nop 1
 v_cndmask_b32_e64 v10, v10, 2, vcc
 v_cmp_eq_u32 vcc, 79, v25
 s_nop 1
 v_cndmask_b32_e64 v10, v10, 3, vcc
 v_lshl_add_u32 v10, v10, 9, v26
 s_mul_i32 s63, s3, 327680
 v_lshlrev_b32 v11, 4, v1
 v_lshrrev_b32 v2, 4, v1
 v_lshlrev_b32 v24, 8, v2
 v_and_b32 v2, 15, v1
 v_lshl_add_u32 v24, v2, 3, v24
 s_and_b32 s46, s4, 3
 s_lshl_b32 s46, s46, 2
 s_and_b32 s47, s5, 1
 s_lshl_b32 s47, s47, 1
 s_add_u32 s46, s46, s47
 s_mul_i32 s46, s46, 20480
 s_mul_i32 s47, s3, 344064
 s_add_u32 s46, s46, s47
 s_add_u32 s46, s46, s58
 s_lshr_b32 s47, s5, 1
 s_lshl_b32 s64, s47, 13
 s_add_u32 s64, s64, s46
 s_add_u32 s65, s64, 20480
 s_lshl_b32 s66, s47, 11
 s_add_u32 s66, s66, s46
 s_add_u32 s66, s66, 16384
 s_add_u32 s67, s66, 20480
 s_cmp_lg_u32 s5, 0
 s_cbranch_scc1 Llb_47
 s_mov_b32 s39, 4194304
Lpoll_48:
 buffer_load_dword v2, v5, s[8:11], 0 offen sc1
 s_waitcnt vmcnt(0)
 v_cmp_gt_u32 vcc, s40, v2
 s_cbranch_vccz Lpdone_49
 s_sub_u32 s39, s39, 1
 s_cmp_lg_u32 s39, 0
 s_cbranch_scc1 Lpoll_48
Lpdone_49:
Llb_47:
 s_barrier
 buffer_load_dwordx4 v[28:31], v11, s[8:11], s64 offen offset:0 sc1
 buffer_load_dwordx4 v[32:35], v11, s[8:11], s65 offen offset:0 sc1
 buffer_load_dwordx4 v[36:39], v11, s[8:11], s64 offen offset:1024 sc1
 buffer_load_dwordx4 v[40:43], v11, s[8:11], s65 offen offset:1024 sc1
 buffer_load_dwordx4 v[44:47], v11, s[8:11], s64 offen offset:2048 sc1
 buffer_load_dwordx4 v[48:51], v11, s[8:11], s65 offen offset:2048 sc1
 buffer_load_dwordx4 v[52:55], v11, s[8:11], s64 offen offset:3072 sc1
 buffer_load_dwordx4 v[56:59], v11, s[8:11], s65 offen offset:3072 sc1
 s_waitcnt vmcnt(6)
 v_mfma_f32_16x16x32_bf16 v[172:175], a[0:3], v[28:31], 0
 v_mfma_f32_16x16x32_bf16 v[176:179], a[4:7], v[28:31], 0
 s_add_u32 s64, s64, 4096
 buffer_load_dwordx4 v[60:63], v11, s[8:11], s64 offen offset:0 sc1
 s_add_u32 s65, s65, 4096
 buffer_load_dwordx4 v[64:67], v11, s[8:11], s65 offen offset:0 sc1
 v_mfma_f32_16x16x32_bf16 v[180:183], a[8:11], v[28:31], 0
 v_mfma_f32_16x16x32_bf16 v[184:187], a[12:15], v[28:31], 0
 v_mfma_f32_16x16x32_bf16 v[188:191], a[16:19], v[28:31], 0
 v_mfma_f32_16x16x32_bf16 v[192:195], a[0:3], v[32:35], 0
 v_mfma_f32_16x16x32_bf16 v[196:199], a[4:7], v[32:35], 0
 v_mfma_f32_16x16x32_bf16 v[200:203], a[8:11], v[32:35], 0
 v_mfma_f32_16x16x32_bf16 v[204:207], a[12:15], v[32:35], 0
 v_mfma_f32_16x16x32_bf16 v[208:211], a[16:19], v[32:35], 0
 s_waitcnt vmcnt(6)
 v_mfma_f32_16x16x32_bf16 v[172:175], a[20:23], v[36:39], v[172:175]
 v_mfma_f32_16x16x32_bf16 v[176:179], a[24:27], v[36:39], v[176:179]
 buffer_load_dwordx4 v[68:71], v11, s[8:11], s64 offen offset:1024 sc1
 buffer_load_dwordx4 v[72:75], v11, s[8:11], s65 offen offset:1024 sc1
 v_mfma_f32_16x16x32_bf16 v[180:183], a[28:31], v[36:39], v[180:183]
 v_mfma_f32_16x16x32_bf16 v[184:187], a[32:35], v[36:39], v[184:187]
 v_mfma_f32_16x16x32_bf16 v[188:191], a[36:39], v[36:39], v[188:191]
 v_mfma_f32_16x16x32_bf16 v[192:195], a[20:23], v[40:43], v[192:195]
 v_mfma_f32_16x16x32_bf16 v[196:199], a[24:27], v[40:43], v[196:199]
 v_mfma_f32_16x16x32_bf16 v[200:203], a[28:31], v[40:43], v[200:203]
 v_mfma_f32_16x16x32_bf16 v[204:207], a[32:35], v[40:43], v[204:207]
 v_mfma_f32_16x16x32_bf16 v[208:211], a[36:39], v[40:43], v[208:211]
 s_waitcnt vmcnt(6)
 v_mfma_f32_16x16x32_bf16 v[172:175], a[40:43], v[44:47], v[172:175]
 v_mfma_f32_16x16x32_bf16 v[176:179], a[44:47], v[44:47], v[176:179]
 buffer_load_dwordx4 v[76:79], v11, s[8:11], s64 offen offset:2048 sc1
 buffer_load_dwordx4 v[80:83], v11, s[8:11], s65 offen offset:2048 sc1
 s_add_u32 s45, s63, s56
 buffer_load_dwordx4 v[12:15], v8, s[8:11], s45 offen sc1
 buffer_load_dwordx4 v[16:19], v9, s[8:11], s45 offen sc1
 buffer_load_dwordx4 v[20:23], v10, s[8:11], s45 offen sc1
 v_mfma_f32_16x16x32_bf16 v[180:183], a[48:51], v[44:47], v[180:183]
 v_mfma_f32_16x16x32_bf16 v[184:187], a[52:55], v[44:47], v[184:187]
 v_mfma_f32_16x16x32_bf16 v[188:191], a[56:59], v[44:47], v[188:191]
 v_mfma_f32_16x16x32_bf16 v[192:195], a[40:43], v[48:51], v[192:195]
 v_mfma_f32_16x16x32_bf16 v[196:199], a[44:47], v[48:51], v[196:199]
 v_mfma_f32_16x16x32_bf16 v[200:203], a[48:51], v[48:51], v[200:203]
 v_mfma_f32_16x16x32_bf16 v[204:207], a[52:55], v[48:51], v[204:207]
 v_mfma_f32_16x16x32_bf16 v[208:211], a[56:59], v[48:51], v[208:211]
 s_waitcnt vmcnt(9)
 v_mfma_f32_16x16x32_bf16 v[172:175], a[60:63], v[52:55], v[172:175]
 v_mfma_f32_16x16x32_bf16 v[176:179], a[64:67], v[52:55], v[176:179]
 buffer_load_dwordx4 v[84:87], v11, s[8:11], s64 offen offset:3072 sc1
 buffer_load_dwordx4 v[88:91], v11, s[8:11], s65 offen offset:3072 sc1
 v_mfma_f32_16x16x32_bf16 v[180:183], a[68:71], v[52:55], v[180:183]
 v_mfma_f32_16x16x32_bf16 v[184:187], a[72:75], v[52:55], v[184:187]
 v_mfma_f32_16x16x32_bf16 v[188:191], a[76:79], v[52:55], v[188:191]
 v_mfma_f32_16x16x32_bf16 v[192:195], a[60:63], v[56:59], v[192:195]
 v_mfma_f32_16x16x32_bf16 v[196:199], a[64:67], v[56:59], v[196:199]
 v_mfma_f32_16x16x32_bf16 v[200:203], a[68:71], v[56:59], v[200:203]
 v_mfma_f32_16x16x32_bf16 v[204:207], a[72:75], v[56:59], v[204:207]
 v_mfma_f32_16x16x32_bf16 v[208:211], a[76:79], v[56:59], v[208:211]
 s_waitcnt vmcnt(9)
 v_mfma_f32_16x16x32_bf16 v[172:175], a[80:83], v[60:63], v[172:175]
 v_mfma_f32_16x16x32_bf16 v[176:179], a[84:87], v[60:63], v[176:179]
 buffer_load_dwordx2 v[92:93], v24, s[8:11], s66 offen offset:0 sc1
 buffer_load_dwordx2 v[94:95], v24, s[8:11], s66 offen offset:128 sc1
 buffer_load_dwordx2 v[96:97], v24, s[8:11], s67 offen offset:0 sc1
 buffer_load_dwordx2 v[98:99], v24, s[8:11], s67 offen offset:128 sc1
 v_mfma_f32_16x16x32_bf16 v[180:183], a[88:91], v[60:63], v[180:183]
 v_mfma_f32_16x16x32_bf16 v[184:187], a[92:95], v[60:63], v[184:187]
 v_mfma_f32_16x16x32_bf16 v[188:191], a[96:99], v[60:63], v[188:191]
 v_mfma_f32_16x16x32_bf16 v[192:195], a[80:83], v[64:67], v[192:195]
 v_mfma_f32_16x16x32_bf16 v[196:199], a[84:87], v[64:67], v[196:199]
 v_mfma_f32_16x16x32_bf16 v[200:203], a[88:91], v[64:67], v[200:203]
 v_mfma_f32_16x16x32_bf16 v[204:207], a[92:95], v[64:67], v[204:207]
 v_mfma_f32_16x16x32_bf16 v[208:211], a[96:99], v[64:67], v[208:211]
 s_waitcnt vmcnt(11)
 v_mfma_f32_16x16x32_bf16 v[172:175], a[100:103], v[68:71], v[172:175]
 v_mfma_f32_16x16x32_bf16 v[176:179], a[104:107], v[68:71], v[176:179]
 buffer_load_dwordx2 v[100:101], v24, s[8:11], s66 offen offset:1024 sc1
 buffer_load_dwordx2 v[102:103], v24, s[8:11], s66 offen offset:1152 sc1
 buffer_load_dwordx2 v[104:105], v24, s[8:11], s67 offen offset:1024 sc1
 buffer_load_dwordx2 v[106:107], v24, s[8:11], s67 offen offset:1152 sc1
 v_mfma_f32_16x16x32_bf16 v[180:183], a[108:111], v[68:71], v[180:183]
 v_mfma_f32_16x16x32_bf16 v[184:187], a[112:115], v[68:71], v[184:187]
 v_mfma_f32_16x16x32_bf16 v[188:191], a[116:119], v[68:71], v[188:191]
 v_mfma_f32_16x16x32_bf16 v[192:195], a[100:103], v[72:75], v[192:195]
 v_mfma_f32_16x16x32_bf16 v[196:199], a[104:107], v[72:75], v[196:199]
 v_mfma_f32_16x16x32_bf16 v[200:203], a[108:111], v[72:75], v[200:203]
 v_mfma_f32_16x16x32_bf16 v[204:207], a[112:115], v[72:75], v[204:207]
 v_mfma_f32_16x16x32_bf16 v[208:211], a[116:119], v[72:75], v[208:211]
 s_waitcnt vmcnt(13)
 v_mfma_f32_16x16x32_bf16 v[172:175], a[120:123], v[76:79], v[172:175]
 v_mfma_f32_16x16x32_bf16 v[176:179], a[124:127], v[76:79], v[176:179]
 v_mfma_f32_16x16x32_bf16 v[180:183], a[128:131], v[76:79], v[180:183]
 v_mfma_f32_16x16x32_bf16 v[184:187], a[132:135], v[76:79], v[184:187]
 v_mfma_f32_16x16x32_bf16 v[188:191], a[136:139], v[76:79], v[188:191]
 v_mfma_f32_16x16x32_bf16 v[192:195], a[120:123], v[80:83], v[192:195]
 v_mfma_f32_16x16x32_bf16 v[196:199], a[124:127], v[80:83], v[196:199]
 v_mfma_f32_16x16x32_bf16 v[200:203], a[128:131], v[80:83], v[200:203]
 v_mfma_f32_16x16x32_bf16 v[204:207], a[132:135], v[80:83], v[204:207]
 v_mfma_f32_16x16x32_bf16 v[208:211], a[136:139], v[80:83], v[208:211]
 s_waitcnt vmcnt(8)
 v_mfma_f32_16x16x32_bf16 v[172:175], a[140:143], v[84:87], v[172:175]
 v_mfma_f32_16x16x32_bf16 v[176:179], a[144:147], v[84:87], v[176:179]
 v_mfma_f32_16x16x32_bf16 v[180:183], a[148:151], v[84:87], v[180:183]
 v_mfma_f32_16x16x32_bf16 v[184:187], a[152:155], v[84:87], v[184:187]
 v_mfma_f32_16x16x32_bf16 v[188:191], a[156:159], v[84:87], v[188:191]
 v_mfma_f32_16x16x32_bf16 v[192:195], a[140:143], v[88:91], v[192:195]
 v_mfma_f32_16x16x32_bf16 v[196:199], a[144:147], v[88:91], v[196:199]
 v_mfma_f32_16x16x32_bf16 v[200:203], a[148:151], v[88:91], v[200:203]
 v_mfma_f32_16x16x32_bf16 v[204:207], a[152:155], v[88:91], v[204:207]
 v_mfma_f32_16x16x32_bf16 v[208:211], a[156:159], v[88:91], v[208:211]
 s_waitcnt vmcnt(4)
 v_mfma_f32_16x16x32_bf16 v[172:175], a[160:163], v[92:95], v[172:175]
 v_mfma_f32_16x16x32_bf16 v[176:179], a[164:167], v[92:95], v[176:179]
 v_mfma_f32_16x16x32_bf16 v[180:183], a[168:171], v[92:95], v[180:183]
 v_mfma_f32_16x16x32_bf16 v[184:187], a[172:175], v[92:95], v[184:187]
 v_mfma_f32_16x16x32_bf16 v[188:191], a[176:179], v[92:95], v[188:191]
 v_mfma_f32_16x16x32_bf16 v[192:195], a[160:163], v[96:99], v[192:195]
 v_mfma_f32_16x16x32_bf16 v[196:199], a[164:167], v[96:99], v[196:199]
 v_mfma_f32_16x16x32_bf16 v[200:203], a[168:171], v[96:99], v[200:203]
 v_mfma_f32_16x16x32_bf16 v[204:207], a[172:175], v[96:99], v[204:207]
 v_mfma_f32_16x16x32_bf16 v[208:211], a[176:179], v[96:99], v[208:211]
 s_waitcnt vmcnt(0)
 v_mfma_f32_16x16x32_bf16 v[172:175], a[180:183], v[100:103], v[172:175]
 v_mfma_f32_16x16x32_bf16 v[176:179], a[184:187], v[100:103], v[176:179]
 v_mfma_f32_16x16x32_bf16 v[180:183], a[188:191], v[100:103], v[180:183]
 v_mfma_f32_16x16x32_bf16 v[184:187], a[192:195], v[100:103], v[184:187]
 v_mfma_f32_16x16x32_bf16 v[188:191], a[196:199], v[100:103], v[188:191]
 v_mfma_f32_16x16x32_bf16 v[192:195], a[180:183], v[104:107], v[192:195]
 v_mfma_f32_16x16x32_bf16 v[196:199], a[184:187], v[104:107], v[196:199]
 v_mfma_f32_16x16x32_bf16 v[200:203], a[188:191], v[104:107], v[200:203]
 v_mfma_f32_16x16x32_bf16 v[204:207], a[192:195], v[104:107], v[204:207]
 v_mfma_f32_16x16x32_bf16 v[208:211], a[196:199], v[104:107], v[208:211]
 s_mul_i32 s46, s5, 5120
 s_add_u32 s46, s46, 97280
 v_lshlrev_b32 v11, 4, v1
 v_add_u32 v3, s46, v11
 s_cmp_ge_u32 s5, 2
 s_cbranch_scc1 Lk1_50
 ds_write_b128 v3, v[192:195] offset:0
 ds_write_b128 v3, v[196:199] offset:1024
 ds_write_b128 v3, v[200:203] offset:2048
 ds_write_b128 v3, v[204:207] offset:3072
 ds_write_b128 v3, v[208:211] offset:4096
 s_branch Lk2_51
Lk1_50:
 ds_write_b128 v3, v[172:175] offset:0
 ds_write_b128 v3, v[176:179] offset:1024
 ds_write_b128 v3, v[180:183] offset:2048
 ds_write_b128 v3, v[184:187] offset:3072
 ds_write_b128 v3, v[188:191] offset:4096
 v_mov_b32 v172, v192
 v_mov_b32 v173, v193
 v_mov_b32 v174, v194
 v_mov_b32 v175, v195
 v_mov_b32 v176, v196
 v_mov_b32 v177, v197
 v_mov_b32 v178, v198
 v_mov_b32 v179, v199
 v_mov_b32 v180, v200
 v_mov_b32 v181, v201
 v_mov_b32 v182, v202
 v_mov_b32 v183, v203
 v_mov_b32 v184, v204
 v_mov_b32 v185, v205
 v_mov_b32 v186, v206
 v_mov_b32 v187, v207
 v_mov_b32 v188, v208
 v_mov_b32 v189, v209
 v_mov_b32 v190, v210
 v_mov_b32 v191, v211
Lk2_51:
 v_add_u32 v84, 81920, v11
 s_waitcnt lgkmcnt(0)
 s_barrier
 s_xor_b32 s46, s5, 2
 s_mul_i32 s46, s46, 5120
 s_add_u32 s46, s46, 97280
 v_add_u32_e64 v3, s46, v11
 ds_read_b128 v[192:195], v3 offset:0
 ds_read_b128 v[196:199], v3 offset:1024
 ds_read_b128 v[200:203], v3 offset:2048
 ds_read_b128 v[204:207], v3 offset:3072
 ds_read_b128 v[208:211], v3 offset:4096
 ds_read_b128 v[24:27], v84 offset:0
 ds_read_b128 v[28:31], v84 offset:1024
 ds_read_b128 v[32:35], v84 offset:2048
 ds_read_b128 v[36:39], v84 offset:3072
 ds_read_b128 v[40:43], v84 offset:4096
 ds_read_b128 v[44:47], v84 offset:5120
 ds_read_b128 v[48:51], v84 offset:6144
 ds_read_b128 v[52:55], v84 offset:7168
 ds_read_b128 v[56:59], v84 offset:8192
 ds_read_b128 v[60:63], v84 offset:9216
 ds_read_b128 v[64:67], v84 offset:10240
 ds_read_b128 v[68:71], v84 offset:11264
 ds_read_b128 v[72:75], v84 offset:12288
 ds_read_b128 v[76:79], v84 offset:13312
 ds_read_b128 v[80:83], v84 offset:14336
 s_waitcnt vmcnt(10) lgkmcnt(15)
 v_permlane16_swap_b32 v12, v14
 v_permlane16_swap_b32 v13, v15
 v_permlane16_swap_b32 v16, v18
 v_permlane16_swap_b32 v17, v19
 v_permlane16_swap_b32 v20, v22
 v_permlane16_swap_b32 v21, v23
 v_pk_add_f32 v[172:173], v[172:173], v[192:193]
 v_pk_add_f32 v[174:175], v[174:175], v[194:195]
 v_lshlrev_b32 v86, 16, v12
 v_and_b32 v87, 0xffff0000, v12
 v_lshlrev_b32_e64 v88, 16, v13
 v_and_b32 v89, 0xffff0000, v13
 v_pk_add_f32 v[172:173], v[172:173], v[86:87]
 v_pk_add_f32 v[174:175], v[174:175], v[88:89]
 v_pk_add_f32 v[176:177], v[176:177], v[196:197]
 v_pk_add_f32 v[178:179], v[178:179], v[198:199]
 v_lshlrev_b32_e64 v86, 16, v14
 v_and_b32 v87, 0xffff0000, v14
 v_lshlrev_b32_e64 v88, 16, v15
 v_and_b32 v89, 0xffff0000, v15
 v_pk_add_f32 v[176:177], v[176:177], v[86:87]
 v_pk_add_f32 v[178:179], v[178:179], v[88:89]
 v_pk_add_f32 v[180:181], v[180:181], v[200:201]
 v_pk_add_f32 v[182:183], v[182:183], v[202:203]
 v_lshlrev_b32_e64 v86, 16, v16
 v_and_b32 v87, 0xffff0000, v16
 v_lshlrev_b32_e64 v88, 16, v17
 v_and_b32 v89, 0xffff0000, v17
 v_pk_add_f32 v[180:181], v[180:181], v[86:87]
 v_pk_add_f32 v[182:183], v[182:183], v[88:89]
 v_pk_add_f32 v[184:185], v[184:185], v[204:205]
 v_pk_add_f32 v[186:187], v[186:187], v[206:207]
 v_lshlrev_b32_e64 v86, 16, v18
 v_and_b32 v87, 0xffff0000, v18
 v_lshlrev_b32_e64 v88, 16, v19
 v_and_b32 v89, 0xffff0000, v19
 v_pk_add_f32 v[184:185], v[184:185], v[86:87]
 v_pk_add_f32 v[186:187], v[186:187], v[88:89]
 v_pk_add_f32 v[188:189], v[188:189], v[208:209]
 v_pk_add_f32 v[190:191], v[190:191], v[210:211]
 v_lshlrev_b32_e64 v86, 16, v20
 v_and_b32 v87, 0xffff0000, v20
 v_lshlrev_b32_e64 v88, 16, v21
 v_and_b32 v89, 0xffff0000, v21
 v_pk_add_f32 v[188:189], v[188:189], v[86:87]
 v_pk_add_f32 v[190:191], v[190:191], v[88:89]
 v_cvt_pk_bf16_f32 v88, v172, v173
 v_cvt_pk_bf16_f32 v89, v174, v175
 v_cvt_pk_bf16_f32 v90, v176, v177
 v_cvt_pk_bf16_f32 v91, v178, v179
 v_cvt_pk_bf16_f32 v92, v180, v181
 v_cvt_pk_bf16_f32 v93, v182, v183
 v_cvt_pk_bf16_f32 v94, v184, v185
 v_cvt_pk_bf16_f32 v95, v186, v187
 v_cvt_pk_bf16_f32 v96, v188, v189
 v_cvt_pk_bf16_f32 v97, v190, v191
 v_mov_b32 v98, 0
 v_mov_b32 v99, 0
 v_mov_b32 v12, v88
 v_mov_b32 v13, v89
 v_mov_b32 v14, v90
 v_mov_b32 v15, v91
 v_mov_b32 v16, v92
 v_mov_b32 v17, v93
 v_mov_b32 v18, v94
 v_mov_b32 v19, v95
 v_mov_b32 v20, v96
 v_mov_b32 v21, v97
 v_mov_b32 v22, v96
 v_mov_b32 v23, v97
 v_permlane16_swap_b32 v12, v14
 v_permlane16_swap_b32 v13, v15
 v_permlane16_swap_b32 v16, v18
 v_permlane16_swap_b32 v17, v19
 v_permlane16_swap_b32 v20, v22
 v_permlane16_swap_b32 v21, v23
 s_waitcnt lgkmcnt(0)
 v_mfma_f32_16x16x32_bf16 v[192:195], v[24:27], v[88:91], 0
 v_mfma_f32_16x16x32_bf16 v[192:195], v[28:31], v[92:95], v[192:195]
 v_mfma_f32_16x16x32_bf16 v[192:195], v[32:35], v[96:99], v[192:195]
 v_mfma_f32_16x16x32_bf16 v[196:199], v[36:39], v[88:91], 0
 v_mfma_f32_16x16x32_bf16 v[196:199], v[40:43], v[92:95], v[196:199]
 v_mfma_f32_16x16x32_bf16 v[196:199], v[44:47], v[96:99], v[196:199]
 v_mfma_f32_16x16x32_bf16 v[200:203], v[48:51], v[88:91], 0
 v_mfma_f32_16x16x32_bf16 v[200:203], v[52:55], v[92:95], v[200:203]
 v_mfma_f32_16x16x32_bf16 v[200:203], v[56:59], v[96:99], v[200:203]
 v_mfma_f32_16x16x32_bf16 v[204:207], v[60:63], v[88:91], 0
 v_mfma_f32_16x16x32_bf16 v[204:207], v[64:67], v[92:95], v[204:207]
 v_mfma_f32_16x16x32_bf16 v[204:207], v[68:71], v[96:99], v[204:207]
 v_mfma_f32_16x16x32_bf16 v[208:211], v[72:75], v[88:91], 0
 v_mfma_f32_16x16x32_bf16 v[208:211], v[76:79], v[92:95], v[208:211]
 v_mfma_f32_16x16x32_bf16 v[208:211], v[80:83], v[96:99], v[208:211]
 s_add_u32 s45, s63, s59
 buffer_store_dwordx4 v[12:15], v8, s[8:11], s45 offen
 buffer_store_dwordx4 v[16:19], v9, s[8:11], s45 offen
 buffer_store_dwordx4 v[20:23], v10, s[8:11], s45 offen
 v_pk_add_f32 v[86:87], v[172:173], v[174:175]
 v_pk_mul_f32 v[100:101], v[172:173], v[172:173]
 v_pk_fma_f32 v[100:101], v[174:175], v[174:175], v[100:101]
 v_pk_add_f32 v[86:87], v[86:87], v[176:177]
 v_pk_fma_f32 v[100:101], v[176:177], v[176:177], v[100:101]
 v_pk_add_f32 v[86:87], v[86:87], v[178:179]
 v_pk_fma_f32 v[100:101], v[178:179], v[178:179], v[100:101]
 v_pk_add_f32 v[86:87], v[86:87], v[180:181]
 v_pk_fma_f32 v[100:101], v[180:181], v[180:181], v[100:101]
 v_pk_add_f32 v[86:87], v[86:87], v[182:183]
 v_pk_fma_f32 v[100:101], v[182:183], v[182:183], v[100:101]
 v_pk_add_f32 v[86:87], v[86:87], v[184:185]
 v_pk_fma_f32 v[100:101], v[184:185], v[184:185], v[100:101]
 v_pk_add_f32 v[86:87], v[86:87], v[186:187]
 v_pk_fma_f32 v[100:101], v[186:187], v[186:187], v[100:101]
 v_pk_add_f32 v[86:87], v[86:87], v[188:189]
 v_pk_fma_f32 v[100:101], v[188:189], v[188:189], v[100:101]
 v_pk_add_f32 v[86:87], v[86:87], v[190:191]
 v_pk_fma_f32 v[100:101], v[190:191], v[190:191], v[100:101]
 v_add_f32 v86, v86, v87
 v_add_f32 v87, v100, v101
 v_mov_b32 v2, v86
 s_nop 1
 v_permlane16_swap_b32 v2, v86
 v_add_f32 v86, v86, v2
 v_mov_b32 v2, v86
 s_nop 1
 v_permlane32_swap_b32 v2, v86
 v_add_f32 v86, v86, v2
 v_mov_b32 v2, v87
 s_nop 1
 v_permlane16_swap_b32 v2, v87
 v_add_f32 v87, v87, v2
 v_mov_b32 v2, v87
 s_nop 1
 v_permlane32_swap_b32 v2, v87
 v_add_f32 v87, v87, v2
 s_lshr_b32 s46, s4, 2
 s_lshl_b32 s46, s46, 11
 v_lshlrev_b32 v3, 3, v6
 v_cmp_gt_u32 vcc, 16, v1
 v_mov_b32 v2, 2146435072
 s_nop 0
 v_cndmask_b32 v3, v2, v3, vcc
 s_mul_i32 s47, s3, 344064
 s_add_u32 s46, s46, s47
 s_add_u32 s46, s46, s61
 buffer_store_dwordx2 v[86:87], v3, s[8:11], s46 offen
 v_cvt_pk_bf16_f32 v102, v192, v193
 v_cvt_pk_bf16_f32 v103, v194, v195
 v_cvt_pk_bf16_f32 v104, v196, v197
 v_cvt_pk_bf16_f32 v105, v198, v199
 v_cvt_pk_bf16_f32 v106, v200, v201
 v_cvt_pk_bf16_f32 v107, v202, v203
 v_cvt_pk_bf16_f32 v108, v204, v205
 v_cvt_pk_bf16_f32 v109, v206, v207
 v_cvt_pk_bf16_f32 v110, v208, v209
 v_cvt_pk_bf16_f32 v111, v210, v211
 v_lshrrev_b32 v2, 4, v1
 v_lshlrev_b32 v3, 14, v2
 v_lshl_add_u32 v3, v6, 3, v3
 s_lshr_b32 s46, s4, 2
 s_lshl_b32 s46, s46, 11
 s_mul_i32 s47, s3, 327680
 s_add_u32 s46, s46, s47
 s_add_u32 s46, s46, s60
 buffer_store_dwordx2 v[102:103], v3, s[8:11], s46 offen
 s_add_u32 s46, s46, 65536
 buffer_store_dwordx2 v[104:105], v3, s[8:11], s46 offen
 s_add_u32 s46, s46, 65536
 buffer_store_dwordx2 v[106:107], v3, s[8:11], s46 offen
 s_add_u32 s46, s46, 65536
 buffer_store_dwordx2 v[108:109], v3, s[8:11], s46 offen
 s_add_u32 s46, s46, 65536
 buffer_store_dwordx2 v[110:111], v3, s[8:11], s46 offen
 s_waitcnt vmcnt(0) lgkmcnt(0)
 s_barrier
 s_add_u32 s40, s40, 1
 s_cmp_lg_u32 s5, 0
 s_cbranch_scc1 Llb_52
 v_mov_b32_e64 v3, s40
 s_mov_b64 s[6:7], exec
 s_mov_b64 exec, 1
 buffer_store_dword v3, v4, s[8:11], 0 offen
 s_mov_b64 exec, s[6:7]
Llb_52:
 s_cmp_lg_u32 s42, 0
 s_cbranch_scc1 Lcst_53
 v_accvgpr_read_b32 v2, a202
 v_accvgpr_read_b32 v3, a203
 v_accvgpr_mov_b32 a206, a200
 v_accvgpr_mov_b32 a207, a201
 v_xor_b32 v2, 0x80008000, v2
 v_xor_b32 v3, 0x80008000, v3
 v_accvgpr_write_b32 a204, v2
 v_accvgpr_write_b32 a205, v3
 v_accvgpr_read_b32 v2, a210
 v_accvgpr_read_b32 v3, a211
 v_accvgpr_mov_b32 a214, a208
 v_accvgpr_mov_b32 a215, a209
 v_xor_b32 v2, 0x80008000, v2
 v_xor_b32 v3, 0x80008000, v3
 v_accvgpr_write_b32 a212, v2
 v_accvgpr_write_b32 a213, v3
 v_accvgpr_read_b32 v2, a218
 v_accvgpr_read_b32 v3, a219
 v_accvgpr_mov_b32 a222, a216
 v_accvgpr_mov_b32 a223, a217
 v_xor_b32 v2, 0x80008000, v2
 v_xor_b32 v3, 0x80008000, v3
 v_accvgpr_write_b32 a220, v2
 v_accvgpr_write_b32 a221, v3
 v_accvgpr_read_b32 v2, a226
 v_accvgpr_read_b32 v3, a227
 v_accvgpr_mov_b32 a230, a224
 v_accvgpr_mov_b32 a231, a225
 v_xor_b32 v2, 0x80008000, v2
 v_xor_b32 v3, 0x80008000, v3
 v_accvgpr_write_b32 a228, v2
 v_accvgpr_write_b32 a229, v3
Lcst_53:
 v_and_b32 v6, 15, v1
 v_lshrrev_b32 v8, 4, v1
 s_sub_u32 s44, s4, 1
 s_cmp_eq_u32 s4, 0
 s_cselect_b32 s44, 0, s44
 s_cmp_ge_u32 s4, 2
 s_cselect_b32 s45, 1, 0
 s_cmp_eq_u32 s4, 1
 s_cselect_b32 s47, 1, 0
 v_lshrrev_b32 v2, 1, v8
 v_mul_u32_u24 v2, s45, v2
 v_add_u32 v2, s47, v2
 v_lshlrev_b32 v9, 2, v2
 v_and_b32 v2, 1, v8
 v_lshl_add_u32 v9, v2, 13, v9
 s_lshl_b32 s44, s44, 14
 s_lshl_b32 s46, s5, 9
 s_add_u32 s44, s44, s46
 v_lshl_add_u32 v9, v6, 3, v9
 v_add_u32 v9, s44, v9
 s_lshl_b32 s46, s5, 9
 v_lshlrev_b32 v10, 3, v1
 v_add_u32_e64 v10, s46, v10
 s_mul_i32 s63, s3, 327680
 s_add_u32 s63, s63, s60
 s_mul_i32 s64, s3, 344064
 s_add_u32 s64, s64, s61
 s_cmp_lg_u32 s5, 0
 s_cbranch_scc1 Llb_54
 s_mov_b32 s39, 4194304
Lpoll_55:
 buffer_load_dword v2, v5, s[8:11], 0 offen sc1
 s_waitcnt vmcnt(0)
 v_cmp_gt_u32_e64 vcc, s40, v2
 s_cbranch_vccz Lpdone_56
 s_sub_u32 s39, s39, 1
 s_cmp_lg_u32 s39, 0
 s_cbranch_scc1 Lpoll_55
Lpdone_56:
Llb_54:
 s_barrier
 s_cmp_gt_u32 s4, 20
 s_cbranch_scc1 Lb1d_57
 buffer_load_dwordx2 v[12:13], v10, s[8:11], s64 offen offset:0 sc1
 buffer_load_dwordx2 v[14:15], v10, s[8:11], s64 offen offset:2048 sc1
 s_add_u32 s64, s64, 4096
 buffer_load_dwordx2 v[16:17], v10, s[8:11], s64 offen offset:0 sc1
 buffer_load_dwordx2 v[18:19], v10, s[8:11], s64 offen offset:2048 sc1
 s_add_u32 s64, s64, 4096
 buffer_load_dwordx2 v[20:21], v10, s[8:11], s64 offen offset:0 sc1
 buffer_load_dwordx2 v[22:23], v10, s[8:11], s64 offen offset:2048 sc1
 s_add_u32 s64, s64, 4096
 buffer_load_dwordx2 v[24:25], v10, s[8:11], s64 offen offset:0 sc1
 buffer_load_dwordx2 v[26:27], v10, s[8:11], s64 offen offset:2048 sc1
 s_add_u32 s68, s63, 0
 s_add_u32 s69, s63, 2048
 s_add_u32 s70, s63, 4096
 s_add_u32 s71, s63, 6144
 buffer_load_dword v28, v9, s[8:11], s68 offen offset:0 sc1
 buffer_load_dword v29, v9, s[8:11], s69 offen offset:0 sc1
 buffer_load_dword v30, v9, s[8:11], s70 offen offset:0 sc1
 buffer_load_dword v31, v9, s[8:11], s71 offen offset:0 sc1
 buffer_load_dword v32, v9, s[8:11], s68 offen offset:128 sc1
 buffer_load_dword v33, v9, s[8:11], s69 offen offset:128 sc1
 buffer_load_dword v34, v9, s[8:11], s70 offen offset:128 sc1
 buffer_load_dword v35, v9, s[8:11], s71 offen offset:128 sc1
 buffer_load_dword v36, v9, s[8:11], s68 offen offset:256 sc1
 buffer_load_dword v37, v9, s[8:11], s69 offen offset:256 sc1
 buffer_load_dword v38, v9, s[8:11], s70 offen offset:256 sc1
 buffer_load_dword v39, v9, s[8:11], s71 offen offset:256 sc1
 buffer_load_dword v40, v9, s[8:11], s68 offen offset:384 sc1
 buffer_load_dword v41, v9, s[8:11], s69 offen offset:384 sc1
 buffer_load_dword v42, v9, s[8:11], s70 offen offset:384 sc1
 buffer_load_dword v43, v9, s[8:11], s71 offen offset:384 sc1
 s_waitcnt vmcnt(16)
 v_pk_add_f32 v[12:13], v[12:13], v[14:15]
 v_pk_add_f32 v[12:13], v[12:13], v[16:17]
 v_pk_add_f32 v[12:13], v[12:13], v[18:19]
 v_pk_add_f32 v[12:13], v[12:13], v[20:21]
 v_pk_add_f32 v[12:13], v[12:13], v[22:23]
 v_pk_add_f32 v[12:13], v[12:13], v[24:25]
 v_pk_add_f32 v[12:13], v[12:13], v[26:27]
 v_mul_f32 v12, 0x3acccccd, v12
 v_mul_f32 v13, 0x3acccccd, v13
 v_fma_f32 v13, -v12, v12, v13
 v_add_f32 v13, 0x3727c5ac, v13
 v_rsq_f32 v13, v13
 s_lshl_b32 s46, s5, 8
 s_add_u32 s46, s46, 113664
 v_lshlrev_b32 v2, 2, v1
 v_add_u32 v2, s46, v2
 ds_write_b32 v2, v13
 v_lshlrev_b32 v3, 4, v8
 v_add_u32 v3, s46, v3
 s_waitcnt lgkmcnt(0)
 ds_read_b128 v[12:15], v3 offset:0
 ds_read_b128 v[16:19], v3 offset:64
 ds_read_b128 v[20:23], v3 offset:128
 ds_read_b128 v[24:27], v3 offset:192
 s_waitcnt vmcnt(12)
 v_mfma_f32_16x16x32_bf16 v[44:47], v[28:31], a[232:235], 0
 v_mfma_f32_16x16x32_bf16 v[60:63], v[28:31], a[236:239], 0
 s_waitcnt vmcnt(8)
 v_mfma_f32_16x16x32_bf16 v[48:51], v[32:35], a[232:235], 0
 v_mfma_f32_16x16x32_bf16 v[64:67], v[32:35], a[236:239], 0
 s_waitcnt vmcnt(4)
 v_mfma_f32_16x16x32_bf16 v[52:55], v[36:39], a[232:235], 0
 v_mfma_f32_16x16x32_bf16 v[68:71], v[36:39], a[236:239], 0
 s_waitcnt vmcnt(0)
 v_mfma_f32_16x16x32_bf16 v[56:59], v[40:43], a[232:235], 0
 v_mfma_f32_16x16x32_bf16 v[72:75], v[40:43], a[236:239], 0
 s_waitcnt lgkmcnt(0)
 v_pk_mul_f32 v[44:45], v[44:45], v[12:13]
 v_pk_mul_f32 v[60:61], v[60:61], v[12:13]
 v_pk_mul_f32 v[46:47], v[46:47], v[14:15]
 v_pk_mul_f32 v[62:63], v[62:63], v[14:15]
 v_cvt_pk_bf16_f32 v28, v44, v45
 v_cvt_pk_bf16_f32 v29, v46, v47
 v_cvt_pk_bf16_f32 v30, v60, v61
 v_cvt_pk_bf16_f32 v31, v62, v63
 v_pk_mul_f32 v[48:49], v[48:49], v[16:17]
 v_pk_mul_f32 v[64:65], v[64:65], v[16:17]
 v_pk_mul_f32 v[50:51], v[50:51], v[18:19]
 v_pk_mul_f32 v[66:67], v[66:67], v[18:19]
 v_cvt_pk_bf16_f32 v32, v48, v49
 v_cvt_pk_bf16_f32 v33, v50, v51
 v_cvt_pk_bf16_f32 v34, v64, v65
 v_cvt_pk_bf16_f32 v35, v66, v67
 v_pk_mul_f32 v[52:53], v[52:53], v[20:21]
 v_pk_mul_f32 v[68:69], v[68:69], v[20:21]
 v_pk_mul_f32 v[54:55], v[54:55], v[22:23]
 v_pk_mul_f32 v[70:71], v[70:71], v[22:23]
 v_cvt_pk_bf16_f32 v36, v52, v53
 v_cvt_pk_bf16_f32 v37, v54, v55
 v_cvt_pk_bf16_f32 v38, v68, v69
 v_cvt_pk_bf16_f32 v39, v70, v71
 v_pk_mul_f32 v[56:57], v[56:57], v[24:25]
 v_pk_mul_f32 v[72:73], v[72:73], v[24:25]
 v_pk_mul_f32 v[58:59], v[58:59], v[26:27]
 v_pk_mul_f32 v[74:75], v[74:75], v[26:27]
 v_cvt_pk_bf16_f32 v40, v56, v57
 v_cvt_pk_bf16_f32 v41, v58, v59
 v_cvt_pk_bf16_f32 v42, v72, v73
 v_cvt_pk_bf16_f32 v43, v74, v75
 v_mfma_f32_16x16x32_bf16 v[44:47], a[240:243], v[28:31], 0
 v_mfma_f32_16x16x32_bf16 v[60:63], a[244:247], v[28:31], 0
 v_mfma_f32_16x16x32_bf16 v[48:51], a[240:243], v[32:35], 0
 v_mfma_f32_16x16x32_bf16 v[64:67], a[244:247], v[32:35], 0
 v_mfma_f32_16x16x32_bf16 v[52:55], a[240:243], v[36:39], 0
 v_mfma_f32_16x16x32_bf16 v[68:71], a[244:247], v[36:39], 0
 v_mfma_f32_16x16x32_bf16 v[56:59], a[240:243], v[40:43], 0
 v_mfma_f32_16x16x32_bf16 v[72:75], a[244:247], v[40:43], 0
 v_lshlrev_b32 v2, 12, v8
 v_lshl_add_u32 v2, v6, 6, v2
 s_lshl_b32 s46, s5, 4
 s_add_u32 s46, s46, 97280
 v_add_u32 v2, s46, v2
 v_cvt_pk_bf16_f32 v12, v44, v48
 s_nop 0
 v_cvt_pk_bf16_f32 v13, v52, v56
 v_cvt_pk_bf16_f32 v14, v60, v64
 v_cvt_pk_bf16_f32 v15, v68, v72
 ds_write_b128 v2, v[12:15] offset:0
 v_cvt_pk_bf16_f32 v16, v45, v49
 v_cvt_pk_bf16_f32 v17, v53, v57
 v_cvt_pk_bf16_f32 v18, v61, v65
 v_cvt_pk_bf16_f32 v19, v69, v73
 ds_write_b128 v2, v[16:19] offset:1024
 v_cvt_pk_bf16_f32 v20, v46, v50
 v_cvt_pk_bf16_f32 v21, v54, v58
 v_cvt_pk_bf16_f32 v22, v62, v66
 v_cvt_pk_bf16_f32 v23, v70, v74
 ds_write_b128 v2, v[20:23] offset:2048
 v_cvt_pk_bf16_f32 v24, v47, v51
 v_cvt_pk_bf16_f32 v25, v55, v59
 v_cvt_pk_bf16_f32 v26, v63, v67
 v_cvt_pk_bf16_f32 v27, v71, v75
 ds_write_b128 v2, v[24:27] offset:3072
 s_waitcnt lgkmcnt(0)
 s_barrier
 s_lshl_b32 s46, s5, 12
 s_add_u32 s46, s46, 97280
 v_lshlrev_b32 v2, 6, v6
 v_lshl_add_u32 v2, v8, 4, v2
 v_add_u32 v2, s46, v2
 ds_read_b128 v[28:31], v2 offset:0
 ds_read_b128 v[32:35], v2 offset:1024
 ds_read_b128 v[36:39], v2 offset:2048
 ds_read_b128 v[40:43], v2 offset:3072
 s_waitcnt lgkmcnt(0)
 v_mfma_f32_16x16x32_bf16 v[44:47], a[200:203], v[28:31], 0
 v_mfma_f32_16x16x32_bf16 v[60:63], a[204:207], v[28:31], 0
 v_mfma_f32_16x16x32_bf16 v[48:51], a[208:211], v[32:35], 0
 v_mfma_f32_16x16x32_bf16 v[64:67], a[212:215], v[32:35], 0
 v_mfma_f32_16x16x32_bf16 v[52:55], a[216:219], v[36:39], 0
 v_mfma_f32_16x16x32_bf16 v[68:71], a[220:223], v[36:39], 0
 v_mfma_f32_16x16x32_bf16 v[56:59], a[224:227], v[40:43], 0
 v_mfma_f32_16x16x32_bf16 v[72:75], a[228:231], v[40:43], 0
 s_mul_i32 s46, s3, 344064
 s_add_u32 s46, s46, s62
 s_lshl_b32 s47, s4, 14
 s_add_u32 s46, s46, s47
 s_lshl_b32 s47, s5, 12
 s_add_u32 s46, s46, s47
 v_and_b32 v2, 1, v8
 v_lshlrev_b32 v3, 7, v2
 v_lshrrev_b32 v2, 1, v8
 v_lshl_add_u32 v3, v2, 6, v3
 v_lshl_add_u32 v3, v6, 2, v3
 v_cvt_pk_bf16_f32 v12, v44, v60
 buffer_store_dword v12, v3, s[8:11], s46 offen offset:0 sc1
 v_cvt_pk_bf16_f32 v13, v45, v61
 buffer_store_dword v13, v3, s[8:11], s46 offen offset:256 sc1
 v_cvt_pk_bf16_f32 v14, v46, v62
 buffer_store_dword v14, v3, s[8:11], s46 offen offset:512 sc1
 v_cvt_pk_bf16_f32 v15, v47, v63
 buffer_store_dword v15, v3, s[8:11], s46 offen offset:768 sc1
 v_cvt_pk_bf16_f32 v16, v48, v64
 buffer_store_dword v16, v3, s[8:11], s46 offen offset:1024 sc1
 v_cvt_pk_bf16_f32 v17, v49, v65
 buffer_store_dword v17, v3, s[8:11], s46 offen offset:1280 sc1
 v_cvt_pk_bf16_f32 v18, v50, v66
 buffer_store_dword v18, v3, s[8:11], s46 offen offset:1536 sc1
 v_cvt_pk_bf16_f32 v19, v51, v67
 buffer_store_dword v19, v3, s[8:11], s46 offen offset:1792 sc1
 v_cvt_pk_bf16_f32 v20, v52, v68
 buffer_store_dword v20, v3, s[8:11], s46 offen offset:2048 sc1
 v_cvt_pk_bf16_f32 v21, v53, v69
 buffer_store_dword v21, v3, s[8:11], s46 offen offset:2304 sc1
 v_cvt_pk_bf16_f32 v22, v54, v70
 buffer_store_dword v22, v3, s[8:11], s46 offen offset:2560 sc1
 v_cvt_pk_bf16_f32 v23, v55, v71
 buffer_store_dword v23, v3, s[8:11], s46 offen offset:2816 sc1
 v_cvt_pk_bf16_f32 v24, v56, v72
 buffer_store_dword v24, v3, s[8:11], s46 offen offset:3072 sc1
 v_cvt_pk_bf16_f32 v25, v57, v73
 buffer_store_dword v25, v3, s[8:11], s46 offen offset:3328 sc1
 v_cvt_pk_bf16_f32 v26, v58, v74
 buffer_store_dword v26, v3, s[8:11], s46 offen offset:3584 sc1
 v_cvt_pk_bf16_f32 v27, v59, v75
 buffer_store_dword v27, v3, s[8:11], s46 offen offset:3840 sc1
Lb1d_57:
 v_and_b32 v6, 15, v1
 v_lshrrev_b32 v8, 4, v1
 s_lshl_b32 s44, s4, 3
 s_add_u32 s44, s44, s3
 v_lshrrev_b32 v11, 1, v8
 v_lshlrev_b32 v11, 7, v11
 v_add_u32 v11, s44, v11
 v_and_b32 v2, 15, v11
 v_lshlrev_b32_e64 v9, 10, v2
 v_bfe_u32 v2, v11, 4, 2
 v_lshl_add_u32 v9, v2, 8, v9
 v_bfe_u32 v2, v11, 6, 1
 v_lshl_add_u32 v9, v2, 7, v9
 v_lshrrev_b32_e64 v2, 7, v11
 v_lshl_add_u32 v9, v2, 6, v9
 v_lshl_add_u32 v9, v6, 2, v9
 v_and_b32_e64 v2, 1, v8
 s_mov_b32 s45, 1376256
 v_mul_lo_u32 v2, v2, s45
 v_add_u32 v9, v9, v2
 v_lshrrev_b32 v11, 1, v8
 v_lshlrev_b32 v11, 7, v11
 v_add_u32 v11, s44, v11
 v_sub_u32 v11, 256, v11
 v_and_b32 v11, 255, v11
 v_and_b32 v2, 15, v11
 v_lshlrev_b32 v10, 10, v2
 v_bfe_u32 v2, v11, 4, 2
 v_lshl_add_u32 v10, v2, 8, v10
 v_bfe_u32 v2, v11, 6, 1
 v_lshl_add_u32 v10, v2, 7, v10
 v_lshrrev_b32_e64 v2, 7, v11
 v_lshl_add_u32 v10, v2, 6, v10
 v_and_b32 v2, 8, v6
 v_and_b32 v3, 7, v6
 v_sub_u32 v3, 7, v3
 v_add_u32 v2, v2, v3
 v_lshl_add_u32 v10, v2, 2, v10
 v_and_b32_e64 v2, 1, v8
 s_mov_b32 s45, 1376256
 v_mul_lo_u32 v2, v2, s45
 v_add_u32 v10, v10, v2
 s_lshr_b32 s45, s4, 1
 s_mul_i32 s45, s45, 40960
 s_and_b32 s46, s4, 1
 s_lshl_b32 s46, s46, 8
 s_add_u32 s45, s45, s46
 s_mul_i32 s46, s5, 10240
 s_add_u32 s45, s45, s46
 s_mul_i32 s46, s3, 327680
 s_add_u32 s45, s45, s46
 v_lshlrev_b32 v11, 4, v6
 v_lshrrev_b32_e64 v2, 1, v8
 v_lshl_add_u32 v11, v2, 9, v11
 v_and_b32_e64 v2, 1, v8
 v_lshl_add_u32 v11, v2, 10, v11
 v_add_u32 v11, s45, v11
 s_cmp_lt_u32 s4, 16
 s_cselect_b32 s63, 1, 0
 s_cmp_eq_u32 s63, 0
 s_cbranch_scc1 Lb2p_59
 s_add_u32 s46, s59, 0
 buffer_load_dwordx4 v[12:15], v11, s[8:11], s46 offen sc1
 s_add_u32 s46, s59, 2048
 buffer_load_dwordx4 v[16:19], v11, s[8:11], s46 offen sc1
 s_add_u32 s46, s59, 4096
 buffer_load_dwordx4 v[20:23], v11, s[8:11], s46 offen sc1
 s_add_u32 s46, s59, 6144
 buffer_load_dwordx4 v[24:27], v11, s[8:11], s46 offen sc1
 s_add_u32 s46, s59, 8192
 buffer_load_dwordx4 v[28:31], v11, s[8:11], s46 offen sc1
 s_waitcnt vmcnt(0)
 v_permlane16_swap_b32 v12, v14
 v_permlane16_swap_b32 v13, v15
 v_permlane16_swap_b32 v16, v18
 v_permlane16_swap_b32 v17, v19
 v_permlane16_swap_b32 v20, v22
 v_permlane16_swap_b32 v21, v23
 v_permlane16_swap_b32 v24, v26
 v_permlane16_swap_b32 v25, v27
 v_permlane16_swap_b32 v28, v30
 v_permlane16_swap_b32 v29, v31
Lb2p_59:
 s_cmp_eq_u32 s63, 0
 s_cbranch_scc1 Lb2d_58
 v_lshrrev_b32 v76, 3, v1
 s_mul_i32 s64, s5, 10
 v_add_u32 v76, s64, v76
 v_subrev_u32 v77, 19, v76
 v_cmp_lt_u32 vcc, 20, v76
 s_nop 1
 v_cndmask_b32 v77, v76, v77, vcc
 v_readlane_b32 s46, v9, 0
 v_readlane_b32 s47, v10, 0
 s_nop 0
 v_mov_b32 v78, s46
 v_mov_b32 v2, s47
 v_cndmask_b32 v78, v78, v2, vcc
 v_lshl_add_u32 v72, v77, 14, v78
 v_and_b32_e64 v2, 7, v1
 s_mov_b32 s46, 344064
 v_mul_lo_u32 v2, v2, s46
 v_add_u32 v72, v72, v2
 v_lshrrev_b32 v76, 3, v1
 v_add_u32 v76, 8, v76
 v_min_u32 v76, 9, v76
 s_mul_i32 s64, s5, 10
 v_add_u32 v76, s64, v76
 v_subrev_u32 v77, 19, v76
 v_cmp_lt_u32 vcc, 20, v76
 s_nop 1
 v_cndmask_b32 v77, v76, v77, vcc
 v_readlane_b32 s46, v9, 0
 v_readlane_b32 s47, v10, 0
 s_nop 0
 v_mov_b32 v78, s46
 v_mov_b32 v2, s47
 v_cndmask_b32 v78, v78, v2, vcc
 v_lshl_add_u32 v73, v77, 14, v78
 v_and_b32_e64 v2, 7, v1
 s_mov_b32 s46, 344064
 v_mul_lo_u32 v2, v2, s46
 v_add_u32 v73, v73, v2
 s_cmp_eq_u32 s42, 0
 s_cbranch_scc1 Loa_60
 s_mul_i32 s64, s5, 20
 v_lshrrev_b32 v88, 1, v8
 v_add_u32 v88, s64, v88
 v_and_b32_e64 v2, 1, v8
 v_mul_u32_u24 v91, 640, v2
 v_mul_u32_u24 v2, 1296, v6
 v_add_u32_e64 v91, v91, v2
 v_add_u32 v91, 97280, v91
 v_lshl_add_u32 v89, v88, 1, v91
 v_subrev_u32 v89, 4, v89
 v_lshlrev_b32 v2, 1, v88
 v_sub_u32_e64 v90, v91, v2
 v_add_u32 v90, 240, v90
 v_cmp_lt_u32 vcc, 41, v88
 s_nop 1
 v_cndmask_b32 v120, v89, v90, vcc
 v_add_u32 v89, 4, v89
 v_subrev_u32 v90, 4, v90
 v_cmp_lt_u32 vcc, 39, v88
 s_nop 1
 v_cndmask_b32 v121, v89, v90, vcc
 v_add_u32 v89, 4, v89
 v_subrev_u32 v90, 4, v90
 v_cmp_lt_u32 vcc, 37, v88
 s_nop 1
 v_cndmask_b32 v122, v89, v90, vcc
 v_add_u32 v89, 4, v89
 v_subrev_u32 v90, 4, v90
 v_cmp_lt_u32 vcc, 35, v88
 s_nop 1
 v_cndmask_b32 v123, v89, v90, vcc
 v_add_u32 v89, 4, v89
 v_subrev_u32 v90, 4, v90
 v_cmp_lt_u32 vcc, 33, v88
 s_nop 1
 v_cndmask_b32 v124, v89, v90, vcc
 v_add_u32 v89, 4, v89
 v_subrev_u32 v90, 4, v90
 v_cmp_lt_u32 vcc, 31, v88
 s_nop 1
 v_cndmask_b32 v125, v89, v90, vcc
 v_add_u32 v89, 4, v89
 v_subrev_u32 v90, 4, v90
 v_cmp_lt_u32 vcc, 29, v88
 s_nop 1
 v_cndmask_b32 v126, v89, v90, vcc
 v_add_u32 v89, 4, v89
 v_subrev_u32 v90, 4, v90
 v_cmp_lt_u32 vcc, 27, v88
 s_nop 1
 v_cndmask_b32 v127, v89, v90, vcc
 v_add_u32 v89, 4, v89
 v_subrev_u32 v90, 4, v90
 v_cmp_lt_u32 vcc, 25, v88
 s_nop 1
 v_cndmask_b32 v128, v89, v90, vcc
 v_add_u32 v89, 4, v89
 v_subrev_u32 v90, 4, v90
 v_cmp_lt_u32 vcc, 23, v88
 s_nop 1
 v_cndmask_b32 v129, v89, v90, vcc
 v_lshrrev_b32_e64 v2, 1, v8
 v_mul_u32_u24 v3, 80, v2
 v_add_u32 v3, v3, v91
 s_cmp_eq_u32 s5, 0
 s_cselect_b64 vcc, -1, 0
 v_cndmask_b32 v120, v120, v3, vcc
 v_mul_u32_u24 v3, 156, v2
 v_add_u32 v3, v3, v91
 v_add_u32 v3, 2, v3
 v_cndmask_b32 v121, v121, v3, vcc
Loa_60:
 s_cmp_eq_u32 s5, 3
 s_cselect_b64 vcc, -1, 0
 v_cndmask_b32 v148, v9, v10, vcc
 s_cmp_ge_u32 s5, 2
 s_cselect_b64 vcc, -1, 0
 v_cndmask_b32_e64 v152, v9, v10, vcc
 v_add_u32 v149, 344064, v148
 v_add_u32 v153, 344064, v152
 v_add_u32 v150, 688128, v148
 v_add_u32 v154, 688128, v152
 v_add_u32 v151, 1032192, v148
 v_add_u32 v155, 1032192, v152
 s_mul_i32 s66, s5, 10
 s_add_u32 s67, s66, 1
 s_sub_u32 s65, s66, 19
 s_cmp_gt_u32 s66, 20
 s_cselect_b32 s66, s65, s66
 s_lshl_b32 s66, s66, 14
 s_add_u32 s66, s66, s62
 s_sub_u32 s65, s67, 19
 s_cmp_gt_u32 s67, 20
 s_cselect_b32 s67, s65, s67
 s_lshl_b32 s67, s67, 14
 s_add_u32 s67, s67, s62
 v_accvgpr_read_b32 v156, a248
 v_accvgpr_read_b32 v157, a249
 v_accvgpr_read_b32 v158, a250
 v_accvgpr_read_b32 v159, a251
 v_accvgpr_read_b32 v160, a252
 v_accvgpr_read_b32 v161, a253
 v_accvgpr_read_b32 v162, a254
 v_accvgpr_read_b32 v163, a255
 s_cmp_eq_u32 s5, 3
 s_cselect_b64 vcc, -1, 0
 v_cndmask_b32 v172, v156, v160, vcc
 v_cndmask_b32 v173, v157, v161, vcc
 v_cndmask_b32 v174, v158, v162, vcc
 v_cndmask_b32 v175, v159, v163, vcc
 s_cmp_ge_u32 s5, 2
 s_cselect_b64 vcc, -1, 0
 v_cndmask_b32 v176, v156, v160, vcc
 v_cndmask_b32 v177, v157, v161, vcc
 v_cndmask_b32 v178, v158, v162, vcc
 v_cndmask_b32 v179, v159, v163, vcc
 v_lshlrev_b32_e64 v80, 16, v12
 v_and_b32 v81, 0xffff0000, v12
 v_lshlrev_b32_e64 v82, 16, v13
 v_and_b32 v83, 0xffff0000, v13
 v_lshlrev_b32_e64 v84, 16, v14
 v_and_b32 v85, 0xffff0000, v14
 v_lshlrev_b32_e64 v86, 16, v15
 v_and_b32 v87, 0xffff0000, v15
 v_lshlrev_b32_e64 v88, 16, v16
 v_and_b32 v89, 0xffff0000, v16
 v_lshlrev_b32_e64 v90, 16, v17
 v_and_b32 v91, 0xffff0000, v17
 v_lshlrev_b32_e64 v92, 16, v18
 v_and_b32 v93, 0xffff0000, v18
 v_lshlrev_b32_e64 v94, 16, v19
 v_and_b32 v95, 0xffff0000, v19
 v_lshlrev_b32_e64 v96, 16, v20
 v_and_b32 v97, 0xffff0000, v20
 v_lshlrev_b32_e64 v98, 16, v21
 v_and_b32 v99, 0xffff0000, v21
 v_lshlrev_b32_e64 v100, 16, v22
 v_and_b32 v101, 0xffff0000, v22
 v_lshlrev_b32_e64 v102, 16, v23
 v_and_b32 v103, 0xffff0000, v23
 v_lshlrev_b32_e64 v104, 16, v24
 v_and_b32 v105, 0xffff0000, v24
 v_lshlrev_b32_e64 v106, 16, v25
 v_and_b32 v107, 0xffff0000, v25
 v_lshlrev_b32_e64 v108, 16, v26
 v_and_b32 v109, 0xffff0000, v26
 v_lshlrev_b32_e64 v110, 16, v27
 v_and_b32 v111, 0xffff0000, v27
 v_lshlrev_b32_e64 v112, 16, v28
 v_and_b32 v113, 0xffff0000, v28
 v_lshlrev_b32_e64 v114, 16, v29
 v_and_b32 v115, 0xffff0000, v29
 v_lshlrev_b32_e64 v116, 16, v30
 v_and_b32 v117, 0xffff0000, v30
 v_lshlrev_b32 v118, 16, v31
 v_and_b32 v119, 0xffff0000, v31
 s_barrier
 s_mov_b32 s39, 262144
Lzq_61:
 buffer_load_dword v74, v72, s[8:11], s62 offen sc1
 buffer_load_dword v75, v73, s[8:11], s62 offen sc1
 s_waitcnt vmcnt(0)
 v_max_u32 v3, v74, v75
 v_cmp_eq_u32 vcc, -1, v3
 s_cbranch_vccz Lzqd_62
 s_sub_u32 s39, s39, 1
 s_cmp_lg_u32 s39, 0
 s_cbranch_scc1 Lzq_61
Lzqd_62:
 s_mov_b32 s39, 65536
Lzp_63:
 buffer_load_dword v32, v148, s[8:11], s66 offen sc1
 buffer_load_dword v33, v149, s[8:11], s66 offen sc1
 buffer_load_dword v34, v150, s[8:11], s66 offen sc1
 buffer_load_dword v35, v151, s[8:11], s66 offen sc1
 s_mov_b32 s65, s67
 buffer_load_dword v36, v152, s[8:11], s65 offen sc1
 buffer_load_dword v37, v153, s[8:11], s65 offen sc1
 buffer_load_dword v38, v154, s[8:11], s65 offen sc1
 buffer_load_dword v39, v155, s[8:11], s65 offen sc1
 s_add_u32 s65, s65, 16384
 buffer_load_dword v40, v152, s[8:11], s65 offen sc1
 buffer_load_dword v41, v153, s[8:11], s65 offen sc1
 buffer_load_dword v42, v154, s[8:11], s65 offen sc1
 buffer_load_dword v43, v155, s[8:11], s65 offen sc1
 s_add_u32 s65, s65, 16384
 buffer_load_dword v44, v152, s[8:11], s65 offen sc1
 buffer_load_dword v45, v153, s[8:11], s65 offen sc1
 buffer_load_dword v46, v154, s[8:11], s65 offen sc1
 buffer_load_dword v47, v155, s[8:11], s65 offen sc1
 s_add_u32 s65, s65, 16384
 buffer_load_dword v48, v152, s[8:11], s65 offen sc1
 buffer_load_dword v49, v153, s[8:11], s65 offen sc1
 buffer_load_dword v50, v154, s[8:11], s65 offen sc1
 buffer_load_dword v51, v155, s[8:11], s65 offen sc1
 s_add_u32 s65, s65, 16384
 buffer_load_dword v52, v152, s[8:11], s65 offen sc1
 buffer_load_dword v53, v153, s[8:11], s65 offen sc1
 buffer_load_dword v54, v154, s[8:11], s65 offen sc1
 buffer_load_dword v55, v155, s[8:11], s65 offen sc1
 s_add_u32 s65, s65, 16384
 buffer_load_dword v56, v152, s[8:11], s65 offen sc1
 buffer_load_dword v57, v153, s[8:11], s65 offen sc1
 buffer_load_dword v58, v154, s[8:11], s65 offen sc1
 buffer_load_dword v59, v155, s[8:11], s65 offen sc1
 s_add_u32 s65, s65, 16384
 buffer_load_dword v60, v152, s[8:11], s65 offen sc1
 buffer_load_dword v61, v153, s[8:11], s65 offen sc1
 buffer_load_dword v62, v154, s[8:11], s65 offen sc1
 buffer_load_dword v63, v155, s[8:11], s65 offen sc1
 s_add_u32 s65, s65, 16384
 buffer_load_dword v64, v152, s[8:11], s65 offen sc1
 buffer_load_dword v65, v153, s[8:11], s65 offen sc1
 buffer_load_dword v66, v154, s[8:11], s65 offen sc1
 buffer_load_dword v67, v155, s[8:11], s65 offen sc1
 s_add_u32 s65, s65, 16384
 buffer_load_dword v68, v152, s[8:11], s65 offen sc1
 buffer_load_dword v69, v153, s[8:11], s65 offen sc1
 buffer_load_dword v70, v154, s[8:11], s65 offen sc1
 buffer_load_dword v71, v155, s[8:11], s65 offen sc1
 s_waitcnt vmcnt(0)
 v_max3_u32 v3, v32, v33, v34
 v_max3_u32 v3, v3, v35, v36
 v_max3_u32 v3, v3, v37, v38
 v_max3_u32 v3, v3, v39, v40
 v_max3_u32 v3, v3, v41, v42
 v_max3_u32 v3, v3, v43, v44
 v_max3_u32 v3, v3, v45, v46
 v_max3_u32 v3, v3, v47, v48
 v_max3_u32 v3, v3, v49, v50
 v_max3_u32 v3, v3, v51, v52
 v_max3_u32 v3, v3, v53, v54
 v_max3_u32 v3, v3, v55, v56
 v_max3_u32 v3, v3, v57, v58
 v_max3_u32 v3, v3, v59, v60
 v_max3_u32 v3, v3, v61, v62
 v_max3_u32 v3, v3, v63, v64
 v_max3_u32 v3, v3, v65, v66
 v_max3_u32 v3, v3, v67, v68
 v_max3_u32 v3, v3, v69, v70
 v_max_u32 v3, v3, v71
 v_cmp_eq_u32_e64 vcc, -1, v3
 s_cbranch_vccz Lzd_64
 s_sub_u32 s39, s39, 1
 s_cmp_lg_u32 s39, 0
 s_cbranch_scc1 Lzp_63
Lzd_64:
 s_cmp_lg_u32 s4, 15
 s_cbranch_scc1 Lwb_65
 s_cmp_lg_u32 s42, 1
 s_cbranch_scc1 Lwb_65
 s_cmp_lg_u32 s5, 3
 s_cbranch_scc1 Lwb_65
 buffer_wbl2 sc1
Lwb_65:
 v_mfma_f32_16x16x32_bf16 v[80:83], v[32:35], v[172:175], v[80:83]
 v_mfma_f32_16x16x32_bf16 v[84:87], v[36:39], v[176:179], v[84:87]
 v_mfma_f32_16x16x32_bf16 v[88:91], v[40:43], v[176:179], v[88:91]
 v_mfma_f32_16x16x32_bf16 v[92:95], v[44:47], v[176:179], v[92:95]
 v_mfma_f32_16x16x32_bf16 v[96:99], v[48:51], v[176:179], v[96:99]
 v_mfma_f32_16x16x32_bf16 v[100:103], v[52:55], v[176:179], v[100:103]
 v_mfma_f32_16x16x32_bf16 v[104:107], v[56:59], v[176:179], v[104:107]
 v_mfma_f32_16x16x32_bf16 v[108:111], v[60:63], v[176:179], v[108:111]
 v_mfma_f32_16x16x32_bf16 v[112:115], v[64:67], v[176:179], v[112:115]
 v_mfma_f32_16x16x32_bf16 v[116:119], v[68:71], v[176:179], v[116:119]
 v_cvt_pk_bf16_f32 v32, v80, v81
 v_cvt_pk_bf16_f32 v33, v82, v83
 v_cvt_pk_bf16_f32 v34, v84, v85
 v_cvt_pk_bf16_f32 v35, v86, v87
 v_cvt_pk_bf16_f32 v36, v88, v89
 v_cvt_pk_bf16_f32 v37, v90, v91
 v_cvt_pk_bf16_f32 v38, v92, v93
 v_cvt_pk_bf16_f32 v39, v94, v95
 v_cvt_pk_bf16_f32 v40, v96, v97
 v_cvt_pk_bf16_f32 v41, v98, v99
 v_cvt_pk_bf16_f32 v42, v100, v101
 v_cvt_pk_bf16_f32 v43, v102, v103
 v_cvt_pk_bf16_f32 v44, v104, v105
 v_cvt_pk_bf16_f32 v45, v106, v107
 v_cvt_pk_bf16_f32 v46, v108, v109
 v_cvt_pk_bf16_f32 v47, v110, v111
 v_cvt_pk_bf16_f32 v48, v112, v113
 v_cvt_pk_bf16_f32 v49, v114, v115
 v_cvt_pk_bf16_f32 v50, v116, v117
 v_cvt_pk_bf16_f32 v51, v118, v119
 s_cmp_lg_u32 s42, 0
 s_cbranch_scc1 Lb2last_66
 v_pk_add_f32 v[134:135], v[80:81], v[82:83]
 v_pk_mul_f32 v[156:157], v[80:81], v[80:81]
 v_pk_fma_f32 v[156:157], v[82:83], v[82:83], v[156:157]
 v_pk_add_f32 v[134:135], v[134:135], v[84:85]
 v_pk_fma_f32 v[156:157], v[84:85], v[84:85], v[156:157]
 v_pk_add_f32 v[134:135], v[134:135], v[86:87]
 v_pk_fma_f32 v[156:157], v[86:87], v[86:87], v[156:157]
 v_pk_add_f32 v[134:135], v[134:135], v[88:89]
 v_pk_fma_f32 v[156:157], v[88:89], v[88:89], v[156:157]
 v_pk_add_f32 v[134:135], v[134:135], v[90:91]
 v_pk_fma_f32 v[156:157], v[90:91], v[90:91], v[156:157]
 v_pk_add_f32 v[134:135], v[134:135], v[92:93]
 v_pk_fma_f32 v[156:157], v[92:93], v[92:93], v[156:157]
 v_pk_add_f32 v[134:135], v[134:135], v[94:95]
 v_pk_fma_f32 v[156:157], v[94:95], v[94:95], v[156:157]
 v_pk_add_f32 v[134:135], v[134:135], v[96:97]
 v_pk_fma_f32 v[156:157], v[96:97], v[96:97], v[156:157]
 v_pk_add_f32 v[134:135], v[134:135], v[98:99]
 v_pk_fma_f32 v[156:157], v[98:99], v[98:99], v[156:157]
 v_pk_add_f32 v[134:135], v[134:135], v[100:101]
 v_pk_fma_f32 v[156:157], v[100:101], v[100:101], v[156:157]
 v_pk_add_f32 v[134:135], v[134:135], v[102:103]
 v_pk_fma_f32 v[156:157], v[102:103], v[102:103], v[156:157]
 v_pk_add_f32 v[134:135], v[134:135], v[104:105]
 v_pk_fma_f32 v[156:157], v[104:105], v[104:105], v[156:157]
 v_pk_add_f32 v[134:135], v[134:135], v[106:107]
 v_pk_fma_f32 v[156:157], v[106:107], v[106:107], v[156:157]
 v_pk_add_f32 v[134:135], v[134:135], v[108:109]
 v_pk_fma_f32 v[156:157], v[108:109], v[108:109], v[156:157]
 v_pk_add_f32 v[134:135], v[134:135], v[110:111]
 v_pk_fma_f32 v[156:157], v[110:111], v[110:111], v[156:157]
 v_pk_add_f32 v[134:135], v[134:135], v[112:113]
 v_pk_fma_f32 v[156:157], v[112:113], v[112:113], v[156:157]
 v_pk_add_f32 v[134:135], v[134:135], v[114:115]
 v_pk_fma_f32 v[156:157], v[114:115], v[114:115], v[156:157]
 v_pk_add_f32 v[134:135], v[134:135], v[116:117]
 v_pk_fma_f32 v[156:157], v[116:117], v[116:117], v[156:157]
 v_pk_add_f32 v[134:135], v[134:135], v[118:119]
 v_pk_fma_f32 v[156:157], v[118:119], v[118:119], v[156:157]
 v_add_f32 v134, v134, v135
 v_add_f32 v135, v156, v157
 v_mov_b32 v2, v134
 s_nop 1
 v_permlane16_swap_b32 v2, v134
 v_add_f32 v134, v134, v2
 v_mov_b32 v2, v134
 s_nop 1
 v_permlane32_swap_b32 v2, v134
 v_add_f32 v134, v134, v2
 v_mov_b32 v2, v135
 s_nop 1
 v_permlane16_swap_b32 v2, v135
 v_add_f32 v135, v135, v2
 v_mov_b32_e64 v2, v135
 s_nop 1
 v_permlane32_swap_b32 v2, v135
 v_add_f32 v135, v135, v2
 s_lshl_b32 s46, s5, 7
 s_add_u32 s46, s46, 117760
 v_lshlrev_b32_e64 v3, 3, v6
 v_add_u32 v2, s46, v3
 ds_write_b64 v2, v[134:135]
 s_waitcnt lgkmcnt(0)
 s_barrier
 v_add_u32 v3, 117760, v3
 ds_read_b64 v[52:53], v3 offset:0
 ds_read_b64 v[54:55], v3 offset:128
 ds_read_b64 v[56:57], v3 offset:256
 ds_read_b64 v[58:59], v3 offset:384
 s_waitcnt lgkmcnt(0)
 v_pk_add_f32 v[52:53], v[52:53], v[54:55]
 v_pk_add_f32 v[56:57], v[56:57], v[58:59]
 v_pk_add_f32 v[134:135], v[52:53], v[56:57]
 v_mul_f32 v134, 0x3acccccd, v134
 v_mul_f32 v135, 0x3acccccd, v135
 v_fma_f32 v156, -v134, v134, v135
 v_add_f32 v156, 0x3727c5ac, v156
 v_rsq_f32 v156, v156
 s_nop 0
 v_mul_f32_e64 v134, -v134, v156
 v_pk_fma_f32 v[80:81], v[80:81], v[156:157], v[134:135] op_sel_hi:[1,0,0]
 v_pk_fma_f32 v[82:83], v[82:83], v[156:157], v[134:135] op_sel_hi:[1,0,0]
 v_pk_fma_f32 v[84:85], v[84:85], v[156:157], v[134:135] op_sel_hi:[1,0,0]
 v_pk_fma_f32 v[86:87], v[86:87], v[156:157], v[134:135] op_sel_hi:[1,0,0]
 v_pk_fma_f32 v[88:89], v[88:89], v[156:157], v[134:135] op_sel_hi:[1,0,0]
 v_pk_fma_f32 v[90:91], v[90:91], v[156:157], v[134:135] op_sel_hi:[1,0,0]
 v_pk_fma_f32 v[92:93], v[92:93], v[156:157], v[134:135] op_sel_hi:[1,0,0]
 v_pk_fma_f32 v[94:95], v[94:95], v[156:157], v[134:135] op_sel_hi:[1,0,0]
 v_pk_fma_f32 v[96:97], v[96:97], v[156:157], v[134:135] op_sel_hi:[1,0,0]
 v_pk_fma_f32 v[98:99], v[98:99], v[156:157], v[134:135] op_sel_hi:[1,0,0]
 v_pk_fma_f32 v[100:101], v[100:101], v[156:157], v[134:135] op_sel_hi:[1,0,0]
 v_pk_fma_f32 v[102:103], v[102:103], v[156:157], v[134:135] op_sel_hi:[1,0,0]
 v_pk_fma_f32 v[104:105], v[104:105], v[156:157], v[134:135] op_sel_hi:[1,0,0]
 v_pk_fma_f32 v[106:107], v[106:107], v[156:157], v[134:135] op_sel_hi:[1,0,0]
 v_pk_fma_f32 v[108:109], v[108:109], v[156:157], v[134:135] op_sel_hi:[1,0,0]
 v_pk_fma_f32 v[110:111], v[110:111], v[156:157], v[134:135] op_sel_hi:[1,0,0]
 v_pk_fma_f32 v[112:113], v[112:113], v[156:157], v[134:135] op_sel_hi:[1,0,0]
 v_pk_fma_f32 v[114:115], v[114:115], v[156:157], v[134:135] op_sel_hi:[1,0,0]
 v_pk_fma_f32 v[116:117], v[116:117], v[156:157], v[134:135] op_sel_hi:[1,0,0]
 v_pk_fma_f32 v[118:119], v[118:119], v[156:157], v[134:135] op_sel_hi:[1,0,0]
 v_cvt_pk_bf16_f32 v60, v80, v81
 v_cvt_pk_bf16_f32 v61, v82, v83
 v_cvt_pk_bf16_f32 v62, v84, v85
 v_cvt_pk_bf16_f32 v63, v86, v87
 v_cvt_pk_bf16_f32 v64, v88, v89
 v_cvt_pk_bf16_f32 v65, v90, v91
 v_cvt_pk_bf16_f32 v66, v92, v93
 v_cvt_pk_bf16_f32 v67, v94, v95
 v_cvt_pk_bf16_f32 v68, v96, v97
 v_cvt_pk_bf16_f32 v69, v98, v99
 v_cvt_pk_bf16_f32 v70, v100, v101
 v_cvt_pk_bf16_f32 v71, v102, v103
 v_cvt_pk_bf16_f32 v72, v104, v105
 v_cvt_pk_bf16_f32 v73, v106, v107
 v_cvt_pk_bf16_f32 v74, v108, v109
 v_cvt_pk_bf16_f32 v75, v110, v111
 v_cvt_pk_bf16_f32 v76, v112, v113
 v_cvt_pk_bf16_f32 v77, v114, v115
 v_cvt_pk_bf16_f32 v78, v116, v117
 v_cvt_pk_bf16_f32 v79, v118, v119
 s_mov_b32 s46, 3670016
 v_permlane16_swap_b32 v60, v62
 v_permlane16_swap_b32 v61, v63
 buffer_store_dwordx4 v[60:63], v11, s[8:11], s46 offen
 s_add_u32 s46, s46, 2048
 v_permlane16_swap_b32 v64, v66
 v_permlane16_swap_b32 v65, v67
 buffer_store_dwordx4 v[64:67], v11, s[8:11], s46 offen
 s_add_u32 s46, s46, 2048
 v_permlane16_swap_b32 v68, v70
 v_permlane16_swap_b32 v69, v71
 buffer_store_dwordx4 v[68:71], v11, s[8:11], s46 offen
 s_add_u32 s46, s46, 2048
 v_permlane16_swap_b32 v72, v74
 v_permlane16_swap_b32 v73, v75
 buffer_store_dwordx4 v[72:75], v11, s[8:11], s46 offen
 s_add_u32 s46, s46, 2048
 v_permlane16_swap_b32 v76, v78
 v_permlane16_swap_b32 v77, v79
 buffer_store_dwordx4 v[76:79], v11, s[8:11], s46 offen
 s_add_u32 s46, s46, 2048
 s_mov_b32 s46, 1048576
 v_permlane16_swap_b32 v32, v34
 v_permlane16_swap_b32 v33, v35
 buffer_store_dwordx4 v[32:35], v11, s[8:11], s46 offen
 s_add_u32 s46, s46, 2048
 v_permlane16_swap_b32 v36, v38
 v_permlane16_swap_b32 v37, v39
 buffer_store_dwordx4 v[36:39], v11, s[8:11], s46 offen
 s_add_u32 s46, s46, 2048
 v_permlane16_swap_b32 v40, v42
 v_permlane16_swap_b32 v41, v43
 buffer_store_dwordx4 v[40:43], v11, s[8:11], s46 offen
 s_add_u32 s46, s46, 2048
 v_permlane16_swap_b32 v44, v46
 v_permlane16_swap_b32 v45, v47
 buffer_store_dwordx4 v[44:47], v11, s[8:11], s46 offen
 s_add_u32 s46, s46, 2048
 v_permlane16_swap_b32 v48, v50
 v_permlane16_swap_b32 v49, v51
 buffer_store_dwordx4 v[48:51], v11, s[8:11], s46 offen
 s_add_u32 s46, s46, 2048
 s_branch Lb2join_67
Lb2last_66:
 ds_write_b16 v120, v32
 ds_write_b16_d16_hi v120, v32 offset:160
 ds_write_b16 v120, v33 offset:320
 ds_write_b16_d16_hi v120, v33 offset:480
 ds_write_b16 v121, v34
 ds_write_b16_d16_hi v121, v34 offset:160
 ds_write_b16 v121, v35 offset:320
 ds_write_b16_d16_hi v121, v35 offset:480
 ds_write_b16 v122, v36
 ds_write_b16_d16_hi v122, v36 offset:160
 ds_write_b16 v122, v37 offset:320
 ds_write_b16_d16_hi v122, v37 offset:480
 ds_write_b16 v123, v38
 ds_write_b16_d16_hi v123, v38 offset:160
 ds_write_b16 v123, v39 offset:320
 ds_write_b16_d16_hi v123, v39 offset:480
 ds_write_b16 v124, v40
 ds_write_b16_d16_hi v124, v40 offset:160
 ds_write_b16 v124, v41 offset:320
 ds_write_b16_d16_hi v124, v41 offset:480
 ds_write_b16 v125, v42
 ds_write_b16_d16_hi v125, v42 offset:160
 ds_write_b16 v125, v43 offset:320
 ds_write_b16_d16_hi v125, v43 offset:480
 ds_write_b16 v126, v44
 ds_write_b16_d16_hi v126, v44 offset:160
 ds_write_b16 v126, v45 offset:320
 ds_write_b16_d16_hi v126, v45 offset:480
 ds_write_b16 v127, v46
 ds_write_b16_d16_hi v127, v46 offset:160
 ds_write_b16 v127, v47 offset:320
 ds_write_b16_d16_hi v127, v47 offset:480
 ds_write_b16 v128, v48
 ds_write_b16_d16_hi v128, v48 offset:160
 ds_write_b16 v128, v49 offset:320
 ds_write_b16_d16_hi v128, v49 offset:480
 ds_write_b16 v129, v50
 ds_write_b16_d16_hi v129, v50 offset:160
 ds_write_b16 v129, v51 offset:320
 ds_write_b16_d16_hi v129, v51 offset:480
 s_waitcnt lgkmcnt(0)
 s_barrier
 s_mov_b32 s12, s24
 s_and_b32 s13, s25, 0xffff
 s_mov_b32 s14, 2621440
 s_mov_b32 s15, 0x20000
 v_lshrrev_b32 v2, 4, v0
 v_and_b32 v3, 15, v0
 v_mul_u32_u24 v105, 1296, v2
 v_lshl_add_u32 v105, v3, 4, v105
 v_add_u32 v105, 97280, v105
 s_lshl_b32 s46, s4, 3
 s_add_u32 s46, s46, s3
 v_lshlrev_b32 v2, 7, v2
 v_add_u32 v2, s46, v2
 v_mul_u32_u24 v104, 1280, v2
 v_lshl_add_u32 v104, v3, 4, v104
 ds_read_b128 v[84:87], v105 offset:0
 ds_read_b128 v[88:91], v105 offset:256
 ds_read_b128 v[92:95], v105 offset:512
 ds_read_b128 v[96:99], v105 offset:768
 ds_read_b128 v[100:103], v105 offset:1024
 s_waitcnt lgkmcnt(0)
 buffer_store_dwordx4 v[84:87], v104, s[12:15], 0 offen offset:0 sc1
 buffer_store_dwordx4 v[88:91], v104, s[12:15], 0 offen offset:256 sc1
 buffer_store_dwordx4 v[92:95], v104, s[12:15], 0 offen offset:512 sc1
 buffer_store_dwordx4 v[96:99], v104, s[12:15], 0 offen offset:768 sc1
 buffer_store_dwordx4 v[100:103], v104, s[12:15], 0 offen offset:1024 sc1
Lb2join_67:
Lb2d_58:
 s_cmp_lg_u32 s42, 0
 s_cbranch_scc1 Lfin_68
 s_waitcnt vmcnt(5) lgkmcnt(0)
 s_barrier
 s_add_u32 s40, s40, 1
 s_cmp_lg_u32 s5, 0
 s_cbranch_scc1 Llb_69
 v_mov_b32_e64 v3, s40
 s_mov_b64 s[6:7], exec
 s_mov_b64 exec, 1
 buffer_store_dword v3, v4, s[8:11], 0 offen
 s_mov_b64 exec, s[6:7]
 s_mov_b32 s39, 4194304
Lpoll_70:
 buffer_load_dword v2, v5, s[8:11], 0 offen sc1
 s_waitcnt vmcnt(0)
 v_cmp_gt_u32 vcc, s40, v2
 s_cbranch_vccz Lpdone_71
 s_sub_u32 s39, s39, 1
 s_cmp_lg_u32 s39, 0
 s_cbranch_scc1 Lpoll_70
Lpdone_71:
Llb_69:
 s_barrier
 s_mov_b32 s42, 1
 s_branch Llayer_23
Lfin_68:
 s_waitcnt vmcnt(0) lgkmcnt(0)
 s_endpgm
Lentry_slow:
 s_mov_b32 s42, 0
Llayer_72:
 s_mul_i32 s43, s42, 0
 s_add_u32 s43, s43, 3670016
 s_mul_i32 s56, s42, 0
 s_add_u32 s56, s56, 1048576
 s_mul_i32 s57, s42, 524288
 s_add_u32 s57, s57, 14548992
 s_mul_i32 s58, s42, 0
 s_add_u32 s58, s58, 6291456
 s_mul_i32 s59, s42, 0
 s_add_u32 s59, s59, 1048576
 s_mul_i32 s60, s42, 0
 s_add_u32 s60, s60, 3670016
 s_mul_i32 s61, s42, 0
 s_add_u32 s61, s61, 6619136
 s_mul_i32 s62, s42, 2752512
 s_add_u32 s62, s62, 9043968
 s_mov_b32 s64, s26
 s_and_b32 s65, s27, 0xffff
 s_mov_b32 s66, 256
 s_mov_b32 s67, 0x20000
 s_mul_i32 s63, s3, 327680
 s_mul_i32 s44, s5, 81920
 s_add_u32 s63, s63, s44
 s_add_u32 s63, s63, s43
 ds_read_b64_tr_b16 v[112:113], v144 offset:0
 ds_read_b64_tr_b16 v[114:115], v144 offset:512
 ds_read_b64_tr_b16 v[116:117], v146 offset:0
 ds_read_b64_tr_b16 v[118:119], v146 offset:512
 ds_read_b64_tr_b16 v[120:121], v144 offset:2048
 ds_read_b64_tr_b16 v[122:123], v144 offset:2560
 ds_read_b64_tr_b16 v[124:125], v146 offset:2048
 ds_read_b64_tr_b16 v[126:127], v146 offset:2560
 buffer_load_dwordx4 v[8:11], v7, s[8:11], s63 offen offset:0 sc1
 buffer_load_dwordx4 v[12:15], v7, s[8:11], s63 offen offset:1024 sc1
 buffer_load_dwordx4 v[16:19], v7, s[8:11], s63 offen offset:2048 sc1
 buffer_load_dwordx4 v[20:23], v7, s[8:11], s63 offen offset:3072 sc1
 s_add_u32 s63, s63, 4096
 buffer_load_dwordx4 v[24:27], v7, s[8:11], s63 offen offset:0 sc1
 buffer_load_dwordx4 v[28:31], v7, s[8:11], s63 offen offset:1024 sc1
 buffer_load_dwordx4 v[32:35], v7, s[8:11], s63 offen offset:2048 sc1
 buffer_load_dwordx4 v[36:39], v7, s[8:11], s63 offen offset:3072 sc1
 s_add_u32 s63, s63, 4096
 buffer_load_dwordx4 v[40:43], v7, s[8:11], s63 offen offset:0 sc1
 buffer_load_dwordx4 v[44:47], v7, s[8:11], s63 offen offset:1024 sc1
 s_waitcnt vmcnt(9) lgkmcnt(4)
 v_mfma_f32_32x32x16_bf16 v[48:63], v[112:115], v[8:11], 0
 ds_read_b64_tr_b16 v[128:129], v144 offset:4096
 ds_read_b64_tr_b16 v[130:131], v144 offset:4608
 v_mfma_f32_32x32x16_bf16 v[64:79], v[116:119], v[8:11], 0
 ds_read_b64_tr_b16 v[132:133], v146 offset:4096
 ds_read_b64_tr_b16 v[134:135], v146 offset:4608
 s_waitcnt vmcnt(8) lgkmcnt(4)
 v_mfma_f32_32x32x16_bf16 v[48:63], v[120:123], v[12:15], v[48:63]
 ds_read_b64_tr_b16 v[112:113], v144 offset:6144
 ds_read_b64_tr_b16 v[114:115], v144 offset:6656
 buffer_load_dwordx4 v[8:11], v7, s[8:11], s63 offen offset:2048 sc1
 v_mfma_f32_32x32x16_bf16 v[64:79], v[124:127], v[12:15], v[64:79]
 ds_read_b64_tr_b16 v[116:117], v146 offset:6144
 ds_read_b64_tr_b16 v[118:119], v146 offset:6656
 s_waitcnt vmcnt(8) lgkmcnt(4)
 v_mfma_f32_32x32x16_bf16 v[48:63], v[128:131], v[16:19], v[48:63]
 ds_read_b64_tr_b16 v[120:121], v144 offset:8192
 ds_read_b64_tr_b16 v[122:123], v144 offset:8704
 buffer_load_dwordx4 v[12:15], v7, s[8:11], s63 offen offset:3072 sc1
 v_mfma_f32_32x32x16_bf16 v[64:79], v[132:135], v[16:19], v[64:79]
 ds_read_b64_tr_b16 v[124:125], v146 offset:8192
 ds_read_b64_tr_b16 v[126:127], v146 offset:8704
 s_waitcnt vmcnt(8) lgkmcnt(4)
 v_mfma_f32_32x32x16_bf16 v[48:63], v[112:115], v[20:23], v[48:63]
 ds_read_b64_tr_b16 v[128:129], v144 offset:10240
 ds_read_b64_tr_b16 v[130:131], v144 offset:10752
 s_add_u32 s63, s63, 4096
 buffer_load_dwordx4 v[16:19], v7, s[8:11], s63 offen offset:0 sc1
 v_mfma_f32_32x32x16_bf16 v[64:79], v[116:119], v[20:23], v[64:79]
 ds_read_b64_tr_b16 v[132:133], v146 offset:10240
 ds_read_b64_tr_b16 v[134:135], v146 offset:10752
 s_waitcnt vmcnt(8) lgkmcnt(4)
 v_mfma_f32_32x32x16_bf16 v[48:63], v[120:123], v[24:27], v[48:63]
 ds_read_b64_tr_b16 v[112:113], v144 offset:12288
 ds_read_b64_tr_b16 v[114:115], v144 offset:12800
 buffer_load_dwordx4 v[20:23], v7, s[8:11], s63 offen offset:1024 sc1
 v_mfma_f32_32x32x16_bf16 v[64:79], v[124:127], v[24:27], v[64:79]
 ds_read_b64_tr_b16 v[116:117], v146 offset:12288
 ds_read_b64_tr_b16 v[118:119], v146 offset:12800
 s_waitcnt vmcnt(8) lgkmcnt(4)
 v_mfma_f32_32x32x16_bf16 v[48:63], v[128:131], v[28:31], v[48:63]
 ds_read_b64_tr_b16 v[120:121], v144 offset:14336
 ds_read_b64_tr_b16 v[122:123], v144 offset:14848
 buffer_load_dwordx4 v[24:27], v7, s[8:11], s63 offen offset:2048 sc1
 v_mfma_f32_32x32x16_bf16 v[64:79], v[132:135], v[28:31], v[64:79]
 ds_read_b64_tr_b16 v[124:125], v146 offset:14336
 ds_read_b64_tr_b16 v[126:127], v146 offset:14848
 s_waitcnt vmcnt(8) lgkmcnt(4)
 v_mfma_f32_32x32x16_bf16 v[48:63], v[112:115], v[32:35], v[48:63]
 ds_read_b64_tr_b16 v[128:129], v144 offset:16384
 ds_read_b64_tr_b16 v[130:131], v144 offset:16896
 buffer_load_dwordx4 v[28:31], v7, s[8:11], s63 offen offset:3072 sc1
 v_mfma_f32_32x32x16_bf16 v[64:79], v[116:119], v[32:35], v[64:79]
 ds_read_b64_tr_b16 v[132:133], v146 offset:16384
 ds_read_b64_tr_b16 v[134:135], v146 offset:16896
 s_waitcnt vmcnt(8) lgkmcnt(4)
 v_mfma_f32_32x32x16_bf16 v[48:63], v[120:123], v[36:39], v[48:63]
 ds_read_b64_tr_b16 v[112:113], v144 offset:18432
 ds_read_b64_tr_b16 v[114:115], v144 offset:18944
 s_add_u32 s63, s63, 4096
 buffer_load_dwordx4 v[32:35], v7, s[8:11], s63 offen offset:0 sc1
 v_mfma_f32_32x32x16_bf16 v[64:79], v[124:127], v[36:39], v[64:79]
 ds_read_b64_tr_b16 v[116:117], v146 offset:18432
 ds_read_b64_tr_b16 v[118:119], v146 offset:18944
 s_waitcnt vmcnt(8) lgkmcnt(4)
 v_mfma_f32_32x32x16_bf16 v[48:63], v[128:131], v[40:43], v[48:63]
 ds_read_b64_tr_b16 v[120:121], v144 offset:20480
 ds_read_b64_tr_b16 v[122:123], v144 offset:20992
 buffer_load_dwordx4 v[36:39], v7, s[8:11], s63 offen offset:1024 sc1
 v_mfma_f32_32x32x16_bf16 v[64:79], v[132:135], v[40:43], v[64:79]
 ds_read_b64_tr_b16 v[124:125], v146 offset:20480
 ds_read_b64_tr_b16 v[126:127], v146 offset:20992
 s_waitcnt vmcnt(8) lgkmcnt(4)
 v_mfma_f32_32x32x16_bf16 v[48:63], v[112:115], v[44:47], v[48:63]
 ds_read_b64_tr_b16 v[128:129], v144 offset:22528
 ds_read_b64_tr_b16 v[130:131], v144 offset:23040
 buffer_load_dwordx4 v[40:43], v7, s[8:11], s63 offen offset:2048 sc1
 v_mfma_f32_32x32x16_bf16 v[64:79], v[116:119], v[44:47], v[64:79]
 ds_read_b64_tr_b16 v[132:133], v146 offset:22528
 ds_read_b64_tr_b16 v[134:135], v146 offset:23040
 s_waitcnt vmcnt(8) lgkmcnt(4)
 v_mfma_f32_32x32x16_bf16 v[48:63], v[120:123], v[8:11], v[48:63]
 ds_read_b64_tr_b16 v[112:113], v144 offset:24576
 ds_read_b64_tr_b16 v[114:115], v144 offset:25088
 buffer_load_dwordx4 v[44:47], v7, s[8:11], s63 offen offset:3072 sc1
 v_mfma_f32_32x32x16_bf16 v[64:79], v[124:127], v[8:11], v[64:79]
 ds_read_b64_tr_b16 v[116:117], v146 offset:24576
 ds_read_b64_tr_b16 v[118:119], v146 offset:25088
 s_waitcnt vmcnt(8) lgkmcnt(4)
 v_mfma_f32_32x32x16_bf16 v[48:63], v[128:131], v[12:15], v[48:63]
 ds_read_b64_tr_b16 v[120:121], v144 offset:26624
 ds_read_b64_tr_b16 v[122:123], v144 offset:27136
 s_add_u32 s63, s63, 4096
 buffer_load_dwordx4 v[8:11], v7, s[8:11], s63 offen offset:0 sc1
 v_mfma_f32_32x32x16_bf16 v[64:79], v[132:135], v[12:15], v[64:79]
 ds_read_b64_tr_b16 v[124:125], v146 offset:26624
 ds_read_b64_tr_b16 v[126:127], v146 offset:27136
 s_waitcnt vmcnt(8) lgkmcnt(4)
 v_mfma_f32_32x32x16_bf16 v[48:63], v[112:115], v[16:19], v[48:63]
 ds_read_b64_tr_b16 v[128:129], v144 offset:28672
 ds_read_b64_tr_b16 v[130:131], v144 offset:29184
 buffer_load_dwordx4 v[12:15], v7, s[8:11], s63 offen offset:1024 sc1
 v_mfma_f32_32x32x16_bf16 v[64:79], v[116:119], v[16:19], v[64:79]
 ds_read_b64_tr_b16 v[132:133], v146 offset:28672
 ds_read_b64_tr_b16 v[134:135], v146 offset:29184
 s_waitcnt vmcnt(8) lgkmcnt(4)
 v_mfma_f32_32x32x16_bf16 v[48:63], v[120:123], v[20:23], v[48:63]
 ds_read_b64_tr_b16 v[112:113], v144 offset:30720
 ds_read_b64_tr_b16 v[114:115], v144 offset:31232
 buffer_load_dwordx4 v[16:19], v7, s[8:11], s63 offen offset:2048 sc1
 v_mfma_f32_32x32x16_bf16 v[64:79], v[124:127], v[20:23], v[64:79]
 ds_read_b64_tr_b16 v[116:117], v146 offset:30720
 ds_read_b64_tr_b16 v[118:119], v146 offset:31232
 s_waitcnt vmcnt(8) lgkmcnt(4)
 v_mfma_f32_32x32x16_bf16 v[48:63], v[128:131], v[24:27], v[48:63]
 ds_read_b64_tr_b16 v[120:121], v144 offset:32768
 ds_read_b64_tr_b16 v[122:123], v144 offset:33280
 buffer_load_dwordx4 v[20:23], v7, s[8:11], s63 offen offset:3072 sc1
 v_mfma_f32_32x32x16_bf16 v[64:79], v[132:135], v[24:27], v[64:79]
 ds_read_b64_tr_b16 v[124:125], v146 offset:32768
 ds_read_b64_tr_b16 v[126:127], v146 offset:33280
 s_waitcnt vmcnt(8) lgkmcnt(4)
 v_mfma_f32_32x32x16_bf16 v[48:63], v[112:115], v[28:31], v[48:63]
 ds_read_b64_tr_b16 v[128:129], v144 offset:34816
 ds_read_b64_tr_b16 v[130:131], v144 offset:35328
 s_add_u32 s63, s63, 4096
 buffer_load_dwordx4 v[24:27], v7, s[8:11], s63 offen offset:0 sc1
 v_mfma_f32_32x32x16_bf16 v[64:79], v[116:119], v[28:31], v[64:79]
 ds_read_b64_tr_b16 v[132:133], v146 offset:34816
 ds_read_b64_tr_b16 v[134:135], v146 offset:35328
 s_waitcnt vmcnt(8) lgkmcnt(4)
 v_mfma_f32_32x32x16_bf16 v[48:63], v[120:123], v[32:35], v[48:63]
 ds_read_b64_tr_b16 v[112:113], v144 offset:36864
 ds_read_b64_tr_b16 v[114:115], v144 offset:37376
 buffer_load_dwordx4 v[28:31], v7, s[8:11], s63 offen offset:1024 sc1
 v_mfma_f32_32x32x16_bf16 v[64:79], v[124:127], v[32:35], v[64:79]
 ds_read_b64_tr_b16 v[116:117], v146 offset:36864
 ds_read_b64_tr_b16 v[118:119], v146 offset:37376
 s_waitcnt vmcnt(8) lgkmcnt(4)
 v_mfma_f32_32x32x16_bf16 v[48:63], v[128:131], v[36:39], v[48:63]
 ds_read_b64_tr_b16 v[120:121], v144 offset:38912
 ds_read_b64_tr_b16 v[122:123], v144 offset:39424
 buffer_load_dwordx4 v[32:35], v7, s[8:11], s63 offen offset:2048 sc1
 v_mfma_f32_32x32x16_bf16 v[64:79], v[132:135], v[36:39], v[64:79]
 ds_read_b64_tr_b16 v[124:125], v146 offset:38912
 ds_read_b64_tr_b16 v[126:127], v146 offset:39424
 s_waitcnt vmcnt(8) lgkmcnt(4)
 v_mfma_f32_32x32x16_bf16 v[48:63], v[112:115], v[40:43], v[48:63]
 ds_read_b64_tr_b16 v[128:129], v144 offset:40960
 ds_read_b64_tr_b16 v[130:131], v144 offset:41472
 buffer_load_dwordx4 v[36:39], v7, s[8:11], s63 offen offset:3072 sc1
 v_mfma_f32_32x32x16_bf16 v[64:79], v[116:119], v[40:43], v[64:79]
 ds_read_b64_tr_b16 v[132:133], v146 offset:40960
 ds_read_b64_tr_b16 v[134:135], v146 offset:41472
 s_waitcnt vmcnt(8) lgkmcnt(4)
 v_mfma_f32_32x32x16_bf16 v[48:63], v[120:123], v[44:47], v[48:63]
 ds_read_b64_tr_b16 v[112:113], v144 offset:43008
 ds_read_b64_tr_b16 v[114:115], v144 offset:43520
 s_add_u32 s63, s63, 4096
 buffer_load_dwordx4 v[40:43], v7, s[8:11], s63 offen offset:0 sc1
 v_mfma_f32_32x32x16_bf16 v[64:79], v[124:127], v[44:47], v[64:79]
 ds_read_b64_tr_b16 v[116:117], v146 offset:43008
 ds_read_b64_tr_b16 v[118:119], v146 offset:43520
 s_waitcnt vmcnt(8) lgkmcnt(4)
 v_mfma_f32_32x32x16_bf16 v[48:63], v[128:131], v[8:11], v[48:63]
 ds_read_b64_tr_b16 v[120:121], v144 offset:45056
 ds_read_b64_tr_b16 v[122:123], v144 offset:45568
 buffer_load_dwordx4 v[44:47], v7, s[8:11], s63 offen offset:1024 sc1
 v_mfma_f32_32x32x16_bf16 v[64:79], v[132:135], v[8:11], v[64:79]
 ds_read_b64_tr_b16 v[124:125], v146 offset:45056
 ds_read_b64_tr_b16 v[126:127], v146 offset:45568
 s_waitcnt vmcnt(8) lgkmcnt(4)
 v_mfma_f32_32x32x16_bf16 v[48:63], v[112:115], v[12:15], v[48:63]
 ds_read_b64_tr_b16 v[128:129], v144 offset:47104
 ds_read_b64_tr_b16 v[130:131], v144 offset:47616
 buffer_load_dwordx4 v[8:11], v7, s[8:11], s63 offen offset:2048 sc1
 v_mfma_f32_32x32x16_bf16 v[64:79], v[116:119], v[12:15], v[64:79]
 ds_read_b64_tr_b16 v[132:133], v146 offset:47104
 ds_read_b64_tr_b16 v[134:135], v146 offset:47616
 s_waitcnt vmcnt(8) lgkmcnt(4)
 v_mfma_f32_32x32x16_bf16 v[48:63], v[120:123], v[16:19], v[48:63]
 ds_read_b64_tr_b16 v[112:113], v144 offset:49152
 ds_read_b64_tr_b16 v[114:115], v144 offset:49664
 buffer_load_dwordx4 v[12:15], v7, s[8:11], s63 offen offset:3072 sc1
 v_mfma_f32_32x32x16_bf16 v[64:79], v[124:127], v[16:19], v[64:79]
 ds_read_b64_tr_b16 v[116:117], v146 offset:49152
 ds_read_b64_tr_b16 v[118:119], v146 offset:49664
 s_waitcnt vmcnt(8) lgkmcnt(4)
 v_mfma_f32_32x32x16_bf16 v[48:63], v[128:131], v[20:23], v[48:63]
 ds_read_b64_tr_b16 v[120:121], v144 offset:51200
 ds_read_b64_tr_b16 v[122:123], v144 offset:51712
 s_add_u32 s63, s63, 4096
 buffer_load_dwordx4 v[16:19], v7, s[8:11], s63 offen offset:0 sc1
 v_mfma_f32_32x32x16_bf16 v[64:79], v[132:135], v[20:23], v[64:79]
 ds_read_b64_tr_b16 v[124:125], v146 offset:51200
 ds_read_b64_tr_b16 v[126:127], v146 offset:51712
 s_waitcnt vmcnt(8) lgkmcnt(4)
 v_mfma_f32_32x32x16_bf16 v[48:63], v[112:115], v[24:27], v[48:63]
 ds_read_b64_tr_b16 v[128:129], v144 offset:53248
 ds_read_b64_tr_b16 v[130:131], v144 offset:53760
 buffer_load_dwordx4 v[20:23], v7, s[8:11], s63 offen offset:1024 sc1
 v_mfma_f32_32x32x16_bf16 v[64:79], v[116:119], v[24:27], v[64:79]
 ds_read_b64_tr_b16 v[132:133], v146 offset:53248
 ds_read_b64_tr_b16 v[134:135], v146 offset:53760
 s_waitcnt vmcnt(8) lgkmcnt(4)
 v_mfma_f32_32x32x16_bf16 v[48:63], v[120:123], v[28:31], v[48:63]
 ds_read_b64_tr_b16 v[112:113], v144 offset:55296
 ds_read_b64_tr_b16 v[114:115], v144 offset:55808
 buffer_load_dwordx4 v[24:27], v7, s[8:11], s63 offen offset:2048 sc1
 v_mfma_f32_32x32x16_bf16 v[64:79], v[124:127], v[28:31], v[64:79]
 ds_read_b64_tr_b16 v[116:117], v146 offset:55296
 ds_read_b64_tr_b16 v[118:119], v146 offset:55808
 s_waitcnt vmcnt(8) lgkmcnt(4)
 v_mfma_f32_32x32x16_bf16 v[48:63], v[128:131], v[32:35], v[48:63]
 ds_read_b64_tr_b16 v[120:121], v144 offset:57344
 ds_read_b64_tr_b16 v[122:123], v144 offset:57856
 buffer_load_dwordx4 v[28:31], v7, s[8:11], s63 offen offset:3072 sc1
 v_mfma_f32_32x32x16_bf16 v[64:79], v[132:135], v[32:35], v[64:79]
 ds_read_b64_tr_b16 v[124:125], v146 offset:57344
 ds_read_b64_tr_b16 v[126:127], v146 offset:57856
 s_waitcnt vmcnt(8) lgkmcnt(4)
 v_mfma_f32_32x32x16_bf16 v[48:63], v[112:115], v[36:39], v[48:63]
 ds_read_b64_tr_b16 v[128:129], v144 offset:59392
 ds_read_b64_tr_b16 v[130:131], v144 offset:59904
 s_add_u32 s63, s63, 4096
 buffer_load_dwordx4 v[32:35], v7, s[8:11], s63 offen offset:0 sc1
 v_mfma_f32_32x32x16_bf16 v[64:79], v[116:119], v[36:39], v[64:79]
 ds_read_b64_tr_b16 v[132:133], v146 offset:59392
 ds_read_b64_tr_b16 v[134:135], v146 offset:59904
 s_waitcnt vmcnt(8) lgkmcnt(4)
 v_mfma_f32_32x32x16_bf16 v[48:63], v[120:123], v[40:43], v[48:63]
 ds_read_b64_tr_b16 v[112:113], v144 offset:61440
 ds_read_b64_tr_b16 v[114:115], v144 offset:61952
 buffer_load_dwordx4 v[36:39], v7, s[8:11], s63 offen offset:1024 sc1
 v_mfma_f32_32x32x16_bf16 v[64:79], v[124:127], v[40:43], v[64:79]
 ds_read_b64_tr_b16 v[116:117], v146 offset:61440
 ds_read_b64_tr_b16 v[118:119], v146 offset:61952
 s_waitcnt vmcnt(8) lgkmcnt(4)
 v_mfma_f32_32x32x16_bf16 v[48:63], v[128:131], v[44:47], v[48:63]
 ds_read_b64_tr_b16 v[120:121], v144 offset:63488
 ds_read_b64_tr_b16 v[122:123], v144 offset:64000
 buffer_load_dwordx4 v[40:43], v7, s[8:11], s63 offen offset:2048 sc1
 v_mfma_f32_32x32x16_bf16 v[64:79], v[132:135], v[44:47], v[64:79]
 ds_read_b64_tr_b16 v[124:125], v146 offset:63488
 ds_read_b64_tr_b16 v[126:127], v146 offset:64000
 s_waitcnt vmcnt(8) lgkmcnt(4)
 v_mfma_f32_32x32x16_bf16 v[48:63], v[112:115], v[8:11], v[48:63]
 ds_read_b64_tr_b16 v[128:129], v145 offset:0
 ds_read_b64_tr_b16 v[130:131], v145 offset:512
 buffer_load_dwordx4 v[44:47], v7, s[8:11], s63 offen offset:3072 sc1
 v_mfma_f32_32x32x16_bf16 v[64:79], v[116:119], v[8:11], v[64:79]
 ds_read_b64_tr_b16 v[132:133], v147 offset:0
 ds_read_b64_tr_b16 v[134:135], v147 offset:512
 s_waitcnt vmcnt(8) lgkmcnt(4)
 v_mfma_f32_32x32x16_bf16 v[48:63], v[120:123], v[12:15], v[48:63]
 ds_read_b64_tr_b16 v[112:113], v145 offset:2048
 ds_read_b64_tr_b16 v[114:115], v145 offset:2560
 s_add_u32 s63, s63, 4096
 buffer_load_dwordx4 v[8:11], v7, s[8:11], s63 offen offset:0 sc1
 v_mfma_f32_32x32x16_bf16 v[64:79], v[124:127], v[12:15], v[64:79]
 ds_read_b64_tr_b16 v[116:117], v147 offset:2048
 ds_read_b64_tr_b16 v[118:119], v147 offset:2560
 s_waitcnt vmcnt(8) lgkmcnt(4)
 v_mfma_f32_32x32x16_bf16 v[48:63], v[128:131], v[16:19], v[48:63]
 ds_read_b64_tr_b16 v[120:121], v145 offset:4096
 ds_read_b64_tr_b16 v[122:123], v145 offset:4608
 buffer_load_dwordx4 v[12:15], v7, s[8:11], s63 offen offset:1024 sc1
 v_mfma_f32_32x32x16_bf16 v[64:79], v[132:135], v[16:19], v[64:79]
 ds_read_b64_tr_b16 v[124:125], v147 offset:4096
 ds_read_b64_tr_b16 v[126:127], v147 offset:4608
 s_waitcnt vmcnt(8) lgkmcnt(4)
 v_mfma_f32_32x32x16_bf16 v[48:63], v[112:115], v[20:23], v[48:63]
 ds_read_b64_tr_b16 v[128:129], v145 offset:6144
 ds_read_b64_tr_b16 v[130:131], v145 offset:6656
 buffer_load_dwordx4 v[16:19], v7, s[8:11], s63 offen offset:2048 sc1
 v_mfma_f32_32x32x16_bf16 v[64:79], v[116:119], v[20:23], v[64:79]
 ds_read_b64_tr_b16 v[132:133], v147 offset:6144
 ds_read_b64_tr_b16 v[134:135], v147 offset:6656
 s_waitcnt vmcnt(8) lgkmcnt(4)
 v_mfma_f32_32x32x16_bf16 v[48:63], v[120:123], v[24:27], v[48:63]
 ds_read_b64_tr_b16 v[112:113], v145 offset:8192
 ds_read_b64_tr_b16 v[114:115], v145 offset:8704
 buffer_load_dwordx4 v[20:23], v7, s[8:11], s63 offen offset:3072 sc1
 v_mfma_f32_32x32x16_bf16 v[64:79], v[124:127], v[24:27], v[64:79]
 ds_read_b64_tr_b16 v[116:117], v147 offset:8192
 ds_read_b64_tr_b16 v[118:119], v147 offset:8704
 s_waitcnt vmcnt(8) lgkmcnt(4)
 v_mfma_f32_32x32x16_bf16 v[48:63], v[128:131], v[28:31], v[48:63]
 ds_read_b64_tr_b16 v[120:121], v145 offset:10240
 ds_read_b64_tr_b16 v[122:123], v145 offset:10752
 s_add_u32 s63, s63, 4096
 buffer_load_dwordx4 v[24:27], v7, s[8:11], s63 offen offset:0 sc1
 v_mfma_f32_32x32x16_bf16 v[64:79], v[132:135], v[28:31], v[64:79]
 ds_read_b64_tr_b16 v[124:125], v147 offset:10240
 ds_read_b64_tr_b16 v[126:127], v147 offset:10752
 s_waitcnt vmcnt(8) lgkmcnt(4)
 v_mfma_f32_32x32x16_bf16 v[48:63], v[112:115], v[32:35], v[48:63]
 ds_read_b64_tr_b16 v[128:129], v145 offset:12288
 ds_read_b64_tr_b16 v[130:131], v145 offset:12800
 buffer_load_dwordx4 v[28:31], v7, s[8:11], s63 offen offset:1024 sc1
 v_mfma_f32_32x32x16_bf16 v[64:79], v[116:119], v[32:35], v[64:79]
 ds_read_b64_tr_b16 v[132:133], v147 offset:12288
 ds_read_b64_tr_b16 v[134:135], v147 offset:12800
 s_waitcnt vmcnt(8) lgkmcnt(4)
 v_mfma_f32_32x32x16_bf16 v[48:63], v[120:123], v[36:39], v[48:63]
 ds_read_b64_tr_b16 v[112:113], v145 offset:14336
 ds_read_b64_tr_b16 v[114:115], v145 offset:14848
 buffer_load_dwordx4 v[32:35], v7, s[8:11], s63 offen offset:2048 sc1
 v_mfma_f32_32x32x16_bf16 v[64:79], v[124:127], v[36:39], v[64:79]
 ds_read_b64_tr_b16 v[116:117], v147 offset:14336
 ds_read_b64_tr_b16 v[118:119], v147 offset:14848
 s_waitcnt vmcnt(8) lgkmcnt(4)
 v_mfma_f32_32x32x16_bf16 v[48:63], v[128:131], v[40:43], v[48:63]
 ds_read_b64_tr_b16 v[120:121], v144 offset:0
 ds_read_b64_tr_b16 v[122:123], v144 offset:512
 buffer_load_dwordx4 v[36:39], v7, s[8:11], s63 offen offset:3072 sc1
 v_mfma_f32_32x32x16_bf16 v[64:79], v[132:135], v[40:43], v[64:79]
 ds_read_b64_tr_b16 v[124:125], v146 offset:0
 ds_read_b64_tr_b16 v[126:127], v146 offset:512
 s_waitcnt vmcnt(8) lgkmcnt(4)
 v_mfma_f32_32x32x16_bf16 v[48:63], v[112:115], v[44:47], v[48:63]
 ds_read_b64_tr_b16 v[128:129], v144 offset:2048
 ds_read_b64_tr_b16 v[130:131], v144 offset:2560
 s_add_u32 s63, s63, 4096
 buffer_load_dwordx4 v[40:43], v7, s[8:11], s63 offen offset:0 sc1
 v_mfma_f32_32x32x16_bf16 v[64:79], v[116:119], v[44:47], v[64:79]
 ds_read_b64_tr_b16 v[132:133], v146 offset:2048
 ds_read_b64_tr_b16 v[134:135], v146 offset:2560
 s_waitcnt vmcnt(8) lgkmcnt(4)
 v_mfma_f32_32x32x16_bf16 v[80:95], v[120:123], v[8:11], 0
 ds_read_b64_tr_b16 v[112:113], v144 offset:4096
 ds_read_b64_tr_b16 v[114:115], v144 offset:4608
 buffer_load_dwordx4 v[44:47], v7, s[8:11], s63 offen offset:1024 sc1
 v_mfma_f32_32x32x16_bf16 v[96:111], v[124:127], v[8:11], 0
 ds_read_b64_tr_b16 v[116:117], v146 offset:4096
 ds_read_b64_tr_b16 v[118:119], v146 offset:4608
 s_waitcnt vmcnt(8) lgkmcnt(4)
 v_mfma_f32_32x32x16_bf16 v[80:95], v[128:131], v[12:15], v[80:95]
 ds_read_b64_tr_b16 v[120:121], v144 offset:6144
 ds_read_b64_tr_b16 v[122:123], v144 offset:6656
 buffer_load_dwordx4 v[8:11], v7, s[8:11], s63 offen offset:2048 sc1
 v_cvt_pk_bf16_f32 v208, v64, v65
 v_cvt_pk_bf16_f32 v209, v66, v67
 v_mfma_f32_32x32x16_bf16 v[96:111], v[132:135], v[12:15], v[96:111]
 ds_read_b64_tr_b16 v[124:125], v146 offset:6144
 ds_read_b64_tr_b16 v[126:127], v146 offset:6656
 v_cvt_pk_bf16_f32 v210, v68, v69
 v_cvt_pk_bf16_f32 v211, v70, v71
 v_cvt_pk_bf16_f32 v212, v72, v73
 s_waitcnt vmcnt(8) lgkmcnt(4)
 v_mfma_f32_32x32x16_bf16 v[80:95], v[112:115], v[16:19], v[80:95]
 ds_read_b64_tr_b16 v[128:129], v144 offset:8192
 ds_read_b64_tr_b16 v[130:131], v144 offset:8704
 buffer_load_dwordx4 v[12:15], v7, s[8:11], s63 offen offset:3072 sc1
 v_cvt_pk_bf16_f32 v213, v74, v75
 v_cvt_pk_bf16_f32 v214, v76, v77
 v_mfma_f32_32x32x16_bf16 v[96:111], v[116:119], v[16:19], v[96:111]
 ds_read_b64_tr_b16 v[132:133], v146 offset:8192
 ds_read_b64_tr_b16 v[134:135], v146 offset:8704
 v_cvt_pk_bf16_f32 v215, v78, v79
 v_mfma_f32_32x32x16_bf16 v[172:187], v[136:139], v[208:211], 0
 s_waitcnt vmcnt(8) lgkmcnt(4)
 v_mfma_f32_32x32x16_bf16 v[80:95], v[120:123], v[20:23], v[80:95]
 ds_read_b64_tr_b16 v[112:113], v144 offset:10240
 ds_read_b64_tr_b16 v[114:115], v144 offset:10752
 s_add_u32 s63, s63, 4096
 buffer_load_dwordx4 v[16:19], v7, s[8:11], s63 offen offset:0 sc1
 v_mfma_f32_32x32x16_bf16 v[172:187], v[140:143], v[212:215], v[172:187]
 v_mfma_f32_32x32x16_bf16 v[96:111], v[124:127], v[20:23], v[96:111]
 ds_read_b64_tr_b16 v[116:117], v146 offset:10240
 ds_read_b64_tr_b16 v[118:119], v146 offset:10752
 v_cvt_pk_bf16_f32 v148, v48, v49
 v_cvt_pk_bf16_f32 v149, v50, v51
 v_cvt_pk_bf16_f32 v150, v52, v53
 s_waitcnt vmcnt(8) lgkmcnt(4)
 v_mfma_f32_32x32x16_bf16 v[80:95], v[128:131], v[24:27], v[80:95]
 ds_read_b64_tr_b16 v[120:121], v144 offset:12288
 ds_read_b64_tr_b16 v[122:123], v144 offset:12800
 buffer_load_dwordx4 v[20:23], v7, s[8:11], s63 offen offset:1024 sc1
 v_cvt_pk_bf16_f32 v151, v54, v55
 v_cvt_pk_bf16_f32 v152, v56, v57
 v_mfma_f32_32x32x16_bf16 v[96:111], v[132:135], v[24:27], v[96:111]
 ds_read_b64_tr_b16 v[124:125], v146 offset:12288
 ds_read_b64_tr_b16 v[126:127], v146 offset:12800
 v_cvt_pk_bf16_f32 v153, v58, v59
 v_cvt_pk_bf16_f32 v154, v60, v61
 v_cvt_pk_bf16_f32 v155, v62, v63
 s_waitcnt vmcnt(8) lgkmcnt(4)
 v_mfma_f32_32x32x16_bf16 v[80:95], v[112:115], v[28:31], v[80:95]
 ds_read_b64_tr_b16 v[128:129], v144 offset:14336
 ds_read_b64_tr_b16 v[130:131], v144 offset:14848
 buffer_load_dwordx4 v[24:27], v7, s[8:11], s63 offen offset:2048 sc1
 v_cndmask_b32_e64 v228, v169, v152, s[54:55]
 v_cndmask_b32_e64 v229, 0, v153, s[54:55]
 v_mfma_f32_32x32x16_bf16 v[96:111], v[116:119], v[28:31], v[96:111]
 ds_read_b64_tr_b16 v[132:133], v146 offset:14336
 ds_read_b64_tr_b16 v[134:135], v146 offset:14848
 ds_write_b64 v165, v[154:155] offset:0
 ds_write_b64 v165, v[214:215] offset:16
 ds_write_b64 v166, v[228:229] offset:0
 s_waitcnt vmcnt(8) lgkmcnt(7)
 v_mfma_f32_32x32x16_bf16 v[80:95], v[120:123], v[32:35], v[80:95]
 ds_read_b64_tr_b16 v[112:113], v144 offset:16384
 ds_read_b64_tr_b16 v[114:115], v144 offset:16896
 buffer_load_dwordx4 v[28:31], v7, s[8:11], s63 offen offset:3072 sc1
 v_max3_f32 v170, v172, v173, v174
 v_min3_f32 v171, v172, v173, v174
 v_mfma_f32_32x32x16_bf16 v[96:111], v[124:127], v[32:35], v[96:111]
 ds_read_b64_tr_b16 v[116:117], v146 offset:16384
 ds_read_b64_tr_b16 v[118:119], v146 offset:16896
 v_max3_f32 v170, v170, v175, v176
 v_min3_f32 v171, v171, v175, v176
 v_max3_f32 v170, v170, v177, v178
 s_waitcnt vmcnt(8) lgkmcnt(7)
 v_mfma_f32_32x32x16_bf16 v[80:95], v[128:131], v[36:39], v[80:95]
 ds_read_b64_tr_b16 v[120:121], v144 offset:18432
 ds_read_b64_tr_b16 v[122:123], v144 offset:18944
 s_add_u32 s63, s63, 4096
 buffer_load_dwordx4 v[32:35], v7, s[8:11], s63 offen offset:0 sc1
 v_min3_f32 v171, v171, v177, v178
 v_max3_f32 v170, v170, v179, v180
 v_mfma_f32_32x32x16_bf16 v[96:111], v[132:135], v[36:39], v[96:111]
 ds_read_b64_tr_b16 v[124:125], v146 offset:18432
 ds_read_b64_tr_b16 v[126:127], v146 offset:18944
 v_min3_f32 v171, v171, v179, v180
 v_max_f32_e64 v170, v170, v181
 v_min_f32 v171, v171, v181
 s_waitcnt vmcnt(8) lgkmcnt(4)
 v_mfma_f32_32x32x16_bf16 v[80:95], v[112:115], v[40:43], v[80:95]
 ds_read_b64_tr_b16 v[128:129], v144 offset:20480
 ds_read_b64_tr_b16 v[130:131], v144 offset:20992
 buffer_load_dwordx4 v[36:39], v7, s[8:11], s63 offen offset:1024 sc1
 v_mov_b32 v241, v170
 v_mov_b32 v6, v171
 v_mfma_f32_32x32x16_bf16 v[96:111], v[116:119], v[40:43], v[96:111]
 ds_read_b64_tr_b16 v[132:133], v146 offset:20480
 ds_read_b64_tr_b16 v[134:135], v146 offset:20992
 s_nop 0
 v_permlane32_swap_b32 v241, v170
 v_permlane32_swap_b32 v6, v171
 s_waitcnt vmcnt(8) lgkmcnt(4)
 v_mfma_f32_32x32x16_bf16 v[80:95], v[120:123], v[44:47], v[80:95]
 ds_read_b64_tr_b16 v[112:113], v144 offset:22528
 ds_read_b64_tr_b16 v[114:115], v144 offset:23040
 buffer_load_dwordx4 v[40:43], v7, s[8:11], s63 offen offset:2048 sc1
 v_max_f32 v170, v170, v241
 v_min_f32 v171, v171, v6
 v_mfma_f32_32x32x16_bf16 v[96:111], v[124:127], v[44:47], v[96:111]
 ds_read_b64_tr_b16 v[116:117], v146 offset:22528
 ds_read_b64_tr_b16 v[118:119], v146 offset:23040
 v_mul_f32 v170, 0xbfb8aa3b, v170
 v_mul_f32 v171, 0x3fb8aa3b, v171
 v_fma_f32 v188, v172, s52, v170
 s_waitcnt vmcnt(8) lgkmcnt(4)
 v_mfma_f32_32x32x16_bf16 v[80:95], v[128:131], v[8:11], v[80:95]
 ds_read_b64_tr_b16 v[120:121], v144 offset:24576
 ds_read_b64_tr_b16 v[122:123], v144 offset:25088
 buffer_load_dwordx4 v[44:47], v7, s[8:11], s63 offen offset:3072 sc1
 v_fma_f32 v198, v172, -s52, v171
 v_fma_f32 v189, v173, s52, v170
 v_mfma_f32_32x32x16_bf16 v[96:111], v[132:135], v[8:11], v[96:111]
 ds_read_b64_tr_b16 v[124:125], v146 offset:24576
 ds_read_b64_tr_b16 v[126:127], v146 offset:25088
 v_fma_f32 v199, v173, -s52, v171
 v_fma_f32 v190, v174, s52, v170
 v_fma_f32 v200, v174, -s52, v171
 s_waitcnt vmcnt(8) lgkmcnt(4)
 v_mfma_f32_32x32x16_bf16 v[80:95], v[112:115], v[12:15], v[80:95]
 ds_read_b64_tr_b16 v[128:129], v144 offset:26624
 ds_read_b64_tr_b16 v[130:131], v144 offset:27136
 s_add_u32 s63, s63, 4096
 buffer_load_dwordx4 v[8:11], v7, s[8:11], s63 offen offset:0 sc1
 v_fma_f32 v191, v175, s52, v170
 v_fma_f32 v201, v175, -s52, v171
 v_mfma_f32_32x32x16_bf16 v[96:111], v[116:119], v[12:15], v[96:111]
 ds_read_b64_tr_b16 v[132:133], v146 offset:26624
 ds_read_b64_tr_b16 v[134:135], v146 offset:27136
 v_fma_f32 v192, v176, s52, v170
 v_fma_f32 v202, v176, -s52, v171
 v_fma_f32 v193, v177, s52, v170
 s_waitcnt vmcnt(8) lgkmcnt(4)
 v_mfma_f32_32x32x16_bf16 v[80:95], v[120:123], v[16:19], v[80:95]
 ds_read_b64_tr_b16 v[112:113], v144 offset:28672
 ds_read_b64_tr_b16 v[114:115], v144 offset:29184
 buffer_load_dwordx4 v[12:15], v7, s[8:11], s63 offen offset:1024 sc1
 v_fma_f32 v203, v177, -s52, v171
 v_fma_f32 v194, v178, s52, v170
 v_mfma_f32_32x32x16_bf16 v[96:111], v[124:127], v[16:19], v[96:111]
 ds_read_b64_tr_b16 v[116:117], v146 offset:28672
 ds_read_b64_tr_b16 v[118:119], v146 offset:29184
 v_fma_f32 v204, v178, -s52, v171
 v_fma_f32 v195, v179, s52, v170
 v_fma_f32 v205, v179, -s52, v171
 s_waitcnt vmcnt(8) lgkmcnt(4)
 v_mfma_f32_32x32x16_bf16 v[80:95], v[128:131], v[20:23], v[80:95]
 ds_read_b64_tr_b16 v[120:121], v144 offset:30720
 ds_read_b64_tr_b16 v[122:123], v144 offset:31232
 buffer_load_dwordx4 v[16:19], v7, s[8:11], s63 offen offset:2048 sc1
 v_fma_f32 v196, v180, s52, v170
 v_fma_f32 v206, v180, -s52, v171
 v_mfma_f32_32x32x16_bf16 v[96:111], v[132:135], v[20:23], v[96:111]
 ds_read_b64_tr_b16 v[124:125], v146 offset:30720
 ds_read_b64_tr_b16 v[126:127], v146 offset:31232
 v_fma_f32 v197, v181, s52, v170
 v_fma_f32 v207, v181, -s52, v171
 v_exp_f32 v188, v188
 s_waitcnt vmcnt(8) lgkmcnt(4)
 v_mfma_f32_32x32x16_bf16 v[80:95], v[112:115], v[24:27], v[80:95]
 ds_read_b64_tr_b16 v[128:129], v144 offset:32768
 ds_read_b64_tr_b16 v[130:131], v144 offset:33280
 buffer_load_dwordx4 v[20:23], v7, s[8:11], s63 offen offset:3072 sc1
 v_exp_f32_e64 v198, v198
 v_mfma_f32_32x32x16_bf16 v[96:111], v[116:119], v[24:27], v[96:111]
 ds_read_b64_tr_b16 v[132:133], v146 offset:32768
 ds_read_b64_tr_b16 v[134:135], v146 offset:33280
 v_exp_f32 v189, v189
 v_exp_f32 v199, v199
 v_lshlrev_b32 v2, 2, v1
 buffer_load_dword v242, v2, s[64:67], 0 offen sc1
 s_waitcnt vmcnt(9) lgkmcnt(4)
 v_mfma_f32_32x32x16_bf16 v[80:95], v[120:123], v[28:31], v[80:95]
 ds_read_b64_tr_b16 v[112:113], v144 offset:34816
 ds_read_b64_tr_b16 v[114:115], v144 offset:35328
 s_add_u32 s63, s63, 4096
 buffer_load_dwordx4 v[24:27], v7, s[8:11], s63 offen offset:0 sc1
 v_exp_f32_e64 v190, v190
 v_mfma_f32_32x32x16_bf16 v[96:111], v[124:127], v[28:31], v[96:111]
 ds_read_b64_tr_b16 v[116:117], v146 offset:34816
 ds_read_b64_tr_b16 v[118:119], v146 offset:35328
 v_exp_f32_e64 v200, v200
 v_exp_f32 v191, v191
 s_waitcnt vmcnt(9) lgkmcnt(4)
 v_mfma_f32_32x32x16_bf16 v[80:95], v[128:131], v[32:35], v[80:95]
 ds_read_b64_tr_b16 v[120:121], v144 offset:36864
 ds_read_b64_tr_b16 v[122:123], v144 offset:37376
 buffer_load_dwordx4 v[28:31], v7, s[8:11], s63 offen offset:1024 sc1
 v_exp_f32_e64 v201, v201
 v_mfma_f32_32x32x16_bf16 v[96:111], v[132:135], v[32:35], v[96:111]
 ds_read_b64_tr_b16 v[124:125], v146 offset:36864
 ds_read_b64_tr_b16 v[126:127], v146 offset:37376
 v_exp_f32_e64 v192, v192
 v_exp_f32 v202, v202
 s_waitcnt vmcnt(9) lgkmcnt(4)
 v_mfma_f32_32x32x16_bf16 v[80:95], v[112:115], v[36:39], v[80:95]
 ds_read_b64_tr_b16 v[128:129], v144 offset:38912
 ds_read_b64_tr_b16 v[130:131], v144 offset:39424
 buffer_load_dwordx4 v[32:35], v7, s[8:11], s63 offen offset:2048 sc1
 v_exp_f32_e64 v193, v193
 v_mfma_f32_32x32x16_bf16 v[96:111], v[116:119], v[36:39], v[96:111]
 ds_read_b64_tr_b16 v[132:133], v146 offset:38912
 ds_read_b64_tr_b16 v[134:135], v146 offset:39424
 v_exp_f32_e64 v203, v203
 v_exp_f32 v194, v194
 s_waitcnt vmcnt(9) lgkmcnt(4)
 v_mfma_f32_32x32x16_bf16 v[80:95], v[120:123], v[40:43], v[80:95]
 ds_read_b64_tr_b16 v[112:113], v144 offset:40960
 ds_read_b64_tr_b16 v[114:115], v144 offset:41472
 buffer_load_dwordx4 v[36:39], v7, s[8:11], s63 offen offset:3072 sc1
 v_exp_f32_e64 v204, v204
 v_mfma_f32_32x32x16_bf16 v[96:111], v[124:127], v[40:43], v[96:111]
 ds_read_b64_tr_b16 v[116:117], v146 offset:40960
 ds_read_b64_tr_b16 v[118:119], v146 offset:41472
 v_exp_f32_e64 v195, v195
 v_exp_f32 v205, v205
 s_waitcnt vmcnt(9) lgkmcnt(4)
 v_mfma_f32_32x32x16_bf16 v[80:95], v[128:131], v[44:47], v[80:95]
 ds_read_b64_tr_b16 v[120:121], v144 offset:43008
 ds_read_b64_tr_b16 v[122:123], v144 offset:43520
 s_add_u32 s63, s63, 4096
 buffer_load_dwordx4 v[40:43], v7, s[8:11], s63 offen offset:0 sc1
 v_exp_f32_e64 v196, v196
 v_mfma_f32_32x32x16_bf16 v[96:111], v[132:135], v[44:47], v[96:111]
 ds_read_b64_tr_b16 v[124:125], v146 offset:43008
 ds_read_b64_tr_b16 v[126:127], v146 offset:43520
 v_exp_f32_e64 v206, v206
 v_exp_f32 v197, v197
 s_waitcnt vmcnt(9) lgkmcnt(4)
 v_mfma_f32_32x32x16_bf16 v[80:95], v[112:115], v[8:11], v[80:95]
 ds_read_b64_tr_b16 v[128:129], v144 offset:45056
 ds_read_b64_tr_b16 v[130:131], v144 offset:45568
 buffer_load_dwordx4 v[44:47], v7, s[8:11], s63 offen offset:1024 sc1
 v_exp_f32_e64 v207, v207
 v_mfma_f32_32x32x16_bf16 v[96:111], v[116:119], v[8:11], v[96:111]
 ds_read_b64_tr_b16 v[132:133], v146 offset:45056
 ds_read_b64_tr_b16 v[134:135], v146 offset:45568
 v_add_f32 v6, v188, v189
 v_add_f32 v240, v198, v199
 v_add_f32 v6, v6, v190
 s_waitcnt vmcnt(9) lgkmcnt(4)
 v_mfma_f32_32x32x16_bf16 v[80:95], v[120:123], v[12:15], v[80:95]
 ds_read_b64_tr_b16 v[112:113], v144 offset:47104
 ds_read_b64_tr_b16 v[114:115], v144 offset:47616
 buffer_load_dwordx4 v[8:11], v7, s[8:11], s63 offen offset:2048 sc1
 v_add_f32 v240, v240, v200
 v_add_f32 v6, v6, v191
 v_mfma_f32_32x32x16_bf16 v[96:111], v[124:127], v[12:15], v[96:111]
 ds_read_b64_tr_b16 v[116:117], v146 offset:47104
 ds_read_b64_tr_b16 v[118:119], v146 offset:47616
 v_add_f32 v240, v240, v201
 v_add_f32 v6, v6, v192
 v_add_f32 v240, v240, v202
 s_waitcnt vmcnt(9) lgkmcnt(4)
 v_mfma_f32_32x32x16_bf16 v[80:95], v[128:131], v[16:19], v[80:95]
 ds_read_b64_tr_b16 v[120:121], v144 offset:49152
 ds_read_b64_tr_b16 v[122:123], v144 offset:49664
 buffer_load_dwordx4 v[12:15], v7, s[8:11], s63 offen offset:3072 sc1
 v_add_f32 v6, v6, v193
 v_add_f32 v240, v240, v203
 v_mfma_f32_32x32x16_bf16 v[96:111], v[132:135], v[16:19], v[96:111]
 ds_read_b64_tr_b16 v[124:125], v146 offset:49152
 ds_read_b64_tr_b16 v[126:127], v146 offset:49664
 v_add_f32 v6, v6, v194
 v_add_f32 v240, v240, v204
 v_add_f32 v6, v6, v195
 s_waitcnt vmcnt(9) lgkmcnt(4)
 v_mfma_f32_32x32x16_bf16 v[80:95], v[112:115], v[20:23], v[80:95]
 ds_read_b64_tr_b16 v[128:129], v144 offset:51200
 ds_read_b64_tr_b16 v[130:131], v144 offset:51712
 s_add_u32 s63, s63, 4096
 buffer_load_dwordx4 v[16:19], v7, s[8:11], s63 offen offset:0 sc1
 v_add_f32 v240, v240, v205
 v_add_f32 v6, v6, v196
 v_mfma_f32_32x32x16_bf16 v[96:111], v[116:119], v[20:23], v[96:111]
 ds_read_b64_tr_b16 v[132:133], v146 offset:51200
 ds_read_b64_tr_b16 v[134:135], v146 offset:51712
 v_add_f32 v240, v240, v206
 v_add_f32 v6, v6, v197
 v_add_f32 v240, v240, v207
 s_waitcnt vmcnt(8) lgkmcnt(4)
 v_mfma_f32_32x32x16_bf16 v[80:95], v[120:123], v[24:27], v[80:95]
 ds_read_b64_tr_b16 v[112:113], v144 offset:53248
 ds_read_b64_tr_b16 v[114:115], v144 offset:53760
 buffer_load_dwordx4 v[20:23], v7, s[8:11], s63 offen offset:1024 sc1
 v_mov_b32 v241, v6
 v_mov_b32 v170, v240
 v_mfma_f32_32x32x16_bf16 v[96:111], v[124:127], v[24:27], v[96:111]
 ds_read_b64_tr_b16 v[116:117], v146 offset:53248
 ds_read_b64_tr_b16 v[118:119], v146 offset:53760
 s_nop 0
 v_permlane32_swap_b32 v241, v6
 v_permlane32_swap_b32 v170, v240
 s_waitcnt vmcnt(8) lgkmcnt(4)
 v_mfma_f32_32x32x16_bf16 v[80:95], v[128:131], v[28:31], v[80:95]
 ds_read_b64_tr_b16 v[120:121], v144 offset:55296
 ds_read_b64_tr_b16 v[122:123], v144 offset:55808
 buffer_load_dwordx4 v[24:27], v7, s[8:11], s63 offen offset:2048 sc1
 v_add_f32 v6, v6, v241
 v_add_f32 v240, v240, v170
 v_mfma_f32_32x32x16_bf16 v[96:111], v[132:135], v[28:31], v[96:111]
 ds_read_b64_tr_b16 v[124:125], v146 offset:55296
 ds_read_b64_tr_b16 v[126:127], v146 offset:55808
 v_rcp_f32_e64 v172, v6
 v_rcp_f32 v174, v240
 s_waitcnt vmcnt(8) lgkmcnt(4)
 v_mfma_f32_32x32x16_bf16 v[80:95], v[112:115], v[32:35], v[80:95]
 ds_read_b64_tr_b16 v[128:129], v144 offset:57344
 ds_read_b64_tr_b16 v[130:131], v144 offset:57856
 buffer_load_dwordx4 v[28:31], v7, s[8:11], s63 offen offset:3072 sc1
 v_mul_f32 v188, v188, v172
 v_mul_f32 v198, v198, v174
 v_mfma_f32_32x32x16_bf16 v[96:111], v[116:119], v[32:35], v[96:111]
 ds_read_b64_tr_b16 v[132:133], v146 offset:57344
 ds_read_b64_tr_b16 v[134:135], v146 offset:57856
 v_mul_f32 v189, v189, v172
 v_mul_f32 v199, v199, v174
 v_mul_f32 v190, v190, v172
 s_waitcnt vmcnt(8) lgkmcnt(4)
 v_mfma_f32_32x32x16_bf16 v[80:95], v[120:123], v[36:39], v[80:95]
 ds_read_b64_tr_b16 v[112:113], v144 offset:59392
 ds_read_b64_tr_b16 v[114:115], v144 offset:59904
 s_add_u32 s63, s63, 4096
 buffer_load_dwordx4 v[32:35], v7, s[8:11], s63 offen offset:0 sc1
 v_mul_f32 v200, v200, v174
 v_mul_f32 v191, v191, v172
 v_mfma_f32_32x32x16_bf16 v[96:111], v[124:127], v[36:39], v[96:111]
 ds_read_b64_tr_b16 v[116:117], v146 offset:59392
 ds_read_b64_tr_b16 v[118:119], v146 offset:59904
 v_mul_f32 v201, v201, v174
 v_mul_f32 v192, v192, v172
 v_mul_f32 v202, v202, v174
 s_waitcnt vmcnt(8) lgkmcnt(4)
 v_mfma_f32_32x32x16_bf16 v[80:95], v[128:131], v[40:43], v[80:95]
 ds_read_b64_tr_b16 v[120:121], v144 offset:61440
 ds_read_b64_tr_b16 v[122:123], v144 offset:61952
 buffer_load_dwordx4 v[36:39], v7, s[8:11], s63 offen offset:1024 sc1
 v_mul_f32 v193, v193, v172
 v_mul_f32 v203, v203, v174
 v_mfma_f32_32x32x16_bf16 v[96:111], v[132:135], v[40:43], v[96:111]
 ds_read_b64_tr_b16 v[124:125], v146 offset:61440
 ds_read_b64_tr_b16 v[126:127], v146 offset:61952
 v_mul_f32 v194, v194, v172
 v_mul_f32 v204, v204, v174
 v_mul_f32 v195, v195, v172
 s_waitcnt vmcnt(8) lgkmcnt(4)
 v_mfma_f32_32x32x16_bf16 v[80:95], v[112:115], v[44:47], v[80:95]
 ds_read_b64_tr_b16 v[128:129], v144 offset:63488
 ds_read_b64_tr_b16 v[130:131], v144 offset:64000
 buffer_load_dwordx4 v[40:43], v7, s[8:11], s63 offen offset:2048 sc1
 v_mul_f32 v205, v205, v174
 v_mul_f32 v196, v196, v172
 v_mfma_f32_32x32x16_bf16 v[96:111], v[116:119], v[44:47], v[96:111]
 ds_read_b64_tr_b16 v[132:133], v146 offset:63488
 ds_read_b64_tr_b16 v[134:135], v146 offset:64000
 v_mul_f32 v206, v206, v174
 v_mul_f32 v197, v197, v172
 v_mul_f32 v207, v207, v174
 s_waitcnt vmcnt(8) lgkmcnt(4)
 v_mfma_f32_32x32x16_bf16 v[80:95], v[120:123], v[8:11], v[80:95]
 ds_read_b64_tr_b16 v[112:113], v145 offset:0
 ds_read_b64_tr_b16 v[114:115], v145 offset:512
 buffer_load_dwordx4 v[44:47], v7, s[8:11], s63 offen offset:3072 sc1
 v_cvt_pk_bf16_f32 v216, v188, v189
 v_cvt_pk_bf16_f32 v222, v198, v199
 v_mfma_f32_32x32x16_bf16 v[96:111], v[124:127], v[8:11], v[96:111]
 ds_read_b64_tr_b16 v[116:117], v147 offset:0
 ds_read_b64_tr_b16 v[118:119], v147 offset:512
 v_cvt_pk_bf16_f32 v217, v190, v191
 v_cvt_pk_bf16_f32 v223, v200, v201
 v_cvt_pk_bf16_f32 v218, v192, v193
 s_waitcnt vmcnt(8) lgkmcnt(4)
 v_mfma_f32_32x32x16_bf16 v[80:95], v[128:131], v[12:15], v[80:95]
 ds_read_b64_tr_b16 v[120:121], v145 offset:2048
 ds_read_b64_tr_b16 v[122:123], v145 offset:2560
 v_cvt_pk_bf16_f32 v224, v202, v203
 v_cvt_pk_bf16_f32 v219, v194, v195
 v_cvt_pk_bf16_f32 v225, v204, v205
 v_mfma_f32_32x32x16_bf16 v[96:111], v[132:135], v[12:15], v[96:111]
 ds_read_b64_tr_b16 v[124:125], v147 offset:2048
 ds_read_b64_tr_b16 v[126:127], v147 offset:2560
 v_cvt_pk_bf16_f32 v220, v196, v197
 v_cvt_pk_bf16_f32 v226, v206, v207
 ds_write_b128 v164, v[216:219] offset:0
 v_lshlrev_b32 v2, 6, v1
 v_add_u32 v2, 12288, v2
 buffer_load_dword v243, v2, s[8:11], 0 offen sc1
 v_min_u32_e64 v2, 15, v1
 v_lshlrev_b32 v2, 6, v2
 v_add_u32 v2, 16384, v2
 buffer_load_dword v244, v2, s[8:11], 0 offen sc1
 s_waitcnt vmcnt(9) lgkmcnt(5)
 v_mfma_f32_32x32x16_bf16 v[80:95], v[112:115], v[16:19], v[80:95]
 ds_read_b64_tr_b16 v[128:129], v145 offset:4096
 ds_read_b64_tr_b16 v[130:131], v145 offset:4608
 ds_write_b32 v164, v220 offset:16
 ds_write_b128 v164, v[222:225] offset:64
 ds_write_b32 v164, v226 offset:80
 v_mfma_f32_32x32x16_bf16 v[96:111], v[116:119], v[16:19], v[96:111]
 ds_read_b64_tr_b16 v[132:133], v147 offset:4096
 ds_read_b64_tr_b16 v[134:135], v147 offset:4608
 s_waitcnt vmcnt(8) lgkmcnt(8)
 v_mfma_f32_32x32x16_bf16 v[80:95], v[120:123], v[20:23], v[80:95]
 ds_read_b64_tr_b16 v[112:113], v145 offset:6144
 ds_read_b64_tr_b16 v[114:115], v145 offset:6656
 v_mfma_f32_32x32x16_bf16 v[96:111], v[124:127], v[20:23], v[96:111]
 ds_read_b64_tr_b16 v[116:117], v147 offset:6144
 ds_read_b64_tr_b16 v[118:119], v147 offset:6656
 s_waitcnt vmcnt(7) lgkmcnt(4)
 v_mfma_f32_32x32x16_bf16 v[80:95], v[128:131], v[24:27], v[80:95]
 ds_read_b64_tr_b16 v[120:121], v145 offset:8192
 ds_read_b64_tr_b16 v[122:123], v145 offset:8704
 s_waitcnt lgkmcnt(6)
 ds_read_b64_tr_b16 v[228:229], v167 offset:0
 ds_read_b64_tr_b16 v[230:231], v167 offset:832
 v_mfma_f32_32x32x16_bf16 v[96:111], v[132:135], v[24:27], v[96:111]
 ds_read_b64_tr_b16 v[124:125], v147 offset:8192
 ds_read_b64_tr_b16 v[126:127], v147 offset:8704
 ds_read_b64_tr_b16 v[232:233], v167 offset:64
 ds_read_b64_tr_b16 v[234:235], v167 offset:896
 ds_read_b64_tr_b16 v[236:237], v167 offset:128
 s_waitcnt vmcnt(6) lgkmcnt(9)
 v_mfma_f32_32x32x16_bf16 v[80:95], v[112:115], v[28:31], v[80:95]
 ds_read_b64_tr_b16 v[128:129], v145 offset:10240
 ds_read_b64_tr_b16 v[130:131], v145 offset:10752
 ds_read_b64_tr_b16 v[238:239], v167 offset:960
 ds_read_b64_tr_b16 v[172:173], v167 offset:3328
 ds_read_b64_tr_b16 v[174:175], v167 offset:4160
 v_mfma_f32_32x32x16_bf16 v[96:111], v[116:119], v[28:31], v[96:111]
 ds_read_b64_tr_b16 v[132:133], v147 offset:10240
 ds_read_b64_tr_b16 v[134:135], v147 offset:10752
 ds_read_b64_tr_b16 v[176:177], v167 offset:3392
 ds_read_b64_tr_b16 v[178:179], v167 offset:4224
 ds_read_b64_tr_b16 v[180:181], v167 offset:3456
 s_waitcnt vmcnt(5) lgkmcnt(13)
 v_mfma_f32_32x32x16_bf16 v[80:95], v[120:123], v[32:35], v[80:95]
 ds_read_b64_tr_b16 v[112:113], v145 offset:12288
 ds_read_b64_tr_b16 v[114:115], v145 offset:12800
 ds_read_b64_tr_b16 v[182:183], v167 offset:4288
 s_waitcnt lgkmcnt(10)
 v_mfma_f32_32x32x16_bf16 v[48:63], v[228:231], v[236:239], 0
 v_mfma_f32_32x32x16_bf16 v[96:111], v[124:127], v[32:35], v[96:111]
 ds_read_b64_tr_b16 v[116:117], v147 offset:12288
 ds_read_b64_tr_b16 v[118:119], v147 offset:12800
 v_mfma_f32_32x32x16_bf16 v[64:79], v[232:235], v[236:239], 0
 s_waitcnt vmcnt(4) lgkmcnt(8)
 v_mfma_f32_32x32x16_bf16 v[80:95], v[128:131], v[36:39], v[80:95]
 ds_read_b64_tr_b16 v[120:121], v145 offset:14336
 ds_read_b64_tr_b16 v[122:123], v145 offset:14848
 s_waitcnt lgkmcnt(4)
 v_mfma_f32_32x32x16_bf16 v[48:63], v[172:175], v[180:183], v[48:63]
 v_mfma_f32_32x32x16_bf16 v[96:111], v[132:135], v[36:39], v[96:111]
 ds_read_b64_tr_b16 v[124:125], v147 offset:14336
 ds_read_b64_tr_b16 v[126:127], v147 offset:14848
 v_mfma_f32_32x32x16_bf16 v[64:79], v[176:179], v[180:183], v[64:79]
 s_waitcnt vmcnt(3) lgkmcnt(4)
 v_mfma_f32_32x32x16_bf16 v[80:95], v[112:115], v[40:43], v[80:95]
 v_mfma_f32_32x32x16_bf16 v[96:111], v[116:119], v[40:43], v[96:111]
 s_waitcnt vmcnt(2) lgkmcnt(0)
 v_mfma_f32_32x32x16_bf16 v[80:95], v[120:123], v[44:47], v[80:95]
 v_mfma_f32_32x32x16_bf16 v[96:111], v[124:127], v[44:47], v[96:111]
 s_cmp_lg_u32 s42, 0
 s_cbranch_scc1 Lwo_73
 s_waitcnt vmcnt(0)
 v_subrev_u32 v2, 0x01010101, v242
 v_bfi_b32 v2, v242, 0, v2
 v_and_b32 v2, 0x80808080, v2
 v_cmp_ne_u32 vcc, 0, v2
 s_cbranch_vccnz Lwsl_75
 v_and_b32 v2, v243, v244
 v_cmp_ne_u32_e64 vcc, 1, v2
 s_cbranch_vccz Lwok_74
Lwsl_75:
 s_mov_b32 s72, s26
 s_and_b32 s73, s27, 0xffff
 s_mov_b32 s74, 256
 s_mov_b32 s75, 0x20000
 v_lshlrev_b32 v246, 2, v1
 s_mov_b32 s39, 1048576
Liwp_77:
 buffer_load_dword v245, v246, s[72:75], 0 offen sc1
 s_waitcnt vmcnt(0)
 v_subrev_u32 v2, 0x01010101, v245
 v_bfi_b32 v2, v245, 0, v2
 v_and_b32 v2, 0x80808080, v2
 v_cmp_ne_u32 vcc, 0, v2
 s_cbranch_vccz Liwd_78
 s_sub_u32 s39, s39, 1
 s_cmp_lg_u32 s39, 0
 s_cbranch_scc1 Liwp_77
Liwd_78:
Liw_76:
 v_lshlrev_b32 v245, 6, v1
 v_add_u32 v245, 12288, v245
 v_min_u32 v246, 15, v1
 v_lshlrev_b32 v246, 6, v246
 v_add_u32 v246, 16384, v246
 s_mov_b32 s39, 1048576
Lwrp_79:
 buffer_load_dword v243, v245, s[8:11], 0 offen sc1
 buffer_load_dword v244, v246, s[8:11], 0 offen sc1
 s_waitcnt vmcnt(0)
 v_and_b32 v2, v243, v244
 v_cmp_ne_u32 vcc, 1, v2
 s_cbranch_vccz Lwrd_80
 s_sub_u32 s39, s39, 1
 s_cmp_lg_u32 s39, 0
 s_cbranch_scc1 Lwrp_79
Lwrd_80:
Lwok_74:
 s_lshr_b32 s69, s4, 2
 s_mul_i32 s69, s69, 102400
 s_add_u32 s69, s69, 15597568
 s_lshr_b32 s70, s5, 1
 s_lshl_b32 s68, s70, 13
 s_add_u32 s68, s69, s68
 s_lshl_b32 s70, s70, 11
 s_add_u32 s69, s69, s70
 s_add_u32 s69, s69, 16384
Lwo_73:
 s_cmp_gt_u32 s4, 20
 s_cbranch_scc1 Lzp_81
 v_mov_b32 v248, -1
 v_mov_b32 v249, -1
 v_mov_b32 v250, -1
 v_mov_b32_e64 v251, -1
 s_mul_i32 s44, s3, 344064
 s_add_u32 s44, s44, s62
 s_lshl_b32 s45, s4, 14
 s_add_u32 s44, s44, s45
 s_lshl_b32 s45, s5, 12
 s_add_u32 s44, s44, s45
 buffer_store_dwordx4 v[248:251], v7, s[8:11], s44 offen offset:0 sc1
 buffer_store_dwordx4 v[248:251], v7, s[8:11], s44 offen offset:1024 sc1
 buffer_store_dwordx4 v[248:251], v7, s[8:11], s44 offen offset:2048 sc1
 buffer_store_dwordx4 v[248:251], v7, s[8:11], s44 offen offset:3072 sc1
Lzp_81:
 s_cmp_lg_u32 s42, 0
 s_cbranch_scc1 Ld1_82
 s_nop 5
 v_cvt_pk_bf16_f32 v208, v96, v97
 v_cvt_pk_bf16_f32 v209, v98, v99
 v_cvt_pk_bf16_f32 v210, v100, v101
 v_cvt_pk_bf16_f32 v211, v102, v103
 v_cvt_pk_bf16_f32 v212, v104, v105
 v_cvt_pk_bf16_f32 v213, v106, v107
 s_add_u32 s70, s68, 0
 buffer_load_dwordx4 a[0:3], v7, s[8:11], s70 offen
 v_cvt_pk_bf16_f32 v214, v108, v109
 v_cvt_pk_bf16_f32 v215, v110, v111
 v_mfma_f32_32x32x16_bf16 v[172:187], v[136:139], v[208:211], 0
 s_nop 0
 v_mfma_f32_32x32x16_bf16 v[172:187], v[140:143], v[212:215], v[172:187]
 v_cvt_pk_bf16_f32 v156, v80, v81
 s_add_u32 s70, s68, 20480
 buffer_load_dwordx4 a[4:7], v7, s[8:11], s70 offen
 v_cvt_pk_bf16_f32 v157, v82, v83
 v_cvt_pk_bf16_f32 v158, v84, v85
 v_cvt_pk_bf16_f32 v159, v86, v87
 v_cvt_pk_bf16_f32 v160, v88, v89
 v_cvt_pk_bf16_f32 v161, v90, v91
 v_cvt_pk_bf16_f32 v162, v92, v93
 s_add_u32 s70, s68, 40960
 buffer_load_dwordx4 a[8:11], v7, s[8:11], s70 offen
 v_cvt_pk_bf16_f32 v163, v94, v95
 v_cndmask_b32_e64 v228, v169, v160, s[54:55]
 v_cndmask_b32_e64 v229, 0, v161, s[54:55]
 ds_write_b64 v165, v[162:163] offset:6656
 ds_write_b64 v165, v[214:215] offset:6672
 s_add_u32 s70, s68, 61440
 buffer_load_dwordx4 a[12:15], v7, s[8:11], s70 offen
 ds_write_b64 v166, v[228:229] offset:6656
 v_max3_f32 v170, v172, v173, v174
 v_min3_f32 v171, v172, v173, v174
 v_max3_f32 v170, v170, v175, v176
 v_min3_f32 v171, v171, v175, v176
 s_add_u32 s70, s68, 81920
 buffer_load_dwordx4 a[16:19], v7, s[8:11], s70 offen
 v_max3_f32 v170, v170, v177, v178
 v_min3_f32 v171, v171, v177, v178
 v_max3_f32 v170, v170, v179, v180
 v_min3_f32 v171, v171, v179, v180
 v_max_f32 v170, v170, v181
 v_min_f32 v171, v171, v181
 s_add_u32 s70, s68, 1024
 buffer_load_dwordx4 a[20:23], v7, s[8:11], s70 offen
 v_mov_b32_e64 v241, v170
 v_mov_b32 v6, v171
 s_nop 0
 v_permlane32_swap_b32 v241, v170
 v_permlane32_swap_b32 v6, v171
 s_add_u32 s70, s68, 21504
 buffer_load_dwordx4 a[24:27], v7, s[8:11], s70 offen
 v_max_f32 v170, v170, v241
 v_min_f32 v171, v171, v6
 v_mul_f32 v170, 0xbfb8aa3b, v170
 v_mul_f32 v171, 0x3fb8aa3b, v171
 v_pk_fma_f32 v[188:189], v[172:173], s[52:53], v[170:171] op_sel_hi:[1,1,0]
 s_add_u32 s70, s68, 41984
 buffer_load_dwordx4 a[28:31], v7, s[8:11], s70 offen
 v_pk_fma_f32 v[198:199], v[172:173], s[52:53], v[170:171] op_sel:[0,0,1] op_sel_hi:[1,1,1] neg_lo:[1,0,0] neg_hi:[1,0,0]
 v_pk_fma_f32 v[190:191], v[174:175], s[52:53], v[170:171] op_sel_hi:[1,1,0]
 v_pk_fma_f32 v[200:201], v[174:175], s[52:53], v[170:171] op_sel:[0,0,1] op_sel_hi:[1,1,1] neg_lo:[1,0,0] neg_hi:[1,0,0]
 v_pk_fma_f32 v[192:193], v[176:177], s[52:53], v[170:171] op_sel_hi:[1,1,0]
 v_pk_fma_f32 v[202:203], v[176:177], s[52:53], v[170:171] op_sel:[0,0,1] op_sel_hi:[1,1,1] neg_lo:[1,0,0] neg_hi:[1,0,0]
 v_pk_fma_f32 v[194:195], v[178:179], s[52:53], v[170:171] op_sel_hi:[1,1,0]
 s_add_u32 s70, s68, 62464
 buffer_load_dwordx4 a[32:35], v7, s[8:11], s70 offen
 v_pk_fma_f32 v[204:205], v[178:179], s[52:53], v[170:171] op_sel:[0,0,1] op_sel_hi:[1,1,1] neg_lo:[1,0,0] neg_hi:[1,0,0]
 v_pk_fma_f32 v[196:197], v[180:181], s[52:53], v[170:171] op_sel_hi:[1,1,0]
 v_pk_fma_f32 v[206:207], v[180:181], s[52:53], v[170:171] op_sel:[0,0,1] op_sel_hi:[1,1,1] neg_lo:[1,0,0] neg_hi:[1,0,0]
 v_exp_f32 v188, v188
 v_exp_f32 v198, v198
 s_add_u32 s70, s68, 82944
 buffer_load_dwordx4 a[36:39], v7, s[8:11], s70 offen
 v_exp_f32 v189, v189
 v_exp_f32 v199, v199
 v_exp_f32 v190, v190
 v_exp_f32 v200, v200
 v_exp_f32_e64 v191, v191
 s_add_u32 s70, s68, 2048
 buffer_load_dwordx4 a[40:43], v7, s[8:11], s70 offen
 v_exp_f32 v201, v201
 v_exp_f32 v192, v192
 v_exp_f32 v202, v202
 v_exp_f32 v193, v193
 v_exp_f32 v203, v203
 v_exp_f32 v194, v194
 s_add_u32 s70, s68, 22528
 buffer_load_dwordx4 a[44:47], v7, s[8:11], s70 offen
 v_exp_f32 v204, v204
 v_exp_f32 v195, v195
 v_exp_f32 v205, v205
 v_exp_f32 v196, v196
 v_exp_f32_e64 v206, v206
 s_add_u32 s70, s68, 43008
 buffer_load_dwordx4 a[48:51], v7, s[8:11], s70 offen
 v_exp_f32 v197, v197
 v_exp_f32 v207, v207
 v_pk_add_f32 v[172:173], v[188:189], v[190:191]
 v_pk_add_f32 v[174:175], v[192:193], v[194:195]
 v_pk_add_f32 v[176:177], v[198:199], v[200:201]
 v_pk_add_f32 v[178:179], v[202:203], v[204:205]
 s_add_u32 s70, s68, 63488
 buffer_load_dwordx4 a[52:55], v7, s[8:11], s70 offen
 v_pk_add_f32 v[172:173], v[172:173], v[196:197]
 v_pk_add_f32 v[176:177], v[176:177], v[206:207]
 v_pk_add_f32 v[172:173], v[172:173], v[174:175]
 v_pk_add_f32 v[176:177], v[176:177], v[178:179]
 v_add_f32_e64 v6, v172, v173
 s_add_u32 s70, s68, 83968
 buffer_load_dwordx4 a[56:59], v7, s[8:11], s70 offen
 v_add_f32 v240, v176, v177
 v_mov_b32 v241, v6
 v_mov_b32_e64 v170, v240
 s_nop 0
 v_permlane32_swap_b32 v241, v6
 s_add_u32 s70, s68, 3072
 buffer_load_dwordx4 a[60:63], v7, s[8:11], s70 offen
 v_permlane32_swap_b32 v170, v240
 v_add_f32 v6, v6, v241
 v_add_f32 v240, v240, v170
 v_rcp_f32 v172, v6
 v_rcp_f32_e64 v174, v240
 v_pk_mul_f32 v[188:189], v[188:189], v[172:173] op_sel_hi:[1,0]
 s_add_u32 s70, s68, 23552
 buffer_load_dwordx4 a[64:67], v7, s[8:11], s70 offen
 v_pk_mul_f32 v[198:199], v[198:199], v[174:175] op_sel_hi:[1,0]
 v_pk_mul_f32 v[190:191], v[190:191], v[172:173] op_sel_hi:[1,0]
 v_pk_mul_f32 v[200:201], v[200:201], v[174:175] op_sel_hi:[1,0]
 v_pk_mul_f32 v[192:193], v[192:193], v[172:173] op_sel_hi:[1,0]
 v_pk_mul_f32 v[202:203], v[202:203], v[174:175] op_sel_hi:[1,0]
 s_add_u32 s70, s68, 44032
 buffer_load_dwordx4 a[68:71], v7, s[8:11], s70 offen
 v_pk_mul_f32 v[194:195], v[194:195], v[172:173] op_sel_hi:[1,0]
 v_pk_mul_f32 v[204:205], v[204:205], v[174:175] op_sel_hi:[1,0]
 v_pk_mul_f32 v[196:197], v[196:197], v[172:173] op_sel_hi:[1,0]
 v_pk_mul_f32 v[206:207], v[206:207], v[174:175] op_sel_hi:[1,0]
 v_cvt_pk_bf16_f32 v216, v188, v189
 s_add_u32 s70, s68, 64512
 buffer_load_dwordx4 a[72:75], v7, s[8:11], s70 offen
 v_cvt_pk_bf16_f32 v222, v198, v199
 v_cvt_pk_bf16_f32 v217, v190, v191
 v_cvt_pk_bf16_f32 v223, v200, v201
 v_cvt_pk_bf16_f32 v218, v192, v193
 v_cvt_pk_bf16_f32 v224, v202, v203
 v_cvt_pk_bf16_f32 v219, v194, v195
 s_add_u32 s70, s68, 84992
 buffer_load_dwordx4 a[76:79], v7, s[8:11], s70 offen
 v_cvt_pk_bf16_f32 v225, v204, v205
 v_cvt_pk_bf16_f32 v220, v196, v197
 v_cvt_pk_bf16_f32 v226, v206, v207
 ds_write_b128 v164, v[216:219] offset:6656
 ds_write_b32 v164, v220 offset:6672
 s_add_u32 s70, s68, 4096
 buffer_load_dwordx4 a[80:83], v7, s[8:11], s70 offen
 ds_write_b128 v164, v[222:225] offset:6720
 ds_write_b32 v164, v226 offset:6736
 s_waitcnt lgkmcnt(0)
 ds_read_b64_tr_b16 v[228:229], v167 offset:6656
 ds_read_b64_tr_b16 v[230:231], v167 offset:7488
 s_add_u32 s70, s68, 24576
 buffer_load_dwordx4 a[84:87], v7, s[8:11], s70 offen
 ds_read_b64_tr_b16 v[232:233], v167 offset:6720
 ds_read_b64_tr_b16 v[234:235], v167 offset:7552
 ds_read_b64_tr_b16 v[236:237], v167 offset:6784
 ds_read_b64_tr_b16 v[238:239], v167 offset:7616
 ds_read_b64_tr_b16 v[172:173], v167 offset:9984
 ds_read_b64_tr_b16 v[174:175], v167 offset:10816
 s_add_u32 s70, s68, 45056
 buffer_load_dwordx4 a[88:91], v7, s[8:11], s70 offen
 ds_read_b64_tr_b16 v[176:177], v167 offset:10048
 ds_read_b64_tr_b16 v[178:179], v167 offset:10880
 ds_read_b64_tr_b16 v[180:181], v167 offset:10112
 ds_read_b64_tr_b16 v[182:183], v167 offset:10944
 s_waitcnt lgkmcnt(6)
 s_add_u32 s70, s68, 65536
 buffer_load_dwordx4 a[92:95], v7, s[8:11], s70 offen
 v_mfma_f32_32x32x16_bf16 v[48:63], v[228:231], v[236:239], v[48:63]
 v_mfma_f32_32x32x16_bf16 v[64:79], v[232:235], v[236:239], v[64:79]
 s_waitcnt lgkmcnt(0)
 v_mfma_f32_32x32x16_bf16 v[48:63], v[172:175], v[180:183], v[48:63]
 v_mfma_f32_32x32x16_bf16 v[64:79], v[176:179], v[180:183], v[64:79]
 s_branch Ld2_83
Ld1_82:
 s_nop 5
 v_cvt_pk_bf16_f32 v208, v96, v97
 v_cvt_pk_bf16_f32 v209, v98, v99
 v_cvt_pk_bf16_f32 v210, v100, v101
 v_cvt_pk_bf16_f32 v211, v102, v103
 v_cvt_pk_bf16_f32 v212, v104, v105
 v_cvt_pk_bf16_f32 v213, v106, v107
 v_cvt_pk_bf16_f32 v214, v108, v109
 v_cvt_pk_bf16_f32 v215, v110, v111
 v_mfma_f32_32x32x16_bf16 v[172:187], v[136:139], v[208:211], 0
 s_nop 0
 v_mfma_f32_32x32x16_bf16 v[172:187], v[140:143], v[212:215], v[172:187]
 v_cvt_pk_bf16_f32 v156, v80, v81
 v_cvt_pk_bf16_f32 v157, v82, v83
 v_cvt_pk_bf16_f32 v158, v84, v85
 v_cvt_pk_bf16_f32 v159, v86, v87
 v_cvt_pk_bf16_f32 v160, v88, v89
 v_cvt_pk_bf16_f32 v161, v90, v91
 v_cvt_pk_bf16_f32 v162, v92, v93
 v_cvt_pk_bf16_f32 v163, v94, v95
 v_cndmask_b32_e64 v228, v169, v160, s[54:55]
 v_cndmask_b32_e64 v229, 0, v161, s[54:55]
 ds_write_b64 v165, v[162:163] offset:6656
 ds_write_b64 v165, v[214:215] offset:6672
 ds_write_b64 v166, v[228:229] offset:6656
 v_max3_f32 v170, v172, v173, v174
 v_min3_f32 v171, v172, v173, v174
 v_max3_f32 v170, v170, v175, v176
 v_min3_f32 v171, v171, v175, v176
 v_max3_f32 v170, v170, v177, v178
 v_min3_f32 v171, v171, v177, v178
 v_max3_f32 v170, v170, v179, v180
 v_min3_f32 v171, v171, v179, v180
 v_max_f32 v170, v170, v181
 v_min_f32 v171, v171, v181
 v_mov_b32 v241, v170
 v_mov_b32 v6, v171
 s_nop 0
 v_permlane32_swap_b32 v241, v170
 v_permlane32_swap_b32 v6, v171
 v_max_f32 v170, v170, v241
 v_min_f32_e64 v171, v171, v6
 v_mul_f32 v170, 0xbfb8aa3b, v170
 v_mul_f32 v171, 0x3fb8aa3b, v171
 v_pk_fma_f32 v[188:189], v[172:173], s[52:53], v[170:171] op_sel_hi:[1,1,0]
 v_pk_fma_f32 v[198:199], v[172:173], s[52:53], v[170:171] op_sel:[0,0,1] op_sel_hi:[1,1,1] neg_lo:[1,0,0] neg_hi:[1,0,0]
 v_pk_fma_f32 v[190:191], v[174:175], s[52:53], v[170:171] op_sel_hi:[1,1,0]
 v_pk_fma_f32 v[200:201], v[174:175], s[52:53], v[170:171] op_sel:[0,0,1] op_sel_hi:[1,1,1] neg_lo:[1,0,0] neg_hi:[1,0,0]
 v_pk_fma_f32 v[192:193], v[176:177], s[52:53], v[170:171] op_sel_hi:[1,1,0]
 v_pk_fma_f32 v[202:203], v[176:177], s[52:53], v[170:171] op_sel:[0,0,1] op_sel_hi:[1,1,1] neg_lo:[1,0,0] neg_hi:[1,0,0]
 v_pk_fma_f32 v[194:195], v[178:179], s[52:53], v[170:171] op_sel_hi:[1,1,0]
 v_pk_fma_f32 v[204:205], v[178:179], s[52:53], v[170:171] op_sel:[0,0,1] op_sel_hi:[1,1,1] neg_lo:[1,0,0] neg_hi:[1,0,0]
 v_pk_fma_f32 v[196:197], v[180:181], s[52:53], v[170:171] op_sel_hi:[1,1,0]
 v_pk_fma_f32 v[206:207], v[180:181], s[52:53], v[170:171] op_sel:[0,0,1] op_sel_hi:[1,1,1] neg_lo:[1,0,0] neg_hi:[1,0,0]
 v_exp_f32 v188, v188
 v_exp_f32 v198, v198
 v_exp_f32 v189, v189
 v_exp_f32 v199, v199
 v_exp_f32 v190, v190
 v_exp_f32 v200, v200
 v_exp_f32 v191, v191
 v_exp_f32 v201, v201
 v_exp_f32 v192, v192
 v_exp_f32 v202, v202
 v_exp_f32 v193, v193
 v_exp_f32 v203, v203
 v_exp_f32 v194, v194
 v_exp_f32 v204, v204
 v_exp_f32 v195, v195
 v_exp_f32 v205, v205
 v_exp_f32 v196, v196
 v_exp_f32 v206, v206
 v_exp_f32 v197, v197
 v_exp_f32 v207, v207
 v_pk_add_f32 v[172:173], v[188:189], v[190:191]
 v_pk_add_f32 v[174:175], v[192:193], v[194:195]
 v_pk_add_f32 v[176:177], v[198:199], v[200:201]
 v_pk_add_f32 v[178:179], v[202:203], v[204:205]
 v_pk_add_f32 v[172:173], v[172:173], v[196:197]
 v_pk_add_f32 v[176:177], v[176:177], v[206:207]
 v_pk_add_f32 v[172:173], v[172:173], v[174:175]
 v_pk_add_f32 v[176:177], v[176:177], v[178:179]
 v_add_f32 v6, v172, v173
 v_add_f32 v240, v176, v177
 v_mov_b32 v241, v6
 v_mov_b32 v170, v240
 s_nop 0
 v_permlane32_swap_b32 v241, v6
 v_permlane32_swap_b32 v170, v240
 v_add_f32 v6, v6, v241
 v_add_f32 v240, v240, v170
 v_rcp_f32 v172, v6
 v_rcp_f32_e64 v174, v240
 v_pk_mul_f32 v[188:189], v[188:189], v[172:173] op_sel_hi:[1,0]
 v_pk_mul_f32 v[198:199], v[198:199], v[174:175] op_sel_hi:[1,0]
 v_pk_mul_f32 v[190:191], v[190:191], v[172:173] op_sel_hi:[1,0]
 v_pk_mul_f32 v[200:201], v[200:201], v[174:175] op_sel_hi:[1,0]
 v_pk_mul_f32 v[192:193], v[192:193], v[172:173] op_sel_hi:[1,0]
 v_pk_mul_f32 v[202:203], v[202:203], v[174:175] op_sel_hi:[1,0]
 v_pk_mul_f32 v[194:195], v[194:195], v[172:173] op_sel_hi:[1,0]
 v_pk_mul_f32 v[204:205], v[204:205], v[174:175] op_sel_hi:[1,0]
 v_pk_mul_f32 v[196:197], v[196:197], v[172:173] op_sel_hi:[1,0]
 v_pk_mul_f32 v[206:207], v[206:207], v[174:175] op_sel_hi:[1,0]
 v_cvt_pk_bf16_f32 v216, v188, v189
 v_cvt_pk_bf16_f32 v222, v198, v199
 v_cvt_pk_bf16_f32 v217, v190, v191
 v_cvt_pk_bf16_f32 v223, v200, v201
 v_cvt_pk_bf16_f32 v218, v192, v193
 v_cvt_pk_bf16_f32 v224, v202, v203
 v_cvt_pk_bf16_f32 v219, v194, v195
 v_cvt_pk_bf16_f32 v225, v204, v205
 v_cvt_pk_bf16_f32 v220, v196, v197
 v_cvt_pk_bf16_f32 v226, v206, v207
 ds_write_b128 v164, v[216:219] offset:6656
 ds_write_b32 v164, v220 offset:6672
 ds_write_b128 v164, v[222:225] offset:6720
 ds_write_b32 v164, v226 offset:6736
 s_waitcnt lgkmcnt(0)
 ds_read_b64_tr_b16 v[228:229], v167 offset:6656
 ds_read_b64_tr_b16 v[230:231], v167 offset:7488
 ds_read_b64_tr_b16 v[232:233], v167 offset:6720
 ds_read_b64_tr_b16 v[234:235], v167 offset:7552
 ds_read_b64_tr_b16 v[236:237], v167 offset:6784
 ds_read_b64_tr_b16 v[238:239], v167 offset:7616
 ds_read_b64_tr_b16 v[172:173], v167 offset:9984
 ds_read_b64_tr_b16 v[174:175], v167 offset:10816
 ds_read_b64_tr_b16 v[176:177], v167 offset:10048
 ds_read_b64_tr_b16 v[178:179], v167 offset:10880
 ds_read_b64_tr_b16 v[180:181], v167 offset:10112
 ds_read_b64_tr_b16 v[182:183], v167 offset:10944
 s_waitcnt lgkmcnt(6)
 v_mfma_f32_32x32x16_bf16 v[48:63], v[228:231], v[236:239], v[48:63]
 v_mfma_f32_32x32x16_bf16 v[64:79], v[232:235], v[236:239], v[64:79]
 s_waitcnt lgkmcnt(0)
 v_mfma_f32_32x32x16_bf16 v[48:63], v[172:175], v[180:183], v[48:63]
 v_mfma_f32_32x32x16_bf16 v[64:79], v[176:179], v[180:183], v[64:79]
Ld2_83:
 s_mov_b64 s[6:7], exec
 s_mov_b32 exec_lo, 0x00ffffff
 s_mov_b32 exec_hi, 0x00ffffff
 s_nop 7
 ds_write_b32 v168, v48 offset:0
 ds_write_b32 v168, v49 offset:96
 ds_write_b32 v168, v50 offset:192
 ds_write_b32 v168, v51 offset:288
 ds_write_b32 v168, v56 offset:1920
 ds_write_b32 v168, v57 offset:2016
 ds_write_b32 v168, v58 offset:2112
 ds_write_b32 v168, v59 offset:2208
 ds_write_b32 v168, v64 offset:960
 ds_write_b32 v168, v65 offset:1056
 ds_write_b32 v168, v66 offset:1152
 ds_write_b32 v168, v67 offset:1248
 ds_write_b32 v168, v72 offset:2880
 ds_write_b32 v168, v73 offset:2976
 ds_write_b32 v168, v74 offset:3072
 ds_write_b32 v168, v75 offset:3168
 s_mov_b32 exec_hi, 0
 ds_write_b32 v168, v52 offset:768
 ds_write_b32 v168, v53 offset:864
 ds_write_b32 v168, v60 offset:2688
 ds_write_b32 v168, v61 offset:2784
 ds_write_b32 v168, v68 offset:1728
 ds_write_b32 v168, v69 offset:1824
 ds_write_b32 v168, v76 offset:3648
 ds_write_b32 v168, v77 offset:3744
 s_mov_b64 exec, s[6:7]
 s_waitcnt lgkmcnt(0)
 s_barrier
 v_lshlrev_b32 v2, 4, v0
 v_add_u32 v3, 97280, v2
 ds_read_b128 v[172:175], v3 offset:0
 ds_read_b128 v[176:179], v3 offset:13312
 ds_read_b128 v[180:183], v3 offset:26624
 ds_read_b128 v[184:187], v3 offset:39936
 s_lshl_b32 s71, s4, 14
 s_add_u32 s71, s71, s57
 s_lshl_b32 s44, s3, 11
 s_add_u32 s44, s44, s71
 v_lshrrev_b32_e64 v245, 1, v2
 v_cmp_gt_u32 vcc, 240, v0
 v_mov_b32 v3, 2146435072
 s_nop 0
 v_cndmask_b32_e64 v245, v3, v245, vcc
 s_waitcnt lgkmcnt(0)
 v_pk_add_f32 v[172:173], v[172:173], v[176:177]
 v_pk_add_f32 v[174:175], v[174:175], v[178:179]
 v_pk_add_f32 v[172:173], v[172:173], v[180:181]
 v_pk_add_f32 v[174:175], v[174:175], v[182:183]
 v_pk_add_f32 v[172:173], v[172:173], v[184:185]
 v_pk_add_f32 v[174:175], v[174:175], v[186:187]
 v_cvt_pk_bf16_f32 v176, v172, v173
 v_cvt_pk_bf16_f32 v177, v174, v175
 s_cmp_lg_u32 s42, 0
 s_cbranch_scc1 Lzw_84
 s_waitcnt vmcnt(24)
 s_branch Lzw_85
Lzw_84:
 s_waitcnt vmcnt(0)
Lzw_85:
 buffer_store_dwordx2 v[176:177], v245, s[8:11], s44 offen sc1
 s_cmp_lg_u32 s42, 0
 s_cbranch_scc1 Ld1_86
 v_mov_b32 v90, 0
 v_mov_b32 v91, 0
 v_mfma_f32_32x32x16_bf16 v[172:187], v[136:139], v[148:151], 0
 v_mfma_f32_32x32x16_bf16 v[172:187], v[140:143], v[152:155], v[172:187]
 s_nop 11
 v_max3_f32 v170, v172, v173, v174
 v_min3_f32 v171, v172, v173, v174
 s_mov_b32 s70, fnet_tab-Lpc+15360
 buffer_load_dwordx4 a[240:243], v7, s[32:35], s70 offen
 v_max3_f32 v170, v170, v175, v176
 v_min3_f32 v171, v171, v175, v176
 v_max3_f32 v170, v170, v177, v178
 v_min3_f32 v171, v171, v177, v178
 v_max3_f32 v170, v170, v179, v180
 v_min3_f32 v171, v171, v179, v180
 s_mov_b32 s70, fnet_tab-Lpc+16384
 buffer_load_dwordx4 a[244:247], v7, s[32:35], s70 offen
 v_max_f32 v170, v170, v181
 v_min_f32 v171, v171, v181
 v_mov_b32 v241, v170
 v_mov_b32 v6, v171
 s_nop 0
 v_permlane32_swap_b32 v241, v170
 s_min_u32 s70, s4, 20
 s_lshl_b32 s70, s70, 11
 s_add_u32 s70, s70, fnet_tab-Lpc+20480
 buffer_load_dwordx4 a[232:235], v7, s[32:35], s70 offen
 v_permlane32_swap_b32 v6, v171
 v_max_f32 v170, v170, v241
 v_min_f32_e64 v171, v171, v6
 v_mul_f32 v170, 0xbfb8aa3b, v170
 v_mul_f32 v171, 0x3fb8aa3b, v171
 s_min_u32 s70, s4, 20
 s_lshl_b32 s70, s70, 11
 s_add_u32 s70, s70, fnet_tab-Lpc+21504
 buffer_load_dwordx4 a[236:239], v7, s[32:35], s70 offen
 v_pk_fma_f32 v[188:189], v[172:173], s[52:53], v[170:171] op_sel_hi:[1,1,0]
 v_pk_fma_f32 v[198:199], v[172:173], s[52:53], v[170:171] op_sel:[0,0,1] op_sel_hi:[1,1,1] neg_lo:[1,0,0] neg_hi:[1,0,0]
 v_pk_fma_f32 v[190:191], v[174:175], s[52:53], v[170:171] op_sel_hi:[1,1,0]
 v_pk_fma_f32 v[200:201], v[174:175], s[52:53], v[170:171] op_sel:[0,0,1] op_sel_hi:[1,1,1] neg_lo:[1,0,0] neg_hi:[1,0,0]
 v_pk_fma_f32 v[192:193], v[176:177], s[52:53], v[170:171] op_sel_hi:[1,1,0]
 v_pk_fma_f32 v[202:203], v[176:177], s[52:53], v[170:171] op_sel:[0,0,1] op_sel_hi:[1,1,1] neg_lo:[1,0,0] neg_hi:[1,0,0]
 s_mov_b32 s70, fnet_tab-Lpc+17408
 buffer_load_dwordx4 a[248:251], v7, s[32:35], s70 offen
 v_pk_fma_f32 v[194:195], v[178:179], s[52:53], v[170:171] op_sel_hi:[1,1,0]
 v_pk_fma_f32 v[204:205], v[178:179], s[52:53], v[170:171] op_sel:[0,0,1] op_sel_hi:[1,1,1] neg_lo:[1,0,0] neg_hi:[1,0,0]
 v_pk_fma_f32 v[196:197], v[180:181], s[52:53], v[170:171] op_sel_hi:[1,1,0]
 v_pk_fma_f32 v[206:207], v[180:181], s[52:53], v[170:171] op_sel:[0,0,1] op_sel_hi:[1,1,1] neg_lo:[1,0,0] neg_hi:[1,0,0]
 v_exp_f32_e64 v188, v188
 v_exp_f32 v198, v198
 s_or_b32 s70, s3, s4
 s_min_u32 s70, s70, 1
 s_lshl_b32 s70, s70, 10
 s_sub_u32 s70, fnet_tab-Lpc+19456, s70
 buffer_load_dwordx4 a[252:255], v7, s[32:35], s70 offen
 v_exp_f32 v189, v189
 v_exp_f32 v199, v199
 v_exp_f32 v190, v190
 v_exp_f32 v200, v200
 v_exp_f32_e64 v191, v191
 v_exp_f32 v201, v201
 s_lshl_b32 s70, s3, 2
 s_add_u32 s70, s70, s5
 s_lshl_b32 s70, s70, 12
 s_add_u32 s70, s70, fnet_tab-Lpc+63488
 buffer_load_dwordx4 a[200:203], v7, s[32:35], s70 offen
 v_exp_f32 v192, v192
 v_exp_f32 v202, v202
 v_exp_f32 v193, v193
 v_exp_f32 v203, v203
 v_exp_f32 v194, v194
 s_lshl_b32 s70, s3, 2
 s_add_u32 s70, s70, s5
 s_lshl_b32 s70, s70, 12
 s_add_u32 s70, s70, fnet_tab-Lpc+64512
 buffer_load_dwordx4 a[208:211], v7, s[32:35], s70 offen
 v_exp_f32 v204, v204
 v_exp_f32 v195, v195
 v_exp_f32 v205, v205
 v_exp_f32 v196, v196
 v_exp_f32_e64 v206, v206
 v_exp_f32 v197, v197
 s_lshl_b32 s70, s3, 2
 s_add_u32 s70, s70, s5
 s_lshl_b32 s70, s70, 12
 s_add_u32 s70, s70, fnet_tab-Lpc+65536
 buffer_load_dwordx4 a[216:219], v7, s[32:35], s70 offen
 v_exp_f32 v207, v207
 v_pk_add_f32 v[172:173], v[188:189], v[190:191]
 v_pk_add_f32 v[174:175], v[192:193], v[194:195]
 v_pk_add_f32 v[176:177], v[198:199], v[200:201]
 v_pk_add_f32 v[178:179], v[202:203], v[204:205]
 v_pk_add_f32 v[172:173], v[172:173], v[196:197]
 s_lshl_b32 s70, s3, 2
 s_add_u32 s70, s70, s5
 s_lshl_b32 s70, s70, 12
 s_add_u32 s70, s70, fnet_tab-Lpc+66560
 buffer_load_dwordx4 a[224:227], v7, s[32:35], s70 offen
 v_pk_add_f32 v[176:177], v[176:177], v[206:207]
 v_pk_add_f32 v[172:173], v[172:173], v[174:175]
 v_pk_add_f32 v[176:177], v[176:177], v[178:179]
 v_add_f32 v6, v172, v173
 v_add_f32 v240, v176, v177
 v_mov_b32_e64 v241, v6
 s_add_u32 s70, s68, 86016
 buffer_load_dwordx4 a[96:99], v7, s[8:11], s70 offen
 v_mov_b32 v170, v240
 s_nop 0
 v_permlane32_swap_b32 v241, v6
 v_permlane32_swap_b32 v170, v240
 v_add_f32_e64 v6, v6, v241
 s_add_u32 s70, s68, 5120
 buffer_load_dwordx4 a[100:103], v7, s[8:11], s70 offen
 v_add_f32 v240, v240, v170
 v_rcp_f32 v172, v6
 v_rcp_f32_e64 v174, v240
 v_pk_mul_f32 v[188:189], v[188:189], v[172:173] op_sel_hi:[1,0]
 v_pk_mul_f32 v[198:199], v[198:199], v[174:175] op_sel_hi:[1,0]
 v_pk_mul_f32 v[190:191], v[190:191], v[172:173] op_sel_hi:[1,0]
 s_add_u32 s70, s68, 25600
 buffer_load_dwordx4 a[104:107], v7, s[8:11], s70 offen
 v_pk_mul_f32 v[200:201], v[200:201], v[174:175] op_sel_hi:[1,0]
 v_pk_mul_f32 v[192:193], v[192:193], v[172:173] op_sel_hi:[1,0]
 v_pk_mul_f32 v[202:203], v[202:203], v[174:175] op_sel_hi:[1,0]
 v_pk_mul_f32 v[194:195], v[194:195], v[172:173] op_sel_hi:[1,0]
 v_pk_mul_f32 v[204:205], v[204:205], v[174:175] op_sel_hi:[1,0]
 v_pk_mul_f32 v[196:197], v[196:197], v[172:173] op_sel_hi:[1,0]
 s_add_u32 s70, s68, 46080
 buffer_load_dwordx4 a[108:111], v7, s[8:11], s70 offen
 v_pk_mul_f32 v[206:207], v[206:207], v[174:175] op_sel_hi:[1,0]
 v_cvt_pk_bf16_f32 v80, v188, v189
 v_cvt_pk_bf16_f32 v85, v198, v199
 v_cvt_pk_bf16_f32 v81, v190, v191
 v_cvt_pk_bf16_f32 v86, v200, v201
 v_cvt_pk_bf16_f32 v82, v192, v193
 s_add_u32 s70, s68, 66560
 buffer_load_dwordx4 a[112:115], v7, s[8:11], s70 offen
 v_cvt_pk_bf16_f32 v87, v202, v203
 v_cvt_pk_bf16_f32 v83, v194, v195
 v_cvt_pk_bf16_f32 v88, v204, v205
 v_cvt_pk_bf16_f32 v84, v196, v197
 v_cvt_pk_bf16_f32 v89, v206, v207
 s_branch Ld2_87
Ld1_86:
 v_mov_b32 v90, 0
 v_mov_b32 v91, 0
 v_mfma_f32_32x32x16_bf16 v[172:187], v[136:139], v[148:151], 0
 v_mfma_f32_32x32x16_bf16 v[172:187], v[140:143], v[152:155], v[172:187]
 s_nop 11
 v_max3_f32 v170, v172, v173, v174
 v_min3_f32 v171, v172, v173, v174
 v_max3_f32 v170, v170, v175, v176
 v_min3_f32 v171, v171, v175, v176
 v_max3_f32 v170, v170, v177, v178
 v_min3_f32 v171, v171, v177, v178
 v_max3_f32 v170, v170, v179, v180
 v_min3_f32 v171, v171, v179, v180
 v_max_f32 v170, v170, v181
 v_min_f32 v171, v171, v181
 v_mov_b32 v241, v170
 v_mov_b32 v6, v171
 s_nop 0
 v_permlane32_swap_b32 v241, v170
 v_permlane32_swap_b32 v6, v171
 v_max_f32 v170, v170, v241
 v_min_f32_e64 v171, v171, v6
 v_mul_f32 v170, 0xbfb8aa3b, v170
 v_mul_f32 v171, 0x3fb8aa3b, v171
 v_pk_fma_f32 v[188:189], v[172:173], s[52:53], v[170:171] op_sel_hi:[1,1,0]
 v_pk_fma_f32 v[198:199], v[172:173], s[52:53], v[170:171] op_sel:[0,0,1] op_sel_hi:[1,1,1] neg_lo:[1,0,0] neg_hi:[1,0,0]
 v_pk_fma_f32 v[190:191], v[174:175], s[52:53], v[170:171] op_sel_hi:[1,1,0]
 v_pk_fma_f32 v[200:201], v[174:175], s[52:53], v[170:171] op_sel:[0,0,1] op_sel_hi:[1,1,1] neg_lo:[1,0,0] neg_hi:[1,0,0]
 v_pk_fma_f32 v[192:193], v[176:177], s[52:53], v[170:171] op_sel_hi:[1,1,0]
 v_pk_fma_f32 v[202:203], v[176:177], s[52:53], v[170:171] op_sel:[0,0,1] op_sel_hi:[1,1,1] neg_lo:[1,0,0] neg_hi:[1,0,0]
 v_pk_fma_f32 v[194:195], v[178:179], s[52:53], v[170:171] op_sel_hi:[1,1,0]
 v_pk_fma_f32 v[204:205], v[178:179], s[52:53], v[170:171] op_sel:[0,0,1] op_sel_hi:[1,1,1] neg_lo:[1,0,0] neg_hi:[1,0,0]
 v_pk_fma_f32 v[196:197], v[180:181], s[52:53], v[170:171] op_sel_hi:[1,1,0]
 v_pk_fma_f32 v[206:207], v[180:181], s[52:53], v[170:171] op_sel:[0,0,1] op_sel_hi:[1,1,1] neg_lo:[1,0,0] neg_hi:[1,0,0]
 v_exp_f32 v188, v188
 v_exp_f32 v198, v198
 v_exp_f32 v189, v189
 v_exp_f32 v199, v199
 v_exp_f32 v190, v190
 v_exp_f32 v200, v200
 v_exp_f32 v191, v191
 v_exp_f32 v201, v201
 v_exp_f32 v192, v192
 v_exp_f32 v202, v202
 v_exp_f32 v193, v193
 v_exp_f32 v203, v203
 v_exp_f32 v194, v194
 v_exp_f32 v204, v204
 v_exp_f32 v195, v195
 v_exp_f32 v205, v205
 v_exp_f32 v196, v196
 v_exp_f32 v206, v206
 v_exp_f32 v197, v197
 v_exp_f32 v207, v207
 v_pk_add_f32 v[172:173], v[188:189], v[190:191]
 v_pk_add_f32 v[174:175], v[192:193], v[194:195]
 v_pk_add_f32 v[176:177], v[198:199], v[200:201]
 v_pk_add_f32 v[178:179], v[202:203], v[204:205]
 v_pk_add_f32 v[172:173], v[172:173], v[196:197]
 v_pk_add_f32 v[176:177], v[176:177], v[206:207]
 v_pk_add_f32 v[172:173], v[172:173], v[174:175]
 v_pk_add_f32 v[176:177], v[176:177], v[178:179]
 v_add_f32 v6, v172, v173
 v_add_f32 v240, v176, v177
 v_mov_b32 v241, v6
 v_mov_b32 v170, v240
 s_nop 0
 v_permlane32_swap_b32 v241, v6
 v_permlane32_swap_b32 v170, v240
 v_add_f32 v6, v6, v241
 v_add_f32 v240, v240, v170
 v_rcp_f32 v172, v6
 v_rcp_f32_e64 v174, v240
 v_pk_mul_f32 v[188:189], v[188:189], v[172:173] op_sel_hi:[1,0]
 v_pk_mul_f32 v[198:199], v[198:199], v[174:175] op_sel_hi:[1,0]
 v_pk_mul_f32 v[190:191], v[190:191], v[172:173] op_sel_hi:[1,0]
 v_pk_mul_f32 v[200:201], v[200:201], v[174:175] op_sel_hi:[1,0]
 v_pk_mul_f32 v[192:193], v[192:193], v[172:173] op_sel_hi:[1,0]
 v_pk_mul_f32 v[202:203], v[202:203], v[174:175] op_sel_hi:[1,0]
 v_pk_mul_f32 v[194:195], v[194:195], v[172:173] op_sel_hi:[1,0]
 v_pk_mul_f32 v[204:205], v[204:205], v[174:175] op_sel_hi:[1,0]
 v_pk_mul_f32 v[196:197], v[196:197], v[172:173] op_sel_hi:[1,0]
 v_pk_mul_f32 v[206:207], v[206:207], v[174:175] op_sel_hi:[1,0]
 v_cvt_pk_bf16_f32 v80, v188, v189
 v_cvt_pk_bf16_f32 v85, v198, v199
 v_cvt_pk_bf16_f32 v81, v190, v191
 v_cvt_pk_bf16_f32 v86, v200, v201
 v_cvt_pk_bf16_f32 v82, v192, v193
 v_cvt_pk_bf16_f32 v87, v202, v203
 v_cvt_pk_bf16_f32 v83, v194, v195
 v_cvt_pk_bf16_f32 v88, v204, v205
 v_cvt_pk_bf16_f32 v84, v196, v197
 v_cvt_pk_bf16_f32 v89, v206, v207
Ld2_87:
 s_mov_b32 s48, s71
 buffer_load_dwordx2 v[8:9], v245, s[8:11], s48 offen sc1
 s_add_u32 s48, s48, 2048
 buffer_load_dwordx2 v[10:11], v245, s[8:11], s48 offen sc1
 s_add_u32 s48, s48, 2048
 buffer_load_dwordx2 v[12:13], v245, s[8:11], s48 offen sc1
 s_add_u32 s48, s48, 2048
 buffer_load_dwordx2 v[14:15], v245, s[8:11], s48 offen sc1
 s_add_u32 s48, s48, 2048
 buffer_load_dwordx2 v[16:17], v245, s[8:11], s48 offen sc1
 s_add_u32 s48, s48, 2048
 buffer_load_dwordx2 v[18:19], v245, s[8:11], s48 offen sc1
 s_add_u32 s48, s48, 2048
 buffer_load_dwordx2 v[20:21], v245, s[8:11], s48 offen sc1
 s_add_u32 s48, s48, 2048
 buffer_load_dwordx2 v[22:23], v245, s[8:11], s48 offen sc1
 s_cmp_lg_u32 s42, 0
 s_cbranch_scc1 Ld1_88
 v_mov_b32 v106, 0
 v_mov_b32 v107, 0
 v_mfma_f32_32x32x16_bf16 v[172:187], v[136:139], v[156:159], 0
 v_mfma_f32_32x32x16_bf16 v[172:187], v[140:143], v[160:163], v[172:187]
 s_nop 11
 v_max3_f32 v170, v172, v173, v174
 v_min3_f32 v171, v172, v173, v174
 v_max3_f32 v170, v170, v175, v176
 v_min3_f32 v171, v171, v175, v176
 s_add_u32 s70, s68, 87040
 buffer_load_dwordx4 a[116:119], v7, s[8:11], s70 offen
 v_max3_f32 v170, v170, v177, v178
 v_min3_f32 v171, v171, v177, v178
 v_max3_f32 v170, v170, v179, v180
 v_min3_f32 v171, v171, v179, v180
 v_max_f32 v170, v170, v181
 v_min_f32 v171, v171, v181
 v_mov_b32 v241, v170
 v_mov_b32 v6, v171
 s_add_u32 s70, s68, 6144
 buffer_load_dwordx4 a[120:123], v7, s[8:11], s70 offen
 s_nop 0
 v_permlane32_swap_b32 v241, v170
 v_permlane32_swap_b32 v6, v171
 v_max_f32 v170, v170, v241
 v_min_f32_e64 v171, v171, v6
 v_mul_f32 v170, 0xbfb8aa3b, v170
 v_mul_f32 v171, 0x3fb8aa3b, v171
 s_add_u32 s70, s68, 26624
 buffer_load_dwordx4 a[124:127], v7, s[8:11], s70 offen
 v_pk_fma_f32 v[188:189], v[172:173], s[52:53], v[170:171] op_sel_hi:[1,1,0]
 v_pk_fma_f32 v[198:199], v[172:173], s[52:53], v[170:171] op_sel:[0,0,1] op_sel_hi:[1,1,1] neg_lo:[1,0,0] neg_hi:[1,0,0]
 v_pk_fma_f32 v[190:191], v[174:175], s[52:53], v[170:171] op_sel_hi:[1,1,0]
 v_pk_fma_f32 v[200:201], v[174:175], s[52:53], v[170:171] op_sel:[0,0,1] op_sel_hi:[1,1,1] neg_lo:[1,0,0] neg_hi:[1,0,0]
 v_pk_fma_f32 v[192:193], v[176:177], s[52:53], v[170:171] op_sel_hi:[1,1,0]
 v_pk_fma_f32 v[202:203], v[176:177], s[52:53], v[170:171] op_sel:[0,0,1] op_sel_hi:[1,1,1] neg_lo:[1,0,0] neg_hi:[1,0,0]
 v_pk_fma_f32 v[194:195], v[178:179], s[52:53], v[170:171] op_sel_hi:[1,1,0]
 v_pk_fma_f32 v[204:205], v[178:179], s[52:53], v[170:171] op_sel:[0,0,1] op_sel_hi:[1,1,1] neg_lo:[1,0,0] neg_hi:[1,0,0]
 s_add_u32 s70, s68, 47104
 buffer_load_dwordx4 a[128:131], v7, s[8:11], s70 offen
 v_pk_fma_f32 v[196:197], v[180:181], s[52:53], v[170:171] op_sel_hi:[1,1,0]
 v_pk_fma_f32 v[206:207], v[180:181], s[52:53], v[170:171] op_sel:[0,0,1] op_sel_hi:[1,1,1] neg_lo:[1,0,0] neg_hi:[1,0,0]
 v_exp_f32 v188, v188
 v_exp_f32 v198, v198
 v_exp_f32 v189, v189
 v_exp_f32 v199, v199
 v_exp_f32 v190, v190
 v_exp_f32 v200, v200
 s_add_u32 s70, s68, 67584
 buffer_load_dwordx4 a[132:135], v7, s[8:11], s70 offen
 v_exp_f32 v191, v191
 v_exp_f32 v201, v201
 v_exp_f32 v192, v192
 v_exp_f32 v202, v202
 v_exp_f32 v193, v193
 v_exp_f32 v203, v203
 v_exp_f32_e64 v194, v194
 s_add_u32 s70, s68, 88064
 buffer_load_dwordx4 a[136:139], v7, s[8:11], s70 offen
 v_exp_f32 v204, v204
 v_exp_f32 v195, v195
 v_exp_f32 v205, v205
 v_exp_f32 v196, v196
 v_exp_f32 v206, v206
 v_exp_f32 v197, v197
 v_exp_f32_e64 v207, v207
 v_pk_add_f32 v[172:173], v[188:189], v[190:191]
 s_add_u32 s70, s68, 7168
 buffer_load_dwordx4 a[140:143], v7, s[8:11], s70 offen
 v_pk_add_f32 v[174:175], v[192:193], v[194:195]
 v_pk_add_f32 v[176:177], v[198:199], v[200:201]
 v_pk_add_f32 v[178:179], v[202:203], v[204:205]
 v_pk_add_f32 v[172:173], v[172:173], v[196:197]
 v_pk_add_f32 v[176:177], v[176:177], v[206:207]
 v_pk_add_f32 v[172:173], v[172:173], v[174:175]
 v_pk_add_f32 v[176:177], v[176:177], v[178:179]
 v_add_f32_e64 v6, v172, v173
 s_add_u32 s70, s68, 27648
 buffer_load_dwordx4 a[144:147], v7, s[8:11], s70 offen
 v_add_f32 v240, v176, v177
 v_mov_b32 v241, v6
 v_mov_b32 v170, v240
 s_nop 0
 v_permlane32_swap_b32 v241, v6
 v_permlane32_swap_b32 v170, v240
 v_add_f32_e64 v6, v6, v241
 s_add_u32 s70, s68, 48128
 buffer_load_dwordx4 a[148:151], v7, s[8:11], s70 offen
 v_add_f32 v240, v240, v170
 v_rcp_f32 v172, v6
 v_rcp_f32_e64 v174, v240
 v_pk_mul_f32 v[188:189], v[188:189], v[172:173] op_sel_hi:[1,0]
 v_pk_mul_f32 v[198:199], v[198:199], v[174:175] op_sel_hi:[1,0]
 v_pk_mul_f32 v[190:191], v[190:191], v[172:173] op_sel_hi:[1,0]
 v_pk_mul_f32 v[200:201], v[200:201], v[174:175] op_sel_hi:[1,0]
 v_pk_mul_f32 v[192:193], v[192:193], v[172:173] op_sel_hi:[1,0]
 s_add_u32 s70, s68, 68608
 buffer_load_dwordx4 a[152:155], v7, s[8:11], s70 offen
 v_pk_mul_f32 v[202:203], v[202:203], v[174:175] op_sel_hi:[1,0]
 v_pk_mul_f32 v[194:195], v[194:195], v[172:173] op_sel_hi:[1,0]
 v_pk_mul_f32 v[204:205], v[204:205], v[174:175] op_sel_hi:[1,0]
 v_pk_mul_f32 v[196:197], v[196:197], v[172:173] op_sel_hi:[1,0]
 v_pk_mul_f32 v[206:207], v[206:207], v[174:175] op_sel_hi:[1,0]
 v_cvt_pk_bf16_f32 v96, v188, v189
 v_cvt_pk_bf16_f32 v101, v198, v199
 v_cvt_pk_bf16_f32 v97, v190, v191
 s_add_u32 s70, s68, 89088
 buffer_load_dwordx4 a[156:159], v7, s[8:11], s70 offen
 v_cvt_pk_bf16_f32 v102, v200, v201
 v_cvt_pk_bf16_f32 v98, v192, v193
 v_cvt_pk_bf16_f32 v103, v202, v203
 v_cvt_pk_bf16_f32 v99, v194, v195
 v_cvt_pk_bf16_f32 v104, v204, v205
 v_cvt_pk_bf16_f32 v100, v196, v197
 v_cvt_pk_bf16_f32 v105, v206, v207
 s_branch Ld2_89
Ld1_88:
 v_mov_b32 v106, 0
 v_mov_b32 v107, 0
 v_mfma_f32_32x32x16_bf16 v[172:187], v[136:139], v[156:159], 0
 v_mfma_f32_32x32x16_bf16 v[172:187], v[140:143], v[160:163], v[172:187]
 s_nop 11
 v_max3_f32 v170, v172, v173, v174
 v_min3_f32 v171, v172, v173, v174
 v_max3_f32 v170, v170, v175, v176
 v_min3_f32 v171, v171, v175, v176
 v_max3_f32 v170, v170, v177, v178
 v_min3_f32 v171, v171, v177, v178
 v_max3_f32 v170, v170, v179, v180
 v_min3_f32 v171, v171, v179, v180
 v_max_f32 v170, v170, v181
 v_min_f32 v171, v171, v181
 v_mov_b32 v241, v170
 v_mov_b32 v6, v171
 s_nop 0
 v_permlane32_swap_b32 v241, v170
 v_permlane32_swap_b32 v6, v171
 v_max_f32 v170, v170, v241
 v_min_f32_e64 v171, v171, v6
 v_mul_f32 v170, 0xbfb8aa3b, v170
 v_mul_f32 v171, 0x3fb8aa3b, v171
 v_pk_fma_f32 v[188:189], v[172:173], s[52:53], v[170:171] op_sel_hi:[1,1,0]
 v_pk_fma_f32 v[198:199], v[172:173], s[52:53], v[170:171] op_sel:[0,0,1] op_sel_hi:[1,1,1] neg_lo:[1,0,0] neg_hi:[1,0,0]
 v_pk_fma_f32 v[190:191], v[174:175], s[52:53], v[170:171] op_sel_hi:[1,1,0]
 v_pk_fma_f32 v[200:201], v[174:175], s[52:53], v[170:171] op_sel:[0,0,1] op_sel_hi:[1,1,1] neg_lo:[1,0,0] neg_hi:[1,0,0]
 v_pk_fma_f32 v[192:193], v[176:177], s[52:53], v[170:171] op_sel_hi:[1,1,0]
 v_pk_fma_f32 v[202:203], v[176:177], s[52:53], v[170:171] op_sel:[0,0,1] op_sel_hi:[1,1,1] neg_lo:[1,0,0] neg_hi:[1,0,0]
 v_pk_fma_f32 v[194:195], v[178:179], s[52:53], v[170:171] op_sel_hi:[1,1,0]
 v_pk_fma_f32 v[204:205], v[178:179], s[52:53], v[170:171] op_sel:[0,0,1] op_sel_hi:[1,1,1] neg_lo:[1,0,0] neg_hi:[1,0,0]
 v_pk_fma_f32 v[196:197], v[180:181], s[52:53], v[170:171] op_sel_hi:[1,1,0]
 v_pk_fma_f32 v[206:207], v[180:181], s[52:53], v[170:171] op_sel:[0,0,1] op_sel_hi:[1,1,1] neg_lo:[1,0,0] neg_hi:[1,0,0]
 v_exp_f32 v188, v188
 v_exp_f32 v198, v198
 v_exp_f32 v189, v189
 v_exp_f32 v199, v199
 v_exp_f32 v190, v190
 v_exp_f32 v200, v200
 v_exp_f32 v191, v191
 v_exp_f32 v201, v201
 v_exp_f32 v192, v192
 v_exp_f32 v202, v202
 v_exp_f32 v193, v193
 v_exp_f32 v203, v203
 v_exp_f32 v194, v194
 v_exp_f32 v204, v204
 v_exp_f32 v195, v195
 v_exp_f32 v205, v205
 v_exp_f32 v196, v196
 v_exp_f32 v206, v206
 v_exp_f32 v197, v197
 v_exp_f32 v207, v207
 v_pk_add_f32 v[172:173], v[188:189], v[190:191]
 v_pk_add_f32 v[174:175], v[192:193], v[194:195]
 v_pk_add_f32 v[176:177], v[198:199], v[200:201]
 v_pk_add_f32 v[178:179], v[202:203], v[204:205]
 v_pk_add_f32 v[172:173], v[172:173], v[196:197]
 v_pk_add_f32 v[176:177], v[176:177], v[206:207]
 v_pk_add_f32 v[172:173], v[172:173], v[174:175]
 v_pk_add_f32 v[176:177], v[176:177], v[178:179]
 v_add_f32 v6, v172, v173
 v_add_f32 v240, v176, v177
 v_mov_b32 v241, v6
 v_mov_b32 v170, v240
 s_nop 0
 v_permlane32_swap_b32 v241, v6
 v_permlane32_swap_b32 v170, v240
 v_add_f32 v6, v6, v241
 v_add_f32 v240, v240, v170
 v_rcp_f32 v172, v6
 v_rcp_f32_e64 v174, v240
 v_pk_mul_f32 v[188:189], v[188:189], v[172:173] op_sel_hi:[1,0]
 v_pk_mul_f32 v[198:199], v[198:199], v[174:175] op_sel_hi:[1,0]
 v_pk_mul_f32 v[190:191], v[190:191], v[172:173] op_sel_hi:[1,0]
 v_pk_mul_f32 v[200:201], v[200:201], v[174:175] op_sel_hi:[1,0]
 v_pk_mul_f32 v[192:193], v[192:193], v[172:173] op_sel_hi:[1,0]
 v_pk_mul_f32 v[202:203], v[202:203], v[174:175] op_sel_hi:[1,0]
 v_pk_mul_f32 v[194:195], v[194:195], v[172:173] op_sel_hi:[1,0]
 v_pk_mul_f32 v[204:205], v[204:205], v[174:175] op_sel_hi:[1,0]
 v_pk_mul_f32 v[196:197], v[196:197], v[172:173] op_sel_hi:[1,0]
 v_pk_mul_f32 v[206:207], v[206:207], v[174:175] op_sel_hi:[1,0]
 v_cvt_pk_bf16_f32 v96, v188, v189
 v_cvt_pk_bf16_f32 v101, v198, v199
 v_cvt_pk_bf16_f32 v97, v190, v191
 v_cvt_pk_bf16_f32 v102, v200, v201
 v_cvt_pk_bf16_f32 v98, v192, v193
 v_cvt_pk_bf16_f32 v103, v202, v203
 v_cvt_pk_bf16_f32 v99, v194, v195
 v_cvt_pk_bf16_f32 v104, v204, v205
 v_cvt_pk_bf16_f32 v100, v196, v197
 v_cvt_pk_bf16_f32 v105, v206, v207
Ld2_89:
 v_mul_u32_u24 v117, 10923, v0
 v_lshrrev_b32 v117, 16, v117
 v_mul_u32_u24 v2, 6, v117
 v_sub_u32_e64 v118, v0, v2
 v_cmp_lt_u32 vcc, 19, v117
 s_nop 1
 v_cndmask_b32_e64 v119, 0, 1, vcc
 v_mul_u32_u24 v2, 20, v119
 v_sub_u32 v120, v117, v2
 v_mul_u32_u24_e64 v119, 48, v119
 v_lshl_add_u32 v119, v120, 1, v119
 v_add_u32 v119, 150784, v119
 v_lshl_add_u32 v121, v118, 2, 0
 v_cmp_lt_u32 vcc, 9, v121
 s_nop 1
 v_cndmask_b32_e64 v2, 0, 1, vcc
 v_mul_u32_u24 v3, 10, v2
 v_sub_u32 v3, v121, v3
 v_lshrrev_b32 v122, 2, v3
 v_lshlrev_b32 v122, 3, v122
 v_lshl_add_u32 v122, v2, 2, v122
 v_and_b32 v3, 3, v3
 v_add_u32 v122, v122, v3
 v_cmp_eq_u32 vcc, 20, v121
 s_nop 1
 v_cndmask_b32_e64 v122, v122, 18, vcc
 v_mul_u32_u24 v112, 96, v122
 v_add_u32_e64 v112, v112, v119
 v_mov_b32 v3, 154368
 v_cmp_lt_u32 vcc, 20, v121
 s_nop 1
 v_cndmask_b32_e64 v112, v112, v3, vcc
 v_cmp_lt_u32 vcc, 239, v0
 s_nop 1
 v_cndmask_b32 v112, v112, v3, vcc
 v_lshl_add_u32 v121, v118, 2, 1
 v_cmp_lt_u32 vcc, 9, v121
 s_nop 1
 v_cndmask_b32_e64 v2, 0, 1, vcc
 v_mul_u32_u24 v3, 10, v2
 v_sub_u32 v3, v121, v3
 v_lshrrev_b32 v122, 2, v3
 v_lshlrev_b32 v122, 3, v122
 v_lshl_add_u32 v122, v2, 2, v122
 v_and_b32 v3, 3, v3
 v_add_u32 v122, v122, v3
 v_cmp_eq_u32 vcc, 20, v121
 s_nop 1
 v_cndmask_b32_e64 v122, v122, 18, vcc
 v_mul_u32_u24 v113, 96, v122
 v_add_u32_e64 v113, v113, v119
 v_mov_b32 v3, 154368
 v_cmp_lt_u32 vcc, 20, v121
 s_nop 1
 v_cndmask_b32_e64 v113, v113, v3, vcc
 v_cmp_lt_u32 vcc, 239, v0
 s_nop 1
 v_cndmask_b32 v113, v113, v3, vcc
 v_lshl_add_u32 v121, v118, 2, 2
 v_cmp_lt_u32 vcc, 9, v121
 s_nop 1
 v_cndmask_b32_e64 v2, 0, 1, vcc
 v_mul_u32_u24 v3, 10, v2
 v_sub_u32 v3, v121, v3
 v_lshrrev_b32 v122, 2, v3
 v_lshlrev_b32 v122, 3, v122
 v_lshl_add_u32 v122, v2, 2, v122
 v_and_b32 v3, 3, v3
 v_add_u32 v122, v122, v3
 v_cmp_eq_u32 vcc, 20, v121
 s_nop 1
 v_cndmask_b32_e64 v122, v122, 18, vcc
 v_mul_u32_u24 v114, 96, v122
 v_add_u32_e64 v114, v114, v119
 v_mov_b32 v3, 154368
 v_cmp_lt_u32 vcc, 20, v121
 s_nop 1
 v_cndmask_b32_e64 v114, v114, v3, vcc
 v_cmp_lt_u32 vcc, 239, v0
 s_nop 1
 v_cndmask_b32 v114, v114, v3, vcc
 v_lshl_add_u32 v121, v118, 2, 3
 v_cmp_lt_u32 vcc, 9, v121
 s_nop 1
 v_cndmask_b32_e64 v2, 0, 1, vcc
 v_mul_u32_u24 v3, 10, v2
 v_sub_u32 v3, v121, v3
 v_lshrrev_b32 v122, 2, v3
 v_lshlrev_b32 v122, 3, v122
 v_lshl_add_u32 v122, v2, 2, v122
 v_and_b32 v3, 3, v3
 v_add_u32 v122, v122, v3
 v_cmp_eq_u32 vcc, 20, v121
 s_nop 1
 v_cndmask_b32_e64 v122, v122, 18, vcc
 v_mul_u32_u24 v115, 96, v122
 v_add_u32_e64 v115, v115, v119
 v_mov_b32 v3, 154368
 v_cmp_lt_u32 vcc, 20, v121
 s_nop 1
 v_cndmask_b32_e64 v115, v115, v3, vcc
 v_cmp_lt_u32 vcc, 239, v0
 s_nop 1
 v_cndmask_b32 v115, v115, v3, vcc
 v_add_u32 v116, 384, v112
 v_mov_b32 v3, 154368
 v_cmp_ne_u32 vcc, 5, v118
 s_nop 1
 v_cndmask_b32 v116, v116, v3, vcc
 v_cmp_lt_u32 vcc, 239, v0
 s_nop 1
 v_cndmask_b32 v116, v116, v3, vcc
 s_mov_b32 s39, 262144
 s_cmp_lg_u32 s42, 0
 s_cbranch_scc1 Lkvp_90
 s_waitcnt vmcnt(11)
 s_branch Lkvc_92
Lkvp_90:
 s_waitcnt vmcnt(0)
Lkvc_92:
 v_max3_u32 v24, v8, v9, v10
 v_max3_u32 v24, v24, v11, v12
 v_max3_u32 v24, v24, v13, v14
 v_max3_u32 v24, v24, v15, v16
 v_max3_u32 v24, v24, v17, v18
 v_max3_u32 v24, v24, v19, v20
 v_max3_u32 v24, v24, v21, v22
 v_max_u32 v24, v24, v23
 v_cmp_eq_u32 vcc, -1, v24
 s_cbranch_vccz Lkvd_91
 s_mov_b32 s48, s71
 buffer_load_dwordx2 v[8:9], v245, s[8:11], s48 offen sc1
 s_add_u32 s48, s48, 2048
 buffer_load_dwordx2 v[10:11], v245, s[8:11], s48 offen sc1
 s_add_u32 s48, s48, 2048
 buffer_load_dwordx2 v[12:13], v245, s[8:11], s48 offen sc1
 s_add_u32 s48, s48, 2048
 buffer_load_dwordx2 v[14:15], v245, s[8:11], s48 offen sc1
 s_add_u32 s48, s48, 2048
 buffer_load_dwordx2 v[16:17], v245, s[8:11], s48 offen sc1
 s_add_u32 s48, s48, 2048
 buffer_load_dwordx2 v[18:19], v245, s[8:11], s48 offen sc1
 s_add_u32 s48, s48, 2048
 buffer_load_dwordx2 v[20:21], v245, s[8:11], s48 offen sc1
 s_add_u32 s48, s48, 2048
 buffer_load_dwordx2 v[22:23], v245, s[8:11], s48 offen sc1
 s_sub_u32 s39, s39, 1
 s_cmp_lg_u32 s39, 0
 s_cbranch_scc1 Lkvp_90
 s_waitcnt vmcnt(0)
Lkvd_91:
 v_lshlrev_b32_e64 v28, 16, v8
 v_and_b32 v29, 0xffff0000, v8
 v_lshlrev_b32_e64 v30, 16, v9
 v_and_b32 v31, 0xffff0000, v9
 v_lshlrev_b32_e64 v36, 16, v10
 v_and_b32 v37, 0xffff0000, v10
 v_lshlrev_b32_e64 v38, 16, v11
 v_and_b32 v39, 0xffff0000, v11
 v_pk_add_f32 v[28:29], v[28:29], v[36:37]
 v_pk_add_f32 v[30:31], v[30:31], v[38:39]
 v_lshlrev_b32_e64 v36, 16, v12
 v_and_b32 v37, 0xffff0000, v12
 v_lshlrev_b32_e64 v38, 16, v13
 v_and_b32 v39, 0xffff0000, v13
 v_pk_add_f32 v[28:29], v[28:29], v[36:37]
 v_pk_add_f32 v[30:31], v[30:31], v[38:39]
 v_lshlrev_b32_e64 v36, 16, v14
 v_and_b32 v37, 0xffff0000, v14
 v_lshlrev_b32_e64 v38, 16, v15
 v_and_b32 v39, 0xffff0000, v15
 v_pk_add_f32 v[28:29], v[28:29], v[36:37]
 v_pk_add_f32 v[30:31], v[30:31], v[38:39]
 v_lshlrev_b32_e64 v36, 16, v16
 v_and_b32 v37, 0xffff0000, v16
 v_lshlrev_b32_e64 v38, 16, v17
 v_and_b32 v39, 0xffff0000, v17
 v_pk_add_f32 v[28:29], v[28:29], v[36:37]
 v_pk_add_f32 v[30:31], v[30:31], v[38:39]
 v_lshlrev_b32_e64 v36, 16, v18
 v_and_b32 v37, 0xffff0000, v18
 v_lshlrev_b32_e64 v38, 16, v19
 v_and_b32 v39, 0xffff0000, v19
 v_pk_add_f32 v[28:29], v[28:29], v[36:37]
 v_pk_add_f32 v[30:31], v[30:31], v[38:39]
 v_lshlrev_b32_e64 v36, 16, v20
 v_and_b32 v37, 0xffff0000, v20
 v_lshlrev_b32_e64 v38, 16, v21
 v_and_b32 v39, 0xffff0000, v21
 v_pk_add_f32 v[28:29], v[28:29], v[36:37]
 v_pk_add_f32 v[30:31], v[30:31], v[38:39]
 v_lshlrev_b32_e64 v36, 16, v22
 v_and_b32 v37, 0xffff0000, v22
 v_lshlrev_b32_e64 v38, 16, v23
 v_and_b32 v39, 0xffff0000, v23
 v_pk_add_f32 v[28:29], v[28:29], v[36:37]
 v_pk_add_f32 v[30:31], v[30:31], v[38:39]
 v_cvt_pk_bf16_f32 v44, v28, v29
 v_cvt_pk_bf16_f32 v45, v30, v31
 ds_write_b16 v112, v44
 ds_write_b16_d16_hi v113, v44
 ds_write_b16 v114, v45
 ds_write_b16_d16_hi v115, v45
 ds_write_b16 v116, v44
 s_waitcnt lgkmcnt(0)
 s_barrier
 v_and_b32_e64 v2, 31, v1
 v_mul_u32_u24 v2, 96, v2
 v_lshrrev_b32 v3, 5, v1
 v_mul_u32_u24 v3, 48, v3
 v_add_u32_e64 v2, v2, v3
 v_add_u32 v2, 150784, v2
 ds_read_b128 v[228:231], v2 offset:0
 ds_read_b128 v[232:235], v2 offset:16
 ds_read_b128 v[236:239], v2 offset:32
 v_bfe_u32 v2, v1, 4, 1
 v_mul_u32_u24 v241, 20480, v2
 v_and_b32_e64 v2, 15, v1
 v_lshl_add_u32 v240, v2, 3, v241
 v_lshl_add_u32 v241, v2, 4, v241
 v_lshrrev_b32 v3, 5, v1
 v_lshl_add_u32 v241, v3, 8, v241
 s_mul_i32 s44, s3, 344064
 s_add_u32 s44, s44, s58
 s_mul_i32 s45, s5, 81920
 s_add_u32 s44, s44, s45
 s_lshl_b32 s45, s4, 7
 s_add_u32 s45, s45, s44
 s_add_u32 s45, s45, 16384
 s_lshr_b32 s46, s4, 1
 s_lshl_b32 s46, s46, 10
 s_add_u32 s44, s44, s46
 s_and_b32 s46, s4, 1
 s_lshl_b32 s46, s46, 9
 s_add_u32 s44, s44, s46
 s_waitcnt lgkmcnt(0)
 v_mfma_f32_32x32x16_bf16 v[48:63], v[228:231], v[80:83], 0
 v_mfma_f32_32x32x16_bf16 v[48:63], v[232:235], v[84:87], v[48:63]
 v_mfma_f32_32x32x16_bf16 v[48:63], v[236:239], v[88:91], v[48:63]
 v_mfma_f32_32x32x16_bf16 v[64:79], v[228:231], v[96:99], 0
 v_mfma_f32_32x32x16_bf16 v[64:79], v[232:235], v[100:103], v[64:79]
 v_mfma_f32_32x32x16_bf16 v[64:79], v[236:239], v[104:107], v[64:79]
 s_nop 8
 v_add_f32 v170, 0x358637bd, v58
 v_rcp_f32_e64 v170, v170
 s_nop 0
 v_pk_mul_f32 v[48:49], v[48:49], v[170:171] op_sel_hi:[1,0]
 v_pk_mul_f32 v[50:51], v[50:51], v[170:171] op_sel_hi:[1,0]
 v_pk_mul_f32 v[52:53], v[52:53], v[170:171] op_sel_hi:[1,0]
 v_pk_mul_f32 v[54:55], v[54:55], v[170:171] op_sel_hi:[1,0]
 v_pk_mul_f32 v[56:57], v[56:57], v[170:171] op_sel_hi:[1,0]
 v_cvt_pk_bf16_f32 v80, v48, v49
 v_cvt_pk_bf16_f32 v81, v50, v51
 v_cvt_pk_bf16_f32 v82, v52, v53
 v_cvt_pk_bf16_f32 v83, v54, v55
 v_cvt_pk_bf16_f32 v84, v56, v57
 buffer_store_dwordx4 v[80:83], v241, s[8:11], s44 offen sc1
 v_mov_b32_e64 v86, v84
 v_mov_b32 v87, v84
 s_nop 1
 v_permlane32_swap_b32 v86, v87
 s_mov_b64 s[6:7], exec
 s_mov_b32 exec_hi, 0
 buffer_store_dwordx2 v[86:87], v240, s[8:11], s45 offen sc1
 s_mov_b64 exec, s[6:7]
 v_add_f32 v170, 0x358637bd, v74
 v_rcp_f32 v170, v170
 s_nop 0
 v_pk_mul_f32 v[64:65], v[64:65], v[170:171] op_sel_hi:[1,0]
 v_pk_mul_f32 v[66:67], v[66:67], v[170:171] op_sel_hi:[1,0]
 v_pk_mul_f32 v[68:69], v[68:69], v[170:171] op_sel_hi:[1,0]
 v_pk_mul_f32 v[70:71], v[70:71], v[170:171] op_sel_hi:[1,0]
 v_pk_mul_f32 v[72:73], v[72:73], v[170:171] op_sel_hi:[1,0]
 v_cvt_pk_bf16_f32 v96, v64, v65
 v_cvt_pk_bf16_f32 v97, v66, v67
 v_cvt_pk_bf16_f32 v98, v68, v69
 v_cvt_pk_bf16_f32 v99, v70, v71
 v_cvt_pk_bf16_f32 v100, v72, v73
 s_add_u32 s44, s44, 40960
 s_add_u32 s45, s45, 40960
 buffer_store_dwordx4 v[96:99], v241, s[8:11], s44 offen sc1
 v_mov_b32 v102, v100
 v_mov_b32 v103, v100
 s_nop 1
 v_permlane32_swap_b32 v102, v103
 s_mov_b64 s[6:7], exec
 s_mov_b32 exec_hi, 0
 buffer_store_dwordx2 v[102:103], v240, s[8:11], s45 offen sc1
 s_mov_b64 exec, s[6:7]
 s_waitcnt vmcnt(0) lgkmcnt(0)
 s_barrier
 s_add_u32 s40, s40, 1
 s_cmp_lg_u32 s5, 0
 s_cbranch_scc1 Llb_93
 v_mov_b32_e64 v3, s40
 s_mov_b64 s[6:7], exec
 s_mov_b64 exec, 1
 buffer_store_dword v3, v4, s[8:11], 0 offen sc1
 s_mov_b64 exec, s[6:7]
Llb_93:
 s_cmp_lg_u32 s42, 0
 s_cbranch_scc1 Lcst_94
 s_add_u32 s70, s69, 0
 buffer_load_dwordx4 a[160:163], v7, s[8:11], s70 offen
 s_add_u32 s70, s69, 20480
 buffer_load_dwordx4 a[164:167], v7, s[8:11], s70 offen
 s_add_u32 s70, s69, 40960
 buffer_load_dwordx4 a[168:171], v7, s[8:11], s70 offen
 s_add_u32 s70, s69, 61440
 buffer_load_dwordx4 a[172:175], v7, s[8:11], s70 offen
 s_add_u32 s70, s69, 81920
 buffer_load_dwordx4 a[176:179], v7, s[8:11], s70 offen
 s_add_u32 s70, s69, 1024
 buffer_load_dwordx4 a[180:183], v7, s[8:11], s70 offen
 s_add_u32 s70, s69, 21504
 buffer_load_dwordx4 a[184:187], v7, s[8:11], s70 offen
 s_add_u32 s70, s69, 41984
 buffer_load_dwordx4 a[188:191], v7, s[8:11], s70 offen
 s_add_u32 s70, s69, 62464
 buffer_load_dwordx4 a[192:195], v7, s[8:11], s70 offen
 s_add_u32 s70, s69, 82944
 buffer_load_dwordx4 a[196:199], v7, s[8:11], s70 offen
Lcst_94:
 s_and_b32 s44, s4, 3
 s_lshl_b32 s44, s44, 6
 s_and_b32 s45, s5, 1
 s_lshl_b32 s45, s45, 5
 s_add_u32 s44, s44, s45
 s_lshr_b32 s45, s5, 1
 s_lshl_b32 s45, s45, 4
 s_add_u32 s44, s44, s45
 v_and_b32 v2, 15, v1
 v_add_u32 v6, s44, v2
 v_lshrrev_b32_e64 v2, 5, v6
 v_mul_u32_u24 v26, 40960, v2
 v_and_b32_e64 v2, 31, v6
 v_lshl_add_u32 v26, v2, 4, v26
 v_lshrrev_b32 v27, 4, v1
 s_lshr_b32 s45, s4, 2
 v_lshrrev_b32 v2, 1, v27
 v_lshlrev_b32 v25, 3, v2
 v_add_u32 v25, s45, v25
 v_and_b32 v2, 1, v27
 v_lshl_add_u32 v25, v2, 4, v25
 v_add_u32_e64 v8, 2, v25
 v_sub_u32 v2, 120, v25
 v_cmp_lt_u32 vcc, 39, v25
 s_nop 1
 v_cndmask_b32_e64 v8, v8, v2, vcc
 v_cmp_eq_u32 vcc, 0, v25
 s_nop 1
 v_cndmask_b32_e64 v8, v8, 0, vcc
 v_cmp_eq_u32 vcc, 40, v25
 s_nop 1
 v_cndmask_b32_e64 v8, v8, 1, vcc
 v_cmp_eq_u32 vcc, 1, v25
 s_nop 1
 v_cndmask_b32_e64 v8, v8, 2, vcc
 v_cmp_eq_u32 vcc, 79, v25
 s_nop 1
 v_cndmask_b32_e64 v8, v8, 3, vcc
 v_lshl_add_u32 v8, v8, 9, v26
 v_lshrrev_b32 v2, 1, v27
 v_lshlrev_b32 v25, 3, v2
 v_add_u32 v25, s45, v25
 v_and_b32_e64 v2, 1, v27
 v_lshl_add_u32 v25, v2, 4, v25
 v_add_u32 v25, 32, v25
 v_add_u32 v9, 2, v25
 v_sub_u32 v2, 120, v25
 v_cmp_lt_u32 vcc, 39, v25
 s_nop 1
 v_cndmask_b32_e64 v9, v9, v2, vcc
 v_cmp_eq_u32 vcc, 0, v25
 s_nop 1
 v_cndmask_b32_e64 v9, v9, 0, vcc
 v_cmp_eq_u32 vcc, 40, v25
 s_nop 1
 v_cndmask_b32_e64 v9, v9, 1, vcc
 v_cmp_eq_u32 vcc, 1, v25
 s_nop 1
 v_cndmask_b32_e64 v9, v9, 2, vcc
 v_cmp_eq_u32 vcc, 79, v25
 s_nop 1
 v_cndmask_b32_e64 v9, v9, 3, vcc
 v_lshl_add_u32 v9, v9, 9, v26
 v_lshrrev_b32 v2, 1, v27
 v_lshlrev_b32 v25, 3, v2
 v_add_u32 v25, s45, v25
 v_add_u32 v25, 64, v25
 v_add_u32 v10, 2, v25
 v_sub_u32 v2, 120, v25
 v_cmp_lt_u32 vcc, 39, v25
 s_nop 1
 v_cndmask_b32_e64 v10, v10, v2, vcc
 v_cmp_eq_u32 vcc, 0, v25
 s_nop 1
 v_cndmask_b32_e64 v10, v10, 0, vcc
 v_cmp_eq_u32 vcc, 40, v25
 s_nop 1
 v_cndmask_b32_e64 v10, v10, 1, vcc
 v_cmp_eq_u32_e64 vcc, 1, v25
 s_nop 1
 v_cndmask_b32_e64 v10, v10, 2, vcc
 v_cmp_eq_u32 vcc, 79, v25
 s_nop 1
 v_cndmask_b32_e64 v10, v10, 3, vcc
 v_lshl_add_u32 v10, v10, 9, v26
 s_mul_i32 s63, s3, 327680
 v_lshlrev_b32 v11, 4, v1
 v_lshrrev_b32 v2, 4, v1
 v_lshlrev_b32 v24, 8, v2
 v_and_b32 v2, 15, v1
 v_lshl_add_u32 v24, v2, 3, v24
 s_and_b32 s46, s4, 3
 s_lshl_b32 s46, s46, 2
 s_and_b32 s47, s5, 1
 s_lshl_b32 s47, s47, 1
 s_add_u32 s46, s46, s47
 s_mul_i32 s46, s46, 20480
 s_mul_i32 s47, s3, 344064
 s_add_u32 s46, s46, s47
 s_add_u32 s46, s46, s58
 s_lshr_b32 s47, s5, 1
 s_lshl_b32 s64, s47, 13
 s_add_u32 s64, s64, s46
 s_add_u32 s65, s64, 20480
 s_lshl_b32 s66, s47, 11
 s_add_u32 s66, s66, s46
 s_add_u32 s66, s66, 16384
 s_add_u32 s67, s66, 20480
 s_cmp_lg_u32 s5, 0
 s_cbranch_scc1 Llb_95
 s_mov_b32 s39, 4194304
Lpoll_96:
 buffer_load_dword v2, v5, s[8:11], 0 offen sc1
 s_waitcnt vmcnt(0)
 v_cmp_gt_u32 vcc, s40, v2
 s_cbranch_vccz Lpdone_97
 s_sub_u32 s39, s39, 1
 s_cmp_lg_u32 s39, 0
 s_cbranch_scc1 Lpoll_96
Lpdone_97:
Llb_95:
 s_barrier
 buffer_load_dwordx4 v[28:31], v11, s[8:11], s64 offen offset:0 sc1
 buffer_load_dwordx4 v[32:35], v11, s[8:11], s65 offen offset:0 sc1
 buffer_load_dwordx4 v[36:39], v11, s[8:11], s64 offen offset:1024 sc1
 buffer_load_dwordx4 v[40:43], v11, s[8:11], s65 offen offset:1024 sc1
 buffer_load_dwordx4 v[44:47], v11, s[8:11], s64 offen offset:2048 sc1
 buffer_load_dwordx4 v[48:51], v11, s[8:11], s65 offen offset:2048 sc1
 buffer_load_dwordx4 v[52:55], v11, s[8:11], s64 offen offset:3072 sc1
 buffer_load_dwordx4 v[56:59], v11, s[8:11], s65 offen offset:3072 sc1
 s_waitcnt vmcnt(6)
 v_mfma_f32_16x16x32_bf16 v[172:175], a[0:3], v[28:31], 0
 v_mfma_f32_16x16x32_bf16 v[176:179], a[4:7], v[28:31], 0
 s_add_u32 s64, s64, 4096
 buffer_load_dwordx4 v[60:63], v11, s[8:11], s64 offen offset:0 sc1
 s_add_u32 s65, s65, 4096
 buffer_load_dwordx4 v[64:67], v11, s[8:11], s65 offen offset:0 sc1
 v_mfma_f32_16x16x32_bf16 v[180:183], a[8:11], v[28:31], 0
 v_mfma_f32_16x16x32_bf16 v[184:187], a[12:15], v[28:31], 0
 v_mfma_f32_16x16x32_bf16 v[188:191], a[16:19], v[28:31], 0
 v_mfma_f32_16x16x32_bf16 v[192:195], a[0:3], v[32:35], 0
 v_mfma_f32_16x16x32_bf16 v[196:199], a[4:7], v[32:35], 0
 v_mfma_f32_16x16x32_bf16 v[200:203], a[8:11], v[32:35], 0
 v_mfma_f32_16x16x32_bf16 v[204:207], a[12:15], v[32:35], 0
 v_mfma_f32_16x16x32_bf16 v[208:211], a[16:19], v[32:35], 0
 s_waitcnt vmcnt(6)
 v_mfma_f32_16x16x32_bf16 v[172:175], a[20:23], v[36:39], v[172:175]
 v_mfma_f32_16x16x32_bf16 v[176:179], a[24:27], v[36:39], v[176:179]
 buffer_load_dwordx4 v[68:71], v11, s[8:11], s64 offen offset:1024 sc1
 buffer_load_dwordx4 v[72:75], v11, s[8:11], s65 offen offset:1024 sc1
 v_mfma_f32_16x16x32_bf16 v[180:183], a[28:31], v[36:39], v[180:183]
 v_mfma_f32_16x16x32_bf16 v[184:187], a[32:35], v[36:39], v[184:187]
 v_mfma_f32_16x16x32_bf16 v[188:191], a[36:39], v[36:39], v[188:191]
 v_mfma_f32_16x16x32_bf16 v[192:195], a[20:23], v[40:43], v[192:195]
 v_mfma_f32_16x16x32_bf16 v[196:199], a[24:27], v[40:43], v[196:199]
 v_mfma_f32_16x16x32_bf16 v[200:203], a[28:31], v[40:43], v[200:203]
 v_mfma_f32_16x16x32_bf16 v[204:207], a[32:35], v[40:43], v[204:207]
 v_mfma_f32_16x16x32_bf16 v[208:211], a[36:39], v[40:43], v[208:211]
 s_waitcnt vmcnt(6)
 v_mfma_f32_16x16x32_bf16 v[172:175], a[40:43], v[44:47], v[172:175]
 v_mfma_f32_16x16x32_bf16 v[176:179], a[44:47], v[44:47], v[176:179]
 buffer_load_dwordx4 v[76:79], v11, s[8:11], s64 offen offset:2048 sc1
 buffer_load_dwordx4 v[80:83], v11, s[8:11], s65 offen offset:2048 sc1
 s_add_u32 s45, s63, s56
 buffer_load_dwordx4 v[12:15], v8, s[8:11], s45 offen sc1
 buffer_load_dwordx4 v[16:19], v9, s[8:11], s45 offen sc1
 buffer_load_dwordx4 v[20:23], v10, s[8:11], s45 offen sc1
 v_mfma_f32_16x16x32_bf16 v[180:183], a[48:51], v[44:47], v[180:183]
 v_mfma_f32_16x16x32_bf16 v[184:187], a[52:55], v[44:47], v[184:187]
 v_mfma_f32_16x16x32_bf16 v[188:191], a[56:59], v[44:47], v[188:191]
 v_mfma_f32_16x16x32_bf16 v[192:195], a[40:43], v[48:51], v[192:195]
 v_mfma_f32_16x16x32_bf16 v[196:199], a[44:47], v[48:51], v[196:199]
 v_mfma_f32_16x16x32_bf16 v[200:203], a[48:51], v[48:51], v[200:203]
 v_mfma_f32_16x16x32_bf16 v[204:207], a[52:55], v[48:51], v[204:207]
 v_mfma_f32_16x16x32_bf16 v[208:211], a[56:59], v[48:51], v[208:211]
 s_waitcnt vmcnt(9)
 v_mfma_f32_16x16x32_bf16 v[172:175], a[60:63], v[52:55], v[172:175]
 v_mfma_f32_16x16x32_bf16 v[176:179], a[64:67], v[52:55], v[176:179]
 buffer_load_dwordx4 v[84:87], v11, s[8:11], s64 offen offset:3072 sc1
 buffer_load_dwordx4 v[88:91], v11, s[8:11], s65 offen offset:3072 sc1
 v_mfma_f32_16x16x32_bf16 v[180:183], a[68:71], v[52:55], v[180:183]
 v_mfma_f32_16x16x32_bf16 v[184:187], a[72:75], v[52:55], v[184:187]
 v_mfma_f32_16x16x32_bf16 v[188:191], a[76:79], v[52:55], v[188:191]
 v_mfma_f32_16x16x32_bf16 v[192:195], a[60:63], v[56:59], v[192:195]
 v_mfma_f32_16x16x32_bf16 v[196:199], a[64:67], v[56:59], v[196:199]
 v_mfma_f32_16x16x32_bf16 v[200:203], a[68:71], v[56:59], v[200:203]
 v_mfma_f32_16x16x32_bf16 v[204:207], a[72:75], v[56:59], v[204:207]
 v_mfma_f32_16x16x32_bf16 v[208:211], a[76:79], v[56:59], v[208:211]
 s_waitcnt vmcnt(9)
 v_mfma_f32_16x16x32_bf16 v[172:175], a[80:83], v[60:63], v[172:175]
 v_mfma_f32_16x16x32_bf16 v[176:179], a[84:87], v[60:63], v[176:179]
 buffer_load_dwordx2 v[92:93], v24, s[8:11], s66 offen offset:0 sc1
 buffer_load_dwordx2 v[94:95], v24, s[8:11], s66 offen offset:128 sc1
 buffer_load_dwordx2 v[96:97], v24, s[8:11], s67 offen offset:0 sc1
 buffer_load_dwordx2 v[98:99], v24, s[8:11], s67 offen offset:128 sc1
 v_mfma_f32_16x16x32_bf16 v[180:183], a[88:91], v[60:63], v[180:183]
 v_mfma_f32_16x16x32_bf16 v[184:187], a[92:95], v[60:63], v[184:187]
 v_mfma_f32_16x16x32_bf16 v[188:191], a[96:99], v[60:63], v[188:191]
 v_mfma_f32_16x16x32_bf16 v[192:195], a[80:83], v[64:67], v[192:195]
 v_mfma_f32_16x16x32_bf16 v[196:199], a[84:87], v[64:67], v[196:199]
 v_mfma_f32_16x16x32_bf16 v[200:203], a[88:91], v[64:67], v[200:203]
 v_mfma_f32_16x16x32_bf16 v[204:207], a[92:95], v[64:67], v[204:207]
 v_mfma_f32_16x16x32_bf16 v[208:211], a[96:99], v[64:67], v[208:211]
 s_waitcnt vmcnt(11)
 v_mfma_f32_16x16x32_bf16 v[172:175], a[100:103], v[68:71], v[172:175]
 v_mfma_f32_16x16x32_bf16 v[176:179], a[104:107], v[68:71], v[176:179]
 buffer_load_dwordx2 v[100:101], v24, s[8:11], s66 offen offset:1024 sc1
 buffer_load_dwordx2 v[102:103], v24, s[8:11], s66 offen offset:1152 sc1
 buffer_load_dwordx2 v[104:105], v24, s[8:11], s67 offen offset:1024 sc1
 buffer_load_dwordx2 v[106:107], v24, s[8:11], s67 offen offset:1152 sc1
 v_mfma_f32_16x16x32_bf16 v[180:183], a[108:111], v[68:71], v[180:183]
 v_mfma_f32_16x16x32_bf16 v[184:187], a[112:115], v[68:71], v[184:187]
 v_mfma_f32_16x16x32_bf16 v[188:191], a[116:119], v[68:71], v[188:191]
 v_mfma_f32_16x16x32_bf16 v[192:195], a[100:103], v[72:75], v[192:195]
 v_mfma_f32_16x16x32_bf16 v[196:199], a[104:107], v[72:75], v[196:199]
 v_mfma_f32_16x16x32_bf16 v[200:203], a[108:111], v[72:75], v[200:203]
 v_mfma_f32_16x16x32_bf16 v[204:207], a[112:115], v[72:75], v[204:207]
 v_mfma_f32_16x16x32_bf16 v[208:211], a[116:119], v[72:75], v[208:211]
 s_waitcnt vmcnt(13)
 v_mfma_f32_16x16x32_bf16 v[172:175], a[120:123], v[76:79], v[172:175]
 v_mfma_f32_16x16x32_bf16 v[176:179], a[124:127], v[76:79], v[176:179]
 v_mfma_f32_16x16x32_bf16 v[180:183], a[128:131], v[76:79], v[180:183]
 v_mfma_f32_16x16x32_bf16 v[184:187], a[132:135], v[76:79], v[184:187]
 v_mfma_f32_16x16x32_bf16 v[188:191], a[136:139], v[76:79], v[188:191]
 v_mfma_f32_16x16x32_bf16 v[192:195], a[120:123], v[80:83], v[192:195]
 v_mfma_f32_16x16x32_bf16 v[196:199], a[124:127], v[80:83], v[196:199]
 v_mfma_f32_16x16x32_bf16 v[200:203], a[128:131], v[80:83], v[200:203]
 v_mfma_f32_16x16x32_bf16 v[204:207], a[132:135], v[80:83], v[204:207]
 v_mfma_f32_16x16x32_bf16 v[208:211], a[136:139], v[80:83], v[208:211]
 s_waitcnt vmcnt(8)
 v_mfma_f32_16x16x32_bf16 v[172:175], a[140:143], v[84:87], v[172:175]
 v_mfma_f32_16x16x32_bf16 v[176:179], a[144:147], v[84:87], v[176:179]
 v_mfma_f32_16x16x32_bf16 v[180:183], a[148:151], v[84:87], v[180:183]
 v_mfma_f32_16x16x32_bf16 v[184:187], a[152:155], v[84:87], v[184:187]
 v_mfma_f32_16x16x32_bf16 v[188:191], a[156:159], v[84:87], v[188:191]
 v_mfma_f32_16x16x32_bf16 v[192:195], a[140:143], v[88:91], v[192:195]
 v_mfma_f32_16x16x32_bf16 v[196:199], a[144:147], v[88:91], v[196:199]
 v_mfma_f32_16x16x32_bf16 v[200:203], a[148:151], v[88:91], v[200:203]
 v_mfma_f32_16x16x32_bf16 v[204:207], a[152:155], v[88:91], v[204:207]
 v_mfma_f32_16x16x32_bf16 v[208:211], a[156:159], v[88:91], v[208:211]
 s_waitcnt vmcnt(4)
 v_mfma_f32_16x16x32_bf16 v[172:175], a[160:163], v[92:95], v[172:175]
 v_mfma_f32_16x16x32_bf16 v[176:179], a[164:167], v[92:95], v[176:179]
 v_mfma_f32_16x16x32_bf16 v[180:183], a[168:171], v[92:95], v[180:183]
 v_mfma_f32_16x16x32_bf16 v[184:187], a[172:175], v[92:95], v[184:187]
 v_mfma_f32_16x16x32_bf16 v[188:191], a[176:179], v[92:95], v[188:191]
 v_mfma_f32_16x16x32_bf16 v[192:195], a[160:163], v[96:99], v[192:195]
 v_mfma_f32_16x16x32_bf16 v[196:199], a[164:167], v[96:99], v[196:199]
 v_mfma_f32_16x16x32_bf16 v[200:203], a[168:171], v[96:99], v[200:203]
 v_mfma_f32_16x16x32_bf16 v[204:207], a[172:175], v[96:99], v[204:207]
 v_mfma_f32_16x16x32_bf16 v[208:211], a[176:179], v[96:99], v[208:211]
 s_waitcnt vmcnt(0)
 v_mfma_f32_16x16x32_bf16 v[172:175], a[180:183], v[100:103], v[172:175]
 v_mfma_f32_16x16x32_bf16 v[176:179], a[184:187], v[100:103], v[176:179]
 v_mfma_f32_16x16x32_bf16 v[180:183], a[188:191], v[100:103], v[180:183]
 v_mfma_f32_16x16x32_bf16 v[184:187], a[192:195], v[100:103], v[184:187]
 v_mfma_f32_16x16x32_bf16 v[188:191], a[196:199], v[100:103], v[188:191]
 v_mfma_f32_16x16x32_bf16 v[192:195], a[180:183], v[104:107], v[192:195]
 v_mfma_f32_16x16x32_bf16 v[196:199], a[184:187], v[104:107], v[196:199]
 v_mfma_f32_16x16x32_bf16 v[200:203], a[188:191], v[104:107], v[200:203]
 v_mfma_f32_16x16x32_bf16 v[204:207], a[192:195], v[104:107], v[204:207]
 v_mfma_f32_16x16x32_bf16 v[208:211], a[196:199], v[104:107], v[208:211]
 s_mul_i32 s46, s5, 5120
 s_add_u32 s46, s46, 97280
 v_lshlrev_b32 v11, 4, v1
 v_add_u32 v3, s46, v11
 s_cmp_ge_u32 s5, 2
 s_cbranch_scc1 Lk1_98
 ds_write_b128 v3, v[192:195] offset:0
 ds_write_b128 v3, v[196:199] offset:1024
 ds_write_b128 v3, v[200:203] offset:2048
 ds_write_b128 v3, v[204:207] offset:3072
 ds_write_b128 v3, v[208:211] offset:4096
 s_branch Lk2_99
Lk1_98:
 ds_write_b128 v3, v[172:175] offset:0
 ds_write_b128 v3, v[176:179] offset:1024
 ds_write_b128 v3, v[180:183] offset:2048
 ds_write_b128 v3, v[184:187] offset:3072
 ds_write_b128 v3, v[188:191] offset:4096
 v_mov_b32 v172, v192
 v_mov_b32 v173, v193
 v_mov_b32 v174, v194
 v_mov_b32 v175, v195
 v_mov_b32 v176, v196
 v_mov_b32 v177, v197
 v_mov_b32 v178, v198
 v_mov_b32 v179, v199
 v_mov_b32 v180, v200
 v_mov_b32 v181, v201
 v_mov_b32 v182, v202
 v_mov_b32 v183, v203
 v_mov_b32 v184, v204
 v_mov_b32 v185, v205
 v_mov_b32 v186, v206
 v_mov_b32 v187, v207
 v_mov_b32 v188, v208
 v_mov_b32 v189, v209
 v_mov_b32 v190, v210
 v_mov_b32 v191, v211
Lk2_99:
 v_add_u32 v84, 81920, v11
 s_waitcnt lgkmcnt(0)
 s_barrier
 s_xor_b32 s46, s5, 2
 s_mul_i32 s46, s46, 5120
 s_add_u32 s46, s46, 97280
 v_add_u32_e64 v3, s46, v11
 ds_read_b128 v[192:195], v3 offset:0
 ds_read_b128 v[196:199], v3 offset:1024
 ds_read_b128 v[200:203], v3 offset:2048
 ds_read_b128 v[204:207], v3 offset:3072
 ds_read_b128 v[208:211], v3 offset:4096
 ds_read_b128 v[24:27], v84 offset:0
 ds_read_b128 v[28:31], v84 offset:1024
 ds_read_b128 v[32:35], v84 offset:2048
 ds_read_b128 v[36:39], v84 offset:3072
 ds_read_b128 v[40:43], v84 offset:4096
 ds_read_b128 v[44:47], v84 offset:5120
 ds_read_b128 v[48:51], v84 offset:6144
 ds_read_b128 v[52:55], v84 offset:7168
 ds_read_b128 v[56:59], v84 offset:8192
 ds_read_b128 v[60:63], v84 offset:9216
 ds_read_b128 v[64:67], v84 offset:10240
 ds_read_b128 v[68:71], v84 offset:11264
 ds_read_b128 v[72:75], v84 offset:12288
 ds_read_b128 v[76:79], v84 offset:13312
 ds_read_b128 v[80:83], v84 offset:14336
 s_waitcnt vmcnt(10) lgkmcnt(15)
 v_permlane16_swap_b32 v12, v14
 v_permlane16_swap_b32 v13, v15
 v_permlane16_swap_b32 v16, v18
 v_permlane16_swap_b32 v17, v19
 v_permlane16_swap_b32 v20, v22
 v_permlane16_swap_b32 v21, v23
 v_pk_add_f32 v[172:173], v[172:173], v[192:193]
 v_pk_add_f32 v[174:175], v[174:175], v[194:195]
 v_lshlrev_b32 v86, 16, v12
 v_and_b32 v87, 0xffff0000, v12
 v_lshlrev_b32_e64 v88, 16, v13
 v_and_b32 v89, 0xffff0000, v13
 v_pk_add_f32 v[172:173], v[172:173], v[86:87]
 v_pk_add_f32 v[174:175], v[174:175], v[88:89]
 v_pk_add_f32 v[176:177], v[176:177], v[196:197]
 v_pk_add_f32 v[178:179], v[178:179], v[198:199]
 v_lshlrev_b32_e64 v86, 16, v14
 v_and_b32 v87, 0xffff0000, v14
 v_lshlrev_b32_e64 v88, 16, v15
 v_and_b32 v89, 0xffff0000, v15
 v_pk_add_f32 v[176:177], v[176:177], v[86:87]
 v_pk_add_f32 v[178:179], v[178:179], v[88:89]
 v_pk_add_f32 v[180:181], v[180:181], v[200:201]
 v_pk_add_f32 v[182:183], v[182:183], v[202:203]
 v_lshlrev_b32_e64 v86, 16, v16
 v_and_b32 v87, 0xffff0000, v16
 v_lshlrev_b32_e64 v88, 16, v17
 v_and_b32 v89, 0xffff0000, v17
 v_pk_add_f32 v[180:181], v[180:181], v[86:87]
 v_pk_add_f32 v[182:183], v[182:183], v[88:89]
 v_pk_add_f32 v[184:185], v[184:185], v[204:205]
 v_pk_add_f32 v[186:187], v[186:187], v[206:207]
 v_lshlrev_b32_e64 v86, 16, v18
 v_and_b32 v87, 0xffff0000, v18
 v_lshlrev_b32_e64 v88, 16, v19
 v_and_b32 v89, 0xffff0000, v19
 v_pk_add_f32 v[184:185], v[184:185], v[86:87]
 v_pk_add_f32 v[186:187], v[186:187], v[88:89]
 v_pk_add_f32 v[188:189], v[188:189], v[208:209]
 v_pk_add_f32 v[190:191], v[190:191], v[210:211]
 v_lshlrev_b32_e64 v86, 16, v20
 v_and_b32 v87, 0xffff0000, v20
 v_lshlrev_b32_e64 v88, 16, v21
 v_and_b32 v89, 0xffff0000, v21
 v_pk_add_f32 v[188:189], v[188:189], v[86:87]
 v_pk_add_f32 v[190:191], v[190:191], v[88:89]
 v_cvt_pk_bf16_f32 v88, v172, v173
 v_cvt_pk_bf16_f32 v89, v174, v175
 v_cvt_pk_bf16_f32 v90, v176, v177
 v_cvt_pk_bf16_f32 v91, v178, v179
 v_cvt_pk_bf16_f32 v92, v180, v181
 v_cvt_pk_bf16_f32 v93, v182, v183
 v_cvt_pk_bf16_f32 v94, v184, v185
 v_cvt_pk_bf16_f32 v95, v186, v187
 v_cvt_pk_bf16_f32 v96, v188, v189
 v_cvt_pk_bf16_f32 v97, v190, v191
 v_mov_b32 v98, 0
 v_mov_b32 v99, 0
 v_mov_b32 v12, v88
 v_mov_b32 v13, v89
 v_mov_b32 v14, v90
 v_mov_b32 v15, v91
 v_mov_b32 v16, v92
 v_mov_b32 v17, v93
 v_mov_b32 v18, v94
 v_mov_b32 v19, v95
 v_mov_b32 v20, v96
 v_mov_b32 v21, v97
 v_mov_b32 v22, v96
 v_mov_b32 v23, v97
 v_permlane16_swap_b32 v12, v14
 v_permlane16_swap_b32 v13, v15
 v_permlane16_swap_b32 v16, v18
 v_permlane16_swap_b32 v17, v19
 v_permlane16_swap_b32 v20, v22
 v_permlane16_swap_b32 v21, v23
 s_waitcnt lgkmcnt(0)
 v_mfma_f32_16x16x32_bf16 v[192:195], v[24:27], v[88:91], 0
 v_mfma_f32_16x16x32_bf16 v[192:195], v[28:31], v[92:95], v[192:195]
 v_mfma_f32_16x16x32_bf16 v[192:195], v[32:35], v[96:99], v[192:195]
 v_mfma_f32_16x16x32_bf16 v[196:199], v[36:39], v[88:91], 0
 v_mfma_f32_16x16x32_bf16 v[196:199], v[40:43], v[92:95], v[196:199]
 v_mfma_f32_16x16x32_bf16 v[196:199], v[44:47], v[96:99], v[196:199]
 v_mfma_f32_16x16x32_bf16 v[200:203], v[48:51], v[88:91], 0
 v_mfma_f32_16x16x32_bf16 v[200:203], v[52:55], v[92:95], v[200:203]
 v_mfma_f32_16x16x32_bf16 v[200:203], v[56:59], v[96:99], v[200:203]
 v_mfma_f32_16x16x32_bf16 v[204:207], v[60:63], v[88:91], 0
 v_mfma_f32_16x16x32_bf16 v[204:207], v[64:67], v[92:95], v[204:207]
 v_mfma_f32_16x16x32_bf16 v[204:207], v[68:71], v[96:99], v[204:207]
 v_mfma_f32_16x16x32_bf16 v[208:211], v[72:75], v[88:91], 0
 v_mfma_f32_16x16x32_bf16 v[208:211], v[76:79], v[92:95], v[208:211]
 v_mfma_f32_16x16x32_bf16 v[208:211], v[80:83], v[96:99], v[208:211]
 s_add_u32 s45, s63, s59
 buffer_store_dwordx4 v[12:15], v8, s[8:11], s45 offen sc1
 buffer_store_dwordx4 v[16:19], v9, s[8:11], s45 offen sc1
 buffer_store_dwordx4 v[20:23], v10, s[8:11], s45 offen sc1
 v_pk_add_f32 v[86:87], v[172:173], v[174:175]
 v_pk_mul_f32 v[100:101], v[172:173], v[172:173]
 v_pk_fma_f32 v[100:101], v[174:175], v[174:175], v[100:101]
 v_pk_add_f32 v[86:87], v[86:87], v[176:177]
 v_pk_fma_f32 v[100:101], v[176:177], v[176:177], v[100:101]
 v_pk_add_f32 v[86:87], v[86:87], v[178:179]
 v_pk_fma_f32 v[100:101], v[178:179], v[178:179], v[100:101]
 v_pk_add_f32 v[86:87], v[86:87], v[180:181]
 v_pk_fma_f32 v[100:101], v[180:181], v[180:181], v[100:101]
 v_pk_add_f32 v[86:87], v[86:87], v[182:183]
 v_pk_fma_f32 v[100:101], v[182:183], v[182:183], v[100:101]
 v_pk_add_f32 v[86:87], v[86:87], v[184:185]
 v_pk_fma_f32 v[100:101], v[184:185], v[184:185], v[100:101]
 v_pk_add_f32 v[86:87], v[86:87], v[186:187]
 v_pk_fma_f32 v[100:101], v[186:187], v[186:187], v[100:101]
 v_pk_add_f32 v[86:87], v[86:87], v[188:189]
 v_pk_fma_f32 v[100:101], v[188:189], v[188:189], v[100:101]
 v_pk_add_f32 v[86:87], v[86:87], v[190:191]
 v_pk_fma_f32 v[100:101], v[190:191], v[190:191], v[100:101]
 v_add_f32 v86, v86, v87
 v_add_f32 v87, v100, v101
 v_mov_b32 v2, v86
 s_nop 1
 v_permlane16_swap_b32 v2, v86
 v_add_f32 v86, v86, v2
 v_mov_b32 v2, v86
 s_nop 1
 v_permlane32_swap_b32 v2, v86
 v_add_f32 v86, v86, v2
 v_mov_b32 v2, v87
 s_nop 1
 v_permlane16_swap_b32 v2, v87
 v_add_f32 v87, v87, v2
 v_mov_b32 v2, v87
 s_nop 1
 v_permlane32_swap_b32 v2, v87
 v_add_f32 v87, v87, v2
 s_lshr_b32 s46, s4, 2
 s_lshl_b32 s46, s46, 11
 v_lshlrev_b32 v3, 3, v6
 v_cmp_gt_u32 vcc, 16, v1
 v_mov_b32 v2, 2146435072
 s_nop 0
 v_cndmask_b32 v3, v2, v3, vcc
 s_mul_i32 s47, s3, 344064
 s_add_u32 s46, s46, s47
 s_add_u32 s46, s46, s61
 buffer_store_dwordx2 v[86:87], v3, s[8:11], s46 offen sc1
 v_cvt_pk_bf16_f32 v102, v192, v193
 v_cvt_pk_bf16_f32 v103, v194, v195
 v_cvt_pk_bf16_f32 v104, v196, v197
 v_cvt_pk_bf16_f32 v105, v198, v199
 v_cvt_pk_bf16_f32 v106, v200, v201
 v_cvt_pk_bf16_f32 v107, v202, v203
 v_cvt_pk_bf16_f32 v108, v204, v205
 v_cvt_pk_bf16_f32 v109, v206, v207
 v_cvt_pk_bf16_f32 v110, v208, v209
 v_cvt_pk_bf16_f32 v111, v210, v211
 v_lshrrev_b32 v2, 4, v1
 v_lshlrev_b32 v3, 14, v2
 v_lshl_add_u32 v3, v6, 3, v3
 s_lshr_b32 s46, s4, 2
 s_lshl_b32 s46, s46, 11
 s_mul_i32 s47, s3, 327680
 s_add_u32 s46, s46, s47
 s_add_u32 s46, s46, s60
 buffer_store_dwordx2 v[102:103], v3, s[8:11], s46 offen sc1
 s_add_u32 s46, s46, 65536
 buffer_store_dwordx2 v[104:105], v3, s[8:11], s46 offen sc1
 s_add_u32 s46, s46, 65536
 buffer_store_dwordx2 v[106:107], v3, s[8:11], s46 offen sc1
 s_add_u32 s46, s46, 65536
 buffer_store_dwordx2 v[108:109], v3, s[8:11], s46 offen sc1
 s_add_u32 s46, s46, 65536
 buffer_store_dwordx2 v[110:111], v3, s[8:11], s46 offen sc1
 s_waitcnt vmcnt(0) lgkmcnt(0)
 s_barrier
 s_add_u32 s40, s40, 1
 s_cmp_lg_u32 s5, 0
 s_cbranch_scc1 Llb_100
 v_mov_b32_e64 v3, s40
 s_mov_b64 s[6:7], exec
 s_mov_b64 exec, 1
 buffer_store_dword v3, v4, s[8:11], 0 offen sc1
 s_mov_b64 exec, s[6:7]
Llb_100:
 s_cmp_lg_u32 s42, 0
 s_cbranch_scc1 Lcst_101
 v_accvgpr_read_b32 v2, a202
 v_accvgpr_read_b32 v3, a203
 v_accvgpr_mov_b32 a206, a200
 v_accvgpr_mov_b32 a207, a201
 v_xor_b32 v2, 0x80008000, v2
 v_xor_b32 v3, 0x80008000, v3
 v_accvgpr_write_b32 a204, v2
 v_accvgpr_write_b32 a205, v3
 v_accvgpr_read_b32 v2, a210
 v_accvgpr_read_b32 v3, a211
 v_accvgpr_mov_b32 a214, a208
 v_accvgpr_mov_b32 a215, a209
 v_xor_b32 v2, 0x80008000, v2
 v_xor_b32 v3, 0x80008000, v3
 v_accvgpr_write_b32 a212, v2
 v_accvgpr_write_b32 a213, v3
 v_accvgpr_read_b32 v2, a218
 v_accvgpr_read_b32 v3, a219
 v_accvgpr_mov_b32 a222, a216
 v_accvgpr_mov_b32 a223, a217
 v_xor_b32 v2, 0x80008000, v2
 v_xor_b32 v3, 0x80008000, v3
 v_accvgpr_write_b32 a220, v2
 v_accvgpr_write_b32 a221, v3
 v_accvgpr_read_b32 v2, a226
 v_accvgpr_read_b32 v3, a227
 v_accvgpr_mov_b32 a230, a224
 v_accvgpr_mov_b32 a231, a225
 v_xor_b32 v2, 0x80008000, v2
 v_xor_b32 v3, 0x80008000, v3
 v_accvgpr_write_b32 a228, v2
 v_accvgpr_write_b32 a229, v3
Lcst_101:
 v_and_b32 v6, 15, v1
 v_lshrrev_b32 v8, 4, v1
 s_sub_u32 s44, s4, 1
 s_cmp_eq_u32 s4, 0
 s_cselect_b32 s44, 0, s44
 s_cmp_ge_u32 s4, 2
 s_cselect_b32 s45, 1, 0
 s_cmp_eq_u32 s4, 1
 s_cselect_b32 s47, 1, 0
 v_lshrrev_b32 v2, 1, v8
 v_mul_u32_u24 v2, s45, v2
 v_add_u32 v2, s47, v2
 v_lshlrev_b32 v9, 2, v2
 v_and_b32 v2, 1, v8
 v_lshl_add_u32 v9, v2, 13, v9
 s_lshl_b32 s44, s44, 14
 s_lshl_b32 s46, s5, 9
 s_add_u32 s44, s44, s46
 v_lshl_add_u32 v9, v6, 3, v9
 v_add_u32 v9, s44, v9
 s_lshl_b32 s46, s5, 9
 v_lshlrev_b32 v10, 3, v1
 v_add_u32_e64 v10, s46, v10
 s_mul_i32 s63, s3, 327680
 s_add_u32 s63, s63, s60
 s_mul_i32 s64, s3, 344064
 s_add_u32 s64, s64, s61
 s_cmp_lg_u32 s5, 0
 s_cbranch_scc1 Llb_102
 s_mov_b32 s39, 4194304
Lpoll_103:
 buffer_load_dword v2, v5, s[8:11], 0 offen sc1
 s_waitcnt vmcnt(0)
 v_cmp_gt_u32_e64 vcc, s40, v2
 s_cbranch_vccz Lpdone_104
 s_sub_u32 s39, s39, 1
 s_cmp_lg_u32 s39, 0
 s_cbranch_scc1 Lpoll_103
Lpdone_104:
Llb_102:
 s_barrier
 s_cmp_gt_u32 s4, 20
 s_cbranch_scc1 Lb1d_105
 buffer_load_dwordx2 v[12:13], v10, s[8:11], s64 offen offset:0 sc1
 buffer_load_dwordx2 v[14:15], v10, s[8:11], s64 offen offset:2048 sc1
 s_add_u32 s64, s64, 4096
 buffer_load_dwordx2 v[16:17], v10, s[8:11], s64 offen offset:0 sc1
 buffer_load_dwordx2 v[18:19], v10, s[8:11], s64 offen offset:2048 sc1
 s_add_u32 s64, s64, 4096
 buffer_load_dwordx2 v[20:21], v10, s[8:11], s64 offen offset:0 sc1
 buffer_load_dwordx2 v[22:23], v10, s[8:11], s64 offen offset:2048 sc1
 s_add_u32 s64, s64, 4096
 buffer_load_dwordx2 v[24:25], v10, s[8:11], s64 offen offset:0 sc1
 buffer_load_dwordx2 v[26:27], v10, s[8:11], s64 offen offset:2048 sc1
 s_add_u32 s68, s63, 0
 s_add_u32 s69, s63, 2048
 s_add_u32 s70, s63, 4096
 s_add_u32 s71, s63, 6144
 buffer_load_dword v28, v9, s[8:11], s68 offen offset:0 sc1
 buffer_load_dword v29, v9, s[8:11], s69 offen offset:0 sc1
 buffer_load_dword v30, v9, s[8:11], s70 offen offset:0 sc1
 buffer_load_dword v31, v9, s[8:11], s71 offen offset:0 sc1
 buffer_load_dword v32, v9, s[8:11], s68 offen offset:128 sc1
 buffer_load_dword v33, v9, s[8:11], s69 offen offset:128 sc1
 buffer_load_dword v34, v9, s[8:11], s70 offen offset:128 sc1
 buffer_load_dword v35, v9, s[8:11], s71 offen offset:128 sc1
 buffer_load_dword v36, v9, s[8:11], s68 offen offset:256 sc1
 buffer_load_dword v37, v9, s[8:11], s69 offen offset:256 sc1
 buffer_load_dword v38, v9, s[8:11], s70 offen offset:256 sc1
 buffer_load_dword v39, v9, s[8:11], s71 offen offset:256 sc1
 buffer_load_dword v40, v9, s[8:11], s68 offen offset:384 sc1
 buffer_load_dword v41, v9, s[8:11], s69 offen offset:384 sc1
 buffer_load_dword v42, v9, s[8:11], s70 offen offset:384 sc1
 buffer_load_dword v43, v9, s[8:11], s71 offen offset:384 sc1
 s_waitcnt vmcnt(16)
 v_pk_add_f32 v[12:13], v[12:13], v[14:15]
 v_pk_add_f32 v[12:13], v[12:13], v[16:17]
 v_pk_add_f32 v[12:13], v[12:13], v[18:19]
 v_pk_add_f32 v[12:13], v[12:13], v[20:21]
 v_pk_add_f32 v[12:13], v[12:13], v[22:23]
 v_pk_add_f32 v[12:13], v[12:13], v[24:25]
 v_pk_add_f32 v[12:13], v[12:13], v[26:27]
 v_mul_f32 v12, 0x3acccccd, v12
 v_mul_f32 v13, 0x3acccccd, v13
 v_fma_f32 v13, -v12, v12, v13
 v_add_f32 v13, 0x3727c5ac, v13
 v_rsq_f32 v13, v13
 s_lshl_b32 s46, s5, 8
 s_add_u32 s46, s46, 113664
 v_lshlrev_b32 v2, 2, v1
 v_add_u32 v2, s46, v2
 ds_write_b32 v2, v13
 v_lshlrev_b32 v3, 4, v8
 v_add_u32 v3, s46, v3
 s_waitcnt lgkmcnt(0)
 ds_read_b128 v[12:15], v3 offset:0
 ds_read_b128 v[16:19], v3 offset:64
 ds_read_b128 v[20:23], v3 offset:128
 ds_read_b128 v[24:27], v3 offset:192
 s_waitcnt vmcnt(12)
 v_mfma_f32_16x16x32_bf16 v[44:47], v[28:31], a[232:235], 0
 v_mfma_f32_16x16x32_bf16 v[60:63], v[28:31], a[236:239], 0
 s_waitcnt vmcnt(8)
 v_mfma_f32_16x16x32_bf16 v[48:51], v[32:35], a[232:235], 0
 v_mfma_f32_16x16x32_bf16 v[64:67], v[32:35], a[236:239], 0
 s_waitcnt vmcnt(4)
 v_mfma_f32_16x16x32_bf16 v[52:55], v[36:39], a[232:235], 0
 v_mfma_f32_16x16x32_bf16 v[68:71], v[36:39], a[236:239], 0
 s_waitcnt vmcnt(0)
 v_mfma_f32_16x16x32_bf16 v[56:59], v[40:43], a[232:235], 0
 v_mfma_f32_16x16x32_bf16 v[72:75], v[40:43], a[236:239], 0
 s_waitcnt lgkmcnt(0)
 v_pk_mul_f32 v[44:45], v[44:45], v[12:13]
 v_pk_mul_f32 v[60:61], v[60:61], v[12:13]
 v_pk_mul_f32 v[46:47], v[46:47], v[14:15]
 v_pk_mul_f32 v[62:63], v[62:63], v[14:15]
 v_cvt_pk_bf16_f32 v28, v44, v45
 v_cvt_pk_bf16_f32 v29, v46, v47
 v_cvt_pk_bf16_f32 v30, v60, v61
 v_cvt_pk_bf16_f32 v31, v62, v63
 v_pk_mul_f32 v[48:49], v[48:49], v[16:17]
 v_pk_mul_f32 v[64:65], v[64:65], v[16:17]
 v_pk_mul_f32 v[50:51], v[50:51], v[18:19]
 v_pk_mul_f32 v[66:67], v[66:67], v[18:19]
 v_cvt_pk_bf16_f32 v32, v48, v49
 v_cvt_pk_bf16_f32 v33, v50, v51
 v_cvt_pk_bf16_f32 v34, v64, v65
 v_cvt_pk_bf16_f32 v35, v66, v67
 v_pk_mul_f32 v[52:53], v[52:53], v[20:21]
 v_pk_mul_f32 v[68:69], v[68:69], v[20:21]
 v_pk_mul_f32 v[54:55], v[54:55], v[22:23]
 v_pk_mul_f32 v[70:71], v[70:71], v[22:23]
 v_cvt_pk_bf16_f32 v36, v52, v53
 v_cvt_pk_bf16_f32 v37, v54, v55
 v_cvt_pk_bf16_f32 v38, v68, v69
 v_cvt_pk_bf16_f32 v39, v70, v71
 v_pk_mul_f32 v[56:57], v[56:57], v[24:25]
 v_pk_mul_f32 v[72:73], v[72:73], v[24:25]
 v_pk_mul_f32 v[58:59], v[58:59], v[26:27]
 v_pk_mul_f32 v[74:75], v[74:75], v[26:27]
 v_cvt_pk_bf16_f32 v40, v56, v57
 v_cvt_pk_bf16_f32 v41, v58, v59
 v_cvt_pk_bf16_f32 v42, v72, v73
 v_cvt_pk_bf16_f32 v43, v74, v75
 v_mfma_f32_16x16x32_bf16 v[44:47], a[240:243], v[28:31], 0
 v_mfma_f32_16x16x32_bf16 v[60:63], a[244:247], v[28:31], 0
 v_mfma_f32_16x16x32_bf16 v[48:51], a[240:243], v[32:35], 0
 v_mfma_f32_16x16x32_bf16 v[64:67], a[244:247], v[32:35], 0
 v_mfma_f32_16x16x32_bf16 v[52:55], a[240:243], v[36:39], 0
 v_mfma_f32_16x16x32_bf16 v[68:71], a[244:247], v[36:39], 0
 v_mfma_f32_16x16x32_bf16 v[56:59], a[240:243], v[40:43], 0
 v_mfma_f32_16x16x32_bf16 v[72:75], a[244:247], v[40:43], 0
 v_lshlrev_b32 v2, 12, v8
 v_lshl_add_u32 v2, v6, 6, v2
 s_lshl_b32 s46, s5, 4
 s_add_u32 s46, s46, 97280
 v_add_u32 v2, s46, v2
 v_cvt_pk_bf16_f32 v12, v44, v48
 s_nop 0
 v_cvt_pk_bf16_f32 v13, v52, v56
 v_cvt_pk_bf16_f32 v14, v60, v64
 v_cvt_pk_bf16_f32 v15, v68, v72
 ds_write_b128 v2, v[12:15] offset:0
 v_cvt_pk_bf16_f32 v16, v45, v49
 v_cvt_pk_bf16_f32 v17, v53, v57
 v_cvt_pk_bf16_f32 v18, v61, v65
 v_cvt_pk_bf16_f32 v19, v69, v73
 ds_write_b128 v2, v[16:19] offset:1024
 v_cvt_pk_bf16_f32 v20, v46, v50
 v_cvt_pk_bf16_f32 v21, v54, v58
 v_cvt_pk_bf16_f32 v22, v62, v66
 v_cvt_pk_bf16_f32 v23, v70, v74
 ds_write_b128 v2, v[20:23] offset:2048
 v_cvt_pk_bf16_f32 v24, v47, v51
 v_cvt_pk_bf16_f32 v25, v55, v59
 v_cvt_pk_bf16_f32 v26, v63, v67
 v_cvt_pk_bf16_f32 v27, v71, v75
 ds_write_b128 v2, v[24:27] offset:3072
 s_waitcnt lgkmcnt(0)
 s_barrier
 s_lshl_b32 s46, s5, 12
 s_add_u32 s46, s46, 97280
 v_lshlrev_b32 v2, 6, v6
 v_lshl_add_u32 v2, v8, 4, v2
 v_add_u32 v2, s46, v2
 ds_read_b128 v[28:31], v2 offset:0
 ds_read_b128 v[32:35], v2 offset:1024
 ds_read_b128 v[36:39], v2 offset:2048
 ds_read_b128 v[40:43], v2 offset:3072
 s_waitcnt lgkmcnt(0)
 v_mfma_f32_16x16x32_bf16 v[44:47], a[200:203], v[28:31], 0
 v_mfma_f32_16x16x32_bf16 v[60:63], a[204:207], v[28:31], 0
 v_mfma_f32_16x16x32_bf16 v[48:51], a[208:211], v[32:35], 0
 v_mfma_f32_16x16x32_bf16 v[64:67], a[212:215], v[32:35], 0
 v_mfma_f32_16x16x32_bf16 v[52:55], a[216:219], v[36:39], 0
 v_mfma_f32_16x16x32_bf16 v[68:71], a[220:223], v[36:39], 0
 v_mfma_f32_16x16x32_bf16 v[56:59], a[224:227], v[40:43], 0
 v_mfma_f32_16x16x32_bf16 v[72:75], a[228:231], v[40:43], 0
 s_mul_i32 s46, s3, 344064
 s_add_u32 s46, s46, s62
 s_lshl_b32 s47, s4, 14
 s_add_u32 s46, s46, s47
 s_lshl_b32 s47, s5, 12
 s_add_u32 s46, s46, s47
 v_and_b32 v2, 1, v8
 v_lshlrev_b32 v3, 7, v2
 v_lshrrev_b32 v2, 1, v8
 v_lshl_add_u32 v3, v2, 6, v3
 v_lshl_add_u32 v3, v6, 2, v3
 v_cvt_pk_bf16_f32 v12, v44, v60
 buffer_store_dword v12, v3, s[8:11], s46 offen offset:0 sc1
 v_cvt_pk_bf16_f32 v13, v45, v61
 buffer_store_dword v13, v3, s[8:11], s46 offen offset:256 sc1
 v_cvt_pk_bf16_f32 v14, v46, v62
 buffer_store_dword v14, v3, s[8:11], s46 offen offset:512 sc1
 v_cvt_pk_bf16_f32 v15, v47, v63
 buffer_store_dword v15, v3, s[8:11], s46 offen offset:768 sc1
 v_cvt_pk_bf16_f32 v16, v48, v64
 buffer_store_dword v16, v3, s[8:11], s46 offen offset:1024 sc1
 v_cvt_pk_bf16_f32 v17, v49, v65
 buffer_store_dword v17, v3, s[8:11], s46 offen offset:1280 sc1
 v_cvt_pk_bf16_f32 v18, v50, v66
 buffer_store_dword v18, v3, s[8:11], s46 offen offset:1536 sc1
 v_cvt_pk_bf16_f32 v19, v51, v67
 buffer_store_dword v19, v3, s[8:11], s46 offen offset:1792 sc1
 v_cvt_pk_bf16_f32 v20, v52, v68
 buffer_store_dword v20, v3, s[8:11], s46 offen offset:2048 sc1
 v_cvt_pk_bf16_f32 v21, v53, v69
 buffer_store_dword v21, v3, s[8:11], s46 offen offset:2304 sc1
 v_cvt_pk_bf16_f32 v22, v54, v70
 buffer_store_dword v22, v3, s[8:11], s46 offen offset:2560 sc1
 v_cvt_pk_bf16_f32 v23, v55, v71
 buffer_store_dword v23, v3, s[8:11], s46 offen offset:2816 sc1
 v_cvt_pk_bf16_f32 v24, v56, v72
 buffer_store_dword v24, v3, s[8:11], s46 offen offset:3072 sc1
 v_cvt_pk_bf16_f32 v25, v57, v73
 buffer_store_dword v25, v3, s[8:11], s46 offen offset:3328 sc1
 v_cvt_pk_bf16_f32 v26, v58, v74
 buffer_store_dword v26, v3, s[8:11], s46 offen offset:3584 sc1
 v_cvt_pk_bf16_f32 v27, v59, v75
 buffer_store_dword v27, v3, s[8:11], s46 offen offset:3840 sc1
Lb1d_105:
 v_and_b32 v6, 15, v1
 v_lshrrev_b32 v8, 4, v1
 s_lshl_b32 s44, s4, 3
 s_add_u32 s44, s44, s3
 v_lshrrev_b32 v11, 1, v8
 v_lshlrev_b32 v11, 7, v11
 v_add_u32 v11, s44, v11
 v_and_b32 v2, 15, v11
 v_lshlrev_b32_e64 v9, 10, v2
 v_bfe_u32 v2, v11, 4, 2
 v_lshl_add_u32 v9, v2, 8, v9
 v_bfe_u32 v2, v11, 6, 1
 v_lshl_add_u32 v9, v2, 7, v9
 v_lshrrev_b32_e64 v2, 7, v11
 v_lshl_add_u32 v9, v2, 6, v9
 v_lshl_add_u32 v9, v6, 2, v9
 v_and_b32_e64 v2, 1, v8
 s_mov_b32 s45, 1376256
 v_mul_lo_u32 v2, v2, s45
 v_add_u32 v9, v9, v2
 v_lshrrev_b32 v11, 1, v8
 v_lshlrev_b32 v11, 7, v11
 v_add_u32 v11, s44, v11
 v_sub_u32 v11, 256, v11
 v_and_b32 v11, 255, v11
 v_and_b32 v2, 15, v11
 v_lshlrev_b32 v10, 10, v2
 v_bfe_u32 v2, v11, 4, 2
 v_lshl_add_u32 v10, v2, 8, v10
 v_bfe_u32 v2, v11, 6, 1
 v_lshl_add_u32 v10, v2, 7, v10
 v_lshrrev_b32_e64 v2, 7, v11
 v_lshl_add_u32 v10, v2, 6, v10
 v_and_b32 v2, 8, v6
 v_and_b32 v3, 7, v6
 v_sub_u32 v3, 7, v3
 v_add_u32 v2, v2, v3
 v_lshl_add_u32 v10, v2, 2, v10
 v_and_b32_e64 v2, 1, v8
 s_mov_b32 s45, 1376256
 v_mul_lo_u32 v2, v2, s45
 v_add_u32 v10, v10, v2
 s_lshr_b32 s45, s4, 1
 s_mul_i32 s45, s45, 40960
 s_and_b32 s46, s4, 1
 s_lshl_b32 s46, s46, 8
 s_add_u32 s45, s45, s46
 s_mul_i32 s46, s5, 10240
 s_add_u32 s45, s45, s46
 s_mul_i32 s46, s3, 327680
 s_add_u32 s45, s45, s46
 v_lshlrev_b32 v11, 4, v6
 v_lshrrev_b32_e64 v2, 1, v8
 v_lshl_add_u32 v11, v2, 9, v11
 v_and_b32_e64 v2, 1, v8
 v_lshl_add_u32 v11, v2, 10, v11
 v_add_u32 v11, s45, v11
 s_cmp_lt_u32 s4, 16
 s_cselect_b32 s63, 1, 0
 s_cmp_eq_u32 s63, 0
 s_cbranch_scc1 Lb2p_107
 s_add_u32 s46, s59, 0
 buffer_load_dwordx4 v[12:15], v11, s[8:11], s46 offen sc1
 s_add_u32 s46, s59, 2048
 buffer_load_dwordx4 v[16:19], v11, s[8:11], s46 offen sc1
 s_add_u32 s46, s59, 4096
 buffer_load_dwordx4 v[20:23], v11, s[8:11], s46 offen sc1
 s_add_u32 s46, s59, 6144
 buffer_load_dwordx4 v[24:27], v11, s[8:11], s46 offen sc1
 s_add_u32 s46, s59, 8192
 buffer_load_dwordx4 v[28:31], v11, s[8:11], s46 offen sc1
 s_waitcnt vmcnt(0)
 v_permlane16_swap_b32 v12, v14
 v_permlane16_swap_b32 v13, v15
 v_permlane16_swap_b32 v16, v18
 v_permlane16_swap_b32 v17, v19
 v_permlane16_swap_b32 v20, v22
 v_permlane16_swap_b32 v21, v23
 v_permlane16_swap_b32 v24, v26
 v_permlane16_swap_b32 v25, v27
 v_permlane16_swap_b32 v28, v30
 v_permlane16_swap_b32 v29, v31
Lb2p_107:
 s_cmp_eq_u32 s63, 0
 s_cbranch_scc1 Lb2d_106
 v_lshrrev_b32 v76, 3, v1
 s_mul_i32 s64, s5, 10
 v_add_u32 v76, s64, v76
 v_subrev_u32 v77, 19, v76
 v_cmp_lt_u32 vcc, 20, v76
 s_nop 1
 v_cndmask_b32 v77, v76, v77, vcc
 v_readlane_b32 s46, v9, 0
 v_readlane_b32 s47, v10, 0
 s_nop 0
 v_mov_b32 v78, s46
 v_mov_b32 v2, s47
 v_cndmask_b32 v78, v78, v2, vcc
 v_lshl_add_u32 v72, v77, 14, v78
 v_and_b32_e64 v2, 7, v1
 s_mov_b32 s46, 344064
 v_mul_lo_u32 v2, v2, s46
 v_add_u32 v72, v72, v2
 v_lshrrev_b32 v76, 3, v1
 v_add_u32 v76, 8, v76
 v_min_u32 v76, 9, v76
 s_mul_i32 s64, s5, 10
 v_add_u32 v76, s64, v76
 v_subrev_u32 v77, 19, v76
 v_cmp_lt_u32 vcc, 20, v76
 s_nop 1
 v_cndmask_b32 v77, v76, v77, vcc
 v_readlane_b32 s46, v9, 0
 v_readlane_b32 s47, v10, 0
 s_nop 0
 v_mov_b32 v78, s46
 v_mov_b32 v2, s47
 v_cndmask_b32 v78, v78, v2, vcc
 v_lshl_add_u32 v73, v77, 14, v78
 v_and_b32_e64 v2, 7, v1
 s_mov_b32 s46, 344064
 v_mul_lo_u32 v2, v2, s46
 v_add_u32 v73, v73, v2
 s_cmp_eq_u32 s42, 0
 s_cbranch_scc1 Loa_108
 s_mul_i32 s64, s5, 20
 v_lshrrev_b32 v88, 1, v8
 v_add_u32 v88, s64, v88
 v_and_b32_e64 v2, 1, v8
 v_mul_u32_u24 v91, 640, v2
 v_mul_u32_u24 v2, 1296, v6
 v_add_u32_e64 v91, v91, v2
 v_add_u32 v91, 97280, v91
 v_lshl_add_u32 v89, v88, 1, v91
 v_subrev_u32 v89, 4, v89
 v_lshlrev_b32 v2, 1, v88
 v_sub_u32_e64 v90, v91, v2
 v_add_u32 v90, 240, v90
 v_cmp_lt_u32 vcc, 41, v88
 s_nop 1
 v_cndmask_b32 v120, v89, v90, vcc
 v_add_u32 v89, 4, v89
 v_subrev_u32 v90, 4, v90
 v_cmp_lt_u32 vcc, 39, v88
 s_nop 1
 v_cndmask_b32 v121, v89, v90, vcc
 v_add_u32 v89, 4, v89
 v_subrev_u32 v90, 4, v90
 v_cmp_lt_u32 vcc, 37, v88
 s_nop 1
 v_cndmask_b32 v122, v89, v90, vcc
 v_add_u32 v89, 4, v89
 v_subrev_u32 v90, 4, v90
 v_cmp_lt_u32 vcc, 35, v88
 s_nop 1
 v_cndmask_b32 v123, v89, v90, vcc
 v_add_u32 v89, 4, v89
 v_subrev_u32 v90, 4, v90
 v_cmp_lt_u32 vcc, 33, v88
 s_nop 1
 v_cndmask_b32 v124, v89, v90, vcc
 v_add_u32 v89, 4, v89
 v_subrev_u32 v90, 4, v90
 v_cmp_lt_u32 vcc, 31, v88
 s_nop 1
 v_cndmask_b32 v125, v89, v90, vcc
 v_add_u32 v89, 4, v89
 v_subrev_u32 v90, 4, v90
 v_cmp_lt_u32 vcc, 29, v88
 s_nop 1
 v_cndmask_b32 v126, v89, v90, vcc
 v_add_u32 v89, 4, v89
 v_subrev_u32 v90, 4, v90
 v_cmp_lt_u32 vcc, 27, v88
 s_nop 1
 v_cndmask_b32 v127, v89, v90, vcc
 v_add_u32 v89, 4, v89
 v_subrev_u32 v90, 4, v90
 v_cmp_lt_u32 vcc, 25, v88
 s_nop 1
 v_cndmask_b32 v128, v89, v90, vcc
 v_add_u32 v89, 4, v89
 v_subrev_u32 v90, 4, v90
 v_cmp_lt_u32 vcc, 23, v88
 s_nop 1
 v_cndmask_b32 v129, v89, v90, vcc
 v_lshrrev_b32_e64 v2, 1, v8
 v_mul_u32_u24 v3, 80, v2
 v_add_u32 v3, v3, v91
 s_cmp_eq_u32 s5, 0
 s_cselect_b64 vcc, -1, 0
 v_cndmask_b32 v120, v120, v3, vcc
 v_mul_u32_u24 v3, 156, v2
 v_add_u32 v3, v3, v91
 v_add_u32 v3, 2, v3
 v_cndmask_b32 v121, v121, v3, vcc
Loa_108:
 s_cmp_eq_u32 s5, 3
 s_cselect_b64 vcc, -1, 0
 v_cndmask_b32 v148, v9, v10, vcc
 s_cmp_ge_u32 s5, 2
 s_cselect_b64 vcc, -1, 0
 v_cndmask_b32_e64 v152, v9, v10, vcc
 v_add_u32 v149, 344064, v148
 v_add_u32 v153, 344064, v152
 v_add_u32 v150, 688128, v148
 v_add_u32 v154, 688128, v152
 v_add_u32 v151, 1032192, v148
 v_add_u32 v155, 1032192, v152
 s_mul_i32 s66, s5, 10
 s_add_u32 s67, s66, 1
 s_sub_u32 s65, s66, 19
 s_cmp_gt_u32 s66, 20
 s_cselect_b32 s66, s65, s66
 s_lshl_b32 s66, s66, 14
 s_add_u32 s66, s66, s62
 s_sub_u32 s65, s67, 19
 s_cmp_gt_u32 s67, 20
 s_cselect_b32 s67, s65, s67
 s_lshl_b32 s67, s67, 14
 s_add_u32 s67, s67, s62
 v_accvgpr_read_b32 v156, a248
 v_accvgpr_read_b32 v157, a249
 v_accvgpr_read_b32 v158, a250
 v_accvgpr_read_b32 v159, a251
 v_accvgpr_read_b32 v160, a252
 v_accvgpr_read_b32 v161, a253
 v_accvgpr_read_b32 v162, a254
 v_accvgpr_read_b32 v163, a255
 s_cmp_eq_u32 s5, 3
 s_cselect_b64 vcc, -1, 0
 v_cndmask_b32 v172, v156, v160, vcc
 v_cndmask_b32 v173, v157, v161, vcc
 v_cndmask_b32 v174, v158, v162, vcc
 v_cndmask_b32 v175, v159, v163, vcc
 s_cmp_ge_u32 s5, 2
 s_cselect_b64 vcc, -1, 0
 v_cndmask_b32 v176, v156, v160, vcc
 v_cndmask_b32 v177, v157, v161, vcc
 v_cndmask_b32 v178, v158, v162, vcc
 v_cndmask_b32 v179, v159, v163, vcc
 v_lshlrev_b32_e64 v80, 16, v12
 v_and_b32 v81, 0xffff0000, v12
 v_lshlrev_b32_e64 v82, 16, v13
 v_and_b32 v83, 0xffff0000, v13
 v_lshlrev_b32_e64 v84, 16, v14
 v_and_b32 v85, 0xffff0000, v14
 v_lshlrev_b32_e64 v86, 16, v15
 v_and_b32 v87, 0xffff0000, v15
 v_lshlrev_b32_e64 v88, 16, v16
 v_and_b32 v89, 0xffff0000, v16
 v_lshlrev_b32_e64 v90, 16, v17
 v_and_b32 v91, 0xffff0000, v17
 v_lshlrev_b32_e64 v92, 16, v18
 v_and_b32 v93, 0xffff0000, v18
 v_lshlrev_b32_e64 v94, 16, v19
 v_and_b32 v95, 0xffff0000, v19
 v_lshlrev_b32_e64 v96, 16, v20
 v_and_b32 v97, 0xffff0000, v20
 v_lshlrev_b32_e64 v98, 16, v21
 v_and_b32 v99, 0xffff0000, v21
 v_lshlrev_b32_e64 v100, 16, v22
 v_and_b32 v101, 0xffff0000, v22
 v_lshlrev_b32_e64 v102, 16, v23
 v_and_b32 v103, 0xffff0000, v23
 v_lshlrev_b32_e64 v104, 16, v24
 v_and_b32 v105, 0xffff0000, v24
 v_lshlrev_b32_e64 v106, 16, v25
 v_and_b32 v107, 0xffff0000, v25
 v_lshlrev_b32_e64 v108, 16, v26
 v_and_b32 v109, 0xffff0000, v26
 v_lshlrev_b32_e64 v110, 16, v27
 v_and_b32 v111, 0xffff0000, v27
 v_lshlrev_b32_e64 v112, 16, v28
 v_and_b32 v113, 0xffff0000, v28
 v_lshlrev_b32_e64 v114, 16, v29
 v_and_b32 v115, 0xffff0000, v29
 v_lshlrev_b32_e64 v116, 16, v30
 v_and_b32 v117, 0xffff0000, v30
 v_lshlrev_b32 v118, 16, v31
 v_and_b32 v119, 0xffff0000, v31
 s_barrier
 s_mov_b32 s39, 262144
Lzq_109:
 buffer_load_dword v74, v72, s[8:11], s62 offen sc1
 buffer_load_dword v75, v73, s[8:11], s62 offen sc1
 s_waitcnt vmcnt(0)
 v_max_u32 v3, v74, v75
 v_cmp_eq_u32 vcc, -1, v3
 s_cbranch_vccz Lzqd_110
 s_sub_u32 s39, s39, 1
 s_cmp_lg_u32 s39, 0
 s_cbranch_scc1 Lzq_109
Lzqd_110:
 s_mov_b32 s39, 65536
Lzp_111:
 buffer_load_dword v32, v148, s[8:11], s66 offen sc1
 buffer_load_dword v33, v149, s[8:11], s66 offen sc1
 buffer_load_dword v34, v150, s[8:11], s66 offen sc1
 buffer_load_dword v35, v151, s[8:11], s66 offen sc1
 s_mov_b32 s65, s67
 buffer_load_dword v36, v152, s[8:11], s65 offen sc1
 buffer_load_dword v37, v153, s[8:11], s65 offen sc1
 buffer_load_dword v38, v154, s[8:11], s65 offen sc1
 buffer_load_dword v39, v155, s[8:11], s65 offen sc1
 s_add_u32 s65, s65, 16384
 buffer_load_dword v40, v152, s[8:11], s65 offen sc1
 buffer_load_dword v41, v153, s[8:11], s65 offen sc1
 buffer_load_dword v42, v154, s[8:11], s65 offen sc1
 buffer_load_dword v43, v155, s[8:11], s65 offen sc1
 s_add_u32 s65, s65, 16384
 buffer_load_dword v44, v152, s[8:11], s65 offen sc1
 buffer_load_dword v45, v153, s[8:11], s65 offen sc1
 buffer_load_dword v46, v154, s[8:11], s65 offen sc1
 buffer_load_dword v47, v155, s[8:11], s65 offen sc1
 s_add_u32 s65, s65, 16384
 buffer_load_dword v48, v152, s[8:11], s65 offen sc1
 buffer_load_dword v49, v153, s[8:11], s65 offen sc1
 buffer_load_dword v50, v154, s[8:11], s65 offen sc1
 buffer_load_dword v51, v155, s[8:11], s65 offen sc1
 s_add_u32 s65, s65, 16384
 buffer_load_dword v52, v152, s[8:11], s65 offen sc1
 buffer_load_dword v53, v153, s[8:11], s65 offen sc1
 buffer_load_dword v54, v154, s[8:11], s65 offen sc1
 buffer_load_dword v55, v155, s[8:11], s65 offen sc1
 s_add_u32 s65, s65, 16384
 buffer_load_dword v56, v152, s[8:11], s65 offen sc1
 buffer_load_dword v57, v153, s[8:11], s65 offen sc1
 buffer_load_dword v58, v154, s[8:11], s65 offen sc1
 buffer_load_dword v59, v155, s[8:11], s65 offen sc1
 s_add_u32 s65, s65, 16384
 buffer_load_dword v60, v152, s[8:11], s65 offen sc1
 buffer_load_dword v61, v153, s[8:11], s65 offen sc1
 buffer_load_dword v62, v154, s[8:11], s65 offen sc1
 buffer_load_dword v63, v155, s[8:11], s65 offen sc1
 s_add_u32 s65, s65, 16384
 buffer_load_dword v64, v152, s[8:11], s65 offen sc1
 buffer_load_dword v65, v153, s[8:11], s65 offen sc1
 buffer_load_dword v66, v154, s[8:11], s65 offen sc1
 buffer_load_dword v67, v155, s[8:11], s65 offen sc1
 s_add_u32 s65, s65, 16384
 buffer_load_dword v68, v152, s[8:11], s65 offen sc1
 buffer_load_dword v69, v153, s[8:11], s65 offen sc1
 buffer_load_dword v70, v154, s[8:11], s65 offen sc1
 buffer_load_dword v71, v155, s[8:11], s65 offen sc1
 s_waitcnt vmcnt(0)
 v_max3_u32 v3, v32, v33, v34
 v_max3_u32 v3, v3, v35, v36
 v_max3_u32 v3, v3, v37, v38
 v_max3_u32 v3, v3, v39, v40
 v_max3_u32 v3, v3, v41, v42
 v_max3_u32 v3, v3, v43, v44
 v_max3_u32 v3, v3, v45, v46
 v_max3_u32 v3, v3, v47, v48
 v_max3_u32 v3, v3, v49, v50
 v_max3_u32 v3, v3, v51, v52
 v_max3_u32 v3, v3, v53, v54
 v_max3_u32 v3, v3, v55, v56
 v_max3_u32 v3, v3, v57, v58
 v_max3_u32 v3, v3, v59, v60
 v_max3_u32 v3, v3, v61, v62
 v_max3_u32 v3, v3, v63, v64
 v_max3_u32 v3, v3, v65, v66
 v_max3_u32 v3, v3, v67, v68
 v_max3_u32 v3, v3, v69, v70
 v_max_u32 v3, v3, v71
 v_cmp_eq_u32_e64 vcc, -1, v3
 s_cbranch_vccz Lzd_112
 s_sub_u32 s39, s39, 1
 s_cmp_lg_u32 s39, 0
 s_cbranch_scc1 Lzp_111
Lzd_112:
 v_mfma_f32_16x16x32_bf16 v[80:83], v[32:35], v[172:175], v[80:83]
 v_mfma_f32_16x16x32_bf16 v[84:87], v[36:39], v[176:179], v[84:87]
 v_mfma_f32_16x16x32_bf16 v[88:91], v[40:43], v[176:179], v[88:91]
 v_mfma_f32_16x16x32_bf16 v[92:95], v[44:47], v[176:179], v[92:95]
 v_mfma_f32_16x16x32_bf16 v[96:99], v[48:51], v[176:179], v[96:99]
 v_mfma_f32_16x16x32_bf16 v[100:103], v[52:55], v[176:179], v[100:103]
 v_mfma_f32_16x16x32_bf16 v[104:107], v[56:59], v[176:179], v[104:107]
 v_mfma_f32_16x16x32_bf16 v[108:111], v[60:63], v[176:179], v[108:111]
 v_mfma_f32_16x16x32_bf16 v[112:115], v[64:67], v[176:179], v[112:115]
 v_mfma_f32_16x16x32_bf16 v[116:119], v[68:71], v[176:179], v[116:119]
 v_cvt_pk_bf16_f32 v32, v80, v81
 v_cvt_pk_bf16_f32 v33, v82, v83
 v_cvt_pk_bf16_f32 v34, v84, v85
 v_cvt_pk_bf16_f32 v35, v86, v87
 v_cvt_pk_bf16_f32 v36, v88, v89
 v_cvt_pk_bf16_f32 v37, v90, v91
 v_cvt_pk_bf16_f32 v38, v92, v93
 v_cvt_pk_bf16_f32 v39, v94, v95
 v_cvt_pk_bf16_f32 v40, v96, v97
 v_cvt_pk_bf16_f32 v41, v98, v99
 v_cvt_pk_bf16_f32 v42, v100, v101
 v_cvt_pk_bf16_f32 v43, v102, v103
 v_cvt_pk_bf16_f32 v44, v104, v105
 v_cvt_pk_bf16_f32 v45, v106, v107
 v_cvt_pk_bf16_f32 v46, v108, v109
 v_cvt_pk_bf16_f32 v47, v110, v111
 v_cvt_pk_bf16_f32 v48, v112, v113
 v_cvt_pk_bf16_f32 v49, v114, v115
 v_cvt_pk_bf16_f32 v50, v116, v117
 v_cvt_pk_bf16_f32 v51, v118, v119
 s_cmp_lg_u32 s42, 0
 s_cbranch_scc1 Lb2last_113
 v_pk_add_f32 v[134:135], v[80:81], v[82:83]
 v_pk_mul_f32 v[156:157], v[80:81], v[80:81]
 v_pk_fma_f32 v[156:157], v[82:83], v[82:83], v[156:157]
 v_pk_add_f32 v[134:135], v[134:135], v[84:85]
 v_pk_fma_f32 v[156:157], v[84:85], v[84:85], v[156:157]
 v_pk_add_f32 v[134:135], v[134:135], v[86:87]
 v_pk_fma_f32 v[156:157], v[86:87], v[86:87], v[156:157]
 v_pk_add_f32 v[134:135], v[134:135], v[88:89]
 v_pk_fma_f32 v[156:157], v[88:89], v[88:89], v[156:157]
 v_pk_add_f32 v[134:135], v[134:135], v[90:91]
 v_pk_fma_f32 v[156:157], v[90:91], v[90:91], v[156:157]
 v_pk_add_f32 v[134:135], v[134:135], v[92:93]
 v_pk_fma_f32 v[156:157], v[92:93], v[92:93], v[156:157]
 v_pk_add_f32 v[134:135], v[134:135], v[94:95]
 v_pk_fma_f32 v[156:157], v[94:95], v[94:95], v[156:157]
 v_pk_add_f32 v[134:135], v[134:135], v[96:97]
 v_pk_fma_f32 v[156:157], v[96:97], v[96:97], v[156:157]
 v_pk_add_f32 v[134:135], v[134:135], v[98:99]
 v_pk_fma_f32 v[156:157], v[98:99], v[98:99], v[156:157]
 v_pk_add_f32 v[134:135], v[134:135], v[100:101]
 v_pk_fma_f32 v[156:157], v[100:101], v[100:101], v[156:157]
 v_pk_add_f32 v[134:135], v[134:135], v[102:103]
 v_pk_fma_f32 v[156:157], v[102:103], v[102:103], v[156:157]
 v_pk_add_f32 v[134:135], v[134:135], v[104:105]
 v_pk_fma_f32 v[156:157], v[104:105], v[104:105], v[156:157]
 v_pk_add_f32 v[134:135], v[134:135], v[106:107]
 v_pk_fma_f32 v[156:157], v[106:107], v[106:107], v[156:157]
 v_pk_add_f32 v[134:135], v[134:135], v[108:109]
 v_pk_fma_f32 v[156:157], v[108:109], v[108:109], v[156:157]
 v_pk_add_f32 v[134:135], v[134:135], v[110:111]
 v_pk_fma_f32 v[156:157], v[110:111], v[110:111], v[156:157]
 v_pk_add_f32 v[134:135], v[134:135], v[112:113]
 v_pk_fma_f32 v[156:157], v[112:113], v[112:113], v[156:157]
 v_pk_add_f32 v[134:135], v[134:135], v[114:115]
 v_pk_fma_f32 v[156:157], v[114:115], v[114:115], v[156:157]
 v_pk_add_f32 v[134:135], v[134:135], v[116:117]
 v_pk_fma_f32 v[156:157], v[116:117], v[116:117], v[156:157]
 v_pk_add_f32 v[134:135], v[134:135], v[118:119]
 v_pk_fma_f32 v[156:157], v[118:119], v[118:119], v[156:157]
 v_add_f32 v134, v134, v135
 v_add_f32 v135, v156, v157
 v_mov_b32 v2, v134
 s_nop 1
 v_permlane16_swap_b32 v2, v134
 v_add_f32 v134, v134, v2
 v_mov_b32 v2, v134
 s_nop 1
 v_permlane32_swap_b32 v2, v134
 v_add_f32 v134, v134, v2
 v_mov_b32 v2, v135
 s_nop 1
 v_permlane16_swap_b32 v2, v135
 v_add_f32 v135, v135, v2
 v_mov_b32_e64 v2, v135
 s_nop 1
 v_permlane32_swap_b32 v2, v135
 v_add_f32 v135, v135, v2
 s_lshl_b32 s46, s5, 7
 s_add_u32 s46, s46, 117760
 v_lshlrev_b32_e64 v3, 3, v6
 v_add_u32 v2, s46, v3
 ds_write_b64 v2, v[134:135]
 s_waitcnt lgkmcnt(0)
 s_barrier
 v_add_u32 v3, 117760, v3
 ds_read_b64 v[52:53], v3 offset:0
 ds_read_b64 v[54:55], v3 offset:128
 ds_read_b64 v[56:57], v3 offset:256
 ds_read_b64 v[58:59], v3 offset:384
 s_waitcnt lgkmcnt(0)
 v_pk_add_f32 v[52:53], v[52:53], v[54:55]
 v_pk_add_f32 v[56:57], v[56:57], v[58:59]
 v_pk_add_f32 v[134:135], v[52:53], v[56:57]
 v_mul_f32 v134, 0x3acccccd, v134
 v_mul_f32 v135, 0x3acccccd, v135
 v_fma_f32 v156, -v134, v134, v135
 v_add_f32 v156, 0x3727c5ac, v156
 v_rsq_f32 v156, v156
 s_nop 0
 v_mul_f32_e64 v134, -v134, v156
 v_pk_fma_f32 v[80:81], v[80:81], v[156:157], v[134:135] op_sel_hi:[1,0,0]
 v_pk_fma_f32 v[82:83], v[82:83], v[156:157], v[134:135] op_sel_hi:[1,0,0]
 v_pk_fma_f32 v[84:85], v[84:85], v[156:157], v[134:135] op_sel_hi:[1,0,0]
 v_pk_fma_f32 v[86:87], v[86:87], v[156:157], v[134:135] op_sel_hi:[1,0,0]
 v_pk_fma_f32 v[88:89], v[88:89], v[156:157], v[134:135] op_sel_hi:[1,0,0]
 v_pk_fma_f32 v[90:91], v[90:91], v[156:157], v[134:135] op_sel_hi:[1,0,0]
 v_pk_fma_f32 v[92:93], v[92:93], v[156:157], v[134:135] op_sel_hi:[1,0,0]
 v_pk_fma_f32 v[94:95], v[94:95], v[156:157], v[134:135] op_sel_hi:[1,0,0]
 v_pk_fma_f32 v[96:97], v[96:97], v[156:157], v[134:135] op_sel_hi:[1,0,0]
 v_pk_fma_f32 v[98:99], v[98:99], v[156:157], v[134:135] op_sel_hi:[1,0,0]
 v_pk_fma_f32 v[100:101], v[100:101], v[156:157], v[134:135] op_sel_hi:[1,0,0]
 v_pk_fma_f32 v[102:103], v[102:103], v[156:157], v[134:135] op_sel_hi:[1,0,0]
 v_pk_fma_f32 v[104:105], v[104:105], v[156:157], v[134:135] op_sel_hi:[1,0,0]
 v_pk_fma_f32 v[106:107], v[106:107], v[156:157], v[134:135] op_sel_hi:[1,0,0]
 v_pk_fma_f32 v[108:109], v[108:109], v[156:157], v[134:135] op_sel_hi:[1,0,0]
 v_pk_fma_f32 v[110:111], v[110:111], v[156:157], v[134:135] op_sel_hi:[1,0,0]
 v_pk_fma_f32 v[112:113], v[112:113], v[156:157], v[134:135] op_sel_hi:[1,0,0]
 v_pk_fma_f32 v[114:115], v[114:115], v[156:157], v[134:135] op_sel_hi:[1,0,0]
 v_pk_fma_f32 v[116:117], v[116:117], v[156:157], v[134:135] op_sel_hi:[1,0,0]
 v_pk_fma_f32 v[118:119], v[118:119], v[156:157], v[134:135] op_sel_hi:[1,0,0]
 v_cvt_pk_bf16_f32 v60, v80, v81
 v_cvt_pk_bf16_f32 v61, v82, v83
 v_cvt_pk_bf16_f32 v62, v84, v85
 v_cvt_pk_bf16_f32 v63, v86, v87
 v_cvt_pk_bf16_f32 v64, v88, v89
 v_cvt_pk_bf16_f32 v65, v90, v91
 v_cvt_pk_bf16_f32 v66, v92, v93
 v_cvt_pk_bf16_f32 v67, v94, v95
 v_cvt_pk_bf16_f32 v68, v96, v97
 v_cvt_pk_bf16_f32 v69, v98, v99
 v_cvt_pk_bf16_f32 v70, v100, v101
 v_cvt_pk_bf16_f32 v71, v102, v103
 v_cvt_pk_bf16_f32 v72, v104, v105
 v_cvt_pk_bf16_f32 v73, v106, v107
 v_cvt_pk_bf16_f32 v74, v108, v109
 v_cvt_pk_bf16_f32 v75, v110, v111
 v_cvt_pk_bf16_f32 v76, v112, v113
 v_cvt_pk_bf16_f32 v77, v114, v115
 v_cvt_pk_bf16_f32 v78, v116, v117
 v_cvt_pk_bf16_f32 v79, v118, v119
 s_mov_b32 s46, 3670016
 v_permlane16_swap_b32 v60, v62
 v_permlane16_swap_b32 v61, v63
 buffer_store_dwordx4 v[60:63], v11, s[8:11], s46 offen sc1
 s_add_u32 s46, s46, 2048
 v_permlane16_swap_b32 v64, v66
 v_permlane16_swap_b32 v65, v67
 buffer_store_dwordx4 v[64:67], v11, s[8:11], s46 offen sc1
 s_add_u32 s46, s46, 2048
 v_permlane16_swap_b32 v68, v70
 v_permlane16_swap_b32 v69, v71
 buffer_store_dwordx4 v[68:71], v11, s[8:11], s46 offen sc1
 s_add_u32 s46, s46, 2048
 v_permlane16_swap_b32 v72, v74
 v_permlane16_swap_b32 v73, v75
 buffer_store_dwordx4 v[72:75], v11, s[8:11], s46 offen sc1
 s_add_u32 s46, s46, 2048
 v_permlane16_swap_b32 v76, v78
 v_permlane16_swap_b32 v77, v79
 buffer_store_dwordx4 v[76:79], v11, s[8:11], s46 offen sc1
 s_add_u32 s46, s46, 2048
 s_mov_b32 s46, 1048576
 v_permlane16_swap_b32 v32, v34
 v_permlane16_swap_b32 v33, v35
 buffer_store_dwordx4 v[32:35], v11, s[8:11], s46 offen sc1
 s_add_u32 s46, s46, 2048
 v_permlane16_swap_b32 v36, v38
 v_permlane16_swap_b32 v37, v39
 buffer_store_dwordx4 v[36:39], v11, s[8:11], s46 offen sc1
 s_add_u32 s46, s46, 2048
 v_permlane16_swap_b32 v40, v42
 v_permlane16_swap_b32 v41, v43
 buffer_store_dwordx4 v[40:43], v11, s[8:11], s46 offen sc1
 s_add_u32 s46, s46, 2048
 v_permlane16_swap_b32 v44, v46
 v_permlane16_swap_b32 v45, v47
 buffer_store_dwordx4 v[44:47], v11, s[8:11], s46 offen sc1
 s_add_u32 s46, s46, 2048
 v_permlane16_swap_b32 v48, v50
 v_permlane16_swap_b32 v49, v51
 buffer_store_dwordx4 v[48:51], v11, s[8:11], s46 offen sc1
 s_add_u32 s46, s46, 2048
 s_branch Lb2join_114
Lb2last_113:
 ds_write_b16 v120, v32
 ds_write_b16_d16_hi v120, v32 offset:160
 ds_write_b16 v120, v33 offset:320
 ds_write_b16_d16_hi v120, v33 offset:480
 ds_write_b16 v121, v34
 ds_write_b16_d16_hi v121, v34 offset:160
 ds_write_b16 v121, v35 offset:320
 ds_write_b16_d16_hi v121, v35 offset:480
 ds_write_b16 v122, v36
 ds_write_b16_d16_hi v122, v36 offset:160
 ds_write_b16 v122, v37 offset:320
 ds_write_b16_d16_hi v122, v37 offset:480
 ds_write_b16 v123, v38
 ds_write_b16_d16_hi v123, v38 offset:160
 ds_write_b16 v123, v39 offset:320
 ds_write_b16_d16_hi v123, v39 offset:480
 ds_write_b16 v124, v40
 ds_write_b16_d16_hi v124, v40 offset:160
 ds_write_b16 v124, v41 offset:320
 ds_write_b16_d16_hi v124, v41 offset:480
 ds_write_b16 v125, v42
 ds_write_b16_d16_hi v125, v42 offset:160
 ds_write_b16 v125, v43 offset:320
 ds_write_b16_d16_hi v125, v43 offset:480
 ds_write_b16 v126, v44
 ds_write_b16_d16_hi v126, v44 offset:160
 ds_write_b16 v126, v45 offset:320
 ds_write_b16_d16_hi v126, v45 offset:480
 ds_write_b16 v127, v46
 ds_write_b16_d16_hi v127, v46 offset:160
 ds_write_b16 v127, v47 offset:320
 ds_write_b16_d16_hi v127, v47 offset:480
 ds_write_b16 v128, v48
 ds_write_b16_d16_hi v128, v48 offset:160
 ds_write_b16 v128, v49 offset:320
 ds_write_b16_d16_hi v128, v49 offset:480
 ds_write_b16 v129, v50
 ds_write_b16_d16_hi v129, v50 offset:160
 ds_write_b16 v129, v51 offset:320
 ds_write_b16_d16_hi v129, v51 offset:480
 s_waitcnt lgkmcnt(0)
 s_barrier
 s_mov_b32 s12, s24
 s_and_b32 s13, s25, 0xffff
 s_mov_b32 s14, 2621440
 s_mov_b32 s15, 0x20000
 v_lshrrev_b32 v2, 4, v0
 v_and_b32 v3, 15, v0
 v_mul_u32_u24 v105, 1296, v2
 v_lshl_add_u32 v105, v3, 4, v105
 v_add_u32 v105, 97280, v105
 s_lshl_b32 s46, s4, 3
 s_add_u32 s46, s46, s3
 v_lshlrev_b32 v2, 7, v2
 v_add_u32 v2, s46, v2
 v_mul_u32_u24 v104, 1280, v2
 v_lshl_add_u32 v104, v3, 4, v104
 ds_read_b128 v[84:87], v105 offset:0
 ds_read_b128 v[88:91], v105 offset:256
 ds_read_b128 v[92:95], v105 offset:512
 ds_read_b128 v[96:99], v105 offset:768
 ds_read_b128 v[100:103], v105 offset:1024
 s_waitcnt lgkmcnt(0)
 buffer_store_dwordx4 v[84:87], v104, s[12:15], 0 offen offset:0 sc1
 buffer_store_dwordx4 v[88:91], v104, s[12:15], 0 offen offset:256 sc1
 buffer_store_dwordx4 v[92:95], v104, s[12:15], 0 offen offset:512 sc1
 buffer_store_dwordx4 v[96:99], v104, s[12:15], 0 offen offset:768 sc1
 buffer_store_dwordx4 v[100:103], v104, s[12:15], 0 offen offset:1024 sc1
Lb2join_114:
Lb2d_106:
 s_cmp_lg_u32 s42, 0
 s_cbranch_scc1 Lfin_115
 s_waitcnt vmcnt(5) lgkmcnt(0)
 s_barrier
 s_add_u32 s40, s40, 1
 s_cmp_lg_u32 s5, 0
 s_cbranch_scc1 Llb_116
 v_mov_b32 v3, s40
 s_mov_b64 s[6:7], exec
 s_mov_b64 exec, 1
 buffer_store_dword v3, v4, s[8:11], 0 offen sc1
 s_mov_b64 exec, s[6:7]
 s_mov_b32 s39, 4194304
Lpoll_117:
 buffer_load_dword v2, v5, s[8:11], 0 offen sc1
 s_waitcnt vmcnt(0)
 v_cmp_gt_u32 vcc, s40, v2
 s_cbranch_vccz Lpdone_118
 s_sub_u32 s39, s39, 1
 s_cmp_lg_u32 s39, 0
 s_cbranch_scc1 Lpoll_117
Lpdone_118:
Llb_116:
 s_barrier
 s_mov_b32 s42, 1
 s_branch Llayer_72
Lfin_115:
 s_waitcnt vmcnt(0) lgkmcnt(0)
 s_endpgm
Lsub_phi:
 s_nop 1
 v_and_b32 v188, 31, v1
 v_lshrrev_b32 v2, 3, v188
 v_lshlrev_b32 v2, 2, v2
 v_and_b32 v3, 3, v188
 v_add_u32_e64 v2, v2, v3
 v_bfe_u32 v3, v188, 2, 1
 v_mul_u32_u24 v191, 10, v3
 v_add_u32 v191, v191, v2
 v_lshrrev_b32_e64 v3, 5, v1
 v_mul_u32_u24 v189, 80, v3
 v_add_u32 v189, v189, v191
 v_lshlrev_b32 v189, 1, v189
 v_add_u32 v189, 154880, v189
 ds_read_u16 v192, v189 offset:0
 ds_read_u16 v193, v189 offset:40
 ds_read_u16 v194, v189 offset:80
 ds_read_u16 v195, v189 offset:120
 ds_read_u16 v196, v189 offset:320
 ds_read_u16 v197, v189 offset:360
 ds_read_u16 v198, v189 offset:400
 ds_read_u16 v199, v189 offset:440
 ds_read_u16 v200, v189 offset:640
 ds_read_u16 v201, v189 offset:680
 ds_read_u16 v202, v189 offset:720
 ds_read_u16 v203, v189 offset:760
 s_waitcnt lgkmcnt(0)
 v_lshl_or_b32 v136, v193, 16, v192
 v_lshl_or_b32 v137, v195, 16, v194
 v_lshl_or_b32 v138, v197, 16, v196
 v_lshl_or_b32 v139, v199, 16, v198
 v_lshl_or_b32 v140, v201, 16, v200
 v_lshl_or_b32 v141, v203, 16, v202
 v_cmp_gt_u32 vcc, 10, v2
 s_nop 1
 v_cndmask_b32 v136, 0, v136, vcc
 v_cndmask_b32 v137, 0, v137, vcc
 v_cndmask_b32 v138, 0, v138, vcc
 v_cndmask_b32 v139, 0, v139, vcc
 v_cndmask_b32 v140, 0, v140, vcc
 v_cndmask_b32 v141, 0, v141, vcc
 v_cmp_gt_u32 vcc, 32, v1
 s_nop 1
 v_cndmask_b32 v140, 0, v140, vcc
 v_cndmask_b32 v141, 0, v141, vcc
 v_mov_b32 v142, 0
 v_mov_b32 v143, 0
 s_nop 1
 s_setpc_b64 s[36:37]
Lsub_raw:
 s_nop 1
 s_mov_b32 s47, 0x05040100
 s_mov_b32 s48, 0x07060302
 v_perm_b32 v188, v150, v148, s47
 v_perm_b32 v189, v154, v152, s47
 v_perm_b32 v190, v158, v156, s47
 v_perm_b32 v191, v162, v160, s47
 ds_write_b128 v184, v[188:191] offset:10240
 v_perm_b32 v192, v150, v148, s48
 v_perm_b32 v193, v154, v152, s48
 v_perm_b32 v194, v158, v156, s48
 v_perm_b32 v195, v162, v160, s48
 ds_write_b128 v185, v[192:195] offset:10240
 v_perm_b32 v188, v151, v149, s47
 v_perm_b32 v189, v155, v153, s47
 v_perm_b32 v190, v159, v157, s47
 v_perm_b32 v191, v163, v161, s47
 ds_write_b128 v186, v[188:191] offset:10240
 v_perm_b32 v192, v151, v149, s48
 v_perm_b32 v193, v155, v153, s48
 v_perm_b32 v194, v159, v157, s48
 v_perm_b32 v195, v163, v161, s48
 ds_write_b128 v187, v[192:195] offset:10240
 s_nop 1
 s_setpc_b64 s[36:37]
Lexit:
 s_endpgm
Lcode_end:
.p2align 8
.type fnet_tab,@object
fnet_tab:
.quad 0x3f803f803f803f80,0x3f803f803f803f80,0x3f803f803f803f80,0x3f803f803f803f80,0xbf3500003f353f80,0xbf4fbe203f163f7d,0xbf35bf80bf350000,0xbf16bf7dbf4fbe20,0xbf8000003f80,0x3e9ebf73be9e3f73,0x3f800000bf800000,0x3f733e9ebf73be9e,0x3f350000bf353f80,0x3e9e3ee8bf733f64,0xbf353f80bf350000,0xbf733f64be9ebee8
.quad 0xbf803f80bf803f80,0xbf4f3f4fbf4f3f4f,0,0x3f16bf163f16bf16,0x3f350000bf353f80,0x3f80bf3500003f35,0x3f35bf803f350000,0xbf353f80bf35,0xbf8000003f80,0xbf4fbf163f4f3f16,0xbf8000003f800000,0xbf163f4f3f16bf4f,0xbf3500003f353f80,0x3e9e3f643f733ee8,0x3f353f803f350000,0x3f733ee8be9ebf64
.quad 0x3f803f803f803f80,0x3f803f803f803f80,0x3f803f803f803f80,0x3f803f803f803f80,0x3f350000bf35bf80,0x3f4f3e20bf16bf7d,0x3f353f803f350000,0x3f163f7d3f4f3e20,0xbf8000003f80,0x3e9ebf73be9e3f73,0x3f800000bf800000,0x3f733e9ebf73be9e,0xbf3500003f35bf80,0xbe9ebee83f73bf64,0x3f35bf803f350000,0x3f73bf643e9e3ee8
.quad 0xbf803f80bf803f80,0xbf4f3f4fbf4f3f4f,0,0x3f16bf163f16bf16,0xbf3500003f35bf80,0xbf803f350000bf35,0xbf353f80bf350000,0x3f35bf803f35,0xbf8000003f80,0xbf4fbf163f4f3f16,0xbf8000003f800000,0xbf163f4f3f16bf4f,0x3f350000bf35bf80,0xbe9ebf64bf73bee8,0xbf35bf80bf350000,0xbf73bee83e9e3f64
.quad 0x3f803f803f803f80,0x3f803f803f803f80,0xbf80bf80bf80bf80,0xbf80bf80bf80bf80,0xbf43bda13f263f7f,0xbf5abe6f3f063f79,0xbf26bf7fbf43bda1,0xbf06bf79bf5abe6f,0x3e20bf7dbe203f7d,0x3ee8bf64bee83f64,0x3f7d3e20bf7dbe20,0x3f643ee8bf64bee8,0x3f063e6fbf5a3f79,0x3da13f26bf7f3f43,0xbf5a3f79bf06be6f,0xbf7f3f43bda1bf26
.quad 0xbf733f73bf733f73,0xbf163f16bf163f16,0x3e9ebe9e3e9ebe9e,0x3f4fbf4f3f4fbf4f,0x3f6dbec4bec43f6d,0x3f6dbf6d3ec43ec4,0x3ec4bf6d3f6dbec4,0xbec4bec43f6dbf6d,0xbee8bf643ee83f64,0xbf7dbe203f7d3e20,0xbf643ee83f64bee8,0xbe203f7d3e20bf7d,0xbe6f3f063f793f5a,0x3f433f7f3f26bda1,0x3f793f5a3e6fbf06,0x3f26bda1bf43bf7f
.quad 0x3f803f803f803f80,0x3f803f803f803f80,0xbf80bf80bf80bf80,0xbf80bf80bf80bf80,0x3f433da1bf26bf7f,0x3f5a3e6fbf06bf79,0x3f263f7f3f433da1,0x3f063f793f5a3e6f,0x3e20bf7dbe203f7d,0x3ee8bf64bee83f64,0x3f7d3e20bf7dbe20,0x3f643ee8bf64bee8,0xbf06be6f3f5abf79,0xbda1bf263f7fbf43,0x3f5abf793f063e6f,0x3f7fbf433da13f26
.quad 0xbf733f73bf733f73,0xbf163f16bf163f16,0x3e9ebe9e3e9ebe9e,0x3f4fbf4f3f4fbf4f,0xbf6d3ec43ec4bf6d,0xbf6d3f6dbec4bec4,0xbec43f6dbf6d3ec4,0x3ec43ec4bf6d3f6d,0xbee8bf643ee83f64,0xbf7dbe203f7d3e20,0xbf643ee83f64bee8,0xbe203f7d3e20bf7d,0x3e6fbf06bf79bf5a,0xbf43bf7fbf263da1,0xbf79bf5abe6f3f06,0xbf263da13f433f7f
.quad 0x3f803f803f803f80,0x3f803f803f803f80,0x3f803f803f803f80,0x3f803f803f803f80,0xbf64be9e3ee83f73,0xbf73bee83e9e3f64,0xbee8bf73bf64be9e,0xbe9ebf64bf73bee8,0x3f16bf4fbf163f4f,0x3f4fbf16bf4f3f16,0x3f4f3f16bf4fbf16,0x3f163f4fbf16bf4f,0xbe203f4fbf7d3f16,0xbf163f7dbf4f3e20,0xbf7d3f163e20bf4f,0xbf4f3e203f16bf7d
.quad 0xbe9e3e9ebe9e3e9e,0x3e9ebe9e3e9ebe9e,0x3f73bf733f73bf73,0x3f73bf733f73bf73,0x3f35bf803f350000,0xbf353f80bf35,0xbf3500003f35bf80,0xbf803f350000bf35,0xbf733e9e3f73be9e,0xbe9e3f733e9ebf73,0x3e9e3f73be9ebf73,0x3f733e9ebf73be9e,0x3f7d3f4f3e20bf16,0x3f16be20bf4fbf7d,0x3e20bf16bf7dbf4f,0xbf4fbf7dbf163e20
.quad 0x3f803f803f803f80,0x3f803f803f803f80,0x3f803f803f803f80,0x3f803f803f803f80,0x3f643e9ebee8bf73,0x3f733ee8be9ebf64,0x3ee83f733f643e9e,0x3e9e3f643f733ee8,0x3f16bf4fbf163f4f,0x3f4fbf16bf4f3f16,0x3f4f3f16bf4fbf16,0x3f163f4fbf16bf4f,0x3e20bf4f3f7dbf16,0x3f16bf7d3f4fbe20,0x3f7dbf16be203f4f,0x3f4fbe20bf163f7d
.quad 0xbe9e3e9ebe9e3e9e,0x3e9ebe9e3e9ebe9e,0x3f73bf733f73bf73,0x3f73bf733f73bf73,0xbf353f80bf350000,0x3f35bf803f35,0x3f350000bf353f80,0x3f80bf3500003f35,0xbf733e9e3f73be9e,0xbe9e3f733e9ebf73,0x3e9e3f73be9ebf73,0x3f733e9ebf73be9e,0xbf7dbf4fbe203f16,0xbf163e203f4f3f7d,0xbe203f163f7d3f4f,0x3f4f3f7d3f16be20
.quad 0x3f803f803f803f80,0x3f803f803f803f80,0xbf80bf80bf80bf80,0xbf80bf80bf80bf80,0xbf6dbec43ec43f6d,0xbf79bf063e6f3f5a,0xbec4bf6dbf6dbec4,0xbe6fbf5abf79bf06,0x3f35bf35bf353f35,0x3f64bee8bf643ee8,0x3f353f35bf35bf35,0x3ee83f64bee8bf64,0xbec43f6dbf6d3ec4,0xbf433f7fbf26bda1,0xbf6d3ec43ec4bf6d,0xbf26bda13f43bf7f
.quad 0,0x3f16bf163f16bf16,0x3f80bf803f80bf80,0x3f4fbf4f3f4fbf4f,0x3ec4bf6d3f6dbec4,0xbec4bec43f6dbf6d,0xbf6d3ec43ec4bf6d,0xbf6d3f6dbec4bec4,0xbf353f353f35bf35,0x3e203f7dbe20bf7d,0x3f353f35bf35bf35,0x3f7dbe20bf7d3e20,0x3f6d3ec4bec4bf6d,0x3da1bf26bf7fbf43,0xbec4bf6dbf6dbec4,0xbf7fbf43bda13f26
.quad 0x3f803f803f803f80,0x3f803f803f803f80,0xbf80bf80bf80bf80,0xbf80bf80bf80bf80,0x3f6d3ec4bec4bf6d,0x3f793f06be6fbf5a,0x3ec43f6d3f6d3ec4,0x3e6f3f5a3f793f06,0x3f35bf35bf353f35,0x3f64bee8bf643ee8,0x3f353f35bf35bf35,0x3ee83f64bee8bf64,0x3ec4bf6d3f6dbec4,0x3f43bf7f3f263da1,0x3f6dbec4bec43f6d,0x3f263da1bf433f7f
.quad 0,0x3f16bf163f16bf16,0x3f80bf803f80bf80,0x3f4fbf4f3f4fbf4f,0xbec43f6dbf6d3ec4,0x3ec43ec4bf6d3f6d,0x3f6dbec4bec43f6d,0x3f6dbf6d3ec43ec4,0xbf353f353f35bf35,0x3e203f7dbe20bf7d,0x3f353f35bf35bf35,0x3f7dbe20bf7d3e20,0xbf6dbec43ec43f6d,0xbda13f263f7f3f43,0x3ec43f6d3f6d3ec4,0x3f7f3f433da1bf26
.quad 0x3f803f803f803f80,0,0x3f803f803f803f80,0,0xbf7dbf163e203f4f,0x8000800000000000,0xbe20bf4fbf7dbf16,0x800080008000,0x3f73be9ebf733e9e,0x80000000,0x3e9e3f73be9ebf73,0x8000,0xbf643f73bee8be9e,0x8000000000008000,0xbee8be9e3f64bf73,0x800000008000
.quad 0x3f4fbf4f3f4fbf4f,0x800000008000,0x3f16bf163f16bf16,0,0xbf3500003f35bf80,0x8000000000008000,0xbf353f80bf350000,0x80000000,0x3f163f4fbf16bf4f,0x80000000,0x3f4fbf16bf4f3f16,0x800000000000,0xbee8bf73bf64be9e,0x8000800000000000,0xbf64be9e3ee83f73,0
.quad 0x3f803f803f803f80,0,0x3f803f803f803f80,0,0x3f7d3f16be20bf4f,0x8000,0x3e203f4f3f7d3f16,0,0x3f73be9ebf733e9e,0x80000000,0x3e9e3f73be9ebf73,0x8000,0x3f64bf733ee83e9e,0x800000000000,0x3ee83e9ebf643f73,0x80000000
.quad 0x3f4fbf4f3f4fbf4f,0x800000008000,0x3f16bf163f16bf16,0,0x3f350000bf353f80,0x800000000000,0x3f35bf803f350000,0x800000008000,0x3f163f4fbf16bf4f,0x80000000,0x3f4fbf16bf4f3f16,0x800000000000,0x3ee83f733f643e9e,0x8000,0x3f643e9ebee8bf73,0x800080008000
.quad 0x3f803f803f803f80,0,0xbf80bf80bf80bf80,0x8000800080008000,0xbf7fbf263da13f43,0x8000800080000000,0xbda1bf43bf7fbf26,0x800080008000,0x3f7dbe20bf7d3e20,0x80008000,0x3e203f7dbe20bf7d,0x8000000000008000,0xbf793f5abe6fbf06,0x8000000000008000,0xbe6fbf063f79bf5a,0x800000008000
.quad 0x3f73bf733f73bf73,0x800000008000,0x3e9ebe9e3e9ebe9e,0x8000000080000000,0xbf6d3ec43ec4bf6d,0x8000000080008000,0xbec43f6dbf6d3ec4,0x80000000,0x3f643ee8bf64bee8,0x800080000000,0x3ee8bf64bee83f64,0x8000800000000000,0xbf5abf79bf063e6f,0x8000800000000000,0xbf063e6f3f5a3f79,0
.quad 0x3f803f803f803f80,0,0xbf80bf80bf80bf80,0x8000800080008000,0x3f7f3f26bda1bf43,0x8000,0x3da13f433f7f3f26,0x8000000000000000,0x3f7dbe20bf7d3e20,0x80008000,0x3e203f7dbe20bf7d,0x8000000000008000,0x3f79bf5a3e6f3f06,0x800080000000,0x3e6f3f06bf793f5a,0x8000000080000000
.quad 0x3f73bf733f73bf73,0x800000008000,0x3e9ebe9e3e9ebe9e,0x8000000080000000,0x3f6dbec4bec43f6d,0x800000000000,0x3ec4bf6d3f6dbec4,0x8000800000008000,0x3f643ee8bf64bee8,0x800080000000,0x3ee8bf64bee83f64,0x8000800000000000,0x3f5a3f793f06be6f,0x80008000,0x3f06be6fbf5abf79,0x8000800080008000
.quad 0x3f803f803f803f80,0x3e9e3e9e3e9e3e9e,0,0xbf73bf73bf73bf73,0xbf3500003f353f80,0xbf4fbf7dbf163e20,0xbf35bf80bf350000,0x3f16be20bf4fbf7d,0xbf8000003f80,0x3f800000bf800000,0x3f800000bf800000,0x3f800000bf80,0x3f350000bf353f80,0xbf4f3f7dbf16be20,0xbf353f80bf350000,0xbf16be203f4fbf7d
.quad 0xbf803f80bf803f80,0x3e9ebe9e3e9ebe9e,0,0x3f73bf733f73bf73,0x3f350000bf353f80,0x3e9ebf643f73bee8,0x3f35bf803f350000,0xbf733ee83e9ebf64,0xbf8000003f80,0xbf4f3f163f4fbf16,0xbf8000003f800000,0x3f163f4fbf16bf4f,0xbf3500003f353f80,0x3f803f350000bf35,0x3f353f803f350000,0xbf35bf80bf35
.quad 0x3f803f803f803f80,0x3e9e3e9e3e9e3e9e,0,0xbf73bf73bf73bf73,0x3f350000bf35bf80,0x3f4f3f7d3f16be20,0x3f353f803f350000,0xbf163e203f4f3f7d,0xbf8000003f80,0x3f800000bf800000,0x3f800000bf800000,0x3f800000bf80,0xbf3500003f35bf80,0x3f4fbf7d3f163e20,0x3f35bf803f350000,0x3f163e20bf4f3f7d
.quad 0xbf803f80bf803f80,0x3e9ebe9e3e9ebe9e,0,0x3f73bf733f73bf73,0xbf3500003f35bf80,0xbe9e3f64bf733ee8,0xbf353f80bf350000,0x3f73bee8be9e3f64,0xbf8000003f80,0xbf4f3f163f4fbf16,0xbf8000003f800000,0x3f163f4fbf16bf4f,0x3f350000bf35bf80,0xbf80bf3500003f35,0xbf35bf80bf350000,0x3f353f803f35
.quad 0x3f4f3f4f3f4f3f4f,0xbe9ebe9ebe9ebe9e,0xbf16bf16bf16bf16,0xbf73bf73bf73bf73,0xbf7fbf263da13f43,0xbe6fbf5abf79bf06,0xbda1bf43bf7fbf26,0x3f793f06be6fbf5a,0x3f35bf35bf353f35,0x3f353f35bf35bf35,0x3f353f35bf35bf35,0xbf353f353f35bf35,0xbda13f43bf7f3f26,0xbf793f063e6fbf5a,0xbf7f3f263da1bf43,0x3e6fbf5a3f79bf06
.quad 0xbf163f16bf163f16,0x3f73bf733f73bf73,0x3f4fbf4f3f4fbf4f,0x3e9ebe9e3e9ebe9e,0x3f79bf5a3e6f3f06,0xbf26bda13f43bf7f,0xbe6fbf063f79bf5a,0xbf433f7fbf26bda1,0xbf64bee83f643ee8,0x3e203f7dbe20bf7d,0xbee83f643ee8bf64,0x3f7dbe20bf7d3e20,0x3ec43f6d3f6d3ec4,0x3ec4bec4bf6dbf6d,0x3f6d3ec4bec4bf6d,0xbf6dbf6dbec43ec4
.quad 0x3f4f3f4f3f4f3f4f,0xbe9ebe9ebe9ebe9e,0xbf16bf16bf16bf16,0xbf73bf73bf73bf73,0x3f7f3f26bda1bf43,0x3e6f3f5a3f793f06,0x3da13f433f7f3f26,0xbf79bf063e6f3f5a,0x3f35bf35bf353f35,0x3f353f35bf35bf35,0x3f353f35bf35bf35,0xbf353f353f35bf35,0x3da1bf433f7fbf26,0x3f79bf06be6f3f5a,0x3f7fbf26bda13f43,0xbe6f3f5abf793f06
.quad 0xbf163f16bf163f16,0x3f73bf733f73bf73,0x3f4fbf4f3f4fbf4f,0x3e9ebe9e3e9ebe9e,0xbf793f5abe6fbf06,0x3f263da1bf433f7f,0x3e6f3f06bf793f5a,0x3f43bf7f3f263da1,0xbf64bee83f643ee8,0x3e203f7dbe20bf7d,0xbee83f643ee8bf64,0x3f7dbe20bf7d3e20,0xbec4bf6dbf6dbec4,0xbec43ec43f6d3f6d,0xbf6dbec43ec43f6d,0x3f6d3f6d3ec4bec4
.quad 0xbf4fbf4fbf4fbf4f,0xbf4fbf4fbf4fbf4f,0xbf16bf16bf16bf16,0x3f163f163f163f16,0x3ee8be9ebf64bf73,0x3f733f643e9ebee8,0x3f643f733ee8be9e,0xbe9e3ee83f733f64,0x3f800000bf80,0xbf8000003f800000,0xbf8000003f800000,0xbf8000003f80,0xbee8be9e3f64bf73,0x3f73bf643e9e3ee8,0x3f64bf733ee83e9e,0x3e9e3ee8bf733f64
.quad 0x3f4fbf4f3f4fbf4f,0xbf4f3f4fbf4f3f4f,0xbf163f16bf163f16,0xbf163f16bf163f16,0xbf7d3f4fbe20bf16,0x3f163e20bf4f3f7d,0x3e203f16bf7d3f4f,0x3f4fbf7d3f163e20,0x3f733e9ebf73be9e,0xbe9ebf733e9e3f73,0x3e9ebf73be9e3f73,0xbf733e9e3f73be9e,0xbf35bf80bf350000,0x3f353f803f35,0xbf3500003f353f80,0x3f803f350000bf35
.quad 0xbf4fbf4fbf4fbf4f,0xbf4fbf4fbf4fbf4f,0xbf16bf16bf16bf16,0x3f163f163f163f16,0xbee83e9e3f643f73,0xbf73bf64be9e3ee8,0xbf64bf73bee83e9e,0x3e9ebee8bf73bf64,0x3f800000bf80,0xbf8000003f800000,0xbf8000003f800000,0xbf8000003f80,0x3ee83e9ebf643f73,0xbf733f64be9ebee8,0xbf643f73bee8be9e,0xbe9ebee83f73bf64
.quad 0x3f4fbf4f3f4fbf4f,0xbf4f3f4fbf4f3f4f,0xbf163f16bf163f16,0xbf163f16bf163f16,0x3f7dbf4f3e203f16,0xbf16be203f4fbf7d,0xbe20bf163f7dbf4f,0xbf4f3f7dbf16be20,0x3f733e9ebf73be9e,0xbe9ebf733e9e3f73,0x3e9ebf73be9e3f73,0xbf733e9e3f73be9e,0x3f353f803f350000,0xbf35bf80bf35,0x3f350000bf35bf80,0xbf80bf3500003f35
.quad 0xbf80bf80bf80bf80,0xbe9ebe9ebe9ebe9e,0,0x3f733f733f733f73,0x3f6d3ec4bec4bf6d,0x3f063f793f5a3e6f,0x3ec43f6d3f6d3ec4,0xbf5abe6f3f063f79,0xbf353f353f35bf35,0xbf35bf353f353f35,0xbf35bf353f353f35,0x3f35bf35bf353f35,0x3ec4bf6d3f6dbec4,0x3f5abe6fbf063f79,0x3f6dbec4bec43f6d,0xbf063f79bf5a3e6f
.quad 0,0xbf733f73bf733f73,0xbf803f80bf803f80,0x3e9ebe9e3e9ebe9e,0xbec43f6dbf6d3ec4,0x3f7fbf433da13f26,0x3f6dbec4bec43f6d,0xbda1bf263f7fbf43,0x3f35bf35bf353f35,0xbf7dbe203f7d3e20,0xbf35bf353f353f35,0xbe203f7d3e20bf7d,0xbf6dbec43ec43f6d,0x3f6d3f6d3ec4bec4,0x3ec43f6d3f6d3ec4,0x3ec4bec4bf6dbf6d
.quad 0xbf80bf80bf80bf80,0xbe9ebe9ebe9ebe9e,0,0x3f733f733f733f73,0xbf6dbec43ec43f6d,0xbf06bf79bf5abe6f,0xbec4bf6dbf6dbec4,0x3f5a3e6fbf06bf79,0xbf353f353f35bf35,0xbf35bf353f353f35,0xbf35bf353f353f35,0x3f35bf35bf353f35,0xbec43f6dbf6d3ec4,0xbf5a3e6f3f06bf79,0xbf6d3ec43ec4bf6d,0x3f06bf793f5abe6f
.quad 0,0xbf733f73bf733f73,0xbf803f80bf803f80,0x3e9ebe9e3e9ebe9e,0x3ec4bf6d3f6dbec4,0xbf7f3f43bda1bf26,0xbf6d3ec43ec4bf6d,0x3da13f26bf7f3f43,0x3f35bf35bf353f35,0xbf7dbe203f7d3e20,0xbf35bf353f353f35,0xbe203f7d3e20bf7d,0x3f6d3ec4bec4bf6d,0xbf6dbf6dbec43ec4,0xbec4bf6dbf6dbec4,0xbec43ec43f6d3f6d
.quad 0x3e9e3e9e3e9e3e9e,0,0x3f733f733f733f73,0,0xbe203f163f7d3f4f,0x8000800000000000,0xbf7dbf4fbe203f16,0x800080008000,0xbf8000003f80,0x80000000,0x3f800000bf800000,0x8000,0x3e203f16bf7d3f4f,0x8000000000008000,0xbf7d3f4fbe20bf16,0x800000008000
.quad 0xbe9e3e9ebe9e3e9e,0x800000008000,0x3f73bf733f73bf73,0,0x3ee8bf733f64be9e,0x8000000000008000,0xbf643e9e3ee8bf73,0x80000000,0xbf163f4f3f16bf4f,0x80000000,0x3f4f3f16bf4fbf16,0x800000000000,0x3f350000bf35bf80,0x8000800000000000,0xbf35bf80bf350000,0
.quad 0x3e9e3e9e3e9e3e9e,0,0x3f733f733f733f73,0,0x3e20bf16bf7dbf4f,0x8000,0x3f7d3f4f3e20bf16,0,0xbf8000003f80,0x80000000,0x3f800000bf800000,0x8000,0xbe20bf163f7dbf4f,0x800000000000,0x3f7dbf4f3e203f16,0x80000000
.quad 0xbe9e3e9ebe9e3e9e,0x800000008000,0x3f73bf733f73bf73,0,0xbee83f73bf643e9e,0x800000000000,0x3f64be9ebee83f73,0x800000008000,0xbf163f4f3f16bf4f,0x80000000,0x3f4f3f16bf4fbf16,0x800000000000,0xbf3500003f353f80,0x8000,0x3f353f803f350000,0x800080008000
.quad 0x3f4f3f4f3f4f3f4f,0,0x3f163f163f163f16,0x8000800080008000,0xbf43bda13f263f7f,0x8000800080000000,0xbf26bf7fbf43bda1,0x800080008000,0x3f35bf35bf353f35,0x80008000,0x3f353f35bf35bf35,0x8000000000008000,0xbf263f7fbf433da1,0x8000800000008000,0xbf433da13f26bf7f,0x800000000000
.quad 0x3f16bf163f16bf16,0x800000008000,0x3f4fbf4f3f4fbf4f,0x8000000080000000,0xbf06be6f3f5abf79,0x8000000080000000,0xbf5a3f79bf06be6f,0x800080000000,0x3ee83f64bee8bf64,0x800080000000,0x3f64bee8bf643ee8,0x8000800000000000,0xbec4bf6dbf6dbec4,0x8000000000000000,0xbf6dbec43ec43f6d,0x8000
.quad 0x3f4f3f4f3f4f3f4f,0,0x3f163f163f163f16,0x8000800080008000,0x3f433da1bf26bf7f,0x8000,0x3f263f7f3f433da1,0x8000000000000000,0x3f35bf35bf353f35,0x80008000,0x3f353f35bf35bf35,0x8000000000008000,0x3f26bf7f3f43bda1,0x80000000,0x3f43bda1bf263f7f,0x8000000080008000
.quad 0x3f16bf163f16bf16,0x800000008000,0x3f4fbf4f3f4fbf4f,0x8000000080000000,0x3f063e6fbf5a3f79,0x800000008000,0x3f5abf793f063e6f,0x8000000000008000,0x3ee83f64bee8bf64,0x800080000000,0x3f64bee8bf643ee8,0x8000800000000000,0x3ec43f6d3f6d3ec4,0x800080008000,0x3f6d3ec4bec4bf6d,0x8000800080000000
.quad 0x3f803f803f803f80,0xbf4fbf4fbf4fbf4f,0,0xbf16bf16bf16bf16,0xbf3500003f353f80,0x3e9ebee8bf73bf64,0xbf35bf80bf350000,0x3f733f643e9ebee8,0xbf8000003f80,0x3e9e3f73be9ebf73,0x3f800000bf800000,0xbf733e9e3f73be9e,0x3f350000bf353f80,0xbf4f3e203f16bf7d,0xbf353f80bf350000,0x3f16bf7d3f4fbe20
.quad 0xbf803f80bf803f80,0x3f80bf803f80bf80,0,0,0x3f350000bf353f80,0xbf4f3e203f16bf7d,0x3f35bf803f350000,0xbf163f7dbf4f3e20,0xbf8000003f80,0x3e9e3f73be9ebf73,0xbf8000003f800000,0x3f73be9ebf733e9e,0xbf3500003f353f80,0x3e9ebee8bf73bf64,0x3f353f803f350000,0xbf73bf64be9e3ee8
.quad 0x3f803f803f803f80,0xbf4fbf4fbf4fbf4f,0,0xbf16bf16bf16bf16,0x3f350000bf35bf80,0xbe9e3ee83f733f64,0x3f353f803f350000,0xbf73bf64be9e3ee8,0xbf8000003f80,0x3e9e3f73be9ebf73,0x3f800000bf800000,0xbf733e9e3f73be9e,0xbf3500003f35bf80,0x3f4fbe20bf163f7d,0x3f35bf803f350000,0xbf163f7dbf4f3e20
.quad 0xbf803f80bf803f80,0x3f80bf803f80bf80,0,0,0xbf3500003f35bf80,0x3f4fbe20bf163f7d,0xbf353f80bf350000,0x3f16bf7d3f4fbe20,0xbf8000003f80,0x3e9e3f73be9ebf73,0xbf8000003f800000,0x3f73be9ebf733e9e,0x3f350000bf35bf80,0xbe9e3ee83f733f64,0xbf35bf80bf350000,0x3f733f643e9ebee8
.quad 0x3e9e3e9e3e9e3e9e,0xbf4fbf4fbf4fbf4f,0xbf73bf73bf73bf73,0x3f163f163f163f16,0xbf5abf79bf063e6f,0x3f7f3f433da1bf26,0x3f06be6fbf5abf79,0xbda13f263f7f3f43,0x3f7dbe20bf7d3e20,0xbf643ee83f64bee8,0x3e203f7dbe20bf7d,0xbee8bf643ee83f64,0xbf263f7fbf433da1,0x3f06bf793f5abe6f,0xbf433da13f26bf7f,0x3f5abe6fbf063f79
.quad 0,0,0x3f80bf803f80bf80,0xbf803f80bf803f80,0x3f26bf7f3f43bda1,0xbf063f79bf5a3e6f,0xbf433da13f26bf7f,0x3f5abe6fbf063f79,0xbf7d3e203f7dbe20,0x3f64bee8bf643ee8,0x3e203f7dbe20bf7d,0xbee8bf643ee83f64,0x3f5a3f793f06be6f,0xbf7fbf43bda13f26,0x3f06be6fbf5abf79,0xbda13f263f7f3f43
.quad 0x3e9e3e9e3e9e3e9e,0xbf4fbf4fbf4fbf4f,0xbf73bf73bf73bf73,0x3f163f163f163f16,0x3f5a3f793f06be6f,0xbf7fbf43bda13f26,0xbf063e6f3f5a3f79,0x3da1bf26bf7fbf43,0x3f7dbe20bf7d3e20,0xbf643ee83f64bee8,0x3e203f7dbe20bf7d,0xbee8bf643ee83f64,0x3f26bf7f3f43bda1,0xbf063f79bf5a3e6f,0x3f43bda1bf263f7f,0xbf5a3e6f3f06bf79
.quad 0,0,0x3f80bf803f80bf80,0xbf803f80bf803f80,0xbf263f7fbf433da1,0x3f06bf793f5abe6f,0x3f43bda1bf263f7f,0xbf5a3e6f3f06bf79,0xbf7d3e203f7dbe20,0x3f64bee8bf643ee8,0x3e203f7dbe20bf7d,0xbee8bf643ee83f64,0xbf5abf79bf063e6f,0x3f7f3f433da1bf26,0xbf063e6f3f5a3f79,0x3da1bf26bf7fbf43
.quad 0x3e9e3e9e3e9e3e9e,0x3e9e3e9e3e9e3e9e,0x3f733f733f733f73,0xbf73bf73bf73bf73,0x3e203f4f3f7d3f16,0xbf16bf7dbf4fbe20,0xbf7dbf163e203f4f,0x3f4f3e20bf16bf7d,0xbf16bf4f3f163f4f,0x3f4f3f16bf4fbf16,0x3f4fbf16bf4f3f16,0xbf163f4f3f16bf4f,0x3f64be9ebee83f73,0xbf733ee83e9ebf64,0xbee83f73bf643e9e,0x3e9ebf643f73bee8
.quad 0xbf803f80bf803f80,0x3f80bf803f80bf80,0,0,0x3f64be9ebee83f73,0xbf733ee83e9ebf64,0x3ee8bf733f64be9e,0xbe9e3f64bf733ee8,0xbf16bf4f3f163f4f,0x3f4f3f16bf4fbf16,0xbf4f3f163f4fbf16,0x3f16bf4fbf163f4f,0x3e203f4f3f7d3f16,0xbf16bf7dbf4fbe20,0x3f7d3f16be20bf4f,0xbf4fbe203f163f7d
.quad 0x3e9e3e9e3e9e3e9e,0x3e9e3e9e3e9e3e9e,0x3f733f733f733f73,0xbf73bf73bf73bf73,0xbe20bf4fbf7dbf16,0x3f163f7d3f4f3e20,0x3f7d3f16be20bf4f,0xbf4fbe203f163f7d,0xbf16bf4f3f163f4f,0x3f4f3f16bf4fbf16,0x3f4fbf16bf4f3f16,0xbf163f4f3f16bf4f,0xbf643e9e3ee8bf73,0x3f73bee8be9e3f64,0x3ee8bf733f64be9e,0xbe9e3f64bf733ee8
.quad 0xbf803f80bf803f80,0x3f80bf803f80bf80,0,0,0xbf643e9e3ee8bf73,0x3f73bee8be9e3f64,0xbee83f73bf643e9e,0x3e9ebf643f73bee8,0xbf16bf4f3f163f4f,0x3f4f3f16bf4fbf16,0xbf4f3f163f4fbf16,0x3f16bf4fbf163f4f,0xbe20bf4fbf7dbf16,0x3f163f7d3f4f3e20,0xbf7dbf163e203f4f,0x3f4f3e20bf16bf7d
.quad 0x3f803f803f803f80,0xbf4fbf4fbf4fbf4f,0,0xbf16bf16bf16bf16,0xbf6dbec43ec43f6d,0x3f26bda1bf43bf7f,0xbec4bf6dbf6dbec4,0x3f433f7f3f26bda1,0x3f35bf35bf353f35,0xbee83f643ee8bf64,0x3f353f35bf35bf35,0xbf64bee83f643ee8,0xbec43f6dbf6d3ec4,0x3e6fbf5a3f79bf06,0xbf6d3ec43ec4bf6d,0x3f79bf06be6f3f5a
.quad 0,0,0x3f80bf803f80bf80,0xbf803f80bf803f80,0x3ec4bf6d3f6dbec4,0xbe6f3f5abf793f06,0xbf6d3ec43ec4bf6d,0x3f79bf06be6f3f5a,0xbf353f353f35bf35,0x3ee8bf64bee83f64,0x3f353f35bf35bf35,0xbf64bee83f643ee8,0x3f6d3ec4bec4bf6d,0xbf263da13f433f7f,0xbec4bf6dbf6dbec4,0x3f433f7f3f26bda1
.quad 0x3f803f803f803f80,0xbf4fbf4fbf4fbf4f,0,0xbf16bf16bf16bf16,0x3f6d3ec4bec4bf6d,0xbf263da13f433f7f,0x3ec43f6d3f6d3ec4,0xbf43bf7fbf263da1,0x3f35bf35bf353f35,0xbee83f643ee8bf64,0x3f353f35bf35bf35,0xbf64bee83f643ee8,0x3ec4bf6d3f6dbec4,0xbe6f3f5abf793f06,0x3f6dbec4bec43f6d,0xbf793f063e6fbf5a
.quad 0,0,0x3f80bf803f80bf80,0xbf803f80bf803f80,0xbec43f6dbf6d3ec4,0x3e6fbf5a3f79bf06,0x3f6dbec4bec43f6d,0xbf793f063e6fbf5a,0xbf353f353f35bf35,0x3ee8bf64bee83f64,0x3f353f35bf35bf35,0xbf64bee83f643ee8,0xbf6dbec43ec43f6d,0x3f26bda1bf43bf7f,0x3ec43f6d3f6d3ec4,0xbf43bf7fbf263da1
.quad 0xbf4fbf4fbf4fbf4f,0,0x3f163f163f163f16,0,0x3f643f733ee8be9e,0x8000800000000000,0xbee83e9e3f643f73,0x800080008000,0xbf73be9e3f733e9e,0x80000000,0x3e9ebf73be9e3f73,0x8000,0x3f7dbf16be203f4f,0x8000000000008000,0xbe203f4fbf7d3f16,0x800000008000
.quad 0xbf803f80bf803f80,0x800000008000,0,0,0x3f7dbf16be203f4f,0x8000000000008000,0x3e20bf4f3f7dbf16,0x80000000,0xbf73be9e3f733e9e,0x80000000,0xbe9e3f733e9ebf73,0x800000000000,0x3f643f733ee8be9e,0x8000800000000000,0x3ee8be9ebf64bf73,0
.quad 0xbf4fbf4fbf4fbf4f,0,0x3f163f163f163f16,0,0xbf64bf73bee83e9e,0x8000,0x3ee8be9ebf64bf73,0,0xbf73be9e3f733e9e,0x80000000,0x3e9ebf73be9e3f73,0x8000,0xbf7d3f163e20bf4f,0x800000000000,0x3e20bf4f3f7dbf16,0x80000000
.quad 0xbf803f80bf803f80,0x800000008000,0,0,0xbf7d3f163e20bf4f,0x800000000000,0xbe203f4fbf7d3f16,0x800000008000,0xbf73be9e3f733e9e,0x80000000,0xbe9e3f733e9ebf73,0x800000000000,0xbf64bf73bee83e9e,0x8000,0xbee83e9e3f643f73,0x800080008000
.quad 0x3e9e3e9e3e9e3e9e,0,0x3f733f733f733f73,0x8000800080008000,0xbe6f3f063f793f5a,0x8000800080008000,0xbf79bf5abe6f3f06,0x80008000,0x3e20bf7dbe203f7d,0x80008000,0x3f7d3e20bf7dbe20,0x8000000000008000,0xbda13f43bf7f3f26,0x8000800000008000,0xbf7f3f263da1bf43,0x800000000000
.quad 0,0,0x3f80bf803f80bf80,0x8000000080000000,0x3da1bf433f7fbf26,0x80000000,0xbf7f3f263da1bf43,0x800000000000,0xbe203f7d3e20bf7d,0x8000800000000000,0x3f7d3e20bf7dbe20,0x8000000000008000,0x3e6fbf06bf79bf5a,0,0xbf79bf5abe6f3f06,0x80008000
.quad 0x3e9e3e9e3e9e3e9e,0,0x3f733f733f733f73,0x8000800080008000,0x3e6fbf06bf79bf5a,0,0x3f793f5a3e6fbf06,0x8000800000000000,0x3e20bf7dbe203f7d,0x80008000,0x3f7d3e20bf7dbe20,0x8000000000008000,0x3da1bf433f7fbf26,0x80000000,0x3f7fbf26bda13f43,0x8000000080008000
.quad 0,0,0x3f80bf803f80bf80,0x8000000080000000,0xbda13f43bf7f3f26,0x8000800000008000,0x3f7fbf26bda13f43,0x8000000080008000,0xbe203f7d3e20bf7d,0x8000800000000000,0x3f7d3e20bf7dbe20,0x8000000000008000,0xbe6f3f063f793f5a,0x8000800080008000,0x3f793f5a3e6fbf06,0x8000800000000000
.quad 0x3f803f803f803f80,0xbf4fbf4fbf4fbf4f,0,0x3f163f163f163f16,0xbf3500003f353f80,0x3f803f350000bf35,0xbf35bf80bf350000,0x3f353f803f35,0xbf8000003f80,0xbf4f3f163f4fbf16,0x3f800000bf800000,0xbf16bf4f3f163f4f,0x3f350000bf353f80,0x3e9ebf643f73bee8,0xbf353f80bf350000,0x3f73bee8be9e3f64
.quad 0xbf803f80bf803f80,0x3e9ebe9e3e9ebe9e,0,0xbf733f73bf733f73,0x3f350000bf353f80,0xbf4f3f7dbf16be20,0x3f35bf803f350000,0x3f163e20bf4f3f7d,0xbf8000003f80,0x3f800000bf800000,0xbf8000003f800000,0xbf8000003f80,0xbf3500003f353f80,0xbf4fbf7dbf163e20,0x3f353f803f350000,0xbf163e203f4f3f7d
.quad 0x3f803f803f803f80,0xbf4fbf4fbf4fbf4f,0,0x3f163f163f163f16,0x3f350000bf35bf80,0xbf80bf3500003f35,0x3f353f803f350000,0xbf35bf80bf35,0xbf8000003f80,0xbf4f3f163f4fbf16,0x3f800000bf800000,0xbf16bf4f3f163f4f,0xbf3500003f35bf80,0xbe9e3f64bf733ee8,0x3f35bf803f350000,0xbf733ee83e9ebf64
.quad 0xbf803f80bf803f80,0x3e9ebe9e3e9ebe9e,0,0xbf733f73bf733f73,0xbf3500003f35bf80,0x3f4fbf7d3f163e20,0xbf353f80bf350000,0xbf16be203f4fbf7d,0xbf8000003f80,0x3f800000bf800000,0xbf8000003f800000,0xbf8000003f80,0x3f350000bf35bf80,0x3f4f3f7d3f16be20,0xbf35bf80bf350000,0x3f16be20bf4fbf7d
.quad 0xbe9ebe9ebe9ebe9e,0x3f4f3f4f3f4f3f4f,0xbf73bf73bf73bf73,0x3f163f163f163f16,0xbec4bf6dbf6dbec4,0xbec43ec43f6d3f6d,0x3f6d3ec4bec4bf6d,0xbf6dbf6dbec43ec4,0x3f643ee8bf64bee8,0xbe20bf7d3e203f7d,0xbee83f643ee8bf64,0x3f7dbe20bf7d3e20,0xbf793f5abe6fbf06,0x3f263da1bf433f7f,0xbe6fbf063f79bf5a,0xbf433f7fbf26bda1
.quad 0x3f16bf163f16bf16,0xbf733f73bf733f73,0x3f4fbf4f3f4fbf4f,0x3e9ebe9e3e9ebe9e,0x3da1bf433f7fbf26,0x3f79bf06be6f3f5a,0xbf7f3f263da1bf43,0x3e6fbf5a3f79bf06,0xbf353f353f35bf35,0xbf35bf353f353f35,0x3f353f35bf35bf35,0xbf353f353f35bf35,0x3f7f3f26bda1bf43,0x3e6f3f5a3f793f06,0xbda1bf43bf7fbf26,0x3f793f06be6fbf5a
.quad 0xbe9ebe9ebe9ebe9e,0x3f4f3f4f3f4f3f4f,0xbf73bf73bf73bf73,0x3f163f163f163f16,0x3ec43f6d3f6d3ec4,0x3ec4bec4bf6dbf6d,0xbf6dbec43ec43f6d,0x3f6d3f6d3ec4bec4,0x3f643ee8bf64bee8,0xbe20bf7d3e203f7d,0xbee83f643ee8bf64,0x3f7dbe20bf7d3e20,0x3f79bf5a3e6f3f06,0xbf26bda13f43bf7f,0x3e6f3f06bf793f5a,0x3f43bf7f3f263da1
.quad 0x3f16bf163f16bf16,0xbf733f73bf733f73,0x3f4fbf4f3f4fbf4f,0x3e9ebe9e3e9ebe9e,0xbda13f43bf7f3f26,0xbf793f063e6fbf5a,0x3f7fbf26bda13f43,0xbe6f3f5abf793f06,0xbf353f353f35bf35,0xbf35bf353f353f35,0x3f353f35bf35bf35,0xbf353f353f35bf35,0xbf7fbf263da13f43,0xbe6fbf5abf79bf06,0x3da13f433f7f3f26,0xbf79bf063e6f3f5a
.quad 0x3e9e3e9e3e9e3e9e,0x3e9e3e9e3e9e3e9e,0xbf73bf73bf73bf73,0x3f733f733f733f73,0xbf35bf80bf350000,0x3f353f803f35,0x3f350000bf35bf80,0xbf80bf3500003f35,0x3f733e9ebf73be9e,0xbe9ebf733e9e3f73,0xbe9e3f733e9ebf73,0x3f73be9ebf733e9e,0xbf7d3f4fbe20bf16,0x3f163e20bf4f3f7d,0xbe20bf163f7dbf4f,0xbf4f3f7dbf16be20
.quad 0x3f4fbf4f3f4fbf4f,0xbf4f3f4fbf4f3f4f,0x3f16bf163f16bf16,0x3f16bf163f16bf16,0xbee8be9e3f64bf73,0x3f73bf643e9e3ee8,0xbf643f73bee8be9e,0xbe9ebee83f73bf64,0x3f800000bf80,0xbf8000003f800000,0x3f800000bf800000,0x3f800000bf80,0x3ee8be9ebf64bf73,0x3f733f643e9ebee8,0xbf64bf73bee83e9e,0x3e9ebee8bf73bf64
.quad 0x3e9e3e9e3e9e3e9e,0x3e9e3e9e3e9e3e9e,0xbf73bf73bf73bf73,0x3f733f733f733f73,0x3f353f803f350000,0xbf35bf80bf35,0xbf3500003f353f80,0x3f803f350000bf35,0x3f733e9ebf73be9e,0xbe9ebf733e9e3f73,0xbe9e3f733e9ebf73,0x3f73be9ebf733e9e,0x3f7dbf4f3e203f16,0xbf16be203f4fbf7d,0x3e203f16bf7d3f4f,0x3f4fbf7d3f163e20
.quad 0x3f4fbf4f3f4fbf4f,0xbf4f3f4fbf4f3f4f,0x3f16bf163f16bf16,0x3f16bf163f16bf16,0x3ee83e9ebf643f73,0xbf733f64be9ebee8,0x3f64bf733ee83e9e,0x3e9e3ee8bf733f64,0x3f800000bf80,0xbf8000003f800000,0x3f800000bf800000,0x3f800000bf80,0xbee83e9e3f643f73,0xbf73bf64be9e3ee8,0x3f643f733ee8be9e,0xbe9e3ee83f733f64
.quad 0xbf80bf80bf80bf80,0x3f4f3f4f3f4f3f4f,0,0xbf16bf16bf16bf16,0x3f6d3ec4bec4bf6d,0xbf6dbf6dbec43ec4,0x3ec43f6d3f6d3ec4,0x3ec4bec4bf6dbf6d,0xbf353f353f35bf35,0x3f7d3e20bf7dbe20,0xbf35bf353f353f35,0xbe203f7d3e20bf7d,0x3ec4bf6d3f6dbec4,0xbf7f3f43bda1bf26,0x3f6dbec4bec43f6d,0xbda1bf263f7fbf43
.quad 0,0x3f73bf733f73bf73,0xbf803f80bf803f80,0x3e9ebe9e3e9ebe9e,0xbec43f6dbf6d3ec4,0xbf5a3e6f3f06bf79,0x3f6dbec4bec43f6d,0xbf063f79bf5a3e6f,0x3f35bf35bf353f35,0x3f353f35bf35bf35,0xbf35bf353f353f35,0x3f35bf35bf353f35,0xbf6dbec43ec43f6d,0xbf06bf79bf5abe6f,0x3ec43f6d3f6d3ec4,0xbf5abe6f3f063f79
.quad 0xbf80bf80bf80bf80,0x3f4f3f4f3f4f3f4f,0,0xbf16bf16bf16bf16,0xbf6dbec43ec43f6d,0x3f6d3f6d3ec4bec4,0xbec4bf6dbf6dbec4,0xbec43ec43f6d3f6d,0xbf353f353f35bf35,0x3f7d3e20bf7dbe20,0xbf35bf353f353f35,0xbe203f7d3e20bf7d,0xbec43f6dbf6d3ec4,0x3f7fbf433da13f26,0xbf6d3ec43ec4bf6d,0x3da13f26bf7f3f43
.quad 0,0x3f73bf733f73bf73,0xbf803f80bf803f80,0x3e9ebe9e3e9ebe9e,0x3ec4bf6d3f6dbec4,0x3f5abe6fbf063f79,0xbf6d3ec43ec4bf6d,0x3f06bf793f5abe6f,0x3f35bf35bf353f35,0x3f353f35bf35bf35,0xbf35bf353f353f35,0x3f35bf35bf353f35,0x3f6d3ec4bec4bf6d,0x3f063f793f5a3e6f,0xbec4bf6dbf6dbec4,0x3f5a3e6fbf06bf79
.quad 0xbf4fbf4fbf4fbf4f,0,0xbf16bf16bf16bf16,0,0x3f350000bf35bf80,0x8000800000000000,0x3f353f803f350000,0x800080008000,0xbf163f4f3f16bf4f,0x80000000,0xbf4fbf163f4f3f16,0x8000,0x3ee8bf733f64be9e,0x8000000000008000,0x3f64be9ebee83f73,0x800000008000
.quad 0xbe9e3e9ebe9e3e9e,0x800000008000,0xbf733f73bf733f73,0,0x3e203f16bf7d3f4f,0x8000000000008000,0x3f7dbf4f3e203f16,0x80000000,0xbf8000003f80,0x80000000,0xbf8000003f800000,0x800000000000,0xbe203f163f7d3f4f,0x8000800000000000,0x3f7d3f4f3e20bf16,0
.quad 0xbf4fbf4fbf4fbf4f,0,0xbf16bf16bf16bf16,0,0xbf3500003f353f80,0x8000,0xbf35bf80bf350000,0,0xbf163f4f3f16bf4f,0x80000000,0xbf4fbf163f4f3f16,0x8000,0xbee83f73bf643e9e,0x800000000000,0xbf643e9e3ee8bf73,0x80000000
.quad 0xbe9e3e9ebe9e3e9e,0x800000008000,0xbf733f73bf733f73,0,0xbe20bf163f7dbf4f,0x800000000000,0xbf7d3f4fbe20bf16,0x800000008000,0xbf8000003f80,0x80000000,0xbf8000003f800000,0x800000000000,0x3e20bf16bf7dbf4f,0x8000,0xbf7dbf4fbe203f16,0x800080008000
.quad 0xbe9ebe9ebe9ebe9e,0x8000800080008000,0x3f733f733f733f73,0x8000800080008000,0x3ec43f6d3f6d3ec4,0x800080008000,0xbf6dbec43ec43f6d,0x8000,0xbee8bf643ee83f64,0x8000000000008000,0x3f64bee8bf643ee8,0x8000800000000000,0x3f063e6fbf5a3f79,0x800000008000,0xbf5a3f79bf06be6f,0x800080000000
.quad 0xbf163f16bf163f16,0x8000000080000000,0x3f4fbf4f3f4fbf4f,0x8000000080000000,0x3f26bf7f3f43bda1,0x80000000,0xbf433da13f26bf7f,0x800000000000,0xbf353f353f35bf35,0x8000800000000000,0x3f353f35bf35bf35,0x8000000000008000,0x3f433da1bf26bf7f,0x8000,0xbf26bf7fbf43bda1,0x800080008000
.quad 0xbe9ebe9ebe9ebe9e,0x8000800080008000,0x3f733f733f733f73,0x8000800080008000,0xbec4bf6dbf6dbec4,0x8000000000000000,0x3f6d3ec4bec4bf6d,0x8000800080000000,0xbee8bf643ee83f64,0x8000000000008000,0x3f64bee8bf643ee8,0x8000800000000000,0xbf06be6f3f5abf79,0x8000000080000000,0x3f5abf793f063e6f,0x8000000000008000
.quad 0xbf163f16bf163f16,0x8000000080000000,0x3f4fbf4f3f4fbf4f,0x8000000080000000,0xbf263f7fbf433da1,0x8000800000008000,0x3f43bda1bf263f7f,0x8000000080008000,0xbf353f353f35bf35,0x8000800000000000,0x3f353f35bf35bf35,0x8000000000008000,0xbf43bda13f263f7f,0x8000800080000000,0x3f263f7f3f433da1,0x8000000000000000
.quad 0x3f803f803f803f80,0x3e9e3e9e3e9e3e9e,0,0x3f733f733f733f73,0xbf3500003f353f80,0x3e9e3f643f733ee8,0xbf35bf80bf350000,0xbf73bee83e9e3f64,0xbf8000003f80,0xbf4fbf163f4f3f16,0x3f800000bf800000,0x3f16bf4fbf163f4f,0x3f350000bf353f80,0x3f80bf3500003f35,0xbf353f80bf350000,0x3f35bf803f35
.quad 0xbf803f80bf803f80,0xbf4f3f4fbf4f3f4f,0,0xbf163f16bf163f16,0x3f350000bf353f80,0x3e9e3ee8bf733f64,0x3f35bf803f350000,0x3f73bf643e9e3ee8,0xbf8000003f80,0x3e9ebf73be9e3f73,0xbf8000003f800000,0xbf73be9e3f733e9e,0xbf3500003f353f80,0xbf4fbe203f163f7d,0x3f353f803f350000,0x3f163f7d3f4f3e20
.quad 0x3f803f803f803f80,0x3e9e3e9e3e9e3e9e,0,0x3f733f733f733f73,0x3f350000bf35bf80,0xbe9ebf64bf73bee8,0x3f353f803f350000,0x3f733ee8be9ebf64,0xbf8000003f80,0xbf4fbf163f4f3f16,0x3f800000bf800000,0x3f16bf4fbf163f4f,0xbf3500003f35bf80,0xbf803f350000bf35,0x3f35bf803f350000,0xbf353f80bf35
.quad 0xbf803f80bf803f80,0xbf4f3f4fbf4f3f4f,0,0xbf163f16bf163f16,0xbf3500003f35bf80,0xbe9ebee83f73bf64,0xbf353f80bf350000,0xbf733f64be9ebee8,0xbf8000003f80,0x3e9ebf73be9e3f73,0xbf8000003f800000,0xbf73be9e3f733e9e,0x3f350000bf35bf80,0x3f4f3e20bf16bf7d,0xbf35bf80bf350000,0xbf16bf7dbf4fbe20
.quad 0xbf4fbf4fbf4fbf4f,0x3e9e3e9e3e9e3e9e,0xbf16bf16bf16bf16,0xbf73bf73bf73bf73,0x3e6fbf06bf79bf5a,0xbf43bf7fbf263da1,0x3f793f5a3e6fbf06,0x3f26bda1bf43bf7f,0x3ee83f64bee8bf64,0x3f7d3e20bf7dbe20,0xbf643ee83f64bee8,0xbe203f7d3e20bf7d,0xbf6d3ec43ec4bf6d,0xbf6d3f6dbec4bec4,0x3ec4bf6d3f6dbec4,0xbec4bec43f6dbf6d
.quad 0x3f73bf733f73bf73,0x3f16bf163f16bf16,0x3e9ebe9e3e9ebe9e,0x3f4fbf4f3f4fbf4f,0xbf06be6f3f5abf79,0xbda1bf263f7fbf43,0xbf5a3f79bf06be6f,0xbf7f3f43bda1bf26,0xbe203f7d3e20bf7d,0xbee83f643ee8bf64,0x3f7d3e20bf7dbe20,0x3f643ee8bf64bee8,0x3f433da1bf26bf7f,0x3f5a3e6fbf06bf79,0xbf26bf7fbf43bda1,0xbf06bf79bf5abe6f
.quad 0xbf4fbf4fbf4fbf4f,0x3e9e3e9e3e9e3e9e,0xbf16bf16bf16bf16,0xbf73bf73bf73bf73,0xbe6f3f063f793f5a,0x3f433f7f3f26bda1,0xbf79bf5abe6f3f06,0xbf263da13f433f7f,0x3ee83f64bee8bf64,0x3f7d3e20bf7dbe20,0xbf643ee83f64bee8,0xbe203f7d3e20bf7d,0x3f6dbec4bec43f6d,0x3f6dbf6d3ec43ec4,0xbec43f6dbf6d3ec4,0x3ec43ec4bf6d3f6d
.quad 0x3f73bf733f73bf73,0x3f16bf163f16bf16,0x3e9ebe9e3e9ebe9e,0x3f4fbf4f3f4fbf4f,0x3f063e6fbf5a3f79,0x3da13f26bf7f3f43,0x3f5abf793f063e6f,0x3f7fbf433da13f26,0xbe203f7d3e20bf7d,0xbee83f643ee8bf64,0x3f7d3e20bf7dbe20,0x3f643ee8bf64bee8,0xbf43bda13f263f7f,0xbf5abe6f3f063f79,0x3f263f7f3f433da1,0x3f063f793f5a3e6f
.quad 0xbf4fbf4fbf4fbf4f,0xbf4fbf4fbf4fbf4f,0x3f163f163f163f16,0xbf16bf16bf16bf16,0x3f7d3f4f3e20bf16,0x3f16be20bf4fbf7d,0xbe203f163f7d3f4f,0x3f4f3f7d3f16be20,0xbf733e9e3f73be9e,0xbe9e3f733e9ebf73,0xbe9ebf733e9e3f73,0xbf73be9e3f733e9e,0x3f35bf803f350000,0xbf353f80bf35,0x3f350000bf353f80,0x3f80bf3500003f35
.quad 0xbe9e3e9ebe9e3e9e,0x3e9ebe9e3e9ebe9e,0xbf733f73bf733f73,0xbf733f73bf733f73,0xbe203f4fbf7d3f16,0xbf163f7dbf4f3e20,0x3f7dbf16be203f4f,0x3f4fbe20bf163f7d,0x3f16bf4fbf163f4f,0x3f4fbf16bf4f3f16,0xbf4fbf163f4f3f16,0xbf16bf4f3f163f4f,0xbf64be9e3ee83f73,0xbf73bee83e9e3f64,0x3ee83f733f643e9e,0x3e9e3f643f733ee8
.quad 0xbf4fbf4fbf4fbf4f,0xbf4fbf4fbf4fbf4f,0x3f163f163f163f16,0xbf16bf16bf16bf16,0xbf7dbf4fbe203f16,0xbf163e203f4f3f7d,0x3e20bf16bf7dbf4f,0xbf4fbf7dbf163e20,0xbf733e9e3f73be9e,0xbe9e3f733e9ebf73,0xbe9ebf733e9e3f73,0xbf73be9e3f733e9e,0xbf353f80bf350000,0x3f35bf803f35,0xbf3500003f35bf80,0xbf803f350000bf35
.quad 0xbe9e3e9ebe9e3e9e,0x3e9ebe9e3e9ebe9e,0xbf733f73bf733f73,0xbf733f73bf733f73,0x3e20bf4f3f7dbf16,0x3f16bf7d3f4fbe20,0xbf7d3f163e20bf4f,0xbf4f3e203f16bf7d,0x3f16bf4fbf163f4f,0x3f4fbf16bf4f3f16,0xbf4fbf163f4f3f16,0xbf16bf4f3f163f4f,0x3f643e9ebee8bf73,0x3f733ee8be9ebf64,0xbee8bf73bf64be9e,0xbe9ebf64bf73bee8
.quad 0x3f803f803f803f80,0x3e9e3e9e3e9e3e9e,0,0x3f733f733f733f73,0xbf6dbec43ec43f6d,0xbda13f263f7f3f43,0xbec4bf6dbf6dbec4,0xbf7fbf43bda13f26,0x3f35bf35bf353f35,0xbe20bf7d3e203f7d,0x3f353f35bf35bf35,0x3f7dbe20bf7d3e20,0xbec43f6dbf6d3ec4,0x3ec43ec4bf6d3f6d,0xbf6d3ec43ec4bf6d,0xbf6d3f6dbec4bec4
.quad 0,0xbf163f16bf163f16,0x3f80bf803f80bf80,0x3f4fbf4f3f4fbf4f,0x3ec4bf6d3f6dbec4,0x3f43bf7f3f263da1,0xbf6d3ec43ec4bf6d,0xbf26bda13f43bf7f,0xbf353f353f35bf35,0xbf643ee83f64bee8,0x3f353f35bf35bf35,0x3ee83f64bee8bf64,0x3f6d3ec4bec4bf6d,0x3f793f06be6fbf5a,0xbec4bf6dbf6dbec4,0xbe6fbf5abf79bf06
.quad 0x3f803f803f803f80,0x3e9e3e9e3e9e3e9e,0,0x3f733f733f733f73,0x3f6d3ec4bec4bf6d,0x3da1bf26bf7fbf43,0x3ec43f6d3f6d3ec4,0x3f7f3f433da1bf26,0x3f35bf35bf353f35,0xbe20bf7d3e203f7d,0x3f353f35bf35bf35,0x3f7dbe20bf7d3e20,0x3ec4bf6d3f6dbec4,0xbec4bec43f6dbf6d,0x3f6dbec4bec43f6d,0x3f6dbf6d3ec43ec4
.quad 0,0xbf163f16bf163f16,0x3f80bf803f80bf80,0x3f4fbf4f3f4fbf4f,0xbec43f6dbf6d3ec4,0xbf433f7fbf26bda1,0x3f6dbec4bec43f6d,0x3f263da1bf433f7f,0xbf353f353f35bf35,0xbf643ee83f64bee8,0x3f353f35bf35bf35,0x3ee83f64bee8bf64,0xbf6dbec43ec43f6d,0xbf79bf063e6f3f5a,0x3ec43f6d3f6d3ec4,0x3e6f3f5a3f793f06
.quad 0x3e9e3e9e3e9e3e9e,0,0xbf73bf73bf73bf73,0,0xbee8bf73bf64be9e,0x8000800000000000,0x3f643e9ebee8bf73,0x800080008000,0x3f163f4fbf16bf4f,0x80000000,0xbf4f3f163f4fbf16,0x8000,0xbf3500003f35bf80,0x8000000000008000,0x3f35bf803f350000,0x800000008000
.quad 0x3f4fbf4f3f4fbf4f,0x800000008000,0xbf163f16bf163f16,0,0xbf643f73bee8be9e,0x8000000000008000,0x3ee83e9ebf643f73,0x80000000,0x3f73be9ebf733e9e,0x80000000,0xbe9ebf733e9e3f73,0x800000000000,0xbf7dbf163e203f4f,0x8000800000000000,0x3e203f4f3f7d3f16,0
.quad 0x3e9e3e9e3e9e3e9e,0,0xbf73bf73bf73bf73,0,0x3ee83f733f643e9e,0x8000,0xbf64be9e3ee83f73,0,0x3f163f4fbf16bf4f,0x80000000,0xbf4f3f163f4fbf16,0x8000,0x3f350000bf353f80,0x800000000000,0xbf353f80bf350000,0x80000000
.quad 0x3f4fbf4f3f4fbf4f,0x800000008000,0xbf163f16bf163f16,0,0x3f64bf733ee83e9e,0x800000000000,0xbee8be9e3f64bf73,0x800000008000,0x3f73be9ebf733e9e,0x80000000,0xbe9ebf733e9e3f73,0x800000000000,0x3f7d3f16be20bf4f,0x8000,0xbe20bf4fbf7dbf16,0x800080008000
.quad 0xbf4fbf4fbf4fbf4f,0x8000800080008000,0x3f163f163f163f16,0x8000800080008000,0x3f5a3f793f06be6f,0x80008000,0xbf063e6f3f5a3f79,0,0xbf64bee83f643ee8,0x8000000000008000,0x3ee8bf64bee83f64,0x8000800000000000,0x3f6dbec4bec43f6d,0x800000000000,0xbec43f6dbf6d3ec4,0x80000000
.quad 0xbf733f73bf733f73,0x8000000080000000,0x3e9ebe9e3e9ebe9e,0x8000000080000000,0x3f79bf5a3e6f3f06,0x800080000000,0xbe6fbf063f79bf5a,0x800000008000,0xbf7d3e203f7dbe20,0x8000800000000000,0x3e203f7dbe20bf7d,0x8000000000008000,0x3f7f3f26bda1bf43,0x8000,0xbda1bf43bf7fbf26,0x800080008000
.quad 0xbf4fbf4fbf4fbf4f,0x8000800080008000,0x3f163f163f163f16,0x8000800080008000,0xbf5abf79bf063e6f,0x8000800000000000,0x3f06be6fbf5abf79,0x8000800080008000,0xbf64bee83f643ee8,0x8000000000008000,0x3ee8bf64bee83f64,0x8000800000000000,0xbf6d3ec43ec4bf6d,0x8000000080008000,0x3ec4bf6d3f6dbec4,0x8000800000008000
.quad 0xbf733f73bf733f73,0x8000000080000000,0x3e9ebe9e3e9ebe9e,0x8000000080000000,0xbf793f5abe6fbf06,0x8000000000008000,0x3e6f3f06bf793f5a,0x8000000080000000,0xbf7d3e203f7dbe20,0x8000800000000000,0x3e203f7dbe20bf7d,0x8000000000008000,0xbf7fbf263da13f43,0x8000800080000000,0x3da13f433f7f3f26,0x8000000000000000
.quad 0x3f803f803f803f80,0,0x3ec43f353f6d3f80,0x3f6d3f353ec40000,0xbf3500003f353f80,0x3f353f803f350000,0xbf6dbf353ec43f80,0xbec43f353f6d0000,0xbf8000003f80,0xbf8000003f800000,0x3f6dbf35bec43f80,0xbec4bf353f6d0000,0x3f350000bf353f80,0x3f35bf803f350000,0xbec43f35bf6d3f80,0x3f6dbf353ec40000
.quad 0xbf803f80bf803f80,0,0xbec43f35bf6d3f80,0xbf6d3f35bec40000,0x3f350000bf353f80,0xbf353f80bf350000,0x3f6dbf35bec43f80,0x3ec43f35bf6d0000,0xbf8000003f80,0x3f800000bf800000,0xbf6dbf353ec43f80,0x3ec4bf35bf6d0000,0xbf3500003f353f80,0xbf35bf80bf350000,0x3ec43f353f6d3f80,0xbf6dbf35bec40000
.quad 0x3f803f803f803f80,0,0xbf6dbf35bec40000,0x3ec43f353f6d3f80,0x3f350000bf35bf80,0xbf35bf80bf350000,0xbec43f353f6d0000,0x3f6d3f35bec4bf80,0xbf8000003f80,0xbf8000003f800000,0x3ec43f35bf6d0000,0x3f6dbf35bec43f80,0xbf3500003f35bf80,0xbf353f80bf350000,0x3f6dbf353ec40000,0x3ec4bf353f6dbf80
.quad 0xbf803f80bf803f80,0,0x3f6dbf353ec40000,0xbec43f35bf6d3f80,0xbf3500003f35bf80,0x3f35bf803f350000,0x3ec43f35bf6d0000,0xbf6d3f353ec4bf80,0xbf8000003f80,0x3f800000bf800000,0xbec43f353f6d0000,0xbf6dbf353ec43f80,0x3f350000bf35bf80,0x3f353f803f350000,0xbf6dbf35bec40000,0xbec4bf35bf6dbf80
.quad 0x3f803f803f803f80,0,0xbec4bf35bf6dbf80,0xbf6dbf35bec40000,0xbf3500003f353f80,0x3f353f803f350000,0x3f6d3f35bec4bf80,0x3ec4bf35bf6d0000,0xbf8000003f80,0xbf8000003f800000,0xbf6d3f353ec4bf80,0x3ec43f35bf6d0000,0x3f350000bf353f80,0x3f35bf803f350000,0x3ec4bf353f6dbf80,0xbf6d3f35bec40000
.quad 0xbf803f80bf803f80,0,0x3ec4bf353f6dbf80,0x3f6dbf353ec40000,0x3f350000bf353f80,0xbf353f80bf350000,0xbf6d3f353ec4bf80,0xbec4bf353f6d0000,0xbf8000003f80,0x3f800000bf800000,0x3f6d3f35bec4bf80,0xbec43f353f6d0000,0xbf3500003f353f80,0xbf35bf80bf350000,0xbec4bf35bf6dbf80,0x3f6d3f353ec40000
.quad 0x3f803f803f803f80,0,0x3f6d3f353ec40000,0xbec4bf35bf6dbf80,0x3f350000bf35bf80,0xbf35bf80bf350000,0x3ec4bf35bf6d0000,0xbf6dbf353ec43f80,0xbf8000003f80,0xbf8000003f800000,0xbec4bf353f6d0000,0xbf6d3f353ec4bf80,0xbf3500003f35bf80,0xbf353f80bf350000,0xbf6d3f35bec40000,0xbec43f35bf6d3f80
.quad 0xbf803f80bf803f80,0,0xbf6d3f35bec40000,0x3ec4bf353f6dbf80,0xbf3500003f35bf80,0x3f35bf803f350000,0xbec4bf353f6d0000,0x3f6dbf35bec43f80,0xbf8000003f80,0x3f800000bf800000,0x3ec4bf35bf6d0000,0x3f6d3f35bec4bf80,0x3f350000bf35bf80,0x3f353f803f350000,0x3f6d3f353ec40000,0x3ec43f353f6d3f80
.quad 0x8000800080008000,0x3f803f803f803f80,0xbf6dbf35bec48000,0x3ec43f353f6d3f80,0xbf35bf80bf358000,0xbf3500003f353f80,0x3ec4bf35bf6d8000,0xbf6dbf353ec43f80,0x3f808000bf808000,0xbf8000003f80,0x3ec43f35bf6d8000,0x3f6dbf35bec43f80,0xbf353f80bf358000,0x3f350000bf353f80,0xbf6d3f35bec48000,0xbec43f35bf6d3f80
.quad 0x8000800080008000,0xbf803f80bf803f80,0x3f6dbf353ec48000,0xbec43f35bf6d3f80,0x3f35bf803f358000,0x3f350000bf353f80,0xbec4bf353f6d8000,0x3f6dbf35bec43f80,0xbf8080003f808000,0xbf8000003f80,0xbec43f353f6d8000,0xbf6dbf353ec43f80,0x3f353f803f358000,0xbf3500003f353f80,0x3f6d3f353ec48000,0x3ec43f353f6d3f80
.quad 0x8000800080008000,0x3f803f803f803f80,0xbec4bf35bf6dbf80,0xbf6dbf35bec40000,0x3f353f803f358000,0x3f350000bf35bf80,0xbf6dbf353ec43f80,0xbec43f353f6d0000,0x3f808000bf808000,0xbf8000003f80,0xbf6d3f353ec4bf80,0x3ec43f35bf6d0000,0x3f35bf803f358000,0xbf3500003f35bf80,0xbec43f35bf6d3f80,0x3f6dbf353ec40000
.quad 0x8000800080008000,0xbf803f80bf803f80,0x3ec4bf353f6dbf80,0x3f6dbf353ec40000,0xbf353f80bf358000,0xbf3500003f35bf80,0x3f6dbf35bec43f80,0x3ec43f35bf6d0000,0xbf8080003f808000,0xbf8000003f80,0x3f6d3f35bec4bf80,0xbec43f353f6d0000,0xbf35bf80bf358000,0x3f350000bf35bf80,0x3ec43f353f6d3f80,0xbf6dbf35bec40000
.quad 0x8000800080008000,0x3f803f803f803f80,0x3f6d3f353ec48000,0xbec4bf35bf6dbf80,0xbf35bf80bf358000,0xbf3500003f353f80,0xbec43f353f6d8000,0x3f6d3f35bec4bf80,0x3f808000bf808000,0xbf8000003f80,0xbec4bf353f6d8000,0xbf6d3f353ec4bf80,0xbf353f80bf358000,0x3f350000bf353f80,0x3f6dbf353ec48000,0x3ec4bf353f6dbf80
.quad 0x8000800080008000,0xbf803f80bf803f80,0xbf6d3f35bec48000,0x3ec4bf353f6dbf80,0x3f35bf803f358000,0x3f350000bf353f80,0x3ec43f35bf6d8000,0xbf6d3f353ec4bf80,0xbf8080003f808000,0xbf8000003f80,0x3ec4bf35bf6d8000,0x3f6d3f35bec4bf80,0x3f353f803f358000,0xbf3500003f353f80,0xbf6dbf35bec48000,0xbec4bf35bf6dbf80
.quad 0x8000800080008000,0x3f803f803f803f80,0x3ec43f353f6d3f80,0x3f6d3f353ec40000,0x3f353f803f358000,0x3f350000bf35bf80,0x3f6d3f35bec4bf80,0x3ec4bf35bf6d0000,0x3f808000bf808000,0xbf8000003f80,0x3f6dbf35bec43f80,0xbec4bf353f6d0000,0x3f35bf803f358000,0xbf3500003f35bf80,0x3ec4bf353f6dbf80,0xbf6d3f35bec40000
.quad 0x8000800080008000,0xbf803f80bf803f80,0xbec43f35bf6d3f80,0xbf6d3f35bec40000,0xbf353f80bf358000,0xbf3500003f35bf80,0xbf6d3f353ec4bf80,0xbec4bf353f6d0000,0xbf8080003f808000,0xbf8000003f80,0xbf6dbf353ec43f80,0x3ec4bf35bf6d0000,0xbf35bf80bf358000,0x3f350000bf35bf80,0xbec4bf35bf6dbf80,0x3f6d3f353ec40000
.quad 0x3f8000003f80,0x3f8000003f80,0,0,0x3f353f3500003f80,0x3f35bf353f800000,0,0x800000000000,0x3f80000000003f80,0xbf8000000000bf80,0,0x8000000000008000,0x3f35bf3500003f80,0x3f353f35bf800000,0x800000000000,0x80000000
.quad 0xbf8000003f80,0xbf8000003f80,0x800000000000,0x800000000000,0xbf35bf3500003f80,0xbf353f353f800000,0x8000800000000000,0x8000000000000000,0xbf80000000003f80,0x3f8000000000bf80,0x8000000000000000,0x8000,0xbf353f3500003f80,0xbf35bf35bf800000,0x8000000000000000,0x8000800080000000
.quad 0x3f8000003f80,0x3f8000003f80,0,0,0xbf35bf350000bf80,0xbf353f35bf800000,0x8000800000008000,0x8000000080000000,0x3f80000000003f80,0xbf8000000000bf80,0,0x8000000000008000,0xbf353f350000bf80,0xbf35bf353f800000,0x8000000000008000,0x8000800000000000
.quad 0xbf8000003f80,0xbf8000003f80,0x800000000000,0x800000000000,0x3f353f350000bf80,0x3f35bf35bf800000,0x8000,0x800080000000,0xbf80000000003f80,0x3f8000000000bf80,0x8000000000000000,0x8000,0x3f35bf350000bf80,0x3f353f353f800000,0x800000008000,0
.quad 0,0,0x3f8000003f80,0x3f8000003f80,0,0x800000000000,0x3f353f3500003f80,0x3f35bf353f800000,0,0x8000000000008000,0x3f80000000003f80,0xbf8000000000bf80,0x800000000000,0x80000000,0x3f35bf3500003f80,0x3f353f35bf800000
.quad 0x800000000000,0x800000000000,0xbf8000003f80,0xbf8000003f80,0x8000800000000000,0x8000000000000000,0xbf35bf3500003f80,0xbf353f353f800000,0x8000000000000000,0x8000,0xbf80000000003f80,0x3f8000000000bf80,0x8000000000000000,0x8000800080000000,0xbf353f3500003f80,0xbf35bf35bf800000
.quad 0,0,0x3f8000003f80,0x3f8000003f80,0x8000800000008000,0x8000000080000000,0xbf35bf350000bf80,0xbf353f35bf800000,0,0x8000000000008000,0x3f80000000003f80,0xbf8000000000bf80,0x8000000000008000,0x8000800000000000,0xbf353f350000bf80,0xbf35bf353f800000
.quad 0x800000000000,0x800000000000,0xbf8000003f80,0xbf8000003f80,0x8000,0x800080000000,0x3f353f350000bf80,0x3f35bf35bf800000,0x8000000000000000,0x8000,0xbf80000000003f80,0x3f8000000000bf80,0x800000008000,0,0x3f35bf350000bf80,0x3f353f353f800000
.quad 0xbf353f3500003f80,0xbf35bf35bf800000,0x8000000000000000,0x8000800080000000,0xbf80000000003f80,0x3f8000000000bf80,0x8000000000000000,0x8000,0xbf35bf3500003f80,0xbf353f353f800000,0x8000800000000000,0x8000000000000000,0xbf8000003f80,0xbf8000003f80,0x800000000000,0x800000000000
.quad 0x3f35bf3500003f80,0x3f353f35bf800000,0x800000000000,0x80000000,0x3f80000000003f80,0xbf8000000000bf80,0,0x8000000000008000,0x3f353f3500003f80,0x3f35bf353f800000,0,0x800000000000,0x3f8000003f80,0x3f8000003f80,0,0
.quad 0x3f35bf350000bf80,0x3f353f353f800000,0x800000008000,0,0xbf80000000003f80,0x3f8000000000bf80,0x8000000000000000,0x8000,0x3f353f350000bf80,0x3f35bf35bf800000,0x8000,0x800080000000,0xbf8000003f80,0xbf8000003f80,0x800000000000,0x800000000000
.quad 0xbf353f350000bf80,0xbf35bf353f800000,0x8000000000008000,0x8000800000000000,0x3f80000000003f80,0xbf8000000000bf80,0,0x8000000000008000,0xbf35bf350000bf80,0xbf353f35bf800000,0x8000800000008000,0x8000000080000000,0x3f8000003f80,0x3f8000003f80,0,0
.quad 0x8000000000000000,0x8000800080000000,0xbf353f3500003f80,0xbf35bf35bf800000,0x8000000000000000,0x8000,0xbf80000000003f80,0x3f8000000000bf80,0x8000800000000000,0x8000000000000000,0xbf35bf3500003f80,0xbf353f353f800000,0x800000000000,0x800000000000,0xbf8000003f80,0xbf8000003f80
.quad 0x800000000000,0x80000000,0x3f35bf3500003f80,0x3f353f35bf800000,0,0x8000000000008000,0x3f80000000003f80,0xbf8000000000bf80,0,0x800000000000,0x3f353f3500003f80,0x3f35bf353f800000,0,0,0x3f8000003f80,0x3f8000003f80
.quad 0x800000008000,0,0x3f35bf350000bf80,0x3f353f353f800000,0x8000000000000000,0x8000,0xbf80000000003f80,0x3f8000000000bf80,0x8000,0x800080000000,0x3f353f350000bf80,0x3f35bf35bf800000,0x800000000000,0x800000000000,0xbf8000003f80,0xbf8000003f80
.quad 0x8000000000008000,0x8000800000000000,0xbf353f350000bf80,0xbf35bf353f800000,0,0x8000000000008000,0x3f80000000003f80,0xbf8000000000bf80,0x8000800000008000,0x8000000080000000,0xbf35bf350000bf80,0xbf353f35bf800000,0,0,0x3f8000003f80,0x3f8000003f80
.quad 0x3f8000003f80,0x3f8000003f80,0,0,0xbf353f3500003f80,0xbf35bf35bf800000,0x8000000000000000,0x8000800080000000,0xbf80000000003f80,0x3f8000000000bf80,0x8000000000000000,0x8000,0xbf35bf3500003f80,0xbf353f353f800000,0x8000800000000000,0x8000000000000000
.quad 0xbf8000003f80,0xbf8000003f80,0x800000000000,0x800000000000,0x3f35bf3500003f80,0x3f353f35bf800000,0x800000000000,0x80000000,0x3f80000000003f80,0xbf8000000000bf80,0,0x8000000000008000,0x3f353f3500003f80,0x3f35bf353f800000,0,0x800000000000
.quad 0x3f8000003f80,0x3f8000003f80,0,0,0x3f35bf350000bf80,0x3f353f353f800000,0x800000008000,0,0xbf80000000003f80,0x3f8000000000bf80,0x8000000000000000,0x8000,0x3f353f350000bf80,0x3f35bf35bf800000,0x8000,0x800080000000
.quad 0xbf8000003f80,0xbf8000003f80,0x800000000000,0x800000000000,0xbf353f350000bf80,0xbf35bf353f800000,0x8000000000008000,0x8000800000000000,0x3f80000000003f80,0xbf8000000000bf80,0,0x8000000000008000,0xbf35bf350000bf80,0xbf353f35bf800000,0x8000800000008000,0x8000000080000000
.quad 0x8000000000000000,0x8000800080000000,0xbf353f3500003f80,0xbf35bf35bf800000,0x8000000000000000,0x8000,0xbf80000000003f80,0x3f8000000000bf80,0x8000800000000000,0x8000000000000000,0xbf35bf3500003f80,0xbf353f353f800000,0x800000000000,0x800000000000,0xbf8000003f80,0xbf8000003f80
.quad 0x800000000000,0x80000000,0x3f35bf3500003f80,0x3f353f35bf800000,0,0x8000000000008000,0x3f80000000003f80,0xbf8000000000bf80,0,0x800000000000,0x3f353f3500003f80,0x3f35bf353f800000,0,0,0x3f8000003f80,0x3f8000003f80
.quad 0x800000008000,0,0x3f35bf350000bf80,0x3f353f353f800000,0x8000000000000000,0x8000,0xbf80000000003f80,0x3f8000000000bf80,0x8000,0x800080000000,0x3f353f350000bf80,0x3f35bf35bf800000,0x800000000000,0x800000000000,0xbf8000003f80,0xbf8000003f80
.quad 0x8000000000008000,0x8000800000000000,0xbf353f350000bf80,0xbf35bf353f800000,0,0x8000000000008000,0x3f80000000003f80,0xbf8000000000bf80,0x8000800000008000,0x8000000080000000,0xbf35bf350000bf80,0xbf353f35bf800000,0,0,0x3f8000003f80,0x3f8000003f80
.quad 0,0,0x3f3500003f80,0xbf3500000000,0x3f80,0xbf80,0xbf3500003f80,0x3f3500000000,0xbf8000003f80,0xbf8000003f80,0x8000bf3500003f80,0x3f3500000000,0x3f80,0xbf80,0x3f3500003f80,0x8000bf3500000000
.quad 0,0,0,0x800000000000,0,0x8000,0x800000000000,0,0x800000000000,0x800000000000,0x8000800000000000,0,0,0x8000,0,0x8000800000000000
.quad 0,0,0x8000bf350000bf80,0x3f3500000000,0x3f80,0xbf80,0x3f350000bf80,0x8000bf3500000000,0xbf8000003f80,0xbf8000003f80,0x3f350000bf80,0xbf3500000000,0x3f80,0xbf80,0xbf350000bf80,0x3f3500000000
.quad 0,0,0x8000800000008000,0,0,0x8000,0x8000,0x8000800000000000,0x800000000000,0x800000000000,0x8000,0x800000000000,0,0x8000,0x800000008000,0
.quad 0,0,0,0x8000800000008000,0x800000000000,0x80008000,0x800000000000,0x800000000000,0x8000800000000000,0x8000800000000000,0x8000800000000000,0x8000,0,0x800080008000,0,0
.quad 0x3f6d00003f800000,0x3ec400003f350000,0x3ec400003f800000,0xbf6d8000bf358000,0xbec480003f800000,0x3f6d0000bf358000,0xbf6d80003f800000,0xbec480003f350000,0xbf6d80003f800000,0xbec480003f350000,0xbec480003f800000,0x3f6d0000bf358000,0x3ec400003f800000,0xbf6d8000bf358000,0x3f6d00003f800000,0x3ec400003f350000
.quad 0x800000000000,0x800000008000,0,0x800000000000,0x8000800000000000,0,0,0x80008000,0,0x8000,0x800000000000,0,0,0x8000800000000000,0x8000800000000000,0x8000800080008000
.quad 0xbec4800000000000,0xbf6d8000bf358000,0x3f6d000000000000,0xbec480003f350000,0xbf6d800000000000,0x3ec400003f350000,0x3ec4000000000000,0x3f6d0000bf358000,0x3ec4000000000000,0x3f6d0000bf358000,0xbf6d800000000000,0x3ec400003f350000,0x3f6d000000000000,0xbec480003f350000,0xbec4800000000000,0xbf6d8000bf358000
.quad 0x800000008000,0x800000008000,0xbf3500008000,0x8000bf350000bf80,0xbf8000008000,0x3f8080008000,0x8000bf3500008000,0xbf3500003f80,0x8000800000008000,0x8000800000008000,0x3f3500008000,0x3f350000bf80,0x3f8000008000,0xbf8080008000,0x3f3500008000,0x3f3500003f80
.quad 0x800000008000,0x800000008000,0x800000008000,0x8000800000008000,0x800000008000,0x80008000,0x8000800000008000,0x800000000000,0x8000800000008000,0x8000800000008000,0x8000,0x8000,0x8000,0x800080008000,0x8000,0
.quad 0x800000008000,0x800000008000,0x3f3580008000,0x3f3500003f80,0xbf8000008000,0x3f8080008000,0x3f3580008000,0x3f350000bf80,0x8000800000008000,0x8000800000008000,0xbf3580008000,0x8000bf3500003f80,0x3f8000008000,0xbf8080008000,0x8000bf3580008000,0xbf350000bf80
.quad 0x800000008000,0x800000008000,0x80008000,0,0x800000008000,0x80008000,0x80008000,0x8000,0x8000800000008000,0x8000800000008000,0x800080008000,0x8000800000000000,0x8000,0x800080008000,0x8000800080008000,0x800000008000
.quad 0x800000008000,0x800000008000,0x800000008000,0x80008000,0x8000800000008000,0,0x8000800000008000,0x8000800000000000,0x8000,0x8000,0x8000,0x800080008000,0x8000,0x8000800000000000,0x8000,0
.quad 0xbec4800000008000,0xbf6d8000bf358000,0xbf6d800000008000,0x3ec40000bf358000,0xbf6d800000008000,0x3ec400003f350000,0xbec4800000008000,0xbf6d80003f350000,0x3ec4000000008000,0x3f6d0000bf358000,0x3f6d000000008000,0xbec48000bf358000,0x3f6d000000008000,0xbec480003f350000,0x3ec4000000008000,0x3f6d00003f350000
.quad 0x8000800000008000,0x8000800080008000,0,0x8000800000008000,0x8000,0x800000000000,0x800000000000,0x800000000000,0x8000,0x80008000,0x8000800000000000,0x8000,0x800000008000,0,0,0
.quad 0xbf6d8000bf808000,0xbec48000bf358000,0x3ec400003f800000,0xbf6d8000bf358000,0x3ec40000bf808000,0xbf6d80003f350000,0xbf6d80003f800000,0xbec480003f350000,0x3f6d0000bf808000,0x3ec40000bf358000,0xbec480003f800000,0x3f6d0000bf358000,0xbec48000bf808000,0x3f6d00003f350000,0x3f6d00003f800000,0x3ec400003f350000
.quad 0x3c213f8000003f80,0x3cf13f803ca13f80,0x3f373f3300003f80,0x3f30bf3a3f80bca1,0x3f80bc2100003f80,0xbf803cf1bca1bf80,0x3f33bf3700003f80,0x3f3a3f30bf803ca1,0xbc21bf8000003f80,0xbcf1bf803ca13f80,0xbf37bf3300003f80,0xbf303f3a3f80bca1,0xbf803c2100003f80,0x3f80bcf1bca1bf80,0xbf333f3700003f80,0xbf3abf30bf803ca1
.quad 0,0,0,0x800000008000,0x800000000000,0x80008000,0x800000000000,0,0x8000800000000000,0x8000800000000000,0x8000800000000000,0x8000,0,0x800080008000,0,0x8000800000000000
.quad 0x3d493f803d213f80,0x3d8d3f7f3d713f80,0xbf3ebf2cbd21bf80,0xbf283f41bf803d71,0x3f80bd493d213f80,0xbf7f3d8dbd71bf80,0xbf2c3f3ebd21bf80,0xbf41bf283f80bd71,0xbd49bf803d213f80,0xbd8dbf7f3d713f80,0x3f3e3f2cbd21bf80,0x3f28bf41bf803d71,0xbf803d493d213f80,0x3f7fbd8dbd71bf80,0x3f2cbf3ebd21bf80,0x3f413f283f80bd71
.quad 0,0,0x8000800080008000,0,0x800000000000,0x80008000,0x80008000,0x8000800000008000,0x8000800000000000,0x8000800000000000,0x80008000,0x800000000000,0,0x800080008000,0x800080008000,0x8000
.quad 0,0x8000800000000000,0,0x800080008000,0x8000800000000000,0x8000,0x8000800000000000,0x8000800000000000,0x800000000000,0,0x800000000000,0x80008000,0,0x800000008000,0,0
.quad 0xbf333f3700003f80,0xbf3abf30bf803ca1,0xbf803c2100003f80,0x3f80bcf1bca1bf80,0xbf37bf3300003f80,0xbf303f3a3f80bca1,0xbc21bf8000003f80,0xbcf1bf803ca13f80,0x3f33bf3700003f80,0x3f3a3f30bf803ca1,0x3f80bc2100003f80,0xbf803cf1bca1bf80,0x3f373f3300003f80,0x3f30bf3a3f80bca1,0x3c213f8000003f80,0x3cf13f803ca13f80
.quad 0x800080008000,0x8000,0,0x800080008000,0x80008000,0x800000000000,0x8000800000000000,0x8000800000000000,0x80008000,0x8000800000008000,0x800000000000,0x80008000,0x8000800080008000,0,0,0
.quad 0x3f2cbf3ebd21bf80,0x3f413f283f80bd71,0xbf803d493d213f80,0x3f7fbd8dbd71bf80,0x3f3e3f2cbd21bf80,0x3f28bf41bf803d71,0xbd49bf803d213f80,0xbd8dbf7f3d713f80,0xbf2c3f3ebd21bf80,0xbf41bf283f80bd71,0x3f80bd493d213f80,0xbf7f3d8dbd71bf80,0xbf3ebf2cbd21bf80,0xbf283f41bf803d71,0x3d493f803d213f80,0x3d8d3f7f3d713f80
.quad 0x3f80bc213f808000,0x3f80bcf13f80bca1,0x3f33bf373f808000,0xbf3abf30bca1bf80,0xbc21bf803f808000,0x3cf13f80bf803ca1,0xbf37bf333f808000,0x3f30bf3a3ca13f80,0xbf803c213f808000,0xbf803cf13f80bca1,0xbf333f373f808000,0x3f3a3f30bca1bf80,0x3c213f803f808000,0xbcf1bf80bf803ca1,0x3f373f333f808000,0xbf303f3a3ca13f80
.quad 0x800000008000,0x800000008000,0x800000008000,0x8000800080008000,0x8000800000008000,0,0x8000800000008000,0x800000000000,0x8000,0x8000,0x8000,0x80008000,0x8000,0x8000800000000000,0x8000,0
.quad 0x3f80bd493f80bd21,0x3f7fbd8d3f80bd71,0xbf2c3f3ebf803d21,0x3f413f283d713f80,0xbd49bf803f80bd21,0x3d8d3f7fbf803d71,0x3f3e3f2cbf803d21,0xbf283f41bd71bf80,0xbf803d493f80bd21,0xbf7f3d8d3f80bd71,0x3f2cbf3ebf803d21,0xbf41bf283d713f80,0x3d493f803f80bd21,0xbd8dbf7fbf803d71,0xbf3ebf2cbf803d21,0x3f28bf41bd71bf80
.quad 0x800000008000,0x800000008000,0,0,0x8000800000008000,0,0,0x80008000,0x8000,0x8000,0x800000000000,0x8000800000000000,0x8000,0x8000800000000000,0x8000800000000000,0x800080008000
.quad 0x8000800080008000,0x800080008000,0x8000800080008000,0x8000,0x800080008000,0x8000800000000000,0x800080008000,0x800000000000,0x80008000,0x80008000,0x80008000,0x8000800000008000,0x80008000,0,0x80008000,0
.quad 0xbf37bf33bf808000,0x3f30bf3abca1bf80,0xbc21bf80bf808000,0x3cf13f803f80bca1,0x3f33bf37bf808000,0xbf3abf303ca13f80,0x3f80bc21bf808000,0x3f80bcf1bf803ca1,0x3f373f33bf808000,0xbf303f3abca1bf80,0x3c213f80bf808000,0xbcf1bf803f80bca1,0xbf333f37bf808000,0x3f3a3f303ca13f80,0xbf803c21bf808000,0xbf803cf1bf803ca1
.quad 0x8000,0,0x8000800000000000,0x8000,0x8000,0x80008000,0x800000000000,0x800000000000,0x8000800000008000,0x800000000000,0,0x8000800000008000,0x800000008000,0x8000800080008000,0,0
.quad 0x3f3e3f2c3f80bd21,0xbf283f413d713f80,0xbd49bf80bf803d21,0x3d8d3f7f3f80bd71,0xbf2c3f3e3f80bd21,0x3f413f28bd71bf80,0x3f80bd49bf803d21,0x3f7fbd8dbf803d71,0xbf3ebf2c3f80bd21,0x3f28bf413d713f80,0x3d493f80bf803d21,0xbd8dbf7f3f80bd71,0x3f2cbf3e3f80bd21,0xbf41bf28bd71bf80,0xbf803d49bf803d21,0xbf7f3d8dbf803d71
.quad 0x3ca13f8000003f80,0x3d713f803d213f80,0x3f393f3100003f80,0x3f2abf3f3f80bd21,0x3f80bca100003f80,0xbf803d71bd21bf80,0x3f31bf3900003f80,0x3f3f3f2abf803d21,0xbca1bf8000003f80,0xbd71bf803d213f80,0xbf39bf3100003f80,0xbf2a3f3f3f80bd21,0xbf803ca100003f80,0x3f80bd71bd21bf80,0xbf313f3900003f80,0xbf3fbf2abf803d21
.quad 0,0,0,0x800000008000,0x800000000000,0x80008000,0x800000000000,0,0x8000800000000000,0x8000800000000000,0x8000800000000000,0x8000,0,0x800080008000,0,0x8000800000000000
.quad 0x3dc93f7f3da13f7f,0x3e0c3f7e3df13f7e,0xbf46bf22bda1bf7f,0xbf1b3f4cbf7e3df1,0x3f7fbdc93da13f7f,0xbf7e3e0cbdf1bf7e,0xbf223f46bda1bf7f,0xbf4cbf1b3f7ebdf1,0xbdc9bf7f3da13f7f,0xbe0cbf7e3df13f7e,0x3f463f22bda1bf7f,0x3f1bbf4cbf7e3df1,0xbf7f3dc93da13f7f,0x3f7ebe0cbdf1bf7e,0x3f22bf46bda1bf7f,0x3f4c3f1b3f7ebdf1
.quad 0,0,0x8000800080008000,0,0x800000000000,0x80008000,0x80008000,0x8000800000008000,0x8000800000000000,0x8000800000000000,0x80008000,0x800000000000,0,0x800080008000,0x800080008000,0x8000
.quad 0,0,0,0x800000008000,0x800000000000,0x80008000,0x800000000000,0,0x8000800000000000,0x8000800000000000,0x8000800000000000,0x8000,0,0x800080008000,0,0x8000800000000000
.quad 0x3cf13f8000003f80,0x3db53f7f3d713f80,0x3f3a3f3000003f80,0x3f24bf443f80bd71,0x3f80bcf100003f80,0xbf7f3db5bd71bf80,0x3f30bf3a00003f80,0x3f443f24bf803d71,0xbcf1bf8000003f80,0xbdb5bf7f3d713f80,0xbf3abf3000003f80,0xbf243f443f80bd71,0xbf803cf100003f80,0x3f7fbdb5bd71bf80,0xbf303f3a00003f80,0xbf44bf24bf803d71
.quad 0,0,0x8000800080008000,0,0x800000000000,0x80008000,0x80008000,0x8000800000008000,0x8000800000000000,0x8000800000000000,0x80008000,0x800000000000,0,0x800080008000,0x800080008000,0x8000
.quad 0x3e163f7d3df13f7e,0x3e523f7b3e343f7c,0xbf4ebf18bdf1bf7e,0xbf0c3f56bf7c3e34,0x3f7dbe163df13f7e,0xbf7b3e52be34bf7c,0xbf183f4ebdf1bf7e,0xbf56bf0c3f7cbe34,0xbe16bf7d3df13f7e,0xbe52bf7b3e343f7c,0x3f4e3f18bdf1bf7e,0x3f0cbf56bf7c3e34,0xbf7d3e163df13f7e,0x3f7bbe52be34bf7c,0x3f18bf4ebdf1bf7e,0x3f563f0c3f7cbe34
.quad 0x3f80bca13f808000,0x3f80bd713f80bd21,0x3f31bf393f808000,0xbf3fbf2abd21bf80,0xbca1bf803f808000,0x3d713f80bf803d21,0xbf39bf313f808000,0x3f2abf3f3d213f80,0xbf803ca13f808000,0xbf803d713f80bd21,0xbf313f393f808000,0x3f3f3f2abd21bf80,0x3ca13f803f808000,0xbd71bf80bf803d21,0x3f393f313f808000,0xbf2a3f3f3d213f80
.quad 0x800000008000,0x800000008000,0x800000008000,0x8000800080008000,0x8000800000008000,0,0x8000800000008000,0x800000000000,0x8000,0x8000,0x8000,0x80008000,0x8000,0x8000800000000000,0x8000,0
.quad 0x3f7fbdc93f7fbda1,0x3f7ebe0c3f7ebdf1,0xbf223f46bf7f3da1,0x3f4c3f1b3df13f7e,0xbdc9bf7f3f7fbda1,0x3e0c3f7ebf7e3df1,0x3f463f22bf7f3da1,0xbf1b3f4cbdf1bf7e,0xbf7f3dc93f7fbda1,0xbf7e3e0c3f7ebdf1,0x3f22bf46bf7f3da1,0xbf4cbf1b3df13f7e,0x3dc93f7f3f7fbda1,0xbe0cbf7ebf7e3df1,0xbf46bf22bf7f3da1,0x3f1bbf4cbdf1bf7e
.quad 0x800000008000,0x800000008000,0,0,0x8000800000008000,0,0,0x80008000,0x8000,0x8000,0x800000000000,0x8000800000000000,0x8000,0x8000800000000000,0x8000800000000000,0x800080008000
.quad 0x800000008000,0x800000008000,0x800000008000,0x8000800080008000,0x8000800000008000,0,0x8000800000008000,0x800000000000,0x8000,0x8000,0x8000,0x80008000,0x8000,0x8000800000000000,0x8000,0
.quad 0x3f80bcf13f808000,0x3f7fbdb53f80bd71,0x3f30bf3a3f808000,0xbf44bf24bd71bf80,0xbcf1bf803f808000,0x3db53f7fbf803d71,0xbf3abf303f808000,0x3f24bf443d713f80,0xbf803cf13f808000,0xbf7f3db53f80bd71,0xbf303f3a3f808000,0x3f443f24bd71bf80,0x3cf13f803f808000,0xbdb5bf7fbf803d71,0x3f3a3f303f808000,0xbf243f443d713f80
.quad 0x800000008000,0x800000008000,0,0,0x8000800000008000,0,0,0x80008000,0x8000,0x8000,0x800000000000,0x8000800000000000,0x8000,0x8000800000000000,0x8000800000000000,0x800080008000
.quad 0x3f7dbe163f7ebdf1,0x3f7bbe523f7cbe34,0xbf183f4ebf7e3df1,0x3f563f0c3e343f7c,0xbe16bf7d3f7ebdf1,0x3e523f7bbf7c3e34,0x3f4e3f18bf7e3df1,0xbf0c3f56be34bf7c,0xbf7d3e163f7ebdf1,0xbf7b3e523f7cbe34,0x3f18bf4ebf7e3df1,0xbf56bf0c3e343f7c,0x3e163f7d3f7ebdf1,0xbe52bf7bbf7c3e34,0xbf4ebf18bf7e3df1,0x3f0cbf56be34bf7c
.quad 0x3d213f8000003f80,0x3df13f7e3da13f7f,0x3f3c3f2e00003f80,0x3f1ebf493f7fbda1,0x3f80bd2100003f80,0xbf7e3df1bda1bf7f,0x3f2ebf3c00003f80,0x3f493f1ebf7f3da1,0xbd21bf8000003f80,0xbdf1bf7e3da13f7f,0xbf3cbf2e00003f80,0xbf1e3f493f7fbda1,0xbf803d2100003f80,0x3f7ebdf1bda1bf7f,0xbf2e3f3c00003f80,0xbf49bf1ebf7f3da1
.quad 0,0,0,0x800000008000,0x800000000000,0x80008000,0x800000000000,0,0x8000800000000000,0x8000800000000000,0x8000800000000000,0x8000,0,0x800080008000,0,0x8000800000000000
.quad 0x3e483f7b3e203f7d,0x3e8b3f763e6f3f79,0xbf55bf0ebe20bf7d,0xbefa3f5fbf793e6f,0x3f7bbe483e203f7d,0xbf763e8bbe6fbf79,0xbf0e3f55be20bf7d,0xbf5fbefa3f79be6f,0xbe48bf7b3e203f7d,0xbe8bbf763e6f3f79,0x3f553f0ebe20bf7d,0x3efabf5fbf793e6f,0xbf7b3e483e203f7d,0x3f76be8bbe6fbf79,0x3f0ebf55be20bf7d,0x3f5f3efa3f79be6f
.quad 0,0,0x8000800080008000,0,0x800000000000,0x80008000,0x80008000,0x8000800000008000,0x8000800000000000,0x8000800000000000,0x80008000,0x800000000000,0,0x800080008000,0x800080008000,0x8000
.quad 0,0,0,0x800000008000,0x800000000000,0x80008000,0x800000000000,0,0x8000800000000000,0x8000800000000000,0x8000800000000000,0x8000,0,0x800080008000,0,0x8000800000000000
.quad 0x3d493f8000003f80,0x3e163f7d3dc93f7f,0x3f3e3f2c00003f80,0x3f18bf4e3f7fbdc9,0x3f80bd4900003f80,0xbf7d3e16bdc9bf7f,0x3f2cbf3e00003f80,0x3f4e3f18bf7f3dc9,0xbd49bf8000003f80,0xbe16bf7d3dc93f7f,0xbf3ebf2c00003f80,0xbf183f4e3f7fbdc9,0xbf803d4900003f80,0x3f7dbe16bdc9bf7f,0xbf2c3f3e00003f80,0xbf4ebf18bf7f3dc9
.quad 0,0,0x8000800080008000,0,0x800000000000,0x80008000,0x80008000,0x8000800000008000,0x8000800000000000,0x8000800000000000,0x80008000,0x800000000000,0,0x800080008000,0x800080008000,0x8000
.quad 0x3e793f783e483f7b,0x3eac3f713e953f75,0xbf5cbf04be48bf7b,0xbedb3f67bf753e95,0x3f78be793e483f7b,0xbf713eacbe95bf75,0xbf043f5cbe48bf7b,0xbf67bedb3f75be95,0xbe79bf783e483f7b,0xbeacbf713e953f75,0x3f5c3f04be48bf7b,0x3edbbf67bf753e95,0xbf783e793e483f7b,0x3f71beacbe95bf75,0x3f04bf5cbe48bf7b,0x3f673edb3f75be95
.quad 0x3f80bd213f808000,0x3f7ebdf13f7fbda1,0x3f2ebf3c3f808000,0xbf49bf1ebda1bf7f,0xbd21bf803f808000,0x3df13f7ebf7f3da1,0xbf3cbf2e3f808000,0x3f1ebf493da13f7f,0xbf803d213f808000,0xbf7e3df13f7fbda1,0xbf2e3f3c3f808000,0x3f493f1ebda1bf7f,0x3d213f803f808000,0xbdf1bf7ebf7f3da1,0x3f3c3f2e3f808000,0xbf1e3f493da13f7f
.quad 0x800000008000,0x800000008000,0x800000008000,0x8000800080008000,0x8000800000008000,0,0x8000800000008000,0x800000000000,0x8000,0x8000,0x8000,0x80008000,0x8000,0x8000800000000000,0x8000,0
.quad 0x3f7bbe483f7dbe20,0x3f76be8b3f79be6f,0xbf0e3f55bf7d3e20,0x3f5f3efa3e6f3f79,0xbe48bf7b3f7dbe20,0x3e8b3f76bf793e6f,0x3f553f0ebf7d3e20,0xbefa3f5fbe6fbf79,0xbf7b3e483f7dbe20,0xbf763e8b3f79be6f,0x3f0ebf55bf7d3e20,0xbf5fbefa3e6f3f79,0x3e483f7b3f7dbe20,0xbe8bbf76bf793e6f,0xbf55bf0ebf7d3e20,0x3efabf5fbe6fbf79
.quad 0x800000008000,0x800000008000,0,0,0x8000800000008000,0,0,0x80008000,0x8000,0x8000,0x800000000000,0x8000800000000000,0x8000,0x8000800000000000,0x8000800000000000,0x800080008000
.quad 0x800000008000,0x800000008000,0x800000008000,0x8000800080008000,0x8000800000008000,0,0x8000800000008000,0x800000000000,0x8000,0x8000,0x8000,0x80008000,0x8000,0x8000800000000000,0x8000,0
.quad 0x3f80bd493f808000,0x3f7dbe163f7fbdc9,0x3f2cbf3e3f808000,0xbf4ebf18bdc9bf7f,0xbd49bf803f808000,0x3e163f7dbf7f3dc9,0xbf3ebf2c3f808000,0x3f18bf4e3dc93f7f,0xbf803d493f808000,0xbf7d3e163f7fbdc9,0xbf2c3f3e3f808000,0x3f4e3f18bdc9bf7f,0x3d493f803f808000,0xbe16bf7dbf7f3dc9,0x3f3e3f2c3f808000,0xbf183f4e3dc93f7f
.quad 0x800000008000,0x800000008000,0,0,0x8000800000008000,0,0,0x80008000,0x8000,0x8000,0x800000000000,0x8000800000000000,0x8000,0x8000800000000000,0x8000800000000000,0x800080008000
.quad 0x3f78be793f7bbe48,0x3f71beac3f75be95,0xbf043f5cbf7b3e48,0x3f673edb3e953f75,0xbe79bf783f7bbe48,0x3eac3f71bf753e95,0x3f5c3f04bf7b3e48,0xbedb3f67be95bf75,0xbf783e793f7bbe48,0xbf713eac3f75be95,0x3f04bf5cbf7b3e48,0xbf67bedb3e953f75,0x3e793f783f7bbe48,0xbeacbf71bf753e95,0xbf5cbf04bf7b3e48,0x3edbbf67be95bf75
.quad 0x3d713f8000003f80,0x3e343f7c3df13f7e,0x3f3f3f2a00003f80,0x3f12bf523f7ebdf1,0x3f80bd7100003f80,0xbf7c3e34bdf1bf7e,0x3f2abf3f00003f80,0x3f523f12bf7e3df1,0xbd71bf8000003f80,0xbe34bf7c3df13f7e,0xbf3fbf2a00003f80,0xbf123f523f7ebdf1,0xbf803d7100003f80,0x3f7cbe34bdf1bf7e,0xbf2a3f3f00003f80,0xbf52bf12bf7e3df1
.quad 0,0,0,0x800000008000,0x800000000000,0x80008000,0x800000000000,0,0x8000800000000000,0x8000800000000000,0x8000800000000000,0x8000,0,0x800080008000,0,0x8000800000000000
.quad 0x3e953f753e6f3f79,0x3ecd3f6b3eb13f70,0xbf62bef1be6fbf79,0xbebb3f6ebf703eb1,0x3f75be953e6f3f79,0xbf6b3ecdbeb1bf70,0xbef13f62be6fbf79,0xbf6ebebb3f70beb1,0xbe95bf753e6f3f79,0xbecdbf6b3eb13f70,0x3f623ef1be6fbf79,0x3ebbbf6ebf703eb1,0xbf753e953e6f3f79,0x3f6bbecdbeb1bf70,0x3ef1bf62be6fbf79,0x3f6e3ebb3f70beb1
.quad 0,0,0x8000800080008000,0,0x800000000000,0x80008000,0x80008000,0x8000800000008000,0x8000800000000000,0x8000800000000000,0x80008000,0x800000000000,0,0x800080008000,0x800080008000,0x8000
.quad 0,0,0,0x800000008000,0x800000000000,0x80008000,0x800000000000,0,0x8000800000000000,0x8000800000000000,0x8000800000000000,0x8000,0,0x800080008000,0,0x8000800000000000
.quad 0x3d8d3f7f00003f80,0x3e523f7b3e0c3f7e,0x3f413f2800003f80,0x3f0cbf563f7ebe0c,0x3f7fbd8d00003f80,0xbf7b3e52be0cbf7e,0x3f28bf4100003f80,0x3f563f0cbf7e3e0c,0xbd8dbf7f00003f80,0xbe52bf7b3e0c3f7e,0xbf41bf2800003f80,0xbf0c3f563f7ebe0c,0xbf7f3d8d00003f80,0x3f7bbe52be0cbf7e,0xbf283f4100003f80,0xbf56bf0cbf7e3e0c
.quad 0,0,0x8000800080008000,0,0x800000000000,0x80008000,0x80008000,0x8000800000008000,0x8000800000000000,0x8000800000000000,0x80008000,0x800000000000,0,0x800080008000,0x800080008000,0x8000
.quad 0x3eac3f713e8b3f76,0x3eed3f633ecd3f6b,0xbf67bedbbe8bbf76,0xbe993f74bf6b3ecd,0x3f71beac3e8b3f76,0xbf633eedbecdbf6b,0xbedb3f67be8bbf76,0xbf74be993f6bbecd,0xbeacbf713e8b3f76,0xbeedbf633ecd3f6b,0x3f673edbbe8bbf76,0x3e99bf74bf6b3ecd,0xbf713eac3e8b3f76,0x3f63beedbecdbf6b,0x3edbbf67be8bbf76,0x3f743e993f6bbecd
.quad 0x3f80bd713f808000,0x3f7cbe343f7ebdf1,0x3f2abf3f3f808000,0xbf52bf12bdf1bf7e,0xbd71bf803f808000,0x3e343f7cbf7e3df1,0xbf3fbf2a3f808000,0x3f12bf523df13f7e,0xbf803d713f808000,0xbf7c3e343f7ebdf1,0xbf2a3f3f3f808000,0x3f523f12bdf1bf7e,0x3d713f803f808000,0xbe34bf7cbf7e3df1,0x3f3f3f2a3f808000,0xbf123f523df13f7e
.quad 0x800000008000,0x800000008000,0x800000008000,0x8000800080008000,0x8000800000008000,0,0x8000800000008000,0x800000000000,0x8000,0x8000,0x8000,0x80008000,0x8000,0x8000800000000000,0x8000,0
.quad 0x3f75be953f79be6f,0x3f6bbecd3f70beb1,0xbef13f62bf793e6f,0x3f6e3ebb3eb13f70,0xbe95bf753f79be6f,0x3ecd3f6bbf703eb1,0x3f623ef1bf793e6f,0xbebb3f6ebeb1bf70,0xbf753e953f79be6f,0xbf6b3ecd3f70beb1,0x3ef1bf62bf793e6f,0xbf6ebebb3eb13f70,0x3e953f753f79be6f,0xbecdbf6bbf703eb1,0xbf62bef1bf793e6f,0x3ebbbf6ebeb1bf70
.quad 0x800000008000,0x800000008000,0,0,0x8000800000008000,0,0,0x80008000,0x8000,0x8000,0x800000000000,0x8000800000000000,0x8000,0x8000800000000000,0x8000800000000000,0x800080008000
.quad 0x800000008000,0x800000008000,0x800000008000,0x8000800080008000,0x8000800000008000,0,0x8000800000008000,0x800000000000,0x8000,0x8000,0x8000,0x80008000,0x8000,0x8000800000000000,0x8000,0
.quad 0x3f7fbd8d3f808000,0x3f7bbe523f7ebe0c,0x3f28bf413f808000,0xbf56bf0cbe0cbf7e,0xbd8dbf7f3f808000,0x3e523f7bbf7e3e0c,0xbf41bf283f808000,0x3f0cbf563e0c3f7e,0xbf7f3d8d3f808000,0xbf7b3e523f7ebe0c,0xbf283f413f808000,0x3f563f0cbe0cbf7e,0x3d8d3f7f3f808000,0xbe52bf7bbf7e3e0c,0x3f413f283f808000,0xbf0c3f563e0c3f7e
.quad 0x800000008000,0x800000008000,0,0,0x8000800000008000,0,0,0x80008000,0x8000,0x8000,0x800000000000,0x8000800000000000,0x8000,0x8000800000000000,0x8000800000000000,0x800080008000
.quad 0x3f71beac3f76be8b,0x3f63beed3f6bbecd,0xbedb3f67bf763e8b,0x3f743e993ecd3f6b,0xbeacbf713f76be8b,0x3eed3f63bf6b3ecd,0x3f673edbbf763e8b,0xbe993f74becdbf6b,0xbf713eac3f76be8b,0xbf633eed3f6bbecd,0x3edbbf67bf763e8b,0xbf74be993ecd3f6b,0x3eac3f713f76be8b,0xbeedbf63bf6b3ecd,0xbf67bedbbf763e8b,0x3e99bf74becdbf6b
.quad 0x3da13f7f00003f80,0x3e6f3f793e203f7d,0x3f433f2600003f80,0x3f06bf5a3f7dbe20,0x3f7fbda100003f80,0xbf793e6fbe20bf7d,0x3f26bf4300003f80,0x3f5a3f06bf7d3e20,0xbda1bf7f00003f80,0xbe6fbf793e203f7d,0xbf43bf2600003f80,0xbf063f5a3f7dbe20,0xbf7f3da100003f80,0x3f79be6fbe20bf7d,0xbf263f4300003f80,0xbf5abf06bf7d3e20
.quad 0,0,0,0x800000008000,0x800000000000,0x80008000,0x800000000000,0,0x8000800000000000,0x8000800000000000,0x8000800000000000,0x8000,0,0x800080008000,0,0x8000800000000000
.quad 0x3ec43f6d3e9e3f73,0x3f063f5a3ee83f64,0xbf6dbec4be9ebf73,0xbe6f3f79bf643ee8,0x3f6dbec43e9e3f73,0xbf5a3f06bee8bf64,0xbec43f6dbe9ebf73,0xbf79be6f3f64bee8,0xbec4bf6d3e9e3f73,0xbf06bf5a3ee83f64,0x3f6d3ec4be9ebf73,0x3e6fbf79bf643ee8,0xbf6d3ec43e9e3f73,0x3f5abf06bee8bf64,0x3ec4bf6dbe9ebf73,0x3f793e6f3f64bee8
.quad 0,0,0x8000800080008000,0,0x800000000000,0x80008000,0x80008000,0x8000800000008000,0x8000800000000000,0x8000800000000000,0x80008000,0x800000000000,0,0x800080008000,0x800080008000,0x8000
.quad 0,0,0,0x800000008000,0x800000000000,0x80008000,0x800000000000,0,0x8000800000000000,0x8000800000000000,0x8000800000000000,0x8000,0,0x800080008000,0,0x8000800000000000
.quad 0x3db53f7f00003f80,0x3e863f773e343f7c,0x3f443f2400003f80,0x3effbf5e3f7cbe34,0x3f7fbdb500003f80,0xbf773e86be34bf7c,0x3f24bf4400003f80,0x3f5e3effbf7c3e34,0xbdb5bf7f00003f80,0xbe86bf773e343f7c,0xbf44bf2400003f80,0xbeff3f5e3f7cbe34,0xbf7f3db500003f80,0x3f77be86be34bf7c,0xbf243f4400003f80,0xbf5ebeffbf7c3e34
.quad 0,0,0x8000800080008000,0,0x800000000000,0x80008000,0x80008000,0x8000800000008000,0x8000800000000000,0x8000800000000000,0x80008000,0x800000000000,0,0x800080008000,0x800080008000,0x8000
.quad 0x3edb3f673eb13f70,0x3f143f513f013f5d,0xbf71beacbeb1bf70,0xbe2a3f7cbf5d3f01,0x3f67bedb3eb13f70,0xbf513f14bf01bf5d,0xbeac3f71beb1bf70,0xbf7cbe2a3f5dbf01,0xbedbbf673eb13f70,0xbf14bf513f013f5d,0x3f713eacbeb1bf70,0x3e2abf7cbf5d3f01,0xbf673edb3eb13f70,0x3f51bf14bf01bf5d,0x3eacbf71beb1bf70,0x3f7c3e2a3f5dbf01
.quad 0x3f7fbda13f808000,0x3f79be6f3f7dbe20,0x3f26bf433f808000,0xbf5abf06be20bf7d,0xbda1bf7f3f808000,0x3e6f3f79bf7d3e20,0xbf43bf263f808000,0x3f06bf5a3e203f7d,0xbf7f3da13f808000,0xbf793e6f3f7dbe20,0xbf263f433f808000,0x3f5a3f06be20bf7d,0x3da13f7f3f808000,0xbe6fbf79bf7d3e20,0x3f433f263f808000,0xbf063f5a3e203f7d
.quad 0x800000008000,0x800000008000,0x800000008000,0x8000800080008000,0x8000800000008000,0,0x8000800000008000,0x800000000000,0x8000,0x8000,0x8000,0x80008000,0x8000,0x8000800000000000,0x8000,0
.quad 0x3f6dbec43f73be9e,0x3f5abf063f64bee8,0xbec43f6dbf733e9e,0x3f793e6f3ee83f64,0xbec4bf6d3f73be9e,0x3f063f5abf643ee8,0x3f6d3ec4bf733e9e,0xbe6f3f79bee8bf64,0xbf6d3ec43f73be9e,0xbf5a3f063f64bee8,0x3ec4bf6dbf733e9e,0xbf79be6f3ee83f64,0x3ec43f6d3f73be9e,0xbf06bf5abf643ee8,0xbf6dbec4bf733e9e,0x3e6fbf79bee8bf64
.quad 0x800000008000,0x800000008000,0,0,0x8000800000008000,0,0,0x80008000,0x8000,0x8000,0x800000000000,0x8000800000000000,0x8000,0x8000800000000000,0x8000800000000000,0x800080008000
.quad 0x800000008000,0x800000008000,0x800000008000,0x8000800080008000,0x8000800000008000,0,0x8000800000008000,0x800000000000,0x8000,0x8000,0x8000,0x80008000,0x8000,0x8000800000000000,0x8000,0
.quad 0x3f7fbdb53f808000,0x3f77be863f7cbe34,0x3f24bf443f808000,0xbf5ebeffbe34bf7c,0xbdb5bf7f3f808000,0x3e863f77bf7c3e34,0xbf44bf243f808000,0x3effbf5e3e343f7c,0xbf7f3db53f808000,0xbf773e863f7cbe34,0xbf243f443f808000,0x3f5e3effbe34bf7c,0x3db53f7f3f808000,0xbe86bf77bf7c3e34,0x3f443f243f808000,0xbeff3f5e3e343f7c
.quad 0x800000008000,0x800000008000,0,0,0x8000800000008000,0,0,0x80008000,0x8000,0x8000,0x800000000000,0x8000800000000000,0x8000,0x8000800000000000,0x8000800000000000,0x800080008000
.quad 0x3f67bedb3f70beb1,0x3f51bf143f5dbf01,0xbeac3f71bf703eb1,0x3f7c3e2a3f013f5d,0xbedbbf673f70beb1,0x3f143f51bf5d3f01,0x3f713eacbf703eb1,0xbe2a3f7cbf01bf5d,0xbf673edb3f70beb1,0xbf513f143f5dbf01,0x3eacbf71bf703eb1,0xbf7cbe2a3f013f5d,0x3edb3f673f70beb1,0xbf14bf51bf5d3f01,0xbf71beacbf703eb1,0x3e2abf7cbf01bf5d
.quad 0x3dc93f7f00003f80,0x3e953f753e483f7b,0x3f463f2200003f80,0x3ef1bf623f7bbe48,0x3f7fbdc900003f80,0xbf753e95be48bf7b,0x3f22bf4600003f80,0x3f623ef1bf7b3e48,0xbdc9bf7f00003f80,0xbe95bf753e483f7b,0xbf46bf2200003f80,0xbef13f623f7bbe48,0xbf7f3dc900003f80,0x3f75be95be48bf7b,0xbf223f4600003f80,0xbf62bef1bf7b3e48
.quad 0,0,0,0x800000008000,0x800000000000,0x80008000,0x800000000000,0,0x8000800000000000,0x8000800000000000,0x8000800000000000,0x8000,0,0x800080008000,0,0x8000800000000000
.quad 0x3ef13f623ec43f6d,0x3f223f463f0e3f55,0xbf75be95bec4bf6d,0xbdc93f7fbf553f0e,0x3f62bef13ec43f6d,0xbf463f22bf0ebf55,0xbe953f75bec4bf6d,0xbf7fbdc93f55bf0e,0xbef1bf623ec43f6d,0xbf22bf463f0e3f55,0x3f753e95bec4bf6d,0x3dc9bf7fbf553f0e,0xbf623ef13ec43f6d,0x3f46bf22bf0ebf55,0x3e95bf75bec4bf6d,0x3f7f3dc93f55bf0e
.quad 0,0,0x8000800080008000,0,0x800000000000,0x80008000,0x80008000,0x8000800000008000,0x8000800000000000,0x8000800000000000,0x80008000,0x800000000000,0,0x800080008000,0x800080008000,0x8000
.quad 0,0,0,0x800000008000,0x800000000000,0x80008000,0x800000000000,0,0x8000800000000000,0x8000800000000000,0x8000800000000000,0x8000,0,0x800080008000,0,0x8000800000000000
.quad 0x3ddd3f7f00003f80,0x3ea33f733e5b3f7a,0x3f473f2000003f80,0x3ee4bf653f7abe5b,0x3f7fbddd00003f80,0xbf733ea3be5bbf7a,0x3f20bf4700003f80,0x3f653ee4bf7a3e5b,0xbdddbf7f00003f80,0xbea3bf733e5b3f7a,0xbf47bf2000003f80,0xbee43f653f7abe5b,0xbf7f3ddd00003f80,0x3f73bea3be5bbf7a,0xbf203f4700003f80,0xbf65bee4bf7a3e5b
.quad 0,0,0x8000800080008000,0,0x800000000000,0x80008000,0x80008000,0x8000800000008000,0x8000800000000000,0x8000800000000000,0x80008000,0x800000000000,0,0x800080008000,0x800080008000,0x8000
.quad 0x3f043f5c3ed63f68,0x3f303f3a3f1b3f4c,0xbf78be79bed6bf68,0xbcf13f80bf4c3f1b,0x3f5cbf043ed63f68,0xbf3a3f30bf1bbf4c,0xbe793f78bed6bf68,0xbf80bcf13f4cbf1b,0xbf04bf5c3ed63f68,0xbf30bf3a3f1b3f4c,0x3f783e79bed6bf68,0x3cf1bf80bf4c3f1b,0xbf5c3f043ed63f68,0x3f3abf30bf1bbf4c,0x3e79bf78bed6bf68,0x3f803cf13f4cbf1b
.quad 0x3f7fbdc93f808000,0x3f75be953f7bbe48,0x3f22bf463f808000,0xbf62bef1be48bf7b,0xbdc9bf7f3f808000,0x3e953f75bf7b3e48,0xbf46bf223f808000,0x3ef1bf623e483f7b,0xbf7f3dc93f808000,0xbf753e953f7bbe48,0xbf223f463f808000,0x3f623ef1be48bf7b,0x3dc93f7f3f808000,0xbe95bf75bf7b3e48,0x3f463f223f808000,0xbef13f623e483f7b
.quad 0x800000008000,0x800000008000,0x800000008000,0x8000800080008000,0x8000800000008000,0,0x8000800000008000,0x800000000000,0x8000,0x8000,0x8000,0x80008000,0x8000,0x8000800000000000,0x8000,0
.quad 0x3f62bef13f6dbec4,0x3f46bf223f55bf0e,0xbe953f75bf6d3ec4,0x3f7f3dc93f0e3f55,0xbef1bf623f6dbec4,0x3f223f46bf553f0e,0x3f753e95bf6d3ec4,0xbdc93f7fbf0ebf55,0xbf623ef13f6dbec4,0xbf463f223f55bf0e,0x3e95bf75bf6d3ec4,0xbf7fbdc93f0e3f55,0x3ef13f623f6dbec4,0xbf22bf46bf553f0e,0xbf75be95bf6d3ec4,0x3dc9bf7fbf0ebf55
.quad 0x800000008000,0x800000008000,0,0,0x8000800000008000,0,0,0x80008000,0x8000,0x8000,0x800000000000,0x8000800000000000,0x8000,0x8000800000000000,0x8000800000000000,0x800080008000
.quad 0x800000008000,0x800000008000,0x800000008000,0x8000800080008000,0x8000800000008000,0,0x8000800000008000,0x800000000000,0x8000,0x8000,0x8000,0x80008000,0x8000,0x8000800000000000,0x8000,0
.quad 0x3f7fbddd3f808000,0x3f73bea33f7abe5b,0x3f20bf473f808000,0xbf65bee4be5bbf7a,0xbdddbf7f3f808000,0x3ea33f73bf7a3e5b,0xbf47bf203f808000,0x3ee4bf653e5b3f7a,0xbf7f3ddd3f808000,0xbf733ea33f7abe5b,0xbf203f473f808000,0x3f653ee4be5bbf7a,0x3ddd3f7f3f808000,0xbea3bf73bf7a3e5b,0x3f473f203f808000,0xbee43f653e5b3f7a
.quad 0x800000008000,0x800000008000,0,0,0x8000800000008000,0,0,0x80008000,0x8000,0x8000,0x800000000000,0x8000800000000000,0x8000,0x8000800000000000,0x8000800000000000,0x800080008000
.quad 0x3f5cbf043f68bed6,0x3f3abf303f4cbf1b,0xbe793f78bf683ed6,0x3f803cf13f1b3f4c,0xbf04bf5c3f68bed6,0x3f303f3abf4c3f1b,0x3f783e79bf683ed6,0xbcf13f80bf1bbf4c,0xbf5c3f043f68bed6,0xbf3a3f303f4cbf1b,0x3e79bf78bf683ed6,0xbf80bcf13f1b3f4c,0x3f043f5c3f68bed6,0xbf30bf3abf4c3f1b,0xbf78be79bf683ed6,0x3cf1bf80bf1bbf4c
.quad 0x3df13f7e00003f80,0x3eb13f703e6f3f79,0x3f493f1e00003f80,0x3ed6bf683f79be6f,0x3f7ebdf100003f80,0xbf703eb1be6fbf79,0x3f1ebf4900003f80,0x3f683ed6bf793e6f,0xbdf1bf7e00003f80,0xbeb1bf703e6f3f79,0xbf49bf1e00003f80,0xbed63f683f79be6f,0xbf7e3df100003f80,0x3f70beb1be6fbf79,0xbf1e3f4900003f80,0xbf68bed6bf793e6f
.quad 0,0,0,0x800000008000,0x800000000000,0x80008000,0x800000000000,0,0x8000800000000000,0x8000800000000000,0x8000800000000000,0x8000,0,0x800080008000,0,0x8000800000000000
.quad 0x3f0e3f553ee83f64,0x3f3c3f2e3f263f43,0xbf7bbe48bee8bf64,0x3d213f80bf433f26,0x3f55bf0e3ee83f64,0xbf2e3f3cbf26bf43,0xbe483f7bbee8bf64,0xbf803d213f43bf26,0xbf0ebf553ee83f64,0xbf3cbf2e3f263f43,0x3f7b3e48bee8bf64,0xbd21bf80bf433f26,0xbf553f0e3ee83f64,0x3f2ebf3cbf26bf43,0x3e48bf7bbee8bf64,0x3f80bd213f43bf26
.quad 0,0,0x8000800080008000,0,0x800000000000,0x80008000,0x80008000,0x8000,0x8000800000000000,0x8000800000000000,0x80008000,0x8000800000000000,0,0x800080008000,0x800080008000,0x800000008000
.quad 0,0,0,0x800000008000,0x800000000000,0x80008000,0x800000000000,0,0x8000800000000000,0x8000800000000000,0x8000800000000000,0x8000,0,0x800080008000,0,0x8000800000000000
.quad 0x3e023f7e00003f80,0x3ebf3f6d3e813f78,0x3f4b3f1d00003f80,0x3ec9bf6c3f78be81,0x3f7ebe0200003f80,0xbf6d3ebfbe81bf78,0x3f1dbf4b00003f80,0x3f6c3ec9bf783e81,0xbe02bf7e00003f80,0xbebfbf6d3e813f78,0xbf4bbf1d00003f80,0xbec93f6c3f78be81,0xbf7e3e0200003f80,0x3f6dbebfbe81bf78,0xbf1d3f4b00003f80,0xbf6cbec9bf783e81
.quad 0,0,0x8000800080008000,0,0x800000000000,0x80008000,0x80008000,0x8000,0x8000800000000000,0x8000800000000000,0x80008000,0x8000800000000000,0,0x800080008000,0x800080008000,0x800000008000
.quad 0x3f183f4e3efa3f5f,0x3f473f203f313f39,0xbf7dbe16befabf5f,0x3ddd3f7fbf393f31,0x3f4ebf183efa3f5f,0xbf203f47bf31bf39,0xbe163f7dbefabf5f,0xbf7f3ddd3f39bf31,0xbf18bf4e3efa3f5f,0xbf47bf203f313f39,0x3f7d3e16befabf5f,0xbdddbf7fbf393f31,0xbf4e3f183efa3f5f,0x3f20bf47bf31bf39,0x3e16bf7dbefabf5f,0x3f7fbddd3f39bf31
.quad 0x3f7ebdf13f808000,0x3f70beb13f79be6f,0x3f1ebf493f808000,0xbf68bed6be6fbf79,0xbdf1bf7e3f808000,0x3eb13f70bf793e6f,0xbf49bf1e3f808000,0x3ed6bf683e6f3f79,0xbf7e3df13f808000,0xbf703eb13f79be6f,0xbf1e3f493f808000,0x3f683ed6be6fbf79,0x3df13f7e3f808000,0xbeb1bf70bf793e6f,0x3f493f1e3f808000,0xbed63f683e6f3f79
.quad 0x800000008000,0x800000008000,0x800000008000,0x8000800080008000,0x8000800000008000,0,0x8000800000008000,0x800000000000,0x8000,0x8000,0x8000,0x80008000,0x8000,0x8000800000000000,0x8000,0
.quad 0x3f55bf0e3f64bee8,0x3f2ebf3c3f43bf26,0xbe483f7bbf643ee8,0x3f80bd213f263f43,0xbf0ebf553f64bee8,0x3f3c3f2ebf433f26,0x3f7b3e48bf643ee8,0x3d213f80bf26bf43,0xbf553f0e3f64bee8,0xbf2e3f3c3f43bf26,0x3e48bf7bbf643ee8,0xbf803d213f263f43,0x3f0e3f553f64bee8,0xbf3cbf2ebf433f26,0xbf7bbe48bf643ee8,0xbd21bf80bf26bf43
.quad 0x800000008000,0x800000008000,0,0x800000000000,0x8000800000008000,0,0,0x80008000,0x8000,0x8000,0x800000000000,0,0x8000,0x8000800000000000,0x8000800000000000,0x8000800080008000
.quad 0x800000008000,0x800000008000,0x800000008000,0x8000800080008000,0x8000800000008000,0,0x8000800000008000,0x800000000000,0x8000,0x8000,0x8000,0x80008000,0x8000,0x8000800000000000,0x8000,0
.quad 0x3f7ebe023f808000,0x3f6dbebf3f78be81,0x3f1dbf4b3f808000,0xbf6cbec9be81bf78,0xbe02bf7e3f808000,0x3ebf3f6dbf783e81,0xbf4bbf1d3f808000,0x3ec9bf6c3e813f78,0xbf7e3e023f808000,0xbf6d3ebf3f78be81,0xbf1d3f4b3f808000,0x3f6c3ec9be81bf78,0x3e023f7e3f808000,0xbebfbf6dbf783e81,0x3f4b3f1d3f808000,0xbec93f6c3e813f78
.quad 0x800000008000,0x800000008000,0,0x800000000000,0x8000800000008000,0,0,0x80008000,0x8000,0x8000,0x800000000000,0,0x8000,0x8000800000000000,0x8000800000000000,0x8000800080008000
.quad 0x3f4ebf183f5fbefa,0x3f20bf473f39bf31,0xbe163f7dbf5f3efa,0x3f7fbddd3f313f39,0xbf18bf4e3f5fbefa,0x3f473f20bf393f31,0x3f7d3e16bf5f3efa,0x3ddd3f7fbf31bf39,0xbf4e3f183f5fbefa,0xbf203f473f39bf31,0x3e16bf7dbf5f3efa,0xbf7f3ddd3f313f39,0x3f183f4e3f5fbefa,0xbf47bf20bf393f31,0xbf7dbe16bf5f3efa,0xbdddbf7fbf31bf39
.quad 0x3e0c3f7e00003f80,0x3ecd3f6b3e8b3f76,0x3f4c3f1b00003f80,0x3ebbbf6e3f76be8b,0x3f7ebe0c00003f80,0xbf6b3ecdbe8bbf76,0x3f1bbf4c00003f80,0x3f6e3ebbbf763e8b,0xbe0cbf7e00003f80,0xbecdbf6b3e8b3f76,0xbf4cbf1b00003f80,0xbebb3f6e3f76be8b,0xbf7e3e0c00003f80,0x3f6bbecdbe8bbf76,0xbf1b3f4c00003f80,0xbf6ebebbbf763e8b
.quad 0,0,0,0x800000008000,0x800000000000,0x80008000,0x800000000000,0,0x8000800000000000,0x8000800000000000,0x8000800000000000,0x8000,0,0x800080008000,0,0x8000800000000000
.quad 0x3f223f463f063f5a,0x3f523f123f3c3f2e,0xbf7fbdc9bf06bf5a,0x3e343f7cbf2e3f3c,0x3f46bf223f063f5a,0xbf123f52bf3cbf2e,0xbdc93f7fbf06bf5a,0xbf7c3e343f2ebf3c,0xbf22bf463f063f5a,0xbf52bf123f3c3f2e,0x3f7f3dc9bf06bf5a,0xbe34bf7cbf2e3f3c,0xbf463f223f063f5a,0x3f12bf52bf3cbf2e,0x3dc9bf7fbf06bf5a,0x3f7cbe343f2ebf3c
.quad 0,0,0x8000800080008000,0,0x800000000000,0x80008000,0x80008000,0x8000,0x8000800000000000,0x8000800000000000,0x80008000,0x8000800000000000,0,0x800080008000,0x800080008000,0x800000008000
.quad 0,0,0,0x800000008000,0x800000000000,0x80008000,0x800000000000,0,0x8000800000000000,0x8000800000000000,0x8000800000000000,0x8000,0,0x800080008000,0,0x8000800000000000
.quad 0x3e163f7d00003f80,0x3edb3f673e953f75,0x3f4e3f1800003f80,0x3eacbf713f75be95,0x3f7dbe1600003f80,0xbf673edbbe95bf75,0x3f18bf4e00003f80,0x3f713eacbf753e95,0xbe16bf7d00003f80,0xbedbbf673e953f75,0xbf4ebf1800003f80,0xbeac3f713f75be95,0xbf7d3e1600003f80,0x3f67bedbbe95bf75,0xbf183f4e00003f80,0xbf71beacbf753e95
.quad 0,0,0x8000800080008000,0,0x800000000000,0x80008000,0x80008000,0x8000,0x8000800000000000,0x8000800000000000,0x80008000,0x8000800000000000,0,0x800080008000,0x800080008000,0x800000008000
.quad 0x3f2c3f3e3f0e3f55,0x3f5c3f043f463f22,0xbf80bd49bf0ebf55,0x3e793f78bf223f46,0x3f3ebf2c3f0e3f55,0xbf043f5cbf46bf22,0xbd493f80bf0ebf55,0xbf783e793f22bf46,0xbf2cbf3e3f0e3f55,0xbf5cbf043f463f22,0x3f803d49bf0ebf55,0xbe79bf78bf223f46,0xbf3e3f2c3f0e3f55,0x3f04bf5cbf46bf22,0x3d49bf80bf0ebf55,0x3f78be793f22bf46
.quad 0x3f7ebe0c3f808000,0x3f6bbecd3f76be8b,0x3f1bbf4c3f808000,0xbf6ebebbbe8bbf76,0xbe0cbf7e3f808000,0x3ecd3f6bbf763e8b,0xbf4cbf1b3f808000,0x3ebbbf6e3e8b3f76,0xbf7e3e0c3f808000,0xbf6b3ecd3f76be8b,0xbf1b3f4c3f808000,0x3f6e3ebbbe8bbf76,0x3e0c3f7e3f808000,0xbecdbf6bbf763e8b,0x3f4c3f1b3f808000,0xbebb3f6e3e8b3f76
.quad 0x800000008000,0x800000008000,0x800000008000,0x8000800080008000,0x8000800000008000,0,0x8000800000008000,0x800000000000,0x8000,0x8000,0x8000,0x80008000,0x8000,0x8000800000000000,0x8000,0
.quad 0x3f46bf223f5abf06,0x3f12bf523f2ebf3c,0xbdc93f7fbf5a3f06,0x3f7cbe343f3c3f2e,0xbf22bf463f5abf06,0x3f523f12bf2e3f3c,0x3f7f3dc9bf5a3f06,0x3e343f7cbf3cbf2e,0xbf463f223f5abf06,0xbf123f523f2ebf3c,0x3dc9bf7fbf5a3f06,0xbf7c3e343f3c3f2e,0x3f223f463f5abf06,0xbf52bf12bf2e3f3c,0xbf7fbdc9bf5a3f06,0xbe34bf7cbf3cbf2e
.quad 0x800000008000,0x800000008000,0,0x800000000000,0x8000800000008000,0,0,0x80008000,0x8000,0x8000,0x800000000000,0,0x8000,0x8000800000000000,0x8000800000000000,0x8000800080008000
.quad 0x800000008000,0x800000008000,0x800000008000,0x8000800080008000,0x8000800000008000,0,0x8000800000008000,0x800000000000,0x8000,0x8000,0x8000,0x80008000,0x8000,0x8000800000000000,0x8000,0
.quad 0x3f7dbe163f808000,0x3f67bedb3f75be95,0x3f18bf4e3f808000,0xbf71beacbe95bf75,0xbe16bf7d3f808000,0x3edb3f67bf753e95,0xbf4ebf183f808000,0x3eacbf713e953f75,0xbf7d3e163f808000,0xbf673edb3f75be95,0xbf183f4e3f808000,0x3f713eacbe95bf75,0x3e163f7d3f808000,0xbedbbf67bf753e95,0x3f4e3f183f808000,0xbeac3f713e953f75
.quad 0x800000008000,0x800000008000,0,0x800000000000,0x8000800000008000,0,0,0x80008000,0x8000,0x8000,0x800000000000,0,0x8000,0x8000800000000000,0x8000800000000000,0x8000800080008000
.quad 0x3f3ebf2c3f55bf0e,0x3f04bf5c3f22bf46,0xbd493f80bf553f0e,0x3f78be793f463f22,0xbf2cbf3e3f55bf0e,0x3f5c3f04bf223f46,0x3f803d49bf553f0e,0x3e793f78bf46bf22,0xbf3e3f2c3f55bf0e,0xbf043f5c3f22bf46,0x3d49bf80bf553f0e,0xbf783e793f463f22,0x3f2c3f3e3f55bf0e,0xbf5cbf04bf223f46,0xbf80bd49bf553f0e,0xbe79bf78bf46bf22
.quad 0x3e203f7d00003f80,0x3ee83f643e9e3f73,0x3f4f3f1600003f80,0x3e9ebf733f73be9e,0x3f7dbe2000003f80,0xbf643ee8be9ebf73,0x3f16bf4f00003f80,0x3f733e9ebf733e9e,0xbe20bf7d00003f80,0xbee8bf643e9e3f73,0xbf4fbf1600003f80,0xbe9e3f733f73be9e,0xbf7d3e2000003f80,0x3f64bee8be9ebf73,0xbf163f4f00003f80,0xbf73be9ebf733e9e
.quad 0,0,0,0x800000008000,0x800000000000,0x80008000,0x800000000000,0,0x8000800000000000,0x8000800000000000,0x8000800000000000,0x8000,0,0x800080008000,0,0x8000800000000000
.quad 0x3f353f353f163f4f,0x3f643ee83f4f3f16,0xbf800000bf16bf4f,0x3e9e3f73bf163f4f,0x3f35bf353f163f4f,0xbee83f64bf4fbf16,0x3f80bf16bf4f,0xbf733e9e3f16bf4f,0xbf35bf353f163f4f,0xbf64bee83f4f3f16,0x3f800000bf16bf4f,0xbe9ebf73bf163f4f,0xbf353f353f163f4f,0x3ee8bf64bf4fbf16,0xbf80bf16bf4f,0x3f73be9e3f16bf4f
.quad 0,0,0x80008000,0,0x800000000000,0x80008000,0x80008000,0x8000,0x8000800000000000,0x8000800000000000,0x80008000,0x8000800000000000,0,0x800080008000,0x800080008000,0x800000008000
.quad 0,0,0,0x800000008000,0x800000000000,0x80008000,0x800000000000,0,0x8000800000000000,0x8000800000000000,0x8000800000000000,0x8000,0,0x800080008000,0,0x8000800000000000
.quad 0x3e2a3f7c00003f80,0x3ef63f613ea83f72,0x3f513f1400003f80,0x3e90bf763f72bea8,0x3f7cbe2a00003f80,0xbf613ef6bea8bf72,0x3f14bf5100003f80,0x3f763e90bf723ea8,0xbe2abf7c00003f80,0xbef6bf613ea83f72,0xbf51bf1400003f80,0xbe903f763f72bea8,0xbf7c3e2a00003f80,0x3f61bef6bea8bf72,0xbf143f5100003f80,0xbf76be90bf723ea8
.quad 0,0,0x80008000,0,0x800000000000,0x80008000,0x80008000,0x8000,0x8000800000000000,0x8000800000000000,0x800080008000,0x8000800000000000,0,0x800080008000,0x8000800080008000,0x800000008000
.quad 0x3f3e3f2c3f1e3f49,0x3f6c3ec93f583f0a,0xbf803d49bf1ebf49,0x3ebf3f6dbf0a3f58,0x3f2cbf3e3f1e3f49,0xbec93f6cbf58bf0a,0x3d493f80bf1ebf49,0xbf6d3ebf3f0abf58,0xbf3ebf2c3f1e3f49,0xbf6cbec93f583f0a,0x3f80bd49bf1ebf49,0xbebfbf6dbf0a3f58,0xbf2c3f3e3f1e3f49,0x3ec9bf6cbf58bf0a,0xbd49bf80bf1ebf49,0x3f6dbebf3f0abf58
.quad 0x3f7dbe203f808000,0x3f64bee83f73be9e,0x3f16bf4f3f808000,0xbf73be9ebe9ebf73,0xbe20bf7d3f808000,0x3ee83f64bf733e9e,0xbf4fbf163f808000,0x3e9ebf733e9e3f73,0xbf7d3e203f808000,0xbf643ee83f73be9e,0xbf163f4f3f808000,0x3f733e9ebe9ebf73,0x3e203f7d3f808000,0xbee8bf64bf733e9e,0x3f4f3f163f808000,0xbe9e3f733e9e3f73
.quad 0x800000008000,0x800000008000,0x800000008000,0x8000800080008000,0x8000800000008000,0,0x8000800000008000,0x800000000000,0x8000,0x8000,0x8000,0x80008000,0x8000,0x8000800000000000,0x8000,0
.quad 0x3f35bf353f4fbf16,0x3ee8bf643f16bf4f,0x3f80bf4f3f16,0x3f73be9e3f4f3f16,0xbf35bf353f4fbf16,0x3f643ee8bf163f4f,0x3f808000bf4f3f16,0x3e9e3f73bf4fbf16,0xbf353f353f4fbf16,0xbee83f643f16bf4f,0xbf80bf4f3f16,0xbf733e9e3f4f3f16,0x3f353f353f4fbf16,0xbf64bee8bf163f4f,0xbf808000bf4f3f16,0xbe9ebf73bf4fbf16
.quad 0x800000008000,0x800000008000,0,0x800000000000,0x8000800000008000,0,0x800000000000,0x80008000,0x8000,0x8000,0x800000000000,0,0x8000,0x8000800000000000,0x8000800000000000,0x8000800080008000
.quad 0x800000008000,0x800000008000,0x800000008000,0x8000800080008000,0x8000800000008000,0,0x8000800000008000,0x800000000000,0x8000,0x8000,0x8000,0x80008000,0x8000,0x8000800000000000,0x8000,0
.quad 0x3f7cbe2a3f808000,0x3f61bef63f72bea8,0x3f14bf513f808000,0xbf76be90bea8bf72,0xbe2abf7c3f808000,0x3ef63f61bf723ea8,0xbf51bf143f808000,0x3e90bf763ea83f72,0xbf7c3e2a3f808000,0xbf613ef63f72bea8,0xbf143f513f808000,0x3f763e90bea8bf72,0x3e2a3f7c3f808000,0xbef6bf61bf723ea8,0x3f513f143f808000,0xbe903f763ea83f72
.quad 0x800000008000,0x800000008000,0,0x800000000000,0x8000800000008000,0,0x800000000000,0x80008000,0x8000,0x8000,0x8000800000000000,0,0x8000,0x8000800000000000,0,0x8000800080008000
.quad 0x3f2cbf3e3f49bf1e,0x3ec9bf6c3f0abf58,0x3d493f80bf493f1e,0x3f6dbebf3f583f0a,0xbf3ebf2c3f49bf1e,0x3f6c3ec9bf0a3f58,0x3f80bd49bf493f1e,0x3ebf3f6dbf58bf0a,0xbf2c3f3e3f49bf1e,0xbec93f6c3f0abf58,0xbd49bf80bf493f1e,0xbf6d3ebf3f583f0a,0x3f3e3f2c3f49bf1e,0xbf6cbec9bf0a3f58,0xbf803d49bf493f1e,0xbebfbf6dbf58bf0a
.quad 0x3e343f7c00003f80,0x3f013f5d3eb13f70,0x3f523f1200003f80,0x3e81bf783f70beb1,0x3f7cbe3400003f80,0xbf5d3f01beb1bf70,0x3f12bf5200003f80,0x3f783e81bf703eb1,0xbe34bf7c00003f80,0xbf01bf5d3eb13f70,0xbf52bf1200003f80,0xbe813f783f70beb1,0xbf7c3e3400003f80,0x3f5dbf01beb1bf70,0xbf123f5200003f80,0xbf78be81bf703eb1
.quad 0,0,0,0x800000008000,0x800000000000,0x80008000,0x800000000000,0,0x8000800000000000,0x8000800000000000,0x8000800000000000,0x8000,0,0x800080008000,0,0x8000800000000000
.quad 0x3f463f223f263f43,0x3f723ea83f5f3efa,0xbf7f3dc9bf26bf43,0x3edf3f66befa3f5f,0x3f22bf463f263f43,0xbea83f72bf5fbefa,0x3dc93f7fbf26bf43,0xbf663edf3efabf5f,0xbf46bf223f263f43,0xbf72bea83f5f3efa,0x3f7fbdc9bf26bf43,0xbedfbf66befa3f5f,0xbf223f463f263f43,0x3ea8bf72bf5fbefa,0xbdc9bf7fbf26bf43,0x3f66bedf3efabf5f
.quad 0,0,0x80008000,0,0x800000000000,0x80008000,0x80008000,0x8000,0x8000800000000000,0x8000800000000000,0x800080008000,0x8000800000000000,0,0x800080008000,0x8000800080008000,0x800000008000
.quad 0,0,0,0x800000008000,0x800000000000,0x80008000,0x800000000000,0,0x8000800000000000,0x8000800000000000,0x8000800000000000,0x8000,0,0x800080008000,0,0x8000800000000000
.quad 0x3e3e3f7c00003f80,0x3f083f593ebb3f6e,0x3f533f1000003f80,0x3e65bf7a3f6ebebb,0x3f7cbe3e00003f80,0xbf593f08bebbbf6e,0x3f10bf5300003f80,0x3f7a3e65bf6e3ebb,0xbe3ebf7c00003f80,0xbf08bf593ebb3f6e,0xbf53bf1000003f80,0xbe653f7a3f6ebebb,0xbf7c3e3e00003f80,0x3f59bf08bebbbf6e,0xbf103f5300003f80,0xbf7abe65bf6e3ebb
.quad 0,0,0x80008000,0,0x800000000000,0x80008000,0x80008000,0x8000,0x8000800000000000,0x8000800000000000,0x800080008000,0x8000800000000000,0,0x800080008000,0x8000800080008000,0x800000008000
.quad 0x3f4e3f183f2e3f3c,0x3f773e863f663edf,0xbf7d3e16bf2ebf3c,0x3eff3f5ebedf3f66,0x3f18bf4e3f2e3f3c,0xbe863f77bf66bedf,0x3e163f7dbf2ebf3c,0xbf5e3eff3edfbf66,0xbf4ebf183f2e3f3c,0xbf77be863f663edf,0x3f7dbe16bf2ebf3c,0xbeffbf5ebedf3f66,0xbf183f4e3f2e3f3c,0x3e86bf77bf66bedf,0xbe16bf7dbf2ebf3c,0x3f5ebeff3edfbf66
.quad 0x3f7cbe343f808000,0x3f5dbf013f70beb1,0x3f12bf523f808000,0xbf78be81beb1bf70,0xbe34bf7c3f808000,0x3f013f5dbf703eb1,0xbf52bf123f808000,0x3e81bf783eb13f70,0xbf7c3e343f808000,0xbf5d3f013f70beb1,0xbf123f523f808000,0x3f783e81beb1bf70,0x3e343f7c3f808000,0xbf01bf5dbf703eb1,0x3f523f123f808000,0xbe813f783eb13f70
.quad 0x800000008000,0x800000008000,0x800000008000,0x8000800080008000,0x8000800000008000,0,0x8000800000008000,0x800000000000,0x8000,0x8000,0x8000,0x80008000,0x8000,0x8000800000000000,0x8000,0
.quad 0x3f22bf463f43bf26,0x3ea8bf723efabf5f,0x3dc93f7fbf433f26,0x3f66bedf3f5f3efa,0xbf46bf223f43bf26,0x3f723ea8befa3f5f,0x3f7fbdc9bf433f26,0x3edf3f66bf5fbefa,0xbf223f463f43bf26,0xbea83f723efabf5f,0xbdc9bf7fbf433f26,0xbf663edf3f5f3efa,0x3f463f223f43bf26,0xbf72bea8befa3f5f,0xbf7f3dc9bf433f26,0xbedfbf66bf5fbefa
.quad 0x800000008000,0x800000008000,0,0x800000000000,0x8000800000008000,0,0x800000000000,0x80008000,0x8000,0x8000,0x8000800000000000,0,0x8000,0x8000800000000000,0,0x8000800080008000
.quad 0x800000008000,0x800000008000,0x800000008000,0x8000800080008000,0x8000800000008000,0,0x8000800000008000,0x800000000000,0x8000,0x8000,0x8000,0x80008000,0x8000,0x8000800000000000,0x8000,0
.quad 0x3f7cbe3e3f808000,0x3f59bf083f6ebebb,0x3f10bf533f808000,0xbf7abe65bebbbf6e,0xbe3ebf7c3f808000,0x3f083f59bf6e3ebb,0xbf53bf103f808000,0x3e65bf7a3ebb3f6e,0xbf7c3e3e3f808000,0xbf593f083f6ebebb,0xbf103f533f808000,0x3f7a3e65bebbbf6e,0x3e3e3f7c3f808000,0xbf08bf59bf6e3ebb,0x3f533f103f808000,0xbe653f7a3ebb3f6e
.quad 0x800000008000,0x800000008000,0,0x800000000000,0x8000800000008000,0,0x800000000000,0x80008000,0x8000,0x8000,0x8000800000000000,0,0x8000,0x8000800000000000,0,0x8000800080008000
.quad 0x3f18bf4e3f3cbf2e,0x3e86bf773edfbf66,0x3e163f7dbf3c3f2e,0x3f5ebeff3f663edf,0xbf4ebf183f3cbf2e,0x3f773e86bedf3f66,0x3f7dbe16bf3c3f2e,0x3eff3f5ebf66bedf,0xbf183f4e3f3cbf2e,0xbe863f773edfbf66,0xbe16bf7dbf3c3f2e,0xbf5e3eff3f663edf,0x3f4e3f183f3cbf2e,0xbf77be86bedf3f66,0xbf7d3e16bf3c3f2e,0xbeffbf5ebf66bedf
.quad 0x3e483f7b00003f80,0x3f0e3f553ec43f6d,0x3f553f0e00003f80,0x3e48bf7b3f6dbec4,0x3f7bbe4800003f80,0xbf553f0ebec4bf6d,0x3f0ebf5500003f80,0x3f7b3e48bf6d3ec4,0xbe48bf7b00003f80,0xbf0ebf553ec43f6d,0xbf55bf0e00003f80,0xbe483f7b3f6dbec4,0xbf7b3e4800003f80,0x3f55bf0ebec4bf6d,0xbf0e3f5500003f80,0xbf7bbe48bf6d3ec4
.quad 0,0,0,0x800000008000,0x800000000000,0x80008000,0x800000000000,0,0x8000800000000000,0x8000800000000000,0x8000800000000000,0x8000,0,0x800080008000,0,0x8000800000000000
.quad 0x3f553f0e3f353f35,0x3f7b3e483f6d3ec4,0xbf7b3e48bf35bf35,0x3f0e3f55bec43f6d,0x3f0ebf553f353f35,0xbe483f7bbf6dbec4,0x3e483f7bbf35bf35,0xbf553f0e3ec4bf6d,0xbf55bf0e3f353f35,0xbf7bbe483f6d3ec4,0x3f7bbe48bf35bf35,0xbf0ebf55bec43f6d,0xbf0e3f553f353f35,0x3e48bf7bbf6dbec4,0xbe48bf7bbf35bf35,0x3f55bf0e3ec4bf6d
.quad 0,0,0x80008000,0,0x800000000000,0x80008000,0x80008000,0x8000,0x8000800000000000,0x8000800000000000,0x800080008000,0x8000800000000000,0,0x800080008000,0x8000800080008000,0x800000008000
.quad 0,0,0,0x800000008000,0x800000000000,0x80008000,0x800000000000,0,0x8000800000000000,0x8000800000000000,0x8000800000000000,0x8000,0,0x800080008000,0,0x8000800000000000
.quad 0x3e523f7b00003f80,0x3f143f513ecd3f6b,0x3f563f0c00003f80,0x3e2abf7c3f6bbecd,0x3f7bbe5200003f80,0xbf513f14becdbf6b,0x3f0cbf5600003f80,0x3f7c3e2abf6b3ecd,0xbe52bf7b00003f80,0xbf14bf513ecd3f6b,0xbf56bf0c00003f80,0xbe2a3f7c3f6bbecd,0xbf7b3e5200003f80,0x3f51bf14becdbf6b,0xbf0c3f5600003f80,0xbf7cbe2abf6b3ecd
.quad 0,0,0x80008000,0,0x800000000000,0x80008000,0x80008000,0x8000,0x8000800000000000,0x8000800000000000,0x800080008000,0x8000800000000000,0,0x800080008000,0x8000800080008000,0x800000008000
.quad 0x3f5c3f043f3c3f2e,0x3f7e3e023f723ea8,0xbf783e79bf3cbf2e,0x3f1d3f4bbea83f72,0x3f04bf5c3f3c3f2e,0xbe023f7ebf72bea8,0x3e793f78bf3cbf2e,0xbf4b3f1d3ea8bf72,0xbf5cbf043f3c3f2e,0xbf7ebe023f723ea8,0x3f78be79bf3cbf2e,0xbf1dbf4bbea83f72,0xbf043f5c3f3c3f2e,0x3e02bf7ebf72bea8,0xbe79bf78bf3cbf2e,0x3f4bbf1d3ea8bf72
.quad 0x3f7bbe483f808000,0x3f55bf0e3f6dbec4,0x3f0ebf553f808000,0xbf7bbe48bec4bf6d,0xbe48bf7b3f808000,0x3f0e3f55bf6d3ec4,0xbf55bf0e3f808000,0x3e48bf7b3ec43f6d,0xbf7b3e483f808000,0xbf553f0e3f6dbec4,0xbf0e3f553f808000,0x3f7b3e48bec4bf6d,0x3e483f7b3f808000,0xbf0ebf55bf6d3ec4,0x3f553f0e3f808000,0xbe483f7b3ec43f6d
.quad 0x800000008000,0x800000008000,0x800000008000,0x8000800080008000,0x8000800000008000,0,0x8000800000008000,0x800000000000,0x8000,0x8000,0x8000,0x80008000,0x8000,0x8000800000000000,0x8000,0
.quad 0x3f0ebf553f35bf35,0x3e48bf7b3ec4bf6d,0x3e483f7bbf353f35,0x3f55bf0e3f6d3ec4,0xbf55bf0e3f35bf35,0x3f7b3e48bec43f6d,0x3f7bbe48bf353f35,0x3f0e3f55bf6dbec4,0xbf0e3f553f35bf35,0xbe483f7b3ec4bf6d,0xbe48bf7bbf353f35,0xbf553f0e3f6d3ec4,0x3f553f0e3f35bf35,0xbf7bbe48bec43f6d,0xbf7b3e48bf353f35,0xbf0ebf55bf6dbec4
.quad 0x800000008000,0x800000008000,0,0x800000000000,0x8000800000008000,0,0x800000000000,0x80008000,0x8000,0x8000,0x8000800000000000,0,0x8000,0x8000800000000000,0,0x8000800080008000
.quad 0x800000008000,0x800000008000,0x800000008000,0x8000800080008000,0x8000800000008000,0,0x8000800000008000,0x800000000000,0x8000,0x8000,0x8000,0x80008000,0x8000,0x8000800000000000,0x8000,0
.quad 0x3f7bbe523f808000,0x3f51bf143f6bbecd,0x3f0cbf563f808000,0xbf7cbe2abecdbf6b,0xbe52bf7b3f808000,0x3f143f51bf6b3ecd,0xbf56bf0c3f808000,0x3e2abf7c3ecd3f6b,0xbf7b3e523f808000,0xbf513f143f6bbecd,0xbf0c3f563f808000,0x3f7c3e2abecdbf6b,0x3e523f7b3f808000,0xbf14bf51bf6b3ecd,0x3f563f0c3f808000,0xbe2a3f7c3ecd3f6b
.quad 0x800000008000,0x800000008000,0,0x800000000000,0x8000800000008000,0,0x800000000000,0x80008000,0x8000,0x8000,0x8000800000000000,0,0x8000,0x8000800000000000,0,0x8000800080008000
.quad 0x3f04bf5c3f2ebf3c,0x3e02bf7e3ea8bf72,0x3e793f78bf2e3f3c,0x3f4bbf1d3f723ea8,0xbf5cbf043f2ebf3c,0x3f7e3e02bea83f72,0x3f78be79bf2e3f3c,0x3f1d3f4bbf72bea8,0xbf043f5c3f2ebf3c,0xbe023f7e3ea8bf72,0xbe79bf78bf2e3f3c,0xbf4b3f1d3f723ea8,0x3f5c3f043f2ebf3c,0xbf7ebe02bea83f72,0xbf783e79bf2e3f3c,0xbf1dbf4bbf72bea8
.quad 0x3e5b3f7a00003f80,0x3f1b3f4c3ed63f68,0x3f583f0a00003f80,0x3e0cbf7e3f68bed6,0x3f7abe5b00003f80,0xbf4c3f1bbed6bf68,0x3f0abf5800003f80,0x3f7e3e0cbf683ed6,0xbe5bbf7a00003f80,0xbf1bbf4c3ed63f68,0xbf58bf0a00003f80,0xbe0c3f7e3f68bed6,0xbf7a3e5b00003f80,0x3f4cbf1bbed6bf68,0xbf0a3f5800003f80,0xbf7ebe0cbf683ed6
.quad 0,0,0,0x800000008000,0x800000000000,0x80008000,0x800000000000,0,0x8000800000000000,0x8000800000000000,0x8000800000000000,0x8000,0,0x800080008000,0,0x8000800000000000
.quad 0x3f623ef13f433f26,0x3f803d713f763e8b,0xbf753e95bf43bf26,0x3f2a3f3fbe8b3f76,0x3ef1bf623f433f26,0xbd713f80bf76be8b,0x3e953f75bf43bf26,0xbf3f3f2a3e8bbf76,0xbf62bef13f433f26,0xbf80bd713f763e8b,0x3f75be95bf43bf26,0xbf2abf3fbe8b3f76,0xbef13f623f433f26,0x3d71bf80bf76be8b,0xbe95bf75bf43bf26,0x3f3fbf2a3e8bbf76
.quad 0,0,0x80008000,0,0x800000000000,0x80008000,0x80008000,0x8000,0x8000800000000000,0x8000800000000000,0x800080008000,0x8000800000000000,0,0x800080008000,0x8000800080008000,0x800000008000
.quad 0,0,0,0x800000008000,0x800000000000,0x80008000,0x800000000000,0,0x8000800000000000,0x8000800000000000,0x8000800000000000,0x8000,0,0x800080008000,0,0x8000800000000000
.quad 0x3e653f7a00003f80,0x3f203f473edf3f66,0x3f593f0800003f80,0x3dddbf7f3f66bedf,0x3f7abe6500003f80,0xbf473f20bedfbf66,0x3f08bf5900003f80,0x3f7f3dddbf663edf,0xbe65bf7a00003f80,0xbf20bf473edf3f66,0xbf59bf0800003f80,0xbddd3f7f3f66bedf,0xbf7a3e6500003f80,0x3f47bf20bedfbf66,0xbf083f5900003f80,0xbf7fbdddbf663edf
.quad 0,0x800000000000,0x80008000,0,0x800000000000,0x80008000,0x80008000,0x8000,0x8000800000000000,0,0x800080008000,0x8000800000000000,0,0x8000800080008000,0x8000800080008000,0x800000008000
.quad 0x3f673edb3f493f1e,0x3f80bc213f7a3e5b,0xbf713eacbf49bf1e,0x3f373f33be5b3f7a,0x3edbbf673f493f1e,0x3c213f80bf7abe5b,0x3eac3f71bf49bf1e,0xbf333f373e5bbf7a,0xbf67bedb3f493f1e,0xbf803c213f7a3e5b,0x3f71beacbf49bf1e,0xbf37bf33be5b3f7a,0xbedb3f673f493f1e,0xbc21bf80bf7abe5b,0xbeacbf71bf49bf1e,0x3f33bf373e5bbf7a
.quad 0x3f7abe5b3f808000,0x3f4cbf1b3f68bed6,0x3f0abf583f808000,0xbf7ebe0cbed6bf68,0xbe5bbf7a3f808000,0x3f1b3f4cbf683ed6,0xbf58bf0a3f808000,0x3e0cbf7e3ed63f68,0xbf7a3e5b3f808000,0xbf4c3f1b3f68bed6,0xbf0a3f583f808000,0x3f7e3e0cbed6bf68,0x3e5b3f7a3f808000,0xbf1bbf4cbf683ed6,0x3f583f0a3f808000,0xbe0c3f7e3ed63f68
.quad 0x800000008000,0x800000008000,0x800000008000,0x8000800080008000,0x8000800000008000,0,0x8000800000008000,0x800000000000,0x8000,0x8000,0x8000,0x80008000,0x8000,0x8000800000000000,0x8000,0
.quad 0x3ef1bf623f26bf43,0x3d71bf803e8bbf76,0x3e953f75bf263f43,0x3f3fbf2a3f763e8b,0xbf62bef13f26bf43,0x3f803d71be8b3f76,0x3f75be95bf263f43,0x3f2a3f3fbf76be8b,0xbef13f623f26bf43,0xbd713f803e8bbf76,0xbe95bf75bf263f43,0xbf3f3f2a3f763e8b,0x3f623ef13f26bf43,0xbf80bd71be8b3f76,0xbf753e95bf263f43,0xbf2abf3fbf76be8b
.quad 0x800000008000,0x800000008000,0,0x800000000000,0x8000800000008000,0,0x800000000000,0x80008000,0x8000,0x8000,0x8000800000000000,0,0x8000,0x8000800000000000,0,0x8000800080008000
.quad 0x800000008000,0x800000008000,0x800000008000,0x8000800080008000,0x8000800000008000,0,0x8000800000008000,0x800000000000,0x8000,0x8000,0x8000,0x80008000,0x8000,0x8000800000000000,0x8000,0
.quad 0x3f7abe653f808000,0x3f47bf203f66bedf,0x3f08bf593f808000,0xbf7fbdddbedfbf66,0xbe65bf7a3f808000,0x3f203f47bf663edf,0xbf59bf083f808000,0x3dddbf7f3edf3f66,0xbf7a3e653f808000,0xbf473f203f66bedf,0xbf083f593f808000,0x3f7f3dddbedfbf66,0x3e653f7a3f808000,0xbf20bf47bf663edf,0x3f593f083f808000,0xbddd3f7f3edf3f66
.quad 0x800000008000,0x8000800000008000,0,0x800000000000,0x8000800000008000,0x800000000000,0x800000000000,0x80008000,0x8000,0x8000,0x8000800000000000,0,0x8000,0,0,0x8000800080008000
.quad 0x3edbbf673f1ebf49,0xbc21bf803e5bbf7a,0x3eac3f71bf1e3f49,0x3f33bf373f7a3e5b,0xbf67bedb3f1ebf49,0x3f80bc21be5b3f7a,0x3f71beacbf1e3f49,0x3f373f33bf7abe5b,0xbedb3f673f1ebf49,0x3c213f803e5bbf7a,0xbeacbf71bf1e3f49,0xbf333f373f7a3e5b,0x3f673edb3f1ebf49,0xbf803c21be5b3f7a,0xbf713eacbf1e3f49,0xbf37bf33bf7abe5b
.quad 0x3e6f3f7900003f80,0x3f263f433ee83f64,0x3f5a3f0600003f80,0x3da1bf7f3f64bee8,0x3f79be6f00003f80,0xbf433f26bee8bf64,0x3f06bf5a00003f80,0x3f7f3da1bf643ee8,0xbe6fbf7900003f80,0xbf26bf433ee83f64,0xbf5abf0600003f80,0xbda13f7f3f64bee8,0xbf793e6f00003f80,0x3f43bf26bee8bf64,0xbf063f5a00003f80,0xbf7fbda1bf643ee8
.quad 0,0,0,0x800000008000,0x800000000000,0x80008000,0x800000000000,0,0x8000800000000000,0x8000800000000000,0x8000800000000000,0x8000,0,0x800080008000,0,0x8000800000000000
.quad 0x3f6d3ec43f4f3f16,0x3f7fbda13f7d3e20,0xbf6d3ec4bf4fbf16,0x3f433f26be203f7d,0x3ec4bf6d3f4f3f16,0x3da13f7fbf7dbe20,0x3ec43f6dbf4fbf16,0xbf263f433e20bf7d,0xbf6dbec43f4f3f16,0xbf7f3da13f7d3e20,0x3f6dbec4bf4fbf16,0xbf43bf26be203f7d,0xbec43f6d3f4f3f16,0xbda1bf7fbf7dbe20,0xbec4bf6dbf4fbf16,0x3f26bf433e20bf7d
.quad 0,0x800000000000,0x80008000,0,0x800000000000,0x80008000,0x80008000,0x8000,0x8000800000000000,0,0x800080008000,0x8000800000000000,0,0x8000800080008000,0x8000800080008000,0x800000008000
.quad 0,0,0,0x800000008000,0x800000000000,0x80008000,0x800000000000,0,0x8000800000000000,0x8000800000000000,0x8000800000000000,0x8000,0,0x800080008000,0,0x8000800000000000
.quad 0x3e793f7800003f80,0x3f2c3f3e3ef13f62,0x3f5c3f0400003f80,0x3d49bf803f62bef1,0x3f78be7900003f80,0xbf3e3f2cbef1bf62,0x3f04bf5c00003f80,0x3f803d49bf623ef1,0xbe79bf7800003f80,0xbf2cbf3e3ef13f62,0xbf5cbf0400003f80,0xbd493f803f62bef1,0xbf783e7900003f80,0x3f3ebf2cbef1bf62,0xbf043f5c00003f80,0xbf80bd49bf623ef1
.quad 0,0x800000000000,0x80008000,0,0x800000000000,0x80008000,0x80008000,0x8000,0x8000800000000000,0,0x800080008000,0x8000800000000000,0,0x8000800080008000,0x8000800080008000,0x800000008000
.quad 0x3f713eac3f553f0e,0x3f7dbe163f7f3dc9,0xbf673edbbf55bf0e,0x3f4e3f18bdc93f7f,0x3eacbf713f553f0e,0x3e163f7dbf7fbdc9,0x3edb3f67bf55bf0e,0xbf183f4e3dc9bf7f,0xbf71beac3f553f0e,0xbf7d3e163f7f3dc9,0x3f67bedbbf55bf0e,0xbf4ebf18bdc93f7f,0xbeac3f713f553f0e,0xbe16bf7dbf7fbdc9,0xbedbbf67bf55bf0e,0x3f18bf4e3dc9bf7f
.quad 0x3f79be6f3f808000,0x3f43bf263f64bee8,0x3f06bf5a3f808000,0xbf7fbda1bee8bf64,0xbe6fbf793f808000,0x3f263f43bf643ee8,0xbf5abf063f808000,0x3da1bf7f3ee83f64,0xbf793e6f3f808000,0xbf433f263f64bee8,0xbf063f5a3f808000,0x3f7f3da1bee8bf64,0x3e6f3f793f808000,0xbf26bf43bf643ee8,0x3f5a3f063f808000,0xbda13f7f3ee83f64
.quad 0x800000008000,0x800000008000,0x800000008000,0x8000800080008000,0x8000800000008000,0,0x8000800000008000,0x800000000000,0x8000,0x8000,0x8000,0x80008000,0x8000,0x8000800000000000,0x8000,0
.quad 0x3ec4bf6d3f16bf4f,0xbda1bf7f3e20bf7d,0x3ec43f6dbf163f4f,0x3f26bf433f7d3e20,0xbf6dbec43f16bf4f,0x3f7fbda1be203f7d,0x3f6dbec4bf163f4f,0x3f433f26bf7dbe20,0xbec43f6d3f16bf4f,0x3da13f7f3e20bf7d,0xbec4bf6dbf163f4f,0xbf263f433f7d3e20,0x3f6d3ec43f16bf4f,0xbf7f3da1be203f7d,0xbf6d3ec4bf163f4f,0xbf43bf26bf7dbe20
.quad 0x800000008000,0x8000800000008000,0,0x800000000000,0x8000800000008000,0x800000000000,0x800000000000,0x80008000,0x8000,0x8000,0x8000800000000000,0,0x8000,0,0,0x8000800080008000
.quad 0x800000008000,0x800000008000,0x800000008000,0x8000800080008000,0x8000800000008000,0,0x8000800000008000,0x800000000000,0x8000,0x8000,0x8000,0x80008000,0x8000,0x8000800000000000,0x8000,0
.quad 0x3f78be793f808000,0x3f3ebf2c3f62bef1,0x3f04bf5c3f808000,0xbf80bd49bef1bf62,0xbe79bf783f808000,0x3f2c3f3ebf623ef1,0xbf5cbf043f808000,0x3d49bf803ef13f62,0xbf783e793f808000,0xbf3e3f2c3f62bef1,0xbf043f5c3f808000,0x3f803d49bef1bf62,0x3e793f783f808000,0xbf2cbf3ebf623ef1,0x3f5c3f043f808000,0xbd493f803ef13f62
.quad 0x800000008000,0x8000800000008000,0,0x800000000000,0x8000800000008000,0x800000000000,0x800000000000,0x80008000,0x8000,0x8000,0x8000800000000000,0,0x8000,0,0,0x8000800080008000
.quad 0x3eacbf713f0ebf55,0xbe16bf7d3dc9bf7f,0x3edb3f67bf0e3f55,0x3f18bf4e3f7f3dc9,0xbf71beac3f0ebf55,0x3f7dbe16bdc93f7f,0x3f67bedbbf0e3f55,0x3f4e3f18bf7fbdc9,0xbeac3f713f0ebf55,0x3e163f7d3dc9bf7f,0xbedbbf67bf0e3f55,0xbf183f4e3f7f3dc9,0x3f713eac3f0ebf55,0xbf7d3e16bdc93f7f,0xbf673edbbf0e3f55,0xbf4ebf18bf7fbdc9
.quad 0x3e813f7800003f80,0x3f313f393efa3f5f,0x3f5d3f0100003f80,0x3ca1bf803f5fbefa,0x3f78be8100003f80,0xbf393f31befabf5f,0x3f01bf5d00003f80,0x3f803ca1bf5f3efa,0xbe81bf7800003f80,0xbf31bf393efa3f5f,0xbf5dbf0100003f80,0xbca13f803f5fbefa,0xbf783e8100003f80,0x3f39bf31befabf5f,0xbf013f5d00003f80,0xbf80bca1bf5f3efa
.quad 0,0,0,0x800000008000,0x800000000000,0x80008000,0x800000000000,0,0x8000800000000000,0x8000800000000000,0x8000800000000000,0x8000,0,0x800080008000,0,0x8000800000000000
.quad 0x3f753e953f5a3f06,0x3f7abe5b3f803d21,0xbf623ef1bf5abf06,0x3f583f0abd213f80,0x3e95bf753f5a3f06,0x3e5b3f7abf80bd21,0x3ef13f62bf5abf06,0xbf0a3f583d21bf80,0xbf75be953f5a3f06,0xbf7a3e5b3f803d21,0x3f62bef1bf5abf06,0xbf58bf0abd213f80,0xbe953f753f5a3f06,0xbe5bbf7abf80bd21,0xbef1bf62bf5abf06,0x3f0abf583d21bf80
.quad 0,0x800000000000,0x80008000,0,0x800000000000,0x80008000,0x80008000,0x8000,0x8000800000000000,0,0x800080008000,0x8000800000000000,0,0x8000800080008000,0x8000800080008000,0x800000008000
.quad 0,0,0,0x8000800000008000,0x800000000000,0x80008000,0x800000000000,0x800000000000,0x8000800000000000,0x8000800000000000,0x8000800000000000,0x8000,0,0x800080008000,0,0
.quad 0x3e863f7700003f80,0x3f373f333f013f5d,0x3f5e3eff00003f80,0xbc21bf803f5dbf01,0x3f77be8600003f80,0xbf333f37bf01bf5d,0x3effbf5e00003f80,0x3f80bc21bf5d3f01,0xbe86bf7700003f80,0xbf37bf333f013f5d,0xbf5ebeff00003f80,0x3c213f803f5dbf01,0xbf773e8600003f80,0x3f33bf37bf01bf5d,0xbeff3f5e00003f80,0xbf803c21bf5d3f01
.quad 0,0x800000008000,0x80008000,0,0x800000000000,0,0x80008000,0x80008000,0x8000800000000000,0x8000,0x800080008000,0x8000800000000000,0,0x8000800000000000,0x8000800080008000,0x800080008000
.quad 0x3f783e793f5f3efa,0x3f76be903f80bca1,0xbf5c3f04bf5fbefa,0x3f613ef63ca13f80,0x3e79bf783f5f3efa,0x3e903f76bf803ca1,0x3f043f5cbf5fbefa,0xbef63f61bca1bf80,0xbf78be793f5f3efa,0xbf763e903f80bca1,0x3f5cbf04bf5fbefa,0xbf61bef63ca13f80,0xbe793f783f5f3efa,0xbe90bf76bf803ca1,0xbf04bf5cbf5fbefa,0x3ef6bf61bca1bf80
.quad 0x3f78be813f808000,0x3f39bf313f5fbefa,0x3f01bf5d3f808000,0xbf80bca1befabf5f,0xbe81bf783f808000,0x3f313f39bf5f3efa,0xbf5dbf013f808000,0x3ca1bf803efa3f5f,0xbf783e813f808000,0xbf393f313f5fbefa,0xbf013f5d3f808000,0x3f803ca1befabf5f,0x3e813f783f808000,0xbf31bf39bf5f3efa,0x3f5d3f013f808000,0xbca13f803efa3f5f
.quad 0x800000008000,0x800000008000,0x800000008000,0x8000800080008000,0x8000800000008000,0,0x8000800000008000,0x800000000000,0x8000,0x8000,0x8000,0x80008000,0x8000,0x8000800000000000,0x8000,0
.quad 0x3e95bf753f06bf5a,0xbe5bbf7a3d21bf80,0x3ef13f62bf063f5a,0x3f0abf583f803d21,0xbf75be953f06bf5a,0x3f7abe5bbd213f80,0x3f62bef1bf063f5a,0x3f583f0abf80bd21,0xbe953f753f06bf5a,0x3e5b3f7a3d21bf80,0xbef1bf62bf063f5a,0xbf0a3f583f803d21,0x3f753e953f06bf5a,0xbf7a3e5bbd213f80,0xbf623ef1bf063f5a,0xbf58bf0abf80bd21
.quad 0x800000008000,0x8000800000008000,0,0x800000000000,0x8000800000008000,0x800000000000,0x800000000000,0x80008000,0x8000,0x8000,0x8000800000000000,0,0x8000,0,0,0x8000800080008000
.quad 0x800000008000,0x800000008000,0x800000008000,0x80008000,0x8000800000008000,0,0x8000800000008000,0x8000800000000000,0x8000,0x8000,0x8000,0x800080008000,0x8000,0x8000800000000000,0x8000,0
.quad 0x3f77be863f808000,0x3f33bf373f5dbf01,0x3effbf5e3f808000,0xbf803c21bf01bf5d,0xbe86bf773f808000,0x3f373f33bf5d3f01,0xbf5ebeff3f808000,0xbc21bf803f013f5d,0xbf773e863f808000,0xbf333f373f5dbf01,0xbeff3f5e3f808000,0x3f80bc21bf01bf5d,0x3e863f773f808000,0xbf37bf33bf5d3f01,0x3f5e3eff3f808000,0x3c213f803f013f5d
.quad 0x800000008000,0x8000800080008000,0,0x800000008000,0x8000800000008000,0x800000000000,0x800000000000,0,0x8000,0x80008000,0x8000800000000000,0x8000,0x8000,0,0,0x8000800000000000
.quad 0x3e79bf783efabf5f,0xbe90bf76bca1bf80,0x3f043f5cbefa3f5f,0x3ef6bf613f80bca1,0xbf78be793efabf5f,0x3f76be903ca13f80,0x3f5cbf04befa3f5f,0x3f613ef6bf803ca1,0xbe793f783efabf5f,0x3e903f76bca1bf80,0xbf04bf5cbefa3f5f,0xbef63f613f80bca1,0x3f783e793efabf5f,0xbf763e903ca13f80,0xbf5c3f04befa3f5f,0xbf61bef6bf803ca1
.quad 0x3e8b3f7600003f80,0x3f3c3f2e3f063f5a,0x3f5f3efa00003f80,0xbd21bf803f5abf06,0x3f76be8b00003f80,0xbf2e3f3cbf06bf5a,0x3efabf5f00003f80,0x3f80bd21bf5a3f06,0xbe8bbf7600003f80,0xbf3cbf2e3f063f5a,0xbf5fbefa00003f80,0x3d213f803f5abf06,0xbf763e8b00003f80,0x3f2ebf3cbf06bf5a,0xbefa3f5f00003f80,0xbf803d21bf5a3f06
.quad 0,0,0,0x8000800000008000,0x800000000000,0x80008000,0x800000000000,0x800000000000,0x8000800000000000,0x8000800000000000,0x8000800000000000,0x8000,0,0x800080008000,0,0
.quad 0x3f7b3e483f643ee8,0x3f70beb13f7fbda1,0xbf553f0ebf64bee8,0x3f683ed63da13f7f,0x3e48bf7b3f643ee8,0x3eb13f70bf7f3da1,0x3f0e3f55bf64bee8,0xbed63f68bda1bf7f,0xbf7bbe483f643ee8,0xbf703eb13f7fbda1,0x3f55bf0ebf64bee8,0xbf68bed63da13f7f,0xbe483f7b3f643ee8,0xbeb1bf70bf7f3da1,0xbf0ebf55bf64bee8,0x3ed6bf68bda1bf7f
.quad 0,0x800000008000,0x80008000,0,0x800000000000,0,0x80008000,0x80008000,0x8000800000000000,0x8000,0x800080008000,0x8000800000000000,0,0x8000800000000000,0x8000800080008000,0x800080008000
.quad 0,0,0,0x8000800000008000,0x800000000000,0x80008000,0x800000000000,0x800000000000,0x8000800000000000,0x8000800000000000,0x8000800000000000,0x8000,0,0x800080008000,0,0
.quad 0x3e903f7600003f80,0x3f413f283f0a3f58,0x3f613ef600003f80,0xbd8dbf7f3f58bf0a,0x3f76be9000003f80,0xbf283f41bf0abf58,0x3ef6bf6100003f80,0x3f7fbd8dbf583f0a,0xbe90bf7600003f80,0xbf41bf283f0a3f58,0xbf61bef600003f80,0x3d8d3f7f3f58bf0a,0xbf763e9000003f80,0x3f28bf41bf0abf58,0xbef63f6100003f80,0xbf7f3d8dbf583f0a
.quad 0,0x800000008000,0x80008000,0,0x800000000000,0,0x80008000,0x80008000,0x8000800000000000,0x8000,0x800080008000,0x8000800000000000,0,0x8000800000000000,0x8000800080008000,0x800080008000
.quad 0x3f7d3e163f683ed6,0x3f6abed23f7ebe0c,0xbf4e3f18bf68bed6,0x3f6f3eb63e0c3f7e,0x3e16bf7d3f683ed6,0x3ed23f6abf7e3e0c,0x3f183f4ebf68bed6,0xbeb63f6fbe0cbf7e,0xbf7dbe163f683ed6,0xbf6a3ed23f7ebe0c,0x3f4ebf18bf68bed6,0xbf6fbeb63e0c3f7e,0xbe163f7d3f683ed6,0xbed2bf6abf7e3e0c,0xbf18bf4ebf68bed6,0x3eb6bf6fbe0cbf7e
.quad 0x3f76be8b3f808000,0x3f2ebf3c3f5abf06,0x3efabf5f3f808000,0xbf803d21bf06bf5a,0xbe8bbf763f808000,0x3f3c3f2ebf5a3f06,0xbf5fbefa3f808000,0xbd21bf803f063f5a,0xbf763e8b3f808000,0xbf2e3f3c3f5abf06,0xbefa3f5f3f808000,0x3f80bd21bf06bf5a,0x3e8b3f763f808000,0xbf3cbf2ebf5a3f06,0x3f5f3efa3f808000,0x3d213f803f063f5a
.quad 0x800000008000,0x800000008000,0x800000008000,0x80008000,0x8000800000008000,0,0x8000800000008000,0x8000800000000000,0x8000,0x8000,0x8000,0x800080008000,0x8000,0x8000800000000000,0x8000,0
.quad 0x3e48bf7b3ee8bf64,0xbeb1bf70bda1bf7f,0x3f0e3f55bee83f64,0x3ed6bf683f7fbda1,0xbf7bbe483ee8bf64,0x3f70beb13da13f7f,0x3f55bf0ebee83f64,0x3f683ed6bf7f3da1,0xbe483f7b3ee8bf64,0x3eb13f70bda1bf7f,0xbf0ebf55bee83f64,0xbed63f683f7fbda1,0x3f7b3e483ee8bf64,0xbf703eb13da13f7f,0xbf553f0ebee83f64,0xbf68bed6bf7f3da1
.quad 0x800000008000,0x8000800080008000,0,0x800000008000,0x8000800000008000,0x800000000000,0x800000000000,0,0x8000,0x80008000,0x8000800000000000,0x8000,0x8000,0,0,0x8000800000000000
.quad 0x800000008000,0x800000008000,0x800000008000,0x80008000,0x8000800000008000,0,0x8000800000008000,0x8000800000000000,0x8000,0x8000,0x8000,0x800080008000,0x8000,0x8000800000000000,0x8000,0
.quad 0x3f76be903f808000,0x3f28bf413f58bf0a,0x3ef6bf613f808000,0xbf7f3d8dbf0abf58,0xbe90bf763f808000,0x3f413f28bf583f0a,0xbf61bef63f808000,0xbd8dbf7f3f0a3f58,0xbf763e903f808000,0xbf283f413f58bf0a,0xbef63f613f808000,0x3f7fbd8dbf0abf58,0x3e903f763f808000,0xbf41bf28bf583f0a,0x3f613ef63f808000,0x3d8d3f7f3f0a3f58
.quad 0x800000008000,0x8000800080008000,0,0x800000008000,0x8000800000008000,0x800000000000,0x800000000000,0,0x8000,0x80008000,0x8000800000000000,0x8000,0x8000,0,0,0x8000800000000000
.quad 0x3e16bf7d3ed6bf68,0xbed2bf6abe0cbf7e,0x3f183f4ebed63f68,0x3eb6bf6f3f7ebe0c,0xbf7dbe163ed6bf68,0x3f6abed23e0c3f7e,0x3f4ebf18bed63f68,0x3f6f3eb6bf7e3e0c,0xbe163f7d3ed6bf68,0x3ed23f6abe0cbf7e,0xbf18bf4ebed63f68,0xbeb63f6f3f7ebe0c,0x3f7d3e163ed6bf68,0xbf6a3ed23e0c3f7e,0xbf4e3f18bed63f68,0xbf6fbeb6bf7e3e0c
.quad 0x3e953f7500003f80,0x3f463f223f0e3f55,0x3f623ef100003f80,0xbdc9bf7f3f55bf0e,0x3f75be9500003f80,0xbf223f46bf0ebf55,0x3ef1bf6200003f80,0x3f7fbdc9bf553f0e,0xbe95bf7500003f80,0xbf46bf223f0e3f55,0xbf62bef100003f80,0x3dc93f7f3f55bf0e,0xbf753e9500003f80,0x3f22bf46bf0ebf55,0xbef13f6200003f80,0xbf7f3dc9bf553f0e
.quad 0,0,0,0x8000800000008000,0x800000000000,0x80008000,0x800000000000,0x800000000000,0x8000800000000000,0x8000800000000000,0x8000800000000000,0x8000,0,0x800080008000,0,0
.quad 0x3f7f3dc93f6d3ec4,0x3f62bef13f7bbe48,0xbf463f22bf6dbec4,0x3f753e953e483f7b,0x3dc9bf7f3f6d3ec4,0x3ef13f62bf7b3e48,0x3f223f46bf6dbec4,0xbe953f75be48bf7b,0xbf7fbdc93f6d3ec4,0xbf623ef13f7bbe48,0x3f46bf22bf6dbec4,0xbf75be953e483f7b,0xbdc93f7f3f6d3ec4,0xbef1bf62bf7b3e48,0xbf22bf46bf6dbec4,0x3e95bf75be48bf7b
.quad 0,0x800000008000,0x80008000,0,0x800000000000,0,0x80008000,0x80008000,0x8000800000000000,0x8000,0x800080008000,0x8000800000000000,0,0x8000800000000000,0x8000800080008000,0x800080008000
.quad 0,0,0,0x8000800000008000,0x800000000000,0x80008000,0x800000000000,0x800000000000,0x8000800000000000,0x8000800000000000,0x8000800000000000,0x8000,0,0x800080008000,0,0
.quad 0x3e993f7400003f80,0x3f4b3f1d3f123f52,0x3f633eed00003f80,0xbe02bf7e3f52bf12,0x3f74be9900003f80,0xbf1d3f4bbf12bf52,0x3eedbf6300003f80,0x3f7ebe02bf523f12,0xbe99bf7400003f80,0xbf4bbf1d3f123f52,0xbf63beed00003f80,0x3e023f7e3f52bf12,0xbf743e9900003f80,0x3f1dbf4bbf12bf52,0xbeed3f6300003f80,0xbf7e3e02bf523f12
.quad 0,0x800000008000,0x80008000,0,0x800000000000,0,0x80008000,0x80008000,0x8000800000000000,0x8000,0x800080008000,0x8000800000000000,0,0x8000800000000000,0x8000800080008000,0x800080008000
.quad 0x3f803d493f703eb1,0x3f59bf083f78be81,0xbf3e3f2cbf70beb1,0x3f7a3e653e813f78,0x3d49bf803f703eb1,0x3f083f59bf783e81,0x3f2c3f3ebf70beb1,0xbe653f7abe81bf78,0xbf80bd493f703eb1,0xbf593f083f78be81,0x3f3ebf2cbf70beb1,0xbf7abe653e813f78,0xbd493f803f703eb1,0xbf08bf59bf783e81,0xbf2cbf3ebf70beb1,0x3e65bf7abe81bf78
.quad 0x3f75be953f808000,0x3f22bf463f55bf0e,0x3ef1bf623f808000,0xbf7f3dc9bf0ebf55,0xbe95bf753f808000,0x3f463f22bf553f0e,0xbf62bef13f808000,0xbdc9bf7f3f0e3f55,0xbf753e953f808000,0xbf223f463f55bf0e,0xbef13f623f808000,0x3f7fbdc9bf0ebf55,0x3e953f753f808000,0xbf46bf22bf553f0e,0x3f623ef13f808000,0x3dc93f7f3f0e3f55
.quad 0x800000008000,0x800000008000,0x800000008000,0x80008000,0x8000800000008000,0,0x8000800000008000,0x8000800000000000,0x8000,0x8000,0x8000,0x800080008000,0x8000,0x8000800000000000,0x8000,0
.quad 0x3dc9bf7f3ec4bf6d,0xbef1bf62be48bf7b,0x3f223f46bec43f6d,0x3e95bf753f7bbe48,0xbf7fbdc93ec4bf6d,0x3f62bef13e483f7b,0x3f46bf22bec43f6d,0x3f753e95bf7b3e48,0xbdc93f7f3ec4bf6d,0x3ef13f62be48bf7b,0xbf22bf46bec43f6d,0xbe953f753f7bbe48,0x3f7f3dc93ec4bf6d,0xbf623ef13e483f7b,0xbf463f22bec43f6d,0xbf75be95bf7b3e48
.quad 0x800000008000,0x8000800080008000,0,0x800000008000,0x8000800000008000,0x800000000000,0x800000000000,0,0x8000,0x80008000,0x8000800000000000,0x8000,0x8000,0,0,0x8000800000000000
.quad 0x800000008000,0x800000008000,0x800000008000,0x80008000,0x8000800000008000,0,0x8000800000008000,0x8000800000000000,0x8000,0x8000,0x8000,0x800080008000,0x8000,0x8000800000000000,0x8000,0
.quad 0x3f74be993f808000,0x3f1dbf4b3f52bf12,0x3eedbf633f808000,0xbf7e3e02bf12bf52,0xbe99bf743f808000,0x3f4b3f1dbf523f12,0xbf63beed3f808000,0xbe02bf7e3f123f52,0xbf743e993f808000,0xbf1d3f4b3f52bf12,0xbeed3f633f808000,0x3f7ebe02bf12bf52,0x3e993f743f808000,0xbf4bbf1dbf523f12,0x3f633eed3f808000,0x3e023f7e3f123f52
.quad 0x800000008000,0x8000800080008000,0,0x800000008000,0x8000800000008000,0x800000000000,0x800000000000,0,0x8000,0x80008000,0x8000800000000000,0x8000,0x8000,0,0,0x8000800000000000
.quad 0x3d49bf803eb1bf70,0xbf08bf59be81bf78,0x3f2c3f3ebeb13f70,0x3e65bf7a3f78be81,0xbf80bd493eb1bf70,0x3f59bf083e813f78,0x3f3ebf2cbeb13f70,0x3f7a3e65bf783e81,0xbd493f803eb1bf70,0x3f083f59be81bf78,0xbf2cbf3ebeb13f70,0xbe653f7a3f78be81,0x3f803d493eb1bf70,0xbf593f083e813f78,0xbf3e3f2cbeb13f70,0xbf7abe65bf783e81
.quad 0x3e9e3f7300003f80,0x3f4f3f163f163f4f,0x3f643ee800003f80,0xbe20bf7d3f4fbf16,0x3f73be9e00003f80,0xbf163f4fbf16bf4f,0x3ee8bf6400003f80,0x3f7dbe20bf4f3f16,0xbe9ebf7300003f80,0xbf4fbf163f163f4f,0xbf64bee800003f80,0x3e203f7d3f4fbf16,0xbf733e9e00003f80,0x3f16bf4fbf16bf4f,0xbee83f6400003f80,0xbf7d3e20bf4f3f16
.quad 0,0,0,0x8000800000008000,0x800000000000,0x80008000,0x800000000000,0x800000000000,0x8000800000000000,0x8000800000000000,0x8000800000000000,0x8000,0,0x800080008000,0,0
.quad 0x3f8000003f733e9e,0x3f4fbf163f73be9e,0xbf353f35bf73be9e,0x3f7d3e203e9e3f73,0xbf803f733e9e,0x3f163f4fbf733e9e,0x3f353f35bf73be9e,0xbe203f7dbe9ebf73,0xbf8000003f733e9e,0xbf4f3f163f73be9e,0x3f35bf35bf73be9e,0xbf7dbe203e9e3f73,0x3f803f733e9e,0xbf16bf4fbf733e9e,0xbf35bf35bf73be9e,0x3e20bf7dbe9ebf73
.quad 0,0x800000008000,0x80008000,0,0x800000000000,0,0x80008000,0x80008000,0,0x8000,0x800080008000,0x8000800000000000,0,0x8000800000000000,0x8000800080008000,0x800080008000
.quad 0,0,0,0x8000800000008000,0x800000000000,0x80008000,0x800000000000,0x800000000000,0x8000800000000000,0x8000800000000000,0x8000800000000000,0x8000,0,0x800080008000,0,0
.quad 0x3ea33f7300003f80,0x3f533f103f1b3f4c,0x3f653ee400003f80,0xbe3ebf7c3f4cbf1b,0x3f73bea300003f80,0xbf103f53bf1bbf4c,0x3ee4bf6500003f80,0x3f7cbe3ebf4c3f1b,0xbea3bf7300003f80,0xbf53bf103f1b3f4c,0xbf65bee400003f80,0x3e3e3f7c3f4cbf1b,0xbf733ea300003f80,0x3f10bf53bf1bbf4c,0xbee43f6500003f80,0xbf7c3e3ebf4c3f1b
.quad 0x800000000000,0x800000008000,0x80008000,0,0x8000800000000000,0,0x80008000,0x80008000,0,0x8000,0x800080008000,0x8000800000000000,0,0x8000800000000000,0x8000800080008000,0x800080008000
.quad 0x3f80bd493f763e8b,0x3f44bf243f6ebebb,0xbf2c3f3ebf76be8b,0x3f7f3db53ebb3f6e,0xbd49bf803f763e8b,0x3f243f44bf6e3ebb,0x3f3e3f2cbf76be8b,0xbdb53f7fbebbbf6e,0xbf803d493f763e8b,0xbf443f243f6ebebb,0x3f2cbf3ebf76be8b,0xbf7fbdb53ebb3f6e,0x3d493f803f763e8b,0xbf24bf44bf6e3ebb,0xbf3ebf2cbf76be8b,0x3db5bf7fbebbbf6e
.quad 0x3f73be9e3f808000,0x3f16bf4f3f4fbf16,0x3ee8bf643f808000,0xbf7d3e20bf16bf4f,0xbe9ebf733f808000,0x3f4f3f16bf4f3f16,0xbf64bee83f808000,0xbe20bf7d3f163f4f,0xbf733e9e3f808000,0xbf163f4f3f4fbf16,0xbee83f643f808000,0x3f7dbe20bf16bf4f,0x3e9e3f733f808000,0xbf4fbf16bf4f3f16,0x3f643ee83f808000,0x3e203f7d3f163f4f
.quad 0x800000008000,0x800000008000,0x800000008000,0x80008000,0x8000800000008000,0,0x8000800000008000,0x8000800000000000,0x8000,0x8000,0x8000,0x800080008000,0x8000,0x8000800000000000,0x8000,0
.quad 0xbf803e9ebf73,0xbf16bf4fbe9ebf73,0x3f353f35be9e3f73,0x3e20bf7d3f73be9e,0xbf8080003e9ebf73,0x3f4fbf163e9e3f73,0x3f35bf35be9e3f73,0x3f7d3e20bf733e9e,0x3f803e9ebf73,0x3f163f4fbe9ebf73,0xbf35bf35be9e3f73,0xbe203f7d3f73be9e,0x3f8080003e9ebf73,0xbf4f3f163e9e3f73,0xbf353f35be9e3f73,0xbf7dbe20bf733e9e
.quad 0x800000008000,0x8000800080008000,0,0x800000008000,0x8000800000008000,0x800000000000,0x800000000000,0,0x8000,0x80008000,0x8000800000000000,0x8000,0x800000008000,0,0,0x8000800000000000
.quad 0x800000008000,0x800000008000,0x800000008000,0x80008000,0x8000800000008000,0,0x8000800000008000,0x8000800000000000,0x8000,0x8000,0x8000,0x800080008000,0x8000,0x8000800000000000,0x8000,0
.quad 0x3f73bea33f808000,0x3f10bf533f4cbf1b,0x3ee4bf653f808000,0xbf7c3e3ebf1bbf4c,0xbea3bf733f808000,0x3f533f10bf4c3f1b,0xbf65bee43f808000,0xbe3ebf7c3f1b3f4c,0xbf733ea33f808000,0xbf103f533f4cbf1b,0xbee43f653f808000,0x3f7cbe3ebf1bbf4c,0x3ea33f733f808000,0xbf53bf10bf4c3f1b,0x3f653ee43f808000,0x3e3e3f7c3f1b3f4c
.quad 0x8000800000008000,0x8000800080008000,0,0x800000008000,0x8000,0x800000000000,0x800000000000,0,0x8000,0x80008000,0x8000800000000000,0x8000,0x800000008000,0,0,0x8000800000000000
.quad 0xbd49bf803e8bbf76,0xbf24bf44bebbbf6e,0x3f3e3f2cbe8b3f76,0x3db5bf7f3f6ebebb,0xbf803d493e8bbf76,0x3f44bf243ebb3f6e,0x3f2cbf3ebe8b3f76,0x3f7f3db5bf6e3ebb,0x3d493f803e8bbf76,0x3f243f44bebbbf6e,0xbf3ebf2cbe8b3f76,0xbdb53f7f3f6ebebb,0x3f80bd493e8bbf76,0xbf443f243ebb3f6e,0xbf2c3f3ebe8b3f76,0xbf7fbdb5bf6e3ebb
.quad 0x3ea83f7200003f80,0x3f583f0a3f1e3f49,0x3f663edf00003f80,0xbe5bbf7a3f49bf1e,0x3f72bea800003f80,0xbf0a3f58bf1ebf49,0x3edfbf6600003f80,0x3f7abe5bbf493f1e,0xbea8bf7200003f80,0xbf58bf0a3f1e3f49,0xbf66bedf00003f80,0x3e5b3f7a3f49bf1e,0xbf723ea800003f80,0x3f0abf58bf1ebf49,0xbedf3f6600003f80,0xbf7a3e5bbf493f1e
.quad 0,0,0,0x8000800000008000,0x800000000000,0x80008000,0x800000000000,0x800000000000,0x8000800000000000,0x8000800000000000,0x8000800000000000,0x8000,0,0x800080008000,0,0
.quad 0x3f7fbdc93f793e6f,0x3f39bf313f68bed6,0xbf223f46bf79be6f,0x3f803ca13ed63f68,0xbdc9bf7f3f793e6f,0x3f313f39bf683ed6,0x3f463f22bf79be6f,0xbca13f80bed6bf68,0xbf7f3dc93f793e6f,0xbf393f313f68bed6,0x3f22bf46bf79be6f,0xbf80bca13ed63f68,0x3dc93f7f3f793e6f,0xbf31bf39bf683ed6,0xbf46bf22bf79be6f,0x3ca1bf80bed6bf68
.quad 0x800000000000,0x800000008000,0x80008000,0,0x8000800000000000,0,0x80008000,0x80008000,0,0x8000,0x800080008000,0x8000800000000000,0,0x8000800000000000,0x8000800080008000,0x800080008000
.quad 0,0,0,0x8000800000008000,0x800000000000,0x80008000,0x800000000000,0x800000000000,0x8000800000000000,0x8000800000000000,0x8000800000000000,0x8000,0,0x800080008000,0,0
.quad 0x3eac3f7100003f80,0x3f5c3f043f223f46,0x3f673edb00003f80,0xbe79bf783f46bf22,0x3f71beac00003f80,0xbf043f5cbf22bf46,0x3edbbf6700003f80,0x3f78be79bf463f22,0xbeacbf7100003f80,0xbf5cbf043f223f46,0xbf67bedb00003f80,0x3e793f783f46bf22,0xbf713eac00003f80,0x3f04bf5cbf22bf46,0xbedb3f6700003f80,0xbf783e79bf463f22
.quad 0x800000000000,0x800000008000,0x80008000,0x800000000000,0x8000800000000000,0,0x80008000,0x80008000,0,0x8000,0x800080008000,0,0,0x8000800000000000,0x8000800080008000,0x8000800080008000
.quad 0x3f7dbe163f7b3e48,0x3f2cbf3e3f62bef1,0xbf183f4ebf7bbe48,0x3f80bd493ef13f62,0xbe16bf7d3f7b3e48,0x3f3e3f2cbf623ef1,0x3f4e3f18bf7bbe48,0x3d493f80bef1bf62,0xbf7d3e163f7b3e48,0xbf2c3f3e3f62bef1,0x3f18bf4ebf7bbe48,0xbf803d493ef13f62,0x3e163f7d3f7b3e48,0xbf3ebf2cbf623ef1,0xbf4ebf18bf7bbe48,0xbd49bf80bef1bf62
.quad 0x3f72bea83f808000,0x3f0abf583f49bf1e,0x3edfbf663f808000,0xbf7a3e5bbf1ebf49,0xbea8bf723f808000,0x3f583f0abf493f1e,0xbf66bedf3f808000,0xbe5bbf7a3f1e3f49,0xbf723ea83f808000,0xbf0a3f583f49bf1e,0xbedf3f663f808000,0x3f7abe5bbf1ebf49,0x3ea83f723f808000,0xbf58bf0abf493f1e,0x3f663edf3f808000,0x3e5b3f7a3f1e3f49
.quad 0x800000008000,0x800000008000,0x800000008000,0x80008000,0x8000800000008000,0,0x8000800000008000,0x8000800000000000,0x8000,0x8000,0x8000,0x800080008000,0x8000,0x8000800000000000,0x8000,0
.quad 0xbdc9bf7f3e6fbf79,0xbf31bf39bed6bf68,0x3f463f22be6f3f79,0x3ca1bf803f68bed6,0xbf7f3dc93e6fbf79,0x3f39bf313ed63f68,0x3f22bf46be6f3f79,0x3f803ca1bf683ed6,0x3dc93f7f3e6fbf79,0x3f313f39bed6bf68,0xbf46bf22be6f3f79,0xbca13f803f68bed6,0x3f7fbdc93e6fbf79,0xbf393f313ed63f68,0xbf223f46be6f3f79,0xbf80bca1bf683ed6
.quad 0x8000800000008000,0x8000800080008000,0,0x800000008000,0x8000,0x800000000000,0x800000000000,0,0x8000,0x80008000,0x8000800000000000,0x8000,0x800000008000,0,0,0x8000800000000000
.quad 0x800000008000,0x800000008000,0x800000008000,0x80008000,0x8000800000008000,0,0x8000800000008000,0x8000800000000000,0x8000,0x8000,0x8000,0x800080008000,0x8000,0x8000800000000000,0x8000,0
.quad 0x3f71beac3f808000,0x3f04bf5c3f46bf22,0x3edbbf673f808000,0xbf783e79bf22bf46,0xbeacbf713f808000,0x3f5c3f04bf463f22,0xbf67bedb3f808000,0xbe79bf783f223f46,0xbf713eac3f808000,0xbf043f5c3f46bf22,0xbedb3f673f808000,0x3f78be79bf22bf46,0x3eac3f713f808000,0xbf5cbf04bf463f22,0x3f673edb3f808000,0x3e793f783f223f46
.quad 0x8000800000008000,0x8000800080008000,0,0x8000800000008000,0x8000,0x800000000000,0x800000000000,0x800000000000,0x8000,0x80008000,0x8000800000000000,0x8000,0x800000008000,0,0,0
.quad 0xbe16bf7d3e48bf7b,0xbf3ebf2cbef1bf62,0x3f4e3f18be483f7b,0xbd49bf803f62bef1,0xbf7d3e163e48bf7b,0x3f2cbf3e3ef13f62,0x3f18bf4ebe483f7b,0x3f80bd49bf623ef1,0x3e163f7d3e48bf7b,0x3f3e3f2cbef1bf62,0xbf4ebf18be483f7b,0x3d493f803f62bef1,0x3f7dbe163e48bf7b,0xbf2c3f3e3ef13f62,0xbf183f4ebe483f7b,0xbf803d49bf623ef1
.quad 0x3eb13f7000003f80,0x3f5f3efa3f263f43,0x3f683ed600003f80,0xbe8bbf763f43bf26,0x3f70beb100003f80,0xbefa3f5fbf26bf43,0x3ed6bf6800003f80,0x3f76be8bbf433f26,0xbeb1bf7000003f80,0xbf5fbefa3f263f43,0xbf68bed600003f80,0x3e8b3f763f43bf26,0xbf703eb100003f80,0x3efabf5fbf26bf43,0xbed63f6800003f80,0xbf763e8bbf433f26
.quad 0,0,0,0x8000800000008000,0x800000000000,0x80008000,0x800000000000,0x800000000000,0x8000800000000000,0x8000800000000000,0x8000800000000000,0x8000,0,0x800080008000,0,0
.quad 0x3f7bbe483f7d3e20,0x3f1ebf493f5abf06,0xbf0e3f55bf7dbe20,0x3f7ebdf13f063f5a,0xbe48bf7b3f7d3e20,0x3f493f1ebf5a3f06,0x3f553f0ebf7dbe20,0x3df13f7ebf06bf5a,0xbf7b3e483f7d3e20,0xbf1e3f493f5abf06,0x3f0ebf55bf7dbe20,0xbf7e3df13f063f5a,0x3e483f7b3f7d3e20,0xbf49bf1ebf5a3f06,0xbf55bf0ebf7dbe20,0xbdf1bf7ebf06bf5a
.quad 0x800000000000,0x800000008000,0x80008000,0x800000000000,0x8000800000000000,0,0x80008000,0x80008000,0,0x8000,0x800080008000,0,0,0x8000800000000000,0x8000800080008000,0x8000800080008000
.quad 0,0,0,0x8000800000008000,0x800000000000,0x80008000,0x800000000000,0x800000000000,0x8000800000000000,0x8000800000000000,0x8000800000000000,0x8000,0,0x800080008000,0,0
.quad 0x3eb63f6f00003f80,0x3f633eed3f2a3f3f,0x3f6a3ed200003f80,0xbe99bf743f3fbf2a,0x3f6fbeb600003f80,0xbeed3f63bf2abf3f,0x3ed2bf6a00003f80,0x3f74be99bf3f3f2a,0xbeb6bf6f00003f80,0xbf63beed3f2a3f3f,0xbf6abed200003f80,0x3e993f743f3fbf2a,0xbf6f3eb600003f80,0x3eedbf63bf2abf3f,0xbed23f6a00003f80,0xbf743e99bf3f3f2a
.quad 0x800000000000,0x800000008000,0x80008000,0x800000000000,0x8000800000000000,0,0x80008000,0x80008000,0,0x8000,0x800080008000,0,0,0x8000800000000000,0x8000800080008000,0x8000800080008000
.quad 0x3f78be793f7e3df1,0x3f10bf533f52bf12,0xbf043f5cbf7ebdf1,0x3f7cbe3e3f123f52,0xbe79bf783f7e3df1,0x3f533f10bf523f12,0x3f5c3f04bf7ebdf1,0x3e3e3f7cbf12bf52,0xbf783e793f7e3df1,0xbf103f533f52bf12,0x3f04bf5cbf7ebdf1,0xbf7c3e3e3f123f52,0x3e793f783f7e3df1,0xbf53bf10bf523f12,0xbf5cbf04bf7ebdf1,0xbe3ebf7cbf12bf52
.quad 0x3f70beb13f808000,0x3efabf5f3f43bf26,0x3ed6bf683f808000,0xbf763e8bbf26bf43,0xbeb1bf703f808000,0x3f5f3efabf433f26,0xbf68bed63f808000,0xbe8bbf763f263f43,0xbf703eb13f808000,0xbefa3f5f3f43bf26,0xbed63f683f808000,0x3f76be8bbf26bf43,0x3eb13f703f808000,0xbf5fbefabf433f26,0x3f683ed63f808000,0x3e8b3f763f263f43
.quad 0x800000008000,0x800000008000,0x800000008000,0x80008000,0x8000800000008000,0,0x8000800000008000,0x8000800000000000,0x8000,0x8000,0x8000,0x800080008000,0x8000,0x8000800000000000,0x8000,0
.quad 0xbe48bf7b3e20bf7d,0xbf49bf1ebf06bf5a,0x3f553f0ebe203f7d,0xbdf1bf7e3f5abf06,0xbf7b3e483e20bf7d,0x3f1ebf493f063f5a,0x3f0ebf55be203f7d,0x3f7ebdf1bf5a3f06,0x3e483f7b3e20bf7d,0x3f493f1ebf06bf5a,0xbf55bf0ebe203f7d,0x3df13f7e3f5abf06,0x3f7bbe483e20bf7d,0xbf1e3f493f063f5a,0xbf0e3f55be203f7d,0xbf7e3df1bf5a3f06
.quad 0x8000800000008000,0x8000800080008000,0,0x8000800000008000,0x8000,0x800000000000,0x800000000000,0x800000000000,0x8000,0x80008000,0x8000800000000000,0x8000,0x800000008000,0,0,0
.quad 0x800000008000,0x800000008000,0x800000008000,0x80008000,0x8000800000008000,0,0x8000800000008000,0x8000800000000000,0x8000,0x8000,0x8000,0x800080008000,0x8000,0x8000800000000000,0x8000,0
.quad 0x3f6fbeb63f808000,0x3eedbf633f3fbf2a,0x3ed2bf6a3f808000,0xbf743e99bf2abf3f,0xbeb6bf6f3f808000,0x3f633eedbf3f3f2a,0xbf6abed23f808000,0xbe99bf743f2a3f3f,0xbf6f3eb63f808000,0xbeed3f633f3fbf2a,0xbed23f6a3f808000,0x3f74be99bf2abf3f,0x3eb63f6f3f808000,0xbf63beedbf3f3f2a,0x3f6a3ed23f808000,0x3e993f743f2a3f3f
.quad 0x8000800000008000,0x8000800080008000,0,0x8000800000008000,0x8000,0x800000000000,0x800000000000,0x800000000000,0x8000,0x80008000,0x8000800000000000,0x8000,0x800000008000,0,0,0
.quad 0xbe79bf783df1bf7e,0xbf53bf10bf12bf52,0x3f5c3f04bdf13f7e,0xbe3ebf7c3f52bf12,0xbf783e793df1bf7e,0x3f10bf533f123f52,0x3f04bf5cbdf13f7e,0x3f7cbe3ebf523f12,0x3e793f783df1bf7e,0x3f533f10bf12bf52,0xbf5cbf04bdf13f7e,0x3e3e3f7c3f52bf12,0x3f78be793df1bf7e,0xbf103f533f123f52,0xbf043f5cbdf13f7e,0xbf7c3e3ebf523f12
.quad 0x3ebb3f6e00003f80,0x3f663edf3f2e3f3c,0x3f6b3ecd00003f80,0xbea8bf723f3cbf2e,0x3f6ebebb00003f80,0xbedf3f66bf2ebf3c,0x3ecdbf6b00003f80,0x3f72bea8bf3c3f2e,0xbebbbf6e00003f80,0xbf66bedf3f2e3f3c,0xbf6bbecd00003f80,0x3ea83f723f3cbf2e,0xbf6e3ebb00003f80,0x3edfbf66bf2ebf3c,0xbecd3f6b00003f80,0xbf723ea8bf3c3f2e
.quad 0,0,0,0x8000800000008000,0x800000000000,0x80008000,0x800000000000,0x800000000000,0x8000800000000000,0x8000800000000000,0x8000800000000000,0x8000,0,0x800080008000,0,0
.quad 0x3f75be953f7f3da1,0x3f01bf5d3f49bf1e,0xbef13f62bf7fbda1,0x3f78be813f1e3f49,0xbe95bf753f7f3da1,0x3f5d3f01bf493f1e,0x3f623ef1bf7fbda1,0x3e813f78bf1ebf49,0xbf753e953f7f3da1,0xbf013f5d3f49bf1e,0x3ef1bf62bf7fbda1,0xbf783e813f1e3f49,0x3e953f753f7f3da1,0xbf5dbf01bf493f1e,0xbf62bef1bf7fbda1,0xbe81bf78bf1ebf49
.quad 0x800000000000,0x800000008000,0x80008000,0x800000000000,0x8000800000000000,0,0x80008000,0x80008000,0,0x8000,0x800080008000,0,0,0x8000800000000000,0x8000800080008000,0x8000800080008000
.quad 0,0,0,0x8000800000008000,0x800000000000,0x80008000,0x800000000000,0x800000000000,0x8000800000000000,0x8000800000000000,0x8000800000000000,0x8000,0,0x800080008000,0,0
.quad 0x3ebf3f6d00003f80,0x3f6a3ed23f313f39,0x3f6c3ec900003f80,0xbeb6bf6f3f39bf31,0x3f6dbebf00003f80,0xbed23f6abf31bf39,0x3ec9bf6c00003f80,0x3f6fbeb6bf393f31,0xbebfbf6d00003f80,0xbf6abed23f313f39,0xbf6cbec900003f80,0x3eb63f6f3f39bf31,0xbf6d3ebf00003f80,0x3ed2bf6abf31bf39,0xbec93f6c00003f80,0xbf6f3eb6bf393f31
.quad 0x800000000000,0x800000008000,0x80008000,0x800000000000,0x8000800000000000,0,0x80008000,0x80008000,0,0x8000,0x800080008000,0,0,0x8000800000000000,0x8000800080008000,0x8000800080008000
.quad 0x3f71beac3f803d21,0x3ee4bf653f3fbf2a,0xbedb3f67bf80bd21,0x3f73bea33f2a3f3f,0xbeacbf713f803d21,0x3f653ee4bf3f3f2a,0x3f673edbbf80bd21,0x3ea33f73bf2abf3f,0xbf713eac3f803d21,0xbee43f653f3fbf2a,0x3edbbf67bf80bd21,0xbf733ea33f2a3f3f,0x3eac3f713f803d21,0xbf65bee4bf3f3f2a,0xbf67bedbbf80bd21,0xbea3bf73bf2abf3f
.quad 0x3f6ebebb3f808000,0x3edfbf663f3cbf2e,0x3ecdbf6b3f808000,0xbf723ea8bf2ebf3c,0xbebbbf6e3f808000,0x3f663edfbf3c3f2e,0xbf6bbecd3f808000,0xbea8bf723f2e3f3c,0xbf6e3ebb3f808000,0xbedf3f663f3cbf2e,0xbecd3f6b3f808000,0x3f72bea8bf2ebf3c,0x3ebb3f6e3f808000,0xbf66bedfbf3c3f2e,0x3f6b3ecd3f808000,0x3ea83f723f2e3f3c
.quad 0x800000008000,0x800000008000,0x800000008000,0x80008000,0x8000800000008000,0,0x8000800000008000,0x8000800000000000,0x8000,0x8000,0x8000,0x800080008000,0x8000,0x8000800000000000,0x8000,0
.quad 0xbe95bf753da1bf7f,0xbf5dbf01bf1ebf49,0x3f623ef1bda13f7f,0xbe81bf783f49bf1e,0xbf753e953da1bf7f,0x3f01bf5d3f1e3f49,0x3ef1bf62bda13f7f,0x3f78be81bf493f1e,0x3e953f753da1bf7f,0x3f5d3f01bf1ebf49,0xbf62bef1bda13f7f,0x3e813f783f49bf1e,0x3f75be953da1bf7f,0xbf013f5d3f1e3f49,0xbef13f62bda13f7f,0xbf783e81bf493f1e
.quad 0x8000800000008000,0x8000800080008000,0,0x8000800000008000,0x8000,0x800000000000,0x800000000000,0x800000000000,0x8000,0x80008000,0x8000800000000000,0x8000,0x800000008000,0,0,0
.quad 0x800000008000,0x800000008000,0x800000008000,0x80008000,0x8000800000008000,0,0x8000800000008000,0x8000800000000000,0x8000,0x8000,0x8000,0x800080008000,0x8000,0x8000800000000000,0x8000,0
.quad 0x3f6dbebf3f808000,0x3ed2bf6a3f39bf31,0x3ec9bf6c3f808000,0xbf6f3eb6bf31bf39,0xbebfbf6d3f808000,0x3f6a3ed2bf393f31,0xbf6cbec93f808000,0xbeb6bf6f3f313f39,0xbf6d3ebf3f808000,0xbed23f6a3f39bf31,0xbec93f6c3f808000,0x3f6fbeb6bf31bf39,0x3ebf3f6d3f808000,0xbf6abed2bf393f31,0x3f6c3ec93f808000,0x3eb63f6f3f313f39
.quad 0x8000800000008000,0x8000800080008000,0,0x8000800000008000,0x8000,0x800000000000,0x800000000000,0x800000000000,0x8000,0x80008000,0x8000800000000000,0x8000,0x800000008000,0,0,0
.quad 0xbeacbf713d21bf80,0xbf65bee4bf2abf3f,0x3f673edbbd213f80,0xbea3bf733f3fbf2a,0xbf713eac3d21bf80,0x3ee4bf653f2a3f3f,0x3edbbf67bd213f80,0x3f73bea3bf3f3f2a,0x3eac3f713d21bf80,0x3f653ee4bf2abf3f,0xbf67bedbbd213f80,0x3ea33f733f3fbf2a,0x3f71beac3d21bf80,0xbee43f653f2a3f3f,0xbedb3f67bd213f80,0xbf733ea3bf3f3f2a
.quad 0x3f803f803f803f80,0,0x3ec43f353f6d3f80,0x3f6d3f353ec40000,0xbf3500003f353f80,0x3f353f803f350000,0xbf6dbf353ec43f80,0xbec43f353f6d0000,0xbf8000003f80,0xbf8000003f800000,0x3f6dbf35bec43f80,0xbec4bf353f6d0000,0x3f350000bf353f80,0x3f35bf803f350000,0xbec43f35bf6d3f80,0x3f6dbf353ec40000
.quad 0xbf803f80bf803f80,0,0xbec43f35bf6d3f80,0xbf6d3f35bec40000,0x3f350000bf353f80,0xbf353f80bf350000,0x3f6dbf35bec43f80,0x3ec43f35bf6d0000,0xbf8000003f80,0x3f800000bf800000,0xbf6dbf353ec43f80,0x3ec4bf35bf6d0000,0xbf3500003f353f80,0xbf35bf80bf350000,0x3ec43f353f6d3f80,0xbf6dbf35bec40000
.quad 0x3f803f803f803f80,0,0xbf6dbf35bec40000,0x3ec43f353f6d3f80,0x3f350000bf35bf80,0xbf35bf80bf350000,0xbec43f353f6d0000,0x3f6d3f35bec4bf80,0xbf8000003f80,0xbf8000003f800000,0x3ec43f35bf6d0000,0x3f6dbf35bec43f80,0xbf3500003f35bf80,0xbf353f80bf350000,0x3f6dbf353ec40000,0x3ec4bf353f6dbf80
.quad 0xbf803f80bf803f80,0,0x3f6dbf353ec40000,0xbec43f35bf6d3f80,0xbf3500003f35bf80,0x3f35bf803f350000,0x3ec43f35bf6d0000,0xbf6d3f353ec4bf80,0xbf8000003f80,0x3f800000bf800000,0xbec43f353f6d0000,0xbf6dbf353ec43f80,0x3f350000bf35bf80,0x3f353f803f350000,0xbf6dbf35bec40000,0xbec4bf35bf6dbf80
.quad 0x3f803f803f803f80,0,0xbec4bf35bf6dbf80,0xbf6dbf35bec40000,0xbf3500003f353f80,0x3f353f803f350000,0x3f6d3f35bec4bf80,0x3ec4bf35bf6d0000,0xbf8000003f80,0xbf8000003f800000,0xbf6d3f353ec4bf80,0x3ec43f35bf6d0000,0x3f350000bf353f80,0x3f35bf803f350000,0x3ec4bf353f6dbf80,0xbf6d3f35bec40000
.quad 0xbf803f80bf803f80,0,0x3ec4bf353f6dbf80,0x3f6dbf353ec40000,0x3f350000bf353f80,0xbf353f80bf350000,0xbf6d3f353ec4bf80,0xbec4bf353f6d0000,0xbf8000003f80,0x3f800000bf800000,0x3f6d3f35bec4bf80,0xbec43f353f6d0000,0xbf3500003f353f80,0xbf35bf80bf350000,0xbec4bf35bf6dbf80,0x3f6d3f353ec40000
.quad 0x3f803f803f803f80,0,0x3f6d3f353ec40000,0xbec4bf35bf6dbf80,0x3f350000bf35bf80,0xbf35bf80bf350000,0x3ec4bf35bf6d0000,0xbf6dbf353ec43f80,0xbf8000003f80,0xbf8000003f800000,0xbec4bf353f6d0000,0xbf6d3f353ec4bf80,0xbf3500003f35bf80,0xbf353f80bf350000,0xbf6d3f35bec40000,0xbec43f35bf6d3f80
.quad 0xbf803f80bf803f80,0,0xbf6d3f35bec40000,0x3ec4bf353f6dbf80,0xbf3500003f35bf80,0x3f35bf803f350000,0xbec4bf353f6d0000,0x3f6dbf35bec43f80,0xbf8000003f80,0x3f800000bf800000,0x3ec4bf35bf6d0000,0x3f6d3f35bec4bf80,0x3f350000bf35bf80,0x3f353f803f350000,0x3f6d3f353ec40000,0x3ec43f353f6d3f80
.quad 0x3f7f3f803f803f80,0x3d973d493cc90000,0x3ea13f2c3f6a3f80,0x3f733f3e3ecf0000,0xbf42bd493f313f80,0x3f273f803f390000,0xbf65bf3e3eb83f80,0xbee63f2c3f6f0000,0x3d97bf80bcc93f80,0xbf7fbd493f800000,0x3f73bf2cbecf3f80,0xbea1bf3e3f6a0000,0x3f273d49bf393f80,0x3f42bf803f310000,0xbee63f3ebf6f3f80,0x3f65bf2c3eb80000
.quad 0xbf7f3f80bf803f80,0xbd973d49bcc90000,0xbea13f2cbf6a3f80,0xbf733f3ebecf0000,0x3f42bd49bf313f80,0xbf273f80bf390000,0x3f65bf3ebeb83f80,0x3ee63f2cbf6f0000,0xbd97bf803cc93f80,0x3f7fbd49bf800000,0xbf73bf2c3ecf3f80,0x3ea1bf3ebf6a0000,0xbf273d493f393f80,0xbf42bf80bf310000,0x3ee63f3e3f6f3f80,0xbf65bf2cbeb80000
.quad 0x3f7c3f7d3f7e3f7f,0x3e2f3e163dfb3dc9,0xbf7abf4ebefcbdc9,0x3e603f183f5f3f7f,0x3f513e16bf1dbf7f,0xbf13bf7dbf4abdc9,0xbf093f183f773dc9,0x3f583f4ebe89bf7f,0x3e2fbf7dbdfb3f7f,0xbf7cbe163f7e3dc9,0x3e603f4ebf5fbdc9,0x3f7abf18befc3f7f,0xbf13be163f4abf7f,0xbf513f7dbf1dbdc9,0x3f58bf183e893dc9,0x3f09bf4e3f77bf7f
.quad 0xbf7c3f7dbf7e3f7f,0xbe2f3e16bdfb3dc9,0x3f7abf4e3efcbdc9,0xbe603f18bf5f3f7f,0xbf513e163f1dbf7f,0x3f13bf7d3f4abdc9,0x3f093f18bf773dc9,0xbf583f4e3e89bf7f,0xbe2fbf7d3dfb3f7f,0x3f7cbe16bf7e3dc9,0xbe603f4e3f5fbdc9,0xbf7abf183efc3f7f,0x3f13be16bf4abf7f,0x3f513f7d3f1dbdc9,0xbf58bf18be893dc9,0xbf09bf4ebf77bf7f
.quad 0x3f773f783f7a3f7b,0x3e893e793e603e48,0xbdfbbf04bf51bf7b,0xbf7ebf5cbf13be48,0xbf5fbe793f093f7b,0x3efc3f783f583e48,0x3f4a3f5cbe2fbf7b,0x3f1dbf04bf7cbe48,0x3e89bf78be603f7b,0xbf77be793f7a3e48,0xbf7e3f043f13bf7b,0x3dfb3f5cbf51be48,0x3efc3e79bf583f7b,0x3f5fbf783f093e48,0x3f1dbf5c3f7cbf7b,0xbf4a3f04be2fbe48
.quad 0xbf773f78bf7a3f7b,0xbe893e79be603e48,0x3dfbbf043f51bf7b,0x3f7ebf5c3f13be48,0x3f5fbe79bf093f7b,0xbefc3f78bf583e48,0xbf4a3f5c3e2fbf7b,0xbf1dbf043f7cbe48,0xbe89bf783e603f7b,0x3f77be79bf7a3e48,0x3f7e3f04bf13bf7b,0xbdfb3f5c3f51be48,0xbefc3e793f583f7b,0xbf5fbf78bf093e48,0xbf1dbf5cbf7cbf7b,0x3f4a3f043e2fbe48
.quad 0x3f6f3f713f733f75,0x3eb83eac3ea13e95,0x3f803f673f273e95,0xbcc9bedbbf42bf75,0x3f6a3eacbee6bf75,0xbecfbf71bf65be95,0x3f31bedbbf7fbe95,0xbf39bf673d973f75,0x3eb8bf71bea13f75,0xbf6fbeac3f733e95,0xbcc9bf673f423e95,0xbf803edb3f27bf75,0xbecfbeac3f65bf75,0xbf6a3f71bee6be95,0xbf393edbbd97be95,0xbf313f67bf7f3f75
.quad 0xbf6f3f71bf733f75,0xbeb83eacbea13e95,0xbf803f67bf273e95,0x3cc9bedb3f42bf75,0xbf6a3eac3ee6bf75,0x3ecfbf713f65be95,0xbf31bedb3f7fbe95,0x3f39bf67bd973f75,0xbeb8bf713ea13f75,0x3f6fbeacbf733e95,0x3cc9bf67bf423e95,0x3f803edbbf27bf75,0x3ecfbeacbf65bf75,0x3f6a3f713ee6be95,0x3f393edb3d97be95,0x3f313f673f7f3f75
.quad 0x3f7d3f7f3f803f80,0x3e163dc93d490000,0x3e793f223f673f80,0x3f783f463edb0000,0xbf4ebdc93f2c3f80,0x3f183f7f3f3e0000,0xbf5cbf463eac3f80,0xbf043f223f710000,0x3e16bf7fbd493f80,0xbf7dbdc93f800000,0x3f78bf22bedb3f80,0xbe79bf463f670000,0x3f183dc9bf3e3f80,0x3f4ebf7f3f2c0000,0xbf043f46bf713f80,0x3f5cbf223eac0000
.quad 0xbf7d3f7fbf803f80,0xbe163dc9bd490000,0xbe793f22bf673f80,0xbf783f46bedb0000,0x3f4ebdc9bf2c3f80,0xbf183f7fbf3e0000,0x3f5cbf46beac3f80,0x3f043f22bf710000,0xbe16bf7f3d493f80,0x3f7dbdc9bf800000,0xbf78bf223edb3f80,0x3e79bf46bf670000,0xbf183dc93f3e3f80,0xbf4ebf7fbf2c0000,0x3f043f463f713f80,0xbf5cbf22beac0000
.quad 0x3f713f753f783f7b,0x3eac3e953e793e48,0xbf80bf62bf18be48,0x3d493ef13f4e3f7b,0x3f673e95bf04bf7b,0xbedbbf75bf5cbe48,0xbf2c3ef13f7d3e48,0x3f3e3f62be16bf7b,0x3eacbf75be793f7b,0xbf71be953f783e48,0x3d493f62bf4ebe48,0x3f80bef1bf183f7b,0xbedbbe953f5cbf7b,0xbf673f75bf04be48,0x3f3ebef13e163e48,0x3f2cbf623f7dbf7b
.quad 0xbf713f75bf783f7b,0xbeac3e95be793e48,0x3f80bf623f18be48,0xbd493ef1bf4e3f7b,0xbf673e953f04bf7b,0x3edbbf753f5cbe48,0x3f2c3ef1bf7d3e48,0xbf3e3f623e16bf7b,0xbeacbf753e793f7b,0x3f71be95bf783e48,0xbd493f623f4ebe48,0xbf80bef13f183f7b,0x3edbbe95bf5cbf7b,0x3f673f753f04be48,0xbf3ebef1be163e48,0xbf2cbf62bf7dbf7b
.quad 0x3f5c3f623f673f6d,0x3f043ef13edb3ec4,0x3e16be95bf2cbf6d,0xbf7dbf75bf3ebec4,0xbf78bef13eac3f6d,0x3e793f623f713ec4,0x3f183f753d49bf6d,0x3f4ebe95bf80bec4,0x3f04bf62bedb3f6d,0xbf5cbef13f673ec4,0xbf7d3e953f3ebf6d,0xbe163f75bf2cbec4,0x3e793ef1bf713f6d,0x3f78bf623eac3ec4,0x3f4ebf753f80bf6d,0xbf183e953d49bec4
.quad 0xbf5c3f62bf673f6d,0xbf043ef1bedb3ec4,0xbe16be953f2cbf6d,0x3f7dbf753f3ebec4,0x3f78bef1beac3f6d,0xbe793f62bf713ec4,0xbf183f75bd49bf6d,0xbf4ebe953f80bec4,0xbf04bf623edb3f6d,0x3f5cbef1bf673ec4,0x3f7d3e95bf3ebf6d,0x3e163f753f2cbec4,0xbe793ef13f713f6d,0xbf78bf62beac3ec4,0xbf4ebf75bf80bf6d,0x3f183e95bd49bec4
.quad 0x3f3e3f463f4e3f55,0x3f2c3f223f183f0e,0x3f713f7f3f5c3f0e,0x3eacbdc9bf04bf55,0x3f803f22be16bf55,0xbd49bf46bf7dbf0e,0x3f67bdc9bf78bf0e,0xbedbbf7fbe793f55,0x3f2cbf46bf183f55,0xbf3ebf223f4e3f0e,0x3eacbf7f3f043f0e,0xbf713dc93f5cbf55,0xbd49bf223f7dbf55,0xbf803f46be16bf0e,0xbedb3dc93e79bf0e,0xbf673f7fbf783f55
.quad 0xbf3e3f46bf4e3f55,0xbf2c3f22bf183f0e,0xbf713f7fbf5c3f0e,0xbeacbdc93f04bf55,0xbf803f223e16bf55,0x3d49bf463f7dbf0e,0xbf67bdc93f78bf0e,0x3edbbf7f3e793f55,0xbf2cbf463f183f55,0x3f3ebf22bf4e3f0e,0xbeacbf7fbf043f0e,0x3f713dc9bf5cbf55,0x3d49bf22bf7dbf55,0x3f803f463e16bf0e,0x3edb3dc9be79bf0e,0x3f673f7f3f783f55
.quad 0x3f7a3f7d3f7f3f80,0x3e603e163d970000,0x3e2f3f183f653f80,0x3f7c3f4e3ee60000,0xbf58be163f273f80,0x3f093f7d3f420000,0xbf51bf4e3ea13f80,0xbf133f183f730000,0x3e60bf7dbd973f80,0xbf7abe163f7f0000,0x3f7cbf18bee63f80,0xbe2fbf4e3f650000,0x3f093e16bf423f80,0x3f58bf7d3f270000,0xbf133f4ebf733f80,0x3f51bf183ea10000
.quad 0xbf7a3f7dbf7f3f80,0xbe603e16bd970000,0xbe2f3f18bf653f80,0xbf7c3f4ebee60000,0x3f58be16bf273f80,0xbf093f7dbf420000,0x3f51bf4ebea13f80,0x3f133f18bf730000,0xbe60bf7d3d973f80,0x3f7abe16bf7f0000,0xbf7cbf183ee63f80,0x3e2fbf4ebf650000,0xbf093e163f423f80,0xbf58bf7dbf270000,0x3f133f4e3f733f80,0xbf51bf18bea10000
.quad 0x3f5f3f673f6f3f75,0x3efc3edb3eb83e95,0xbf7ebf71bf31be95,0xbdfb3eac3f393f75,0x3f773edbbecfbf75,0xbe89bf67bf6abe95,0xbf4a3eac3f803e95,0x3f1d3f71bcc9bf75,0x3efcbf67beb83f75,0xbf5fbedb3f6f3e95,0xbdfb3f71bf39be95,0x3f7ebeacbf313f75,0xbe89bedb3f6abf75,0xbf773f67becfbe95,0x3f1dbeac3cc93e95,0x3f4abf713f80bf75
.quad 0xbf5f3f67bf6f3f75,0xbefc3edbbeb83e95,0x3f7ebf713f31be95,0x3dfb3eacbf393f75,0xbf773edb3ecfbf75,0x3e89bf673f6abe95,0x3f4a3eacbf803e95,0xbf1d3f713cc9bf75,0xbefcbf673eb83f75,0x3f5fbedbbf6f3e95,0x3dfb3f713f39be95,0xbf7ebeac3f313f75,0x3e89bedbbf6abf75,0x3f773f673ecfbe95,0xbf1dbeacbcc93e95,0xbf4abf71bf80bf75
.quad 0x3f313f3e3f4a3f55,0x3f393f2c3f1d3f0e,0x3ecfbd49befcbf55,0xbf6abf80bf5fbf0e,0xbf80bf2c3dfb3f55,0xbcc93f3e3f7e3f0e,0x3eb83f803e89bf55,0x3f6fbd49bf77bf0e,0x3f39bf3ebf1d3f55,0xbf31bf2c3f4a3f0e,0xbf6a3d493f5fbf55,0xbecf3f80befcbf0e,0xbcc93f2cbf7e3f55,0x3f80bf3e3dfb3f0e,0x3f6fbf803f77bf55,0xbeb83d493e89bf0e
.quad 0xbf313f3ebf4a3f55,0xbf393f2cbf1d3f0e,0xbecfbd493efcbf55,0x3f6abf803f5fbf0e,0x3f80bf2cbdfb3f55,0x3cc93f3ebf7e3f0e,0xbeb83f80be89bf55,0xbf6fbd493f77bf0e,0xbf39bf3e3f1d3f55,0x3f31bf2cbf4a3f0e,0x3f6a3d49bf5fbf55,0x3ecf3f803efcbf0e,0x3cc93f2c3f7e3f55,0xbf80bf3ebdfb3f0e,0xbf6fbf80bf77bf55,0x3eb83d49be89bf0e
.quad 0x3ee63f043f133f22,0x3f653f5c3f513f46,0x3f423f783f7a3f46,0x3f273e79be60bf22,0x3f733f5c3e2fbf22,0x3ea1bf04bf7cbf46,0x3f7f3e79bf58bf46,0xbd97bf78bf093f22,0x3f65bf04bf513f22,0xbee6bf5c3f133f46,0x3f27bf783e603f46,0xbf42be793f7abf22,0x3ea1bf5c3f7cbf22,0xbf733f043e2fbf46,0xbd97be793f09bf46,0xbf7f3f78bf583f22
.quad 0xbee63f04bf133f22,0xbf653f5cbf513f46,0xbf423f78bf7a3f46,0xbf273e793e60bf22,0xbf733f5cbe2fbf22,0xbea1bf043f7cbf46,0xbf7f3e793f58bf46,0x3d97bf783f093f22,0xbf65bf043f513f22,0x3ee6bf5cbf133f46,0xbf27bf78be603f46,0x3f42be79bf7abf22,0xbea1bf5cbf7cbf22,0x3f733f04be2fbf46,0x3d97be79bf09bf46,0x3f7f3f783f583f22
.quad 0x3f753f7b3f7f3f80,0x3e953e483dc90000,0x3dc93f0e3f623f80,0x3f7f3f553ef10000,0xbf62be483f223f80,0x3ef13f7b3f460000,0xbf46bf553e953f80,0xbf223f0e3f750000,0x3e95bf7bbdc93f80,0xbf75be483f7f0000,0x3f7fbf0ebef13f80,0xbdc9bf553f620000,0x3ef13e48bf463f80,0x3f62bf7b3f220000,0xbf223f55bf753f80,0x3f46bf0e3e950000
.quad 0xbf753f7bbf7f3f80,0xbe953e48bdc90000,0xbdc93f0ebf623f80,0xbf7f3f55bef10000,0x3f62be48bf223f80,0xbef13f7bbf460000,0x3f46bf55be953f80,0x3f223f0ebf750000,0xbe95bf7b3dc93f80,0x3f75be48bf7f0000,0xbf7fbf0e3ef13f80,0x3dc9bf55bf620000,0xbef13e483f463f80,0xbf62bf7bbf220000,0x3f223f553f753f80,0xbf46bf0ebe950000
.quad 0x3f463f553f623f6d,0x3f223f0e3ef13ec4,0xbf75bf7bbf46bec4,0xbe953e483f223f6d,0x3f7f3f0ebe95bf6d,0xbdc9bf55bf75bec4,0xbf623e483f7f3ec4,0x3ef13f7b3dc9bf6d,0x3f22bf55bef13f6d,0xbf46bf0e3f623ec4,0xbe953f7bbf22bec4,0x3f75be48bf463f6d,0xbdc9bf0e3f75bf6d,0xbf7f3f55be95bec4,0x3ef1be48bdc93ec4,0x3f62bf7b3f7fbf6d
.quad 0xbf463f55bf623f6d,0xbf223f0ebef13ec4,0x3f75bf7b3f46bec4,0x3e953e48bf223f6d,0xbf7f3f0e3e95bf6d,0x3dc9bf553f75bec4,0x3f623e48bf7f3ec4,0xbef13f7bbdc9bf6d,0xbf22bf553ef13f6d,0x3f46bf0ebf623ec4,0x3e953f7b3f22bec4,0xbf75be483f463f6d,0x3dc9bf0ebf75bf6d,0x3f7f3f553e95bec4,0xbef1be483dc93ec4,0xbf62bf7bbf7fbf6d
.quad 0x3ef13f0e3f223f35,0x3f623f553f463f35,0x3f223e48be95bf35,0xbf46bf7bbf75bf35,0xbf75bf55bdc93f35,0xbe953f0e3f7f3f35,0x3dc93f7b3ef1bf35,0x3f7f3e48bf62bf35,0x3f62bf0ebf463f35,0xbef1bf553f223f35,0xbf46be483f75bf35,0xbf223f7bbe95bf35,0xbe953f55bf7f3f35,0x3f75bf0ebdc93f35,0x3f7fbf7b3f62bf35,0xbdc9be483ef1bf35
.quad 0xbef13f0ebf223f35,0xbf623f55bf463f35,0xbf223e483e95bf35,0x3f46bf7b3f75bf35,0x3f75bf553dc93f35,0x3e953f0ebf7f3f35,0xbdc93f7bbef1bf35,0xbf7f3e483f62bf35,0xbf62bf0e3f463f35,0x3ef1bf55bf223f35,0x3f46be48bf75bf35,0x3f223f7b3e95bf35,0x3e953f553f7f3f35,0xbf75bf0e3dc93f35,0xbf7fbf7bbf62bf35,0x3dc9be48bef1bf35
.quad 0x3dc93e483e953ec4,0x3f7f3f7b3f753f6d,0x3ef13f553f7f3f6d,0x3f623f0e3dc9bec4,0x3f463f7b3ef1bec4,0x3f22be48bf62bf6d,0x3f753f0ebf22bf6d,0x3e95bf55bf463ec4,0x3f7fbe48bf753ec4,0xbdc9bf7b3e953f6d,0x3f62bf55bdc93f6d,0xbef1bf0e3f7fbec4,0x3f22bf7b3f62bec4,0xbf463e483ef1bf6d,0x3e95bf0e3f46bf6d,0xbf753f55bf223ec4
.quad 0xbdc93e48be953ec4,0xbf7f3f7bbf753f6d,0xbef13f55bf7f3f6d,0xbf623f0ebdc9bec4,0xbf463f7bbef1bec4,0xbf22be483f62bf6d,0xbf753f0e3f22bf6d,0xbe95bf553f463ec4,0xbf7fbe483f753ec4,0x3dc9bf7bbe953f6d,0xbf62bf553dc93f6d,0x3ef1bf0ebf7fbec4,0xbf22bf7bbf62bec4,0x3f463e48bef1bf6d,0xbe95bf0ebf46bf6d,0x3f753f553f223ec4
.quad 0x3f6f3f783f7e3f80,0x3eb83e793dfb0000,0x3cc93f043f5f3f80,0x3f803f5c3efc0000,0xbf6abe793f1d3f80,0x3ecf3f783f4a0000,0xbf39bf5c3e893f80,0xbf313f043f770000,0x3eb8bf78bdfb3f80,0xbf6fbe793f7e0000,0x3f80bf04befc3f80,0xbcc9bf5c3f5f0000,0x3ecf3e79bf4a3f80,0x3f6abf783f1d0000,0xbf313f5cbf773f80,0x3f39bf043e890000
.quad 0xbf6f3f78bf7e3f80,0xbeb83e79bdfb0000,0xbcc93f04bf5f3f80,0xbf803f5cbefc0000,0x3f6abe79bf1d3f80,0xbecf3f78bf4a0000,0x3f39bf5cbe893f80,0x3f313f04bf770000,0xbeb8bf783dfb3f80,0x3f6fbe79bf7e0000,0xbf80bf043efc3f80,0x3cc9bf5cbf5f0000,0xbecf3e793f4a3f80,0xbf6abf78bf1d0000,0x3f313f5c3f773f80,0xbf39bf04be890000
.quad 0x3f273f3e3f513f62,0x3f423f2c3f133ef1,0xbf65bf80bf58bef1,0xbee63d493f093f62,0x3f7f3f2cbe2fbf62,0x3d97bf3ebf7cbef1,0xbf733d493f7a3ef1,0x3ea13f803e60bf62,0x3f42bf3ebf133f62,0xbf27bf2c3f513ef1,0xbee63f80bf09bef1,0x3f65bd49bf583f62,0x3d97bf2c3f7cbf62,0xbf7f3f3ebe2fbef1,0x3ea1bd49be603ef1,0x3f73bf803f7abf62
.quad 0xbf273f3ebf513f62,0xbf423f2cbf133ef1,0x3f65bf803f58bef1,0x3ee63d49bf093f62,0xbf7f3f2c3e2fbf62,0xbd97bf3e3f7cbef1,0x3f733d49bf7a3ef1,0xbea13f80be60bf62,0xbf42bf3e3f133f62,0x3f27bf2cbf513ef1,0x3ee63f803f09bef1,0xbf65bd493f583f62,0xbd97bf2cbf7cbf62,0x3f7f3f3e3e2fbef1,0xbea1bd493e603ef1,0xbf73bf80bf7abf62
.quad 0x3e603eac3ee63f0e,0x3f7a3f713f653f55,0x3f513edbbd97bf0e,0xbf13bf67bf7fbf55,0xbf58bf71bea13f0e,0xbf093eac3f733f55,0xbe2f3f673f27bf0e,0x3f7c3edbbf42bf55,0x3f7abeacbf653f0e,0xbe60bf713ee63f55,0xbf13bedb3f7fbf0e,0xbf513f67bd97bf55,0xbf093f71bf733f0e,0x3f58beacbea13f55,0x3f7cbf673f42bf0e,0x3e2fbedb3f27bf55
.quad 0xbe603eacbee63f0e,0xbf7a3f71bf653f55,0xbf513edb3d97bf0e,0x3f13bf673f7fbf55,0x3f58bf713ea13f0e,0x3f093eacbf733f55,0x3e2f3f67bf27bf0e,0xbf7c3edb3f42bf55,0xbf7abeac3f653f0e,0x3e60bf71bee63f55,0x3f13bedbbf7fbf0e,0x3f513f673d97bf55,0x3f093f713f733f0e,0xbf58beac3ea13f55,0xbf7cbf67bf42bf0e,0xbe2fbedbbf27bf55
.quad 0xbe89be16bcc93dc9,0x3f773f7d3f803f7f,0x3dfb3f183f6a3f7f,0x3f7e3f4e3ecfbdc9,0x3efc3f7d3f39bdc9,0x3f5f3e16bf31bf7f,0x3f4a3f4ebeb8bf7f,0x3f1dbf18bf6f3dc9,0x3f773e16bf803dc9,0x3e89bf7dbcc93f7f,0x3f7ebf18becf3f7f,0xbdfbbf4e3f6abdc9,0x3f5fbf7d3f31bdc9,0xbefcbe163f39bf7f,0x3f1dbf4e3f6fbf7f,0xbf4a3f18beb83dc9
.quad 0x3e89be163cc93dc9,0xbf773f7dbf803f7f,0xbdfb3f18bf6a3f7f,0xbf7e3f4ebecfbdc9,0xbefc3f7dbf39bdc9,0xbf5f3e163f31bf7f,0xbf4a3f4e3eb8bf7f,0xbf1dbf183f6f3dc9,0xbf773e163f803dc9,0xbe89bf7d3cc93f7f,0xbf7ebf183ecf3f7f,0x3dfbbf4ebf6abdc9,0xbf5fbf7dbf31bdc9,0x3efcbe16bf39bf7f,0xbf1dbf4ebf6fbf7f,0x3f4a3f183eb83dc9
.quad 0x3f673f753f7d3f80,0x3edb3e953e160000,0xbd493ef13f5c3f80,0x3f803f623f040000,0xbf71be953f183f80,0x3eac3f753f4e0000,0xbf2cbf623e793f80,0xbf3e3ef13f780000,0x3edbbf75be163f80,0xbf67be953f7d0000,0x3f80bef1bf043f80,0x3d49bf623f5c0000,0x3eac3e95bf4e3f80,0x3f71bf753f180000,0xbf3e3f62bf783f80,0x3f2cbef13e790000
.quad 0xbf673f75bf7d3f80,0xbedb3e95be160000,0x3d493ef1bf5c3f80,0xbf803f62bf040000,0x3f71be95bf183f80,0xbeac3f75bf4e0000,0x3f2cbf62be793f80,0x3f3e3ef1bf780000,0xbedbbf753e163f80,0x3f67be95bf7d0000,0xbf80bef13f043f80,0xbd49bf62bf5c0000,0xbeac3e953f4e3f80,0xbf71bf75bf180000,0x3f3e3f623f783f80,0xbf2cbef1be790000
.quad 0x3f043f223f3e3f55,0x3f5c3f463f2c3f0e,0xbf4ebf7fbf67bf0e,0xbf18bdc93edb3f55,0x3f783f46bd49bf55,0x3e79bf22bf80bf0e,0xbf7dbdc93f713f0e,0x3e163f7f3eacbf55,0x3f5cbf22bf2c3f55,0xbf04bf463f3e3f0e,0xbf183f7fbedbbf0e,0x3f4e3dc9bf673f55,0x3e79bf463f80bf55,0xbf783f22bd49bf0e,0x3e163dc9beac3f0e,0x3f7dbf7f3f71bf55
.quad 0xbf043f22bf3e3f55,0xbf5c3f46bf2c3f0e,0x3f4ebf7f3f67bf0e,0x3f18bdc9bedb3f55,0xbf783f463d49bf55,0xbe79bf223f80bf0e,0x3f7dbdc9bf713f0e,0xbe163f7fbeacbf55,0xbf5cbf223f2c3f55,0x3f04bf46bf3e3f0e,0x3f183f7f3edbbf0e,0xbf4e3dc93f673f55,0xbe79bf46bf80bf55,0x3f783f223d49bf0e,0xbe163dc93eac3f0e,0xbf7dbf7fbf71bf55
.quad 0xbd493dc93e793ec4,0x3f803f7f3f783f6d,0x3f713f223e16bec4,0xbeacbf46bf7dbf6d,0xbf2cbf7fbf043ec4,0xbf3e3dc93f5c3f6d,0xbedb3f463f4ebec4,0x3f673f22bf18bf6d,0x3f80bdc9bf783ec4,0x3d49bf7f3e793f6d,0xbeacbf223f7dbec4,0xbf713f463e16bf6d,0xbf3e3f7fbf5c3ec4,0x3f2cbdc9bf043f6d,0x3f67bf463f18bec4,0x3edbbf223f4ebf6d
.quad 0x3d493dc9be793ec4,0xbf803f7fbf783f6d,0xbf713f22be16bec4,0x3eacbf463f7dbf6d,0x3f2cbf7f3f043ec4,0x3f3e3dc9bf5c3f6d,0x3edb3f46bf4ebec4,0xbf673f223f18bf6d,0xbf80bdc93f783ec4,0xbd49bf7fbe793f6d,0x3eacbf22bf7dbec4,0x3f713f46be16bf6d,0x3f3e3f7f3f5c3ec4,0xbf2cbdc93f043f6d,0xbf67bf46bf18bec4,0xbedbbf22bf4ebf6d
.quad 0xbf18bef1beacbe48,0x3f4e3f623f713f7b,0xbe793e953f3e3f7b,0x3f783f753f2c3e48,0x3e163f623f673e48,0x3f7d3ef1bedbbf7b,0x3f043f75bd49bf7b,0x3f5cbe95bf80be48,0x3f4e3ef1bf71be48,0x3f18bf62beac3f7b,0x3f78be95bf2c3f7b,0x3e79bf753f3e3e48,0x3f7dbf623edb3e48,0xbe16bef13f67bf7b,0x3f5cbf753f80bf7b,0xbf043e95bd49be48
.quad 0x3f18bef13eacbe48,0xbf4e3f62bf713f7b,0x3e793e95bf3e3f7b,0xbf783f75bf2c3e48,0xbe163f62bf673e48,0xbf7d3ef13edbbf7b,0xbf043f753d49bf7b,0xbf5cbe953f80be48,0xbf4e3ef13f71be48,0xbf18bf623eac3f7b,0xbf78be953f2c3f7b,0xbe79bf75bf3e3e48,0xbf7dbf62bedb3e48,0x3e16bef1bf67bf7b,0xbf5cbf75bf80bf7b,0x3f043e953d49be48
.quad 0x3f5f3f713f7c3f80,0x3efc3eac3e2f0000,0xbdfb3edb3f583f80,0x3f7e3f673f090000,0xbf77beac3f133f80,0x3e893f713f510000,0xbf1dbf673e603f80,0xbf4a3edb3f7a0000,0x3efcbf71be2f3f80,0xbf5fbeac3f7c0000,0x3f7ebedbbf093f80,0x3dfbbf673f580000,0x3e893eacbf513f80,0x3f77bf713f130000,0xbf4a3f67bf7a3f80,0x3f1dbedb3e600000
.quad 0xbf5f3f71bf7c3f80,0xbefc3eacbe2f0000,0x3dfb3edbbf583f80,0xbf7e3f67bf090000,0x3f77beacbf133f80,0xbe893f71bf510000,0x3f1dbf67be603f80,0x3f4a3edbbf7a0000,0xbefcbf713e2f3f80,0x3f5fbeacbf7c0000,0xbf7ebedb3f093f80,0xbdfbbf67bf580000,0xbe893eac3f513f80,0xbf77bf71bf130000,0x3f4a3f673f7a3f80,0xbf1dbedbbe600000
.quad 0x3eb83f043f273f46,0x3f6f3f5c3f423f22,0xbf31bf78bf73bf22,0xbf39be793ea13f46,0x3f6a3f5c3d97bf46,0x3ecfbf04bf7fbf22,0xbf80be793f653f22,0xbcc93f783ee6bf46,0x3f6fbf04bf423f46,0xbeb8bf5c3f273f22,0xbf393f78bea1bf22,0x3f313e79bf733f46,0x3ecfbf5c3f7fbf46,0xbf6a3f043d97bf22,0xbcc93e79bee63f22,0x3f80bf783f65bf46
.quad 0xbeb83f04bf273f46,0xbf6f3f5cbf423f22,0x3f31bf783f73bf22,0x3f39be79bea13f46,0xbf6a3f5cbd97bf46,0xbecfbf043f7fbf22,0x3f80be79bf653f22,0x3cc93f78bee6bf46,0xbf6fbf043f423f46,0x3eb8bf5cbf273f22,0x3f393f783ea1bf22,0xbf313e793f733f46,0xbecfbf5cbf7fbf46,0x3f6a3f04bd97bf22,0x3cc93e793ee63f22,0xbf80bf78bf65bf46
.quad 0xbea1be163cc93e48,0x3f733f7d3f803f7b,0x3f7f3f4e3eb8be48,0xbd97bf18bf6fbf7b,0xbee6bf7dbf313e48,0xbf65be163f393f7b,0xbf273f183f6abe48,0x3f423f4ebecfbf7b,0x3f733e16bf803e48,0x3ea1bf7d3cc93f7b,0xbd97bf4e3f6fbe48,0xbf7f3f183eb8bf7b,0xbf653f7dbf393e48,0x3ee63e16bf313f7b,0x3f42bf183ecfbe48,0x3f27bf4e3f6abf7b
.quad 0x3ea1be16bcc93e48,0xbf733f7dbf803f7b,0xbf7f3f4ebeb8be48,0x3d97bf183f6fbf7b,0x3ee6bf7d3f313e48,0x3f65be16bf393f7b,0x3f273f18bf6abe48,0xbf423f4e3ecfbf7b,0xbf733e163f803e48,0xbea1bf7dbcc93f7b,0x3d97bf4ebf6fbe48,0x3f7f3f18beb8bf7b,0x3f653f7d3f393e48,0xbee63e163f313f7b,0xbf42bf18becfbe48,0xbf27bf4ebf6abf7b
.quad 0xbf58bf3ebf1dbef1,0x3f093f2c3f4a3f62,0xbf13bd493efc3f62,0x3f513f803f5f3ef1,0xbe603f2c3f7e3ef1,0x3f7a3f3ebdfbbf62,0x3e2f3f803e89bf62,0x3f7c3d49bf77bef1,0x3f093f3ebf4abef1,0x3f58bf2cbf1d3f62,0x3f513d49bf5f3f62,0x3f13bf803efc3ef1,0x3f7abf2c3dfb3ef1,0x3e60bf3e3f7ebf62,0x3f7cbf803f77bf62,0xbe2fbd493e89bef1
.quad 0x3f58bf3e3f1dbef1,0xbf093f2cbf4a3f62,0x3f13bd49befc3f62,0xbf513f80bf5f3ef1,0x3e603f2cbf7e3ef1,0xbf7a3f3e3dfbbf62,0xbe2f3f80be89bf62,0xbf7c3d493f77bef1,0xbf093f3e3f4abef1,0xbf58bf2c3f1d3f62,0xbf513d493f5f3f62,0xbf13bf80befc3ef1,0xbf7abf2cbdfb3ef1,0xbe60bf3ebf7ebf62,0xbf7cbf80bf77bf62,0x3e2fbd49be89bef1
.quad 0x3f553f6d3f7b3f80,0x3f0e3ec43e480000,0xbe483ec43f553f80,0x3f7b3f6d3f0e0000,0xbf7bbec43f0e3f80,0x3e483f6d3f550000,0xbf0ebf6d3e483f80,0xbf553ec43f7b0000,0x3f0ebf6dbe483f80,0xbf55bec43f7b0000,0x3f7bbec4bf0e3f80,0x3e48bf6d3f550000,0x3e483ec4bf553f80,0x3f7bbf6d3f0e0000,0xbf553f6dbf7b3f80,0x3f0ebec43e480000
.quad 0xbf553f6dbf7b3f80,0xbf0e3ec4be480000,0x3e483ec4bf553f80,0xbf7b3f6dbf0e0000,0x3f7bbec4bf0e3f80,0xbe483f6dbf550000,0x3f0ebf6dbe483f80,0x3f553ec4bf7b0000,0xbf0ebf6d3e483f80,0x3f55bec4bf7b0000,0xbf7bbec43f0e3f80,0xbe48bf6dbf550000,0xbe483ec43f553f80,0xbf7bbf6dbf0e0000,0x3f553f6d3f7b3f80,0xbf0ebec4be480000
.quad 0x3e483ec43f0e3f35,0x3f7b3f6d3f553f35,0xbf0ebf6dbf7bbf35,0xbf55bec43e483f35,0x3f553f6d3e48bf35,0x3f0ebec4bf7bbf35,0xbf7bbec43f553f35,0xbe483f6d3f0ebf35,0x3f7bbec4bf553f35,0xbe48bf6d3f0e3f35,0xbf553f6dbe48bf35,0x3f0e3ec4bf7b3f35,0x3f0ebf6d3f7bbf35,0xbf553ec43e48bf35,0xbe483ec4bf0e3f35,0x3f7bbf6d3f55bf35
.quad 0xbe483ec4bf0e3f35,0xbf7b3f6dbf553f35,0x3f0ebf6d3f7bbf35,0x3f55bec4be483f35,0xbf553f6dbe48bf35,0xbf0ebec43f7bbf35,0x3f7bbec4bf553f35,0x3e483f6dbf0ebf35,0xbf7bbec43f553f35,0x3e48bf6dbf0e3f35,0x3f553f6d3e48bf35,0xbf0e3ec43f7b3f35,0xbf0ebf6dbf7bbf35,0x3f553ec4be48bf35,0x3e483ec43f0e3f35,0xbf7bbf6dbf55bf35
.quad 0xbf0ebec4be480000,0x3f553f6d3f7b3f80,0x3f7b3f6d3f0e0000,0x3e48bec4bf55bf80,0xbe48bf6dbf550000,0xbf7bbec43f0e3f80,0xbf553ec43f7b0000,0x3f0e3f6dbe48bf80,0x3f553ec4bf7b0000,0x3f0ebf6dbe483f80,0x3e48bf6d3f550000,0xbf7b3ec43f0ebf80,0xbf7b3f6dbf0e0000,0x3e483ec4bf553f80,0x3f0ebec43e480000,0x3f55bf6d3f7bbf80
.quad 0x3f0ebec43e480000,0xbf553f6dbf7b3f80,0xbf7b3f6dbf0e0000,0xbe48bec43f55bf80,0x3e48bf6d3f550000,0x3f7bbec4bf0e3f80,0x3f553ec4bf7b0000,0xbf0e3f6d3e48bf80,0xbf553ec43f7b0000,0xbf0ebf6d3e483f80,0xbe48bf6dbf550000,0x3f7b3ec4bf0ebf80,0x3f7b3f6d3f0e0000,0xbe483ec43f553f80,0xbf0ebec4be480000,0xbf55bf6dbf7bbf80
.quad 0xbf7bbf6dbf55bf35,0x3e483ec43f0e3f35,0xbf55bec43e483f35,0x3f0e3f6d3f7b3f35,0xbf0e3ec43f7b3f35,0x3f553f6d3e48bf35,0xbe483f6d3f0ebf35,0x3f7b3ec4bf55bf35,0x3e483f6dbf0ebf35,0x3f7bbec4bf553f35,0x3f0e3ec4bf7b3f35,0x3f55bf6d3e483f35,0x3f55bec4be483f35,0x3f0ebf6d3f7bbf35,0x3f7bbf6d3f55bf35,0x3e48bec43f0ebf35
.quad 0x3f7bbf6d3f55bf35,0xbe483ec4bf0e3f35,0x3f55bec4be483f35,0xbf0e3f6dbf7b3f35,0x3f0e3ec4bf7b3f35,0xbf553f6dbe48bf35,0x3e483f6dbf0ebf35,0xbf7b3ec43f55bf35,0xbe483f6d3f0ebf35,0xbf7bbec43f553f35,0xbf0e3ec43f7b3f35,0xbf55bf6dbe483f35,0xbf55bec43e483f35,0xbf0ebf6dbf7bbf35,0xbf7bbf6dbf55bf35,0xbe48bec4bf0ebf35
.quad 0x3f4a3f673f7a3f80,0x3f1d3edb3e600000,0xbe893eac3f513f80,0x3f773f713f130000,0xbf7ebedb3f093f80,0x3dfb3f673f580000,0xbefcbf713e2f3f80,0xbf5f3eac3f7c0000,0x3f1dbf67be603f80,0xbf4abedb3f7a0000,0x3f77beacbf133f80,0x3e89bf713f510000,0x3dfb3edbbf583f80,0x3f7ebf673f090000,0xbf5f3f71bf7c3f80,0x3efcbeac3e2f0000
.quad 0xbf4a3f67bf7a3f80,0xbf1d3edbbe600000,0x3e893eacbf513f80,0xbf773f71bf130000,0x3f7ebedbbf093f80,0xbdfb3f67bf580000,0x3efcbf71be2f3f80,0x3f5f3eacbf7c0000,0xbf1dbf673e603f80,0x3f4abedbbf7a0000,0xbf77beac3f133f80,0xbe89bf71bf510000,0xbdfb3edb3f583f80,0xbf7ebf67bf090000,0x3f5f3f713f7c3f80,0xbefcbeacbe2f0000
.quad 0x3cc93e793ee63f22,0x3f803f783f653f46,0xbecfbf5cbf7fbf46,0xbf6abf043d973f22,0x3f393f783ea1bf22,0x3f31be79bf73bf46,0xbf6fbf043f423f46,0xbeb83f5c3f27bf22,0x3f80be79bf653f22,0xbcc9bf783ee63f46,0xbf6a3f5cbd97bf46,0x3ecf3f04bf7f3f22,0x3f31bf783f73bf22,0xbf393e793ea1bf46,0xbeb83f04bf273f46,0x3f6fbf5c3f42bf22
.quad 0xbcc93e79bee63f22,0xbf803f78bf653f46,0x3ecfbf5c3f7fbf46,0x3f6abf04bd973f22,0xbf393f78bea1bf22,0xbf31be793f73bf46,0x3f6fbf04bf423f46,0x3eb83f5cbf27bf22,0xbf80be793f653f22,0x3cc9bf78bee63f46,0x3f6a3f5c3d97bf46,0xbecf3f043f7f3f22,0xbf31bf78bf73bf22,0x3f393e79bea1bf46,0x3eb83f043f273f46,0xbf6fbf5cbf42bf22
.quad 0xbf42bf18becfbe48,0x3f273f4e3f6a3f7b,0x3f653f7d3f393e48,0x3ee6be16bf31bf7b,0x3d97bf4ebf6fbe48,0xbf7fbf183eb83f7b,0xbf733e163f803e48,0x3ea13f7d3cc9bf7b,0x3f273f18bf6abe48,0x3f42bf4ebecf3f7b,0x3ee6bf7d3f313e48,0xbf653e163f39bf7b,0xbf7f3f4ebeb8be48,0xbd973f18bf6f3f7b,0x3ea1be16bcc93e48,0x3f73bf7d3f80bf7b
.quad 0x3f42bf183ecfbe48,0xbf273f4ebf6a3f7b,0xbf653f7dbf393e48,0xbee6be163f31bf7b,0xbd97bf4e3f6fbe48,0x3f7fbf18beb83f7b,0x3f733e16bf803e48,0xbea13f7dbcc9bf7b,0xbf273f183f6abe48,0xbf42bf4e3ecf3f7b,0xbee6bf7dbf313e48,0x3f653e16bf39bf7b,0x3f7f3f4e3eb8be48,0x3d973f183f6f3f7b,0xbea1be163cc93e48,0xbf73bf7dbf80bf7b
.quad 0xbf7cbf80bf77bf62,0xbe2f3d493e893ef1,0xbf7abf2cbdfb3ef1,0x3e603f3e3f7e3f62,0xbf513d493f5f3f62,0x3f133f803efcbef1,0xbf093f3e3f4abef1,0x3f583f2cbf1dbf62,0xbe2f3f80be89bf62,0x3f7cbd49bf773ef1,0x3e603f2cbf7e3ef1,0x3f7abf3ebdfb3f62,0x3f13bd49befc3f62,0x3f51bf803f5fbef1,0x3f58bf3e3f1dbef1,0x3f09bf2c3f4abf62
.quad 0x3f7cbf803f77bf62,0x3e2f3d49be893ef1,0x3f7abf2c3dfb3ef1,0xbe603f3ebf7e3f62,0x3f513d49bf5f3f62,0xbf133f80befcbef1,0x3f093f3ebf4abef1,0xbf583f2c3f1dbf62,0x3e2f3f803e89bf62,0xbf7cbd493f773ef1,0xbe603f2c3f7e3ef1,0xbf7abf3e3dfb3f62,0xbf13bd493efc3f62,0xbf51bf80bf5fbef1,0xbf58bf3ebf1dbef1,0xbf09bf2cbf4abf62
.quad 0x3f3e3f623f783f80,0x3f2c3ef13e790000,0xbeac3e953f4e3f80,0x3f713f753f180000,0xbf80bef13f043f80,0x3d493f623f5c0000,0xbedbbf753e163f80,0xbf673e953f7d0000,0x3f2cbf62be793f80,0xbf3ebef13f780000,0x3f71be95bf183f80,0x3eacbf753f4e0000,0x3d493ef1bf5c3f80,0x3f80bf623f040000,0xbf673f75bf7d3f80,0x3edbbe953e160000
.quad 0xbf3e3f62bf783f80,0xbf2c3ef1be790000,0x3eac3e95bf4e3f80,0xbf713f75bf180000,0x3f80bef1bf043f80,0xbd493f62bf5c0000,0x3edbbf75be163f80,0x3f673e95bf7d0000,0xbf2cbf623e793f80,0x3f3ebef1bf780000,0xbf71be953f183f80,0xbeacbf75bf4e0000,0xbd493ef13f5c3f80,0xbf80bf62bf040000,0x3f673f753f7d3f80,0xbedbbe95be160000
.quad 0xbe163dc93eac3f0e,0x3f7d3f7f3f713f55,0xbe79bf46bf80bf55,0xbf78bf22bd493f0e,0x3f183f7f3edbbf0e,0x3f4ebdc9bf67bf55,0xbf5cbf223f2c3f55,0xbf043f463f3ebf0e,0x3f7dbdc9bf713f0e,0x3e16bf7f3eac3f55,0xbf783f463d49bf55,0x3e793f22bf803f0e,0x3f4ebf7f3f67bf0e,0xbf183dc93edbbf55,0xbf043f22bf3e3f55,0x3f5cbf463f2cbf0e
.quad 0x3e163dc9beac3f0e,0xbf7d3f7fbf713f55,0x3e79bf463f80bf55,0x3f78bf223d493f0e,0xbf183f7fbedbbf0e,0xbf4ebdc93f67bf55,0x3f5cbf22bf2c3f55,0x3f043f46bf3ebf0e,0xbf7dbdc93f713f0e,0xbe16bf7fbeac3f55,0x3f783f46bd49bf55,0xbe793f223f803f0e,0xbf4ebf7fbf67bf0e,0x3f183dc9bedbbf55,0x3f043f223f3e3f55,0xbf5cbf46bf2cbf0e
.quad 0xbf67bf46bf18bec4,0x3edb3f223f4e3f6d,0x3f3e3f7f3f5c3ec4,0x3f2c3dc9bf04bf6d,0x3eacbf22bf7dbec4,0xbf71bf463e163f6d,0xbf80bdc93f783ec4,0x3d493f7f3e79bf6d,0x3edb3f46bf4ebec4,0x3f67bf22bf183f6d,0x3f2cbf7f3f043ec4,0xbf3ebdc93f5cbf6d,0xbf713f22be16bec4,0xbeac3f46bf7d3f6d,0x3d493dc9be793ec4,0x3f80bf7f3f78bf6d
.quad 0x3f67bf463f18bec4,0xbedb3f22bf4e3f6d,0xbf3e3f7fbf5c3ec4,0xbf2c3dc93f04bf6d,0xbeacbf223f7dbec4,0x3f71bf46be163f6d,0x3f80bdc9bf783ec4,0xbd493f7fbe79bf6d,0xbedb3f463f4ebec4,0xbf67bf223f183f6d,0xbf2cbf7fbf043ec4,0x3f3ebdc9bf5cbf6d,0x3f713f223e16bec4,0x3eac3f463f7d3f6d,0xbd493dc93e793ec4,0xbf80bf7fbf78bf6d
.quad 0xbf5cbf75bf80bf7b,0xbf04be95bd493e48,0xbf7dbf62bedb3e48,0xbe163ef13f673f7b,0xbf78be953f2c3f7b,0x3e793f753f3ebe48,0xbf4e3ef13f71be48,0x3f183f62beacbf7b,0xbf043f753d49bf7b,0x3f5c3e95bf803e48,0xbe163f62bf673e48,0x3f7dbef1bedb3f7b,0x3e793e95bf3e3f7b,0x3f78bf753f2cbe48,0x3f18bef13eacbe48,0x3f4ebf623f71bf7b
.quad 0x3f5cbf753f80bf7b,0x3f04be953d493e48,0x3f7dbf623edb3e48,0x3e163ef1bf673f7b,0x3f78be95bf2c3f7b,0xbe793f75bf3ebe48,0x3f4e3ef1bf71be48,0xbf183f623eacbf7b,0x3f043f75bd49bf7b,0xbf5c3e953f803e48,0x3e163f623f673e48,0xbf7dbef13edb3f7b,0xbe793e953f3e3f7b,0xbf78bf75bf2cbe48,0xbf18bef1beacbe48,0xbf4ebf62bf71bf7b
.quad 0x3f313f5c3f773f80,0x3f393f043e890000,0xbecf3e793f4a3f80,0x3f6a3f783f1d0000,0xbf80bf043efc3f80,0xbcc93f5c3f5f0000,0xbeb8bf783dfb3f80,0xbf6f3e793f7e0000,0x3f39bf5cbe893f80,0xbf31bf043f770000,0x3f6abe79bf1d3f80,0x3ecfbf783f4a0000,0xbcc93f04bf5f3f80,0x3f80bf5c3efc0000,0xbf6f3f78bf7e3f80,0x3eb8be793dfb0000
.quad 0xbf313f5cbf773f80,0xbf393f04be890000,0x3ecf3e79bf4a3f80,0xbf6a3f78bf1d0000,0x3f80bf04befc3f80,0x3cc93f5cbf5f0000,0x3eb8bf78bdfb3f80,0x3f6f3e79bf7e0000,0xbf39bf5c3e893f80,0x3f31bf04bf770000,0xbf6abe793f1d3f80,0xbecfbf78bf4a0000,0x3cc93f043f5f3f80,0xbf80bf5cbefc0000,0x3f6f3f783f7e3f80,0xbeb8be79bdfb0000
.quad 0xbea1bd493e603ef1,0x3f733f803f7a3f62,0xbd97bf2cbf7cbf62,0xbf7fbf3ebe2f3ef1,0x3ee63f803f09bef1,0x3f653d49bf58bf62,0xbf42bf3e3f133f62,0xbf273f2c3f51bef1,0x3f733d49bf7a3ef1,0x3ea1bf803e603f62,0xbf7f3f2c3e2fbf62,0x3d973f3ebf7c3ef1,0x3f65bf803f58bef1,0xbee6bd493f09bf62,0xbf273f3ebf513f62,0x3f42bf2c3f13bef1
.quad 0x3ea1bd49be603ef1,0xbf733f80bf7a3f62,0x3d97bf2c3f7cbf62,0x3f7fbf3e3e2f3ef1,0xbee63f80bf09bef1,0xbf653d493f58bf62,0x3f42bf3ebf133f62,0x3f273f2cbf51bef1,0xbf733d493f7a3ef1,0xbea1bf80be603f62,0x3f7f3f2cbe2fbf62,0xbd973f3e3f7c3ef1,0xbf65bf80bf58bef1,0x3ee6bd49bf09bf62,0x3f273f3e3f513f62,0xbf42bf2cbf13bef1
.quad 0xbf7cbf67bf42bf0e,0x3e2f3edb3f273f55,0x3f093f713f733f0e,0x3f583eacbea1bf55,0x3f13bedbbf7fbf0e,0xbf51bf67bd973f55,0xbf7abeac3f653f0e,0xbe603f713ee6bf55,0x3e2f3f67bf27bf0e,0x3f7cbedbbf423f55,0x3f58bf713ea13f0e,0xbf09beac3f73bf55,0xbf513edb3d97bf0e,0xbf133f67bf7f3f55,0xbe603eacbee63f0e,0x3f7abf713f65bf55
.quad 0x3f7cbf673f42bf0e,0xbe2f3edbbf273f55,0xbf093f71bf733f0e,0xbf583eac3ea1bf55,0xbf13bedb3f7fbf0e,0x3f51bf673d973f55,0x3f7abeacbf653f0e,0x3e603f71bee6bf55,0xbe2f3f673f27bf0e,0xbf7cbedb3f423f55,0xbf58bf71bea13f0e,0x3f09beacbf73bf55,0x3f513edbbd97bf0e,0x3f133f673f7f3f55,0x3e603eac3ee63f0e,0xbf7abf71bf65bf55
.quad 0xbf1dbf4ebf6fbf7f,0xbf4abf18beb8bdc9,0xbf5fbf7dbf31bdc9,0xbefc3e163f393f7f,0xbf7ebf183ecf3f7f,0xbdfb3f4e3f6a3dc9,0xbf773e163f803dc9,0x3e893f7dbcc9bf7f,0xbf4a3f4e3eb8bf7f,0x3f1d3f18bf6fbdc9,0xbefc3f7dbf39bdc9,0x3f5fbe16bf313f7f,0xbdfb3f18bf6a3f7f,0x3f7ebf4e3ecf3dc9,0x3e89be163cc93dc9,0x3f77bf7d3f80bf7f
.quad 0x3f1dbf4e3f6fbf7f,0x3f4abf183eb8bdc9,0x3f5fbf7d3f31bdc9,0x3efc3e16bf393f7f,0x3f7ebf18becf3f7f,0x3dfb3f4ebf6a3dc9,0x3f773e16bf803dc9,0xbe893f7d3cc9bf7f,0x3f4a3f4ebeb8bf7f,0xbf1d3f183f6fbdc9,0x3efc3f7d3f39bdc9,0xbf5fbe163f313f7f,0x3dfb3f183f6a3f7f,0xbf7ebf4ebecf3dc9,0xbe89be16bcc93dc9,0xbf77bf7dbf80bf7f
.quad 0x3f223f553f753f80,0x3f463f0e3e950000,0xbef13e483f463f80,0x3f623f7b3f220000,0xbf7fbf0e3ef13f80,0xbdc93f553f620000,0xbe95bf7b3dc93f80,0xbf753e483f7f0000,0x3f46bf55be953f80,0xbf22bf0e3f750000,0x3f62be48bf223f80,0x3ef1bf7b3f460000,0xbdc93f0ebf623f80,0x3f7fbf553ef10000,0xbf753f7bbf7f3f80,0x3e95be483dc90000
.quad 0xbf223f55bf753f80,0xbf463f0ebe950000,0x3ef13e48bf463f80,0xbf623f7bbf220000,0x3f7fbf0ebef13f80,0x3dc93f55bf620000,0x3e95bf7bbdc93f80,0x3f753e48bf7f0000,0xbf46bf553e953f80,0x3f22bf0ebf750000,0xbf62be483f223f80,0xbef1bf7bbf460000,0x3dc93f0e3f623f80,0xbf7fbf55bef10000,0x3f753f7b3f7f3f80,0xbe95be48bdc90000
.quad 0xbef1be483dc93ec4,0x3f623f7b3f7f3f6d,0x3dc9bf0ebf75bf6d,0xbf7fbf55be953ec4,0x3e953f7b3f22bec4,0x3f753e48bf46bf6d,0xbf22bf553ef13f6d,0xbf463f0e3f62bec4,0x3f623e48bf7f3ec4,0x3ef1bf7b3dc93f6d,0xbf7f3f0e3e95bf6d,0xbdc93f55bf753ec4,0x3f75bf7b3f46bec4,0xbe95be483f22bf6d,0xbf463f55bf623f6d,0x3f22bf0e3ef1bec4
.quad 0x3ef1be48bdc93ec4,0xbf623f7bbf7f3f6d,0xbdc9bf0e3f75bf6d,0x3f7fbf553e953ec4,0xbe953f7bbf22bec4,0xbf753e483f46bf6d,0x3f22bf55bef13f6d,0x3f463f0ebf62bec4,0xbf623e483f7f3ec4,0xbef1bf7bbdc93f6d,0x3f7f3f0ebe95bf6d,0x3dc93f553f753ec4,0xbf75bf7bbf46bec4,0x3e95be48bf22bf6d,0x3f463f553f623f6d,0xbf22bf0ebef1bec4
.quad 0xbf7fbf7bbf62bf35,0xbdc93e483ef13f35,0x3e953f553f7f3f35,0x3f753f0ebdc9bf35,0x3f46be48bf75bf35,0xbf22bf7bbe953f35,0xbf62bf0e3f463f35,0xbef13f553f22bf35,0xbdc93f7bbef1bf35,0x3f7fbe48bf623f35,0x3f75bf553dc93f35,0xbe95bf0e3f7fbf35,0xbf223e483e95bf35,0xbf463f7bbf753f35,0xbef13f0ebf223f35,0x3f62bf553f46bf35
.quad 0x3f7fbf7b3f62bf35,0x3dc93e48bef13f35,0xbe953f55bf7f3f35,0xbf753f0e3dc9bf35,0xbf46be483f75bf35,0x3f22bf7b3e953f35,0x3f62bf0ebf463f35,0x3ef13f55bf22bf35,0x3dc93f7b3ef1bf35,0xbf7fbe483f623f35,0xbf75bf55bdc93f35,0x3e95bf0ebf7fbf35,0x3f223e48be95bf35,0x3f463f7b3f753f35,0x3ef13f0e3f223f35,0xbf62bf55bf46bf35
.quad 0xbe95bf0ebf46bf6d,0xbf75bf55bf22bec4,0xbf22bf7bbf62bec4,0xbf46be483ef13f6d,0xbf62bf553dc93f6d,0xbef13f0e3f7f3ec4,0xbf7fbe483f753ec4,0xbdc93f7b3e95bf6d,0xbf753f0e3f22bf6d,0x3e953f55bf46bec4,0xbf463f7bbef1bec4,0x3f223e48bf623f6d,0xbef13f55bf7f3f6d,0x3f62bf0e3dc93ec4,0xbdc93e48be953ec4,0x3f7fbf7b3f75bf6d
.quad 0x3e95bf0e3f46bf6d,0x3f75bf553f22bec4,0x3f22bf7b3f62bec4,0x3f46be48bef13f6d,0x3f62bf55bdc93f6d,0x3ef13f0ebf7f3ec4,0x3f7fbe48bf753ec4,0x3dc93f7bbe95bf6d,0x3f753f0ebf22bf6d,0xbe953f553f46bec4,0x3f463f7b3ef1bec4,0xbf223e483f623f6d,0x3ef13f553f7f3f6d,0xbf62bf0ebdc93ec4,0x3dc93e483e953ec4,0xbf7fbf7bbf75bf6d
.quad 0x3f133f4e3f733f80,0x3f513f183ea10000,0xbf093e163f423f80,0x3f583f7d3f270000,0xbf7cbf183ee63f80,0xbe2f3f4e3f650000,0xbe60bf7d3d973f80,0xbf7a3e163f7f0000,0x3f51bf4ebea13f80,0xbf13bf183f730000,0x3f58be16bf273f80,0x3f09bf7d3f420000,0xbe2f3f18bf653f80,0x3f7cbf4e3ee60000,0xbf7a3f7dbf7f3f80,0x3e60be163d970000
.quad 0xbf133f4ebf733f80,0xbf513f18bea10000,0x3f093e16bf423f80,0xbf583f7dbf270000,0x3f7cbf18bee63f80,0x3e2f3f4ebf650000,0x3e60bf7dbd973f80,0x3f7a3e16bf7f0000,0xbf51bf4e3ea13f80,0x3f13bf18bf730000,0xbf58be163f273f80,0xbf09bf7dbf420000,0x3e2f3f183f653f80,0xbf7cbf4ebee60000,0x3f7a3f7d3f7f3f80,0xbe60be16bd970000
.quad 0xbf1dbeacbcc93e95,0x3f4a3f713f803f75,0x3e89bedbbf6abf75,0xbf77bf67becf3e95,0x3dfb3f713f39be95,0x3f7e3eacbf31bf75,0xbefcbf673eb83f75,0xbf5f3edb3f6fbe95,0x3f4a3eacbf803e95,0x3f1dbf71bcc93f75,0xbf773edb3ecfbf75,0xbe893f67bf6a3e95,0x3f7ebf713f31be95,0xbdfbbeac3f39bf75,0xbf5f3f67bf6f3f75,0x3efcbedb3eb8be95
.quad 0x3f1dbeac3cc93e95,0xbf4a3f71bf803f75,0xbe89bedb3f6abf75,0x3f77bf673ecf3e95,0xbdfb3f71bf39be95,0xbf7e3eac3f31bf75,0x3efcbf67beb83f75,0x3f5f3edbbf6fbe95,0xbf4a3eac3f803e95,0xbf1dbf713cc93f75,0x3f773edbbecfbf75,0x3e893f673f6a3e95,0xbf7ebf71bf31be95,0x3dfbbeacbf39bf75,0x3f5f3f673f6f3f75,0xbefcbedbbeb8be95
.quad 0xbf6fbf80bf77bf55,0xbeb8bd493e893f0e,0x3cc93f2c3f7e3f55,0x3f803f3e3dfbbf0e,0x3f6a3d49bf5fbf55,0xbecfbf80befc3f0e,0xbf39bf3e3f1d3f55,0xbf313f2c3f4abf0e,0xbeb83f80be89bf55,0x3f6f3d49bf773f0e,0x3f80bf2cbdfb3f55,0xbcc9bf3e3f7ebf0e,0xbecfbd493efcbf55,0xbf6a3f80bf5f3f0e,0xbf313f3ebf4a3f55,0x3f39bf2c3f1dbf0e
.quad 0x3f6fbf803f77bf55,0x3eb8bd49be893f0e,0xbcc93f2cbf7e3f55,0xbf803f3ebdfbbf0e,0xbf6a3d493f5fbf55,0x3ecfbf803efc3f0e,0x3f39bf3ebf1d3f55,0x3f313f2cbf4abf0e,0x3eb83f803e89bf55,0xbf6f3d493f773f0e,0xbf80bf2c3dfb3f55,0x3cc9bf3ebf7ebf0e,0x3ecfbd49befcbf55,0x3f6a3f803f5f3f0e,0x3f313f3e3f4a3f55,0xbf39bf2cbf1dbf0e
.quad 0x3d97be79bf09bf46,0xbf7fbf78bf58bf22,0xbea1bf5cbf7cbf22,0xbf73bf043e2f3f46,0xbf27bf78be603f46,0xbf423e793f7a3f22,0xbf65bf043f513f22,0xbee63f5c3f13bf46,0xbf7f3e793f58bf46,0xbd973f78bf09bf22,0xbf733f5cbe2fbf22,0x3ea13f04bf7c3f46,0xbf423f78bf7a3f46,0x3f27be79be603f22,0xbee63f04bf133f22,0x3f65bf5c3f51bf46
.quad 0xbd97be793f09bf46,0x3f7fbf783f58bf22,0x3ea1bf5c3f7cbf22,0x3f73bf04be2f3f46,0x3f27bf783e603f46,0x3f423e79bf7a3f22,0x3f65bf04bf513f22,0x3ee63f5cbf13bf46,0x3f7f3e79bf58bf46,0x3d973f783f09bf22,0x3f733f5c3e2fbf22,0xbea13f043f7c3f46,0x3f423f783f7a3f46,0xbf27be793e603f22,0x3ee63f043f133f22,0xbf65bf5cbf51bf46
.quad 0x3f043f463f713f80,0x3f5c3f223eac0000,0xbf183dc93f3e3f80,0x3f4e3f7f3f2c0000,0xbf78bf223edb3f80,0xbe793f463f670000,0xbe16bf7f3d493f80,0xbf7d3dc93f800000,0x3f5cbf46beac3f80,0xbf04bf223f710000,0x3f4ebdc9bf2c3f80,0x3f18bf7f3f3e0000,0xbe793f22bf673f80,0x3f78bf463edb0000,0xbf7d3f7fbf803f80,0x3e16bdc93d490000
.quad 0xbf043f46bf713f80,0xbf5c3f22beac0000,0x3f183dc9bf3e3f80,0xbf4e3f7fbf2c0000,0x3f78bf22bedb3f80,0x3e793f46bf670000,0x3e16bf7fbd493f80,0x3f7d3dc9bf800000,0xbf5cbf463eac3f80,0x3f04bf22bf710000,0xbf4ebdc93f2c3f80,0xbf18bf7fbf3e0000,0x3e793f223f673f80,0xbf78bf46bedb0000,0x3f7d3f7f3f803f80,0xbe16bdc9bd490000
.quad 0xbf3ebef1be163e48,0x3f2c3f623f7d3f7b,0x3edbbe95bf5cbf7b,0xbf67bf75bf043e48,0xbd493f623f4ebe48,0x3f803ef1bf18bf7b,0xbeacbf753e793f7b,0xbf713e953f78be48,0x3f2c3ef1bf7d3e48,0x3f3ebf62be163f7b,0xbf673e953f04bf7b,0xbedb3f75bf5c3e48,0x3f80bf623f18be48,0x3d49bef13f4ebf7b,0xbf713f75bf783f7b,0x3eacbe953e79be48
.quad 0x3f3ebef13e163e48,0xbf2c3f62bf7d3f7b,0xbedbbe953f5cbf7b,0x3f67bf753f043e48,0x3d493f62bf4ebe48,0xbf803ef13f18bf7b,0x3eacbf75be793f7b,0x3f713e95bf78be48,0xbf2c3ef13f7d3e48,0xbf3ebf623e163f7b,0x3f673e95bf04bf7b,0x3edb3f753f5c3e48,0xbf80bf62bf18be48,0xbd49bef1bf4ebf7b,0x3f713f753f783f7b,0xbeacbe95be79be48
.quad 0xbf4ebf75bf80bf6d,0xbf18be953d493ec4,0xbe793ef13f713f6d,0x3f783f623eacbec4,0x3f7d3e95bf3ebf6d,0xbe16bf75bf2c3ec4,0xbf04bf623edb3f6d,0xbf5c3ef13f67bec4,0xbf183f75bd49bf6d,0x3f4e3e95bf803ec4,0x3f78bef1beac3f6d,0x3e79bf623f71bec4,0xbe16be953f2cbf6d,0xbf7d3f75bf3e3ec4,0xbf5c3f62bf673f6d,0x3f04bef13edbbec4
.quad 0x3f4ebf753f80bf6d,0x3f18be95bd493ec4,0x3e793ef1bf713f6d,0xbf783f62beacbec4,0xbf7d3e953f3ebf6d,0x3e16bf753f2c3ec4,0x3f04bf62bedb3f6d,0x3f5c3ef1bf67bec4,0x3f183f753d49bf6d,0xbf4e3e953f803ec4,0xbf78bef13eac3f6d,0xbe79bf62bf71bec4,0x3e16be95bf2cbf6d,0x3f7d3f753f3e3ec4,0x3f5c3f623f673f6d,0xbf04bef1bedbbec4
.quad 0x3edb3dc9be79bf0e,0xbf67bf7fbf78bf55,0x3d49bf22bf7dbf55,0xbf80bf46be163f0e,0xbeacbf7fbf043f0e,0xbf71bdc93f5c3f55,0xbf2cbf463f183f55,0xbf3e3f223f4ebf0e,0xbf67bdc93f78bf0e,0xbedb3f7fbe79bf55,0xbf803f223e16bf55,0xbd493f46bf7d3f0e,0xbf713f7fbf5c3f0e,0x3eac3dc9bf043f55,0xbf3e3f46bf4e3f55,0x3f2cbf223f18bf0e
.quad 0xbedb3dc93e79bf0e,0x3f67bf7f3f78bf55,0xbd49bf223f7dbf55,0x3f80bf463e163f0e,0x3eacbf7f3f043f0e,0x3f71bdc9bf5c3f55,0x3f2cbf46bf183f55,0x3f3e3f22bf4ebf0e,0x3f67bdc9bf78bf0e,0x3edb3f7f3e79bf55,0x3f803f22be16bf55,0x3d493f463f7d3f0e,0x3f713f7f3f5c3f0e,0xbeac3dc93f043f55,0x3f3e3f463f4e3f55,0xbf2cbf22bf18bf0e
.quad 0x3ee63f3e3f6f3f80,0x3f653f2c3eb80000,0xbf273d493f393f80,0x3f423f803f310000,0xbf73bf2c3ecf3f80,0xbea13f3e3f6a0000,0xbd97bf803cc93f80,0xbf7f3d493f800000,0x3f65bf3ebeb83f80,0xbee6bf2c3f6f0000,0x3f42bd49bf313f80,0x3f27bf803f390000,0xbea13f2cbf6a3f80,0x3f73bf3e3ecf0000,0xbf7f3f80bf803f80,0x3d97bd493cc90000
.quad 0xbee63f3ebf6f3f80,0xbf653f2cbeb80000,0x3f273d49bf393f80,0xbf423f80bf310000,0x3f73bf2cbecf3f80,0x3ea13f3ebf6a0000,0x3d97bf80bcc93f80,0x3f7f3d49bf800000,0xbf65bf3e3eb83f80,0x3ee6bf2cbf6f0000,0xbf42bd493f313f80,0xbf27bf80bf390000,0x3ea13f2c3f6a3f80,0xbf73bf3ebecf0000,0x3f7f3f803f803f80,0xbd97bd49bcc90000
.quad 0xbf58bf18be893dc9,0x3f093f4e3f773f7f,0x3f13be16bf4abf7f,0xbf51bf7dbf1d3dc9,0xbe603f4e3f5fbdc9,0x3f7a3f18befcbf7f,0xbe2fbf7d3dfb3f7f,0xbf7c3e163f7ebdc9,0x3f093f18bf773dc9,0x3f58bf4ebe893f7f,0xbf513e163f1dbf7f,0xbf133f7dbf4a3dc9,0x3f7abf4e3efcbdc9,0x3e60bf183f5fbf7f,0xbf7c3f7dbf7e3f7f,0x3e2fbe163dfbbdc9
.quad 0x3f58bf183e893dc9,0xbf093f4ebf773f7f,0xbf13be163f4abf7f,0x3f51bf7d3f1d3dc9,0x3e603f4ebf5fbdc9,0xbf7a3f183efcbf7f,0x3e2fbf7dbdfb3f7f,0x3f7c3e16bf7ebdc9,0xbf093f183f773dc9,0xbf58bf4e3e893f7f,0x3f513e16bf1dbf7f,0x3f133f7d3f4a3dc9,0xbf7abf4ebefcbdc9,0xbe60bf18bf5fbf7f,0x3f7c3f7d3f7e3f7f,0xbe2fbe16bdfbbdc9
.quad 0xbf1dbf5cbf7cbf7b,0xbf4abf04be2f3e48,0xbefc3e793f583f7b,0x3f5f3f783f09be48,0x3f7e3f04bf13bf7b,0x3dfbbf5cbf513e48,0xbe89bf783e603f7b,0xbf773e793f7abe48,0xbf4a3f5c3e2fbf7b,0x3f1d3f04bf7c3e48,0x3f5fbe79bf093f7b,0x3efcbf783f58be48,0x3dfbbf043f51bf7b,0xbf7e3f5cbf133e48,0xbf773f78bf7a3f7b,0x3e89be793e60be48
.quad 0x3f1dbf5c3f7cbf7b,0x3f4abf043e2f3e48,0x3efc3e79bf583f7b,0xbf5f3f78bf09be48,0xbf7e3f043f13bf7b,0xbdfbbf5c3f513e48,0x3e89bf78be603f7b,0x3f773e79bf7abe48,0x3f4a3f5cbe2fbf7b,0xbf1d3f043f7c3e48,0xbf5fbe793f093f7b,0xbefcbf78bf58be48,0xbdfbbf04bf51bf7b,0x3f7e3f5c3f133e48,0x3f773f783f7a3f7b,0xbe89be79be60be48
.quad 0x3f393edb3d97be95,0xbf31bf67bf7fbf75,0x3ecfbeacbf65bf75,0xbf6abf71bee63e95,0x3cc9bf67bf423e95,0xbf80bedb3f273f75,0xbeb8bf713ea13f75,0xbf6f3eac3f73be95,0xbf31bedb3f7fbe95,0xbf393f673d97bf75,0xbf6a3eac3ee6bf75,0xbecf3f71bf653e95,0xbf803f67bf273e95,0xbcc93edbbf423f75,0xbf6f3f71bf733f75,0x3eb8beac3ea1be95
.quad 0xbf393edbbd97be95,0x3f31bf673f7fbf75,0xbecfbeac3f65bf75,0x3f6abf713ee63e95,0xbcc9bf673f423e95,0x3f80bedbbf273f75,0x3eb8bf71bea13f75,0x3f6f3eacbf73be95,0x3f31bedbbf7fbe95,0x3f393f67bd97bf75,0x3f6a3eacbee6bf75,0x3ecf3f713f653e95,0x3f803f673f273e95,0x3cc93edb3f423f75,0x3f6f3f713f733f75,0xbeb8beacbea1be95
.quad 0x3f803f803f803f80,0,0x3eac3f2c3f673f80,0x3f713f3e3edb3d49,0xbf46bdc93f223f7f,0x3f223f7f3f463dc9,0xbf5cbf4e3e793f7d,0xbf043f183f783e16,0x3e48bf7bbe483f7b,0xbf7bbe483f7b3e48,0x3f7dbf04bf183f78,0xbe16bf5c3f4e3e79,0x3ef13e95bf623f75,0x3f62bf753ef13e95,0xbf2c3f67bf803f71,0x3f3ebedb3d493eac
.quad 0xbf6d3f6dbf6d3f6d,0xbec43ec4bec43ec4,0x3d493eacbf2c3f67,0xbf803f71bf3e3edb,0x3f75bef1be953f62,0xbe953f62bf753ef1,0x3f18bf783e163f5c,0x3f4e3e79bf7d3f04,0xbf0ebf553f0e3f55,0x3f55bf0ebf553f0e,0xbf78be163f5c3f4e,0xbe79bf7dbf043f18,0xbdc93f223f7f3f46,0xbf7fbf46bdc93f22,0x3f673f803f713f3e,0xbedbbd493eac3f2c
.quad 0x3f803f803f803f80,0,0xbf71bf3ebedbbd49,0x3eac3f2c3f673f80,0x3f463dc9bf22bf7f,0xbf22bf7fbf46bdc9,0xbf043f183f783e16,0x3f5c3f4ebe79bf7d,0x3e48bf7bbe483f7b,0xbf7bbe483f7b3e48,0x3e163f5cbf4ebe79,0x3f7dbf04bf183f78,0xbef1be953f62bf75,0xbf623f75bef1be95,0x3f3ebedb3d493eac,0x3f2cbf673f80bf71
.quad 0xbf6d3f6dbf6d3f6d,0xbec43ec4bec43ec4,0x3f80bf713f3ebedb,0x3d493eacbf2c3f67,0xbf753ef13e95bf62,0x3e95bf623f75bef1,0x3f4e3e79bf7d3f04,0xbf183f78be16bf5c,0xbf0ebf553f0e3f55,0x3f55bf0ebf553f0e,0x3e793f7d3f04bf18,0xbf78be163f5c3f4e,0x3dc9bf22bf7fbf46,0x3f7f3f463dc9bf22,0xbedbbd493eac3f2c,0xbf67bf80bf71bf3e
.quad 0x3f803f803f803f80,0,0xbeacbf2cbf67bf80,0xbf71bf3ebedbbd49,0xbf46bdc93f223f7f,0x3f223f7f3f463dc9,0x3f5c3f4ebe79bf7d,0x3f04bf18bf78be16,0x3e48bf7bbe483f7b,0xbf7bbe483f7b3e48,0xbf7d3f043f18bf78,0x3e163f5cbf4ebe79,0x3ef13e95bf623f75,0x3f62bf753ef13e95,0x3f2cbf673f80bf71,0xbf3e3edbbd49beac
.quad 0xbf6d3f6dbf6d3f6d,0xbec43ec4bec43ec4,0xbd49beac3f2cbf67,0x3f80bf713f3ebedb,0x3f75bef1be953f62,0xbe953f62bf753ef1,0xbf183f78be16bf5c,0xbf4ebe793f7dbf04,0xbf0ebf553f0e3f55,0x3f55bf0ebf553f0e,0x3f783e16bf5cbf4e,0x3e793f7d3f04bf18,0xbdc93f223f7f3f46,0xbf7fbf46bdc93f22,0xbf67bf80bf71bf3e,0x3edb3d49beacbf2c
.quad 0x3f803f803f803f80,0,0x3f713f3e3edb3d49,0xbeacbf2cbf67bf80,0x3f463dc9bf22bf7f,0xbf22bf7fbf46bdc9,0x3f04bf18bf78be16,0xbf5cbf4e3e793f7d,0x3e48bf7bbe483f7b,0xbf7bbe483f7b3e48,0xbe16bf5c3f4e3e79,0xbf7d3f043f18bf78,0xbef1be953f62bf75,0xbf623f75bef1be95,0xbf3e3edbbd49beac,0xbf2c3f67bf803f71
.quad 0xbf6d3f6dbf6d3f6d,0xbec43ec4bec43ec4,0xbf803f71bf3e3edb,0xbd49beac3f2cbf67,0xbf753ef13e95bf62,0x3e95bf623f75bef1,0xbf4ebe793f7dbf04,0x3f18bf783e163f5c,0xbf0ebf553f0e3f55,0x3f55bf0ebf553f0e,0xbe79bf7dbf043f18,0x3f783e16bf5cbf4e,0x3dc9bf22bf7fbf46,0x3f7f3f463dc9bf22,0x3edb3d49beacbf2c,0x3f673f803f713f3e
.quad 0x3f7f3f803f803f80,0x3d9d3d563ce23b49,0x3e873f223f643f80,0x3f773f463ee83d56,0xbf52be193f1d3f7f,0x3f133f7d3f4a3dcf,0xbf51bf553e5d3f7d,0xbf143f0e3f7a3e19,0x3e8abf78be633f7b,0xbf77be7c3f7a3e4b,0x3f7fbef0bf1e3f78,0xbd90bf623f493e7c,0x3ece3eaebf653f75,0x3f6abf713ee53e96,0xbf3a3f6dbf803f71,0x3f30bec23cb03eae
.quad 0xbf643f67bf6a3f6c,0xbee83edcbed13ec5,0x3e003e93bf273f67,0xbf7e3f75bf423edc,0x3f7abf04be873f61,0xbe5d3f5bbf773ef3,0x3f08bf7b3e323f5b,0x3f593e45bf7c3f04,0xbf1ebf4d3f143f54,0x3f49bf19bf513f0f,0xbf73bdc23f5f3f4d,0xbea2bf7fbefb3f19,0xbcb03f2d3f7f3f45,0xbf80bf3dbd903f23,0x3f6f3f803f6f3f3d,0xbeb73b493eba3f2d
.quad 0x3f7c3f7d3f7e3f7f,0x3e323e193e003dcf,0xbf7cbf55bf0abe19,0x3e2c3f0e3f583f7d,0x3f5f3e7cbf08bf7b,0xbefbbf78bf59be4b,0xbf283ef03f7e3e7c,0x3f413f62bdf4bf78,0x3ebabf71bea23f75,0xbf6fbeae3f733e96,0xbce23f6dbf39beae,0x3f80bec2bf313f71,0xbe9fbedc3f6fbf6c,0xbf733f67beb7bec5,0x3f1dbe93bd9d3edc,0x3f4abf753f7fbf67
.quad 0xbf583f5bbf5e3f61,0xbf0a3f04befe3ef3,0x3f7abf7b3f52bf04,0x3e633e45bf133f5b,0xbf7e3f193e2cbf54,0x3df4bf4d3f7cbf0f,0x3f653dc2bf773f19,0xbee53f7fbe8abf4d,0xbf31bf3d3f283f45,0x3f39bf2dbf413f23,0x3ed13f803ecebf2d,0xbf6a3b493f6a3f3d,0xbd9dbf3ebf80bf34,0x3f7f3f2bbce2bf36,0xbe873dcf3ee83f3e,0xbf77bf7fbf64bf2b
.quad 0x3f773f783f7a3f7b,0x3e8a3e7c3e633e4b,0xbd90bef0bf49bf78,0xbf7fbf62bf1ebe7c,0xbf6abeae3ee53f75,0x3ece3f713f653e96,0x3f303f6dbcb0bf71,0x3f3abec2bf80beae,0x3ee8bf67bed13f6c,0xbf64bedc3f6a3ec5,0xbf7e3e933f42bf67,0xbe003f75bf27bedc,0x3e5d3f04bf773f61,0x3f7abf5b3e873ef3,0x3f59bf7b3f7cbf5b,0xbf083e453e32bf04
.quad 0xbf493f4dbf513f54,0xbf1e3f19bf143f0f,0xbea2bdc23efbbf4d,0x3f73bf7f3f5fbf19,0x3f80bf2dbd903f45,0xbcb03f3dbf7f3f23,0xbeb73f80bebabf3d,0xbf6f3b493f6fbf2d,0xbf42bf2b3f3a3f34,0x3f27bf3ebf303f36,0x3f5ebdcfbf73bf2b,0x3efe3f7f3e9fbf3e,0x3e323f4e3f7e3f22,0xbf7cbf183e003f46,0xbf7cbf7bbf58bf18,0x3e2cbe4bbf0abf4e
.quad 0x3f6f3f713f733f75,0x3eba3eae3ea23e96,0x3f803f6d3f313eae,0x3ce2bec2bf39bf71,0x3f733edcbeb7bf6c,0xbe9fbf67bf6fbec5,0x3f4abe93bf7fbedc,0xbf1dbf75bd9d3f67,0x3f0abf5bbefe3f61,0xbf58bf043f5e3ef3,0x3e63bf7b3f133f04,0xbf7a3e453f52bf5b,0xbdf4bf193f7cbf54,0xbf7e3f4dbe2cbf0f,0xbee53dc23e8abf19,0xbf653f7fbf773f4d
.quad 0xbf393f3dbf413f45,0xbf313f2dbf283f23,0xbf6a3f80bf6a3f2d,0xbed13b493ecebf3d,0xbf7f3f3ebce2bf34,0xbd9dbf2b3f80bf36,0xbf773dcf3f64bf3e,0x3e87bf7f3ee83f2b,0xbf52bf183f4a3f22,0x3f13bf4ebf1d3f46,0xbf14bf7bbe5d3f4e,0x3f51be4bbf7abf18,0xbe8abf5cbf7abf0e,0x3f773f03be63bf55,0x3d90be96bf1ebf5c,0x3f7f3f753f493f03
.quad 0x3f7d3f7f3f803f80,0x3e1c3dd53d623bc9,0x3e423f173f613f80,0x3f7b3f4f3ef43d62,0xbf5cbe4e3f173f7f,0x3f023f7b3f4f3dd5,0xbf45bf5c3e423f7d,0xbf243f023f7b3e1c,0x3eafbf75be7f3f7b,0xbf71be983f783e4e,0x3f80bed8bf243f78,0x3bc9bf683f453e7f,0x3eaa3ec7bf683f75,0x3f72bf6c3ed83e98,0xbf473f72bf803f71,0x3f21beaabbc93eaf
.quad 0xbf5b3f61bf673f6c,0xbf053ef4bede3ec7,0x3e4e3e73bf213f67,0xbf7b3f79bf473ede,0x3f7dbf10be733f61,0xbe103f54bf793ef4,0x3eefbf7d3e4e3f5b,0x3f633e10bf7b3f05,0xbf2dbf453f1a3f54,0x3f3dbf24bf4d3f10,0xbf6cbd303f633f4d,0xbec7bf80beef3f1a,0x3d623f363f803f45,0xbf80bf34bd303f24,0x3f753f803f6c3f3d,0xbe923d623ec73f2d
.quad 0x3f713f753f783f7b,0x3eaf3e983e7f3e4e,0xbf80bf68bf24be7f,0xbbc93ed83f453f78,0x3f723ec7bed8bf75,0xbeaabf6cbf68be98,0xbf473eaa3f803eaf,0x3f213f723bc9bf71,0x3f05bf61bede3f6c,0xbf5bbef43f673ec7,0xbe4e3f79bf21bede,0x3f7bbe73bf473f67,0xbe10bf103f79bf61,0xbf7d3f54be73bef4,0x3eefbe10be4e3f05,0x3f63bf7d3f7bbf5b
.quad 0xbf3d3f45bf4d3f54,0xbf2d3f24bf1a3f10,0x3f6cbf803f63bf1a,0x3ec73d30beef3f4d,0xbf803f363d30bf45,0xbd62bf343f80bf24,0x3f75bd62bf6c3f2d,0xbe923f80bec7bf3d,0xbf4fbf213f3f3f34,0x3f17bf47bf2b3f36,0x3f103f7d3e92bf3f,0xbf543e1c3f753f2b,0xbe7fbf56bf7dbf21,0x3f783f0dbe1cbf47,0xbdbc3e7f3f103f4f,0xbf7fbf78bf54bf17
.quad 0x3f5b3f613f673f6c,0x3f053ef43ede3ec7,0x3e4ebe73bf21bf67,0xbf7bbf79bf47bede,0xbf7dbf103e733f61,0x3e103f543f793ef4,0x3eef3f7d3e4ebf5b,0x3f63be10bf7bbf05,0x3f2dbf45bf1a3f54,0xbf3dbf243f4d3f10,0xbf6c3d303f63bf4d,0xbec73f80beefbf1a,0xbd623f36bf803f45,0x3f80bf343d303f24,0x3f75bf803f6cbf3d,0xbe92bd623ec7bf2d
.quad 0xbf173f21bf2b3f34,0xbf4f3f47bf3f3f36,0xbf103e1c3e92bf2b,0x3f54bf7d3f75bf3f,0x3f78bf563e1c3f21,0x3e7f3f0dbf7d3f47,0xbdbc3f78bf10bf17,0xbf7f3e7f3f54bf4f,0xbf68beef3f5c3f0d,0x3ed8bf63bf023f56,0x3f34beafbf7fbf02,0x3f363f713dbcbf5c,0x3ede3f6d3f713eef,0xbf67bec13eaf3f63,0xbf7fbf67bf34bed8,0xbdd5bedebf36bf68
.quad 0x3f3d3f453f4d3f54,0x3f2d3f243f1a3f10,0x3f6c3f803f633f1a,0x3ec7bd30beefbf4d,0x3f803f36bd30bf45,0x3d62bf34bf80bf24,0x3f753d62bf6cbf2d,0xbe92bf80bec73f3d,0x3f4fbf21bf3f3f34,0xbf17bf473f2b3f36,0x3f10bf7d3e923f3f,0xbf54be1c3f75bf2b,0x3e7fbf563f7dbf21,0xbf783f0d3e1cbf47,0xbdbcbe7f3f10bf4f,0xbf7f3f78bf543f17
.quad 0xbed83eefbf023f0d,0xbf683f63bf5c3f56,0xbf343f71bf7f3f5c,0xbf363eaf3dbcbf02,0xbf673f6dbeafbeef,0xbedebec13f71bf63,0xbf7f3ede3f34bf68,0xbdd5bf673f363ed8,0xbf79be923f723ec1,0x3e73bf75beaa3f6d,0xbf56bf5b3dd53f72,0x3f0dbf05bf7fbeaa,0xbf1abf7bbf5bbe92,0x3f4d3e42bf05bf75,0xbe98bf1abf56bf79,0x3f753f4d3f0d3e73
.quad 0x3f793f7d3f7f3f80,0x3e6a3e203da93c17,0x3de83f0c3f5e3f80,0x3f7e3f563f003d6f,0xbf66be813f113f7f,0x3ee23f783f533ddb,0xbf38bf633e263f7d,0xbf323eed3f7d3e20,0x3ed4bf70be8d3f7b,0xbf69beb13f763e51,0x3f7fbec0bf293f78,0x3da9bf6d3f403e81,0x3e843edfbf6b3f74,0x3f77bf663ecb3e99,0xbf533f76bf803f70,0x3f11be90bd0a3eb1
.quad 0xbf503f5abf643f6c,0xbf153f06beea3ec8,0x3e8d3e3fbf1c3f66,0xbf763f7cbf4b3edf,0x3f7fbf1abe573f61,0xbd843f4cbf7a3ef6,0x3ecbbf7f3e6a3f5a,0x3f6b3db6bf793f06,0xbf3bbf3c3f1f3f54,0x3f2fbf2ebf483f10,0xbf643c173f663f4c,0xbeeabf80bee23f1a,0x3e073f3f3f803f44,0xbf7ebf2abc7b3f24,0x3f7a3f7f3f693f3c,0xbe573ddb3ed43f2e
.quad 0x3f5e3f663f6e3f74,0x3f003edf3ebd3e99,0xbf7cbf76bf3bbeb1,0xbe383e903f2f3f70,0x3f7d3f06be9cbf6c,0xbe26bf5abf74bec8,0xbf603e3f3f7e3edf,0x3ef83f7c3e07bf66,0x3f29bf4cbf0b3f61,0xbf40bf1a3f573ef6,0xbebd3f7fbf07bf06,0x3f6ebdb6bf5a3f5a,0x3d0abf2e3f7ebf54,0xbf803f3cbde8bf10,0x3e9c3c17bea53f1a,0x3f74bf803f72bf4c
.quad 0xbf1c3f2abf383f44,0xbf4b3f3fbf323f24,0x3f57bf7f3f70bf2e,0x3f0bbddbbeb43f3c,0xbf793f4fbda9bf33,0xbe6abf173f7fbf37,0x3f7ebe51bf5e3f3f,0xbde83f7bbf00bf2a,0xbf66bf023f533f21,0x3ee2bf5dbf113f47,0x3f323f743e26bf4f,0xbf383e993f7d3f17,0xbed4bf68bf76bf0c,0x3f693ed7be8dbf56,0x3da93ec83f293f5d,0xbf7fbf6cbf40bf02
.quad 0x3f2f3f3c3f483f54,0x3f3b3f2e3f1f3f10,0x3eea3c17bee2bf4c,0xbf64bf80bf66bf1a,0xbf7ebf3f3c7b3f44,0xbe073f2a3f803f24,0x3e573f7f3ed4bf3c,0x3f7a3ddbbf69bf2e,0x3f5abf17bf433f33,0xbf07bf4f3f253f37,0xbf48be513f77bf2a,0xbf1f3f7bbe84bf3f,0xbea53f5dbf7c3f21,0x3f72bf02be383f47,0x3f80bf743f50bf17,0xbc7bbe993f15bf4f
.quad 0xbeb43ed7bef83f0c,0xbf703f68bf603f56,0xbf433ec83d84bf02,0x3f25bf6c3f7fbf5d,0x3f5ebf723ebd3eed,0x3f003ea8bf6e3f63,0x3e383f61bf3bbed7,0xbf7c3ef63f2fbf68,0xbf7dbe703f743ec0,0x3e26bf79be9c3f6d,0x3ef8bf10bf7ebea8,0x3f603f54be07bf72,0x3f293f7e3f573e90,0xbf40be0d3f0b3f76,0xbf6ebf44bf07be70,0xbebdbf24bf5abf79
.quad 0x3ee23f023f113f21,0x3f663f5d3f533f47,0x3f383f743f7d3f4f,0x3f323e99be26bf17,0x3f693f683e8dbf0c,0x3ed4bed7bf76bf56,0x3f7f3ec8bf40bf5d,0x3da9bf6cbf293f02,0x3f77bea8bf6b3eed,0xbe84bf723ecb3f63,0x3f53bf61bd0a3f68,0xbf11bef63f80bed7,0x3f15bf793f64bec0,0xbf503e703eeabf6d,0x3e8dbf103f4bbf72,0xbf763f54bf1c3ea8
.quad 0xbd843e0dbe573e90,0xbf7f3f7ebf7a3f76,0xbecb3f44bf793f79,0xbf6b3f24be6abe70,0xbf2f3f80bf1fbe3f,0xbf3bbd233f48bf7c,0xbf643f373ee2bf7e,0xbeeabf333f663e0d,0xbf7e3d6f3f803db6,0xbe07bf80bc7b3f7f,0xbf7abf213ed43f80,0x3e57bf47bf69bd23,0xbf5abf7dbf253c17,0x3f07be20bf43bf80,0xbf1fbf56bf77bf80,0x3f483f0c3e84bd6f
.quad 0x3f743f7a3f7e3f80,0x3e9b3e543de23c49,0x3d173f013f5a3f80,0x3f803f5d3f063d7b,0xbf6ebe9b3f0c3f7e,0x3ebe3f743f573de2,0xbf2abf693e0a3f7d,0xbf403ed53f7e3e23,0x3ef7bf6bbe9b3f7a,0xbf60beca3f743e54,0x3f7dbea7bf2e3f78,0x3e23bf723f3c3e82,0x3e3b3ef7bf6e3f74,0x3f7cbf603ebe3e9b,0xbf5d3f79bf803f70,0x3f01be6dbd7b3eb2
.quad 0xbf443f53bf603f6b,0xbf253f11bef73eca,0x3eb23e0abf163f66,0xbf703f7ebf4f3ee1,0x3f80bf25be3b3f60,0x3c493f44bf7c3ef7,0x3ea7bf803e823f5a,0x3f723d17bf783f06,0xbf48bf333f253f53,0x3f20bf37bf443f11,0xbf5a3d7b3f693f4c,0xbf06bf80bed53f1b,0x3e543f483f803f44,0xbf7abf203c493f25,0x3f7e3f7d3f663f3c,0xbe0a3e233ee13f2e
.quad 0x3f443f533f603f6b,0x3f253f113ef73eca,0xbf70bf7ebf4fbee1,0xbeb23e0a3f163f66,0x3f803f25be3bbf60,0x3c49bf44bf7cbef7,0xbf723d173f783f06,0x3ea73f803e82bf5a,0x3f48bf33bf253f53,0xbf20bf373f443f11,0xbf063f80bed5bf1b,0x3f5a3d7bbf693f4c,0x3e54bf483f80bf44,0xbf7a3f203c49bf25,0x3e0a3e23bee13f2e,0x3f7ebf7d3f66bf3c
.quad 0xbeec3f0cbf203f33,0xbf633f57bf483f37,0x3f3cbf783f79bf40,0x3f2ebe82be6d3f2a,0xbf6b3f63be54bf20,0xbecabeec3f7abf48,0x3f80beb2bf4c3f4f,0x3d7b3f70bf1bbf16,0xbf76bebe3f633f0c,0x3e8fbf6ebeec3f57,0x3f4f3f663d17bf5d,0xbf163ee13f803f01,0xbf11bf76bf6bbeec,0x3f533e8fbecabf63,0x3e823f063f403f69,0xbf78bf5abf2abed5
.quad 0x3eec3f0c3f203f33,0x3f633f573f483f37,0x3f2e3e82be6dbf2a,0xbf3cbf78bf79bf40,0xbf6bbf63be543f20,0xbeca3eec3f7a3f48,0xbd7b3f703f1bbf16,0x3f803eb2bf4cbf4f,0x3f76bebebf633f0c,0xbe8fbf6e3eec3f57,0xbf16bee13f80bf01,0xbf4f3f66bd17bf5d,0xbf113f76bf6b3eec,0x3f53be8fbeca3f63,0x3f78bf5a3f2abed5,0x3e82bf063f40bf69
.quad 0xbdb03e3bbe8f3ebe,0xbf7f3f7cbf763f6e,0xbf693f1bbe23bea7,0x3ed5bf4c3f7dbf72,0x3f33bf7f3f113e8f,0x3f373db0bf533f76,0x3ee13f3cbf5dbe6d,0xbf663f2e3f01bf79,0xbf7e3c493f7f3e3b,0xbde2bf80bdb03f7c,0x3e6dbf40bf70be0a,0x3f793f2abeb2bf7e,0x3f573f7e3f333db0,0xbf0c3de23f373f7f,0xbf4cbf16bea7bd17,0xbf1bbf4fbf72bf80
.quad 0x3db03e3b3e8f3ebe,0x3f7f3f7c3f763f6e,0x3ed53f4c3f7d3f72,0x3f693f1b3e23bea7,0x3f333f7f3f11be8f,0x3f37bdb0bf53bf76,0x3f663f2ebf01bf79,0x3ee1bf3cbf5d3e6d,0x3f7e3c49bf7f3e3b,0x3de2bf803db03f7c,0x3f79bf2abeb23f7e,0xbe6dbf403f70be0a,0x3f57bf7e3f33bdb0,0xbf0cbde23f37bf7f,0x3f1bbf4f3f72bf80,0xbf4c3f16bea73d17
.quad 0x3e9bbe543de2bc49,0xbf743f7abf7e3f80,0xbd173f01bf5a3f80,0xbf803f5dbf063d7b,0xbebe3f74bf573de2,0xbf6e3e9b3f0cbf7e,0xbf2a3f693e0abf7d,0xbf40bed53f7ebe23,0xbf603eca3f74be54,0xbef7bf6b3e9b3f7a,0xbf7dbea73f2e3f78,0xbe23bf72bf3c3e82,0xbf7cbf60bebe3e9b,0x3e3bbef7bf6ebf74,0xbf5dbf79bf80bf70,0x3f013e6dbd7bbeb2
.quad 0x3f6d3f773f7e3f80,0x3ec03e843e0d3c7b,0xbd233eea3f563f7f,0x3f803f643f0c3d84,0xbf74beb43f063f7e,0x3e993f703f5a3de8,0xbf1abf6e3ddb3f7d,0xbf4c3ebd3f7f3e26,0x3f0cbf66bea83f7a,0xbf56bee23f723e57,0x3f79be8dbf333f77,0x3e70bf763f373e84,0x3ddb3f07bf703f74,0x3f7fbf5a3eb13e9c,0xbf663f7cbf7f3f70,0x3edfbe38bdb63eb4
.quad 0xbf373f4bbf5d3f6b,0xbf333f1cbf023ecb,0x3ed73da9bf103f66,0xbf683f7fbf543ee2,0x3f7fbf2fbe203f60,0x3db63f3bbf7d3ef8,0x3e81bf803e903f5a,0x3f78bc7bbf763f07,0xbf54bf293f2a3f53,0x3f10bf40bf3f3f11,0xbf4f3de83f6c3f4b,0xbf17bf7ebec83f1c,0x3e903f503f803f43,0xbf76bf153d233f25,0x3f803f7a3f633f3b,0xbd6f3e573eed3f2f
.quad 0x3f243f3b3f4f3f60,0x3f443f2f3f173ef8,0xbf5dbf80bf61bf07,0xbf02bc7b3ef63f5a,0x3f7c3f40bd6fbf53,0x3e3fbf29bf80bf11,0xbf7dbde83f6d3f1c,0x3e203f7e3ec0bf4b,0x3f61bf15bf3c3f43,0xbef6bf503f2e3f25,0xbf2a3f7abe99bf2f,0x3f3f3e57bf743f3b,0x3ec0bf5e3f7ebf32,0xbf6d3f003e0dbf38,0xbd233e9cbf0c3f40,0x3f80bf743f56bf29
.quad 0xbe993ed4bf063f1f,0xbf743f69bf5a3f48,0x3f1abf6b3f7fbf50,0x3f4cbecbbddb3f15,0xbf563f72bea8bf0b,0xbf0cbea53f72bf57,0x3f79bef8bf373f5e,0x3e703f60bf33bf00,0xbf7fbe6a3f703eea,0x3ddbbf79beb13f64,0x3f663f53bdb6bf69,0xbedf3f113f7f3ed4,0xbf33bf7ebf5dbebd,0x3f373e07bf02bf6e,0x3ed73f253f543f72,0xbf68bf43bf10bea5
.quad 0x3e513ea53edf3f0b,0x3f7b3f723f663f57,0x3f5a3ef8bc17bf00,0xbf06bf60bf80bf5e,0xbf47bf79bed73eea,0xbf213e6a3f683f64,0xbea83f533f44bed4,0x3f723f11bf24bf69,0x3f80be07bf783ebd,0xbc17bf7e3e813f6e,0xbeb1bf253f7cbea5,0xbf703f433e3fbf72,0xbf443f80bf4f3e8d,0x3f24bd0abf173f76,0x3f5dbf323ef6be6a,0x3f02bf383f61bf79
.quad 0x3e3fbd84bd6f3e38,0xbf7c3f7fbf803f7c,0xbf7d3f48bec0be07,0x3e20bf1f3f6dbf7e,0x3ef6bf7d3f3c3da9,0x3f61be26bf2e3f7f,0x3f2a3f0bbf74bd0a,0xbf3f3f573e99bf80,0xbf6d3e843f7ebc7b,0xbec0bf773e0d3f80,0xbd23bf64bf563d84,0x3f803eeabf0cbf7f,0x3f743f703f06bde8,0xbe993eb43f5a3f7e,0xbf1abebdbddb3e26,0xbf4cbf6ebf7fbf7d
.quad 0xbe90be26bd233da9,0x3f763f7d3f803f7f,0x3d6f3f0b3f633f80,0x3f803f573eedbd0a,0x3ec83f773f4c3c7b,0x3f6c3e84bf1abf80,0x3f2e3f64be51bf7f,0x3f3cbeeabf7bbd84,0x3f633eb4bf79bde8,0x3eedbf70be703f7e,0x3f7ebebdbf213f7d,0x3e0dbf6e3f473e26,0x3f7bbf663edf3e57,0xbe51bee23f66bf7a,0x3f5abf763f80bf77,0xbf063e8dbc17be84
.quad 0x3f21bf073ed7be9c,0xbf473f5abf683f74,0x3ea83e38bf243f70,0xbf723f7cbf443eb4,0xbc173f4bbf783ecb,0xbf803f1c3e81bf6b,0xbeb13f7fbe3fbf66,0xbf70bda93f7cbee2,0xbf243f2f3f4fbef8,0xbf44bf3b3f173f60,0xbf5d3c7b3f613f5a,0xbf02bf80bef63f07,0xbf7cbf29bd6f3f11,0xbe3fbf40bf80bf53,0xbf7dbf7ebf6dbf4b,0x3e20bde8bec0bf1c
.quad 0x3f653f743f7c3f80,0x3ee33e9e3e293c97,0xbdee3ed23f523f7f,0x3f7e3f693f123d8a,0xbf79becd3eff3f7e,0x3e663f6b3f5e3dee,0xbf0abf733da33f7c,0xbf573ea43f7f3e29,0x3f1cbf60beb53f7a,0xbf4bbefa3f6f3e5a,0x3f74be66bf383f77,0x3e9ebf793f323e86,0x3cfb3f12bf733f74,0x3f80bf523ea43e9e,0xbf6e3f7ebf7e3f6f,0x3ebbbe04bdee3eb5
.quad 0xbf283f43bf593f6b,0xbf413f26bf083ecd,0x3efa3cfbbf0a3f65,0xbf603f80bf573ee3,0x3f7cbf38be043f60,0x3e293f32bf7e3efa,0x3e35bf7f3e9e3f59,0x3f7cbd8abf743f08,0xbf5ebf1f3f2f3f52,0x3effbf49bf3a3f12,0xbf433e293f6e3f4b,0xbf26bf7cbebb3f1c,0x3eb53f573f7f3f43,0xbf6fbf0a3d8a3f26,0x3f803f773f603f3a,0x3c973e863efa3f2f
.quad 0x3eff3f1f3f3a3f52,0x3f5e3f493f2f3f12,0xbf43bf7cbf6ebf1c,0xbf26be293ebb3f4b,0x3f6f3f573d8abf43,0x3eb5bf0abf7fbf26,0xbf80be863f603f2f,0xbc973f773efabf3a,0x3f73bee9bf503f32,0xbea4bf643f153f38,0xbf493f6fbe35bf41,0x3f1f3eb5bf7c3f28,0x3f08bf6e3f77bf1f,0xbf593ebb3e86bf49,0xbe5a3ee3bf263f50,0x3f7abf653f43bf15
.quad 0xbe043e8cbed23f0a,0xbf7e3f76bf693f57,0x3ee9bf593f80bf5e,0x3f64bf083c973eff,0xbf3a3f7cbee3bee9,0xbf2fbe353f65bf64,0x3f6bbf1cbf1f3f69,0x3ecd3f4bbf49bed2,0xbf7fbda33f793ebb,0xbd8abf7fbe663f6e,0x3f763f3abe5abf73,0xbe8c3f2f3f7a3ea4,0xbf50bf80bf4bbe8c,0x3f15bc97bf1cbf76,0x3f123f413f643f79,0xbf52bf28bee9be66
.quad 0xbd8a3da33e663ebb,0x3f7f3f7f3f793f6e,0x3f763f2f3e5abea4,0xbe8cbf3abf7abf73,0xbf15bf80bf1c3e8c,0xbf50bc973f4b3f76,0xbf123f283f64be66,0x3f523f41bee9bf79,0x3f773deebf803e35,0x3e86bf7e3cfb3f7c,0xbda3bf503f6bbe04,0xbf7f3f153ecdbf7e,0xbf693f7abf283da3,0x3ed23e5abf413f7f,0x3f32beff3e8cbcfb,0x3f38bf5e3f76bf80
.quad 0x3ee3be9e3e29bc97,0xbf653f74bf7c3f80,0xbf7e3f69bf123d8a,0xbdeebed23f52bf7f,0x3e66bf6b3f5ebdee,0x3f79becdbeff3f7e,0x3f573ea4bf7f3e29,0xbf0a3f733da3bf7c,0xbf4b3efa3f6fbe5a,0xbf1cbf603eb53f7a,0xbe9ebf79bf323e86,0x3f743e66bf38bf77,0x3f803f523ea4be9e,0xbcfb3f123f733f74,0xbebbbe043dee3eb5,0xbf6ebf7ebf7ebf6f
.quad 0xbf1cbefabeb5be5a,0x3f4b3f603f6f3f7a,0xbe9e3e663f323f77,0x3f743f793f383e86,0x3cfb3f523f733e9e,0x3f803f12bea4bf74,0x3ebb3f7e3deebf6f,0x3f6ebe04bf7ebeb5,0x3f283f26bf59becd,0x3f41bf43bf083f6b,0x3f60bcfbbf573f65,0x3efabf803f0a3ee3,0x3f7cbf323e043efa,0x3e29bf383f7ebf60,0x3f7cbf7f3f74bf59,0xbe35bd8a3e9ebf08
.quad 0x3f5ebf493f2fbf12,0xbeff3f1fbf3a3f52,0x3f26be29bebb3f4b,0xbf433f7cbf6e3f1c,0x3eb53f0abf7f3f26,0xbf6f3f57bd8abf43,0x3c973f77befabf3a,0xbf803e863f60bf2f,0xbea43f643f15bf38,0xbf73bee93f503f32,0xbf1f3eb53f7c3f28,0xbf49bf6fbe353f41,0xbf59bebb3e863f49,0xbf08bf6ebf77bf1f,0xbf7abf65bf43bf15,0xbe5abee3bf26bf50
.quad 0x3f5c3f6f3f7b3f80,0x3f033eb73e453cb0,0xbe453eba3f4e3f7f,0x3f7b3f6f3f183d90,0xbf7dbee53ef33f7e,0x3e193f653f613df4,0xbef3bf773d563f7c,0xbf613e8a3f803e2c,0x3f2bbf59bec23f7a,0xbf3ebf083f6d3e5d,0x3f6dbe32bf3d3f77,0x3ec2bf7c3f2d3e87,0xbd3c3f1dbf753f73,0x3f80bf4a3e963e9f,0xbf753f7fbf7d3f6f,0x3e96bd9dbe133eb7
.quad 0xbf193f3abf553f6a,0xbf4d3f30bf0e3ece,0x3f0ebcb0bf043f65,0xbf553f80bf5b3ee5,0x3f79bf41bdcf3f5f,0x3e763f28bf7f3efb,0x3dcfbf7e3eab3f59,0x3f7fbdf4bf713f08,0xbf67bf143f343f52,0x3edcbf51bf363f13,0xbf363e5d3f713f4a,0xbf34bf7abeae3f1d,0x3ed93f5e3f7f3f42,0xbf68befe3dc23f27,0x3f7f3f733f5c3f3a,0x3dc23e9f3f033f30
.quad 0x3eae3efe3f233f42,0x3f713f5e3f453f27,0xbf23bf73bf78bf30,0xbf45be9f3e7c3f3a,0x3f5c3f6a3e45bf31,0x3f03bed1bf7bbf39,0xbf7bbece3f4e3f41,0xbe453f6a3f18bf28,0x3f7dbea2bf613f1e,0xbe19bf733ef33f49,0xbf613f5fbd56bf51,0x3ef33efbbf803f14,0x3f2bbf7a3f6dbf0a,0xbf3e3e633ec2bf58,0xbec23f13bf3d3f5e,0x3f6dbf523f2dbefe
.quad 0x3d3c3e00be963ee8,0xbf803f7ebf753f64,0x3e96bf423f7dbf6a,0x3f75bf273e133ed1,0xbf193f80bf0ebeba,0xbf4dbce23f55bf6f,0x3f55bf39bf043f73,0x3f0e3f31bf5bbea2,0xbf793d903f7f3e8a,0xbe76bf7fbdcf3f77,0x3f7f3f1ebeabbf7a,0xbdcf3f493f713e63,0xbf67bf7cbf36be32,0x3edcbe2cbf34bf7c,0x3f343f583f713f7e,0xbf36bf0abeaebe00
.quad 0xbeabbe2c3b493e32,0x3f713f7c3f803f7c,0x3f803f583ed9be00,0xbb49bf0abf68bf7e,0xbeaebf77bf453d9d,0xbf71be873f233f7f,0xbf453ee83f78bce2,0x3f233f64be7cbf80,0x3f5c3eb7bf7bbcb0,0x3f03bf6fbe453f80,0x3e45bf6f3f4e3d90,0xbf7b3eba3f18bf7f,0xbf7d3f65bef3bdf4,0x3e193ee5bf613f7e,0x3ef3be8a3d563e2c,0x3f61bf773f80bf7c
.quad 0x3f2bbf083ec2be5d,0xbf3e3f59bf6d3f7a,0xbf6d3f7cbf3d3e87,0xbec2be323f2dbf77,0xbd3cbf4a3f75be9f,0x3f80bf1dbe963f73,0x3f753d9dbf7d3eb7,0xbe963f7fbe13bf6f,0xbf193f303f55bece,0xbf4dbf3a3f0e3f6a,0xbf0ebf80bf043ee5,0x3f55bcb0bf5bbf65,0x3f793f283dcfbefb,0x3e763f413f7f3f5f,0xbdcf3df43eab3f08,0xbf7fbf7ebf71bf59
.quad 0xbf5bbf41bf22befb,0x3f043f283f463f5f,0xbf22bdf43edc3f59,0x3f463f7e3f673f08,0xbeab3f143f803f13,0x3f713f51bb49bf52,0x3b493f7a3ed9bf4a,0x3f803e5dbf68bf1d,0x3eae3f5ebf23bf27,0x3f71befebf453f42,0x3f233e9fbf783f3a,0x3f45bf733e7c3f30,0x3f5cbed1be453f39,0x3f03bf6a3f7bbf31,0x3f7bbf6a3f4ebf28,0x3e45bece3f18bf41
.quad 0x3f7dbf733f61bf49,0xbe193ea2bef33f1e,0x3f61befbbd563f14,0xbef33f5fbf803f51,0x3f2b3e63bf6d3f58,0xbf3e3f7abec2bf0a,0x3ec23f52bf3dbefe,0xbf6d3f133f2dbf5e,0x3d3c3f7e3e96bf64,0xbf80be003f753ee8,0xbe963f273f7d3ed1,0xbf75bf423e133f6a,0xbf19bce23f0e3f6f,0xbf4dbf80bf55beba,0xbf55bf31bf04bea2,0xbf0ebf39bf5bbf73
.quad 0x3f513f6a3f7a3f80,0x3f133ecf3e603cc9,0xbe893ea13f4a3f7f,0x3f773f733f1d3d97,0xbf7fbefc3ee63f7e,0x3d973f5f3f653dfb,0xbecfbf7a3cc93f7c,0xbf6a3e603f803e2f,0x3f39bf51becf3f7a,0xbf31bf133f6a3e60,0x3f65bdfbbf423f77,0x3ee6bf7e3f273e89,0xbdfb3f27bf773f73,0x3f7ebf423e893ea1,0xbf7a3f80bf7c3f6f,0x3e60bcc9be2f3eb8
.quad 0xbf093f31bf513f6a,0xbf583f39bf133ecf,0x3f1dbd97befc3f65,0xbf4a3f7fbf5f3ee6,0x3f73bf4abd973f5f,0x3ea13f1dbf7f3efc,0x3cc9bf7c3eb83f58,0x3f80be2fbf6f3f09,0xbf6fbf093f393f51,0x3eb8bf58bf313f13,0xbf273e893f733f4a,0xbf42bf77bea13f1d,0x3efc3f653f7e3f42,0xbf5fbee63dfb3f27,0x3f7c3f6f3f583f39,0x3e2f3eb83f093f31
.quad 0x3e2f3eb83f093f31,0x3f7c3f6f3f583f39,0xbefcbf65bf7ebf42,0xbf5fbee63dfb3f27,0x3f423f773ea1bf1d,0x3f27be89bf73bf4a,0xbf6fbf093f393f51,0xbeb83f583f31bf13,0x3f80be2fbf6f3f09,0x3cc9bf7c3eb83f58,0xbf733f4a3d97bf5f,0x3ea13f1dbf7f3efc,0x3f4abf7f3f5fbee6,0xbf1d3d973efcbf65,0xbf093f31bf513f6a,0x3f58bf393f13becf
.quad 0x3e60bcc9be2f3eb8,0xbf7a3f80bf7c3f6f,0x3dfbbf273f77bf73,0x3f7ebf423e893ea1,0xbee63f7ebf27be89,0xbf653dfb3f42bf77,0x3f39bf51becf3f7a,0x3f313f13bf6abe60,0xbf6a3e603f803e2f,0xbecfbf7a3cc93f7c,0x3f7f3efcbee6bf7e,0x3d973f5f3f653dfb,0xbf77bf73bf1dbd97,0x3e89bea1bf4abf7f,0x3f513f6a3f7a3f80,0xbf13becfbe60bcc9
.quad 0xbf13becfbe60bcc9,0x3f513f6a3f7a3f80,0x3f773f733f1d3d97,0x3e89bea1bf4abf7f,0xbd97bf5fbf65bdfb,0xbf7fbefc3ee63f7e,0xbf6a3e603f803e2f,0x3ecf3f7abcc9bf7c,0x3f313f13bf6abe60,0x3f39bf51becf3f7a,0x3ee6bf7e3f273e89,0xbf653dfb3f42bf77,0xbf7e3f42be89bea1,0xbdfb3f27bf773f73,0x3e60bcc9be2f3eb8,0x3f7abf803f7cbf6f
.quad 0x3f58bf393f13becf,0xbf093f31bf513f6a,0xbf4a3f7fbf5f3ee6,0xbf1d3d973efcbf65,0xbea1bf1d3f7fbefc,0x3f73bf4abd973f5f,0x3f80be2fbf6f3f09,0xbcc93f7cbeb8bf58,0xbeb83f583f31bf13,0xbf6fbf093f393f51,0xbf42bf77bea13f1d,0x3f27be89bf73bf4a,0x3f5f3ee6bdfbbf27,0x3efc3f653f7e3f42,0x3e2f3eb83f093f31,0xbf7cbf6fbf58bf39
.quad 0xbf7cbf6fbf58bf39,0x3e2f3eb83f093f31,0xbf5fbee63dfb3f27,0x3efc3f653f7e3f42,0xbf273e893f733f4a,0x3f423f773ea1bf1d,0xbeb83f583f31bf13,0x3f6f3f09bf39bf51,0xbcc93f7cbeb8bf58,0x3f80be2fbf6f3f09,0x3ea13f1dbf7f3efc,0x3f73bf4abd973f5f,0x3f1dbd97befc3f65,0x3f4abf7f3f5fbee6,0x3f58bf393f13becf,0x3f09bf313f51bf6a
.quad 0x3f7abf803f7cbf6f,0x3e60bcc9be2f3eb8,0x3f7ebf423e893ea1,0xbdfb3f27bf773f73,0x3f65bdfbbf423f77,0xbee63f7ebf27be89,0x3f313f13bf6abe60,0xbf393f513ecfbf7a,0x3ecf3f7abcc9bf7c,0xbf6a3e603f803e2f,0x3d973f5f3f653dfb,0xbf7fbefc3ee63f7e,0xbe893ea13f4a3f7f,0xbf77bf73bf1dbd97,0xbf13becfbe60bcc9,0xbf51bf6abf7abf80
.quad 0x3f453f643f783f80,0x3f233ee83e7c3ce2,0xbeae3e873f453f7f,0x3f713f773f233d9d,0xbf80bf0a3ed93f7e,0xbb493f583f683e00,0xbeabbf7cbb493f7c,0xbf713e2c3f803e32,0x3f46bf49bedc3f7a,0xbf22bf1e3f673e63,0x3f5bbd90bf463f77,0x3f04bf7f3f223e8a,0xbe4b3f31bf793f73,0x3f7bbf393e763ea2,0xbf7d3f80bf7b3f6f,0x3e133ce2be4b3eba
.quad 0xbef03f27bf4d3f6a,0xbf623f42bf193ed1,0x3f2dbe00bef03f64,0xbf3d3f7ebf623ee8,0x3f6cbf52bd3c3f5e,0x3ec53f13bf803efe,0xbd56bf7a3ec53f58,0x3f80be63bf6c3f0a,0xbf75befb3f3e3f51,0x3e93bf5fbf2b3f14,0xbf183ea23f753f49,0xbf4ebf73be933f1e,0x3f0f3f6a3f7d3f41,0xbf54bece3e193f28,0x3f783f6a3f543f39,0x3e7c3ed13f0f3f31
.quad 0xbb493e5d3ed93f1d,0x3f803f7a3f683f4a,0xbeabbf51bf80bf52,0xbf71bf14bb493f13,0x3f223f7e3edcbf08,0x3f46bdf4bf67bf59,0xbf5bbf283f223f5f,0xbf043f413f46befb,0x3f7bbcb0bf793ee5,0x3e4bbf803e763f65,0xbf7d3f303e4bbf6a,0x3e133f3abf7b3ece,0x3f62bf7f3f4dbeb7,0xbef0bd9d3f19bf6f,0xbf2d3f4abf623f73,0x3f3dbf1d3ef0be9f
.quad 0x3ec5be32bd3c3e87,0xbf6c3f7cbf803f77,0xbd56bf083f6cbf7a,0x3f80bf593ec53e5d,0xbe933f77bf3ebe2c,0xbf753e8a3f2bbf7c,0x3f18bf65be933f7e,0x3f4e3ee5bf75bdf4,0xbf543eba3f7d3d90,0xbf0fbf6f3e193f7f,0x3f783eb7bf0fbf80,0x3e7c3f6f3f543cb0,0xbf7fbf64bf033ce2,0x3dc2bee8bf5cbf80,0x3f683f773f7f3f7f,0xbed9be87bdc23d9d
.quad 0xbf46bf1ebedcbe63,0x3f223f493f673f7a,0x3f5b3f7f3f463e8a,0x3f04bd90bf22bf77,0x3e4bbf39bf79bea2,0xbf7bbf313e763f73,0xbf7dbce23f7b3eba,0x3e133f803e4bbf6f,0x3ef03f42bf4dbed1,0x3f62bf27bf193f6a,0x3f2dbf7e3ef03ee8,0xbf3dbe003f62bf64,0xbf6c3f13bd3cbefe,0xbec53f52bf803f5e,0xbd563e63bec53f0a,0x3f80bf7a3f6cbf58
.quad 0x3f75bf5f3f3ebf14,0xbe933efbbf2b3f51,0xbf183f73bf753f1e,0xbf4e3ea23e93bf49,0xbf0fbece3f7dbf28,0x3f54bf6a3e193f41,0x3f78bed1bf543f31,0x3e7c3f6abf0fbf39,0xbdc23f733f03bf3a,0xbf7fbe9f3f5c3f30,0xbf68bf5ebdc23f42,0x3ed9befebf7fbf27,0x3f343e5dbeaebf4a,0x3f363f7a3f713f1d,0x3edc3f143f363f52,0xbf67bf51bf34bf13
.quad 0xbf7bbf80bf79bf65,0xbe4b3cb03e763ee5,0xbf7dbf3abe4b3ece,0x3e133f303f7b3f6a,0xbf62bd9d3f4d3f6f,0x3ef03f7f3f19beb7,0xbf2d3f1d3f62be9f,0x3f3d3f4abef0bf73,0xbec53f7cbd3cbf77,0x3f6c3e32bf803e87,0xbd563f59bf6c3e5d,0x3f80bf08bec53f7a,0x3e933e8abf3e3f7c,0x3f75bf773f2bbe2c,0x3f18bee53e93bdf4,0x3f4ebf653f75bf7e
.quad 0x3f54bf6f3f7dbf7f,0x3f0fbeba3e193d90,0x3f78bf6f3f0f3cb0,0x3e7c3eb7bf543f80,0x3f7fbee8bf033f80,0xbdc23f64bf5c3ce2,0x3f683e87bf7f3d9d,0xbed93f773dc2bf7f,0x3f363f58beaebf7e,0xbf343f0a3f71be00,0x3edc3f7c3f34be32,0xbf67be2c3f363f7c,0x3dcf3f1e3f713f7a,0xbf7fbf49beab3e63,0xbe76bd903dcf3e8a,0xbf79bf7fbf7fbf77
.quad 0x3f383f5e3f763f80,0x3f323eff3e8c3cfb,0xbed23e5a3f413f7f,0x3f693f7a3f283da3,0xbf7fbf153ecd3f7e,0xbda33f503f6b3e04,0xbe86bf7ebcfb3f7c,0xbf773dee3f803e35,0x3f52bf41bee93f79,0xbf12bf283f643e66,0x3f50bc97bf4b3f76,0x3f15bf803f1c3e8c,0xbe8c3f3abf7a3f73,0x3f76bf2f3e5a3ea4,0xbf7f3f7fbf793f6e,0x3d8a3da3be663ebb
.quad 0xbecd3f1cbf493f69,0xbf6b3f4bbf1f3ed2,0x3f3abe35bee33f64,0xbf2f3f7cbf653ee9,0x3f64bf59bc973f5e,0x3ee93f08bf803eff,0xbe04bf763ed23f57,0x3f7ebe8cbf693f0a,0xbf7abee33f433f50,0x3e5abf65bf263f15,0xbf083ebb3f773f49,0xbf59bf6ebe863f1f,0x3f1f3f6f3f7c3f41,0xbf49beb53e353f28,0x3f733f643f503f38,0x3ea43ee93f153f32
.quad 0xbe353d8a3e9e3f08,0x3f7c3f7f3f743f59,0xbe29bf38bf7ebf60,0xbf7cbf32be043efa,0x3efa3f803f0abee3,0x3f603cfbbf57bf65,0xbf41bf433f083f6b,0xbf283f263f59becd,0x3f6e3e04bf7e3eb5,0x3ebbbf7e3dee3f6f,0xbf803f123ea4bf74,0xbcfb3f52bf733e9e,0x3f74bf793f38be86,0xbe9ebe663f32bf77,0xbf4b3f60bf6f3f7a,0x3f1cbefa3eb5be5a
.quad 0x3f0abea43da33e29,0xbf573f73bf7f3f7c,0xbe66becd3f5ebf7e,0x3f79bf6b3eff3dee,0xbdee3f69bf52bd8a,0xbf7e3ed23f12bf7f,0x3ee3bf74be293f80,0x3f653e9ebf7cbc97,0xbf383eff3f76bcfb,0xbf32bf5e3e8c3f80,0x3f693e5abf28bf7f,0x3ed23f7a3f41bda3,0xbf7fbf50becd3e04,0xbda3bf15bf6bbf7e,0x3f773f7e3f803f7c,0xbe86bdee3cfb3e35
.quad 0xbf6bbf4bbf1fbed2,0x3ecd3f1c3f493f69,0x3f2f3f7c3f653ee9,0x3f3a3e35bee3bf64,0x3ee9bf08bf80beff,0xbf64bf593c973f5e,0xbf7ebe8c3f693f0a,0xbe043f763ed2bf57,0x3e5a3f65bf26bf15,0x3f7abee3bf433f50,0x3f59bf6e3e863f1f,0xbf08bebb3f77bf49,0xbf493eb53e35bf28,0xbf1f3f6fbf7c3f41,0xbea43ee9bf153f32,0x3f73bf643f50bf38
.quad 0x3f80bf773f60bf3a,0xbc973e86befa3f2f,0xbeb53f57bf7f3f43,0xbf6f3f0a3d8abf26,0xbf43be293f6ebf4b,0x3f26bf7c3ebb3f1c,0x3f5ebf1fbf2f3f52,0x3eff3f49bf3abf12,0x3e353f7f3e9ebf59,0xbf7cbd8a3f743f08,0xbf7cbf383e043f60,0x3e29bf32bf7ebefa,0x3efabcfbbf0abf65,0x3f603f803f573ee3,0x3f283f433f593f6b,0xbf41bf26bf08becd
.quad 0xbf57bf73bf7fbf7c,0xbf0abea4bda33e29,0xbf79bf6bbeff3dee,0xbe663ecd3f5e3f7e,0xbf7ebed23f123f7f,0x3dee3f693f52bd8a,0xbf653e9e3f7cbc97,0x3ee33f74be29bf80,0xbf323f5e3e8cbf80,0x3f383effbf76bcfb,0xbed23f7abf41bda3,0x3f69be5abf283f7f,0xbda33f15bf6b3f7e,0x3f7fbf503ecd3e04,0x3e86bdeebcfb3e35,0x3f77bf7e3f80bf7c
.quad 0x3f12bf413f64bf79,0x3f52bf283ee9be66,0x3f50bf803f4bbe8c,0x3f153c97bf1c3f76,0x3f76bf3abe5a3f73,0x3e8c3f2fbf7a3ea4,0x3f7fbda3bf793ebb,0xbd8a3f7fbe66bf6e,0x3f6b3f1cbf1fbf69,0xbecd3f4b3f49bed2,0x3f3a3f7c3ee3bee9,0xbf2f3e353f653f64,0x3ee93f593f803f5e,0xbf64bf08bc973eff,0x3e043e8c3ed23f0a,0xbf7ebf76bf69bf57
.quad 0x3f2a3f573f743f80,0x3f3f3f0b3e993d0a,0xbef63e263f3c3f7f,0x3f613f7d3f2e3da9,0xbf7dbf1f3ec03f7e,0xbe203f483f6d3e07,0xbe3fbf7fbd6f3f7c,0xbf7c3d843f803e38,0x3f5dbf38bef63f79,0xbf02bf323f613e6a,0x3f443d0abf4f3f76,0x3f24bf803f173e8d,0xbeb13f43bf7c3f72,0x3f70bf253e3f3ea5,0xbf803f7ebf783f6e,0xbc173e07be813ebd
.quad 0xbea83f11bf443f69,0xbf723f53bf243ed4,0x3f47be6abed73f64,0xbf213f79bf683eea,0x3f5abf603c173f5e,0x3f063ef8bf803f00,0xbe51bf723edf3f57,0x3f7bbea5bf663f0b,0xbf7ebecb3f473f50,0x3e0dbf6bbf213f15,0xbeed3ed43f793f48,0xbf63bf69be703f1f,0x3f2e3f743f7b3f40,0xbf3cbe9c3e513f29,0x3f6c3f5e3f4c3f38,0x3ec83f003f1a3f32
.quad 0xbeb1bda93e3f3ee2,0x3f703f7f3f7c3f66,0x3c17bf1cbf78bf6b,0xbf80bf4bbe813ecb,0x3ea83f7c3f24beb4,0x3f723e38bf44bf70,0xbf21bf5a3ed73f74,0xbf473f073f68be9c,0x3f5a3e8dbf803e84,0x3f06bf76bc173f77,0xbf7b3ee23edfbf7a,0xbe513f66bf663e57,0x3f7ebf6e3f21be26,0xbe0dbebd3f47bf7d,0xbf633f70bf793f7e,0x3eedbeb43e70bde8
.quad 0x3f2ebeea3e513d84,0xbf3c3f64bf7b3f7f,0xbec8be843f4cbf80,0x3f6cbf773f1a3c7b,0x3d6f3f57bf633d0a,0xbf803f0b3eedbf80,0x3e90bf7dbd233f7f,0x3f763e26bf803da9,0xbf173f1f3f6cbe07,0xbf4fbf483ec83f7e,0x3f543d84bf3fbf7c,0x3f103f7f3f2abe38,0xbf78bf38be903e6a,0xbe81bf32bf76bf79,0x3f7f3f803f7d3f76,0xbdb63d0a3e203e8d
.quad 0xbf7ebf6bbf47bf15,0x3e0d3ecb3f213f50,0x3eed3f693f793f1f,0x3f633ed4be70bf48,0x3f2ebe9cbf7bbf29,0xbf3cbf74be513f40,0xbf6cbf003f4c3f32,0xbec83f5e3f1abf38,0xbd6f3f7abeedbf3b,0x3f80be57bf633f2f,0x3f76bf503d233f43,0xbe90bf153f80bf25,0xbf173de83ec8bf4b,0xbf4f3f7ebf6c3f1c,0xbf103f29bf3f3f53,0x3f54bf403f2abf11
.quad 0x3f78bf803f76bf5a,0x3e813c7bbe903f07,0xbdb63f2fbf7d3f60,0xbf7f3f3bbe20bef8,0xbf683da93f54bf66,0x3ed7bf7f3f103ee2,0x3f33bf4bbf023f6b,0x3f373f1cbf5dbecb,0x3edf3f7c3db6bf70,0xbf663e383f7f3eb4,0xbf7fbf073eb13f74,0xbddbbf5abf70be9c,0x3e70be8dbf37bf77,0x3f793f763f333e84,0x3f563f663f723f7a,0xbf0cbee2bea8be57
.quad 0xbf17bf48bf6cbf7e,0xbf4fbf1fbec8be07,0xbf54bf7fbf3fbe38,0xbf103d843f2a3f7c,0xbf78bf323e903f79,0xbe813f383f763e6a,0xbf7fbd0a3f7d3e8d,0x3db63f803e20bf76,0xbf683f253f10bf72,0x3ed73f43bf54bea5,0xbf373f7ebf02bebd,0x3f333e07bf5d3f6e,0xbedf3f53bf7f3f69,0x3f66bf113db63ed4,0xbddb3e6abeb13eea,0x3f7fbf793f70bf64
.quad 0x3e70bef83f33bf5e,0x3f79bf603f37bf00,0x3f0cbf723f72bf0b,0x3f56bea5bea83f57,0x3f4cbf6b3ddb3f50,0x3f1a3ecbbf7f3f15,0x3f74bed4bf5a3f1f,0x3e993f69bf06bf48,0x3f803e9cbf56bf40,0xbd233f743f0cbf29,0x3f6d3f5e3e0dbf32,0xbec03f003f7e3f38,0x3f3f3f7a3f743f2f,0xbf2abe573e993f3b,0x3ef63f153f2e3f43,0xbf61bf50bf3cbf25
.quad 0x3f1b3f4f3f723f80,0x3f4c3f163ea73d17,0xbf0c3de23f373f7f,0x3f573f7e3f333db0,0xbf79bf2a3eb23f7e,0xbe6d3f403f703e0a,0xbde2bf80bdb03f7c,0xbf7e3c493f7f3e3b,0x3f66bf2ebf013f79,0xbee1bf3c3f5d3e6d,0x3f373db0bf533f76,0x3f33bf7f3f113e8f,0xbed53f4cbf7d3f72,0x3f69bf1b3e233ea7,0xbf7f3f7cbf763f6e,0xbdb03e3bbe8f3ebe
.quad 0xbe823f06bf403f69,0xbf783f5abf2a3ed5,0x3f53be8fbeca3f63,0xbf113f76bf6b3eec,0x3f4fbf663d173f5d,0x3f163ee1bf803f01,0xbe8fbf6e3eec3f57,0x3f76bebebf633f0c,0xbf80beb23f4c3f4f,0x3d7bbf70bf1b3f16,0xbeca3eec3f7a3f48,0xbf6bbf63be543f20,0x3f3c3f783f793f40,0xbf2ebe823e6d3f2a,0x3f633f573f483f37,0x3eec3f0c3f203f33
.quad 0xbf01be6d3d7b3eb2,0x3f5d3f793f803f70,0x3e3bbef7bf6ebf74,0xbf7cbf60bebe3e9b,0x3e233f723f3cbe82,0x3f7d3ea7bf2ebf78,0xbef7bf6b3e9b3f7a,0xbf603eca3f74be54,0x3f403ed5bf7e3e23,0x3f2abf69be0a3f7d,0xbf6e3e9b3f0cbf7e,0xbebe3f74bf573de2,0x3f80bf5d3f06bd7b,0x3d17bf013f5abf80,0xbf743f7abf7e3f80,0x3e9bbe543de2bc49
.quad 0x3f4cbf163ea7bd17,0xbf1b3f4fbf723f80,0xbf0cbde23f37bf7f,0x3f57bf7e3f33bdb0,0x3e6d3f40bf703e0a,0xbf793f2a3eb2bf7e,0x3de2bf803db03f7c,0x3f7e3c49bf7f3e3b,0xbee13f3c3f5dbe6d,0xbf66bf2e3f013f79,0x3f37bdb0bf53bf76,0x3f333f7f3f11be8f,0xbf69bf1bbe233ea7,0xbed5bf4cbf7dbf72,0x3f7f3f7c3f763f6e,0x3db03e3b3e8f3ebe
.quad 0xbf7ebf7dbf66bf3c,0xbe0a3e233ee13f2e,0x3e543f483f803f44,0x3f7a3f20bc49bf25,0x3f5abd7bbf69bf4c,0xbf06bf80bed53f1b,0xbf48bf333f253f53,0xbf203f373f44bf11,0xbea73f80be82bf5a,0x3f723d17bf783f06,0x3f80bf25be3b3f60,0xbc49bf443f7cbef7,0xbeb2be0a3f16bf66,0xbf703f7ebf4f3ee1,0xbf443f53bf603f6b,0x3f25bf113ef7beca
.quad 0x3f5dbf793f80bf70,0x3f01be6dbd7b3eb2,0x3e3b3ef7bf6e3f74,0xbf7c3f60bebebe9b,0xbf7d3ea73f2ebf78,0x3e23bf723f3c3e82,0x3ef7bf6bbe9b3f7a,0x3f603ecabf74be54,0x3f2a3f69be0abf7d,0xbf403ed53f7e3e23,0xbf6ebe9b3f0c3f7e,0xbebebf74bf57bde2,0xbd17bf01bf5abf80,0x3f803f5d3f063d7b,0x3f743f7a3f7e3f80,0xbe9bbe54bde2bc49
.quad 0xbe82bf06bf40bf69,0xbf78bf5abf2abed5,0xbf11bf76bf6bbeec,0xbf53be8f3eca3f63,0xbf4fbf66bd173f5d,0xbf163ee13f803f01,0xbf76bebe3f633f0c,0xbe8f3f6e3eecbf57,0xbf803eb23f4cbf4f,0x3d7b3f70bf1bbf16,0xbf6b3f63be54bf20,0x3eca3eecbf7a3f48,0xbf3c3f78bf793f40,0x3f2ebe82be6d3f2a,0xbeec3f0cbf203f33,0x3f63bf573f48bf37
.quad 0xbe0abe233ee1bf2e,0x3f7ebf7d3f66bf3c,0x3e54bf483f80bf44,0x3f7abf20bc493f25,0x3f06bf803ed53f1b,0x3f5a3d7bbf693f4c,0x3f48bf33bf253f53,0x3f203f37bf44bf11,0x3f72bd17bf78bf06,0x3ea73f803e82bf5a,0x3f803f25be3bbf60,0xbc493f443f7c3ef7,0x3f703f7e3f4f3ee1,0xbeb23e0a3f163f66,0x3f443f533f603f6b,0xbf25bf11bef7beca
.quad 0x3f0b3f473f703f80,0x3f573f213eb43d23,0xbf1c3d6f3f323f7f,0x3f4b3f803f383db6,0xbf74bf333ea53f7e,0xbe9c3f373f723e0d,0xbd0abf80bde83f7c,0xbf80bd233f7e3e3f,0x3f6ebf24bf073f79,0xbebdbf443f5a3e70,0x3f293e0dbf573f76,0x3f40bf7e3f0b3e90,0xbef83f54bf7e3f72,0x3f60bf103e073ea8,0xbf7d3f79bf743f6d,0xbe263e70be9c3ec0
.quad 0xbe383ef6bf3b3f68,0xbf7c3f61bf2f3ed7,0x3f5ebea8bebd3f63,0xbf003f72bf6e3eed,0x3f43bf6c3d843f5d,0x3f253ec8bf7f3f02,0xbeb4bf683ef83f56,0x3f70bed7bf603f0c,0xbf80be993f503f4f,0xbc7bbf74bf153f17,0xbea53f023f7c3f47,0xbf72bf5dbe383f21,0x3f483f7b3f773f3f,0xbf1fbe513e843f2a,0x3f5a3f4f3f433f37,0x3f073f173f253f33
.quad 0xbf25bec0bd843e81,0x3f433f6d3f7f3f78,0x3eb4beb1bf60bf7b,0xbf70bf70bef83e51,0xbc7b3f633f50be20,0x3f803eedbf15bf7d,0xbea5bf783e383f7f,0xbf723e813f7cbddb,0x3f1f3f0cbf773d6f,0x3f48bf56be843f80,0xbf5a3e203f25bf80,0xbf073f7dbf433c17,0x3f7abf473ed43d23,0x3e57bf213f69bf80,0xbf7e3f80bf803f7f,0x3e07bd6fbc7b3db6
.quad 0x3f64bf333ee2be0d,0xbeea3f37bf663f7e,0xbf2f3d233f1fbf7c,0x3f3bbf803f48be3f,0x3ecb3f24bf793e70,0xbf6b3f443e6abf79,0xbd84bf7e3e573f76,0x3f7fbe0dbf7a3e90,0xbe8d3f543f4bbea8,0xbf76bf103f1c3f72,0x3f15be70bf64bf6d,0x3f503f793eeabec0,0xbf53bef6bd0a3ed7,0xbf11bf61bf80bf68,0x3f773f723f6b3f63,0x3e843ea83ecb3eed
.quad 0xbf6bbf7fbf79bf5a,0xbecbbdb63e6a3f06,0xbd843f1a3f7a3f61,0x3f7f3f4c3e57bef6,0x3f763e3fbf4bbf66,0xbe8dbf7cbf1c3edf,0xbf15bf5a3eea3f6c,0xbf503f063f64bec8,0xbf113f76bd0abf70,0x3f533e90bf803eb1,0x3f77bedfbecb3f74,0x3e84bf663f6bbe99,0xbda9bec03f40bf78,0xbf7f3f6dbf293e81,0xbf693f70bf763f7b,0x3ed4beb13e8dbe51
.quad 0x3f32bf633f7dbf7d,0x3f38beed3e263e20,0x3ee23e81bf533f7f,0xbf663f78bf11bddb,0xbf7e3f0c3f00bf80,0xbde8bf563f5e3d6f,0x3e6abf7dbda93f80,0x3f793e20bf7fbc17,0x3f573f47beb4bf80,0xbf0b3f213f70bd23,0xbf4bbd6f3f383f7f,0xbf1cbf80bf323db6,0xbe9cbf33bf72bf7e,0x3f743f373ea5be0d,0x3f803f803f7e3f7c,0xbd0a3d233de83e3f
.quad 0x3de8be51bf00bf3f,0xbf7ebf7bbf5ebf2a,0xbe6abf4fbf7fbf33,0xbf79bf173da93f37,0xbf0bbf7fbeb43f2e,0xbf573ddb3f703f3c,0xbf4bbf2a3f323f44,0xbf1c3f3f3f38bf24,0xbf743c173f72bf1a,0xbe9c3f80bea5bf4c,0xbf803f2e3de8bf54,0x3d0a3f3cbf7e3f10,0xbf6e3f7fbf5a3f06,0x3ebd3db6bf073f5a,0xbf403f4cbf573f61,0x3f29bf1a3f0bbef6
.quad 0xbef83e3f3e07bedf,0x3f60bf7c3f7ebf66,0xbe26bf063f74bf6c,0x3f7dbf5a3e9c3ec8,0x3e38bf763f2f3eb1,0x3f7cbe90bf3b3f70,0x3f00bf66bebd3f74,0x3f5e3edfbf6ebe99,0x3f43bec0bf7fbe81,0x3f253f6dbd84bf78,0x3f703eb1bef8bf7b,0x3eb43f703f603e51,0x3f803f633f153e20,0x3c7b3eed3f503f7d,0x3f723f783f7c3f7f,0xbea5be81be38bddb
.quad 0x3ef43f3f3f6d3f80,0x3f613f2b3ec13d30,0xbf2b3bc93f2d3f7f,0x3f3f3f803f3d3dbc,0xbf6dbf3d3e983f7d,0xbec13f2d3f753e10,0x3d30bf7fbe103f7b,0xbf80bdbc3f7d3e42,0x3f75bf1abf0d3f79,0xbe98bf4d3f563e73,0x3f1a3e42bf5b3f75,0x3f4dbf7b3f053e92,0xbf0d3f5bbf7f3f72,0x3f56bf053dd53eaa,0xbf793f75bf723f6d,0xbe733e92beaa3ec1
.quad 0xbdd53edebf363f68,0xbf7f3f67bf343ed8,0x3f67bec1beaf3f63,0xbede3f6dbf713eef,0x3f36bf713dbc3f5c,0x3f343eafbf7f3f02,0xbed8bf633f023f56,0x3f68beefbf5c3f0d,0xbf7fbe7f3f543f4f,0xbdbcbf78bf103f17,0xbe7f3f0d3f7d3f47,0xbf78bf56be1c3f21,0x3f543f7d3f753f3f,0xbf10be1c3e923f2b,0x3f4f3f473f3f3f36,0x3f173f213f2b3f34
.quad 0xbf45bf02be423e1c,0x3f243f5c3f7b3f7d,0x3f02be4ebf4fbf7f,0xbf5cbf7bbf173dd5,0xbe423f4f3f61bd62,0x3f7b3f17bef4bf80,0xbe1cbf7f3d623f80,0xbf7d3dd53f80bbc9,0x3ef43f2bbf6dbd30,0x3f61bf3fbec13f80,0xbf3f3bc93f3dbf7f,0xbf2b3f80bf2dbdbc,0x3f6dbf2d3e983e10,0x3ec1bf3d3f75bf7d,0xbf803f7fbf7d3f7b,0xbd303dbcbe103e42
.quad 0x3f75bf4d3f0dbe73,0xbe983f1abf563f79,0xbf4d3e423f05bf75,0x3f1abf7b3f5bbe92,0x3f0d3f05bf7f3eaa,0xbf563f5b3dd5bf72,0xbe73bf753eaa3f6d,0x3f79be92bf723ec1,0xbdd53f673f36bed8,0xbf7fbede3f343f68,0x3edebec1bf71bf63,0x3f673f6d3eafbeef,0xbf36beaf3dbc3f02,0xbf34bf71bf7fbf5c,0x3f683f633f5c3f56,0x3ed83eef3f023f0d
.quad 0xbf47bf72bf80bf71,0xbf21beaa3bc93eaf,0xbeaa3ec73f683f75,0x3f723f6c3ed8be98,0x3f803ed8bf24bf78,0xbbc9bf68bf453e7f,0xbeafbf753e7f3f7b,0xbf713e983f78be4e,0xbf453f5c3e42bf7d,0x3f243f02bf7b3e1c,0x3f5cbe4ebf173f7f,0x3f02bf7b3f4fbdd5,0x3e42bf173f61bf80,0xbf7b3f4fbef43d62,0xbf7d3f7fbf803f80,0x3e1cbdd53d62bbc9
.quad 0x3ef4bf3f3f6dbf80,0x3f61bf2b3ec1bd30,0x3f2b3bc9bf2d3f7f,0xbf3f3f80bf3d3dbc,0xbf6d3f3d3e98bf7d,0xbec1bf2d3f75be10,0xbd30bf7f3e103f7b,0x3f80bdbcbf7d3e42,0x3f753f1abf0dbf79,0xbe983f4d3f56be73,0xbf1a3e423f5b3f75,0xbf4dbf7bbf053e92,0xbf0dbf5bbf7fbf72,0x3f563f053dd5beaa,0x3f793f753f723f6d,0x3e733e923eaa3ec1
.quad 0x3eef3e10be4ebf05,0xbf63bf7dbf7bbf5b,0x3e10bf10bf79bf61,0xbf7dbf54be733ef4,0xbe4ebf79bf213ede,0xbf7bbe733f473f67,0xbf05bf613ede3f6c,0xbf5b3ef43f67bec7,0xbf47beaa3f80beaf,0xbf213f72bbc9bf71,0xbf723ec73ed8bf75,0xbeaa3f6cbf683e98,0xbf803f68bf243e7f,0x3bc93ed8bf453f78,0xbf713f75bf783f7b,0x3eafbe983e7fbe4e
.quad 0xbf453f02be42be1c,0x3f24bf5c3f7bbf7d,0xbf02be4e3f4fbf7f,0x3f5cbf7b3f173dd5,0xbe42bf4f3f613d62,0x3f7bbf17bef43f80,0x3e1cbf7fbd623f80,0x3f7d3dd5bf80bbc9,0x3ef4bf2bbf6d3d30,0x3f613f3fbec1bf80,0x3f3f3bc9bf3dbf7f,0x3f2b3f803f2dbdbc,0x3f6d3f2d3e98be10,0x3ec13f3d3f753f7d,0x3f803f7f3f7d3f7b,0x3d303dbc3e103e42
.quad 0x3ed13f363f6a3f80,0x3f6a3f343ece3d3c,0xbf39bd3c3f283f7f,0x3f313f803f413dc2,0xbf65bf453e8a3f7d,0xbee53f233f773e13,0x3df4bf7dbe2c3f7b,0xbf7ebe133f7c3e45,0x3f7abf0fbf133f79,0xbe63bf543f523e76,0x3f0a3e76bf5e3f75,0x3f58bf793efe3e93,0xbf1d3f61bf7f3f71,0x3f4abef33d9d3eab,0xbf733f71bf6f3f6d,0xbe9f3eabbeb73ec2
.quad 0xbce23ec5bf313f68,0xbf803f6cbf393ed9,0x3f6fbed9bea23f62,0xbeba3f68bf733ef0,0x3f28bf753df43f5c,0x3f413e96bf7e3f03,0xbefbbf5c3f083f55,0x3f5fbf03bf593f0e,0xbf7cbe4b3f583f4e,0xbe2cbf7bbf0a3f18,0xbe323f183f7e3f46,0xbf7cbf4ebe003f22,0x3f5e3f7f3f733f3e,0xbefebdcf3e9f3f2b,0x3f423f3e3f3a3f36,0x3f273f2b3f303f34
.quad 0xbf5ebf22be9f3d56,0x3efe3f463f733f80,0x3f27bd56bf3abf80,0xbf42bf80bf303b49,0xbeb73f363f6f3d3c,0x3f6f3f34bebabf80,0x3cb0bf80bd903f7f,0xbf80bd3c3f7f3dc2,0x3ea23f45bf5fbe13,0x3f73bf23befb3f7d,0xbf1ebe133f51bf7b,0xbf493f7dbf14be45,0x3f59bf0f3e323e76,0x3f08bf543f7cbf79,0xbf7a3f79bf773f75,0xbe5d3e76be873e93
.quad 0x3f7ebf613f27beab,0xbe003ef3bf423f71,0xbf643eab3ed1bf6d,0x3ee8bf713f6abec2,0x3f303ec5bf803ed9,0xbf3a3f6cbcb0bf68,0xbecebf683ee53f62,0x3f6abed9bf653ef0,0x3d903f753f1ebf03,0xbf7fbe963f493f5c,0x3e8abf03bf7abf55,0x3f773f5c3e63bf0e,0xbf14be4b3e5d3f18,0xbf51bf7bbf7abf4e,0x3f523f4e3f4a3f46,0x3f133f183f1d3f22
.quad 0xbf14bf55bf7abf7d,0xbf51bf0ebe5d3e19,0xbf133e193f4a3f7f,0x3f523f7d3f1dbdcf,0x3f773f22bee8bf80,0x3e87bf46bf643d56,0xbd9dbf803ce23f80,0xbf7f3d563f80bb49,0xbf6a3f363ecebf80,0x3ed13f34bf6abd3c,0x3f313d3cbf413f7f,0x3f39bf803f283dc2,0x3ee5bf453f77bf7d,0xbf653f23be8abe13,0xbf7e3f7dbf7c3f7b,0xbdf43e13be2c3e45
.quad 0x3e63bf0f3f52bf79,0x3f7abf543f13be76,0x3f58be76befe3f75,0xbf0a3f79bf5e3e93,0xbf4a3f613d9dbf71,0xbf1dbef33f7fbeab,0xbe9fbf713eb73f6d,0x3f73beabbf6f3ec2,0x3f803ec5bf39bf68,0xbce23f6c3f31bed9,0xbeba3ed93f733f62,0xbf6fbf68bea23ef0,0xbf41bf75bf7ebf5c,0x3f283e96bdf4bf03,0x3f5f3f5c3f593f55,0x3efb3f033f083f0e
.quad 0x3f413ef03df4be7c,0xbf28bf62bf7ebf78,0x3efbbe7cbf59bf7b,0xbf5fbf78bf083e4b,0x3e2cbf55bf583e19,0xbf7cbf0e3f0a3f7d,0xbe32bf7d3e003f7f,0xbf7c3e193f7ebdcf,0xbefebf223f73bd56,0xbf5e3f463e9fbf80,0xbf423d563f30bf80,0xbf273f80bf3a3b49,0xbf6f3f36bebabd3c,0xbeb73f34bf6f3f80,0xbf803f80bf7f3f7f,0xbcb03d3cbd903dc2
.quad 0xbf733f45befb3e13,0x3ea2bf233f5fbf7d,0xbf493e133f14bf7b,0x3f1ebf7d3f51be45,0xbf08bf0f3f7cbe76,0x3f59bf54be323f79,0xbe5dbf793e873f75,0x3f7abe76bf773e93,0x3e00bf61bf423eab,0x3f7e3ef3bf27bf71,0x3ee8beabbf6abf6d,0x3f643f713ed1bec2,0x3f3a3ec5bcb0bed9,0x3f303f6c3f803f68,0x3f6a3f683f653f62,0x3ece3ed93ee53ef0
.quad 0x3f803f803f803f80,0,0x3e953f223f623f7f,0x3f753f463ef13dc9,0xbf55be483f0e3f7b,0x3f0e3f7b3f553e48,0xbf46bf623dc93f75,0xbf223ef13f7f3e95,0x3ec4bf6dbec43f6d,0xbf6dbec43f6d3ec4,0x3f7fbe95bf463f62,0x3dc9bf753f223ef1,0x3e483f0ebf7b3f55,0x3f7bbf553e483f0e,0xbf623f7fbf753f46,0x3ef1bdc9be953f22
.quad 0xbf353f35bf353f35,0xbf353f35bf353f35,0x3ef1bdc9be953f22,0xbf623f7fbf753f46,0x3f7bbf553e483f0e,0x3e483f0ebf7b3f55,0x3dc9bf753f223ef1,0x3f7fbe95bf463f62,0xbf6dbec43f6d3ec4,0x3ec4bf6dbec43f6d,0xbf223ef13f7f3e95,0xbf46bf623dc93f75,0x3f0e3f7b3f553e48,0xbf55be483f0e3f7b,0x3f753f463ef13dc9,0x3e953f223f623f7f
.quad 0x3f803f803f803f80,0,0xbf75bf46bef1bdc9,0x3e953f223f623f7f,0x3f553e48bf0ebf7b,0xbf0ebf7bbf55be48,0xbf223ef13f7f3e95,0x3f463f62bdc9bf75,0x3ec4bf6dbec43f6d,0xbf6dbec43f6d3ec4,0xbdc93f75bf22bef1,0x3f7fbe95bf463f62,0xbe48bf0e3f7bbf55,0xbf7b3f55be48bf0e,0x3ef1bdc9be953f22,0x3f62bf7f3f75bf46
.quad 0xbf353f35bf353f35,0xbf353f35bf353f35,0x3f62bf7f3f75bf46,0x3ef1bdc9be953f22,0xbf7b3f55be48bf0e,0xbe48bf0e3f7bbf55,0x3f7fbe95bf463f62,0xbdc93f75bf22bef1,0xbf6dbec43f6d3ec4,0x3ec4bf6dbec43f6d,0x3f463f62bdc9bf75,0xbf223ef13f7f3e95,0xbf0ebf7bbf55be48,0x3f553e48bf0ebf7b,0x3e953f223f623f7f,0xbf75bf46bef1bdc9
.quad 0x3f803f803f803f80,0,0xbe95bf22bf62bf7f,0xbf75bf46bef1bdc9,0xbf55be483f0e3f7b,0x3f0e3f7b3f553e48,0x3f463f62bdc9bf75,0x3f22bef1bf7fbe95,0x3ec4bf6dbec43f6d,0xbf6dbec43f6d3ec4,0xbf7f3e953f46bf62,0xbdc93f75bf22bef1,0x3e483f0ebf7b3f55,0x3f7bbf553e483f0e,0x3f62bf7f3f75bf46,0xbef13dc93e95bf22
.quad 0xbf353f35bf353f35,0xbf353f35bf353f35,0xbef13dc93e95bf22,0x3f62bf7f3f75bf46,0x3f7bbf553e483f0e,0x3e483f0ebf7b3f55,0xbdc93f75bf22bef1,0xbf7f3e953f46bf62,0xbf6dbec43f6d3ec4,0x3ec4bf6dbec43f6d,0x3f22bef1bf7fbe95,0x3f463f62bdc9bf75,0x3f0e3f7b3f553e48,0xbf55be483f0e3f7b,0xbf75bf46bef1bdc9,0xbe95bf22bf62bf7f
.quad 0x3f803f803f803f80,0,0x3f753f463ef13dc9,0xbe95bf22bf62bf7f,0x3f553e48bf0ebf7b,0xbf0ebf7bbf55be48,0x3f22bef1bf7fbe95,0xbf46bf623dc93f75,0x3ec4bf6dbec43f6d,0xbf6dbec43f6d3ec4,0x3dc9bf753f223ef1,0xbf7f3e953f46bf62,0xbe48bf0e3f7bbf55,0xbf7b3f55be48bf0e,0xbef13dc93e95bf22,0xbf623f7fbf753f46
.quad 0xbf353f35bf353f35,0xbf353f35bf353f35,0xbf623f7fbf753f46,0xbef13dc93e95bf22,0xbf7b3f55be48bf0e,0xbe48bf0e3f7bbf55,0xbf7f3e953f46bf62,0x3dc9bf753f223ef1,0xbf6dbec43f6d3ec4,0x3ec4bf6dbec43f6d,0xbf46bf623dc93f75,0x3f22bef1bf7fbe95,0xbf0ebf7bbf55be48,0x3f553e48bf0ebf7b,0xbe95bf22bf62bf7f,0x3f753f463ef13dc9
.quad 0x3f7f3f803f803f80,0x3da33d623cfb3bc9,0x3e5a3f173f5e3f7f,0x3f7a3f4f3eff3dd5,0xbf60be7f3f083f7b,0x3efa3f783f593e4e,0xbf38bf683d8a3f75,0xbf323ed83f7f3e98,0x3ee9bf67bed23f6c,0xbf64bede3f693ec7,0x3f7cbe73bf4b3f61,0x3e35bf793f1c3ef4,0x3dee3f1abf7c3f54,0x3f7ebf4d3e293f10,0xbf6b3f80bf733f45,0x3ecdbd30bea43f24
.quad 0xbf263f2bbf2f3f34,0xbf433f3fbf3a3f36,0x3f0abe1cbe863f21,0xbf573f7dbf773f47,0x3f76bf5c3e663f0d,0x3e8c3f02bf793f56,0x3c97bf713f283eef,0x3f80beafbf413f63,0xbf74beaa3f6f3ec1,0x3e9ebf72beb53f6d,0xbf123f053f7e3e92,0xbf52bf5b3e043f75,0x3f1f3f7d3f503e42,0xbf49be103f153f7b,0x3f6e3f3d3ee33dbc,0x3ebb3f2d3f653f7f
.quad 0x3f7c3f7d3f7e3f7f,0x3e353e1c3e043dd5,0xbf7ebf5cbf15be4e,0x3dee3f023f503f7b,0x3f6b3eafbee3bf75,0xbecdbf71bf65be98,0xbf433eaa3f803ec7,0x3f263f723cfbbf6c,0x3f0abf5bbeff3f61,0xbf57bf053f5e3ef4,0xbe8c3f7dbf08bf10,0x3f76be10bf593f54,0xbc97bf2d3f7fbf45,0xbf803f3dbd8abf24,0x3e9e3d62bed23f36,0x3f74bf803f69bf34
.quad 0xbf123f17bf1c3f21,0xbf523f4fbf4b3f47,0x3f49bf783f7cbf56,0x3f1fbe7fbe293f0d,0xbf6e3f68bea4beef,0xbebbbed83f73bf63,0x3f7fbedebf2f3f6d,0x3da33f67bf3abec1,0xbf7abe733f773e92,0x3e5abf79be863f75,0x3f603f4dbe66bf7b,0xbefa3f1a3f793e42,0xbf32bf80bf41bdbc,0x3f383d30bf28bf7f,0x3ee93f3f3f6f3f80,0xbf64bf2bbeb53bc9
.quad 0x3f763f783f793f7b,0x3e8c3e7f3e663e4e,0xbc97bed8bf41bf75,0xbf80bf68bf28be98,0xbf74bede3eb53f6c,0x3e9e3f673f6f3ec7,0x3f123f793e04bf61,0x3f52be73bf7ebef4,0x3f1fbf4dbf153f54,0xbf49bf1a3f503f10,0xbf6e3d303f65bf45,0xbebb3f80bee3bf24,0xbda33f3fbf803f34,0x3f7fbf2bbcfb3f36,0x3f7abf7d3f5ebf21,0xbe5abe1c3effbf47
.quad 0xbefa3f02bf083f0d,0xbf603f5cbf593f56,0xbf323eaf3d8abeef,0x3f38bf713f7fbf63,0x3f64bf723ed23ec1,0x3ee93eaabf693f6d,0x3e353f5bbf4bbe92,0xbf7c3f053f1cbf75,0xbf7ebe103f7c3e42,0x3deebf7dbe293f7b,0x3ecdbf2dbf73bdbc,0x3f6b3f3dbea4bf7f,0x3f433f803f2fbbc9,0xbf263d623f3a3f80,0xbf57bf17be863dd5,0xbf0abf4fbf77bf7f
.quad 0x3f6e3f713f733f75,0x3ebb3eaf3ea43e98,0x3f7f3f723f3a3ec7,0x3da3beaabf2fbf6c,0x3f7a3f05be86bf61,0xbe5abf5bbf77bef4,0x3f60be10bf79bf10,0xbefabf7dbe663f54,0x3f32bf3dbf283f45,0xbf38bf2d3f413f24,0x3ee9bf803eb53f36,0xbf64bd623f6fbf34,0x3e35bf4f3f7ebf21,0xbf7c3f173e04bf47,0xbdeebe7f3f15bf56,0xbf7e3f78bf503f0d
.quad 0xbecd3ed8bee33eef,0xbf6b3f68bf653f63,0xbf263f67bf803f6d,0xbf433edebcfbbec1,0xbf573f79beffbe92,0xbf0abe733f5ebf75,0xbf763f1a3f08bf7b,0xbe8cbf4d3f593e42,0xbf80bd303f7f3dbc,0x3c97bf80bd8a3f7f,0xbf74bf2b3ed23f80,0x3e9ebf3fbf693bc9,0xbf52bf7dbf1c3dd5,0x3f12be1cbf4bbf7f,0xbf1fbf5cbf7cbf7b,0x3f493f023e29be4e
.quad 0x3f7d3f7e3f803f80,0x3e233de23d7b3c49,0x3e0a3f0c3f5a3f7e,0x3f7e3f573f063de2,0xbf69be9b3f013f7a,0x3ed53f743f5d3e54,0xbf2abf6e3d173f74,0xbf403ebe3f803e9b,0x3f06bf60bee13f6b,0xbf5abef73f663eca,0x3f78be3bbf4f3f60,0x3e82bf7c3f163ef7,0x3d173f25bf7e3f53,0x3f80bf443e0a3f11,0xbf723f80bf703f44,0x3ea73c49beb23f25
.quad 0xbf163f20bf2a3f33,0xbf4f3f48bf403f37,0x3f1bbe54be6d3f20,0xbf4c3f7abf793f48,0x3f70bf633e823f0c,0x3eb23eecbf783f57,0xbd7bbf6b3f2e3eec,0x3f80becabf3c3f63,0xbf79be8f3f723ebe,0x3e6dbf76bea73f6e,0xbf013f113f7d3e8f,0xbf5dbf533e233f76,0x3f2e3f7f3f4c3e3b,0xbf3cbdb03f1b3f7c,0x3f663f333ed53db0,0x3ee13f373f693f7f
.quad 0x3f703f743f783f7a,0x3eb23e9b3e823e54,0xbf80bf6ebf2ebe9b,0xbd7b3ebe3f3c3f74,0x3f793ef7bea7bf6b,0xbe6dbf60bf72beca,0xbf5d3e3b3f7d3ef7,0x3f013f7c3e23bf60,0x3f2ebf44bf1b3f53,0xbf3cbf253f4c3f11,0xbee13f80bed5bf25,0x3f663c49bf693f44,0x3e23bf483f80bf33,0xbf7d3f203d7bbf37,0x3e0a3e54bf063f48,0x3f7ebf7a3f5abf20
.quad 0xbed53eecbf013f0c,0xbf693f63bf5d3f57,0x3f2abf6b3f80bf63,0x3f40becabd173eec,0xbf5a3f76bee1bebe,0xbf06be8f3f66bf6e,0x3f78bf11bf163f76,0x3e823f53bf4fbe8f,0xbf80bdb03f7e3e3b,0x3d17bf7fbe0a3f7c,0x3f723f33beb2bf7f,0xbea73f373f703db0,0xbf4fbf7ebf2a3c49,0x3f16bde2bf40bf80,0x3f1b3f573f793f7e,0xbf4cbf0cbe6d3de2
.quad 0x3f5a3f603f663f6b,0x3f063ef73ee13eca,0x3e82be3bbf16bf60,0xbf78bf7cbf4fbef7,0xbf80bf253e0a3f53,0x3d173f443f7e3f11,0x3ea73f803eb2bf44,0x3f723c49bf70bf25,0x3f4fbf20bf403f33,0xbf16bf483f2a3f37,0xbf4cbe543f79bf20,0xbf1b3f7abe6dbf48,0xbeb23f63bf783f0c,0x3f70beecbe823f57,0x3f80bf6b3f3cbeec,0x3d7bbeca3f2ebf63
.quad 0xbe6d3e8fbea73ebe,0xbf793f76bf723f6e,0xbf5d3f11be23be8f,0x3f01bf533f7dbf76,0x3f3cbf7f3f1b3e3b,0x3f2e3db0bf4c3f7c,0x3ee13f33bf69bdb0,0xbf663f373ed5bf7f,0xbf7d3de23f80bc49,0xbe23bf7e3d7b3f80,0x3e0abf57bf5a3de2,0x3f7e3f0cbf06bf7e,0x3f693f743f01be54,0xbed53e9b3f5d3f7a,0xbf2abebebd173e9b,0xbf40bf6ebf80bf74
.quad 0x3f3c3f443f4c3f53,0x3f2e3f253f1b3f11,0x3f663f803f693f25,0x3ee13c49bed5bf44,0x3f7d3f483d7bbf33,0x3e23bf20bf80bf37,0x3f7e3e54bf5abf48,0xbe0abf7abf063f20,0x3f69beecbf5d3f0c,0xbed5bf633f013f57,0x3f40bf6b3d173f63,0xbf2abeca3f80beec,0x3f06bf763f66bebe,0xbf5a3e8f3ee1bf6e,0x3e82bf113f4fbf76,0xbf783f53bf163e8f
.quad 0xbd173db0be0a3e3b,0xbf803f7fbf7e3f7c,0xbea73f33bf703f7f,0xbf723f37beb2bdb0,0xbf163f7ebf403c49,0xbf4f3de23f2abf80,0xbf4c3f573e6dbf7e,0xbf1bbf0c3f79bde2,0xbf703e9b3f78be54,0xbeb2bf743e823f7a,0xbf80bebe3f2e3f74,0xbd7bbf6ebf3c3e9b,0xbf79bf60bea73eca,0x3e6dbef7bf72bf6b,0xbf5dbf7cbf7dbf60,0x3f013e3bbe23bef7
.quad 0x3f793f7c3f7f3f80,0x3e733e293dbc3c97,0x3d623eff3f563f7e,0x3f803f5e3f0d3dee,0xbf71beb53ef43f7a,0x3eaf3f6f3f613e5a,0xbf1abf733bc93f74,0xbf4d3ea43f803e9e,0x3f17bf59beef3f6b,0xbf4fbf083f633ecd,0x3f72be04bf543f60,0x3eaabf7e3f103efa,0xbd303f2fbf7f3f52,0x3f80bf3a3dd53f12,0xbf783f7fbf6d3f43,0x3e7f3d8abec13f26
.quad 0xbf053f15bf243f32,0xbf5b3f50bf453f38,0x3f2bbe86be4e3f1f,0xbf3f3f77bf7b3f49,0x3f68bf693e923f0a,0x3ed83ed2bf753f57,0xbe10bf653f343ee9,0x3f7dbee3bf363f64,0xbf7dbe663f753ebb,0x3e1cbf79be983f6e,0xbede3f1c3f7b3e8c,0xbf67bf4b3e423f76,0x3f3d3f803f473e35,0xbf2dbcfb3f213f7c,0x3f5c3f283ec73da3,0x3f023f413f6c3f7f
.quad 0x3f5c3f653f6d3f74,0x3f023ee33ec13e9e,0xbf79bf79bf45becd,0xbe733e663f243f6b,0x3f803f1cbe4ebf60,0xbd62bf4bbf7bbefa,0xbf713cfb3f753f12,0x3eaf3f803e92bf52,0x3f4dbf28bf343f43,0xbf1abf413f363f26,0xbf173f7cbe98bf38,0x3f4f3e29bf753f32,0x3eaabf5e3f7bbf1f,0xbf723eff3e42bf49,0xbd303eb5bf213f57,0x3f80bf6f3f47bf0a
.quad 0xbe7f3ea4bec73ee9,0xbf783f73bf6c3f64,0x3f05bf593f7fbf6e,0x3f5bbf083dbc3ebb,0xbf3f3f7ebf0dbe8c,0xbf2bbe043f56bf76,0x3f68bf2fbef43f7c,0x3ed83f3abf61be35,0xbf7d3d8a3f803da3,0xbe10bf7fbbc93f7f,0x3f7d3f15beefbf80,0xbe1c3f503f63bc97,0xbf67bf77bf103dee,0x3edebe86bf54bf7e,0x3f3d3f693f7f3f7a,0xbf2dbed2bdd53e5a
.quad 0x3f2d3f3a3f473f52,0x3f3d3f2f3f213f12,0x3f023d8abec7bf43,0xbf5cbf7fbf6cbf26,0xbf79bf50bdbc3f32,0xbe733f153f7f3f38,0x3d623f773f0dbf1f,0x3f803e86bf56bf49,0x3f71bed2bf613f0a,0xbeafbf693ef43f57,0xbf1abee33f80bee9,0xbf4d3f65bbc9bf64,0xbf173f79bf633ebb,0x3f4fbe66beef3f6e,0x3f72bf4b3f10be8c,0x3eaabf1c3f54bf76
.quad 0x3d303cfbbdd53e35,0xbf803f80bf7f3f7c,0xbf783f41bec1bda3,0x3e7fbf283f6dbf7f,0x3f05bf7c3f45bc97,0x3f5bbe29bf243f80,0x3f2b3effbf7b3dee,0xbf3f3f5e3e4ebf7e,0xbf683eb53f75be5a,0xbed8bf6f3e923f7a,0xbe10bf73bf363e9e,0x3f7d3ea4bf34bf74,0x3f7d3f593e98becd,0xbe1c3f083f753f6b,0xbedebe043e423efa,0xbf67bf7ebf7bbf60
.quad 0x3ede3eff3f103f1f,0x3f673f5e3f543f49,0x3f2d3f6f3f7f3f57,0x3f3d3eb5bdd5bf0a,0x3f5c3f733ec1bee9,0x3f02bea4bf6dbf64,0x3f793f08bf24bf6e,0x3e73bf59bf453ebb,0x3f80be04bf7b3e8c,0xbd62bf7e3e4e3f76,0x3f71bf3abe923f7c,0xbeafbf2f3f75be35,0x3f4dbf7f3f36bda3,0xbf1abd8a3f34bf7f,0x3f17bf503f75bf80,0xbf4f3f15be98bc97
.quad 0x3eaabe863e42bdee,0xbf723f77bf7b3f7e,0x3d303ed2bf473f7a,0xbf803f69bf213e5a,0xbe7f3f65bf6c3e9e,0xbf783ee33ec7bf74,0xbf053f79bdbcbf6b,0xbf5bbe663f7fbecd,0xbf3f3f1c3f56befa,0xbf2bbf4b3f0d3f60,0xbf68bcfb3f613f52,0xbed8bf80bef43f12,0xbf7dbf28bbc93f26,0xbe10bf41bf80bf43,0xbf7dbf7cbf63bf32,0x3e1cbe29beefbf38
.quad 0x3f733f7a3f7e3f80,0x3ea13e603dfb3cc9,0xbcc93ee63f513f7e,0x3f803f653f133dfb,0xbf77becf3ee63f7a,0x3e893f6a3f653e60,0xbf09bf77bcc93f73,0xbf583e893f803ea1,0x3f27bf51befc3f6a,0xbf42bf133f5f3ecf,0x3f6abd97bf583f5f,0x3ecfbf7f3f093efc,0xbdfb3f39bf7f3f51,0x3f7ebf313d973f13,0xbf7c3f7ebf6a3f42,0x3e2f3dfbbecf3f27
.quad 0xbee63f09bf1d3f31,0xbf653f58bf4a3f39,0x3f39bea1be2f3f1d,0xbf313f73bf7c3f4a,0x3f5fbf6f3ea13f09,0x3efc3eb8bf733f58,0xbe60bf5f3f393ee6,0x3f7abefcbf313f65,0xbf7fbe2f3f773eb8,0x3d97bf7cbe893f6f,0xbeb83f273f7a3e89,0xbf6fbf423e603f77,0x3f4a3f803f423e2f,0xbf1d3cc93f273f7c,0x3f513f1d3eb83d97,0x3f133f4a3f6f3f7f
.quad 0x3f423f513f5f3f6a,0x3f273f133efc3ecf,0xbf6abf7fbf58befc,0xbecf3d973f093f5f,0x3f7e3f39bd97bf51,0x3dfbbf31bf7fbf13,0xbf7cbdfb3f6a3f27,0x3e2f3f7e3ecfbf42,0x3f65bf09bf4a3f31,0xbee6bf583f1d3f39,0xbf393f73be2fbf4a,0x3f313ea1bf7c3f1d,0x3efcbf6f3f73bf09,0xbf5f3eb83ea1bf58,0xbe603efcbf393f65,0x3f7abf5f3f31bee6
.quad 0xbd973e2fbe893eb8,0xbf7f3f7cbf773f6f,0x3eb8bf423f7abf77,0x3f6fbf273e603e89,0xbf1d3f80bf27be2f,0xbf4a3cc93f42bf7c,0x3f51bf4abeb83f7f,0x3f133f1dbf6fbd97,0xbf733e603f7ebcc9,0xbea1bf7a3dfb3f80,0x3f803ee6bf13bf7e,0x3cc93f653f51bdfb,0xbf77bf6abee63e60,0x3e89becfbf65bf7a,0x3f583f773f803f73,0xbf09be893cc93ea1
.quad 0x3ee63f093f1d3f31,0x3f653f583f4a3f39,0x3f393ea1be2fbf1d,0xbf31bf73bf7cbf4a,0xbf5fbf6fbea13f09,0xbefc3eb83f733f58,0xbe603f5f3f39bee6,0x3f7a3efcbf31bf65,0x3f7fbe2fbf773eb8,0xbd97bf7c3e893f6f,0xbeb8bf273f7abe89,0xbf6f3f423e60bf77,0xbf4a3f80bf423e2f,0x3f1d3cc9bf273f7c,0x3f51bf1d3eb8bd97,0x3f13bf4a3f6fbf7f
.quad 0x3ea1be603dfbbcc9,0xbf733f7abf7e3f80,0xbf803f65bf133dfb,0xbcc9bee63f51bf7e,0x3e89bf6a3f65be60,0x3f77becfbee63f7a,0x3f583e89bf803ea1,0xbf093f77bcc9bf73,0xbf423f133f5fbecf,0xbf27bf513efc3f6a,0xbecfbf7fbf093efc,0x3f6a3d97bf58bf5f,0x3f7e3f313d97bf13,0x3dfb3f393f7f3f51,0xbe2f3dfb3ecf3f27,0xbf7cbf7ebf6abf42
.quad 0x3d973e2f3e893eb8,0x3f7f3f7c3f773f6f,0x3eb83f423f7a3f77,0x3f6f3f273e60be89,0x3f1d3f803f27be2f,0x3f4a3cc9bf42bf7c,0x3f513f4abeb8bf7f,0x3f13bf1dbf6f3d97,0x3f733e60bf7ebcc9,0x3ea1bf7abdfb3f80,0x3f80bee6bf133f7e,0x3cc9bf653f513dfb,0x3f77bf6a3ee63e60,0xbe89becf3f65bf7a,0x3f58bf773f80bf73,0xbf093e893cc9bea1
.quad 0x3f27bf133efcbecf,0xbf423f51bf5f3f6a,0x3ecf3d97bf093f5f,0xbf6a3f7fbf583efc,0x3dfb3f31bf7f3f13,0xbf7e3f393d97bf51,0xbe2f3f7ebecfbf42,0xbf7c3dfb3f6abf27,0xbee63f583f1dbf39,0xbf65bf093f4a3f31,0xbf313ea13f7c3f1d,0xbf39bf73be2f3f4a,0xbf5fbeb83ea13f58,0xbefcbf6fbf73bf09,0xbf7abf5fbf31bee6,0xbe60befcbf39bf65
.quad 0x3f6c3f763f7d3f80,0x3ec73e8c3e1c3cfb,0xbdd53ecd3f4d3f7e,0x3f7f3f6b3f1a3e04,0xbf7bbee93ed83f79,0x3e423f643f683e66,0xbeefbf7abd623f73,0xbf633e5a3f803ea4,0x3f36bf49bf053f69,0xbf34bf1f3f5b3ed2,0x3f61bc97bf5c3f5e,0x3ef4bf803f023eff,0xbe4e3f43bf803f50,0x3f7bbf263d303f15,0xbf7f3f7cbf673f41,0x3dbc3e35bede3f28
.quad 0xbec13efabf173f2f,0xbf6d3f60bf4f3f3a,0x3f47bebbbe103f1c,0xbf213f6ebf7d3f4b,0x3f54bf743eaf3f08,0x3f103e9ebf713f59,0xbe98bf573f3f3ee3,0x3f75bf0abf2b3f65,0xbf80bdee3f793eb5,0xbbc9bf7ebe733f6f,0xbe923f323f783e86,0xbf75bf383e7f3f77,0x3f563f7f3f3d3e29,0xbf0d3da33f2d3f7c,0x3f453f123eaa3d8a,0x3f243f523f723f7f
.quad 0x3f213f383f4d3f5e,0x3f473f323f1a3eff,0xbf54bf7fbf68bf15,0xbf10bda33ed83f50,0x3f753f523d62bf41,0x3e98bf12bf80bf28,0xbf80be8c3f5b3f3a,0xbbc93f763f05bf2f,0x3f75becdbf5c3f1c,0xbe92bf6b3f023f4b,0xbf563f64bd30bf59,0x3f0d3ee9bf803f08,0x3f24bf7a3f67bee3,0xbf453e5a3edebf65,0xbec73f1fbf4f3f6f,0x3f6cbf493f17beb5
.quad 0x3dd53c97be103e86,0xbf7f3f80bf7d3f77,0x3e42bf263f71bf7c,0x3f7bbf433eaf3e29,0xbeef3f7cbf3fbd8a,0xbf633e353f2bbf7f,0x3f34bf60be733f80,0x3f363efabf793cfb,0xbf613ebb3f78be04,0xbef4bf6e3e7f3f7e,0x3f7b3e9ebf2dbf79,0x3e4e3f743f3dbe66,0xbf7fbf57beaa3ea4,0x3dbcbf0abf72bf73,0x3f6d3f7e3f7d3f69,0xbec1bdee3e1c3ed2
.quad 0x3e423e9e3ed83f08,0x3f7b3f743f683f59,0x3f633f0a3d62bee3,0xbeefbf57bf80bf65,0xbf34bf7ebf053eb5,0xbf363dee3f5b3f6f,0xbef43f383f5cbe86,0x3f613f32bf02bf77,0x3f7b3da3bf803e29,0x3e4ebf7f3d303f7c,0xbdbcbf523f67bd8a,0xbf7f3f123edebf7f,0xbf6d3f76bf17bcfb,0x3ec13e8cbf4f3f80,0x3f21becd3e103e04,0x3f47bf6b3f7dbf7e
.quad 0x3f10bee93eafbe66,0xbf543f64bf713f79,0xbf753f7abf3f3ea4,0xbe98be5a3f2bbf73,0xbbc9bf493f79bed2,0x3f80bf1fbe733f69,0x3f753c97bf783eff,0xbe923f80be7fbf5e,0xbf0d3f433f3dbf15,0xbf56bf263f2d3f50,0xbf24bf7cbeaa3f28,0x3f45be35bf72bf41,0x3f6c3efabe1cbf3a,0x3ec73f603f7d3f2f,0x3dd53ebb3f1a3f4b,0xbf7fbf6ebf4dbf1c
.quad 0xbe98be35bd623d8a,0x3f753f7c3f803f7f,0xbbc93efa3f5b3f80,0x3f803f603f053cfb,0x3e923f6e3f5c3e04,0x3f753ebbbf02bf7e,0x3f0d3f74bd30bf79,0x3f56be9ebf80be66,0x3f453f0abf67bea4,0x3f24bf57bede3f73,0x3f6cbdeebf4f3f69,0x3ec7bf7e3f173ed2,0x3f7fbf383e103eff,0x3dd5bf323f7dbf5e,0x3f7bbf7f3f71bf50,0xbe42bda33eafbf15
.quad 0x3f63bf523f3fbf28,0xbeef3f12bf2b3f41,0x3f36be8cbe733f2f,0xbf343f76bf793f3a,0x3ef43ecdbf783f4b,0xbf613f6bbe7fbf1c,0x3e4e3f64bf2dbf08,0xbf7b3ee93f3dbf59,0xbdbc3f7a3eaabf65,0xbf7fbe5a3f723ee3,0xbec13f1f3f7d3eb5,0xbf6dbf493e1c3f6f,0xbf21bc973f1a3f77,0xbf47bf80bf4dbe86,0xbf54bf26bed8be29,0xbf10bf43bf68bf7c
.quad 0x3f633f723f7c3f80,0x3eec3ea73e3b3d17,0xbe3b3eb23f483f7e,0x3f7c3f703f203e0a,0xbf7ebf013eca3f79,0x3de23f5d3f6b3e6d,0xbecabf7dbdb03f72,0xbf6b3e233f7f3ea7,0x3f44bf40bf0c3f69,0xbf25bf2a3f573ed5,0x3f573d17bf603f5d,0x3f0cbf803ef73f01,0xbe8f3f4cbf803f4f,0x3f76bf1b3c493f16,0xbf803f79bf633f40,0x3c493e6dbeec3f2a
.quad 0xbe9b3ee1bf113f2e,0xbf743f66bf533f3c,0x3f53bed5bde23f1b,0xbf113f69bf7e3f4c,0x3f48bf783ebe3f06,0x3f203e82bf6e3f5a,0xbebebf4f3f443ee1,0x3f6ebf16bf253f66,0xbf7fbd7b3f7a3eb2,0xbdb0bf80be543f70,0xbe543f3c3f763e82,0xbf7abf2e3e8f3f78,0x3f603f7e3f373e23,0xbef73e0a3f333f7d,0x3f373f063e9b3d7b,0x3f333f5a3f743f80
.quad 0x3ef73f1b3f373f4f,0x3f603f4c3f333f16,0xbf37bf79bf74bf2a,0xbf33be6d3e9b3f40,0x3f633f663e3bbf2e,0x3eecbee1bf7cbf3c,0xbf7cbed53f483f4c,0xbe3b3f693f20bf1b,0x3f7ebe82bf6b3f06,0xbde2bf783eca3f5a,0xbf6b3f4f3db0bf66,0x3eca3f16bf7f3ee1,0x3f44bf803f57beb2,0xbf253d7b3f0cbf70,0xbf0c3f3cbf603f78,0x3f57bf2e3ef7be82
.quad 0x3e8fbe0abc493e23,0xbf763f7ebf803f7d,0x3c49bf063f63bf80,0x3f80bf5a3eec3d7b,0xbe9b3f72bf533d17,0xbf743ea73f11bf80,0x3f11bf70bde23f7e,0x3f533eb2bf7e3e0a,0xbf483f013f6ebe6d,0xbf20bf5d3ebe3f79,0x3f6e3e23bf44bf72,0x3ebe3f7d3f25bea7,0xbf7fbf40be543ed5,0xbdb0bf2abf7abf69,0x3f7a3f803f763f5d,0xbe543d173e8f3f01
.quad 0xbdb03d7b3e543eb2,0x3f7f3f803f7a3f70,0x3f7a3f3c3e8fbe82,0xbe54bf2ebf76bf78,0xbef7bf7ebf333e23,0xbf60be0a3f373f7d,0xbf333f063f74bd7b,0x3f373f5abe9bbf80,0x3f633ea7bf7cbd17,0x3eecbf72be3b3f80,0x3e3bbf703f483e0a,0xbf7c3eb23f20bf7e,0xbf7e3f5dbecabe6d,0x3de23f01bf6b3f79,0x3ecabe23bdb03ea7,0x3f6bbf7d3f7fbf72
.quad 0x3f44bf2a3f0cbed5,0xbf253f40bf573f69,0xbf573f80bf603f01,0xbf0c3d173ef7bf5d,0xbe8fbf1b3f80bf16,0x3f76bf4cbc493f4f,0x3f80be6dbf633f2a,0xbc493f79beecbf40,0xbe9b3f663f11bf3c,0xbf74bee13f533f2e,0xbf53bf69bde23f4c,0x3f11bed5bf7ebf1b,0x3f483e82bebebf5a,0x3f203f783f6e3f06,0x3ebe3f163f443f66,0xbf6ebf4fbf25bee1
.quad 0xbf20bf01bebebe6d,0x3f483f5d3f6e3f79,0xbebe3e233f253f72,0x3f6e3f7d3f443ea7,0xbdb03f403f7a3ed5,0x3f7f3f2abe54bf69,0x3e543f803e8fbf5d,0x3f7a3d17bf76bf01,0x3ef73f4cbf37bf16,0x3f60bf1bbf333f4f,0x3f373e6dbf743f40,0x3f33bf793e9b3f2a,0x3f63bee1be3b3f3c,0x3eecbf663f7cbf2e,0x3f7cbf693f48bf1b,0x3e3bbed53f20bf4c
.quad 0x3f7ebf783f6bbf5a,0xbde23e82beca3f06,0x3f6bbf163db03ee1,0xbeca3f4fbf7f3f66,0x3f443d7bbf573f70,0xbf253f80bf0cbeb2,0x3f0c3f2ebf60be82,0xbf573f3c3ef7bf78,0x3e8f3f7e3c49bf7d,0xbf763e0a3f803e23,0xbc493f5a3f633d7b,0xbf80bf063eec3f80,0xbe9b3ea73f533f80,0xbf74bf72bf113d17,0xbf11beb2bde23e0a,0xbf53bf70bf7ebf7e
.quad 0x3f593f6d3f7a3f80,0x3f083ec13e5a3d30,0xbe863e983f433f7d,0x3f773f753f263e10,0xbf80bf0d3ebb3f79,0x3cfb3f563f6e3e73,0xbea4bf7fbdee3f72,0xbf733dd53f7e3eaa,0x3f50bf36bf123f68,0xbf15bf343f523ed8,0x3f4b3dbcbf643f5c,0x3f1cbf7f3ee93f02,0xbeb53f54bf803f4f,0x3f6fbf10bc973f17,0xbf7f3f75bf603f3f,0xbd8a3e92befa3f2b
.quad 0xbe663ec7bf0a3f2d,0xbf793f6cbf573f3d,0x3f5ebeefbda33f1a,0xbeff3f63bf7f3f4d,0x3f3abf7b3ecd3f05,0x3f2f3e4ebf6b3f5b,0xbee3bf473f493ede,0x3f65bf21bf1f3f67,0xbf7cbbc93f7c3eaf,0xbe29bf80be353f71,0xbe043f453f743e7f,0xbf7ebf243e9e3f78,0x3f693f7b3f323e1c,0xbed23e423f383f7d,0x3f283ef43e8c3d62,0x3f413f613f763f80
.quad 0x3ea43ef43f1f3f3f,0x3f733f613f493f2b,0xbf15bf6dbf7cbf3d,0xbf50bec13e353f2d,0x3f4b3f753e9ebf1a,0x3f1cbe98bf74bf4d,0xbf6fbf0d3f323f5b,0xbeb53f563f38bf05,0x3f7fbdd5bf763ede,0x3d8abf7f3e8c3f67,0xbf793f363e5abf71,0x3e663f34bf7a3eaf,0x3f5ebf7f3f43be7f,0xbeffbdbc3f26bf78,0xbf2f3f54bf6e3f7d,0x3f3abf103ebbbe1c
.quad 0x3ee3be923dee3d62,0xbf653f75bf7e3f80,0xbe29bec73f52bf80,0x3f7cbf6c3f12bd30,0xbe043f63bf643e10,0xbf7e3eef3ee9bf7d,0x3ed2bf7b3c973f79,0x3f693e4ebf803e73,0xbf283f213f60beaa,0xbf41bf473efa3f72,0x3f593bc9bf57bf68,0x3f083f803f0abed8,0xbf77bf24bda33f02,0xbe86bf45bf7fbf5c,0x3f803f7b3f6b3f4f,0xbcfb3e423ecd3f17
.quad 0xbeb5be42bc973e1c,0x3f6f3f7b3f803f7d,0x3f7f3f613efabd62,0x3d8abef4bf60bf80,0xbe66bf6dbf57bd30,0xbf79bec13f0a3f80,0xbf5e3e983f7f3e10,0x3eff3f75bda3bf7d,0x3f3a3f0dbf6bbe73,0x3f2fbf56becd3f79,0x3ee3bf7f3f1f3eaa,0xbf653dd53f49bf72,0xbf7c3f36be35bed8,0xbe293f34bf7c3f68,0x3e043dbcbe9e3f02,0x3f7ebf7f3f74bf5c
.quad 0x3f69bf543f38bf17,0xbed23f10bf323f4f,0xbf283f75bf763f2b,0xbf413e923e8cbf3f,0xbf08bec73f7abf3d,0x3f59bf6c3e5a3f2d,0x3f77beefbf433f4d,0x3e863f63bf26bf1a,0xbcfb3f7b3ebbbf5b,0xbf80be4e3f6e3f05,0xbf73bf473dee3f67,0x3ea4bf21bf7ebede,0x3f153bc9bf12bf71,0x3f503f803f523eaf,0x3f1c3f453f643f78,0xbf4bbf24bee9be7f
.quad 0xbf5ebf45bf26bf02,0x3eff3f243f433f5c,0xbf2fbe423ebb3f4f,0x3f3a3f7b3f6e3f17,0xbee33ef43f7e3f2b,0x3f653f613deebf3f,0xbe293f6d3f12bf2d,0x3f7c3ec1bf52bf3d,0x3e043f75bee9bf4d,0x3f7ebe98bf643f1a,0x3ed23f0dbf803f05,0x3f69bf56bc973f5b,0x3f28bdd5befa3f67,0x3f41bf7f3f60bede,0x3f59bf363f0abeaf,0x3f08bf343f57bf71
.quad 0x3f77bf7f3f7fbf78,0x3e86bdbcbda33e7f,0x3f80bf543ecd3e1c,0xbcfb3f10bf6b3f7d,0x3f73be92bf1f3f80,0xbea43f75bf49bd62,0x3f503ec7bf7c3d30,0xbf153f6c3e35bf80,0x3f1c3f63be9ebf7d,0xbf4b3eef3f74be10,0x3eb53f7b3f32be73,0xbf6fbe4e3f383f79,0x3d8a3f213f763f72,0xbf7fbf47be8c3eaa,0xbe66bbc93e5a3ed8,0xbf79bf80bf7abf68
.quad 0x3f4e3f673f783f80,0x3f183edb3e793d49,0xbeac3e793f3e3f7d,0x3f713f783f2c3e16,0xbf80bf183eac3f78,0xbd493f4e3f713e79,0xbe79bf80be163f71,0xbf783d493f7d3eac,0x3f5cbf2cbf183f67,0xbf04bf3e3f4e3edb,0x3f3e3e16bf673f5c,0x3f2cbf7d3edb3f04,0xbedb3f5cbf803f4e,0x3f67bf04bd493f18,0xbf7d3f71bf5c3f3e,0xbe163eacbf043f2c
.quad 0xbe163eacbf043f2c,0xbf7d3f71bf5c3f3e,0x3f67bf04bd493f18,0xbedb3f5cbf803f4e,0x3f2cbf7d3edb3f04,0x3f3e3e16bf673f5c,0xbf04bf3e3f4e3edb,0x3f5cbf2cbf183f67,0xbf783d493f7d3eac,0xbe79bf80be163f71,0xbd493f4e3f713e79,0xbf80bf183eac3f78,0x3f713f783f2c3e16,0xbeac3e793f3e3f7d,0x3f183edb3e793d49,0x3f4e3f673f783f80
.quad 0x3e163eac3f043f2c,0x3f7d3f713f5c3f3e,0xbedbbf5cbf80bf4e,0xbf67bf043d493f18,0x3f2c3f7d3edbbf04,0x3f3ebe16bf67bf5c,0xbf5cbf2c3f183f67,0xbf043f3e3f4ebedb,0x3f783d49bf7d3eac,0x3e79bf803e163f71,0xbf803f183eacbf78,0x3d493f4ebf713e79,0x3f71bf783f2cbe16,0xbeacbe793f3ebf7d,0xbf4e3f67bf783f80,0x3f18bedb3e79bd49
.quad 0x3f18bedb3e79bd49,0xbf4e3f67bf783f80,0xbeacbe793f3ebf7d,0x3f71bf783f2cbe16,0x3d493f4ebf713e79,0xbf803f183eacbf78,0x3e79bf803e163f71,0x3f783d49bf7d3eac,0xbf043f3e3f4ebedb,0xbf5cbf2c3f183f67,0x3f3ebe16bf67bf5c,0x3f2c3f7d3edbbf04,0xbf67bf043d493f18,0xbedbbf5cbf80bf4e,0x3f7d3f713f5c3f3e,0x3e163eac3f043f2c
.quad 0xbf18bedbbe79bd49,0x3f4e3f673f783f80,0x3f713f783f2c3e16,0x3eacbe79bf3ebf7d,0x3d49bf4ebf71be79,0xbf80bf183eac3f78,0xbf783d493f7d3eac,0x3e793f803e16bf71,0x3f043f3ebf4ebedb,0x3f5cbf2cbf183f67,0x3f2cbf7d3edb3f04,0xbf3ebe163f67bf5c,0xbf673f043d49bf18,0xbedb3f5cbf803f4e,0xbe163eacbf043f2c,0x3f7dbf713f5cbf3e
.quad 0x3f7dbf713f5cbf3e,0xbe163eacbf043f2c,0xbedb3f5cbf803f4e,0xbf673f043d49bf18,0xbf3ebe163f67bf5c,0x3f2cbf7d3edb3f04,0x3f5cbf2cbf183f67,0x3f043f3ebf4ebedb,0x3e793f803e16bf71,0xbf783d493f7d3eac,0xbf80bf183eac3f78,0x3d49bf4ebf71be79,0x3eacbe79bf3ebf7d,0x3f713f783f2c3e16,0x3f4e3f673f783f80,0xbf18bedbbe79bd49
.quad 0xbf7dbf71bf5cbf3e,0x3e163eac3f043f2c,0xbf67bf043d493f18,0x3edb3f5c3f803f4e,0xbf3e3e163f673f5c,0x3f2c3f7d3edbbf04,0xbf043f3e3f4ebedb,0x3f5c3f2cbf18bf67,0xbe793f80be16bf71,0x3f783d49bf7d3eac,0x3d493f4ebf713e79,0x3f80bf18beac3f78,0x3eac3e79bf3e3f7d,0x3f71bf783f2cbe16,0x3f18bedb3e79bd49,0x3f4ebf673f78bf80
.quad 0x3f4ebf673f78bf80,0x3f18bedb3e79bd49,0x3f71bf783f2cbe16,0x3eac3e79bf3e3f7d,0x3f80bf18beac3f78,0x3d493f4ebf713e79,0x3f783d49bf7d3eac,0xbe793f80be16bf71,0x3f5c3f2cbf18bf67,0xbf043f3e3f4ebedb,0x3f2c3f7d3edbbf04,0xbf3e3e163f673f5c,0x3edb3f5c3f803f4e,0xbf67bf043d493f18,0x3e163eac3f043f2c,0xbf7dbf71bf5cbf3e
.quad 0x3f413f613f763f80,0x3f283ef43e8c3d62,0xbed23e423f383f7d,0x3f693f7b3f323e1c,0xbf7ebf243e9e3f78,0xbe043f453f743e7f,0xbe29bf80be353f71,0xbf7cbbc93f7c3eaf,0x3f65bf21bf1f3f67,0xbee3bf473f493ede,0x3f2f3e4ebf6b3f5b,0x3f3abf7b3ecd3f05,0xbeff3f63bf7f3f4d,0x3f5ebeefbda33f1a,0xbf793f6cbf573f3d,0xbe663ec7bf0a3f2d
.quad 0xbd8a3e92befa3f2b,0xbf7f3f75bf603f3f,0x3f6fbf10bc973f17,0xbeb53f54bf803f4f,0x3f1cbf7f3ee93f02,0x3f4b3dbcbf643f5c,0xbf15bf343f523ed8,0x3f50bf36bf123f68,0xbf733dd53f7e3eaa,0xbea4bf7fbdee3f72,0x3cfb3f563f6e3e73,0xbf80bf0d3ebb3f79,0x3f773f753f263e10,0xbe863e983f433f7d,0x3f083ec13e5a3d30,0x3f593f6d3f7a3f80
.quad 0xbcfb3e423ecd3f17,0x3f803f7b3f6b3f4f,0xbe86bf45bf7fbf5c,0xbf77bf24bda33f02,0x3f083f803f0abed8,0x3f593bc9bf57bf68,0xbf41bf473efa3f72,0xbf283f213f60beaa,0x3f693e4ebf803e73,0x3ed2bf7b3c973f79,0xbf7e3eef3ee9bf7d,0xbe043f63bf643e10,0x3f7cbf6c3f12bd30,0xbe29bec73f52bf80,0xbf653f75bf7e3f80,0x3ee3be923dee3d62
.quad 0x3f3abf103ebbbe1c,0xbf2f3f54bf6e3f7d,0xbeffbdbc3f26bf78,0x3f5ebf7f3f43be7f,0x3e663f34bf7a3eaf,0xbf793f363e5abf71,0x3d8abf7f3e8c3f67,0x3f7fbdd5bf763ede,0xbeb53f563f38bf05,0xbf6fbf0d3f323f5b,0x3f1cbe98bf74bf4d,0x3f4b3f753e9ebf1a,0xbf50bec13e353f2d,0xbf15bf6dbf7cbf3d,0x3f733f613f493f2b,0x3ea43ef43f1f3f3f
.quad 0xbf4bbf24bee9be7f,0x3f1c3f453f643f78,0x3f503f803f523eaf,0x3f153bc9bf12bf71,0x3ea4bf21bf7ebede,0xbf73bf473dee3f67,0xbf80be4e3f6e3f05,0xbcfb3f7b3ebbbf5b,0x3e863f63bf26bf1a,0x3f77beefbf433f4d,0x3f59bf6c3e5a3f2d,0xbf08bec73f7abf3d,0xbf413e923e8cbf3f,0xbf283f75bf763f2b,0xbed23f10bf323f4f,0x3f69bf543f38bf17
.quad 0x3f7ebf7f3f74bf5c,0x3e043dbcbe9e3f02,0xbe293f34bf7c3f68,0xbf7c3f36be35bed8,0xbf653dd53f49bf72,0x3ee3bf7f3f1f3eaa,0x3f2fbf56becd3f79,0x3f3a3f0dbf6bbe73,0x3eff3f75bda3bf7d,0xbf5e3e983f7f3e10,0xbf79bec13f0a3f80,0xbe66bf6dbf57bd30,0x3d8abef4bf60bf80,0x3f7f3f613efabd62,0x3f6f3f7b3f803f7d,0xbeb5be42bc973e1c
.quad 0xbf79bf80bf7abf68,0xbe66bbc93e5a3ed8,0xbf7fbf47be8c3eaa,0x3d8a3f213f763f72,0xbf6fbe4e3f383f79,0x3eb53f7b3f32be73,0xbf4b3eef3f74be10,0x3f1c3f63be9ebf7d,0xbf153f6c3e35bf80,0x3f503ec7bf7c3d30,0xbea43f75bf49bd62,0x3f73be92bf1f3f80,0xbcfb3f10bf6b3f7d,0x3f80bf543ecd3e1c,0x3e86bdbcbda33e7f,0x3f77bf7f3f7fbf78
.quad 0x3f08bf343f57bf71,0x3f59bf363f0abeaf,0x3f41bf7f3f60bede,0x3f28bdd5befa3f67,0x3f69bf56bc973f5b,0x3ed23f0dbf803f05,0x3f7ebe98bf643f1a,0x3e043f75bee9bf4d,0x3f7c3ec1bf52bf3d,0xbe293f6d3f12bf2d,0x3f653f613deebf3f,0xbee33ef43f7e3f2b,0x3f3a3f7b3f6e3f17,0xbf2fbe423ebb3f4f,0x3eff3f243f433f5c,0xbf5ebf45bf26bf02
.quad 0x3f333f5a3f743f80,0x3f373f063e9b3d7b,0xbef73e0a3f333f7d,0x3f603f7e3f373e23,0xbf7abf2e3e8f3f78,0xbe543f3c3f763e82,0xbdb0bf80be543f70,0xbf7fbd7b3f7a3eb2,0x3f6ebf16bf253f66,0xbebebf4f3f443ee1,0x3f203e82bf6e3f5a,0x3f48bf783ebe3f06,0xbf113f69bf7e3f4c,0x3f53bed5bde23f1b,0xbf743f66bf533f3c,0xbe9b3ee1bf113f2e
.quad 0x3c493e6dbeec3f2a,0xbf803f79bf633f40,0x3f76bf1b3c493f16,0xbe8f3f4cbf803f4f,0x3f0cbf803ef73f01,0x3f573d17bf603f5d,0xbf25bf2a3f573ed5,0x3f44bf40bf0c3f69,0xbf6b3e233f7f3ea7,0xbecabf7dbdb03f72,0x3de23f5d3f6b3e6d,0xbf7ebf013eca3f79,0x3f7c3f703f203e0a,0xbe3b3eb23f483f7e,0x3eec3ea73e3b3d17,0x3f633f723f7c3f80
.quad 0xbe543d173e8f3f01,0x3f7a3f803f763f5d,0xbdb0bf2abf7abf69,0xbf7fbf40be543ed5,0x3ebe3f7d3f25bea7,0x3f6e3e23bf44bf72,0xbf20bf5d3ebe3f79,0xbf483f013f6ebe6d,0x3f533eb2bf7e3e0a,0x3f11bf70bde23f7e,0xbf743ea73f11bf80,0xbe9b3f72bf533d17,0x3f80bf5a3eec3d7b,0x3c49bf063f63bf80,0xbf763f7ebf803f7d,0x3e8fbe0abc493e23
.quad 0x3f57bf2e3ef7be82,0xbf0c3f3cbf603f78,0xbf253d7b3f0cbf70,0x3f44bf803f57beb2,0x3eca3f16bf7f3ee1,0xbf6b3f4f3db0bf66,0xbde2bf783eca3f5a,0x3f7ebe82bf6b3f06,0xbe3b3f693f20bf1b,0xbf7cbed53f483f4c,0x3eecbee1bf7cbf3c,0x3f633f663e3bbf2e,0xbf33be6d3e9b3f40,0xbf37bf79bf74bf2a,0x3f603f4c3f333f16,0x3ef73f1b3f373f4f
.quad 0xbf6ebf4fbf25bee1,0x3ebe3f163f443f66,0x3f203f783f6e3f06,0x3f483e82bebebf5a,0x3f11bed5bf7ebf1b,0xbf53bf69bde23f4c,0xbf74bee13f533f2e,0xbe9b3f663f11bf3c,0xbc493f79beecbf40,0x3f80be6dbf633f2a,0x3f76bf4cbc493f4f,0xbe8fbf1b3f80bf16,0xbf0c3d173ef7bf5d,0xbf573f80bf603f01,0xbf253f40bf573f69,0x3f44bf2a3f0cbed5
.quad 0x3f6bbf7d3f7fbf72,0x3ecabe23bdb03ea7,0x3de23f01bf6b3f79,0xbf7e3f5dbecabe6d,0xbf7c3eb23f20bf7e,0x3e3bbf703f483e0a,0x3eecbf72be3b3f80,0x3f633ea7bf7cbd17,0x3f373f5abe9bbf80,0xbf333f063f74bd7b,0xbf60be0a3f373f7d,0xbef7bf7ebf333e23,0xbe54bf2ebf76bf78,0x3f7a3f3c3e8fbe82,0x3f7f3f803f7a3f70,0xbdb03d7b3e543eb2
.quad 0xbf53bf70bf7ebf7e,0xbf11beb2bde23e0a,0xbf74bf72bf113d17,0xbe9b3ea73f533f80,0xbf80bf063eec3f80,0xbc493f5a3f633d7b,0xbf763e0a3f803e23,0x3e8f3f7e3c49bf7d,0xbf573f3c3ef7bf78,0x3f0c3f2ebf60be82,0xbf253f80bf0cbeb2,0x3f443d7bbf573f70,0xbeca3f4fbf7f3f66,0x3f6bbf163db03ee1,0xbde23e82beca3f06,0x3f7ebf783f6bbf5a
.quad 0x3e3bbed53f20bf4c,0x3f7cbf693f48bf1b,0x3eecbf663f7cbf2e,0x3f63bee1be3b3f3c,0x3f33bf793e9b3f2a,0x3f373e6dbf743f40,0x3f60bf1bbf333f4f,0x3ef73f4cbf37bf16,0x3f7a3d17bf76bf01,0x3e543f803e8fbf5d,0x3f7f3f2abe54bf69,0xbdb03f403f7a3ed5,0x3f6e3f7d3f443ea7,0xbebe3e233f253f72,0x3f483f5d3f6e3f79,0xbf20bf01bebebe6d
.quad 0x3f243f523f723f7f,0x3f453f123eaa3d8a,0xbf0d3da33f2d3f7c,0x3f563f7f3f3d3e29,0xbf75bf383e7f3f77,0xbe923f323f783e86,0xbbc9bf7ebe733f6f,0xbf80bdee3f793eb5,0x3f75bf0abf2b3f65,0xbe98bf573f3f3ee3,0x3f103e9ebf713f59,0x3f54bf743eaf3f08,0xbf213f6ebf7d3f4b,0x3f47bebbbe103f1c,0xbf6d3f60bf4f3f3a,0xbec13efabf173f2f
.quad 0x3dbc3e35bede3f28,0xbf7f3f7cbf673f41,0x3f7bbf263d303f15,0xbe4e3f43bf803f50,0x3ef4bf803f023eff,0x3f61bc97bf5c3f5e,0xbf34bf1f3f5b3ed2,0x3f36bf49bf053f69,0xbf633e5a3f803ea4,0xbeefbf7abd623f73,0x3e423f643f683e66,0xbf7bbee93ed83f79,0x3f7f3f6b3f1a3e04,0xbdd53ecd3f4d3f7e,0x3ec73e8c3e1c3cfb,0x3f6c3f763f7d3f80
.quad 0xbec1bdee3e1c3ed2,0x3f6d3f7e3f7d3f69,0x3dbcbf0abf72bf73,0xbf7fbf57beaa3ea4,0x3e4e3f743f3dbe66,0x3f7b3e9ebf2dbf79,0xbef4bf6e3e7f3f7e,0xbf613ebb3f78be04,0x3f363efabf793cfb,0x3f34bf60be733f80,0xbf633e353f2bbf7f,0xbeef3f7cbf3fbd8a,0x3f7bbf433eaf3e29,0x3e42bf263f71bf7c,0xbf7f3f80bf7d3f77,0x3dd53c97be103e86
.quad 0x3f6cbf493f17beb5,0xbec73f1fbf4f3f6f,0xbf453e5a3edebf65,0x3f24bf7a3f67bee3,0x3f0d3ee9bf803f08,0xbf563f64bd30bf59,0xbe92bf6b3f023f4b,0x3f75becdbf5c3f1c,0xbbc93f763f05bf2f,0xbf80be8c3f5b3f3a,0x3e98bf12bf80bf28,0x3f753f523d62bf41,0xbf10bda33ed83f50,0xbf54bf7fbf68bf15,0x3f473f323f1a3eff,0x3f213f383f4d3f5e
.quad 0xbf7fbf6ebf4dbf1c,0x3dd53ebb3f1a3f4b,0x3ec73f603f7d3f2f,0x3f6c3efabe1cbf3a,0x3f45be35bf72bf41,0xbf24bf7cbeaa3f28,0xbf56bf263f2d3f50,0xbf0d3f433f3dbf15,0xbe923f80be7fbf5e,0x3f753c97bf783eff,0x3f80bf1fbe733f69,0xbbc9bf493f79bed2,0xbe98be5a3f2bbf73,0xbf753f7abf3f3ea4,0xbf543f64bf713f79,0x3f10bee93eafbe66
.quad 0x3f47bf6b3f7dbf7e,0x3f21becd3e103e04,0x3ec13e8cbf4f3f80,0xbf6d3f76bf17bcfb,0xbf7f3f123edebf7f,0xbdbcbf523f67bd8a,0x3e4ebf7f3d303f7c,0x3f7b3da3bf803e29,0x3f613f32bf02bf77,0xbef43f383f5cbe86,0xbf363dee3f5b3f6f,0xbf34bf7ebf053eb5,0xbeefbf57bf80bf65,0x3f633f0a3d62bee3,0x3f7b3f743f683f59,0x3e423e9e3ed83f08
.quad 0xbf10bf43bf68bf7c,0xbf54bf26bed8be29,0xbf47bf80bf4dbe86,0xbf21bc973f1a3f77,0xbf6dbf493e1c3f6f,0xbec13f1f3f7d3eb5,0xbf7fbe5a3f723ee3,0xbdbc3f7a3eaabf65,0xbf7b3ee93f3dbf59,0x3e4e3f64bf2dbf08,0xbf613f6bbe7fbf1c,0x3ef43ecdbf783f4b,0xbf343f76bf793f3a,0x3f36be8cbe733f2f,0xbeef3f12bf2b3f41,0x3f63bf523f3fbf28
.quad 0xbe42bda33eafbf15,0x3f7bbf7f3f71bf50,0x3dd5bf323f7dbf5e,0x3f7fbf383e103eff,0x3ec7bf7e3f173ed2,0x3f6cbdeebf4f3f69,0x3f24bf57bede3f73,0x3f453f0abf67bea4,0x3f56be9ebf80be66,0x3f0d3f74bd30bf79,0x3f753ebbbf02bf7e,0x3e923f6e3f5c3e04,0x3f803f603f053cfb,0xbbc93efa3f5b3f80,0x3f753f7c3f803f7f,0xbe98be35bd623d8a
.quad 0x3f133f4a3f6f3f7f,0x3f513f1d3eb83d97,0xbf1d3cc93f273f7c,0x3f4a3f803f423e2f,0xbf6fbf423e603f77,0xbeb83f273f7a3e89,0x3d97bf7cbe893f6f,0xbf7fbe2f3f773eb8,0x3f7abefcbf313f65,0xbe60bf5f3f393ee6,0x3efc3eb8bf733f58,0x3f5fbf6f3ea13f09,0xbf313f73bf7c3f4a,0x3f39bea1be2f3f1d,0xbf653f58bf4a3f39,0xbee63f09bf1d3f31
.quad 0x3e2f3dfbbecf3f27,0xbf7c3f7ebf6a3f42,0x3f7ebf313d973f13,0xbdfb3f39bf7f3f51,0x3ecfbf7f3f093efc,0x3f6abd97bf583f5f,0xbf42bf133f5f3ecf,0x3f27bf51befc3f6a,0xbf583e893f803ea1,0xbf09bf77bcc93f73,0x3e893f6a3f653e60,0xbf77becf3ee63f7a,0x3f803f653f133dfb,0xbcc93ee63f513f7e,0x3ea13e603dfb3cc9,0x3f733f7a3f7e3f80
.quad 0xbf09be893cc93ea1,0x3f583f773f803f73,0x3e89becfbf65bf7a,0xbf77bf6abee63e60,0x3cc93f653f51bdfb,0x3f803ee6bf13bf7e,0xbea1bf7a3dfb3f80,0xbf733e603f7ebcc9,0x3f133f1dbf6fbd97,0x3f51bf4abeb83f7f,0xbf4a3cc93f42bf7c,0xbf1d3f80bf27be2f,0x3f6fbf273e603e89,0x3eb8bf423f7abf77,0xbf7f3f7cbf773f6f,0xbd973e2fbe893eb8
.quad 0x3f7abf5f3f31bee6,0xbe603efcbf393f65,0xbf5f3eb83ea1bf58,0x3efcbf6f3f73bf09,0x3f313ea1bf7c3f1d,0xbf393f73be2fbf4a,0xbee6bf583f1d3f39,0x3f65bf09bf4a3f31,0x3e2f3f7e3ecfbf42,0xbf7cbdfb3f6a3f27,0x3dfbbf31bf7fbf13,0x3f7e3f39bd97bf51,0xbecf3d973f093f5f,0xbf6abf7fbf58befc,0x3f273f133efc3ecf,0x3f423f513f5f3f6a
.quad 0xbf7cbf7ebf6abf42,0xbe2f3dfb3ecf3f27,0x3dfb3f393f7f3f51,0x3f7e3f313d97bf13,0x3f6a3d97bf58bf5f,0xbecfbf7fbf093efc,0xbf27bf513efc3f6a,0xbf423f133f5fbecf,0xbf093f77bcc9bf73,0x3f583e89bf803ea1,0x3f77becfbee63f7a,0x3e89bf6a3f65be60,0xbcc9bee63f51bf7e,0xbf803f65bf133dfb,0xbf733f7abf7e3f80,0x3ea1be603dfbbcc9
.quad 0x3f13bf4a3f6fbf7f,0x3f51bf1d3eb8bd97,0x3f1d3cc9bf273f7c,0xbf4a3f80bf423e2f,0xbf6f3f423e60bf77,0xbeb8bf273f7abe89,0xbd97bf7c3e893f6f,0x3f7fbe2fbf773eb8,0x3f7a3efcbf31bf65,0xbe603f5f3f39bee6,0xbefc3eb83f733f58,0xbf5fbf6fbea13f09,0xbf31bf73bf7cbf4a,0x3f393ea1be2fbf1d,0x3f653f583f4a3f39,0x3ee63f093f1d3f31
.quad 0xbe60befcbf39bf65,0xbf7abf5fbf31bee6,0xbefcbf6fbf73bf09,0xbf5fbeb83ea13f58,0xbf39bf73be2f3f4a,0xbf313ea13f7c3f1d,0xbf65bf093f4a3f31,0xbee63f583f1dbf39,0xbf7c3dfb3f6abf27,0xbe2f3f7ebecfbf42,0xbf7e3f393d97bf51,0x3dfb3f31bf7f3f13,0xbf6a3f7fbf583efc,0x3ecf3d97bf093f5f,0xbf423f51bf5f3f6a,0x3f27bf133efcbecf
.quad 0xbf093e893cc9bea1,0x3f58bf773f80bf73,0xbe89becf3f65bf7a,0x3f77bf6a3ee63e60,0x3cc9bf653f513dfb,0x3f80bee6bf133f7e,0x3ea1bf7abdfb3f80,0x3f733e60bf7ebcc9,0x3f13bf1dbf6f3d97,0x3f513f4abeb8bf7f,0x3f4a3cc9bf42bf7c,0x3f1d3f803f27be2f,0x3f6f3f273e60be89,0x3eb83f423f7a3f77,0x3f7f3f7c3f773f6f,0x3d973e2f3e893eb8
.quad 0x3f023f413f6c3f7f,0x3f5c3f283ec73da3,0xbf2dbcfb3f213f7c,0x3f3d3f803f473e35,0xbf67bf4b3e423f76,0xbede3f1c3f7b3e8c,0x3e1cbf79be983f6e,0xbf7dbe663f753ebb,0x3f7dbee3bf363f64,0xbe10bf653f343ee9,0x3ed83ed2bf753f57,0x3f68bf693e923f0a,0xbf3f3f77bf7b3f49,0x3f2bbe86be4e3f1f,0xbf5b3f50bf453f38,0xbf053f15bf243f32
.quad 0x3e7f3d8abec13f26,0xbf783f7fbf6d3f43,0x3f80bf3a3dd53f12,0xbd303f2fbf7f3f52,0x3eaabf7e3f103efa,0x3f72be04bf543f60,0xbf4fbf083f633ecd,0x3f17bf59beef3f6b,0xbf4d3ea43f803e9e,0xbf1abf733bc93f74,0x3eaf3f6f3f613e5a,0xbf71beb53ef43f7a,0x3f803f5e3f0d3dee,0x3d623eff3f563f7e,0x3e733e293dbc3c97,0x3f793f7c3f7f3f80
.quad 0xbf2dbed2bdd53e5a,0x3f3d3f693f7f3f7a,0x3edebe86bf54bf7e,0xbf67bf77bf103dee,0xbe1c3f503f63bc97,0x3f7d3f15beefbf80,0xbe10bf7fbbc93f7f,0xbf7d3d8a3f803da3,0x3ed83f3abf61be35,0x3f68bf2fbef43f7c,0xbf2bbe043f56bf76,0xbf3f3f7ebf0dbe8c,0x3f5bbf083dbc3ebb,0x3f05bf593f7fbf6e,0xbf783f73bf6c3f64,0xbe7f3ea4bec73ee9
.quad 0x3f80bf6f3f47bf0a,0xbd303eb5bf213f57,0xbf723eff3e42bf49,0x3eaabf5e3f7bbf1f,0x3f4f3e29bf753f32,0xbf173f7cbe98bf38,0xbf1abf413f363f26,0x3f4dbf28bf343f43,0x3eaf3f803e92bf52,0xbf713cfb3f753f12,0xbd62bf4bbf7bbefa,0x3f803f1cbe4ebf60,0xbe733e663f243f6b,0xbf79bf79bf45becd,0x3f023ee33ec13e9e,0x3f5c3f653f6d3f74
.quad 0xbf67bf7ebf7bbf60,0xbedebe043e423efa,0xbe1c3f083f753f6b,0x3f7d3f593e98becd,0x3f7d3ea4bf34bf74,0xbe10bf73bf363e9e,0xbed8bf6f3e923f7a,0xbf683eb53f75be5a,0xbf3f3f5e3e4ebf7e,0x3f2b3effbf7b3dee,0x3f5bbe29bf243f80,0x3f05bf7c3f45bc97,0x3e7fbf283f6dbf7f,0xbf783f41bec1bda3,0xbf803f80bf7f3f7c,0x3d303cfbbdd53e35
.quad 0x3eaabf1c3f54bf76,0x3f72bf4b3f10be8c,0x3f4fbe66beef3f6e,0xbf173f79bf633ebb,0xbf4d3f65bbc9bf64,0xbf1abee33f80bee9,0xbeafbf693ef43f57,0x3f71bed2bf613f0a,0x3f803e86bf56bf49,0x3d623f773f0dbf1f,0xbe733f153f7f3f38,0xbf79bf50bdbc3f32,0xbf5cbf7fbf6cbf26,0x3f023d8abec7bf43,0x3f3d3f2f3f213f12,0x3f2d3f3a3f473f52
.quad 0x3e1cbe29beefbf38,0xbf7dbf7cbf63bf32,0xbe10bf41bf80bf43,0xbf7dbf28bbc93f26,0xbed8bf80bef43f12,0xbf68bcfb3f613f52,0xbf2bbf4b3f0d3f60,0xbf3f3f1c3f56befa,0xbf5bbe663f7fbecd,0xbf053f79bdbcbf6b,0xbf783ee33ec7bf74,0xbe7f3f65bf6c3e9e,0xbf803f69bf213e5a,0x3d303ed2bf473f7a,0xbf723f77bf7b3f7e,0x3eaabe863e42bdee
.quad 0xbf4f3f15be98bc97,0x3f17bf503f75bf80,0xbf1abd8a3f34bf7f,0x3f4dbf7f3f36bda3,0xbeafbf2f3f75be35,0x3f71bf3abe923f7c,0xbd62bf7e3e4e3f76,0x3f80be04bf7b3e8c,0x3e73bf59bf453ebb,0x3f793f08bf24bf6e,0x3f02bea4bf6dbf64,0x3f5c3f733ec1bee9,0x3f3d3eb5bdd5bf0a,0x3f2d3f6f3f7f3f57,0x3f673f5e3f543f49,0x3ede3eff3f103f1f
.quad 0x3ee13f373f693f7f,0x3f663f333ed53db0,0xbf3cbdb03f1b3f7c,0x3f2e3f7f3f4c3e3b,0xbf5dbf533e233f76,0xbf013f113f7d3e8f,0x3e6dbf76bea73f6e,0xbf79be8f3f723ebe,0x3f80becabf3c3f63,0xbd7bbf6b3f2e3eec,0x3eb23eecbf783f57,0x3f70bf633e823f0c,0xbf4c3f7abf793f48,0x3f1bbe54be6d3f20,0xbf4f3f48bf403f37,0xbf163f20bf2a3f33
.quad 0x3ea73c49beb23f25,0xbf723f80bf703f44,0x3f80bf443e0a3f11,0x3d173f25bf7e3f53,0x3e82bf7c3f163ef7,0x3f78be3bbf4f3f60,0xbf5abef73f663eca,0x3f06bf60bee13f6b,0xbf403ebe3f803e9b,0xbf2abf6e3d173f74,0x3ed53f743f5d3e54,0xbf69be9b3f013f7a,0x3f7e3f573f063de2,0x3e0a3f0c3f5a3f7e,0x3e233de23d7b3c49,0x3f7d3f7e3f803f80
.quad 0xbf4cbf0cbe6d3de2,0x3f1b3f573f793f7e,0x3f16bde2bf40bf80,0xbf4fbf7ebf2a3c49,0xbea73f373f703db0,0x3f723f33beb2bf7f,0x3d17bf7fbe0a3f7c,0xbf80bdb03f7e3e3b,0x3e823f53bf4fbe8f,0x3f78bf11bf163f76,0xbf06be8f3f66bf6e,0xbf5a3f76bee1bebe,0x3f40becabd173eec,0x3f2abf6b3f80bf63,0xbf693f63bf5d3f57,0xbed53eecbf013f0c
.quad 0x3f7ebf7a3f5abf20,0x3e0a3e54bf063f48,0xbf7d3f203d7bbf37,0x3e23bf483f80bf33,0x3f663c49bf693f44,0xbee13f80bed5bf25,0xbf3cbf253f4c3f11,0x3f2ebf44bf1b3f53,0x3f013f7c3e23bf60,0xbf5d3e3b3f7d3ef7,0xbe6dbf60bf72beca,0x3f793ef7bea7bf6b,0xbd7b3ebe3f3c3f74,0xbf80bf6ebf2ebe9b,0x3eb23e9b3e823e54,0x3f703f743f783f7a
.quad 0xbf40bf6ebf80bf74,0xbf2abebebd173e9b,0xbed53e9b3f5d3f7a,0x3f693f743f01be54,0x3f7e3f0cbf06bf7e,0x3e0abf57bf5a3de2,0xbe23bf7e3d7b3f80,0xbf7d3de23f80bc49,0xbf663f373ed5bf7f,0x3ee13f33bf69bdb0,0x3f2e3db0bf4c3f7c,0x3f3cbf7f3f1b3e3b,0x3f01bf533f7dbf76,0xbf5d3f11be23be8f,0xbf793f76bf723f6e,0xbe6d3e8fbea73ebe
.quad 0x3d7bbeca3f2ebf63,0x3f80bf6b3f3cbeec,0x3f70beecbe823f57,0xbeb23f63bf783f0c,0xbf1b3f7abe6dbf48,0xbf4cbe543f79bf20,0xbf16bf483f2a3f37,0x3f4fbf20bf403f33,0x3f723c49bf70bf25,0x3ea73f803eb2bf44,0x3d173f443f7e3f11,0xbf80bf253e0a3f53,0xbf78bf7cbf4fbef7,0x3e82be3bbf16bf60,0x3f063ef73ee13eca,0x3f5a3f603f663f6b
.quad 0x3f013e3bbe23bef7,0xbf5dbf7cbf7dbf60,0x3e6dbef7bf72bf6b,0xbf79bf60bea73eca,0xbd7bbf6ebf3c3e9b,0xbf80bebe3f2e3f74,0xbeb2bf743e823f7a,0xbf703e9b3f78be54,0xbf1bbf0c3f79bde2,0xbf4c3f573e6dbf7e,0xbf4f3de23f2abf80,0xbf163f7ebf403c49,0xbf723f37beb2bdb0,0xbea73f33bf703f7f,0xbf803f7fbf7e3f7c,0xbd173db0be0a3e3b
.quad 0xbf783f53bf163e8f,0x3e82bf113f4fbf76,0xbf5a3e8f3ee1bf6e,0x3f06bf763f66bebe,0xbf2abeca3f80beec,0x3f40bf6b3d173f63,0xbed5bf633f013f57,0x3f69beecbf5d3f0c,0xbe0abf7abf063f20,0x3f7e3e54bf5abf48,0x3e23bf20bf80bf37,0x3f7d3f483d7bbf33,0x3ee13c49bed5bf44,0x3f663f803f693f25,0x3f2e3f253f1b3f11,0x3f3c3f443f4c3f53
.quad 0x3ebb3f2d3f653f7f,0x3f6e3f3d3ee33dbc,0xbf49be103f153f7b,0x3f1f3f7d3f503e42,0xbf52bf5b3e043f75,0xbf123f053f7e3e92,0x3e9ebf72beb53f6d,0xbf74beaa3f6f3ec1,0x3f80beafbf413f63,0x3c97bf713f283eef,0x3e8c3f02bf793f56,0x3f76bf5c3e663f0d,0xbf573f7dbf773f47,0x3f0abe1cbe863f21,0xbf433f3fbf3a3f36,0xbf263f2bbf2f3f34
.quad 0x3ecdbd30bea43f24,0xbf6b3f80bf733f45,0x3f7ebf4d3e293f10,0x3dee3f1abf7c3f54,0x3e35bf793f1c3ef4,0x3f7cbe73bf4b3f61,0xbf64bede3f693ec7,0x3ee9bf67bed23f6c,0xbf323ed83f7f3e98,0xbf38bf683d8a3f75,0x3efa3f783f593e4e,0xbf60be7f3f083f7b,0x3f7a3f4f3eff3dd5,0x3e5a3f173f5e3f7f,0x3da33d623cfb3bc9,0x3f7f3f803f803f80
.quad 0xbf64bf2bbeb53bc9,0x3ee93f3f3f6f3f80,0x3f383d30bf28bf7f,0xbf32bf80bf41bdbc,0xbefa3f1a3f793e42,0x3f603f4dbe66bf7b,0x3e5abf79be863f75,0xbf7abe733f773e92,0x3da33f67bf3abec1,0x3f7fbedebf2f3f6d,0xbebbbed83f73bf63,0xbf6e3f68bea4beef,0x3f1fbe7fbe293f0d,0x3f49bf783f7cbf56,0xbf523f4fbf4b3f47,0xbf123f17bf1c3f21
.quad 0x3f74bf803f69bf34,0x3e9e3d62bed23f36,0xbf803f3dbd8abf24,0xbc97bf2d3f7fbf45,0x3f76be10bf593f54,0xbe8c3f7dbf08bf10,0xbf57bf053f5e3ef4,0x3f0abf5bbeff3f61,0x3f263f723cfbbf6c,0xbf433eaa3f803ec7,0xbecdbf71bf65be98,0x3f6b3eafbee3bf75,0x3dee3f023f503f7b,0xbf7ebf5cbf15be4e,0x3e353e1c3e043dd5,0x3f7c3f7d3f7e3f7f
.quad 0xbf0abf4fbf77bf7f,0xbf57bf17be863dd5,0xbf263d623f3a3f80,0x3f433f803f2fbbc9,0x3f6b3f3dbea4bf7f,0x3ecdbf2dbf73bdbc,0x3deebf7dbe293f7b,0xbf7ebe103f7c3e42,0xbf7c3f053f1cbf75,0x3e353f5bbf4bbe92,0x3ee93eaabf693f6d,0x3f64bf723ed23ec1,0x3f38bf713f7fbf63,0xbf323eaf3d8abeef,0xbf603f5cbf593f56,0xbefa3f02bf083f0d
.quad 0xbe5abe1c3effbf47,0x3f7abf7d3f5ebf21,0x3f7fbf2bbcfb3f36,0xbda33f3fbf803f34,0xbebb3f80bee3bf24,0xbf6e3d303f65bf45,0xbf49bf1a3f503f10,0x3f1fbf4dbf153f54,0x3f52be73bf7ebef4,0x3f123f793e04bf61,0x3e9e3f673f6f3ec7,0xbf74bede3eb53f6c,0xbf80bf68bf28be98,0xbc97bed8bf41bf75,0x3e8c3e7f3e663e4e,0x3f763f783f793f7b
.quad 0x3f493f023e29be4e,0xbf1fbf5cbf7cbf7b,0x3f12be1cbf4bbf7f,0xbf52bf7dbf1c3dd5,0x3e9ebf3fbf693bc9,0xbf74bf2b3ed23f80,0x3c97bf80bd8a3f7f,0xbf80bd303f7f3dbc,0xbe8cbf4d3f593e42,0xbf763f1a3f08bf7b,0xbf0abe733f5ebf75,0xbf573f79beffbe92,0xbf433edebcfbbec1,0xbf263f67bf803f6d,0xbf6b3f68bf653f63,0xbecd3ed8bee33eef
.quad 0xbf7e3f78bf503f0d,0xbdeebe7f3f15bf56,0xbf7c3f173e04bf47,0x3e35bf4f3f7ebf21,0xbf64bd623f6fbf34,0x3ee9bf803eb53f36,0xbf38bf2d3f413f24,0x3f32bf3dbf283f45,0xbefabf7dbe663f54,0x3f60be10bf79bf10,0xbe5abf5bbf77bef4,0x3f7a3f05be86bf61,0x3da3beaabf2fbf6c,0x3f7f3f723f3a3ec7,0x3ebb3eaf3ea43e98,0x3f6e3f713f733f75
.quad 0x3f803f803f803f80,0,0x3e793f183f5c3f7d,0x3f783f4e3f043e16,0xbf62be953ef13f75,0x3ef13f753f623e95,0xbf2cbf71bd493f67,0xbf3e3eac3f803edb,0x3f0ebf55bf0e3f55,0xbf55bf0e3f553f0e,0x3f71bd49bf673f3e,0x3eacbf803edb3f2c,0xbdc93f46bf7f3f22,0x3f7fbf22bdc93f46,0xbf7d3f78bf4e3f04,0x3e163e79bf183f5c
.quad 0xbec43ec4bec43ec4,0xbf6d3f6dbf6d3f6d,0x3f4ebf043e163e79,0xbf183f5cbf7d3f78,0x3f46bf7f3f223dc9,0x3f223dc9bf463f7f,0xbedbbf2c3f71bd49,0x3f67bf3ebeac3f80,0xbf7b3e483f7bbe48,0xbe48bf7b3e483f7b,0xbd493f673f3ebeac,0xbf80bedb3f2c3f71,0x3f753f623e95bef1,0xbe953ef13f753f62,0x3f043e16be79bf18,0x3f5c3f7d3f783f4e
.quad 0x3f803f803f803f80,0,0xbf78bf4ebf04be16,0x3e793f183f5c3f7d,0x3f623e95bef1bf75,0xbef1bf75bf62be95,0xbf3e3eac3f803edb,0x3f2c3f713d49bf67,0x3f0ebf55bf0e3f55,0xbf55bf0e3f553f0e,0xbeac3f80bedbbf2c,0x3f71bd49bf673f3e,0x3dc9bf463f7fbf22,0xbf7f3f223dc9bf46,0x3e163e79bf183f5c,0x3f7dbf783f4ebf04
.quad 0xbec43ec4bec43ec4,0xbf6d3f6dbf6d3f6d,0x3f18bf5c3f7dbf78,0x3f4ebf043e163e79,0xbf463f7fbf22bdc9,0xbf22bdc93f46bf7f,0x3f67bf3ebeac3f80,0x3edb3f2cbf713d49,0xbf7b3e483f7bbe48,0xbe48bf7b3e483f7b,0x3f803edbbf2cbf71,0xbd493f673f3ebeac,0xbf75bf62be953ef1,0x3e95bef1bf75bf62,0x3f5c3f7d3f783f4e,0xbf04be163e793f18
.quad 0x3f803f803f803f80,0,0xbe79bf18bf5cbf7d,0xbf78bf4ebf04be16,0xbf62be953ef13f75,0x3ef13f753f623e95,0x3f2c3f713d49bf67,0x3f3ebeacbf80bedb,0x3f0ebf55bf0e3f55,0xbf55bf0e3f553f0e,0xbf713d493f67bf3e,0xbeac3f80bedbbf2c,0xbdc93f46bf7f3f22,0x3f7fbf22bdc93f46,0x3f7dbf783f4ebf04,0xbe16be793f18bf5c
.quad 0xbec43ec4bec43ec4,0xbf6d3f6dbf6d3f6d,0xbf4e3f04be16be79,0x3f18bf5c3f7dbf78,0x3f46bf7f3f223dc9,0x3f223dc9bf463f7f,0x3edb3f2cbf713d49,0xbf673f3e3eacbf80,0xbf7b3e483f7bbe48,0xbe48bf7b3e483f7b,0x3d49bf67bf3e3eac,0x3f803edbbf2cbf71,0x3f753f623e95bef1,0xbe953ef13f753f62,0xbf04be163e793f18,0xbf5cbf7dbf78bf4e
.quad 0x3f803f803f803f80,0,0x3f783f4e3f043e16,0xbe79bf18bf5cbf7d,0x3f623e95bef1bf75,0xbef1bf75bf62be95,0x3f3ebeacbf80bedb,0xbf2cbf71bd493f67,0x3f0ebf55bf0e3f55,0xbf55bf0e3f553f0e,0x3eacbf803edb3f2c,0xbf713d493f67bf3e,0x3dc9bf463f7fbf22,0xbf7f3f223dc9bf46,0xbe16be793f18bf5c,0xbf7d3f78bf4e3f04
.quad 0xbec43ec4bec43ec4,0xbf6d3f6dbf6d3f6d,0xbf183f5cbf7d3f78,0xbf4e3f04be16be79,0xbf463f7fbf22bdc9,0xbf22bdc93f46bf7f,0xbf673f3e3eacbf80,0xbedbbf2c3f71bd49,0xbf7b3e483f7bbe48,0xbe48bf7b3e483f7b,0xbf80bedb3f2c3f71,0x3d49bf67bf3e3eac,0xbf75bf62be953ef1,0x3e95bef1bf75bf62,0xbf5cbf7dbf78bf4e,0x3f043e16be79bf18
.quad 0x3f7f3f803f803f80,0x3da93d6f3d0a3c17,0x3e263f0c3f573f7d,0x3f7d3f563f0b3e20,0xbf6bbeb13ee23f74,0x3ecb3f703f663e99,0xbf1cbf76bda93f66,0xbf4b3e903f7f3edf,0x3f1fbf4cbf153f54,0xbf48bf1a3f503f10,0x3f693c17bf6b3f3c,0x3ed4bf803ecb3f2e,0xbe383f4fbf7e3f21,0x3f7cbf17be073f47,0xbf7f3f74bf483f02,0x3d843e99bf1f3f5d
.quad 0xbe9c3ea8beb43ec0,0xbf743f72bf703f6d,0x3f5abf103e383e70,0xbf073f54bf7c3f79,0x3f38bf803f293db6,0x3f323d23bf403f7f,0xbf00bf213f74bd6f,0x3f5ebf47be9c3f80,0xbf763e813f79be51,0xbe8dbf783e6a3f7b,0x3d0a3f6d3f38beb1,0xbf80bec03f323f70,0x3f7a3f5a3e84bef6,0xbe573f063f773f61,0x3ee23db6be8dbf1a,0x3f663f7f3f763f4c
.quad 0x3f7c3f7d3f7e3f7f,0x3e383e203e073ddb,0xbf7fbf63bf1fbe81,0x3d843eed3f483f78,0x3f743edfbeb4bf6c,0xbe9cbf66bf70bec8,0xbf5a3e3f3f7c3f06,0x3f073f7c3e38bf5a,0x3f32bf3cbf293f44,0xbf38bf2e3f403f24,0xbf003f7fbe9cbf3f,0x3f5e3ddbbf743f2a,0x3e8dbf5d3f79bf0c,0xbf763f023e6abf56,0xbd0a3ec8bf323f68,0x3f80bf6c3f38bed7
.quad 0xbe573e70be843e90,0xbf7a3f79bf773f76,0x3ee2bf443f76bf7e,0x3f66bf243e8d3e0d,0xbf253f80bf3b3c17,0xbf433d6f3f2fbf80,0x3f50bf56be573f7d,0x3f153f0cbf7a3e20,0xbf6e3eb13f72be99,0xbebdbf703ea53f74,0x3f7e3e90bf43bf66,0x3e073f763f25bedf,0xbf7ebf4cbe263f10,0x3de8bf1abf7dbf54,0x3f703f803f6e3f3c,0xbeb43c173ebd3f2e
.quad 0x3f763f783f793f7b,0x3e8d3e813e6a3e51,0x3d0abec0bf38bf70,0xbf80bf6dbf32beb1,0xbf7abf063e843f61,0x3e573f5a3f773ef6,0x3ee23f7f3e8dbf4c,0x3f66bdb6bf76bf1a,0x3f43bf2abf3b3f33,0xbf25bf3f3f2f3f37,0xbf50be513f7abf17,0xbf153f7bbe57bf4f,0xbebd3f68bf723eed,0x3f6ebed7bea53f63,0x3f7ebf613f25bea8,0x3e07bef63f43bf72
.quad 0xbde83e0dbe263e3f,0xbf7e3f7ebf7d3f7c,0xbf703f37bebdbd23,0x3eb4bf333f6ebf80,0x3f11bf7d3f4bbddb,0x3f53be20bf1c3f7f,0x3f293eedbf7e3e81,0xbf403f633de8bf78,0xbf643edf3f69bec8,0xbeeabf663ed43f6c,0xbe6abf7cbf113f06,0x3f793e3fbf53bf5a,0x3f803f3c3d84bf24,0xbc7b3f2e3f7f3f44,0xbe843ddb3eea3f3f,0xbf77bf7fbf64bf2a
.quad 0x3f6e3f703f723f74,0x3ebd3eb13ea53e99,0x3f7e3f763f433edf,0x3e07be90bf25bf66,0x3f7e3f1abe26bf54,0xbde8bf4cbf7dbf10,0x3f703c17bf6ebf2e,0xbeb4bf80bebd3f3c,0x3f53bf17bf4b3f21,0xbf11bf4f3f1c3f47,0x3f29bf743de83f5d,0xbf40be993f7ebf02,0x3eeabf723f69bec0,0xbf643ea83ed4bf6d,0x3e6abf103f53bf79,0xbf793f54bf113e70
.quad 0xbc7b3d23bd843db6,0xbf803f80bf7f3f7f,0xbe843f21bf643f80,0xbf773f47beea3d6f,0xbef83f78bf5a3e51,0xbf603e813f07bf7b,0xbf2f3f6d3c7bbf70,0xbf3bbec03f80beb1,0xbf573f063f5ebef6,0xbf0bbf5a3f003f61,0xbf72bdb63f603f4c,0xbea5bf7fbef83f1a,0xbf7fbf2a3d0a3f37,0xbda9bf3fbf80bf33,0xbf7dbf7bbf57bf17,0x3e26be51bf0bbf4f
.quad 0x3f7c3f7e3f7f3f80,0x3e293dee3d8a3c97,0x3da33eff3f523f7c,0x3f7f3f5e3f123e29,0xbf73becd3ed23f74,0x3ea43f6b3f693e9e,0xbf0abf79bdee3f65,0xbf573e663f7e3ee3,0x3f2fbf43bf1c3f52,0xbf3abf263f4b3f12,0x3f603d8abf6e3f3a,0x3efabf7f3ebb3f2f,0xbe863f57bf7c3f1f,0x3f77bf0abe293f49,0xbf803f6fbf433eff,0xbc973eb5bf263f5e
.quad 0xbe663e8cbea43ebb,0xbf793f76bf733f6e,0x3f64bf1c3e5a3e66,0xbee93f4bbf7a3f79,0x3f28bf803f2f3da3,0x3f41bc97bf3a3f7f,0xbf12bf153f76bd8a,0x3f52bf50be8c3f7f,0xbf6f3e9e3f77be5a,0xbeb5bf743e863f7a,0x3dee3f733f32beb5,0xbf7ebea43f383f6f,0x3f7e3f523e66befa,0xbe043f123f793f60,0x3ebb3cfbbe9ebf1c,0x3f6e3f803f743f4b
.quad 0x3f6f3f743f773f7a,0x3eb53e9e3e863e5a,0xbf7ebf73bf38beb5,0xbdee3ea43f323f6f,0x3f7e3f12be66bf60,0xbe04bf52bf79befa,0xbf6e3cfb3f743f1c,0x3ebb3f803e9ebf4b,0x3f50bf1fbf413f32,0xbf15bf493f283f38,0xbf263f77be35bf50,0x3f433e86bf7c3f15,0x3ee3bf6e3f6fbee9,0xbf653ebb3eb5bf64,0xbe5a3f08bf493f73,0x3f7abf593f1fbea4
.quad 0xbcfb3da3be043e35,0xbf803f7fbf7e3f7c,0x3e8cbf283f6bbf80,0x3f76bf413ecd3cfb,0xbeff3f7abf503dee,0xbf5e3e5a3f15bf7e,0x3f32bf69bda33f77,0x3f383ed2bf7f3e86,0xbf593efa3f65becd,0xbf08bf603ee33f6b,0x3f743e04bf57bf59,0x3e9e3f7e3f0abf08,0xbf7fbf32bcfb3f26,0xbd8abf38bf80bf43,0x3f7c3f7c3f603f28,0xbe353e293efa3f41
.quad 0x3f593f603f653f6b,0x3f083efa3ee33ecd,0x3e9ebe04bf0abf59,0xbf74bf7ebf57bf08,0xbf7fbf383cfb3f43,0xbd8a3f323f803f26,0x3e353f7c3efabf28,0x3f7c3e29bf60bf41,0x3f69bee9bf5e3f0a,0xbed2bf643eff3f57,0xbf1fbee33f80bed2,0xbf493f653c97bf69,0xbf1c3f7cbf593e8c,0x3f4bbe35bf083f76,0x3f6bbf3a3ee9be04,0x3ecdbf2f3f64bf7e
.quad 0x3e29bdee3d8abc97,0xbf7c3f7ebf7f3f80,0xbf7f3f5ebf123e29,0x3da3beff3f52bf7c,0x3ea4bf6b3f69be9e,0x3f73becdbed23f74,0x3f573e66bf7e3ee3,0xbf0a3f79bdeebf65,0xbf3a3f263f4bbf12,0xbf2fbf433f1c3f52,0xbefabf7fbebb3f2f,0x3f60bd8abf6ebf3a,0x3f773f0abe29bf49,0x3e863f573f7c3f1f,0x3c973eb53f263f5e,0xbf80bf6fbf43beff
.quad 0x3f3a3f433f4b3f52,0x3f2f3f263f1c3f12,0x3f603f7f3f6e3f2f,0x3efa3d8abebbbf3a,0x3f773f573e29bf1f,0x3e86bf0abf7cbf49,0x3f803eb5bf43bf5e,0x3c97bf6fbf263eff,0x3f79be8cbf733ebb,0xbe66bf763ea43f6e,0x3f64bf4bbe5a3f79,0xbee9bf1c3f7abe66,0x3f41bf803f3abda3,0xbf28bc973f2fbf7f,0x3f12bf503f76bf7f,0xbf523f15be8cbd8a
.quad 0x3eb5be9e3e86be5a,0xbf6f3f74bf773f7a,0x3dee3ea4bf323f6f,0xbf7e3f73bf383eb5,0xbe043f52bf793efa,0xbf7e3f123e66bf60,0xbebb3f80be9ebf4b,0xbf6ebcfb3f74bf1c,0xbf153f493f28bf38,0xbf50bf1f3f413f32,0xbf433e863f7c3f15,0xbf26bf77be353f50,0xbf65bebb3eb53f64,0xbee3bf6ebf6fbee9,0xbf7abf59bf1fbea4,0xbe5abf08bf49bf73
.quad 0x3f783f7c3f7f3f80,0x3e7c3e323dcf3ce2,0xbb493ee53f4d3f7c,0x3f803f653f193e32,0xbf79bee83ec23f73,0x3e763f643f6d3ea2,0xbef0bf7cbe193f64,0xbf623e2c3f7d3ee8,0x3f3ebf39bf233f51,0xbf2bbf313f453f14,0x3f543e00bf713f39,0x3f0fbf7e3eab3f31,0xbeae3f5fbf7b3f1d,0x3f71befbbe4b3f4a,0xbf7f3f6abf3d3efb,0xbdcf3ed1bf2d3f5f
.quad 0xbe133e5dbe933eb7,0xbf7d3f7abf753f6f,0x3f6dbf283e7c3e5d,0xbec23f41bf783f7a,0x3f18bf7f3f363d90,0x3f4ebd9dbf343f7f,0xbf23bf083f79bd9d,0x3f45bf59be763f7f,0xbf673eba3f75be63,0xbedcbf6f3e963f7a,0x3e4b3f773f2bbeba,0xbf7bbe873f3e3f6f,0x3f803f493e45befe,0xbd3c3f1e3f7b3f5e,0x3e93bce2beaebf1e,0x3f753f803f713f49
.quad 0x3f5b3f643f6c3f73,0x3f043ee83ec53ea2,0xbf75bf7cbf4ebee8,0xbe963e2c3f183f64,0x3f803f31bdc2bf51,0x3d56bf39bf7fbf14,0xbf7bbe003f673f31,0x3e453f7e3edcbf39,0x3f68befbbf553f1d,0xbed9bf5f3f0e3f4a,0xbf463f6abd3cbf5f,0x3f223ed1bf803efb,0x3f19bf7a3f61beb7,0xbf4d3e5d3ef3bf6f,0xbec53f28bf5c3f7a,0x3f6cbf413f03be5d
.quad 0x3e19bd9d3b493d90,0xbf7d3f7fbf803f7f,0x3dc2bf083f5bbf7f,0x3f7fbf593f04bd9d,0xbeab3f6fbf623e63,0xbf713eba3ef0bf7a,0x3f0ebf773d563f6f,0x3f553e87bf803eba,0xbf3d3f1e3f54befe,0xbf2dbf493f0f3f5e,0x3f61bce2bf68bf49,0x3ef33f803ed9bf1e,0xbf78bf133dcf3f3a,0xbe7cbf52bf7fbf30,0x3f803f733f4d3f13,0x3b493ea23f193f52
.quad 0x3f2b3f393f453f51,0x3f3e3f313f233f14,0x3f0f3e00beabbf39,0xbf54bf7ebf71bf31,0xbf71bf5fbe4b3f1d,0xbeae3efb3f7b3f4a,0xbdcf3f6a3f2dbefb,0x3f7f3ed1bf3dbf5f,0x3f7dbe5dbf753eb7,0xbe13bf7a3e933f6f,0xbec2bf283f78be5d,0xbf6d3f413e7cbf7a,0xbf4e3f7fbf343d90,0x3f183d9dbf363f7f,0x3f45bf083e763d9d,0x3f23bf593f79bf7f
.quad 0x3edcbeba3e96be63,0xbf673f6fbf753f7a,0xbf7b3f77bf3e3eba,0xbe4bbe873f2bbf6f,0x3d3cbf493f7bbefe,0x3f80bf1ebe453f5e,0x3f75bce2bf713f1e,0xbe933f80beaebf49,0xbf033f523f22bf3a,0xbf5cbf133f463f30,0xbf36bf73be133f52,0x3f34bea2bf7dbf13,0x3f5b3e9fbec5bf65,0x3f043f733f6c3ee5,0x3e963f143f4e3f73,0xbf75bf51bf18be9f
.quad 0x3ed93efb3f0e3f1d,0x3f683f5f3f553f4a,0x3f223f6a3f803f5f,0x3f463ed1bd3cbefb,0x3f4d3f7a3ef3beb7,0x3f19be5dbf61bf6f,0x3f6c3f28bf03bf7a,0x3ec5bf41bf5c3e5d,0x3f7d3d9dbf803d90,0x3e19bf7fbb493f7f,0x3f7fbf08bf043f7f,0xbdc2bf593f5b3d9d,0x3f71bf6f3ef03e63,0xbeabbeba3f62bf7a,0x3f55bf773f80bf6f,0xbf0e3e873d56beba
.quad 0x3f2dbf1e3f0fbefe,0xbf3d3f49bf543f5e,0x3ef3bce2bed93f49,0xbf613f80bf683f1e,0x3e7c3f13bf7f3f3a,0xbf783f52bdcfbf30,0x3b493f73bf19bf13,0xbf803ea23f4dbf52,0xbe763f733ec2bf65,0xbf79be9f3f6d3ee5,0xbef03f143f7d3e9f,0xbf62bf513e193f73,0xbf2bbcb03f233f7c,0xbf3ebf80bf45be2c,0xbf54bf1dbeabbcb0,0xbf0fbf4abf71bf80
.quad 0x3f723f793f7e3f80,0x3ea73e6d3e0a3d17,0xbdb03eca3f483f7c,0x3f7f3f6b3f203e3b,0xbf7dbf013eb23f72,0x3e233f5d3f703ea7,0xbecabf7ebe3b3f63,0xbf6b3de23f7c3eec,0x3f4cbf2ebf2a3f4f,0xbf1bbf3c3f403f16,0x3f483e3bbf743f37,0x3f20bf7c3e9b3f33,0xbed53f66bf793f1b,0x3f69bee1be6d3f4c,0xbf7c3f63bf373ef7,0xbe3b3eecbf333f60
.quad 0xbd7b3e23be823eb2,0xbf803f7dbf783f70,0x3f74bf333e8f3e54,0xbe9b3f37bf763f7a,0x3f06bf7e3f3c3d7b,0x3f5abe0abf2e3f80,0xbf33bef73f7abdb0,0x3f37bf60be543f7f,0xbf5d3ed53f72be6d,0xbf01bf693ea73f79,0x3e8f3f7a3f25bebe,0xbf76be543f443f6e,0x3f803f403e23bf01,0x3d173f2a3f7d3f5d,0x3e54bdb0bebebf20,0x3f7a3f7f3f6e3f48
.quad 0x3f403f4f3f5d3f69,0x3f2a3f163f013ed5,0xbf63bf80bf60bf0c,0xbeec3c493ef73f57,0x3f793f4c3d17bf40,0x3e6dbf1bbf80bf2a,0xbf80be8f3f573f44,0x3c493f763f0cbf25,0x3f78beb2bf663f06,0xbe82bf703ee13f5a,0xbf603f573db0bf6b,0x3ef73f0cbf7f3eca,0x3f3cbf803f4fbe82,0xbf2e3d7b3f16bf78,0xbf0c3f44bf6b3f7e,0x3f57bf253ecabde2
.quad 0x3ea7be6d3e0abd17,0xbf723f79bf7e3f80,0xbdb0beca3f48bf7c,0x3f7fbf6b3f20be3b,0xbe233f5dbf703ea7,0xbf7d3f013eb2bf72,0x3ecabf7e3e3b3f63,0x3f6b3de2bf7c3eec,0xbf1b3f3c3f40bf16,0xbf4cbf2e3f2a3f4f,0x3f48be3bbf74bf37,0x3f203f7c3e9bbf33,0xbf69bee13e6d3f4c,0xbed5bf66bf79bf1b,0x3f7c3f633f373ef7,0x3e3b3eec3f333f60
.quad 0x3ee13f063f1b3f2e,0x3f663f5a3f4c3f3c,0x3f443ebebde2bf11,0xbf25bf6ebf7ebf53,0xbf4fbf78bed53ee1,0xbf163e823f693f66,0xbebe3f483f53be9b,0x3f6e3f20bf11bf74,0x3f7e3d17bf803e23,0x3e0abf803d7b3f7d,0xbde2bf533f63bc49,0xbf7e3f113eecbf80,0xbf703f72bf06be0a,0x3eb23ea7bf5a3f7e,0x3f11be9b3c493e8f,0x3f53bf743f80bf76
.quad 0x3f2abf163f01bed5,0xbf403f4fbf5d3f69,0xbf633f80bf603f0c,0xbeecbc493ef7bf57,0xbe6dbf1b3f80bf2a,0x3f79bf4c3d173f40,0x3f80be8fbf573f44,0xbc493f76bf0cbf25,0xbe823f703ee1bf5a,0xbf78beb23f663f06,0xbf60bf573db03f6b,0x3ef7bf0cbf7fbeca,0x3f2e3d7bbf16bf78,0x3f3c3f803f4f3e82,0x3f0c3f443f6b3f7e,0xbf57bf25becabde2
.quad 0x3d7b3e233e823eb2,0x3f803f7d3f783f70,0x3e9b3f373f763f7a,0x3f743f333e8fbe54,0x3f063f7e3f3cbd7b,0x3f5a3e0abf2ebf80,0x3f373f60be54bf7f,0x3f33bef7bf7abdb0,0x3f5d3ed5bf72be6d,0x3f01bf69bea73f79,0x3f76be54bf443f6e,0x3e8fbf7a3f253ebe,0x3f80bf403e233f01,0x3d17bf2a3f7dbf5d,0x3f7abf7f3f6ebf48,0xbe54bdb03ebebf20
.quad 0x3f66bf5a3f4cbf3c,0xbee13f06bf1b3f2e,0x3f44bebebde23f11,0xbf253f6ebf7e3f53,0x3f163e82bf693f66,0xbf4f3f78bed5bee1,0x3ebe3f48bf53be9b,0xbf6e3f203f11bf74,0x3e0a3f803d7bbf7d,0xbf7e3d173f803e23,0xbde23f533f633c49,0xbf7ebf113eec3f80,0xbeb23ea73f5a3f7e,0xbf70bf72bf063e0a,0xbf11be9bbc493e8f,0xbf53bf74bf80bf76
.quad 0x3f6a3f753f7c3f80,0x3ece3e933e2c3d3c,0xbe2c3eae3f423f7b,0x3f7c3f713f273e45,0xbf7fbf0e3ea23f71,0x3d9d3f553f733eab,0xbea2bf80be5d3f62,0xbf733d563f7a3ef0,0x3f58bf23bf303f4e,0xbf0abf453f3a3f18,0x3f3a3e76bf773f36,0x3f30bf793e8a3f34,0xbefb3f6cbf773f19,0x3f5fbec5be873f4d,0xbf773f5cbf313ef3,0xbe873f03bf393f61
.quad 0x3cb03dcfbe633eae,0xbf803f7fbf7a3f71,0x3f7abf3d3e9f3e4b,0xbe633f2dbf733f7b,0x3ee8bf7b3f413d56,0x3f64be45bf283f80,0xbf41bedc3f7cbdc2,0x3f28bf67be323f7f,0xbf523ef03f6fbe76,0xbf13bf623eb73f79,0x3eb73f7d3f1ebec2,0xbf6fbe193f493f6d,0x3f7e3f363e00bf03,0x3df43f343f7e3f5c,0x3e00be13becebf22,0x3f7e3f7d3f6a3f46
.quad 0x3f1e3f363f4a3f5c,0x3f493f343f1d3f03,0xbf4abf7dbf6fbf22,0xbf1dbe133eba3f46,0x3f6a3f613e2cbf2d,0x3ecebef3bf7cbf3d,0xbf7cbed93f423f54,0xbe2c3f683f27bf0f,0x3f7fbe4bbf733edc,0xbd9dbf7b3ea23f67,0xbf733f3e3e5dbf75,0x3ea23f2bbf7a3e96,0x3f58bf7f3f3abe19,0xbf0abdc23f30bf7d,0xbf303f5bbf773f80,0x3f3abf043e8abb49
.quad 0x3efbbec23e87be13,0xbf5f3f6dbf773f7d,0xbe87be7c3f31bf75,0x3f77bf783f39be93,0x3cb03f46bf7a3ed9,0xbf803f223e63bf68,0x3e63bf803e9f3f55,0x3f7abd3cbf733f0e,0xbee83f543f28bf2b,0xbf64bf0f3f413f3e,0x3f28beabbf7cbf23,0x3f413f713e32bf45,0xbf52be963eb73f5b,0xbf13bf75bf6fbf04,0x3f6f3f4e3f1e3ec5,0x3eb73f183f493f6c
.quad 0x3e323e963ed13f04,0x3f7c3f753f6a3f5b,0x3f6a3f183df4bec5,0xbed1bf4ebf7ebf6c,0xbf1ebf80bf1d3e7c,0xbf493b493f4a3f78,0xbf1d3f193f6fbdcf,0x3f4a3f4dbebabf7f,0x3f6a3e93bf7cbd3c,0x3ecebf75be2c3f80,0x3e2cbf713f423e45,0xbf7c3eae3f27bf7b,0xbf7f3f55bea2beab,0x3d9d3f0ebf733f71,0x3ea2bd56be5d3ef0,0x3f73bf803f7abf62
.quad 0x3f58bf453f30bf18,0xbf0a3f23bf3a3f4e,0xbf3a3f79bf773f34,0xbf303e763e8abf36,0xbefbbec53f77bf4d,0x3f5fbf6c3e873f19,0x3f77bf03bf313f61,0x3e873f5cbf39bef3,0x3cb03f7f3e63bf71,0xbf80bdcf3f7a3eae,0xbf7abf2d3e9f3f7b,0x3e63bf3dbf73be4b,0x3ee8be45bf41bf80,0x3f643f7b3f283d56,0x3f413f673f7c3f7f,0xbf28bedcbe323dc2
.quad 0xbe9fbe45bd903d56,0x3f733f7b3f7f3f80,0xbd903edc3f523f7f,0x3f7f3f673f133dc2,0x3e323f623f6a3e76,0x3f7c3ef0bed1bf79,0x3ed13f7d3df4bf6d,0x3f6abe19bf7ebec2,0x3f1e3f34bf4abf03,0x3f49bf36bf1d3f5c,0x3f4a3e13bf6f3f46,0x3f1dbf7d3eba3f22,0x3f6abef3be2c3f3d,0x3ecebf613f7cbf2d,0x3f7cbf683f42bf0f,0x3e2cbed93f27bf54
.quad 0x3f7fbf7b3f73bf67,0xbd9d3e4bbea23edc,0x3f73bf2b3e5d3e96,0xbea23f3ebf7a3f75,0x3f58bdc2bf3a3f7d,0xbf0a3f7fbf30be19,0x3f303f04bf77bb49,0xbf3a3f5b3e8abf80,0x3efb3f6dbe87bf7d,0xbf5f3ec23f77be13,0x3e873f783f31be93,0xbf77be7c3f393f75,0x3cb03f223f7a3f68,0xbf80bf46be633ed9,0xbe633d3c3e9f3f0e,0xbf7abf80bf73bf55
.quad 0x3f613f713f7b3f80,0x3ef43eaf3e4e3d62,0xbe7f3e923f3d3f7b,0x3f783f753f2d3e4e,0xbf80bf1a3e923f71,0xbbc93f4d3f753eaf,0xbe73bf80be7f3f61,0xbf79bbc93f783ef4,0x3f63bf17bf363f4d,0xbeefbf4f3f343f1a,0x3f2b3e98bf793f34,0x3f3fbf753e733f36,0xbf103f72bf753f17,0x3f54beaabe983f4f,0xbf713f54bf2b3eef,0xbeaf3f10bf3f3f63
.quad 0x3dd53d30be423eaa,0xbf7f3f80bf7b3f72,0x3f7dbf473eaf3e42,0xbe103f21bf713f7b,0x3ec1bf783f473d30,0x3f6dbe7fbf213f80,0xbf4fbec13f7dbdd5,0x3f17bf6dbe103f7f,0xbf453f053f6cbe7f,0xbf24bf5b3ec73f78,0x3ede3f7f3f17bec7,0xbf67bdbc3f4f3f6c,0x3f7b3f2b3dbcbf05,0x3e4e3f3f3f7f3f5b,0x3d30be4ebedebf24,0x3f803f7b3f673f45
.quad 0x3eef3f173f343f4d,0x3f633f4f3f363f1a,0xbf2bbf75bf79bf36,0xbf3fbe983e733f34,0x3f543f723e98bf17,0x3f10beaabf75bf4f,0xbf71bf103f2b3f63,0xbeaf3f543f3fbeef,0x3f7fbd30bf7b3eaa,0x3dd5bf803e423f72,0xbf7d3f213eafbf7b,0x3e103f47bf713e42,0x3f6dbf783f21bd30,0xbec1be7f3f47bf80,0xbf4f3f6dbf7d3f7f,0x3f17bec13e103dd5
.quad 0x3f24bf053ec7be7f,0xbf453f5bbf6c3f78,0xbedebdbc3f17bf6c,0x3f67bf7f3f4fbec7,0x3e4e3f2bbf7f3f05,0xbf7b3f3f3dbcbf5b,0x3d30bf7b3ede3f45,0x3f80be4ebf673f24,0xbe923f683f0dbf3f,0xbf75bed83f563f2b,0x3f02bef4bf80bf0d,0x3f5c3f613d30bf56,0xbf34be103ef43f68,0xbf36bf7dbf61bed8,0x3f5b3f343f023e92,0x3f053f363f5c3f75
.quad 0xbdd53d303e423eaa,0x3f7f3f803f7b3f72,0x3f7d3f473eafbe42,0xbe10bf21bf71bf7b,0xbec1bf78bf473d30,0xbf6dbe7f3f213f80,0xbf4f3ec13f7d3dd5,0x3f173f6dbe10bf7f,0x3f453f05bf6cbe7f,0x3f24bf5bbec73f78,0x3edebf7f3f173ec7,0xbf673dbc3f4fbf6c,0xbf7b3f2bbdbcbf05,0xbe4e3f3fbf7f3f5b,0x3d303e4ebede3f24,0x3f80bf7b3f67bf45
.quad 0x3f75bf683f56bf3f,0xbe923ed8bf0d3f2b,0xbf023f61bf803f56,0xbf5c3ef43d30bf0d,0xbf36be103f61bf68,0x3f34bf7d3ef43ed8,0x3f5bbf36bf023f75,0x3f053f34bf5cbe92,0x3e983f7dbbc9bf7d,0xbf753e1c3f803e10,0xbf80beef3f053f80,0xbd62bf63bf5b3bc9,0x3e42bedebf63bf7d,0x3f7b3f673eefbe1c,0x3f683f7b3f803f75,0xbed8be423d623e98
.quad 0xbf24bf05bec7be7f,0x3f453f5b3f6c3f78,0xbede3dbc3f173f6c,0x3f673f7f3f4f3ec7,0xbe4e3f2b3f7f3f05,0x3f7b3f3fbdbcbf5b,0x3d303f7b3edebf45,0x3f803e4ebf67bf24,0x3e923f68bf0dbf3f,0x3f75bed8bf563f2b,0x3f023ef4bf803f0d,0x3f5cbf613d303f56,0x3f34be10bef43f68,0x3f36bf7d3f61bed8,0x3f5bbf343f02be92,0x3f05bf363f5cbf75
.quad 0x3f75bf7d3f80bf7d,0x3e98be1c3bc93e10,0x3f80bf633f05bbc9,0x3d623eefbf5b3f80,0x3f7bbedebeef3f7d,0xbe423f67bf633e1c,0x3f683e42bf803e98,0xbed83f7bbd62bf75,0x3f473f3dbf10bf67,0xbf213f2d3f54bede,0x3f1a3f7f3ed8bf10,0xbf4d3dd53f683f54,0x3ec73f5c3f7f3f3d,0xbf6cbf023dd53f2d,0x3e1c3ec73f1a3f47,0xbf7dbf6cbf4dbf21
.quad 0x3f563f6b3f793f7f,0x3f0c3ecb3e703d84,0xbea83e6a3f373f7a,0x3f723f793f333e57,0xbf7fbf253e813f70,0xbdb63f433f783eb4,0xbe20bf7fbe903f60,0xbf7dbd843f763ef8,0x3f6cbf0bbf3c3f4b,0xbec8bf573f2e3f1c,0x3f1a3eb4bf7b3f32,0x3f4cbf703e513f38,0xbf213f76bf723f15,0x3f47be8dbea83f50,0xbf683f4bbf243eea,0xbed73f1cbf443f64
.quad 0x3e3fbc7bbe203ea5,0xbf7c3f80bf7d3f72,0x3f80bf503ec03e38,0xbd6f3f15bf6d3f7c,0x3e99bf743f4c3d0a,0x3f74be9cbf1a3f80,0xbf5abea53f7fbde8,0x3f06bf72bddb3f7e,0xbf373f113f68be84,0xbf33bf533ed73f77,0x3f023f803f10becb,0xbf5dbd0a3f543f6b,0x3f763f1f3d6fbf07,0x3e903f483f803f5a,0xbd23be84beedbf25,0x3f803f773f633f43
.quad 0x3e993eea3f1a3f3b,0x3f743f643f4c3f2f,0xbf06bf66bf7fbf48,0xbf5abee23ddb3f1f,0x3f373f7c3ed7bf00,0x3f33be38bf68bf5e,0xbf5dbf2f3f103f6e,0xbf023f3b3f54bebd,0x3f763de8bf803e6a,0x3e90bf7e3d6f3f79,0xbf803f003eedbf7f,0xbd233f5ebf633da9,0x3f7bbf6b3f063d84,0xbe51becb3f5abf7f,0xbf663f79bf803f7a,0x3edfbe6a3c173e57
.quad 0x3f44bf253f02beb4,0xbf243f43bf5d3f70,0xbf173d843ef6bf60,0x3f4fbf7f3f61bef8,0x3ec03f0bbf803f1c,0xbf6d3f57bd23bf4b,0xbe0dbf703f0c3f32,0x3f7ebeb4bf563f38,0xbddb3f763edfbf50,0xbf7fbe8d3f663f15,0x3eb1bf1cbf7fbeea,0x3f703f4bbdb6bf64,0xbf103c7b3f173f72,0xbf54bf80bf4fbea5,0x3f3f3f153ec83e38,0x3f2a3f503f6c3f7c
.quad 0xbec0be57bd233e07,0x3f6d3f7a3f803f7e,0x3f7e3f693f0c3c7b,0x3e0dbed4bf56bf80,0xbddbbf60bf66be26,0xbf7fbef83edf3f7d,0xbf703e073f7f3e9c,0x3eb13f7e3db6bf74,0x3f103f38bf4fbee2,0x3f54bf32bf173f66,0x3f2abf7d3ec83f11,0xbf3fbe263f6cbf53,0xbf633eea3e0dbf2f,0xbeed3f64bf7e3f3b,0xbe703ee2bf213f48,0x3f79bf663f47bf1f
.quad 0x3f80bf7c3f70bf5e,0xbc173e38beb13f00,0xbe813f3bbf7c3f6e,0xbf783f2fbe3fbebd,0xbf613de83f3fbf79,0x3ef6bf7e3f2a3e6a,0x3f2ebf5ebe993f7f,0x3f3c3f00bf74bda9,0x3f0c3f6bbe70bf7f,0xbf563ecb3f79bd84,0xbf72be6a3f333f7a,0xbea8bf79bf373e57,0xbdb6bf25bf78bf70,0x3f7f3f433e81beb4,0x3f7d3f7f3f763f60,0xbe203d843e903ef8
.quad 0xbf61bf48bf2abf07,0x3ef63f1f3f3f3f5a,0xbf3cbe843e993f43,0x3f2e3f773f743f25,0xbf0c3ebd3f793f40,0x3f563f6e3e70bf29,0xbea83f5a3f33bf0b,0x3f723f07bf37bf57,0xbdb63f7fbe81bf69,0x3f7fbda9bf783ed4,0x3e203f40bf763e8d,0x3f7dbf29be903f76,0x3ec83e57bf3c3f7e,0x3f6cbf7a3f2ebe07,0x3f1abed43e513c7b,0x3f4cbf693f7bbf80
.quad 0x3f47bf603f72bf7d,0x3f21bef83ea8be26,0x3f68bf7e3f44be9c,0x3ed73e07bf243f74,0x3f7cbf38be203f66,0x3e3f3f32bf7d3ee2,0x3f80be26bf6d3f11,0xbd6f3f7dbec0bf53,0x3f743eeabf4cbf3b,0xbe993f643f1abf2f,0x3f5a3f663ddbbf48,0xbf063ee23f7f3f1f,0x3f333f7c3f683f00,0xbf37be383ed73f5e,0x3f023f2f3f543f6e,0xbf5dbf3bbf10bebd
.quad 0x3f4a3f653f773f7f,0x3f1d3ee63e893d97,0xbecf3e2f3f313f7a,0x3f6a3f7c3f393e60,0xbf7cbf313e603f6f,0xbe2f3f393f7a3eb8,0xbd97bf7ebea13f5f,0xbf7fbdfb3f733efc,0x3f73befcbf423f4a,0xbea1bf5f3f273f1d,0x3f093ecfbf7c3f31,0x3f58bf6a3e2f3f39,0xbf313f7abf6f3f13,0x3f39be60beb83f51,0xbf5f3f42bf1d3ee6,0xbefc3f27bf4a3f65
.quad 0x3e89bd97bdfb3ea1,0xbf773f7fbf7e3f73,0x3f80bf583ecf3e2f,0x3cc93f09bf6a3f7c,0x3e60bf6f3f513cc9,0x3f7abeb8bf133f80,0xbf65be893f7fbdfb,0x3ee6bf77bd973f7e,0xbf273f1d3f65be89,0xbf42bf4a3ee63f77,0x3f133f803f09becf,0xbf513cc93f583f6a,0x3f6f3f133cc9bf09,0x3eb83f513f803f58,0xbdfbbea1befcbf27,0x3f7e3f733f5f3f42
.quad 0x3dfb3ea13efc3f27,0x3f7e3f733f5f3f42,0xbeb8bf51bf80bf58,0xbf6fbf13bcc93f09,0x3f133f803f09becf,0x3f51bcc9bf58bf6a,0xbf42bf4a3ee63f77,0xbf273f1d3f65be89,0x3f653e89bf7f3dfb,0x3ee6bf77bd973f7e,0xbf7a3eb83f13bf80,0xbe603f6fbf51bcc9,0x3f80bf583ecf3e2f,0xbcc9bf093f6abf7c,0xbf773f7fbf7e3f73,0x3e89bd97bdfb3ea1
.quad 0x3f5fbf423f1dbee6,0xbefc3f27bf4a3f65,0xbf393e603eb8bf51,0x3f31bf7a3f6fbf13,0x3f093ecfbf7c3f31,0xbf583f6abe2fbf39,0xbea1bf5f3f273f1d,0x3f73befcbf423f4a,0x3d973f7e3ea1bf5f,0xbf7fbdfb3f733efc,0x3e2fbf39bf7abeb8,0x3f7c3f31be60bf6f,0xbecf3e2f3f313f7a,0xbf6abf7cbf39be60,0x3f1d3ee63e893d97,0x3f4a3f653f773f7f
.quad 0xbf1dbee6be89bd97,0x3f4a3f653f773f7f,0x3f6a3f7c3f393e60,0x3ecfbe2fbf31bf7a,0x3e2fbf39bf7abeb8,0xbf7cbf313e603f6f,0xbf7fbdfb3f733efc,0x3d973f7e3ea1bf5f,0x3ea13f5fbf27bf1d,0x3f73befcbf423f4a,0x3f58bf6a3e2f3f39,0xbf09becf3f7cbf31,0xbf393e603eb8bf51,0xbf313f7abf6f3f13,0xbefc3f27bf4a3f65,0x3f5fbf423f1dbee6
.quad 0x3f77bf7f3f7ebf73,0x3e89bd97bdfb3ea1,0x3cc93f09bf6a3f7c,0xbf803f58becfbe2f,0xbf7a3eb83f13bf80,0x3e60bf6f3f513cc9,0x3ee6bf77bd973f7e,0x3f653e89bf7f3dfb,0x3f423f4abee6bf77,0xbf273f1d3f65be89,0xbf513cc93f583f6a,0xbf13bf80bf093ecf,0xbeb8bf51bf80bf58,0x3f6f3f133cc9bf09,0x3f7e3f733f5f3f42,0x3dfb3ea13efc3f27
.quad 0xbf7ebf73bf5fbf42,0x3dfb3ea13efc3f27,0xbf6fbf13bcc93f09,0x3eb83f513f803f58,0xbf513cc93f583f6a,0x3f133f803f09becf,0xbf273f1d3f65be89,0x3f423f4abee6bf77,0xbee63f773d97bf7e,0x3f653e89bf7f3dfb,0xbe603f6fbf51bcc9,0x3f7abeb8bf133f80,0x3cc93f09bf6a3f7c,0x3f80bf583ecf3e2f,0x3e89bd97bdfb3ea1,0x3f77bf7f3f7ebf73
.quad 0x3efcbf273f4abf65,0x3f5fbf423f1dbee6,0x3f31bf7a3f6fbf13,0x3f39be60beb83f51,0x3f58bf6a3e2f3f39,0x3f093ecfbf7c3f31,0x3f73befcbf423f4a,0x3ea13f5fbf27bf1d,0x3f7f3dfbbf73befc,0x3d973f7e3ea1bf5f,0x3f7c3f31be60bf6f,0xbe2f3f393f7a3eb8,0x3f6a3f7c3f393e60,0xbecf3e2f3f313f7a,0x3f4a3f653f773f7f,0xbf1dbee6be89bd97
.quad 0x3f3c3f5e3f743f7f,0x3f2e3f003e993da9,0xbef63de83f2a3f79,0x3f613f7e3f3f3e6a,0xbf78bf3b3e3f3f6e,0xbe813f2f3f7c3ebd,0x3c17bf7cbeb13f5e,0xbf80be383f703f00,0x3f79bee2bf473f48,0xbe70bf663f213f1f,0x3eed3eeabf7e3f2f,0x3f63bf643e0d3f3b,0xbf3f3f7dbf6c3f11,0x3f2abe26bec83f53,0xbf543f38bf173ee2,0xbf103f32bf4f3f66
.quad 0x3eb1be07bdb63e9c,0xbf703f7ebf7f3f74,0x3f7fbf603edf3e26,0x3ddb3ef8bf663f7d,0x3e0dbf693f563c7b,0x3f7ebed4bf0c3f80,0xbf6dbe573f80be07,0x3ec0bf7abd233f7e,0xbf173f293f61be8d,0xbf4fbf403ef63f76,0x3f243f7f3f02bed4,0xbf443da93f5d3f69,0x3f663f07bc17bf0b,0x3edf3f5a3f803f57,0xbe51bebdbf06bf29,0x3f7b3f6e3f5a3f40
.quad 0xbd6f3e263ec03f11,0x3f803f7d3f6d3f53,0xbe3fbf38bf7dbf66,0xbf7cbf32be203ee2,0x3ed73f7e3f24be9c,0x3f683e07bf44bf74,0xbf21bf603ea83f7d,0xbf473ef83f72be26,0x3f4c3ed4bf7b3c7b,0x3f1abf69be513f80,0xbf6c3e573f2ebf7e,0xbec83f7abf3cbe07,0x3f7dbf403e903e8d,0x3e20bf293f76bf76,0xbf7f3f7fbf783f69,0x3db63da9be813ed4
.quad 0x3f72bf5a3f37bf0b,0xbea83f07bf333f57,0xbf563ebd3e70bf40,0x3f0cbf6e3f79bf29,0x3f2e3e84bf743f43,0xbf3c3f77be99bf25,0xbef6bf483f3f3f07,0x3f61bf1fbf2a3f5a,0x3e813f803e3fbf6b,0xbf783d0a3f7c3ecb,0xbc17bf53bf70be84,0x3f803f11beb1bf77,0xbe703ea53f473f7e,0xbf79bf72bf21bde8,0x3eed3e9c3e0dbd0a,0x3f633f743f7e3f80
.quad 0xbf4fbf29bef6be8d,0x3f173f403f613f76,0x3f443f7f3f5d3ed4,0x3f243da9bf02bf69,0x3edfbf07bf80bf0b,0xbf66bf5abc173f57,0xbf7bbebd3f5a3f29,0xbe513f6e3f06bf40,0x3d233f77beedbf43,0x3f80be84bf633f25,0x3f76bf48bd6f3f5a,0xbe90bf1f3f80bf07,0xbf02bd0a3f10bf6b,0xbf5d3f80bf543ecb,0xbf373f53bf683f77,0x3f33bf113ed7be84
.quad 0x3f5abf723f7fbf7e,0x3f06bea53ddb3de8,0x3e993e9cbf4c3f80,0xbf743f74bf1a3d0a,0xbf803f153ec0bf7c,0xbd6fbf503f6dbe38,0x3e3fbf803e203f72,0x3f7c3c7bbf7d3ea5,0x3f683f1cbf24bf64,0xbed73f4b3f44beea,0xbf213e8d3f723f50,0xbf47bf76bea83f15,0xbf1abf70bf7bbf38,0x3f4c3eb4be51bf32,0x3f6c3f573f3c3f1c,0x3ec83f0b3f2e3f4b
.quad 0xbf78bf80bf7cbf6b,0xbe81bd0a3e3f3ecb,0xbf80bf53beb13e84,0xbc173f113f703f77,0xbf79bea53f213f7e,0x3e703f723f47bde8,0xbf633e9c3f7e3d0a,0x3eed3f74be0dbf80,0xbf3f3f503ec8bf7c,0x3f2a3f15bf6cbe38,0xbf103f80bf17bea5,0x3f54bc7bbf4f3f72,0xbeb13f4bbf7f3f64,0x3f70bf1c3db63eea,0xbddb3e8dbedf3f15,0x3f7fbf763f66bf50
.quad 0x3e0dbeb43f0cbf38,0x3f7ebf703f56bf32,0x3ec0bf573f80bf4b,0x3f6dbf0bbd233f1c,0x3f17bf7f3ef63ef8,0x3f4f3d84bf613f60,0x3f44bf43bf023f70,0x3f243f25bf5dbeb4,0x3f66be6abf80be57,0x3edf3f79bc17bf7a,0x3f7b3ecbbf06bf7f,0x3e513f6b3f5a3d84,0x3f803f5e3eedbda9,0xbd233f003f633f7f,0x3f763f7e3f803f79,0xbe90bde83d6f3e6a
.quad 0x3f2d3f563f723f7f,0x3f3d3f0d3eaa3dbc,0xbf0d3d623f243f79,0x3f563f803f453e73,0xbf72bf453e1c3f6d,0xbeaa3f243f7d3ec1,0x3dbcbf79bec13f5c,0xbf7fbe733f6d3f02,0x3f7dbec7bf4d3f47,0xbe1cbf6c3f1a3f21,0x3ec73f02bf7f3f2d,0x3f6cbf5c3dd53f3d,0xbf4d3f7fbf683f10,0x3f1abdd5bed83f54,0xbf473f2dbf103ede,0xbf213f3dbf543f67
.quad 0x3ed8be42bd623e98,0xbf683f7bbf803f75,0x3f7bbf673eef3e1c,0x3e423edebf633f7d,0x3d62bf633f5b3bc9,0x3f80beefbf053f80,0xbf75be1c3f80be10,0x3e98bf7dbbc93f7d,0xbf053f343f5cbe92,0xbf5bbf363f023f75,0x3f343f7d3ef4bed8,0xbf363e103f613f68,0x3f5c3ef4bd30bf0d,0x3f023f613f803f56,0xbe92bed8bf0dbf2b,0x3f753f683f563f3f
.quad 0xbe733bc93e7f3ef4,0x3f793f803f783f61,0xbbc9bf1abf75bf71,0xbf80bf4dbe923eaf,0x3e7f3f753f3dbe4e,0x3f783e92bf2dbf7b,0xbef4bf713e4e3f80,0xbf613eaf3f7bbd62,0x3f2d3f0dbf72bdbc,0x3f3dbf56beaa3f7f,0xbf563d623f45bf79,0xbf0d3f80bf24be73,0x3f72bf243e1c3ec1,0x3eaabf453f7dbf6d,0xbf7f3f79bf6d3f5c,0xbdbc3e73bec13f02
.quad 0x3f7dbf6c3f4dbf21,0xbe1c3ec7bf1a3f47,0xbf6c3f023dd5bf2d,0x3ec7bf5c3f7fbf3d,0x3f4d3dd5bf683f54,0xbf1a3f7fbed8bf10,0xbf21bf2d3f543ede,0x3f47bf3dbf103f67,0x3ed83f7b3d62bf75,0xbf683e423f803e98,0xbe42bf67bf63be1c,0x3f7b3edebeefbf7d,0xbd623eef3f5b3f80,0xbf80bf63bf05bbc9,0x3e983e1c3bc9be10,0x3f753f7d3f803f7d
.quad 0xbf71bf54bf2bbeef,0x3eaf3f103f3f3f63,0x3f103f723f753f17,0x3f543eaabe98bf4f,0x3f2bbe98bf79bf34,0xbf3fbf75be733f36,0xbf63bf173f363f4d,0xbeef3f4f3f34bf1a,0xbe733f80be7fbf61,0x3f79bbc9bf783ef4,0x3f80bf1abe923f71,0xbbc9bf4d3f75beaf,0xbe7fbe923f3dbf7b,0xbf783f75bf2d3e4e,0xbf613f71bf7b3f80,0x3ef4beaf3e4ebd62
.quad 0x3f2dbf563f72bf7f,0x3f3dbf0d3eaabdbc,0x3f0d3d62bf243f79,0xbf563f80bf453e73,0xbf723f453e1cbf6d,0xbeaabf243f7dbec1,0xbdbcbf793ec13f5c,0x3f7fbe73bf6d3f02,0x3f7d3ec7bf4dbf47,0xbe1c3f6c3f1abf21,0xbec73f023f7f3f2d,0xbf6cbf5cbdd53f3d,0xbf4dbf7fbf68bf10,0x3f1a3dd5bed8bf54,0x3f473f2d3f103ede,0x3f213f3d3f543f67
.quad 0xbf4fbf6dbf7dbf7f,0xbf17bec1be103dd5,0xbf6dbf78bf21bd30,0xbec13e7f3f473f80,0xbf7dbf213eaf3f7b,0xbe103f473f713e42,0xbf7fbd303f7b3eaa,0x3dd53f803e42bf72,0xbf713f103f2bbf63,0x3eaf3f54bf3fbeef,0xbf543f72be98bf17,0x3f103eaabf753f4f,0xbf2b3f75bf793f36,0x3f3fbe98be733f34,0xbeef3f17bf343f4d,0x3f63bf4f3f36bf1a
.quad 0xbe73bbc93e7fbef4,0x3f79bf803f78bf61,0x3bc9bf1a3f75bf71,0x3f80bf4d3e923eaf,0x3e7fbf753f3d3e4e,0x3f78be92bf2d3f7b,0x3ef4bf71be4e3f80,0x3f613eafbf7bbd62,0x3f2dbf0dbf723dbc,0x3f3d3f56beaabf7f,0x3f563d62bf45bf79,0x3f0d3f803f24be73,0x3f723f243e1cbec1,0x3eaa3f453f7d3f6d,0x3f7f3f793f6d3f5c,0x3dbc3e733ec13f02
.quad 0x3f1d3f4d3f6f3f7f,0x3f4a3f193eba3dcf,0xbf1ebb493f1d3f78,0x3f493f803f4a3e7c,0xbf6abf4e3df43f6c,0xbed13f183f7e3ec5,0x3e32bf75bed13f5b,0xbf7cbe963f6a3f04,0x3f7fbeabbf523f45,0xbd90bf713f133f23,0x3e9f3f0fbf7f3f2b,0x3f73bf543d903f3e,0xbf593f80bf643f0e,0x3f08bd3cbee83f55,0xbf393f22bf083ed9,0xbf313f46bf593f68
.quad 0x3efebe7cbcb03e93,0xbf5e3f78bf803f75,0x3f77bf6d3efe3e13,0x3e8a3ec2bf5e3f7d,0xbce2bf5b3f5fbb49,0x3f80bf04befb3f80,0xbf7abdc23f80be19,0x3e5dbf7f3ce23f7d,0xbee53f3e3f58be96,0xbf65bf2b3f0a3f75,0x3f423f7b3ee5bedc,0xbf273e4b3f653f67,0x3f513ed9bd9dbf0f,0x3f143f683f7f3f54,0xbebabef3bf14bf2d,0x3f6f3f613f513f3d
.quad 0xbed1be193df43ec2,0x3f6a3f7d3f7e3f6d,0x3e32bef0bf6abf79,0xbf7cbf62bed13e76,0x3d903f673f52bdc2,0x3f7f3edcbf13bf7f,0xbe9fbf7b3d903f80,0xbf733e453f7f3d56,0x3f083f2dbf64be4b,0x3f59bf3dbee83f7b,0xbf39bdcf3f59bf71,0xbf313f7fbf08beae,0x3f5ebf033cb03ef3,0x3efebf5c3f80bf61,0xbf773f6cbf5e3f4d,0xbe8a3ec5befe3f19
.quad 0x3f80bf793f5fbf36,0x3ce23e76befb3f34,0xbf7a3f23bce2bf18,0x3e5dbf453f80bf4e,0x3f65bd56bf583f62,0xbee53f80bf0abef0,0xbf42bf0e3f653eab,0x3f27bf55bee53f71,0x3f143f71bd9dbf7b,0xbf513eae3f7f3e45,0xbebabf75bf51bd3c,0x3f6f3e93bf14bf80,0x3e003f193f6a3f7f,0xbf7ebf4dbece3dcf,0x3df4bb49be00be7c,0x3f7e3f803f7e3f78
.quad 0xbf7fbf71bf52bf23,0x3d903eab3f133f45,0x3e9f3f543f7f3f3e,0x3f733f0fbd90bf2b,0x3f59bd3cbf64bf55,0xbf08bf80bee83f0e,0xbf39bf463f083f68,0xbf313f223f59bed9,0xbefe3f78bcb0bf75,0x3f5e3e7cbf803e93,0x3f77bec2befe3f7d,0x3e8abf6d3f5ebe13,0x3ce2bf043f5fbf80,0xbf803f5bbefbbb49,0xbf7a3f7fbf803f7d,0x3e5dbdc2bce23e19
.quad 0x3ee5bf2b3f58bf75,0x3f65bf3e3f0abe96,0x3f42be4bbee53f67,0xbf273f7bbf653edc,0xbf513f68bd9dbf54,0xbf14bed93f7fbf0f,0xbebabf613f143f3d,0x3f6fbef3bf513f2d,0x3f7e3e13bf6abf22,0x3e003f7d3ecebf46,0xbdf43f363f7e3f03,0xbf7ebf343e003f5c,0xbf6fbf7dbf49bec2,0x3eb7be19bf1ebf6d,0x3f133ef03eb73e76,0x3f523f623f6f3f79
.quad 0xbf08bf3dbf64bf7b,0xbf59bf2dbee8be4b,0xbf39bf7fbf59beae,0xbf31bdcf3f083f71,0xbf5ebf5c3cb03f61,0xbefe3f033f803ef3,0xbf77bec53f5e3f19,0xbe8a3f6c3efebf4d,0xbf803e763f5fbf34,0xbce23f79befbbf36,0xbf7a3f453ce2bf4e,0x3e5d3f23bf803f18,0xbf653f80bf583ef0,0x3ee53d56bf0a3f62,0xbf423f55bf653f71,0x3f27bf0e3ee5beab
.quad 0xbf143eaebd9dbe45,0x3f51bf713f7fbf7b,0xbebabe933f51bf80,0x3f6fbf753f143d3c,0xbe00bf4d3f6abdcf,0x3f7ebf19bece3f7f,0x3df4bf803e003f78,0x3f7ebb49bf7e3e7c,0x3eb7bf4ebf493ec5,0x3f6f3f18bf1ebf6c,0x3f13be96bf6fbf5b,0x3f523f753eb7bf04,0x3f413eabbe32bf23,0x3f283f713f7c3f45,0x3f643f543f413f2b,0x3ee83f0f3f283f3e
.quad 0x3f0c3f443f6b3f7e,0x3f573f253eca3de2,0xbf2ebd7b3f163f78,0x3f3c3f803f4f3e82,0xbf60bf573db03f6b,0xbef73f0c3f7f3eca,0x3e82bf70bee13f5a,0xbf78beb23f663f06,0x3f80be8fbf573f44,0x3c49bf763f0c3f25,0x3e6d3f1bbf803f2a,0x3f79bf4c3d173f40,0xbf633f80bf603f0c,0x3eec3c49bef73f57,0xbf2a3f16bf013ed5,0xbf403f4fbf5d3f69
.quad 0x3f11be9b3c493e8f,0xbf533f74bf803f76,0x3f70bf723f063e0a,0x3eb23ea7bf5a3f7e,0xbde2bf533f63bc49,0x3f7ebf11beec3f80,0xbf7ebd173f80be23,0x3e0abf803d7b3f7d,0xbebe3f483f53be9b,0xbf6ebf203f113f74,0x3f4f3f783ed5bee1,0xbf163e823f693f66,0x3f443ebebde2bf11,0x3f253f6e3f7e3f53,0xbee1bf06bf1bbf2e,0x3f663f5a3f4c3f3c
.quad 0xbf11be9bbc493e8f,0x3f533f743f803f76,0x3eb2bea7bf5abf7e,0xbf70bf72bf063e0a,0xbde23f533f633c49,0x3f7e3f11beecbf80,0xbe0abf80bd7b3f7d,0xbf7e3d173f803e23,0x3ebe3f48bf53be9b,0x3f6ebf20bf113f74,0xbf16be823f69bf66,0xbf4f3f78bed5bee1,0x3f44bebebde23f11,0x3f25bf6e3f7ebf53,0xbf663f5abf4c3f3c,0xbee13f06bf1b3f2e
.quad 0x3f7abf7f3f6ebf48,0x3e543db0bebe3f20,0xbf803f40be23bf01,0x3d17bf2a3f7dbf5d,0x3f76be54bf443f6e,0xbe8f3f7abf25bebe,0xbf5dbed53f723e6d,0x3f01bf69bea73f79,0x3f373f60be54bf7f,0xbf333ef73f7a3db0,0xbf06bf7ebf3c3d7b,0x3f5a3e0abf2ebf80,0x3e9b3f373f763f7a,0xbf74bf33be8f3e54,0xbd7bbe23be82beb2,0x3f803f7d3f783f70
.quad 0xbf7abf7fbf6ebf48,0xbe543db03ebe3f20,0x3d173f2a3f7d3f5d,0x3f803f403e23bf01,0x3f763e54bf44bf6e,0xbe8fbf7abf253ebe,0xbf01bf693ea73f79,0xbf5d3ed53f72be6d,0xbf373f603e54bf7f,0x3f333ef7bf7a3db0,0x3f5abe0abf2e3f80,0x3f06bf7e3f3c3d7b,0x3e9bbf373f76bf7a,0xbf743f33be8fbe54,0xbf803f7dbf783f70,0xbd7b3e23be823eb2
.quad 0x3e3bbeec3f33bf60,0x3f7cbf633f37bef7,0x3f69bee1be6d3f4c,0xbed53f66bf793f1b,0xbf203f7cbe9bbf33,0xbf48be3b3f74bf37,0xbf1bbf3c3f403f16,0x3f4cbf2ebf2a3f4f,0x3f6bbde2bf7cbeec,0x3eca3f7e3e3bbf63,0x3e233f5d3f703ea7,0xbf7dbf013eb23f72,0xbf7fbf6bbf20be3b,0x3db0becabf48bf7c,0x3ea73e6d3e0a3d17,0x3f723f793f7e3f80
.quad 0xbe3bbeecbf33bf60,0xbf7cbf63bf37bef7,0xbed5bf66bf79bf1b,0xbf69bee13e6d3f4c,0xbf20bf7cbe9b3f33,0xbf483e3b3f743f37,0xbf4cbf2e3f2a3f4f,0xbf1b3f3c3f40bf16,0xbf6bbde23f7cbeec,0xbeca3f7ebe3bbf63,0xbf7d3f013eb2bf72,0xbe233f5dbf703ea7,0xbf7f3f6bbf203e3b,0x3db03ecabf483f7c,0xbf723f79bf7e3f80,0x3ea7be6d3e0abd17
.quad 0xbf573f25beca3de2,0x3f0cbf443f6bbf7e,0xbf2e3d7b3f16bf78,0x3f3cbf803f4fbe82,0xbef7bf0c3f7fbeca,0x3f60bf57bdb03f6b,0xbe82bf703ee13f5a,0x3f78beb2bf663f06,0xbc49bf76bf0c3f25,0x3f803e8fbf57bf44,0x3e6dbf1bbf80bf2a,0x3f793f4c3d17bf40,0x3eecbc49bef7bf57,0x3f633f803f603f0c,0x3f2a3f163f013ed5,0x3f403f4f3f5d3f69
.quad 0x3ef33f3a3f683f7e,0x3f613f303ed93df4,0xbf3dbdf43f0f3f77,0x3f2d3f7e3f543e87,0xbf55bf5e3d563f6a,0xbf0e3efe3f803ece,0x3eabbf6abef03f59,0xbf71bece3f623f08,0x3f7fbe63bf5b3f42,0x3dc2bf7a3f043f27,0x3e193f27bf803f28,0x3f7dbf423b493f41,0xbf6c3f7fbf5c3f0a,0x3ec53d90bf033f58,0xbf193f0abef33ed1,0xbf4d3f58bf613f6a
.quad 0x3f22beb73d3c3e8a,0xbf463f6fbf803f77,0x3f68bf773f0e3e00,0x3ed93e8abf553f7e,0xbe45bf4a3f67bcb0,0x3f7bbf1dbedc3f80,0xbf803cb03f7fbe2c,0x3d56bf803dc23f7c,0xbe963f513f4ebe9f,0xbf75bf143f183f73,0x3f5b3f733ec5bee5,0xbf043e9f3f6c3f65,0x3f363ea2be13bf13,0x3f343f733f7d3f52,0xbf03bf13bf22bf30,0x3f5c3f523f463f3a
.quad 0xbf34bee5be133e32,0x3f363f653f7d3f7c,0x3f03be32bf46bf80,0xbf5cbf7cbf223ce2,0xbe933f3a3f713df4,0x3f753f30beaebf7e,0x3d3cbf7ebe453f77,0xbf80bdf43f7b3e87,0x3e4b3f5ebf3ebece,0x3f7bbefebf2b3f6a,0xbedcbece3f75bf59,0xbf673f6abe96bf08,0x3f23be63be763f27,0x3f45bf7a3f79bf42,0xbf4e3f42bf363f28,0xbf183f27bf343f41
.quad 0x3f6dbf7f3f78bf58,0x3ec2bd90be7c3f0a,0xbf7d3f58be93bed1,0xbe13bf0a3f75bf6a,0x3f7fbeb7bf2d3f77,0xbdcf3f6fbf3dbe8a,0xbf71be8a3f7b3e00,0x3eaebf77be4b3f7e,0x3f543f4abeabbf80,0xbf0f3f1d3f71bcb0,0xbf2bbf80bf233e2c,0x3f3ebcb0bf45bf7c,0x3ef03f513f7d3f73,0xbf62bf14be193e9f,0xbe76be9fbec2bee5,0x3f793f733f6d3f65
.quad 0xbf62bf7cbf7dbf64,0xbef0be2c3e193ee8,0xbe763ee83f6d3f73,0x3f793f643ec2bea2,0x3f803ee5bf19bf7c,0xbb49bf65bf4d3e32,0xbe7cbf7c3dcf3f80,0xbf783e323f7fbce2,0xbf613f3a3ed9bf7e,0x3ef33f30bf68bdf4,0x3f2d3df4bf543f77,0x3f3dbf7e3f0f3e87,0x3f0ebf5e3f80bf6a,0xbf553efebd56bece,0xbf713f6abf623f59,0xbeab3ecebef03f08
.quad 0xbdc2be633f04bf42,0x3f7fbf7a3f5bbf27,0x3f7dbf27bb493f28,0xbe193f42bf803f41,0xbec53f7fbf03bf0a,0xbf6c3d903f5cbf58,0xbf4dbf0a3f613ed1,0x3f19bf58bef33f6a,0x3f46beb7bf80be8a,0x3f223f6fbd3cbf77,0x3ed93f773f553e00,0xbf68be8a3f0e3f7e,0xbf7bbf4abedc3cb0,0xbe45bf1dbf67bf80,0x3d56bcb0bdc2be2c,0x3f803f803f7f3f7c
.quad 0x3e45be00bedcbf31,0xbf7bbf7ebf67bf39,0xbd56bf31bf7fbf51,0xbf80bf39bdc23f14,0xbe96bf7cbf183ee8,0xbf75be2c3f4e3f64,0xbf04bf643ec53f73,0xbf5b3ee83f6cbea2,0xbf36bee53f7dbe32,0xbf343f653e13bf7c,0xbf5c3e323f22bf80,0xbf033f7cbf463ce2,0xbf753f3abeaebdf4,0xbe933f30bf713f7e,0xbf803f7ebf7b3f77,0xbd3c3df4be453e87
.quad 0xbf7b3f5ebf2b3ece,0x3e4bbefe3f3ebf6a,0xbf673ece3e96bf59,0x3edcbf6a3f75bf08,0xbf45be633f79bf27,0x3f23bf7a3e763f42,0xbf18bf423f343f28,0x3f4ebf27bf363f41,0xbec2bf7fbe7c3f58,0x3f6dbd90bf78bf0a,0xbe13bf58bf75bed1,0x3f7d3f0abe93bf6a,0x3dcfbeb7bf3dbf77,0x3f7f3f6f3f2d3e8a,0x3eae3e8a3e4b3e00,0x3f713f773f7b3f7e
.quad 0x3ecd3f2f3f643f7e,0x3f6b3f3a3ee93e04,0xbf4bbe353f083f76,0x3f1c3f7c3f593e8c,0xbf49bf653c973f69,0xbf1f3ee33f803ed2,0x3ed2bf64beff3f57,0xbf69bee93f5e3f0a,0x3f7cbe29bf603f41,0x3e35bf7c3efa3f28,0x3d8a3f32bf803f26,0x3f7fbf38bcfb3f43,0xbf743f7ebf573f08,0x3e9e3e04bf0a3f59,0xbf083efabee33ecd,0xbf593f60bf653f6b
.quad 0x3f32bed23da33e86,0xbf383f69bf7f3f77,0x3f5ebf7a3f153dee,0x3eff3e5abf503f7e,0xbe8cbf413f6bbcfb,0x3f76bf28becd3f80,0xbf803da33f7ebe35,0xbcfbbf7f3e043f7c,0xbe5a3f593f49bea4,0xbf7abf083f1f3f73,0x3f653f6e3eb5bee9,0xbee33ebb3f6f3f64,0x3f263e86be35bf15,0x3f433f773f7c3f50,0xbf15bf1fbf28bf32,0x3f503f493f413f38
.quad 0xbf52bf15be8c3d8a,0x3f123f503f763f7f,0x3f28bc97bf2fbf7f,0xbf41bf80bf3abda3,0xbee93f1c3f7a3e66,0x3f643f4bbe5abf79,0x3e66bf76bea43f6e,0xbf79be8c3f733ebb,0x3c973f6fbf26beff,0x3f80beb5bf433f5e,0xbe86bf0a3f7cbf49,0xbf773f57be29bf1f,0x3efabd8abebb3f3a,0x3f60bf7f3f6ebf2f,0xbf2f3f26bf1c3f12,0xbf3a3f43bf4b3f52
.quad 0x3f57bf793f7ebf65,0x3f0abe66bdee3ee3,0xbf733f6bbed2be9e,0xbea4becd3f69bf74,0x3f7fbeffbf123f7c,0x3da33f5ebf52be29,0xbf7cbdee3f7f3c97,0x3e29bf7ebd8a3f80,0x3f6b3f2fbee9bf7e,0xbecd3f3a3f64be04,0xbf4bbf7cbf083e8c,0x3f1cbe35bf59bf76,0x3f1f3f653f803f69,0xbf49bee3bc973ed2,0xbed2bee9beffbf0a,0x3f693f643f5e3f57
.quad 0xbf38bf69bf7fbf77,0xbf32bed2bda33e86,0xbeff3e5a3f503f7e,0x3f5e3f7a3f15bdee,0x3f763f28becdbf80,0x3e8cbf41bf6bbcfb,0x3cfbbf7fbe043f7c,0xbf80bda33f7e3e35,0xbf7a3f083f1fbf73,0x3e5a3f59bf49bea4,0x3ee33ebbbf6f3f64,0x3f65bf6e3eb53ee9,0x3f43bf773f7cbf50,0xbf263e863e35bf15,0xbf503f49bf413f38,0xbf153f1fbf283f32
.quad 0xbebb3cfb3e9ebf1c,0x3f6ebf803f74bf4b,0x3f7ebf523e663efa,0x3e043f12bf793f60,0xbdee3f73bf32beb5,0xbf7e3ea43f38bf6f,0xbf6fbe9e3f773e5a,0x3eb5bf74be863f7a,0x3f12bf15bf76bd8a,0x3f523f50be8cbf7f,0x3f283f803f2fbda3,0xbf41bc973f3a3f7f,0xbf64bf1cbe5a3e66,0xbee9bf4bbf7abf79,0xbe66be8cbea4bebb,0x3f793f763f733f6e
.quad 0x3f0a3e66bdeebee3,0xbf57bf79bf7ebf65,0x3ea4becdbf69bf74,0xbf73bf6bbed23e9e,0x3da3bf5ebf523e29,0xbf7fbeff3f123f7c,0xbe29bf7e3d8a3f80,0xbf7c3dee3f7fbc97,0xbecdbf3a3f643e04,0xbf6b3f2f3ee9bf7e,0xbf1cbe353f59bf76,0xbf4b3f7cbf08be8c,0xbf493ee3bc97bed2,0xbf1f3f65bf803f69,0xbf693f64bf5e3f57,0xbed23ee9beff3f0a
.quad 0xbf7c3f7cbf603f28,0xbe35be293efabf41,0xbf7f3f32bcfbbf26,0x3d8abf383f80bf43,0xbf743e043f57bf59,0x3e9ebf7e3f0a3f08,0xbf59befa3f653ecd,0x3f08bf60bee33f6b,0xbf32bf693da33f77,0x3f38bed2bf7fbe86,0xbeffbf7abf50bdee,0x3f5e3e5abf15bf7e,0xbe8cbf28bf6bbf80,0x3f763f413ecdbcfb,0xbcfbbda3be04be35,0x3f803f7f3f7e3f7c
.quad 0x3ea53f243f603f7e,0x3f723f443ef83e0d,0xbf57be703f003f76,0x3f0b3f793f5e3e90,0xbf3bbf6cbc7b3f68,0xbf2f3ec83f803ed7,0x3ef8bf5dbf073f56,0xbf60bf023f5a3f0c,0x3f77bddbbf643f3f,0x3e84bf7f3eea3f2a,0xbc7b3f3cbf7f3f24,0x3f80bf2ebd843f44,0xbf793f7cbf533f06,0x3e6a3e3fbf113f5a,0xbeea3edfbed43ec8,0xbf643f66bf693f6c
.quad 0x3f40beed3de83e81,0xbf293f63bf7e3f78,0x3f53bf7d3f1c3ddb,0x3f113e20bf4b3f7f,0xbeb4bf373f6ebd23,0x3f70bf33bebd3f80,0xbf7e3e0d3f7dbe3f,0xbde8bf7e3e263f7c,0xbe073f613f43bea8,0xbf7ebef63f253f72,0x3f6e3f683ea5beed,0xbebd3ed73f723f63,0x3f153e51be57bf17,0x3f503f7b3f7a3f4f,0xbf25bf2abf2fbf33,0x3f433f3f3f3b3f37
.quad 0xbf69bf33becbbd23,0x3ed43f373f6b3f80,0x3f483e0dbf15bf7c,0xbf1fbf7ebf50be3f,0xbf1c3ef63f7f3ea8,0x3f4b3f61bda9bf72,0x3ecbbf68bee23f63,0xbf6bbed73f663eed,0xbe263f7bbf0bbf17,0x3f7dbe51bf573f4f,0xbda9bf2a3f80bf37,0xbf7f3f3fbd0abf33,0x3ea53db6bef83f4c,0x3f72bf7f3f60bf1a,0xbf0b3f06bf003ef6,0xbf573f5abf5e3f61
.quad 0x3f3bbf6d3f80bf70,0x3f2fbec03c7b3eb1,0xbf603f78bf07be51,0xbef8be813f5abf7b,0x3f77bf21beea3f80,0x3e843f47bf64bd6f,0xbf803d233f7fbdb6,0xbc7bbf803d843f7f,0x3f793f10bf11bf79,0xbe6a3f543f53be70,0xbf64bf72bed43ec0,0x3eeabea8bf69bf6d,0x3f403f743f7e3f5d,0xbf29be993de83f02,0xbf11bf17bf1cbf21,0x3f533f4f3f4b3f47
.quad 0xbf00bf47bf74bf80,0xbf5ebf21be9c3d6f,0xbf38bd233f293f7f,0x3f323f803f403db6,0x3f5a3f54be38bf79,0x3f07bf10bf7cbe70,0x3e9cbf72beb43f6d,0xbf74bea83f703ec0,0xbf7f3e993f48bf5d,0xbd843f74bf1fbf02,0x3e383f17bf7e3f47,0x3f7cbf4f3e073f21,0x3f69bf803f6bbf2e,0xbed43c173ecbbf3c,0xbf1f3f1abf153f10,0xbf483f4cbf503f54
.quad 0xbf1c3e903da9bedf,0x3f4bbf763f7fbf66,0x3f6bbf703ee23e99,0x3ecb3eb1bf663f74,0x3e263f56bf57be20,0xbf7d3f0c3f0bbf7d,0xbf7fbd6f3f803c17,0x3da9bf80bd0a3f80,0x3ea5bf44bf603e0d,0x3f723f24bef8bf7e,0x3f573f793f00be90,0xbf0b3e703f5e3f76,0xbf3bbec83c7b3ed7,0xbf2fbf6cbf80bf68,0xbef8bf02bf07bf0c,0x3f603f5d3f5a3f56
.quad 0x3f503f0c3e57be20,0xbf15bf56bf7abf7d,0x3f25bd6fbf3bbf80,0xbf43bf80bf2f3c17,0x3ee2bf24bf76be0d,0xbf66bf443e8d3f7e,0x3e57bf79be843f76,0xbf7abe703f773e90,0xbd0abf6c3f323ed7,0xbf803ec83f38bf68,0xbe8dbf023f79bf56,0xbf763f5dbe6abf0c,0xbf003ddb3e9cbf2a,0xbf5e3f7fbf743f3f,0xbf323f2ebf293f24,0xbf383f3cbf403f44
.quad 0xbf5a3f7cbf7c3f5a,0xbf073e3f3e38bf06,0xbf743f66beb4bec8,0xbe9cbedf3f70bf6c,0xbf7f3eed3f1fbf78,0xbd84bf633f483e81,0xbf7cbe203f7e3ddb,0x3e38bf7dbe073f7f,0xbf69bf373ecb3f80,0x3ed4bf33bf6b3d23,0xbf48bf7ebf153e3f,0x3f1fbe0dbf50bf7c,0xbf1cbf61bf7fbf72,0x3f4b3ef63da9bea8,0xbecbbed7bee2beed,0x3f6b3f683f663f63
.quad 0x3f803f803f803f80,0,0x3e483f0e3f553f7b,0x3f7b3f553f0e3e48,0xbf6dbec43ec43f6d,0x3ec43f6d3f6d3ec4,0xbf0ebf7bbe483f55,0xbf553e483f7b3f0e,0x3f35bf35bf353f35,0xbf35bf353f353f35,0x3f553e48bf7b3f0e,0x3f0ebf7b3e483f55,0xbec43f6dbf6d3ec4,0x3f6dbec4bec43f6d,0xbf7b3f55bf0e3e48,0xbe483f0ebf553f7b
.quad 0,0xbf803f80bf803f80,0x3f7bbf553f0ebe48,0xbe483f0ebf553f7b,0x3ec4bf6d3f6dbec4,0x3f6dbec4bec43f6d,0xbf55be483f7bbf0e,0x3f0ebf7b3e483f55,0xbf353f353f35bf35,0xbf35bf353f353f35,0x3f0e3f7b3e48bf55,0xbf553e483f7b3f0e,0x3f6d3ec4bec4bf6d,0x3ec43f6d3f6d3ec4,0xbe48bf0ebf55bf7b,0x3f7b3f553f0e3e48
.quad 0x3f803f803f803f80,0,0xbf7bbf55bf0ebe48,0x3e483f0e3f553f7b,0x3f6d3ec4bec4bf6d,0xbec4bf6dbf6dbec4,0xbf553e483f7b3f0e,0x3f0e3f7b3e48bf55,0x3f35bf35bf353f35,0xbf35bf353f353f35,0xbf0e3f7bbe48bf55,0x3f553e48bf7b3f0e,0x3ec4bf6d3f6dbec4,0xbf6d3ec43ec4bf6d,0xbe483f0ebf553f7b,0x3f7bbf553f0ebe48
.quad 0,0xbf803f80bf803f80,0x3e48bf0e3f55bf7b,0x3f7bbf553f0ebe48,0xbec43f6dbf6d3ec4,0xbf6d3ec43ec4bf6d,0x3f0ebf7b3e483f55,0x3f553e48bf7b3f0e,0xbf353f353f35bf35,0xbf35bf353f353f35,0x3f55be48bf7bbf0e,0x3f0e3f7b3e48bf55,0xbf6dbec43ec43f6d,0xbec4bf6dbf6dbec4,0x3f7b3f553f0e3e48,0x3e483f0e3f553f7b
.quad 0x3f803f803f803f80,0,0xbe48bf0ebf55bf7b,0xbf7bbf55bf0ebe48,0xbf6dbec43ec43f6d,0x3ec43f6d3f6d3ec4,0x3f0e3f7b3e48bf55,0x3f55be48bf7bbf0e,0x3f35bf35bf353f35,0xbf35bf353f353f35,0xbf55be483f7bbf0e,0xbf0e3f7bbe48bf55,0xbec43f6dbf6d3ec4,0x3f6dbec4bec43f6d,0x3f7bbf553f0ebe48,0x3e48bf0e3f55bf7b
.quad 0,0xbf803f80bf803f80,0xbf7b3f55bf0e3e48,0x3e48bf0e3f55bf7b,0x3ec4bf6d3f6dbec4,0x3f6dbec4bec43f6d,0x3f553e48bf7b3f0e,0xbf0e3f7bbe48bf55,0xbf353f353f35bf35,0xbf35bf353f353f35,0xbf0ebf7bbe483f55,0x3f55be48bf7bbf0e,0x3f6d3ec4bec4bf6d,0x3ec43f6d3f6d3ec4,0x3e483f0e3f553f7b,0xbf7bbf55bf0ebe48
.quad 0x3f803f803f803f80,0,0x3f7b3f553f0e3e48,0xbe48bf0ebf55bf7b,0x3f6d3ec4bec4bf6d,0xbec4bf6dbf6dbec4,0x3f55be48bf7bbf0e,0xbf0ebf7bbe483f55,0x3f35bf35bf353f35,0xbf35bf353f353f35,0x3f0ebf7b3e483f55,0xbf55be483f7bbf0e,0x3ec4bf6d3f6dbec4,0xbf6d3ec43ec4bf6d,0x3e48bf0e3f55bf7b,0xbf7b3f55bf0e3e48
.quad 0,0xbf803f80bf803f80,0xbe483f0ebf553f7b,0xbf7b3f55bf0e3e48,0xbec43f6dbf6d3ec4,0xbf6d3ec43ec4bf6d,0xbf0e3f7bbe48bf55,0xbf55be483f7bbf0e,0xbf353f353f35bf35,0xbf35bf353f353f35,0xbf553e483f7b3f0e,0xbf0ebf7bbe483f55,0xbf6dbec43ec43f6d,0xbec4bf6dbf6dbec4,0xbf7bbf55bf0ebe48,0xbe48bf0ebf55bf7b
.quad 0x3f7f3f803f803f80,0x3db03d7b3d173c49,0x3de23f013f4f3f7a,0x3f7e3f5d3f163e54,0xbf74bee13eb23f6b,0x3e9b3f663f703eca,0xbef7bf7ebe6d3f53,0xbf603e0a3f793f11,0x3f44bf2abf3c3f33,0xbf25bf403f2e3f37,0x3f483e82bf7d3f0c,0x3f20bf783e233f57,0xbeec3f72bf693ebe,0x3f63bea7bed53f6e,0xbf763f4cbf063e3b,0xbe8f3f1bbf5a3f7c
.quad 0x3db0bd7b3d17bc49,0xbf7f3f80bf803f80,0x3f7ebf5d3f16be54,0xbde23f01bf4f3f7a,0x3e9bbf663f70beca,0x3f74bee1beb23f6b,0xbf60be0a3f79bf11,0x3ef7bf7e3e6d3f53,0xbf253f403f2ebf37,0xbf44bf2a3f3c3f33,0x3f203f783e23bf57,0xbf483e823f7d3f0c,0x3f633ea7bed5bf6e,0x3eec3f723f693ebe,0xbe8fbf1bbf5abf7c,0x3f763f4c3f063e3b
.quad 0x3f7c3f7d3f7e3f7e,0x3e3b3e233e0a3de2,0xbf80bf69bf2abe9b,0x3c493ed53f403f74,0x3f7a3f06be82bf60,0xbe54bf5abf78bef7,0xbf6b3d173f723f25,0x3eca3f803ea7bf44,0x3f53bf16bf4c3f20,0xbf11bf4f3f1b3f48,0xbf333f70bd7bbf63,0x3f373eb2bf803eec,0x3f0cbf793f5dbe8f,0xbf573e6d3f01bf76,0xbebe3f2ebf663f7f,0x3f6ebf3c3ee1bdb0
.quad 0x3e3bbe233e0abde2,0xbf7c3f7dbf7e3f7e,0x3c49bed53f40bf74,0x3f80bf693f2abe9b,0xbe543f5abf783ef7,0xbf7a3f063e82bf60,0x3ecabf803ea73f44,0x3f6b3d17bf723f25,0xbf113f4f3f1bbf48,0xbf53bf163f4c3f20,0x3f37beb2bf80beec,0x3f333f703d7bbf63,0xbf57be6d3f013f76,0xbf0cbf79bf5dbe8f,0x3f6e3f3c3ee13db0,0x3ebe3f2e3f663f7f
.quad 0x3f763f783f793f7a,0x3e8f3e823e6d3e54,0x3db0bea7bf2ebf6b,0xbf7fbf72bf3cbeca,0xbf7ebf1b3e233f53,0x3de23f4c3f7d3f11,0x3e9b3f803ed5bf33,0x3f743d7bbf69bf37,0x3f60bf01bf5a3f0c,0xbef7bf5d3f063f57,0xbf25bee13f80bebe,0xbf443f663d17bf6e,0xbf203f7ebf4f3e3b,0x3f48be0abf163f7c,0x3f63bf2a3eb23c49,0x3eecbf403f70bf80
.quad 0x3e8fbe823e6dbe54,0xbf763f78bf793f7a,0xbf7f3f72bf3c3eca,0xbdb0bea73f2ebf6b,0x3de2bf4c3f7dbf11,0x3f7ebf1bbe233f53,0x3f74bd7bbf693f37,0xbe9b3f80bed5bf33,0xbef73f5d3f06bf57,0xbf60bf013f5a3f0c,0xbf44bf663d173f6e,0x3f25bee1bf80bebe,0x3f483e0abf16bf7c,0x3f203f7e3f4f3e3b,0x3eec3f403f703f80,0xbf63bf2abeb23c49
.quad 0x3f6e3f703f723f74,0x3ebe3eb23ea73e9b,0x3f7c3f793f4c3ef7,0x3e3bbe6dbf1bbf60,0x3f803f2ebd7bbf44,0xbc49bf3cbf80bf25,0x3f7a3e23bf5dbf48,0xbe54bf7dbf013f20,0x3f6bbed5bf663eec,0xbecabf693ee13f63,0x3f53bf5abe0a3f76,0xbf11bf063f7ebe8f,0x3f33bf803f40bdb0,0xbf373d173f2abf7f,0x3f0cbf4f3f78bf7e,0xbf573f16be82bde2
.quad 0x3ebebeb23ea7be9b,0xbf6e3f70bf723f74,0x3e3b3e6dbf1b3f60,0xbf7c3f79bf4c3ef7,0xbc493f3cbf803f25,0xbf803f2e3d7bbf44,0xbe543f7dbf01bf20,0xbf7a3e233f5dbf48,0xbeca3f693ee1bf63,0xbf6bbed53f663eec,0xbf113f063f7e3e8f,0xbf53bf5a3e0a3f76,0xbf37bd173f2a3f7f,0xbf33bf80bf40bdb0,0xbf57bf16be823de2,0xbf0cbf4fbf78bf7e
.quad 0x3f7c3f7e3f7f3f80,0x3e2f3dfb3d973cc9,0x3cc93ee63f4a3f7a,0x3f803f653f1d3e60,0xbf7abefc3ea13f6a,0x3e603f5f3f733ecf,0xbecfbf7fbe893f51,0xbf6a3d973f773f13,0x3f51bf1dbf423f31,0xbf13bf4a3f273f39,0x3f393ea1bf7e3f09,0x3f31bf733dfb3f58,0xbf093f77bf653eb8,0x3f58be89bee63f6f,0xbf6f3f42befc3e2f,0xbeb83f27bf5f3f7c
.quad 0x3e2fbdfb3d97bcc9,0xbf7c3f7ebf7f3f80,0x3f80bf653f1dbe60,0xbcc93ee6bf4a3f7a,0x3e60bf5f3f73becf,0x3f7abefcbea13f6a,0xbf6abd973f77bf13,0x3ecfbf7f3e893f51,0xbf133f4a3f27bf39,0xbf51bf1d3f423f31,0x3f313f733dfbbf58,0xbf393ea13f7e3f09,0x3f583e89bee6bf6f,0x3f093f773f653eb8,0xbeb8bf27bf5fbf7c,0x3f6f3f423efc3e2f
.quad 0x3f6f3f733f773f7a,0x3eb83ea13e893e60,0xbf7cbf77bf42becf,0xbe2f3e893f273f6a,0x3f803f27bdfbbf51,0xbcc9bf42bf7ebf13,0xbf7abdfb3f653f39,0x3e603f7e3ee6bf31,0x3f6abee6bf5f3f09,0xbecfbf653efc3f58,0xbf513f5f3d97bf6f,0x3f133efcbf7f3eb8,0x3f31bf7f3f4abe2f,0xbf393d973f1dbf7c,0xbf093f4abf733f80,0x3f58bf1d3ea13cc9
.quad 0x3eb8bea13e89be60,0xbf6f3f73bf773f7a,0xbe2fbe893f27bf6a,0x3f7cbf773f42becf,0xbcc93f42bf7e3f13,0xbf803f273dfbbf51,0x3e60bf7e3ee63f31,0x3f7abdfbbf653f39,0xbecf3f653efcbf58,0xbf6abee63f5f3f09,0x3f13befcbf7fbeb8,0x3f513f5fbd97bf6f,0xbf39bd973f1d3f7c,0xbf31bf7fbf4abe2f,0x3f583f1d3ea1bcc9,0x3f093f4a3f733f80
.quad 0x3f583f5f3f653f6a,0x3f093efc3ee63ecf,0x3eb8bd97befcbf51,0xbf6fbf7fbf5fbf13,0xbf7cbf4abd973f31,0xbe2f3f1d3f7f3f39,0x3cc93f733f1dbf09,0x3f803ea1bf4abf58,0x3f7abe89bf733eb8,0xbe60bf773ea13f6f,0xbecfbf273f77be2f,0xbf6a3f423e89bf7c,0xbf513f7ebf27bcc9,0x3f133dfbbf423f80,0x3f39bee63dfb3e60,0x3f31bf653f7ebf7a
.quad 0x3f09befc3ee6becf,0xbf583f5fbf653f6a,0xbf6f3f7fbf5f3f13,0xbeb8bd973efcbf51,0xbe2fbf1d3f7fbf39,0x3f7cbf4a3d973f31,0x3f80bea1bf4a3f58,0xbcc93f73bf1dbf09,0xbe603f773ea1bf6f,0xbf7abe893f733eb8,0xbf6abf423e893f7c,0x3ecfbf27bf77be2f,0x3f13bdfbbf42bf80,0x3f513f7e3f27bcc9,0x3f313f653f7e3f7a,0xbf39bee6bdfb3e60
.quad 0x3f393f423f4a3f51,0x3f313f273f1d3f13,0x3f583f7e3f733f39,0x3f093dfbbea1bf31,0x3f6f3f653e89bf09,0x3eb8bee6bf77bf58,0x3f7c3efcbf27bf6f,0x3e2fbf5fbf423eb8,0x3f80bd97bf7e3e2f,0xbcc9bf7f3dfb3f7c,0x3f7abf1dbee63f80,0xbe60bf4a3f653cc9,0x3f6abf733efc3e60,0xbecfbea13f5fbf7a,0x3f51bf773f7fbf6a,0xbf133e893d97becf
.quad 0x3f31bf273f1dbf13,0xbf393f42bf4a3f51,0x3f09bdfbbea13f31,0xbf583f7ebf733f39,0x3eb83ee6bf773f58,0xbf6f3f65be89bf09,0x3e2f3f5fbf42beb8,0xbf7c3efc3f27bf6f,0xbcc93f7f3dfbbf7c,0xbf80bd973f7e3e2f,0xbe603f4a3f65bcc9,0xbf7abf1d3ee63f80,0xbecf3ea13f5f3f7a,0xbf6abf73befc3e60,0xbf13be893d973ecf,0xbf51bf77bf7fbf6a
.quad 0x3f783f7c3f7e3f80,0x3e823e3b3de23d17,0xbd7b3eca3f443f79,0x3f803f6b3f253e6d,0xbf7ebf0c3e8f3f69,0x3e0a3f573f763ed5,0xbea7bf80be9b3f4f,0xbf723c493f743f16,0x3f5dbf11bf483f2e,0xbf01bf533f203f3c,0x3f2a3ebebf7f3f06,0x3f40bf6e3db03f5a,0xbf1b3f7abf603eb2,0x3f4cbe54bef73f70,0xbf663f37beec3e23,0xbee13f33bf633f7d
.quad 0x3e82be3b3de2bd17,0xbf783f7cbf7e3f80,0x3f80bf6b3f25be6d,0x3d7b3ecabf443f79,0x3e0abf573f76bed5,0x3f7ebf0cbe8f3f69,0xbf72bc493f74bf16,0x3ea7bf803e9b3f4f,0xbf013f533f20bf3c,0xbf5dbf113f483f2e,0x3f403f6e3db0bf5a,0xbf2a3ebe3f7f3f06,0x3f4c3e54bef7bf70,0x3f1b3f7a3f603eb2,0xbee1bf33bf63bf7d,0x3f663f373eec3e23
.quad 0x3f5a3f633f6b3f72,0x3f063eec3eca3ea7,0xbf70bf7ebf57bf01,0xbeb23de23f0c3f5d,0x3f7d3f443c49bf40,0x3e23bf25bf80bf2a,0xbf80be8f3f533f4c,0x3d173f763f11bf1b,0x3f79be9bbf6e3ee1,0xbe6dbf743ebe3f66,0xbf693f483e54bf78,0x3ed53f20bf7a3e82,0x3f4fbf7f3f33bd7b,0xbf16bdb03f37bf80,0xbf2e3f60bf7c3f7e,0x3f3cbef73e3b3e0a
.quad 0x3f06beec3ecabea7,0xbf5a3f63bf6b3f72,0xbeb2bde23f0cbf5d,0x3f70bf7e3f57bf01,0x3e233f25bf803f2a,0xbf7d3f44bc49bf40,0x3d17bf763f113f1b,0x3f80be8fbf533f4c,0xbe6d3f743ebebf66,0xbf79be9b3f6e3ee1,0x3ed5bf20bf7abe82,0x3f693f48be54bf78,0xbf163db03f373f80,0xbf4fbf7fbf33bd7b,0x3f3c3ef73e3bbe0a,0x3f2e3f603f7c3f7e
.quad 0x3f2a3f373f443f4f,0x3f403f333f253f16,0x3f1b3e3bbe8fbf2e,0xbf4cbf7cbf76bf3c,0xbf66bf6bbe9b3f06,0xbee13eca3f743f5a,0xbe823f573f48beb2,0x3f783f0cbf20bf70,0x3f80bc49bf7f3e23,0x3d7bbf803db03f7d,0xbe0abf533f603d17,0xbf7e3f113ef7bf80,0xbf723f6ebeecbe6d,0x3ea73ebebf633f79,0x3f01be54bde23ed5,0x3f5dbf7a3f7ebf69
.quad 0x3f40bf333f25bf16,0xbf2a3f37bf443f4f,0xbf4c3f7cbf763f3c,0xbf1b3e3b3e8fbf2e,0xbee1beca3f74bf5a,0x3f66bf6b3e9b3f06,0x3f78bf0cbf203f70,0x3e823f57bf48beb2,0x3d7b3f803db0bf7d,0xbf80bc493f7f3e23,0xbf7ebf113ef73f80,0x3e0abf53bf603d17,0x3ea7bebebf63bf79,0x3f723f6e3eecbe6d,0x3f5d3f7a3f7e3f69,0xbf01be543de23ed5
.quad 0x3ed53ef73f0c3f1b,0x3f693f603f573f4c,0x3f163f633f803f66,0x3f4f3eec3c49bee1,0x3f3c3f7e3f11be82,0x3f2ebde2bf53bf78,0x3f5a3f44bebebf80,0x3f06bf25bf6e3d7b,0x3f703e8fbf7abe0a,0x3eb2bf76be543f7e,0x3f7dbe9bbf373f72,0x3e23bf743f333ea7,0x3f80bf483e3b3f01,0xbd17bf203f7cbf5d,0x3f79bf7f3f6bbf40,0xbe6dbdb03ecabf2a
.quad 0x3f69bf603f57bf4c,0xbed53ef7bf0c3f1b,0x3f4fbeec3c493ee1,0xbf163f63bf803f66,0x3f2e3de2bf533f78,0xbf3c3f7ebf11be82,0x3f063f25bf6ebd7b,0xbf5a3f443ebebf80,0x3eb23f76be54bf7e,0xbf703e8f3f7abe0a,0x3e233f743f33bea7,0xbf7dbe9b3f373f72,0xbd173f203f7c3f5d,0xbf80bf48be3b3f01,0xbe6d3db03eca3f2a,0xbf79bf7fbf6bbf40
.quad 0x3f713f783f7d3f80,0x3eac3e793e163d49,0xbe163eac3f3e3f78,0x3f7d3f713f2c3e79,0xbf80bf183e793f67,0x3d493f4e3f783edb,0xbe79bf80beac3f4e,0xbf78bd493f713f18,0x3f67bf04bf4e3f2c,0xbedbbf5c3f183f3e,0x3f183edbbf803f04,0x3f4ebf673d493f5c,0xbf2c3f7dbf5c3eac,0x3f3ebe16bf043f71,0xbf5c3f2cbedb3e16,0xbf043f3ebf673f7d
.quad 0x3eacbe793e16bd49,0xbf713f78bf7d3f80,0x3f7dbf713f2cbe79,0x3e163eacbf3e3f78,0x3d49bf4e3f78bedb,0x3f80bf18be793f67,0xbf783d493f71bf18,0x3e79bf803eac3f4e,0xbedb3f5c3f18bf3e,0xbf67bf043f4e3f2c,0x3f4e3f673d49bf5c,0xbf183edb3f803f04,0x3f3e3e16bf04bf71,0x3f2c3f7d3f5c3eac,0xbf04bf3ebf67bf7d,0x3f5c3f2c3edb3e16
.quad 0x3f3e3f4e3f5c3f67,0x3f2c3f183f043edb,0xbf5cbf80bf67bf18,0xbf04bd493edb3f4e,0x3f713f5c3e16bf2c,0x3eacbf04bf7dbf3e,0xbf7dbedb3f3e3f5c,0xbe163f673f2cbf04,0x3f80be16bf783eac,0xbd49bf7d3e793f71,0xbf783f2c3eacbf7d,0x3e793f3ebf713e16,0x3f67bf783f183d49,0xbedbbe793f4ebf80,0xbf4e3f71bf803f78,0x3f18beac3d493e79
.quad 0x3f2cbf183f04bedb,0xbf3e3f4ebf5c3f67,0xbf043d493edbbf4e,0x3f5cbf803f67bf18,0x3eac3f04bf7d3f3e,0xbf713f5cbe16bf2c,0xbe16bf673f2c3f04,0x3f7dbedbbf3e3f5c,0xbd493f7d3e79bf71,0xbf80be163f783eac,0x3e79bf3ebf71be16,0x3f783f2cbeacbf7d,0xbedb3e793f4e3f80,0xbf67bf78bf183d49,0x3f183eac3d49be79,0x3f4e3f713f803f78
.quad 0x3edb3f043f183f2c,0x3f673f5c3f4e3f3e,0x3f4e3edbbd49bf04,0xbf18bf67bf80bf5c,0xbf3ebf7dbf043eac,0xbf2c3e163f5c3f71,0xbf043f2c3f67be16,0x3f5c3f3ebedbbf7d,0x3f713e79bf7dbd49,0x3eacbf78be163f80,0x3e16bf713f3e3e79,0xbf7d3eac3f2cbf78,0xbf803f4ebe79bedb,0x3d493f18bf783f67,0x3e793d49beac3f18,0x3f78bf803f71bf4e
.quad 0x3f67bf5c3f4ebf3e,0xbedb3f04bf183f2c,0xbf183f67bf803f5c,0xbf4e3edb3d49bf04,0xbf2cbe163f5cbf71,0x3f3ebf7d3f043eac,0x3f5cbf3ebedb3f7d,0x3f043f2cbf67be16,0x3eac3f78be16bf80,0xbf713e793f7dbd49,0xbf7dbeac3f2c3f78,0xbe16bf71bf3e3e79,0x3d49bf18bf78bf67,0x3f803f4e3e79bedb,0x3f783f803f713f4e,0xbe793d493eac3f18
.quad 0x3d493e163e793eac,0x3f803f7d3f783f71,0x3e793f2c3f713f7d,0x3f783f3e3eacbe16,0x3edb3f783f4e3d49,0x3f673e79bf18bf80,0x3f183f71bd49bf78,0x3f4ebeacbf80be79,0x3f3e3f18bf5cbedb,0x3f2cbf4ebf043f67,0x3f5c3d49bf673f4e,0x3f04bf803edb3f18,0x3f71bf04be163f3e,0x3eacbf5c3f7dbf2c,0x3f7dbf673f3ebf04,0x3e16bedb3f2cbf5c
.quad 0x3f80bf7d3f78bf71,0xbd493e16be793eac,0x3f78bf3e3eac3e16,0xbe793f2cbf713f7d,0x3f67be79bf183f80,0xbedb3f78bf4e3d49,0x3f4e3eacbf803e79,0xbf183f713d49bf78,0x3f2c3f4ebf04bf67,0xbf3e3f183f5cbedb,0x3f043f803edbbf18,0xbf5c3d493f673f4e,0x3eac3f5c3f7d3f2c,0xbf71bf043e163f3e,0x3e163edb3f2c3f5c,0xbf7dbf67bf3ebf04
.quad 0x3f693f743f7c3f80,0x3ed53e9b3e3b3d7b,0xbe6d3e8f3f373f78,0x3f793f763f333e82,0xbf80bf253e543f66,0xbd173f443f7a3ee1,0xbe23bf7ebebe3f4c,0xbf7dbde23f6e3f1b,0x3f70beecbf533f2a,0xbeb2bf633f113f40,0x3f063ef7bf803f01,0x3f5abf603c493f5d,0xbf3c3f7fbf573ea7,0x3f2ebdb0bf0c3f72,0xbf4f3f20beca3e0a,0xbf163f48bf6b3f7e
.quad 0x3ed5be9b3e3bbd7b,0xbf693f74bf7c3f80,0x3f79bf763f33be82,0x3e6d3e8fbf373f78,0xbd17bf443f7abee1,0x3f80bf25be543f66,0xbf7d3de23f6ebf1b,0x3e23bf7e3ebe3f4c,0xbeb23f633f11bf40,0xbf70beec3f533f2a,0x3f5a3f603c49bf5d,0xbf063ef73f803f01,0x3f2e3db0bf0cbf72,0x3f3c3f7f3f573ea7,0xbf16bf48bf6bbf7e,0x3f4f3f203eca3e0a
.quad 0x3f1b3f333f483f5a,0x3f4c3f373f203f06,0xbf40bf7abf74bf2e,0xbf2abe543e9b3f3c,0x3f5d3f6e3e8fbf16,0x3f01bebebf76bf4f,0xbf72bf113f253f69,0xbea73f533f44bed5,0x3f7e3c49bf7e3e6d,0x3e0abf803de23f79,0xbf803f0c3eecbf80,0x3d7b3f57bf633d17,0x3f78bf6b3ef73e23,0xbe82beca3f60bf7d,0xbf663f7cbf7f3f70,0x3ee1be3bbdb03eb2
.quad 0x3f4cbf373f20bf06,0xbf1b3f33bf483f5a,0xbf2a3e543e9bbf3c,0x3f40bf7a3f74bf2e,0x3f013ebebf763f4f,0xbf5d3f6ebe8fbf16,0xbea7bf533f443ed5,0x3f72bf11bf253f69,0x3e0a3f803de2bf79,0xbf7e3c493f7e3e6d,0x3d7bbf57bf63bd17,0x3f803f0cbeecbf80,0xbe823eca3f603f7d,0xbf78bf6bbef73e23,0x3ee13e3bbdb0beb2,0x3f663f7c3f7f3f70
.quad 0x3e233e8f3eca3f01,0x3f7d3f763f6b3f5d,0x3f703f253e3bbea7,0xbeb2bf44bf7cbf72,0xbf06bf7ebf333e0a,0xbf5abde23f373f7e,0xbf3c3eec3f7a3d7b,0x3f2e3f63be54bf80,0x3f4f3ef7bf6ebe82,0x3f16bf60bebe3f78,0x3ed5bf7f3f113ee1,0xbf693db03f53bf66,0xbf793f20bc49bf1b,0xbe6d3f48bf803f4c,0xbd173e9bbf0c3f40,0x3f80bf743f57bf2a
.quad 0x3f7dbf763f6bbf5d,0xbe233e8fbeca3f01,0xbeb23f44bf7c3f72,0xbf703f25be3bbea7,0xbf5a3de23f37bf7e,0x3f06bf7e3f333e0a,0x3f2ebf63be543f80,0x3f3c3eecbf7a3d7b,0x3f163f60bebebf78,0xbf4f3ef73f6ebe82,0xbf69bdb03f533f66,0xbed5bf7fbf113ee1,0xbe6dbf48bf80bf4c,0x3f793f203c49bf1b,0x3f803f743f573f2a,0x3d173e9b3f0c3f40
.quad 0xbea7be54bdb03d17,0x3f723f7a3f7f3f80,0xbe0a3ebe3f483f7d,0x3f7e3f6e3f203e23,0x3d7b3f533f743eb2,0x3f803f11be9bbf70,0x3e823f803e8fbf5a,0x3f783c49bf76bf06,0x3ee13f57bf25bf2e,0x3f66bf0cbf443f3c,0x3f1b3ecabf7e3f16,0x3f4cbf6b3de23f4f,0x3f40be3bbeec3f69,0x3f2abf7c3f63bed5,0x3f5dbf333ef7be6d,0x3f01bf373f60bf79
.quad 0x3f72bf7a3f7fbf80,0x3ea7be543db03d17,0x3f7ebf6e3f20be23,0x3e0a3ebebf483f7d,0x3f80bf11be9b3f70,0xbd7b3f53bf743eb2,0x3f78bc49bf763f06,0xbe823f80be8fbf5a,0x3f663f0cbf44bf3c,0xbee13f573f25bf2e,0x3f4c3f6b3de2bf4f,0xbf1b3eca3f7e3f16,0x3f2a3f7c3f633ed5,0xbf40be3b3eec3f69,0x3f013f373f603f79,0xbf5dbf33bef7be6d
.quad 0x3f5f3f6f3f7a3f7f,0x3efc3eb83e603d97,0xbea13e603f313f77,0x3f733f7a3f393e89,0xbf7ebf313e2f3f65,0xbdfb3f393f7c3ee6,0xbd97bf7cbecf3f4a,0xbf7fbe2f3f6a3f1d,0x3f77becfbf583f27,0xbe89bf6a3f093f42,0x3ee63f09bf803efc,0x3f65bf58bcc93f5f,0xbf4a3f80bf513ea1,0x3f1dbcc9bf133f73,0xbf423f13beb83dfb,0xbf273f51bf6f3f7e
.quad 0x3efcbeb83e60bd97,0xbf5f3f6fbf7a3f7f,0x3f73bf7a3f39be89,0x3ea13e60bf313f77,0xbdfbbf393f7cbee6,0x3f7ebf31be2f3f65,0xbf7f3e2f3f6abf1d,0x3d97bf7c3ecf3f4a,0xbe893f6a3f09bf42,0xbf77becf3f583f27,0x3f653f58bcc9bf5f,0xbee63f093f803efc,0x3f1d3cc9bf13bf73,0x3f4a3f803f513ea1,0xbf27bf51bf6fbf7e,0x3f423f133eb83dfb
.quad 0x3ee63f133f313f4a,0x3f653f513f393f1d,0xbf1dbf6fbf7cbf42,0xbf4abeb83e2f3f27,0x3f423f7a3ecfbefc,0x3f27be60bf6abf5f,0xbf5fbf313f093f73,0xbefc3f393f58bea1,0x3f733e2fbf803dfb,0x3ea1bf7cbcc93f7e,0xbf7e3ecf3f13bf7f,0xbdfb3f6abf51bd97,0x3f7fbf583eb83e89,0xbd97bf093f6fbf77,0xbf773f80bf7a3f65,0x3e89bcc9be603ee6
.quad 0x3f65bf513f39bf1d,0xbee63f13bf313f4a,0xbf4a3eb83e2fbf27,0x3f1dbf6f3f7cbf42,0x3f273e60bf6a3f5f,0xbf423f7abecfbefc,0xbefcbf393f583ea1,0x3f5fbf31bf093f73,0x3ea13f7cbcc9bf7e,0xbf733e2f3f803dfb,0xbdfbbf6abf513d97,0x3f7e3ecfbf13bf7f,0xbd973f093f6f3f77,0xbf7fbf58beb83e89,0x3e893cc9be60bee6,0x3f773f803f7a3f65
.quad 0xbdfb3cc93e2f3ea1,0x3f7e3f803f7c3f73,0x3f7f3f513ecfbdfb,0xbd97bf13bf6abf7e,0xbe89bf6fbf58bd97,0xbf77beb83f093f7f,0xbf653e603f803e89,0x3ee63f7a3cc9bf77,0x3f1d3f31bf51bee6,0x3f4abf39bf133f65,0x3f27bf7c3eb83f1d,0xbf42be2f3f6fbf4a,0xbf5f3ecf3e60bf42,0xbefc3f6abf7a3f27,0xbea13f09bf393f5f,0x3f73bf583f31befc
.quad 0x3f7ebf803f7cbf73,0x3dfb3cc9be2f3ea1,0xbd973f13bf6a3f7e,0xbf7f3f51becfbdfb,0xbf773eb83f09bf7f,0x3e89bf6f3f58bd97,0x3ee6bf7a3cc93f77,0x3f653e60bf803e89,0x3f4a3f39bf13bf65,0xbf1d3f313f51bee6,0xbf423e2f3f6f3f4a,0xbf27bf7cbeb83f1d,0xbefcbf6abf7abf27,0x3f5f3ecfbe60bf42,0x3f733f583f313efc,0x3ea13f093f393f5f
.quad 0xbf27bf09becfbe89,0x3f423f583f6a3f77,0xbefc3cc93f093f65,0x3f5f3f803f583ee6,0xbea13f133f803f1d,0x3f733f513cc9bf4a,0xbdfb3f6f3f13bf27,0x3f7e3eb8bf51bf42,0x3d973f7abeb8bf5f,0x3f7fbe60bf6f3efc,0x3e893f31bf7a3ea1,0x3f77bf39be603f73,0x3ee63e2fbf393f7e,0x3f65bf7c3f31bdfb,0x3f1dbecf3e2f3d97,0x3f4abf6a3f7cbf7f
.quad 0x3f42bf583f6abf77,0x3f27bf093ecfbe89,0x3f5fbf803f58bee6,0x3efc3cc9bf093f65,0x3f73bf513cc93f4a,0x3ea13f13bf803f1d,0x3f7ebeb8bf513f42,0x3dfb3f6fbf13bf27,0x3f7f3e60bf6fbefc,0xbd973f7a3eb8bf5f,0x3f773f39be60bf73,0xbe893f313f7a3ea1,0x3f653f7c3f313dfb,0xbee63e2f3f393f7e,0x3f4a3f6a3f7c3f7f,0xbf1dbecfbe2f3d97
.quad 0x3f533f693f783f7f,0x3f113ed53e823db0,0xbeca3e233f2a3f76,0x3f6b3f7d3f403e8f,0xbf7abf3c3e0a3f63,0xbe543f2e3f7e3eec,0x3c49bf79bee13f48,0xbf80be6d3f663f20,0x3f7cbeb2bf5d3f25,0xbe3bbf703f013f44,0x3ebe3f16bf803ef7,0x3f6ebf4fbd7b3f60,0xbf573f80bf4c3e9b,0x3f0c3d17bf1b3f74,0xbf333f06bea73de2,0xbf373f5abf723f7e
.quad 0x3f11bed53e82bdb0,0xbf533f69bf783f7f,0x3f6bbf7d3f40be8f,0x3eca3e23bf2a3f76,0xbe54bf2e3f7ebeec,0x3f7abf3cbe0a3f63,0xbf803e6d3f66bf20,0xbc49bf793ee13f48,0xbe3b3f703f01bf44,0xbf7cbeb23f5d3f25,0x3f6e3f4fbd7bbf60,0xbebe3f163f803ef7,0x3f0cbd17bf1bbf74,0x3f573f803f4c3e9b,0xbf37bf5abf72bf7e,0x3f333f063ea73de2
.quad 0x3e8f3ee13f163f37,0x3f763f663f4f3f33,0xbeecbf5dbf80bf53,0xbf63bf013d173f11,0x3f203f803f06beca,0x3f48bd7bbf5abf6b,0xbf44bf4c3ed53f7a,0xbf253f1b3f69be54,0x3f603ea7bf7d3c49,0x3ef7bf72be233f80,0xbf743e823f2ebf7c,0xbe9b3f78bf3cbe3b,0x3f7ebf403e6d3ebe,0x3de2bf2a3f79bf6e,0xbf7f3f7ebf703f57,0x3db03e0abeb23f0c
.quad 0x3f76bf663f4fbf33,0xbe8f3ee1bf163f37,0xbf633f013d17bf11,0x3eecbf5d3f80bf53,0x3f483d7bbf5a3f6b,0xbf203f80bf06beca,0xbf25bf1b3f693e54,0x3f44bf4cbed53f7a,0x3ef73f72be23bf80,0xbf603ea73f7d3c49,0xbe9bbf78bf3c3e3b,0x3f743e82bf2ebf7c,0x3de23f2a3f793f6e,0xbf7ebf40be6d3ebe,0x3db0be0abeb2bf0c,0x3f7f3f7e3f703f57
.quad 0xbecabe6dbd7b3de2,0x3f6b3f793f803f7e,0x3f7a3f703f1b3db0,0x3e54beb2bf4cbf7f,0x3c49bf4fbf72be8f,0xbf80bf163ea73f76,0xbf7cbd173f783eec,0x3e3b3f803e82bf63,0x3ebe3f5abf2abf20,0x3f6ebf06bf403f48,0x3f57bf693e0a3f44,0xbf0cbed53f7ebf25,0xbf333e233ee1bf60,0xbf373f7dbf663ef7,0xbf113f3cbf5d3f74,0x3f53bf2e3f01be9b
.quad 0x3f6bbf793f80bf7e,0x3ecabe6d3d7b3de2,0x3e543eb2bf4c3f7f,0xbf7a3f70bf1b3db0,0xbf803f163ea7bf76,0xbc49bf4f3f72be8f,0x3e3bbf803e823f63,0x3f7cbd17bf783eec,0x3f6e3f06bf40bf48,0xbebe3f5a3f2abf20,0xbf0c3ed53f7e3f25,0xbf57bf69be0a3f44,0xbf37bf7dbf66bef7,0x3f333e23bee1bf60,0x3f533f2e3f013e9b,0x3f113f3c3f5d3f74
.quad 0xbf63bf4cbf2ebf0c,0x3eec3f1b3f3c3f57,0xbf48bea73e6d3f37,0x3f203f723f793f33,0xbf253e823f703f53,0x3f443f783eb2bf11,0xbef73f403f4fbeca,0x3f603f2abf16bf6b,0xbe9b3f7ebd17bf7a,0x3f743e0abf803e54,0xbde23f66bf5a3c49,0x3f7ebee1bf063f80,0x3db03f01bf693f7c,0x3f7fbf5d3ed53e3b,0x3e8fbd7bbe233ebe,0x3f76bf803f7dbf6e
.quad 0x3eecbf1b3f3cbf57,0x3f63bf4c3f2ebf0c,0x3f20bf723f79bf33,0x3f48bea7be6d3f37,0x3f44bf783eb23f11,0x3f253e82bf703f53,0x3f60bf2abf163f6b,0x3ef73f40bf4fbeca,0x3f74be0abf80be54,0x3e9b3f7e3d17bf7a,0x3f7e3ee1bf06bf80,0x3de23f663f5a3c49,0x3f7f3f5d3ed5be3b,0xbdb03f013f693f7c,0x3f763f803f7d3f6e,0xbe8fbd7b3e233ebe
.quad 0x3f463f623f753f7f,0x3f223ef13e953dc9,0xbef13dc93f223f75,0x3f623f7f3f463e95,0xbf75bf463dc93f62,0xbe953f223f7f3ef1,0x3dc9bf75bef13f46,0xbf7fbe953f623f22,0x3f7fbe95bf623f22,0xbdc9bf753ef13f46,0x3e953f22bf7f3ef1,0x3f75bf46bdc93f62,0xbf623f7fbf463e95,0x3ef13dc9bf223f75,0xbf223ef1be953dc9,0xbf463f62bf753f7f
.quad 0x3f22bef13e95bdc9,0xbf463f62bf753f7f,0x3f62bf7f3f46be95,0x3ef13dc9bf223f75,0xbe95bf223f7fbef1,0x3f75bf46bdc93f62,0xbf7f3e953f62bf22,0xbdc9bf753ef13f46,0xbdc93f753ef1bf46,0xbf7fbe953f623f22,0x3f753f46bdc9bf62,0xbe953f223f7f3ef1,0x3ef1bdc9bf22bf75,0x3f623f7f3f463e95,0xbf46bf62bf75bf7f,0x3f223ef13e953dc9
.quad 0x3dc93e953ef13f22,0x3f7f3f753f623f46,0xbe95bf46bf7fbf62,0xbf75bf22bdc93ef1,0x3ef13f7f3f22be95,0x3f623dc9bf46bf75,0xbf22bf623e953f7f,0xbf463ef13f75bdc9,0x3f463ef1bf75bdc9,0x3f22bf62be953f7f,0xbf623dc93f46bf75,0xbef13f7fbf22be95,0x3f75bf223dc93ef1,0x3e95bf463f7fbf62,0xbf7f3f75bf623f46,0xbdc93e95bef13f22
.quad 0x3f7fbf753f62bf46,0xbdc93e95bef13f22,0xbf753f22bdc9bef1,0x3e95bf463f7fbf62,0x3f62bdc9bf463f75,0xbef13f7fbf22be95,0xbf46bef13f753dc9,0x3f22bf62be953f7f,0x3f223f62be95bf7f,0xbf463ef13f75bdc9,0xbef1bf7fbf223e95,0x3f623dc9bf46bf75,0x3e953f463f7f3f62,0xbf75bf22bdc93ef1,0xbdc9be95bef1bf22,0x3f7f3f753f623f46
.quad 0xbf22bef1be95bdc9,0x3f463f623f753f7f,0x3f623f7f3f463e95,0x3ef1bdc9bf22bf75,0x3e95bf22bf7fbef1,0xbf75bf463dc93f62,0xbf7fbe953f623f22,0xbdc93f753ef1bf46,0x3dc93f75bef1bf46,0x3f7fbe95bf623f22,0x3f75bf46bdc93f62,0xbe95bf223f7fbef1,0xbef1bdc93f22bf75,0xbf623f7fbf463e95,0xbf463f62bf753f7f,0x3f22bef13e95bdc9
.quad 0x3f46bf623f75bf7f,0x3f22bef13e95bdc9,0x3ef13dc9bf223f75,0xbf623f7fbf463e95,0xbf753f463dc9bf62,0xbe95bf223f7fbef1,0xbdc9bf753ef13f46,0x3f7fbe95bf623f22,0x3f7f3e95bf62bf22,0xbdc93f753ef1bf46,0xbe953f223f7f3ef1,0xbf75bf463dc93f62,0xbf62bf7fbf46be95,0x3ef1bdc9bf22bf75,0x3f223ef13e953dc9,0x3f463f623f753f7f
.quad 0xbf7fbf75bf62bf46,0x3dc93e953ef13f22,0xbf75bf22bdc93ef1,0x3e953f463f7f3f62,0xbf62bdc93f463f75,0x3ef13f7f3f22be95,0xbf463ef13f75bdc9,0x3f223f62be95bf7f,0xbf223f623e95bf7f,0x3f463ef1bf75bdc9,0xbef13f7fbf22be95,0x3f62bdc9bf463f75,0xbe953f46bf7f3f62,0x3f75bf223dc93ef1,0xbdc93e95bef13f22,0x3f7fbf753f62bf46
.quad 0x3dc9be953ef1bf22,0x3f7fbf753f62bf46,0x3e95bf463f7fbf62,0x3f75bf223dc93ef1,0x3ef1bf7f3f223e95,0x3f62bdc9bf463f75,0x3f22bf62be953f7f,0x3f463ef1bf75bdc9,0x3f46bef1bf753dc9,0x3f223f62be95bf7f,0x3f623dc9bf46bf75,0x3ef13f7f3f22be95,0x3f753f223dc9bef1,0x3e953f463f7f3f62,0x3f7f3f753f623f46,0x3dc93e953ef13f22
.quad 0x3f373f5a3f723f7e,0x3f333f063ea73de2,0xbf0c3d173f1b3f74,0x3f573f803f4c3e9b,0xbf6ebf4f3d7b3f60,0xbebe3f163f803ef7,0x3e3bbf70bf013f44,0xbf7cbeb23f5d3f25,0x3f80be6dbf663f20,0xbc49bf793ee13f48,0x3e543f2ebf7e3eec,0x3f7abf3cbe0a3f63,0xbf6b3f7dbf403e8f,0x3eca3e23bf2a3f76,0xbf113ed5be823db0,0xbf533f69bf783f7f
.quad 0x3f33bf063ea7bde2,0xbf373f5abf723f7e,0x3f57bf803f4cbe9b,0x3f0c3d17bf1b3f74,0xbebebf163f80bef7,0x3f6ebf4fbd7b3f60,0xbf7c3eb23f5dbf25,0xbe3bbf703f013f44,0xbc493f793ee1bf48,0xbf80be6d3f663f20,0x3f7a3f3cbe0abf63,0xbe543f2e3f7e3eec,0x3ecabe23bf2abf76,0x3f6b3f7d3f403e8f,0xbf53bf69bf78bf7f,0x3f113ed53e823db0
.quad 0xbdb03e0a3eb23f0c,0x3f7f3f7e3f703f57,0xbde2bf2abf79bf6e,0xbf7ebf40be6d3ebe,0x3e9b3f783f3cbe3b,0x3f743e82bf2ebf7c,0xbef7bf723e233f80,0xbf603ea73f7d3c49,0x3f253f1bbf69be54,0x3f44bf4cbed53f7a,0xbf48bd7b3f5abf6b,0xbf203f80bf06beca,0x3f63bf01bd173f11,0x3eecbf5d3f80bf53,0xbf763f66bf4f3f33,0xbe8f3ee1bf163f37
.quad 0x3f7fbf7e3f70bf57,0x3db03e0abeb23f0c,0xbf7e3f40be6dbebe,0x3de2bf2a3f79bf6e,0x3f74be82bf2e3f7c,0xbe9b3f78bf3cbe3b,0xbf60bea73f7dbc49,0x3ef7bf72be233f80,0x3f443f4cbed5bf7a,0xbf253f1b3f69be54,0xbf20bf80bf063eca,0x3f48bd7bbf5abf6b,0x3eec3f5d3f803f53,0xbf63bf013d173f11,0xbe8fbee1bf16bf37,0x3f763f663f4f3f33
.quad 0xbf53bf2ebf01be9b,0x3f113f3c3f5d3f74,0x3f373f7d3f663ef7,0x3f333e23bee1bf60,0x3f0cbed5bf7ebf25,0xbf57bf69be0a3f44,0xbf6ebf063f403f48,0xbebe3f5a3f2abf20,0xbe3b3f80be82bf63,0x3f7cbd17bf783eec,0x3f80bf16bea73f76,0xbc49bf4f3f72be8f,0xbe54beb23f4cbf7f,0xbf7a3f70bf1b3db0,0xbf6b3f79bf803f7e,0x3ecabe6d3d7b3de2
.quad 0x3f11bf3c3f5dbf74,0x3f53bf2e3f01be9b,0x3f33be23bee13f60,0xbf373f7dbf663ef7,0xbf573f69be0abf44,0xbf0cbed53f7ebf25,0xbebebf5a3f2a3f20,0x3f6ebf06bf403f48,0x3f7c3d17bf78beec,0x3e3b3f803e82bf63,0xbc493f4f3f723e8f,0xbf80bf163ea73f76,0xbf7abf70bf1bbdb0,0x3e54beb2bf4cbf7f,0x3eca3e6d3d7bbde2,0x3f6b3f793f803f7e
.quad 0xbf76bf80bf7dbf6e,0xbe8fbd7b3e233ebe,0xbf7fbf5dbed53e3b,0xbdb03f013f693f7c,0xbf7ebee13f063f80,0x3de23f663f5a3c49,0xbf743e0a3f803e54,0x3e9b3f7e3d17bf7a,0xbf603f2a3f16bf6b,0x3ef73f40bf4fbeca,0xbf443f78beb2bf11,0x3f253e82bf703f53,0xbf203f72bf793f33,0x3f48bea7be6d3f37,0xbeec3f1bbf3c3f57,0x3f63bf4c3f2ebf0c
.quad 0xbe8f3d7b3e23bebe,0x3f76bf803f7dbf6e,0xbdb0bf013f69bf7c,0x3f7fbf5d3ed53e3b,0x3de2bf663f5abc49,0x3f7ebee1bf063f80,0x3e9bbf7e3d173f7a,0x3f743e0abf803e54,0x3ef7bf40bf4f3eca,0x3f603f2abf16bf6b,0x3f25be82bf70bf53,0x3f443f783eb2bf11,0x3f483ea7be6dbf37,0x3f203f723f793f33,0x3f633f4c3f2e3f0c,0x3eec3f1b3f3c3f57
.quad 0x3f273f513f6f3f7e,0x3f423f133eb83dfb,0xbf1dbcc93f133f73,0x3f4a3f803f513ea1,0xbf65bf583cc93f5f,0xbee63f093f803efc,0x3e89bf6abf093f42,0xbf77becf3f583f27,0x3f7fbe2fbf6a3f1d,0x3d97bf7c3ecf3f4a,0x3dfb3f39bf7c3ee6,0x3f7ebf31be2f3f65,0xbf733f7abf393e89,0x3ea13e60bf313f77,0xbefc3eb8be603d97,0xbf5f3f6fbf7a3f7f
.quad 0x3f42bf133eb8bdfb,0xbf273f51bf6f3f7e,0x3f4abf803f51bea1,0x3f1dbcc9bf133f73,0xbee6bf093f80befc,0x3f65bf58bcc93f5f,0xbf773ecf3f58bf27,0xbe89bf6a3f093f42,0x3d973f7c3ecfbf4a,0xbf7fbe2f3f6a3f1d,0x3f7e3f31be2fbf65,0xbdfb3f393f7c3ee6,0x3ea1be60bf31bf77,0x3f733f7a3f393e89,0xbf5fbf6fbf7abf7f,0x3efc3eb83e603d97
.quad 0xbe89bcc93e603ee6,0x3f773f803f7a3f65,0x3d97bf09bf6fbf77,0xbf7fbf58beb83e89,0x3dfb3f6a3f51bd97,0x3f7e3ecfbf13bf7f,0xbea1bf7c3cc93f7e,0xbf733e2f3f803dfb,0x3efc3f39bf58bea1,0x3f5fbf31bf093f73,0xbf27be603f6abf5f,0xbf423f7abecfbefc,0x3f4abeb8be2f3f27,0x3f1dbf6f3f7cbf42,0xbf653f51bf393f1d,0xbee63f13bf313f4a
.quad 0x3f77bf803f7abf65,0x3e89bcc9be603ee6,0xbf7f3f58beb8be89,0xbd97bf093f6fbf77,0x3f7ebecfbf133f7f,0xbdfb3f6abf51bd97,0xbf73be2f3f80bdfb,0x3ea1bf7cbcc93f7e,0x3f5f3f31bf09bf73,0xbefc3f393f58bea1,0xbf42bf7abecf3efc,0x3f27be60bf6abf5f,0x3f1d3f6f3f7c3f42,0xbf4abeb83e2f3f27,0xbee6bf13bf31bf4a,0x3f653f513f393f1d
.quad 0xbf73bf58bf31befc,0x3ea13f093f393f5f,0x3efc3f6a3f7a3f27,0x3f5f3ecfbe60bf42,0x3f42be2fbf6fbf4a,0xbf27bf7cbeb83f1d,0xbf4abf393f133f65,0xbf1d3f313f51bee6,0xbee63f7abcc9bf77,0x3f653e60bf803e89,0x3f77beb8bf093f7f,0x3e89bf6f3f58bd97,0x3d97bf133f6abf7e,0xbf7f3f51becfbdfb,0xbf7e3f80bf7c3f73,0x3dfb3cc9be2f3ea1
.quad 0x3ea1bf093f39bf5f,0x3f73bf583f31befc,0x3f5fbecfbe603f42,0xbefc3f6abf7a3f27,0xbf273f7cbeb8bf1d,0xbf42be2f3f6fbf4a,0xbf1dbf313f513ee6,0x3f4abf39bf133f65,0x3f65be60bf80be89,0x3ee63f7a3cc9bf77,0x3e893f6f3f583d97,0xbf77beb83f093f7f,0xbf7fbf51becf3dfb,0xbd97bf13bf6abf7e,0x3dfbbcc9be2fbea1,0x3f7e3f803f7c3f73
.quad 0xbf4abf6abf7cbf7f,0xbf1dbecfbe2f3d97,0xbf65bf7cbf31bdfb,0xbee63e2f3f393f7e,0xbf77bf393e603f73,0xbe893f313f7a3ea1,0xbf7fbe603f6f3efc,0xbd973f7a3eb8bf5f,0xbf7e3eb83f51bf42,0x3dfb3f6fbf13bf27,0xbf733f51bcc9bf4a,0x3ea13f13bf803f1d,0xbf5f3f80bf583ee6,0x3efc3cc9bf093f65,0xbf423f58bf6a3f77,0x3f27bf093ecfbe89
.quad 0xbf1d3ecfbe2fbd97,0x3f4abf6a3f7cbf7f,0xbee6be2f3f39bf7e,0x3f65bf7c3f31bdfb,0xbe89bf313f7abea1,0x3f77bf39be603f73,0xbd97bf7a3eb83f5f,0x3f7fbe60bf6f3efc,0x3dfbbf6fbf133f27,0x3f7e3eb8bf51bf42,0x3ea1bf13bf80bf1d,0x3f733f513cc9bf4a,0x3efcbcc9bf09bf65,0x3f5f3f803f583ee6,0x3f273f093ecf3e89,0x3f423f583f6a3f77
.quad 0x3f163f483f6b3f7e,0x3f4f3f203eca3e0a,0xbf2ebdb03f0c3f72,0x3f3c3f7f3f573ea7,0xbf5abf60bc493f5d,0xbf063ef73f803f01,0x3eb2bf63bf113f40,0xbf70beec3f533f2a,0x3f7dbde2bf6e3f1b,0x3e23bf7e3ebe3f4c,0x3d173f44bf7a3ee1,0x3f80bf25be543f66,0xbf793f76bf333e82,0x3e6d3e8fbf373f78,0xbed53e9bbe3b3d7b,0xbf693f74bf7c3f80
.quad 0x3f4fbf203ecabe0a,0xbf163f48bf6b3f7e,0x3f3cbf7f3f57bea7,0x3f2ebdb0bf0c3f72,0xbf06bef73f80bf01,0x3f5abf603c493f5d,0xbf703eec3f53bf2a,0xbeb2bf633f113f40,0x3e233f7e3ebebf4c,0xbf7dbde23f6e3f1b,0x3f803f25be54bf66,0xbd173f443f7a3ee1,0x3e6dbe8fbf37bf78,0x3f793f763f333e82,0xbf69bf74bf7cbf80,0x3ed53e9b3e3b3d7b
.quad 0xbee1be3b3db03eb2,0x3f663f7c3f7f3f70,0x3e82becabf60bf7d,0xbf78bf6bbef73e23,0xbd7b3f573f633d17,0x3f803f0cbeecbf80,0xbe0abf80bde23f79,0xbf7e3c493f7e3e6d,0x3ea73f53bf44bed5,0x3f72bf11bf253f69,0xbf01bebe3f76bf4f,0xbf5d3f6ebe8fbf16,0x3f2abe54be9b3f3c,0x3f40bf7a3f74bf2e,0xbf4c3f37bf203f06,0xbf1b3f33bf483f5a
.quad 0x3f66bf7c3f7fbf70,0x3ee1be3bbdb03eb2,0xbf783f6bbef7be23,0xbe82beca3f60bf7d,0x3f80bf0cbeec3f80,0x3d7b3f57bf633d17,0xbf7ebc493f7ebe6d,0x3e0abf803de23f79,0x3f723f11bf25bf69,0xbea73f533f44bed5,0xbf5dbf6ebe8f3f16,0x3f01bebebf76bf4f,0x3f403f7a3f743f2e,0xbf2abe543e9b3f3c,0xbf1bbf33bf48bf5a,0x3f4c3f373f203f06
.quad 0xbf80bf74bf57bf2a,0x3d173e9b3f0c3f40,0x3e6d3f483f803f4c,0x3f793f203c49bf1b,0x3f693db0bf53bf66,0xbed5bf7fbf113ee1,0xbf16bf603ebe3f78,0xbf4f3ef73f6ebe82,0xbf2e3f633e54bf80,0x3f3c3eecbf7a3d7b,0x3f5abde2bf373f7e,0x3f06bf7e3f333e0a,0x3eb2bf443f7cbf72,0xbf703f25be3bbea7,0xbf7d3f76bf6b3f5d,0xbe233e8fbeca3f01
.quad 0x3d17be9b3f0cbf40,0x3f80bf743f57bf2a,0x3f79bf203c493f1b,0xbe6d3f48bf803f4c,0xbed53f7fbf11bee1,0xbf693db03f53bf66,0xbf4fbef73f6e3e82,0x3f16bf60bebe3f78,0x3f3cbeecbf7abd7b,0x3f2e3f63be54bf80,0x3f063f7e3f33be0a,0xbf5abde23f373f7e,0xbf70bf25be3b3ea7,0xbeb2bf44bf7cbf72,0xbe23be8fbecabf01,0x3f7d3f763f6b3f5d
.quad 0xbf01bf37bf60bf79,0xbf5dbf33bef7be6d,0xbf2abf7cbf63bed5,0xbf40be3b3eec3f69,0xbf4cbf6bbde23f4f,0xbf1b3eca3f7e3f16,0xbf66bf0c3f443f3c,0xbee13f573f25bf2e,0xbf783c493f76bf06,0xbe823f80be8fbf5a,0xbf803f113e9bbf70,0xbd7b3f53bf743eb2,0xbf7e3f6ebf203e23,0x3e0a3ebebf483f7d,0xbf723f7abf7f3f80,0x3ea7be543db03d17
.quad 0xbf5d3f33bef73e6d,0x3f01bf373f60bf79,0xbf403e3b3eecbf69,0x3f2abf7c3f63bed5,0xbf1bbeca3f7ebf16,0x3f4cbf6b3de23f4f,0xbee1bf573f253f2e,0x3f66bf0cbf443f3c,0xbe82bf80be8f3f5a,0x3f783c49bf76bf06,0xbd7bbf53bf74beb2,0x3f803f11be9bbf70,0x3e0abebebf48bf7d,0x3f7e3f6e3f203e23,0x3ea73e543db0bd17,0x3f723f7a3f7f3f80
.quad 0x3f043f3e3f673f7d,0x3f5c3f2c3edb3e16,0xbf3ebe163f043f71,0x3f2c3f7d3f5c3eac,0xbf4ebf67bd493f5c,0xbf183edb3f803f04,0x3edbbf5cbf183f3e,0xbf67bf043f4e3f2c,0x3f78bd49bf713f18,0x3e79bf803eac3f4e,0xbd493f4ebf783edb,0x3f80bf18be793f67,0xbf7d3f71bf2c3e79,0x3e163eacbf3e3f78,0xbeac3e79be163d49,0xbf713f78bf7d3f80
.quad 0x3f5cbf2c3edbbe16,0xbf043f3ebf673f7d,0x3f2cbf7d3f5cbeac,0x3f3ebe16bf043f71,0xbf18bedb3f80bf04,0x3f4ebf673d493f5c,0xbf673f043f4ebf2c,0xbedbbf5c3f183f3e,0x3e793f803eacbf4e,0xbf78bd493f713f18,0x3f803f18be79bf67,0x3d493f4e3f783edb,0x3e16beacbf3ebf78,0x3f7d3f713f2c3e79,0xbf71bf78bf7dbf80,0x3eac3e793e163d49
.quad 0xbf18beacbd493e79,0x3f4e3f713f803f78,0x3edbbe79bf4ebf80,0xbf67bf78bf183d49,0xbe793f3e3f713e16,0x3f783f2cbeacbf7d,0x3d49bf7dbe793f71,0xbf80be163f783eac,0x3e163f67bf2cbf04,0x3f7dbedbbf3e3f5c,0xbeacbf043f7dbf3e,0xbf713f5cbe16bf2c,0x3f04bd49bedb3f4e,0x3f5cbf803f67bf18,0xbf2c3f18bf043edb,0xbf3e3f4ebf5c3f67
.quad 0x3f4ebf713f80bf78,0x3f18beac3d493e79,0xbf673f78bf18bd49,0xbedbbe793f4ebf80,0x3f78bf2cbeac3f7d,0x3e793f3ebf713e16,0xbf803e163f78beac,0xbd49bf7d3e793f71,0x3f7d3edbbf3ebf5c,0xbe163f673f2cbf04,0xbf71bf5cbe163f2c,0x3eacbf04bf7dbf3e,0x3f5c3f803f673f18,0xbf04bd493edb3f4e,0xbf3ebf4ebf5cbf67,0x3f2c3f183f043edb
.quad 0xbf78bf80bf71bf4e,0xbe793d493eac3f18,0xbd493f183f783f67,0x3f803f4e3e79bedb,0x3f7d3eacbf2cbf78,0xbe16bf71bf3e3e79,0xbeacbf783e163f80,0xbf713e793f7dbd49,0xbf5c3f3e3edbbf7d,0x3f043f2cbf67be16,0x3f2c3e16bf5c3f71,0x3f3ebf7d3f043eac,0x3f18bf673f80bf5c,0xbf4e3edb3d49bf04,0xbf673f5cbf4e3f3e,0xbedb3f04bf183f2c
.quad 0xbe79bd493eacbf18,0x3f78bf803f71bf4e,0x3f80bf4e3e793edb,0x3d493f18bf783f67,0xbe163f71bf3ebe79,0xbf7d3eac3f2cbf78,0xbf71be793f7d3d49,0x3eacbf78be163f80,0x3f04bf2cbf673e16,0x3f5c3f3ebedbbf7d,0x3f3e3f7d3f04beac,0xbf2c3e163f5c3f71,0xbf4ebedb3d493f04,0xbf18bf67bf80bf5c,0xbedbbf04bf18bf2c,0x3f673f5c3f4e3f3e
.quad 0xbe16bedbbf2cbf5c,0xbf7dbf67bf3ebf04,0xbeacbf5cbf7dbf2c,0xbf71bf043e163f3e,0xbf04bf80bedb3f18,0xbf5c3d493f673f4e,0xbf2cbf4e3f043f67,0xbf3e3f183f5cbedb,0xbf4ebeac3f80be79,0xbf183f713d49bf78,0xbf673e793f18bf80,0xbedb3f78bf4e3d49,0xbf783f3ebeacbe16,0xbe793f2cbf713f7d,0xbf803f7dbf783f71,0xbd493e16be793eac
.quad 0xbf7d3f67bf3e3f04,0x3e16bedb3f2cbf5c,0xbf713f043e16bf3e,0x3eacbf5c3f7dbf2c,0xbf5cbd493f67bf4e,0x3f04bf803edb3f18,0xbf3ebf183f5c3edb,0x3f2cbf4ebf043f67,0xbf18bf713d493f78,0x3f4ebeacbf80be79,0xbedbbf78bf4ebd49,0x3f673e79bf18bf80,0xbe79bf2cbf71bf7d,0x3f783f3e3eacbe16,0xbd49be16be79beac,0x3f803f7d3f783f71
.quad 0x3ee13f333f633f7d,0x3f663f373eec3e23,0xbf4cbe543ef73f70,0x3f1b3f7a3f603eb2,0xbf40bf6ebdb03f5a,0xbf2a3ebe3f7f3f06,0x3f01bf53bf203f3c,0xbf5dbf113f483f2e,0x3f723c49bf743f16,0x3ea7bf803e9b3f4f,0xbe0a3f57bf763ed5,0x3f7ebf0cbe8f3f69,0xbf803f6bbf253e6d,0x3d7b3ecabf443f79,0xbe823e3bbde23d17,0xbf783f7cbf7e3f80
.quad 0x3f66bf373eecbe23,0xbee13f33bf633f7d,0x3f1bbf7a3f60beb2,0x3f4cbe54bef73f70,0xbf2abebe3f7fbf06,0x3f40bf6e3db03f5a,0xbf5d3f113f48bf2e,0xbf01bf533f203f3c,0x3ea73f803e9bbf4f,0xbf723c493f743f16,0x3f7e3f0cbe8fbf69,0x3e0a3f573f763ed5,0x3d7bbecabf44bf79,0x3f803f6b3f253e6d,0xbf78bf7cbf7ebf80,0x3e823e3b3de23d17
.quad 0xbf3cbef7be3b3e0a,0x3f2e3f603f7c3f7e,0x3f16bdb0bf37bf80,0xbf4fbf7fbf33bd7b,0xbed53f203f7a3e82,0x3f693f48be54bf78,0x3e6dbf74bebe3f66,0xbf79be9b3f6e3ee1,0xbd173f76bf11bf1b,0x3f80be8fbf533f4c,0xbe23bf253f80bf2a,0xbf7d3f44bc49bf40,0x3eb23de2bf0c3f5d,0x3f70bf7e3f57bf01,0xbf063eecbeca3ea7,0xbf5a3f63bf6b3f72
.quad 0x3f2ebf603f7cbf7e,0x3f3cbef73e3b3e0a,0xbf4f3f7fbf333d7b,0xbf16bdb03f37bf80,0x3f69bf48be543f78,0x3ed53f20bf7a3e82,0xbf793e9b3f6ebee1,0xbe6dbf743ebe3f66,0x3f803e8fbf53bf4c,0x3d173f763f11bf1b,0xbf7dbf44bc493f40,0x3e23bf25bf80bf2a,0x3f703f7e3f573f01,0xbeb23de23f0c3f5d,0xbf5abf63bf6bbf72,0x3f063eec3eca3ea7
.quad 0xbf5dbf7abf7ebf69,0xbf01be543de23ed5,0xbea73ebe3f633f79,0x3f723f6e3eecbe6d,0x3f7e3f11bef7bf80,0x3e0abf53bf603d17,0xbd7bbf80bdb03f7d,0xbf80bc493f7f3e23,0xbf783f0c3f20bf70,0x3e823f57bf48beb2,0x3ee13ecabf743f5a,0x3f66bf6b3e9b3f06,0x3f4cbf7c3f76bf3c,0xbf1b3e3b3e8fbf2e,0xbf403f33bf253f16,0xbf2a3f37bf443f4f
.quad 0xbf013e543de2bed5,0x3f5dbf7a3f7ebf69,0x3f72bf6e3eec3e6d,0x3ea73ebebf633f79,0x3e0a3f53bf60bd17,0xbf7e3f113ef7bf80,0xbf803c493f7fbe23,0x3d7bbf803db03f7d,0x3e82bf57bf483eb2,0x3f783f0cbf20bf70,0x3f663f6b3e9bbf06,0xbee13eca3f743f5a,0xbf1bbe3b3e8f3f2e,0xbf4cbf7cbf76bf3c,0xbf2abf37bf44bf4f,0x3f403f333f253f16
.quad 0x3e6dbdb0becabf2a,0xbf79bf7fbf6bbf40,0x3d17bf20bf7cbf5d,0xbf80bf48be3b3f01,0xbe23bf74bf333ea7,0xbf7dbe9b3f373f72,0xbeb2bf763e543f7e,0xbf703e8f3f7abe0a,0xbf06bf253f6e3d7b,0xbf5a3f443ebebf80,0xbf2ebde23f53bf78,0xbf3c3f7ebf11be82,0xbf4f3eecbc49bee1,0xbf163f63bf803f66,0xbf693f60bf573f4c,0xbed53ef7bf0c3f1b
.quad 0xbf793f7fbf6b3f40,0xbe6dbdb03ecabf2a,0xbf803f48be3bbf01,0xbd17bf203f7cbf5d,0xbf7d3e9b3f37bf72,0x3e23bf743f333ea7,0xbf70be8f3f7a3e0a,0x3eb2bf76be543f7e,0xbf5abf443ebe3f80,0x3f06bf25bf6e3d7b,0xbf3cbf7ebf113e82,0x3f2ebde2bf53bf78,0xbf16bf63bf80bf66,0x3f4f3eec3c49bee1,0xbed5bef7bf0cbf1b,0x3f693f603f573f4c
.quad 0x3eb83f273f5f3f7c,0x3f6f3f423efc3e2f,0xbf58be893ee63f6f,0x3f093f773f653eb8,0xbf31bf73bdfb3f58,0xbf393ea13f7e3f09,0x3f13bf4abf273f39,0xbf51bf1d3f423f31,0x3f6a3d97bf773f13,0x3ecfbf7f3e893f51,0xbe603f5fbf733ecf,0x3f7abefcbea13f6a,0xbf803f65bf1d3e60,0xbcc93ee6bf4a3f7a,0xbe2f3dfbbd973cc9,0xbf7c3f7ebf7f3f80
.quad 0x3f6fbf423efcbe2f,0xbeb83f27bf5f3f7c,0x3f09bf773f65beb8,0x3f58be89bee63f6f,0xbf39bea13f7ebf09,0x3f31bf733dfb3f58,0xbf513f1d3f42bf31,0xbf13bf4a3f273f39,0x3ecf3f7f3e89bf51,0xbf6a3d973f773f13,0x3f7a3efcbea1bf6a,0x3e603f5f3f733ecf,0xbcc9bee6bf4abf7a,0x3f803f653f1d3e60,0xbf7cbf7ebf7fbf80,0x3e2f3dfb3d973cc9
.quad 0xbf58bf1dbea13cc9,0x3f093f4a3f733f80,0x3f393d97bf1dbf7c,0xbf31bf7fbf4abe2f,0xbf133efc3f7f3eb8,0x3f513f5fbd97bf6f,0x3ecfbf65befc3f58,0xbf6abee63f5f3f09,0xbe603f7ebee6bf31,0x3f7abdfbbf653f39,0x3cc9bf423f7ebf13,0xbf803f273dfbbf51,0x3e2f3e89bf273f6a,0x3f7cbf773f42becf,0xbeb83ea1be893e60,0xbf6f3f73bf773f7a
.quad 0x3f09bf4a3f73bf80,0x3f58bf1d3ea13cc9,0xbf313f7fbf4a3e2f,0xbf393d973f1dbf7c,0x3f51bf5fbd973f6f,0x3f133efcbf7f3eb8,0xbf6a3ee63f5fbf09,0xbecfbf653efc3f58,0x3f7a3dfbbf65bf39,0x3e603f7e3ee6bf31,0xbf80bf273dfb3f51,0xbcc9bf42bf7ebf13,0x3f7c3f773f423ecf,0xbe2f3e893f273f6a,0xbf6fbf73bf77bf7a,0x3eb83ea13e893e60
.quad 0xbf31bf65bf7ebf7a,0xbf39bee6bdfb3e60,0xbf133dfb3f423f80,0x3f513f7e3f27bcc9,0x3f6a3f42be89bf7c,0x3ecfbf27bf77be2f,0x3e60bf77bea13f6f,0xbf7abe893f733eb8,0xbf803ea13f4abf58,0xbcc93f73bf1dbf09,0x3e2f3f1dbf7f3f39,0x3f7cbf4a3d973f31,0x3f6fbf7f3f5fbf13,0xbeb8bd973efcbf51,0xbf093efcbee63ecf,0xbf583f5fbf653f6a
.quad 0xbf393ee6bdfbbe60,0x3f31bf653f7ebf7a,0x3f51bf7e3f273cc9,0x3f133dfbbf423f80,0x3ecf3f27bf773e2f,0xbf6a3f423e89bf7c,0xbf7a3e893f73beb8,0xbe60bf773ea13f6f,0xbcc9bf73bf1d3f09,0x3f803ea1bf4abf58,0x3f7c3f4a3d97bf31,0xbe2f3f1d3f7f3f39,0xbeb83d973efc3f51,0xbf6fbf7fbf5fbf13,0xbf58bf5fbf65bf6a,0x3f093efc3ee63ecf
.quad 0x3f133e89bd97becf,0xbf51bf77bf7fbf6a,0x3ecfbea1bf5fbf7a,0xbf6abf73befc3e60,0x3e60bf4abf653cc9,0xbf7abf1d3ee63f80,0x3cc9bf7fbdfb3f7c,0xbf80bd973f7e3e2f,0xbe2fbf5f3f423eb8,0xbf7c3efc3f27bf6f,0xbeb8bee63f77bf58,0xbf6f3f65be89bf09,0xbf093dfb3ea1bf31,0xbf583f7ebf733f39,0xbf313f27bf1d3f13,0xbf393f42bf4a3f51
.quad 0xbf513f77bf7f3f6a,0xbf133e893d97becf,0xbf6a3f73befcbe60,0xbecfbea13f5fbf7a,0xbf7a3f1d3ee6bf80,0xbe60bf4a3f653cc9,0xbf803d973f7ebe2f,0xbcc9bf7f3dfb3f7c,0xbf7cbefc3f273f6f,0x3e2fbf5fbf423eb8,0xbf6fbf65be893f09,0x3eb8bee6bf77bf58,0xbf58bf7ebf73bf39,0x3f093dfbbea1bf31,0xbf39bf42bf4abf51,0x3f313f273f1d3f13
.quad 0x3e8f3f1b3f5a3f7c,0x3f763f4c3f063e3b,0xbf63bea73ed53f6e,0x3eec3f723f693ebe,0xbf20bf78be233f57,0xbf483e823f7d3f0c,0x3f25bf40bf2e3f37,0xbf44bf2a3f3c3f33,0x3f603e0abf793f11,0x3ef7bf7e3e6d3f53,0xbe9b3f66bf703eca,0x3f74bee1beb23f6b,0xbf7e3f5dbf163e54,0xbde23f01bf4f3f7a,0xbdb03d7bbd173c49,0xbf7f3f80bf803f80
.quad 0x3f76bf4c3f06be3b,0xbe8f3f1bbf5a3f7c,0x3eecbf723f69bebe,0x3f63bea7bed53f6e,0xbf48be823f7dbf0c,0x3f20bf783e233f57,0xbf443f2a3f3cbf33,0xbf25bf403f2e3f37,0x3ef73f7e3e6dbf53,0xbf603e0a3f793f11,0x3f743ee1beb2bf6b,0x3e9b3f663f703eca,0xbde2bf01bf4fbf7a,0x3f7e3f5d3f163e54,0xbf7fbf80bf80bf80,0x3db03d7b3d173c49
.quad 0xbf6ebf3cbee1bdb0,0x3ebe3f2e3f663f7f,0x3f573e6dbf01bf76,0xbf0cbf79bf5dbe8f,0xbf373eb23f803eec,0x3f333f703d7bbf63,0x3f11bf4fbf1b3f48,0xbf53bf163f4c3f20,0xbeca3f80bea7bf44,0x3f6b3d17bf723f25,0x3e54bf5a3f78bef7,0xbf7a3f063e82bf60,0xbc493ed5bf403f74,0x3f80bf693f2abe9b,0xbe3b3e23be0a3de2,0xbf7c3f7dbf7e3f7e
.quad 0x3ebebf2e3f66bf7f,0x3f6ebf3c3ee1bdb0,0xbf0c3f79bf5d3e8f,0xbf573e6d3f01bf76,0x3f33bf703d7b3f63,0x3f373eb2bf803eec,0xbf533f163f4cbf20,0xbf11bf4f3f1b3f48,0x3f6bbd17bf72bf25,0x3eca3f803ea7bf44,0xbf7abf063e823f60,0xbe54bf5abf78bef7,0x3f803f693f2a3e9b,0x3c493ed53f403f74,0xbf7cbf7dbf7ebf7e,0x3e3b3e233e0a3de2
.quad 0xbeecbf40bf70bf80,0xbf63bf2abeb23c49,0xbf48be0a3f163f7c,0x3f203f7e3f4f3e3b,0x3f443f66bd17bf6e,0x3f25bee1bf80bebe,0x3ef7bf5dbf063f57,0xbf60bf013f5a3f0c,0xbf743d7b3f69bf37,0xbe9b3f80bed5bf33,0xbde23f4cbf7d3f11,0x3f7ebf1bbe233f53,0x3f7fbf723f3cbeca,0xbdb0bea73f2ebf6b,0xbe8f3e82be6d3e54,0xbf763f78bf793f7a
.quad 0xbf633f2abeb2bc49,0x3eecbf403f70bf80,0x3f20bf7e3f4fbe3b,0x3f48be0abf163f7c,0x3f253ee1bf803ebe,0xbf443f663d17bf6e,0xbf603f013f5abf0c,0xbef7bf5d3f063f57,0xbe9bbf80bed53f33,0x3f743d7bbf69bf37,0x3f7e3f1bbe23bf53,0x3de23f4c3f7d3f11,0xbdb03ea73f2e3f6b,0xbf7fbf72bf3cbeca,0xbf76bf78bf79bf7a,0x3e8f3e823e6d3e54
.quad 0x3f573f163e82bde2,0xbf0cbf4fbf78bf7e,0x3f373d17bf2abf7f,0xbf33bf80bf40bdb0,0x3f11bf06bf7ebe8f,0xbf53bf5a3e0a3f76,0x3ecabf69bee13f63,0xbf6bbed53f663eec,0x3e54bf7d3f013f20,0xbf7a3e233f5dbf48,0x3c49bf3c3f80bf25,0xbf803f2e3d7bbf44,0xbe3bbe6d3f1bbf60,0xbf7c3f79bf4c3ef7,0xbebe3eb2bea73e9b,0xbf6e3f70bf723f74
.quad 0xbf0c3f4fbf783f7e,0xbf573f16be82bde2,0xbf333f80bf403db0,0xbf373d173f2abf7f,0xbf533f5a3e0abf76,0xbf11bf063f7ebe8f,0xbf6b3ed53f66beec,0xbecabf693ee13f63,0xbf7abe233f5d3f48,0xbe54bf7dbf013f20,0xbf80bf2e3d7b3f44,0xbc49bf3cbf80bf25,0xbf7cbf79bf4cbef7,0x3e3bbe6dbf1bbf60,0xbf6ebf70bf72bf74,0x3ebe3eb23ea73e9b
.quad 0x3f803f803f803f80,0,0x3e163f043f4e3f78,0x3f7d3f5c3f183e79,0xbf75bef13e953f62,0x3e953f623f753ef1,0xbedbbf80beac3f3e,0xbf673d493f713f2c,0x3f55bf0ebf553f0e,0xbf0ebf553f0e3f55,0x3f2c3edbbf803eac,0x3f3ebf67bd493f71,0xbf223f7fbf463dc9,0x3f46bdc9bf223f7f,0xbf5c3f18be79be16,0xbf043f4ebf783f7d
.quad 0x3ec4bec43ec4bec4,0xbf6d3f6dbf6d3f6d,0x3f78bf7d3f5cbf18,0x3e793e16bf043f4e,0xbdc9bf223f7fbf46,0x3f7fbf463dc93f22,0xbf803eac3f3ebf67,0x3d49bf713f2c3edb,0xbe483f7b3e48bf7b,0xbf7bbe483f7b3e48,0x3f713f2cbedbbf80,0xbeac3f3e3f67bd49,0x3ef1be95bf62bf75,0x3f623f753ef1be95,0xbf4ebf78bf7dbf5c,0x3f183e79be16bf04
.quad 0x3f803f803f803f80,0,0xbf7dbf5cbf18be79,0x3e163f043f4e3f78,0x3f753ef1be95bf62,0xbe95bf62bf75bef1,0xbf673d493f713f2c,0x3edb3f803eacbf3e,0x3f55bf0ebf553f0e,0xbf0ebf553f0e3f55,0xbf3e3f673d49bf71,0x3f2c3edbbf803eac,0x3f22bf7f3f46bdc9,0xbf463dc93f22bf7f,0xbf043f4ebf783f7d,0x3f5cbf183e793e16
.quad 0x3ec4bec43ec4bec4,0xbf6d3f6dbf6d3f6d,0xbe79be163f04bf4e,0x3f78bf7d3f5cbf18,0x3dc93f22bf7f3f46,0xbf7f3f46bdc9bf22,0x3d49bf713f2c3edb,0x3f80beacbf3e3f67,0xbe483f7b3e48bf7b,0xbf7bbe483f7b3e48,0x3eacbf3ebf673d49,0x3f713f2cbedbbf80,0xbef13e953f623f75,0xbf62bf75bef13e95,0x3f183e79be16bf04,0x3f4e3f783f7d3f5c
.quad 0x3f803f803f803f80,0,0xbe16bf04bf4ebf78,0xbf7dbf5cbf18be79,0xbf75bef13e953f62,0x3e953f623f753ef1,0x3edb3f803eacbf3e,0x3f67bd49bf71bf2c,0x3f55bf0ebf553f0e,0xbf0ebf553f0e3f55,0xbf2cbedb3f80beac,0xbf3e3f673d49bf71,0xbf223f7fbf463dc9,0x3f46bdc9bf223f7f,0x3f5cbf183e793e16,0x3f04bf4e3f78bf7d
.quad 0x3ec4bec43ec4bec4,0xbf6d3f6dbf6d3f6d,0xbf783f7dbf5c3f18,0xbe79be163f04bf4e,0xbdc9bf223f7fbf46,0x3f7fbf463dc93f22,0x3f80beacbf3e3f67,0xbd493f71bf2cbedb,0xbe483f7b3e48bf7b,0xbf7bbe483f7b3e48,0xbf71bf2c3edb3f80,0x3eacbf3ebf673d49,0x3ef1be95bf62bf75,0x3f623f753ef1be95,0x3f4e3f783f7d3f5c,0xbf18be793e163f04
.quad 0x3f803f803f803f80,0,0x3f7d3f5c3f183e79,0xbe16bf04bf4ebf78,0x3f753ef1be95bf62,0xbe95bf62bf75bef1,0x3f67bd49bf71bf2c,0xbedbbf80beac3f3e,0x3f55bf0ebf553f0e,0xbf0ebf553f0e3f55,0x3f3ebf67bd493f71,0xbf2cbedb3f80beac,0x3f22bf7f3f46bdc9,0xbf463dc93f22bf7f,0x3f04bf4e3f78bf7d,0xbf5c3f18be79be16
.quad 0x3ec4bec43ec4bec4,0xbf6d3f6dbf6d3f6d,0x3e793e16bf043f4e,0xbf783f7dbf5c3f18,0x3dc93f22bf7f3f46,0xbf7f3f46bdc9bf22,0xbd493f71bf2cbedb,0xbf803eac3f3ebf67,0xbe483f7b3e48bf7b,0xbf7bbe483f7b3e48,0xbeac3f3e3f67bd49,0xbf71bf2c3edb3f80,0xbef13e953f623f75,0xbf62bf75bef13e95,0xbf18be793e163f04,0xbf4ebf78bf7dbf5c
.quad 0x3f7f3f7f3f803f80,0x3db63d843d233c7b,0x3d6f3eea3f473f77,0x3f803f643f213e84,0xbf7bbf073e813f60,0x3e513f5a3f783ef8,0xbeb1bf80bec03f3b,0xbf70bc7b3f6d3f2f,0x3f61bf00bf5a3f0b,0xbef6bf5e3f063f57,0x3f1a3ef8bf7f3ea5,0x3f4cbf60bdb63f72,0xbf333f80bf3f3da9,0x3f37bd0abf2a3f7f,0xbf4f3f0bbe51be26,0xbf173f57bf7b3f7d
.quad 0x3eedbee23ed7becb,0xbf633f66bf683f6b,0x3f72bf7f3f61bf1c,0x3ea83da9bef63f4b,0xbe3fbf153f7ebf48,0x3f7cbf503e0d3f1f,0xbf803ecb3f37bf69,0xbd23bf6b3f333ed4,0xbddb3f7e3e20bf7c,0xbf7fbe073f7d3e38,0x3f783f1fbeedbf7f,0xbe813f483f63bd84,0x3ec8beb4bf66bf74,0x3f6c3f703edfbe9c,0xbf5abf7cbf7cbf5a,0x3f063e38be3fbf07
.quad 0x3f7c3f7d3f7e3f7e,0x3e3f3e263e0d3de8,0xbf80bf6ebf33beb4,0xbd233ebd3f373f70,0x3f7f3f1cbe20bf53,0xbddbbf4bbf7dbf11,0xbf78bde83f633f40,0x3e813f7e3eedbf29,0x3f6cbed4bf663eea,0xbec8bf693edf3f64,0xbf5a3f533e3fbf79,0x3f063f11bf7c3e6a,0x3f44bf7f3f2e3c7b,0xbf24bd843f3cbf80,0xbf2a3f64bf7f3f77,0x3f3fbeea3ddb3e84
.quad 0x3f0cbf073f02bef8,0xbf563f5abf5d3f60,0xbed73c7b3ec8bf3b,0x3f68bf803f6cbf2f,0x3e903f00bf793f57,0xbf763f5ebe70bf0b,0xbe0dbf603f443ea5,0x3f7ebef8bf243f72,0xbc173f803d6fbf7f,0xbf80bd0a3f803da9,0x3e20bf57bf563e26,0x3f7d3f0bbf0cbf7d,0xbe993ee23f703f6b,0xbf74bf66beb13ecb,0x3edf3da9be90bf1c,0x3f663f7f3f763f4b
.quad 0x3f763f773f793f7a,0x3e903e843e703e57,0x3e0dbe8dbf24bf66,0xbf7ebf76bf44bee2,0xbf80bf2f3d6f3f43,0x3c173f3b3f803f25,0x3e203f7a3f0cbf15,0x3f7d3e57bf56bf50,0x3f74bea5bf703ebd,0xbe99bf723eb13f6e,0xbedfbf253f76be07,0xbf663f433e90bf7e,0xbf543f7dbf1abde8,0x3f103e26bf4c3f7e,0x3f2ebebd3c173eb4,0x3f3cbf6e3f80bf70
.quad 0x3f21bf1c3f17bf11,0xbf473f4bbf4f3f53,0xbf5d3f7ebf743f40,0xbf023de83e99bf29,0xbec0bed43f72bf64,0x3f6dbf693ea83eea,0x3f79bf11bf103f79,0x3e703f53bf54be6a,0x3db63f7fbd23bf80,0xbf7f3d843f80bc7b,0xbf80beea3f213f77,0x3d6fbf64bf473e84,0x3e51bf07bf78bf60,0x3f7b3f5a3e81bef8,0x3f703f803f6d3f3b,0xbeb13c7b3ec03f2f
.quad 0x3f6d3f703f723f74,0x3ec03eb43ea83e9c,0x3f793f7c3f543f07,0x3e70be38bf10bf5a,0x3f7f3f403d23bf32,0x3db6bf29bf80bf38,0x3f803e9cbf47bf5e,0xbd6fbf74bf213f00,0x3f7bbe6abf783e8d,0xbe51bf793e813f76,0x3f70bf32bec03f80,0xbeb1bf383f6dbd0a,0x3f61bf773f063e57,0xbef6be843f5abf7a,0x3f4cbf763f7fbf66,0xbf1a3e8d3db6bee2
.quad 0x3f33bf2f3f2abf25,0xbf373f3bbf3f3f43,0x3f17be57be513f15,0xbf4f3f7abf7b3f50,0x3eed3ea5bf683f6e,0xbf633f72bed7bebd,0x3ea83f43bf61be07,0xbf723f253ef6bf7e,0x3e3f3f7dbe0dbf7e,0xbf7c3e263f7ebde8,0x3d233f6e3f37beb4,0xbf80bebd3f333f70,0xbddb3f1c3f7d3f53,0xbf7fbf4bbe203f11,0xbe813de83eed3f40,0xbf78bf7ebf63bf29
.quad 0x3f7c3f7e3f7f3f80,0x3e353e043da33cfb,0xbcfb3ecd3f413f76,0x3f803f6b3f283e8c,0xbf7ebf153e5a3f5e,0x3dee3f503f7a3eff,0xbe86bf7fbed23f38,0xbf77bda33f693f32,0x3f6bbee3bf603f08,0xbecdbf653efa3f59,0x3f083f0abf7e3e9e,0x3f59bf57be043f74,0xbf433f80bf383d8a,0x3f263cfbbf323f7f,0xbf413efabe29be35,0xbf283f60bf7c3f7c
.quad 0x3f0abeff3ee9bed2,0xbf573f5ebf643f69,0x3f69bf803f65bf1f,0x3ed23c97bee33f49,0xbe8cbf083f7cbf4b,0x3f76bf593e353f1c,0xbf7e3ee93f2fbf6b,0xbe04bf643f3a3ecd,0xbc973f7f3deebf7c,0xbf80bd8a3f7e3e29,0x3f7c3f12beffbf7f,0xbe293f523f5ebda3,0x3e9ebed2bf6bbf73,0x3f743f693ecdbea4,0xbf65bf7ebf79bf57,0x3ee33deebe66bf0a
.quad 0x3f6e3f733f763f79,0x3ebb3ea43e8c3e66,0xbf79bf7abf4bbee9,0xbe663e5a3f1c3f64,0x3f7f3f3abc97bf41,0x3da3bf2fbf80bf28,0xbf7fbe8c3f503f52,0x3d8a3f763f15bf12,0x3f7abe86bf743eb5,0xbe5abf773e9e3f6f,0xbf6f3f383ea4bf7e,0x3eb53f32bf733dee,0x3f60bf793f123e04,0xbefabe663f52bf7e,0xbf4b3f74bf803f6e,0x3f1cbe9ebcfb3ebb
.quad 0x3f32bf283f1fbf15,0xbf383f41bf493f50,0xbf153e353e86bf26,0x3f50bf7c3f77bf43,0x3ee93eb5bf6e3f65,0xbf643f6fbebbbee3,0xbea4bf493f593e5a,0x3f73bf1fbf083f7a,0x3e353f7ebda3bf80,0xbf7c3e043f7fbcfb,0xbcfbbf6bbf413e8c,0x3f803ecdbf28bf76,0xbdee3f153f7a3f5e,0xbf7ebf50be5a3eff,0x3e86bda3bed2bf32,0x3f773f7f3f693f38
.quad 0x3f573f5e3f643f69,0x3f0a3eff3ee93ed2,0x3ed2bc97bee3bf49,0xbf69bf80bf65bf1f,0xbf76bf59be353f1c,0xbe8c3f083f7c3f4b,0xbe043f643f3abecd,0x3f7e3ee9bf2fbf6b,0x3f80bd8abf7e3e29,0xbc97bf7f3dee3f7c,0xbe29bf523f5e3da3,0xbf7c3f123effbf7f,0xbf743f69becdbea4,0x3e9e3ed2bf6b3f73,0x3ee3bdeebe663f0a,0x3f65bf7e3f79bf57
.quad 0x3f52bf4b3f43bf3a,0xbf123f1cbf263f2f,0xbf2f3f6ebf7f3f60,0xbf3a3ebb3d8abefa,0xbf1fbe293f57bf77,0x3f49bf7c3f0a3e86,0x3f5ebf43beb53f80,0x3eff3f26bf6fbc97,0x3ebb3f73be8cbf79,0xbf6e3ea43f76be66,0xbf79be5a3f4b3f64,0xbe66bf7abf1c3ee9,0xbda3bf3abf80bf41,0x3f7f3f2f3c97bf28,0x3f7f3f763f503f12,0xbd8a3e8c3f153f52
.quad 0x3f383f413f493f50,0x3f323f283f1f3f15,0x3f503f7c3f773f43,0x3f153e35be86bf26,0x3f643f6f3ebbbee3,0x3ee9beb5bf6ebf65,0x3f733f1fbf08bf7a,0x3ea4bf49bf593e5a,0x3f7c3e04bf7fbcfb,0x3e35bf7ebda33f80,0x3f80becdbf283f76,0x3cfbbf6b3f413e8c,0x3f7ebf503e5a3eff,0xbdeebf153f7abf5e,0x3f77bf7f3f69bf38,0xbe86bda33ed2bf32
.quad 0x3f6bbf653f60bf59,0xbecd3ee3befa3f08,0x3f59bf0a3e043e9e,0xbf083f57bf7e3f74,0x3f43bcfbbf383f7f,0xbf263f80bf32bd8a,0x3f283efabf7c3e35,0xbf413f603e29bf7c,0x3f0a3f5ebee9bf69,0xbf573eff3f64bed2,0x3ed23f803ee3bf1f,0xbf69bc973f653f49,0x3e8c3f593f7c3f1c,0xbf76bf083e353f4b,0x3e043ee93f3a3f6b,0xbf7ebf64bf2fbecd
.quad 0x3f773f7b3f7e3f80,0x3e873e453df43d3c,0xbdf43eae3f3a3f75,0x3f7e3f713f303e93,0xbf80bf223e323f5c,0x3ce23f463f7c3f03,0xbe32bf7dbee53f36,0xbf7cbe133f653f34,0x3f73bec5bf643f04,0xbea2bf6c3ee83f5b,0x3ee83f18bf7c3e96,0x3f64bf4ebe2c3f75,0xbf513f7fbf313d56,0x3f143dc2bf393f80,0xbf313edcbe00be45,0xbf393f67bf7e3f7b
.quad 0x3f1dbf0e3efbbed9,0xbf4a3f55bf5f3f68,0x3f5fbf803f6abf22,0x3efbbd3cbed13f46,0xbeb7bef33f7abf4d,0x3f6fbf613e5d3f19,0xbf7a3f033f28bf6c,0xbe5dbf5c3f413ec5,0x3d903f803d9dbf7d,0xbf7fbb493f7f3e19,0x3f7f3f04bf08bf7f,0xbd9d3f5b3f59bdc2,0x3e63bef0bf6fbf71,0x3f7a3f623ebabeab,0xbf6fbf80bf77bf55,0x3eba3d56be87bf0e
.quad 0x3f593f623f6a3f71,0x3f083ef03ece3eab,0xbf6abf80bf5ebf0e,0xbece3d563efe3f55,0x3f773f543df4bf2d,0x3e87bf0fbf7ebf3d,0xbf7ebed93f3a3f61,0xbdf43f683f30bef3,0x3f80bdcfbf7c3e7c,0xbce2bf7f3e323f78,0xbf7c3f193ee5bf80,0x3e323f4dbf653b49,0x3f73bf6d3ee83e76,0xbea2bec23f64bf79,0xbf643f7dbf7c3f62,0x3ee8be19be2c3ef0
.quad 0x3f51bf453f39bf2b,0xbf143f23bf313f3e,0xbf393eab3e00bf0f,0x3f31bf713f7ebf54,0x3f1d3e4bbf5f3f71,0xbf4a3f7bbefbbeae,0xbefbbf2d3f6a3dcf,0x3f5fbf3dbed13f7f,0x3eb73f75be5dbf7d,0xbf6f3e933f7abe13,0xbe5dbf78bf283ec2,0x3f7a3e7cbf41bf6d,0x3d903f343f7f3f4e,0xbf7fbf36bd9d3f18,0x3d9dbe76bf08bf45,0x3f7f3f793f593f23
.quad 0x3f283f363f423f4e,0x3f413f343f273f18,0x3f273e76be63bf23,0xbf42bf79bf7abf45,0xbf59bf75bece3edc,0xbf083e963f6a3f67,0xbece3f3e3f5ebe4b,0x3f6a3f2bbefebf7b,0x3f773e45bf7ebd3c,0x3e87bf7bbdf43f80,0x3df4bf713f3a3e93,0xbf7e3eae3f30bf75,0xbf803f46be32bf03,0x3ce23f22bf7c3f5c,0x3e323e13bee53f34,0x3f7cbf7d3f65bf36
.quad 0x3f73bf6c3f64bf5b,0xbea23ec5bee83f04,0xbee83f4ebf7c3f75,0xbf643f18be2cbe96,0xbf513dc23f31bf80,0x3f14bf7f3f393d56,0x3f31bf67be003f7b,0x3f393edcbf7e3e45,0x3f1d3f55befbbf68,0xbf4a3f0e3f5fbed9,0xbf5f3d3c3f6a3f46,0xbefbbf80bed13f22,0xbeb7bf61bf7abf19,0x3f6f3ef3be5dbf4d,0x3f7a3f5c3f283ec5,0x3e5d3f033f413f6c
.quad 0x3ed13ef33f0a3f19,0x3f6a3f613f583f4d,0x3f0a3f5c3f7f3f6c,0x3f583f033d90bec5,0x3f283f803f27be19,0x3f41bb49bf42bf7d,0x3f423f5bbe63bf7f,0x3f27bf04bf7abdc2,0x3f593ef0bf6abeab,0x3f08bf62bece3f71,0x3f6abd56bf5e3f55,0x3ecebf803efe3f0e,0x3f77bf0fbdf43f3d,0x3e87bf543f7ebf2d,0x3f7ebf683f3abef3,0x3df4bed93f30bf61
.quad 0x3f80bf7f3f7cbf78,0xbce23dcfbe323e7c,0x3f7cbf4d3ee53b49,0xbe323f19bf653f80,0x3f73bec2bee83f79,0xbea23f6dbf643e76,0x3f643e19bf7c3ef0,0xbee83f7dbe2cbf62,0x3f513f23bf39bf3e,0xbf143f453f31bf2b,0x3f393f713e00bf54,0xbf313eab3f7e3f0f,0x3f1d3f7b3f5f3eae,0xbf4abe4b3efb3f71,0x3efb3f3d3f6a3f7f,0xbf5fbf2dbed1bdcf
.quad 0x3f703f783f7d3f80,0x3eb23e823e233d7b,0xbe543e8f3f333f74,0x3f7a3f763f373e9b,0xbf80bf2e3e0a3f5a,0xbd7b3f3c3f7e3f06,0xbdb0bf7abef73f33,0xbf7fbe543f603f37,0x3f79bea7bf693f01,0xbe6dbf723ed53f5d,0x3ebe3f25bf7a3e8f,0x3f6ebf44be543f76,0xbf5d3f7dbf2a3d17,0x3f013e23bf403f80,0xbf203ebebdb0be54,0xbf483f6ebf7f3f7a
.quad 0x3f2ebf1b3f06bee1,0xbf3c3f4cbf5a3f66,0x3f53bf7e3f6ebf25,0x3f11bde2bebe3f44,0xbee1bed53f78bf4f,0x3f66bf693e823f16,0xbf743f113f20bf6e,0xbe9bbf533f483ebe,0x3e233f803d17bf7e,0xbf7d3d7b3f803e0a,0x3f803eecbf11bf7e,0x3c493f633f53bde2,0x3e0abf06bf72bf70,0x3f7e3f5a3ea7beb2,0xbf76bf80bf74bf53,0x3e8fbc49be9bbf11
.quad 0x3f3c3f4c3f5a3f66,0x3f2e3f1b3f063ee1,0xbf53bf7ebf6ebf25,0xbf11bde23ebe3f44,0x3f663f693e82bf16,0x3ee1bed5bf78bf4f,0xbf74bf113f203f6e,0xbe9b3f533f48bebe,0x3f7d3d7bbf803e0a,0x3e23bf803d173f7e,0xbf803eec3f11bf7e,0xbc493f63bf53bde2,0x3f7ebf5a3ea73eb2,0xbe0abf063f72bf70,0xbf763f80bf743f53,0x3e8f3c49be9b3f11
.quad 0x3f69bf5d3f4fbf40,0xbed53f01bf163f2a,0xbf573ef7bc49beec,0x3f0cbf603f80bf63,0x3f403d17bf4c3f79,0xbf2a3f80bf1bbe6d,0xbf25bf0c3f76bc49,0x3f44bf57be8f3f80,0x3f063f66beb2bf78,0xbf5a3ee13f70be82,0xbecabf7fbf0c3ef7,0x3f6b3db0bf57bf60,0x3e823f4f3f803f3c,0xbf78bf163d7b3f2e,0xbde2becabf25bf57,0x3f7e3f6b3f443f0c
.quad 0x3ed53f013f163f2a,0x3f693f5d3f4f3f40,0x3f573ef73c49beec,0xbf0cbf60bf80bf63,0xbf2abf80bf1b3e6d,0xbf403d173f4c3f79,0xbf253f0c3f763c49,0x3f443f57be8fbf80,0x3f5a3ee1bf70be82,0x3f06bf66beb23f78,0x3ecabf7f3f0c3ef7,0xbf6b3db03f57bf60,0xbf783f163d7bbf2e,0xbe823f4fbf803f3c,0xbde23ecabf253f57,0x3f7ebf6b3f44bf0c
.quad 0x3f80bf7e3f79bf72,0xbd173e0abe6d3ea7,0xbe3b3f20bf6b3f7f,0xbf7c3f48becabdb0,0xbf723eb23f01bf7d,0x3ea7bf703f5dbe23,0x3eecbf7c3de23f6b,0x3f633e3bbf7e3eca,0x3f4f3f2abf2ebf4c,0xbf163f403f3cbf1b,0xbf333e9b3f7c3f20,0xbf37bf74be3b3f48,0xbf1bbf79bf66bed5,0x3f4c3e6dbee1bf69,0x3f603f333eec3e3b,0x3ef73f373f633f7c
.quad 0x3d173e0a3e6d3ea7,0x3f803f7e3f793f72,0x3e3b3f203f6b3f7f,0x3f7c3f483ecabdb0,0x3ea73f703f5d3e23,0x3f723eb2bf01bf7d,0x3eec3f7c3de2bf6b,0x3f63be3bbf7ebeca,0x3f163f40bf3cbf1b,0x3f4fbf2abf2e3f4c,0x3f333e9bbf7c3f20,0x3f37bf743e3b3f48,0x3f4cbe6dbee13f69,0x3f1bbf793f66bed5,0x3f60bf333eecbe3b,0x3ef7bf373f63bf7c
.quad 0x3f70bf783f7dbf80,0x3eb2be823e23bd7b,0x3f7abf763f37be9b,0x3e543e8fbf333f74,0x3f80bf2ebe0a3f5a,0x3d7b3f3cbf7e3f06,0x3f7fbe54bf603f37,0xbdb03f7abef7bf33,0x3f793ea7bf69bf01,0xbe6d3f723ed5bf5d,0x3f6e3f44be54bf76,0xbebe3f253f7a3e8f,0x3f5d3f7d3f2a3d17,0xbf013e233f403f80,0x3f483f6e3f7f3f7a,0xbf20bebebdb03e54
.quad 0x3f673f733f7b3f7f,0x3edc3ea23e4b3d9d,0xbe963e5d3f2b3f73,0x3f753f7a3f3e3ea2,0xbf7dbf3a3dc23f58,0xbe193f303f7f3f0a,0x3b49bf77bf043f30,0xbf80be8a3f5b3f3a,0x3f7dbe87bf6d3efb,0xbe13bf773ec23f5f,0x3e933f31bf783e87,0x3f75bf39be7c3f77,0xbf683f7abf223cb0,0x3ed93e63bf463f80,0xbf0e3e9fbd3cbe63,0xbf553f73bf803f7a
.quad 0x3f3ebf283f0fbee8,0xbf2b3f41bf543f64,0x3f45bf7c3f71bf28,0x3f23be32beab3f41,0xbf04beb73f75bf52,0x3f5bbf6f3e963f13,0xbf6c3f1e3f18bf6f,0xbec5bf493f4e3eb7,0x3e7c3f7ebb49bf7e,0xbf783e003f803df4,0x3f7f3ecebf19bf7e,0x3dcf3f6a3f4dbe00,0x3d3cbf14bf75bf6f,0x3f803f513e93beba,0xbf7bbf7fbf71bf51,0x3e45bd9dbeaebf14
.quad 0x3f183f303f453f58,0x3f4e3f3a3f233f0a,0xbf34bf77bf79bf3a,0xbf36be8a3e763f30,0x3f4d3f773ec5befb,0x3f19be87bf6cbf5f,0xbf61bf313f033f77,0xbef33f393f5cbe87,0x3f713e63bf7f3cb0,0x3eaebf7abdcf3f80,0xbf7b3e9f3f2dbf7a,0xbe4b3f73bf3dbe63,0x3f80bf413e453ee8,0x3d56bf283f7bbf64,0xbf7f3f7cbf673f41,0x3dc23e32bedc3f28
.quad 0x3f79bf6f3f62bf52,0xbe763eb7bef03f13,0xbf6d3f1ebe19beb7,0x3ec2bf493f7dbf6f,0x3f5cbe00bf343f7e,0xbf033f7ebf36bdf4,0xbf46bece3f7dbe00,0x3f22bf6abe133f7e,0x3f2d3f51bef3bf6f,0xbf3d3f143f61beba,0xbf0fbf7fbed93f14,0x3f54bd9dbf68bf51,0x3edc3f653f7b3f27,0xbf67bee53e4b3f42,0xbe96bf0abf3ebf65,0x3f753f583f2b3ee5
.quad 0x3e133e873ec23efb,0x3f7d3f773f6d3f5f,0x3f753f313e7cbe87,0xbe93bf39bf78bf77,0xbed9bf7abf463cb0,0xbf68be633f223f80,0xbf553e9f3f803e63,0x3f0e3f73bd3cbf7a,0x3f2b3f28bf54bee8,0x3f3ebf41bf0f3f64,0x3f23bf7c3eab3f28,0xbf45be323f71bf41,0xbf5b3eb73e96bf52,0xbf043f6fbf753f13,0xbec53f1ebf4e3f6f,0x3f6cbf493f18beb7
.quad 0x3f78bf7e3f80bf7e,0x3e7cbe003b493df4,0x3dcf3ecebf4d3f7e,0xbf7f3f6abf193e00,0xbf803f143e93bf6f,0x3d3cbf513f75beba,0x3e45bf7f3eae3f51,0x3f7bbd9dbf713f14,0x3f713ee5bf55bf27,0xbeab3f653f0ebf42,0xbef03f0a3f803ee5,0xbf62bf583d563f65,0xbf4ebf80bf45be5d,0x3f18bce2bf23bf7a,0x3f343efb3e76bce2,0x3f363f5f3f793f80
.quad 0xbeaebe63bdcf3cb0,0x3f713f7a3f7f3f80,0xbe4b3e9f3f3d3f7a,0x3f7b3f733f2d3e63,0xbd563f413f7b3ee8,0x3f803f28be45bf64,0x3dc23f7c3edcbf41,0x3f7f3e32bf67bf28,0x3e763f6fbef0bf52,0x3f79beb7bf623f13,0x3ec23f1ebf7d3eb7,0x3f6dbf49be193f6f,0x3f033e00bf363f7e,0x3f5cbf7e3f34bdf4,0x3f22bece3e133e00,0x3f46bf6a3f7dbf7e
.quad 0x3f3dbf513f61bf6f,0x3f2dbf143ef3beba,0x3f54bf7f3f68bf14,0x3f0fbd9dbed93f51,0x3f67bf653e4b3f27,0x3edc3ee5bf7b3f42,0x3f75bf0abf2b3f65,0x3e963f58bf3ebee5,0x3f7dbce2bf7fbe5d,0x3e193f803dc2bf7a,0x3f803efbbf04bf80,0x3b493f5f3f5bbce2,0x3f7d3f5e3ec2be8a,0xbe133efe3f6d3f77,0x3f753f803f783f5e,0xbe93bcb03e7c3efe
.quad 0x3f5c3f6d3f793f7f,0x3f023ec13e733dbc,0xbec13e1c3f243f72,0x3f6d3f7d3f453eaa,0xbf79bf453d623f56,0xbe733f243f803f0d,0x3dbcbf72bf0d3f2d,0xbf7fbeaa3f563f3d,0x3f80be4ebf713ef4,0xbd62bf7b3eaf3f61,0x3e4e3f3dbf753e7f,0x3f7bbf2dbe923f78,0xbf713f75bf1a3bc9,0x3eaf3e92bf4d3f80,0xbef43e7fbbc9be73,0xbf613f78bf803f79
.quad 0x3f4dbf343f17beef,0xbf1a3f36bf4f3f63,0x3f36bf793f75bf2b,0x3f34be73be983f3f,0xbf17be983f72bf54,0x3f4fbf753eaa3f10,0xbf633f2b3f10bf71,0xbeefbf3f3f543eaf,0x3eaa3f7bbd30bf7f,0xbf723e423f803dd5,0x3f7b3eafbf21bf7d,0x3e423f713f47be10,0xbd30bf21bf78bf6d,0x3f803f473e7fbec1,0xbf7fbf7dbf6dbf4f,0x3dd5be10bec1bf17
.quad 0x3ede3f103f2d3f47,0x3f673f543f3d3f21,0xbf10bf68bf7fbf4d,0xbf54bed83dd53f1a,0x3f2d3f7f3f02bec7,0x3f3dbdd5bf5cbf6c,0xbf47bf4d3ec73f7d,0xbf213f1a3f6cbe1c,0x3f5c3ec1bf79bdbc,0x3f02bf6dbe733f7f,0xbf6d3e1c3f45bf72,0xbec13f7dbf24beaa,0x3f79bf243d623f0d,0x3e73bf453f80bf56,0xbf7f3f72bf563f2d,0xbdbc3eaabf0d3f3d
.quad 0x3f80bf7b3f71bf61,0xbd623e4ebeaf3ef4,0xbf7b3f3dbe92be7f,0x3e4ebf2d3f75bf78,0x3f71be92bf1a3f80,0xbeaf3f75bf4dbbc9,0xbf61be7f3f80be73,0x3ef4bf78bbc93f79,0x3f4d3f36bf17bf63,0xbf1a3f343f4fbeef,0xbf34bf79be983f2b,0x3f36be73bf75bf3f,0x3f173f753f723f10,0xbf4fbe983eaa3f54,0xbeefbf2bbf54bf71,0x3f633f3f3f103eaf
.quad 0xbe103bc93e1c3e98,0x3f7d3f803f7d3f75,0x3f803f5b3eefbd62,0xbbc9bf05bf63bf80,0xbe1cbf63bf67be42,0xbf7dbeef3ede3f7b,0xbf753d623f7b3ed8,0x3e983f803e42bf68,0x3ede3f54bf2dbf21,0x3f67bf10bf3d3f47,0x3f54bf683dd53f4d,0xbf10bed83f7fbf1a,0xbf2d3dd53f02bf6c,0xbf3d3f7fbf5c3ec7,0xbf213f4dbf6c3f7d,0x3f47bf1a3ec7be1c
.quad 0x3f5cbf6d3f79bf7f,0x3f02bec13e73bdbc,0x3ec13e1cbf243f72,0xbf6d3f7dbf453eaa,0xbf793f453d62bf56,0xbe73bf243f80bf0d,0xbdbcbf723f0d3f2d,0x3f7fbeaabf563f3d,0x3f803e4ebf71bef4,0xbd623f7b3eafbf61,0xbe4e3f3d3f753e7f,0xbf7bbf2d3e923f78,0xbf71bf75bf1abbc9,0x3eafbe92bf4dbf80,0x3ef43e7f3bc9be73,0x3f613f783f803f79
.quad 0xbf2bbf0dbed8be92,0x3f3f3f563f683f75,0xbf0dbd303ef43f5c,0x3f563f803f613f02,0xbed83ef43f7d3f34,0x3f683f613e10bf36,0xbe923f5c3f34bf05,0x3f753f02bf36bf5b,0xbe103f80be1cbf75,0x3f7dbbc9bf7d3e98,0x3bc93f5bbf633d62,0x3f80bf05beef3f80,0x3e1c3eefbf673f7b,0x3f7dbf633ede3e42,0x3e98bd62be423ed8,0x3f75bf803f7bbf68
.quad 0x3edebf103f2dbf47,0x3f67bf543f3dbf21,0x3f10bf683f7fbf4d,0x3f54bed8bdd53f1a,0x3f2dbf7f3f023ec7,0x3f3d3dd5bf5c3f6c,0x3f47bf4dbec73f7d,0x3f213f1abf6cbe1c,0x3f5cbec1bf793dbc,0x3f023f6dbe73bf7f,0x3f6d3e1cbf45bf72,0x3ec13f7d3f24beaa,0x3f793f243d62bf0d,0x3e733f453f803f56,0x3f7f3f723f563f2d,0x3dbc3eaa3f0d3f3d
.quad 0x3f503f663f763f7f,0x3f153edf3e8d3ddb,0xbeea3db63f1c3f70,0x3f643f7f3f4b3eb1,0xbf72bf4f3c7b3f54,0xbea53f173f803f10,0x3e38bf6cbf153f2a,0xbf7cbec83f503f3f,0x3f80be0dbf743eed,0x3d0abf7e3e9c3f63,0x3de83f47bf723e70,0x3f7ebf21bea53f79,0xbf773f70bf11bc17,0x3e843eb1bf533f80,0xbecb3e3f3d0abe81,0xbf6b3f7cbf803f78
.quad 0x3f5abf3f3f1fbef6,0xbf073f2abf483f61,0x3f25bf743f77bf2e,0x3f43be99be843f3c,0xbf29be703f6ebf56,0x3f40bf793ebd3f0c,0xbf573f373f07bf72,0xbf0bbf333f5a3ea8,0x3ed43f78bda9bf7f,0xbf693e813f7f3db6,0x3f763e90bf29bf7d,0x3e8d3f763f40be20,0xbe07bf2ebf7abf6c,0x3f7e3f3c3e57bec8,0xbf80bf7bbf69bf4c,0x3c7bbe51bed4bf1a
.quad 0x3e843ed73f113f33,0x3f773f683f533f37,0xbecbbf54bf80bf5d,0xbf6bbf10bd0a3f02,0x3f073f803f1fbe90,0x3f5a3d6fbf48bf76,0xbf25bf633e843f80,0xbf433eed3f77bd23,0x3f403f06bf6ebe51,0x3f29bf5abebd3f7b,0xbf57bc173f5abf66,0xbf0b3f80bf07bedf,0x3f69bf02bda93f24,0x3ed4bf5d3f7fbf44,0xbf763f61bf403f17,0xbe8d3ef6bf293f4f
.quad 0x3f7ebf803f7abf6d,0x3e073d23be573ec0,0xbf803f56bed4be0d,0x3c7bbf0c3f69bf7e,0x3f7dbedfbef83f7f,0xbe263f66bf603ddb,0xbf74bdb63f7ebeb1,0x3e9cbf7f3e073f70,0x3f663f17bf32bf54,0xbee23f4f3f38bf10,0xbf53bf6cbe263f3f,0x3f11bec8bf7dbf2a,0x3f3b3f7e3f643eed,0xbf2fbe0d3eea3f63,0xbf1fbf47bf66bf79,0x3f483f213ee23e70
.quad 0xbed4be81bda93db6,0x3f693f783f7f3f7f,0x3f763f763f293e20,0x3e8dbe90bf40bf7d,0x3e07bf3cbf7abec8,0xbf7ebf2e3e573f6c,0xbf80be513f693f1a,0x3c7b3f7b3ed4bf4c,0x3e263f72bef8bf47,0x3f7dbea8bf603f21,0x3f74bf44be073f68,0xbe9cbf243f7ebed7,0xbee2be203f32bf7c,0xbf663f7dbf383e3f,0xbf533f6dbf7d3f80,0x3f11bec03e263d6f
.quad 0x3f2fbf4c3f64bf74,0x3f3bbf1a3eeabe99,0x3f1fbddbbee23f5a,0xbf483f7fbf663f06,0xbf5e3f68be38bf33,0xbf00bed73f7cbf37,0xbebdbf543f3b3f02,0x3f6ebf10bf2f3f5d,0x3f79bd6fbf7ebe90,0x3e6a3f803de8bf76,0x3da93f633f5e3d23,0xbf7fbeed3f003f80,0xbf7fbf5abecb3e51,0x3d84bf06bf6bbf7b,0x3e57bc17be6abedf,0x3f7a3f803f793f66
.quad 0xbf66bf4fbf32bf10,0x3ee23f173f383f54,0xbf53bec83e263f2a,0x3f113f6c3f7d3f3f,0xbf3b3e0d3f643f63,0x3f2f3f7e3eeabeed,0xbf1f3f213f66be70,0x3f483f47bee2bf79,0xbf003f703e38bf80,0x3f5e3eb1bf7cbc17,0xbebd3f7cbf2fbe81,0x3f6ebe3fbf3b3f78,0xbe6a3f3fbf7e3f61,0x3f79bf2a3de83ef6,0xbda93e99bf003f2e,0x3f7fbf743f5ebf3c
.quad 0x3d84be703ecbbf0c,0x3f7fbf793f6bbf56,0x3e57bf333f79bf72,0x3f7abf373e6a3ea8,0x3eb4bf783f433db6,0x3f70be81bf253f7f,0x3ef8bf76bd843f7d,0x3f603e90bf7f3e20,0x3f1cbf2ebf573ec8,0x3f4b3f3cbf0bbf6c,0x3f38be51bf70bf4c,0x3f323f7b3eb4bf1a,0x3f503ea8be8dbf47,0x3f153f723f763f21,0x3f643f443f1c3ed7,0x3eea3f243f4b3f68
.quad 0x3f423f5f3f733f7e,0x3f273efc3ea13dfb,0xbf093cc93f133f6f,0x3f583f803f513eb8,0xbf6abf58bcc93f51,0xbecf3f093f803f13,0x3e89bf65bf1d3f27,0xbf77bee63f4a3f42,0x3f7ebd97bf773ee6,0x3dfbbf7f3e893f65,0x3cc93f51bf6f3e60,0x3f80bf13beb83f7a,0xbf7c3f6abf09bcc9,0x3e2f3ecfbf583f80,0xbea13dfb3d97be89,0xbf733f7ebf7f3f77
.quad 0x3f65bf4a3f27befc,0xbee63f1dbf423f5f,0x3f13bf6f3f7abf31,0x3f51beb8be603f39,0xbf39be2f3f6abf58,0x3f31bf7c3ecf3f09,0xbf4a3f423efcbf73,0xbf1dbf273f5f3ea1,0x3efc3f73bdfbbf7f,0xbf5f3ea13f7e3d97,0x3f6f3e60bf31bf7c,0x3eb83f7a3f39be2f,0xbe60bf39bf7cbf6a,0x3f7a3f313e2fbecf,0xbf7fbf77bf65bf4a,0xbd97be89bee6bf1d
.quad 0x3d973e893ee63f1d,0x3f7f3f773f653f4a,0xbe60bf39bf7cbf6a,0xbf7abf31be2f3ecf,0x3eb83f7a3f39be2f,0x3f6f3e60bf31bf7c,0xbefcbf733dfb3f7f,0xbf5f3ea13f7e3d97,0x3f1d3f27bf5fbea1,0x3f4abf42befc3f73,0xbf39be2f3f6abf58,0xbf313f7cbecfbf09,0x3f51beb8be603f39,0x3f13bf6f3f7abf31,0xbf653f4abf273efc,0xbee63f1dbf423f5f
.quad 0x3f73bf7e3f7fbf77,0x3ea1bdfbbd973e89,0xbf7c3f6abf09bcc9,0xbe2fbecf3f58bf80,0x3f80bf13beb83f7a,0x3cc93f51bf6f3e60,0xbf7e3d973f77bee6,0x3dfbbf7f3e893f65,0x3f773ee6bf4abf42,0xbe893f653f1dbf27,0xbf6abf58bcc93f51,0x3ecfbf09bf80bf13,0x3f583f803f513eb8,0xbf093cc93f133f6f,0xbf42bf5fbf73bf7e,0x3f273efc3ea13dfb
.quad 0xbf27befcbea1bdfb,0x3f423f5f3f733f7e,0x3f583f803f513eb8,0x3f09bcc9bf13bf6f,0x3ecfbf09bf80bf13,0xbf6abf58bcc93f51,0xbf77bee63f4a3f42,0xbe893f653f1dbf27,0xbdfb3f7fbe89bf65,0x3f7ebd97bf773ee6,0x3f80bf13beb83f7a,0xbcc9bf513f6fbe60,0xbe2fbecf3f58bf80,0xbf7c3f6abf09bcc9,0xbf733f7ebf7f3f77,0x3ea1bdfbbd973e89
.quad 0x3ee6bf1d3f42bf5f,0x3f65bf4a3f27befc,0x3f51beb8be603f39,0xbf133f6fbf7a3f31,0xbf313f7cbecfbf09,0xbf39be2f3f6abf58,0xbf1dbf273f5f3ea1,0x3f4abf42befc3f73,0x3f5fbea1bf7ebd97,0x3efc3f73bdfbbf7f,0x3eb83f7a3f39be2f,0xbf6fbe603f313f7c,0xbf7abf31be2f3ecf,0xbe60bf39bf7cbf6a,0xbd97be89bee6bf1d,0x3f7f3f773f653f4a
.quad 0xbf7fbf77bf65bf4a,0x3d973e893ee63f1d,0xbf7abf31be2f3ecf,0x3e603f393f7c3f6a,0xbf6fbe603f313f7c,0x3eb83f7a3f39be2f,0xbf5f3ea13f7e3d97,0x3efc3f73bdfbbf7f,0xbf4a3f423efcbf73,0x3f1d3f27bf5fbea1,0xbf313f7cbecfbf09,0x3f393e2fbf6a3f58,0xbf133f6fbf7a3f31,0x3f51beb8be603f39,0xbee63f1dbf423f5f,0x3f65bf4a3f27befc
.quad 0xbea13dfb3d97be89,0x3f73bf7e3f7fbf77,0xbe2fbecf3f58bf80,0x3f7cbf6a3f093cc9,0xbcc9bf513f6fbe60,0x3f80bf13beb83f7a,0x3dfbbf7f3e893f65,0x3f7ebd97bf773ee6,0x3e89bf65bf1d3f27,0x3f773ee6bf4abf42,0x3ecfbf09bf80bf13,0x3f6a3f583cc9bf51,0x3f09bcc9bf13bf6f,0x3f583f803f513eb8,0x3f273efc3ea13dfb,0x3f423f5f3f733f7e
.quad 0x3f323f563f703f7e,0x3f383f0c3eb43e0d,0xbf1cbd233f0b3f6d,0x3f4b3f803f573ec0,0xbf60bf61bd843f4f,0xbef83ef63f7f3f17,0x3eb4bf5dbf253f24,0xbf70bf023f433f44,0x3f7abc17bf793edf,0x3e57bf803e6a3f66,0xbd843f5abf6b3e51,0x3f7fbf06becb3f7b,0xbf7f3f63bf00bd23,0x3da93eedbf5e3f80,0xbe6a3d6f3de8be90,0xbf793f80bf7e3f76
.quad 0x3f6ebf543f2fbf02,0xbebd3f10bf3b3f5d,0x3f00bf683f7cbf33,0x3f5ebed7be383f37,0xbf48bddb3f66bf5a,0x3f1fbf7f3ee23f06,0xbf3b3f4c3eeabf74,0xbf2fbf1a3f643e99,0x3f113f6dbe26bf80,0xbf533ec03f7d3d6f,0x3f663e20bf38bf7c,0x3ee23f7d3f32be3f,0xbe9cbf44bf7ebf68,0x3f743f243e07bed7,0xbf7dbf72bf60bf47,0xbe26bea8bef8bf21
.quad 0xbde83ddb3ea53f06,0x3f7e3f7f3f723f5a,0xbd0abf1abf74bf74,0xbf80bf4cbe9c3e99,0x3e383f6d3f50bd6f,0x3f7c3ec0bf15bf80,0xbea5bf7dbc7b3f7c,0xbf723e203f803e3f,0x3eea3f44bf4bbed7,0x3f64bf24bf1c3f68,0xbf15bea83f76bf47,0xbf503f72be8dbf21,0x3f32be51beb43f4c,0x3f38bf7b3f70bf1a,0xbf4b3f2ebf0b3ec8,0xbf1c3f3cbf573f6c
.quad 0x3f60bf763f7fbf7d,0x3ef8be903d843e20,0xbf703f78bf253db6,0xbeb4be813f43bf7f,0x3f7abf33be6a3f72,0x3e573f37bf793ea8,0xbf7f3e703f6bbf0c,0xbd84bf793ecb3f56,0x3f7f3e99bf5ebf2e,0xbda93f743f00bf3c,0xbf79bf3f3de83f61,0x3e6abf2abf7ebef6,0x3f6e3f7c3f3b3e81,0xbebd3e3f3f2f3f78,0xbf5ebf70bf7cbf80,0x3f003eb13e383c17
.quad 0xbf57bf33bf07bea8,0x3f0b3f373f5a3f72,0x3f293f793f6e3f0c,0x3f403e70bebdbf56,0x3f25be99bf77bf3c,0xbf43bf74be843f2e,0xbf5abf2a3f1f3f61,0xbf073f3f3f48bef6,0xbecb3f7cbd0abf78,0x3f6b3e3fbf803e81,0x3f77beb1bf113f80,0x3e84bf703f53bc17,0x3de8bf213f72bf79,0xbf7e3f47bea5be70,0xbf803f7ebf743f63,0x3d0a3e0dbe9c3eed
.quad 0x3e38bec83f15bf3f,0x3f7cbf6c3f50bf2a,0x3f72bf173c7b3f10,0xbea53f4fbf803f54,0xbeea3f7fbf1cbeb1,0xbf643db63f4bbf70,0xbf50bedf3f763ddb,0x3f15bf66be8d3f7f,0x3f32bf0cbf703e0d,0x3f383f56beb4bf7e,0x3f1c3f803f0bbec0,0xbf4b3d233f573f6d,0xbf60bef63d843f17,0xbef8bf61bf7fbf4f,0xbeb4bf02bf25bf44,0x3f703f5d3f433f24
.quad 0xbf74bf7fbf7ebf70,0xbe9cbdb63e073eb1,0xbf7dbf66bef83ddb,0xbe263edf3f603f7f,0xbf80bf0c3ed43f7e,0xbc7b3f563f693e0d,0xbf7ebd233f7a3ec0,0x3e073f803e57bf6d,0xbf763ef63f40bf4f,0x3e8d3f61bf29bf17,0xbf693f5dbda9bf44,0x3ed43f02bf7f3f24,0xbf573f80bf5a3edf,0x3f0bbc17bf073f66,0xbf403f5abf6e3f7b,0x3f29bf063ebdbe51
.quad 0xbf253eedbe843d23,0x3f43bf633f77bf80,0xbf07bd6f3f1fbf76,0x3f5abf803f48be90,0xbecbbf103f80bf02,0x3f6bbf54bd0a3f5d,0xbe84bf683f113f37,0x3f77bed7bf533f33,0xbde8bf7fbea53f5a,0x3f7e3ddbbf72bf06,0x3d0abf4cbf74be99,0x3f803f1abe9cbf74,0x3e38bec0bf50bf80,0x3f7c3f6d3f153d6f,0x3ea53e20bc7bbe3f,0x3f723f7d3f803f7c
.quad 0x3f213f4d3f6c3f7d,0x3f473f1a3ec73e1c,0xbf2dbdd53f023f6c,0x3f3d3f7f3f5c3ec7,0xbf54bf68bdd53f4d,0xbf103ed83f7f3f1a,0x3edebf54bf2d3f21,0xbf67bf103f3d3f47,0x3f753d62bf7b3ed8,0x3e98bf803e423f68,0xbe1c3f63bf673e42,0x3f7dbeefbede3f7b,0xbf803f5bbeefbd62,0xbbc93f05bf633f80,0xbe10bbc93e1cbe98,0xbf7d3f80bf7d3f75
.quad 0x3f75bf5c3f36bf05,0xbe923f02bf343f5b,0x3ed8bf613f7dbf36,0x3f68bef4be103f34,0xbf56bd303f61bf5c,0x3f0dbf803ef43f02,0xbf2b3f563ed8bf75,0xbf3fbf0d3f683e92,0x3f243f67be4ebf80,0xbf453ede3f7b3d30,0x3f5b3dbcbf3fbf7b,0x3f053f7f3f2bbe4e,0xbec7bf4fbf7fbf67,0x3f6c3f173dbcbede,0xbf78bf6cbf5bbf45,0xbe7fbec7bf05bf24
.quad 0xbe98bd623e423ed8,0x3f753f803f7b3f68,0x3e1cbeefbf67bf7b,0xbf7dbf63bede3e42,0xbbc93f5b3f633d62,0x3f803f05beefbf80,0xbe10bf80be1c3f75,0xbf7dbbc93f7d3e98,0x3e923f5cbf34bf05,0x3f75bf02bf363f5b,0xbed8bef43f7dbf34,0xbf683f61be10bf36,0x3f0dbd30bef43f5c,0x3f56bf803f61bf02,0xbf2b3f0dbed83e92,0xbf3f3f56bf683f75
.quad 0x3f45bf673f7bbf80,0x3f24bede3e4e3d30,0xbf5b3f7fbf3f3e4e,0xbf05bdbc3f2bbf7b,0x3f6cbf4fbdbc3f67,0x3ec73f17bf7f3ede,0xbf783ec73f5bbf24,0xbe7fbf6c3f053f45,0x3f7f3e10bf6dbf17,0x3dd53f7d3ec1bf4f,0xbf80bf213e7f3f6d,0x3d30bf47bf78bec1,0x3f7b3f713f213e10,0xbe423eaf3f473f7d,0xbf72bf7bbf80bf7f,0x3eaa3e423d30bdd5
.quad 0xbf75bf5cbf36bf05,0x3e923f023f343f5b,0x3ed83f613f7d3f36,0x3f683ef4be10bf34,0x3f56bd30bf61bf5c,0xbf0dbf80bef43f02,0xbf2bbf563ed83f75,0xbf3f3f0d3f68be92,0xbf243f673e4ebf80,0x3f453edebf7b3d30,0x3f5bbdbcbf3f3f7b,0x3f05bf7f3f2b3e4e,0x3ec7bf4f3f7fbf67,0xbf6c3f17bdbcbede,0xbf783f6cbf5b3f45,0xbe7f3ec7bf053f24
.quad 0xbdd5be103ec1bf17,0x3f7fbf7d3f6dbf4f,0x3f80bf473e7f3ec1,0xbd303f21bf783f6d,0xbe423f71bf47be10,0xbf7b3eaf3f21bf7d,0xbf72be423f80bdd5,0x3eaabf7bbd303f7f,0x3eefbf3fbf543eaf,0x3f633f2bbf10bf71,0x3f4f3f753eaabf10,0xbf173e983f723f54,0xbf34be733e983f3f,0xbf36bf79bf75bf2b,0xbf1abf36bf4fbf63,0x3f4d3f343f173eef
.quad 0xbf45bf67bf7bbf80,0xbf24bedebe4e3d30,0xbf5bbf7fbf3fbe4e,0xbf053dbc3f2b3f7b,0xbf6cbf4f3dbc3f67,0xbec73f173f7f3ede,0xbf78bec73f5b3f24,0xbe7f3f6c3f05bf45,0xbf7f3e103f6dbf17,0xbdd53f7dbec1bf4f,0xbf803f213e7fbf6d,0x3d303f47bf783ec1,0xbf7b3f71bf213e10,0x3e423eafbf473f7d,0xbf723f7bbf803f7f,0x3eaabe423d303dd5
.quad 0xbf633f3fbf103eaf,0x3eefbf2b3f54bf71,0xbf4f3e983eaabf54,0x3f17bf753f72bf10,0xbf36be733f75bf3f,0x3f34bf793e983f2b,0xbf1abf343f4f3eef,0x3f4dbf36bf173f63,0xbef4bf783bc93f79,0x3f61be7fbf80be73,0xbeafbf75bf4d3bc9,0x3f713e92bf1abf80,0xbe4ebf2dbf75bf78,0x3f7b3f3d3e92be7f,0xbd62be4ebeafbef4,0x3f803f7b3f713f61
.quad 0x3f0f3f423f683f7c,0x3f543f273ed93e2c,0xbf3dbe2c3ef33f6a,0x3f2d3f7c3f613ece,0xbf46bf6fbe133f4a,0xbf223eba3f7d3f1d,0x3f03bf4abf343f1e,0xbf5cbf1d3f363f49,0x3f6d3df4bf7d3ed1,0x3ec2bf7e3e193f6a,0xbe763f6abf623e32,0x3f79bed1bef03f7c,0xbf7f3f52bedcbd90,0xbdc23f13bf673f7f,0xbd56bd903e45be9f,0xbf803f7fbf7b3f73
.quad 0x3f7bbf643f3dbf08,0xbe4b3ee8bf2d3f59,0x3eaebf593f7fbf39,0x3f71bf08bdcf3f31,0xbf613cb03f5cbf5e,0x3ef3bf803f033efe,0xbf193f5e3ec5bf77,0xbf4dbefe3f6c3e8a,0x3f343f5fbe76bf80,0xbf363efb3f793ce2,0x3f4e3ce2bf45bf7a,0x3f183f803f23be5d,0xbef0bf58bf80bf65,0x3f623f0a3d56bee5,0xbf71bf65bf55bf42,0xbeabbee5bf0ebf27
.quad 0xbef0be5d3d563ea2,0x3f623f7a3f803f73,0x3eabbea2bf55bf7f,0xbf71bf73bf0e3d9d,0xbe453f423f713e2c,0x3f7b3f27beaebf7c,0x3d3cbf7cbe933f6a,0xbf80be2c3f753ece,0x3dcf3f6fbf19bf1d,0x3f7fbebabf4d3f4a,0xbe7cbf1d3f80bf1e,0xbf783f4abb49bf49,0x3ec53df4bf183f6a,0x3f6cbf7e3f4ebed1,0xbf043ed1be963e32,0xbf5b3f6abf753f7c
.quad 0x3f23bf523f71bf7f,0x3f45bf133eabbd90,0xbf3e3f7fbf543e9f,0xbf2b3d903f0fbf73,0x3f55bf643d3c3f59,0x3f0e3ee8bf803f08,0xbf683f083f46bf39,0xbed9bf593f223f31,0x3f75bcb0bf78befe,0x3e933f803e7cbf5e,0xbf7dbefe3ec23f77,0xbe13bf5ebf6dbe8a,0x3f803f5f3f043ce2,0xbb493efb3f5b3f80,0xbf7dbf80bf7fbf7a,0x3e193ce2bdc2be5d
.quad 0xbf80bf77bf5bbf30,0x3b493e8a3f043f3a,0x3e193f3a3f7f3f58,0x3f7d3f303dc2bf0a,0x3f753e5dbf3ebf73,0xbe96bf7abf2b3ea2,0xbedcbf733e4b3f7f,0xbf673ea23f7bbd9d,0xbf543f423ed9bf7c,0x3f0f3f27bf68be2c,0x3f2d3e2cbf613f6a,0x3f3dbf7c3ef33ece,0x3f22bf6f3f7dbf4a,0xbf463eba3e13bf1d,0xbf5c3f4abf363f1e,0xbf033f1dbf343f49
.quad 0xbec23df43e19bed1,0x3f6dbf7e3f7dbf6a,0x3f79bf6a3ef03e32,0x3e763ed1bf623f7c,0x3dc23f52bf673d90,0xbf7f3f133edcbf7f,0xbf803d903f7bbe9f,0x3d56bf7f3e453f73,0x3e4bbf64bf2d3f08,0x3f7b3ee8bf3dbf59,0x3f713f593dcfbf39,0xbeae3f083f7f3f31,0xbef33cb03f033f5e,0xbf61bf80bf5cbefe,0xbf4dbf5ebf6cbf77,0x3f193efe3ec53e8a
.quad 0xbef3bf31bf5cbf77,0xbf61bf39bf03be87,0xbf19bf77bf6cbefb,0xbf4dbe873ec53f5f,0xbf36bf77be763f3a,0xbf343e8a3f793f30,0xbf4ebf303f233f58,0xbf183f3a3f45bf0a,0xbf62be5d3f80bea2,0xbef03f7abd56bf73,0xbf713ea23f0ebf7f,0xbeab3f73bf553d9d,0xbf7b3f42beaebe2c,0xbe453f27bf713f7c,0xbf803f7cbf753f6a,0xbd3c3e2cbe933ece
.quad 0xbf7f3f6fbf4d3f1d,0x3dcfbeba3f19bf4a,0xbf783f1d3b49bf1e,0x3e7cbf4a3f80bf49,0xbf6c3df43f4ebf6a,0x3ec5bf7e3f183ed1,0xbf5bbed13f753e32,0x3f04bf6abe963f7c,0xbf45bf523eab3f7f,0x3f23bf13bf713d90,0xbf2bbf7fbf0f3e9f,0x3f3ebd90bf54bf73,0xbf0ebf64bf80bf59,0x3f553ee8bd3cbf08,0xbed9bf08bf22bf39,0x3f683f593f463f31
.quad 0x3ef73f373f633f7c,0x3f603f333eec3e3b,0xbf4cbe6d3ee13f69,0x3f1b3f793f663ed5,0xbf37bf74be3b3f48,0xbf333e9b3f7c3f20,0x3f16bf40bf3c3f1b,0xbf4fbf2a3f2e3f4c,0x3f633e3bbf7e3eca,0x3eecbf7c3de23f6b,0xbea73f70bf5d3e23,0x3f72beb2bf013f7d,0xbf7c3f48becabdb0,0xbe3b3f20bf6b3f7f,0x3d17be0a3e6dbea7,0xbf803f7ebf793f72
.quad 0x3f7ebf6b3f44bf0c,0xbde23ecabf253f57,0x3e82bf4f3f80bf3c,0x3f78bf16bd7b3f2e,0xbf6b3db03f57bf60,0x3ecabf7f3f0c3ef7,0xbf063f663eb2bf78,0xbf5abee13f703e82,0x3f443f57be8fbf80,0xbf253f0c3f763c49,0x3f40bd17bf4cbf79,0x3f2a3f803f1bbe6d,0xbf0cbf60bf80bf63,0x3f573ef73c49beec,0xbf69bf5dbf4fbf40,0xbed5bf01bf16bf2a
.quad 0xbf20bebebdb03e54,0x3f483f6e3f7f3f7a,0x3f01be23bf40bf80,0xbf5dbf7dbf2abd17,0xbebe3f253f7a3e8f,0x3f6e3f44be54bf76,0x3e6dbf72bed53f5d,0xbf79bea73f693f01,0xbdb03f7abef7bf33,0x3f7fbe54bf603f37,0xbd7bbf3c3f7ebf06,0xbf803f2e3e0abf5a,0x3e543e8fbf333f74,0x3f7abf763f37be9b,0xbeb23e82be233d7b,0xbf703f78bf7d3f80
.quad 0x3ef7bf373f63bf7c,0x3f60bf333eecbe3b,0xbf1b3f79bf663ed5,0xbf4c3e6d3ee1bf69,0x3f37bf743e3b3f48,0x3f333e9bbf7c3f20,0xbf4f3f2a3f2ebf4c,0xbf16bf403f3c3f1b,0x3f63be3bbf7ebeca,0x3eec3f7c3de2bf6b,0xbf72beb23f013f7d,0xbea7bf70bf5dbe23,0x3f7c3f483ecabdb0,0x3e3b3f203f6b3f7f,0xbf80bf7ebf79bf72,0xbd17be0abe6dbea7
.quad 0xbf76bf80bf74bf53,0xbe8f3c493e9b3f11,0xbe0a3f063f723f70,0x3f7e3f5a3ea7beb2,0x3f803eecbf11bf7e,0xbc49bf63bf533de2,0xbe23bf80bd173f7e,0xbf7d3d7b3f803e0a,0xbf743f113f20bf6e,0x3e9b3f53bf48bebe,0x3ee13ed5bf783f4f,0x3f66bf693e823f16,0x3f53bf7e3f6ebf25,0xbf113de23ebebf44,0xbf2e3f1bbf063ee1,0xbf3c3f4cbf5a3f66
.quad 0xbf203ebebdb0be54,0x3f48bf6e3f7fbf7a,0x3f5dbf7d3f2abd17,0x3f013e23bf403f80,0x3ebe3f25bf7a3e8f,0xbf6e3f443e54bf76,0xbf793ea73f69bf01,0xbe6dbf723ed53f5d,0xbdb0bf7abef73f33,0x3f7f3e54bf60bf37,0x3f803f2ebe0abf5a,0xbd7b3f3c3f7e3f06,0xbe543e8f3f333f74,0xbf7abf76bf37be9b,0xbf70bf78bf7dbf80,0x3eb23e823e233d7b
.quad 0xbde2becabf25bf57,0xbf7ebf6bbf44bf0c,0xbe82bf4fbf80bf3c,0xbf78bf163d7b3f2e,0xbecabf7fbf0c3ef7,0xbf6bbdb03f573f60,0xbf06bf663eb23f78,0xbf5a3ee13f70be82,0xbf25bf0c3f76bc49,0xbf443f573e8fbf80,0xbf40bd173f4cbf79,0xbf2a3f80bf1bbe6d,0xbf573ef7bc49beec,0xbf0c3f60bf803f63,0xbf693f5dbf4f3f40,0xbed53f01bf163f2a
.quad 0xbf763f80bf743f53,0xbe8fbc493e9bbf11,0xbf7e3f5abea7beb2,0xbe0abf063f72bf70,0xbf803eec3f11bf7e,0x3c49bf633f533de2,0xbf7dbd7b3f80be0a,0x3e23bf803d173f7e,0xbf74bf113f203f6e,0x3e9bbf53bf483ebe,0xbf66bf69be823f16,0x3ee1bed5bf78bf4f,0xbf53bf7ebf6ebf25,0x3f113de2bebebf44,0xbf3cbf4cbf5abf66,0x3f2e3f1b3f063ee1
.quad 0x3ece3f2b3f5e3f7b,0x3f6a3f3e3efe3e4b,0xbf59be963ece3f67,0x3f083f753f6a3edc,0xbf27bf79be633f45,0xbf423e763f7a3f23,0x3f28bf34bf423f18,0xbf41bf363f273f4e,0x3f583e7cbf7f3ec2,0x3f0abf783d903f6d,0xbed13f75bf583e13,0x3f6abe93bf0a3f7d,0xbf773f3dbeb7bdcf,0xbe8a3f2dbf6f3f7f,0x3e00be4b3e8abeae,0xbf7e3f7bbf773f71
.quad 0x3f80bf713f4abf0f,0xbcb03eabbf1d3f54,0x3e2cbf453f80bf3e,0x3f7cbf23bcb03f2b,0xbf733e193f51bf62,0x3e9fbf7d3f143ef0,0xbee53f6d3e9fbf79,0xbf65bec23f733e76,0x3f523f4dbea2bf80,0xbf133f193f73bb49,0x3f30bdcfbf52bf78,0x3f3a3f7f3f13be7c,0xbf1ebf68bf80bf61,0x3f493ed9bce2bef3,0xbf5ebf54bf49bf3d,0xbefebf0fbf1ebf2d
.quad 0xbf42bf04be633dc2,0x3f273f5b3f7a3f7f,0x3f283b49bf27bf7d,0xbf41bf80bf42be19,0xbf0a3f033f7f3ec5,0x3f583f5cbd90bf6c,0x3ed1bf61bf0a3f4d,0xbf6abef33f583f19,0xbe8a3f80beb7bf46,0x3f77bd3cbf6f3f22,0x3e00bf553f77bed9,0xbf7e3f0e3e8abf68,0x3cb03edcbf4a3f7b,0x3f80bf673f1dbe45,0xbe2c3dc2bcb0bd56,0xbf7c3f7fbf803f80
.quad 0x3e9fbf183f51bf75,0x3f73bf4e3f14be96,0xbee53f6cbf733f04,0xbf653ec53e9fbf5b,0x3f13bf7d3ea23f34,0x3f523e13bf733f36,0xbf303f463f13bf5c,0xbf3abf223f523f03,0x3f49beaebf80be93,0x3f1e3f71bce2bf75,0xbf5ebe453f1e3f80,0xbefebf7bbf49bd3c,0x3f6f3f2b3e87be4b,0x3eba3f3e3f773f7b,0xbf7abf75bf6fbf67,0xbe63be96bebabedc
.quad 0xbf58bf78bf7fbf6d,0xbf0abe7c3d903ec2,0xbed13e933f583f7d,0x3f6a3f753f0abe13,0x3f773f2dbeb7bf7f,0x3e8abf3dbf6fbdcf,0x3e00bf7bbe8a3f71,0xbf7ebe4b3f773eae,0xbf803eab3f4abf54,0x3cb03f71bf1dbf0f,0x3e2c3f23bf803f2b,0x3f7cbf453cb03f3e,0x3f73bf7d3f51bef0,0xbe9fbe193f14bf62,0xbee53ec2be9f3e76,0xbf653f6dbf733f79
.quad 0xbf523f19bea23b49,0x3f13bf4d3f73bf80,0x3f30bf7f3f52be7c,0x3f3abdcfbf133f78,0x3f1e3ed9bf803ef3,0xbf493f68bce2bf61,0xbf5e3f0f3f49bf2d,0xbefebf543f1e3f3d,0xbebabf80be873f55,0x3f6fbd56bf77bf0e,0x3f7a3ef0bebabf71,0x3e633f623f6f3eab,0x3d9d3f043f593f7f,0xbf7fbf5bbf08bdc2,0xbf7fbf80bf7fbf7d,0x3d90bb49bd9dbe19
.quad 0x3e8abd3cbeb7bf22,0xbf77bf80bf6fbf46,0x3e00bf0ebf77bf68,0xbf7ebf55be8a3ed9,0xbcb0bf67bf4a3e45,0xbf80bedc3f1d3f7b,0xbe2cbf7f3cb03f80,0xbf7c3dc23f803d56,0xbe9fbf4e3f513e96,0xbf733f183f14bf75,0xbee5bec53f73bf5b,0xbf653f6cbe9fbf04,0xbf133e133ea2bf36,0xbf523f7dbf733f34,0xbf303f22bf133f03,0xbf3a3f46bf523f5c
.quad 0xbf493f71bf803f75,0xbf1e3eaebce2be93,0xbf5e3f7bbf1ebd3c,0xbefebe453f49bf80,0xbf6f3f3e3e87bf7b,0xbebabf2b3f77be4b,0xbf7a3e963f6fbedc,0xbe63bf753eba3f67,0xbf7fbe763f593f45,0xbd9dbf79bf083f23,0xbf7fbf343d9d3f4e,0x3d90bf36bf7fbf18,0xbf7abf78bf41bec2,0x3e5dbe7cbf28bf6d,0xbf6fbf75bf7abf7d,0x3eb73e933e5d3e13
.quad 0x3ea43f1f3f593f7a,0x3f733f493f083e5a,0xbf64beb53ebb3f65,0x3ee93f6f3f6e3ee3,0xbf15bf7cbe863f43,0xbf503e353f773f26,0x3f38bf28bf493f15,0xbf32bf413f1f3f50,0x3f4b3e9ebf803ebb,0x3f1cbf743cfb3f6e,0xbefa3f79bf523e04,0x3f60be66bf123f7e,0xbf6f3f32bea4bdee,0xbeb53f38bf733f7e,0x3e5abe863e9ebeb5,0xbf7a3f77bf743f6f
.quad 0x3f7fbf763f50bf12,0x3d8a3e8cbf153f52,0x3da3bf3a3f80bf41,0x3f7fbf2f3c973f28,0xbf793e5a3f4bbf64,0x3e66bf7a3f1c3ee9,0xbebb3f733e8cbf79,0xbf6ebea43f763e66,0x3f5e3f43beb5bf80,0xbeff3f263f6fbc97,0x3f1fbe29bf57bf77,0x3f493f7c3f0abe86,0xbf2fbf6ebf7fbf60,0x3f3a3ebbbd8abefa,0xbf52bf4bbf43bf3a,0xbf12bf1cbf26bf2f
.quad 0xbf5ebf26beb5bc97,0x3eff3f433f6f3f80,0x3f493e29bf0abf77,0xbf1fbf7cbf57be86,0xbf2f3ebb3f7f3efa,0x3f3a3f6e3d8abf60,0x3f12bf4bbf263f3a,0xbf52bf1c3f433f2f,0xbee33f7ebe66bf57,0x3f653deebf793f0a,0x3e9ebf693f6bbea4,0xbf743ed23ecdbf73,0xbe293f12bf5e3f7f,0x3f7cbf523effbda3,0x3c97bd8a3deebe29,0xbf803f7fbf7e3f7c
.quad 0x3e04bee93f3abf6b,0x3f7ebf643f2fbecd,0xbe8c3f59bf7c3f1c,0xbf763f083e35bf4b,0x3ed2bf803ee33f1f,0x3f69bc97bf653f49,0xbf0a3f5e3ee9bf69,0xbf57beff3f643ed2,0x3f28befabf7cbe35,0x3f413f60be29bf7c,0xbf43bcfb3f383f7f,0xbf26bf80bf323d8a,0x3f593f0a3e04be9e,0x3f083f573f7e3f74,0xbf6bbf65bf60bf59,0xbecdbee3befabf08
.quad 0xbf28bf60bf7cbf7c,0xbf41befabe293e35,0xbf263cfb3f323f7f,0x3f433f803f383d8a,0x3f593f57be04bf74,0x3f08bf0abf7ebe9e,0x3ecdbf65befa3f59,0xbf6bbee33f603f08,0xbf773da33f69bf32,0xbe863f7fbed2bf38,0xbdee3f50bf7a3eff,0x3f7ebf15be5a3f5e,0x3f80bf6b3f28be8c,0xbcfbbecd3f41bf76,0xbe353e04bda33cfb,0xbf7c3f7ebf7f3f80
.quad 0xbf733f49bf083e5a,0x3ea4bf1f3f59bf7a,0x3ee9bf6f3f6ebee3,0x3f64beb5bebb3f65,0x3f503e35bf773f26,0xbf153f7cbe86bf43,0xbf323f413f1fbf50,0xbf38bf283f493f15,0xbf1cbf74bcfb3f6e,0x3f4bbe9ebf80bebb,0x3f603e66bf12bf7e,0x3efa3f793f523e04,0x3eb53f383f733f7e,0xbf6fbf32bea43dee,0xbf7abf77bf74bf6f,0xbe5abe86be9ebeb5
.quad 0x3f1c3e9ebcfbbebb,0xbf4bbf74bf80bf6e,0x3efabe66bf52bf7e,0xbf60bf79bf123e04,0x3eb5bf32bf73bdee,0xbf6fbf383ea43f7e,0x3e5abf77be9e3f6f,0xbf7abe863f743eb5,0x3d8abf763f153f12,0xbf7f3e8c3f50bf52,0xbda3bf2f3f80bf28,0xbf7f3f3a3c97bf41,0xbe66be5a3f1cbf64,0xbf793f7abf4b3ee9,0xbebb3ea4be8c3e66,0xbf6e3f73bf763f79
.quad 0xbeff3f43bf6f3f80,0xbf5e3f26beb53c97,0xbf1f3f7cbf573e86,0xbf493e293f0abf77,0xbf3a3f6ebd8abf60,0xbf2fbebb3f7fbefa,0xbf523f1c3f43bf2f,0xbf12bf4b3f263f3a,0xbf653dee3f793f0a,0xbee3bf7ebe663f57,0xbf74bed23ecd3f73,0xbe9ebf69bf6bbea4,0xbf7cbf52beffbda3,0xbe29bf12bf5ebf7f,0xbf80bf7fbf7ebf7c,0xbc97bd8abdeebe29
.quad 0x3e703f113f543f79,0x3f793f533f103e6a,0xbf6dbed43ea83f64,0x3ec03f693f723eea,0xbf02bf7ebe993f40,0xbf5d3de83f743f29,0x3f47bf1cbf4f3f11,0xbf21bf4b3f173f53,0x3f3c3ebdbf803eb4,0x3f2ebf6ebc173f70,0xbf103f7dbf4c3de8,0x3f54be26bf1a3f7e,0xbf663f25be90be07,0xbedf3f43bf763f7e,0x3e99bea53eb1bebd,0xbf743f72bf703f6e
.quad 0x3f7dbf7a3f56bf15,0x3e203e57bf0c3f50,0xbc17bf2f3f80bf43,0x3f80bf3b3d6f3f25,0xbf7e3e8d3f44bf66,0x3e0dbf763f243ee2,0xbe903f773e70bf7a,0xbf76be843f793e57,0x3f683f38bec8bf80,0xbed73f323f6cbd0a,0x3f0cbe6abf5dbf76,0x3f563f793f02be8d,0xbf3fbf74bf7fbf5e,0x3f2a3e9cbddbbf00,0xbf44bf40bf3cbf38,0xbf24bf29bf2ebf32
.quad 0xbf72bf43bef6be07,0x3ea83f253f613f7e,0x3f633ea5bed7bf6e,0xbeedbf72bf68bebd,0xbf4f3e573f7b3f15,0x3f173f7a3e51bf50,0x3f37bf2fbf3f3f25,0xbf33bf3b3f2a3f43,0xbf1a3f76bdb6bf66,0x3f4c3e8dbf7f3ee2,0x3ef6bf773f5abe57,0xbf613e843f06bf7a,0xbeb13f32bf6d3f80,0x3f70bf383ec03d0a,0x3e51be6a3e81be8d,0xbf7b3f79bf783f76
.quad 0xbd6fbe9c3f21bf5e,0x3f80bf743f47bf00,0xbdb63f40bf803f32,0xbf7f3f293d23bf38,0x3e70bf7c3f103f07,0x3f79be38bf543f5a,0xbec03f703ea8bf74,0xbf6dbeb43f723e9c,0x3f02bf1fbf74bd84,0x3f5d3f48be99bf7f,0xbf213e073f4f3f7c,0xbf47bf7ebf173e38,0x3f3c3ecbbc17bed4,0x3f2e3f6b3f803f69,0xbf54bf50bf4cbf48,0xbf10bf15bf1abf1f
.quad 0xbed7bf38bf6cbf80,0xbf68bf32bec8bd0a,0xbf56be6a3f023f76,0x3f0c3f793f5d3e8d,0x3f2a3f743ddbbf5e,0x3f3fbe9cbf7fbf00,0x3f24bf40bf2e3f38,0xbf44bf293f3c3f32,0xbf5abe383f7cbf07,0xbf063f7cbe3fbf5a,0xbec83f70bf663e9c,0x3f6cbeb4bedf3f74,0x3f78bf483eedbd84,0x3e81bf1f3f63bf7f,0x3ddbbe073e20be38,0xbf7f3f7ebf7d3f7c
.quad 0xbf803f6bbf373ed4,0x3d23becb3f33bf69,0x3e3fbf503f7ebf1f,0x3f7cbf15be0d3f48,0x3f72bda9bf613f4b,0xbea83f7fbef6bf1c,0xbeed3f663ed7bf6b,0xbf63bee23f683ecb,0xbf4fbf573e513f7d,0x3f17bf0bbf7bbe26,0x3f33bd0abf3fbf7f,0x3f373f803f2abda9,0x3f1a3f603f7f3f72,0xbf4cbef8bdb63ea5,0xbf61bf5ebf5abf57,0xbef6bf00bf06bf0b
.quad 0x3f5d3f1f3e99bd84,0xbf02bf48bf74bf7f,0x3f473e07bf17bf7c,0xbf21bf7ebf4fbe38,0x3f2ebecbbf80bed4,0xbf3cbf6bbc173f69,0x3f10bf50bf1a3f48,0xbf54bf153f4c3f1f,0x3edfbf7f3e903f4b,0xbf66bda93f76bf1c,0x3e99bf663f70becb,0xbf743ee23eb1bf6b,0x3e20bf0b3f56bf7d,0xbf7d3f57bf0c3e26,0x3c17bd0a3d6fbda9,0xbf803f80bf803f7f
.quad 0xbe0d3ef8bf443f72,0xbf7e3f60bf243ea5,0xbe903f5ebf793f0b,0xbf763f003e70bf57,0xbed73f80bec8bf2f,0xbf68bc7b3f6cbf3b,0xbf0c3f5a3f02bf60,0xbf56bf073f5d3ef8,0xbf2a3eea3f7f3e84,0xbf3fbf643ddb3f77,0xbf44bd843f2e3f80,0xbf24bf7fbf3cbc7b,0xbf5abf11be3f3e6a,0xbf06bf53bf7cbf79,0xbf6cbf69bf66bf64,0xbec8bed4bedfbeea
.quad 0x3f803f803f803f80,0,0x3dc93ef13f463f75,0x3f7f3f623f223e95,0xbf7bbf0e3e483f55,0x3e483f553f7b3f0e,0xbe95bf7fbef13f22,0xbf75bdc93f623f46,0x3f6dbec4bf6d3ec4,0xbec4bf6d3ec43f6d,0x3ef13f22bf753dc9,0x3f62bf46be953f7f,0xbf553f7bbf0ebe48,0x3f0e3e48bf553f7b,0xbf223e953dc9bef1,0xbf463f75bf7f3f62
.quad 0x3f35bf353f35bf35,0xbf353f35bf353f35,0x3f46bf753f7fbf62,0x3f22be95bdc93ef1,0xbf0ebe483f55bf7b,0x3f55bf7b3f0e3e48,0xbf623f463e95bf7f,0xbef1bf223f75bdc9,0x3ec43f6dbec4bf6d,0xbf6d3ec43f6dbec4,0x3f753dc9bf62bf46,0x3e953f7f3ef1bf22,0xbe48bf55bf7bbf0e,0x3f7b3f0ebe48bf55,0xbf7fbf62bf22be95,0xbdc9bef1bf46bf75
.quad 0x3f803f803f803f80,0,0xbf7fbf62bf22be95,0x3dc93ef13f463f75,0x3f7b3f0ebe48bf55,0xbe48bf55bf7bbf0e,0xbf75bdc93f623f46,0x3e953f7f3ef1bf22,0x3f6dbec4bf6d3ec4,0xbec4bf6d3ec43f6d,0xbf623f463e95bf7f,0x3ef13f22bf753dc9,0x3f55bf7b3f0e3e48,0xbf0ebe483f55bf7b,0xbf463f75bf7f3f62,0x3f22be95bdc93ef1
.quad 0x3f35bf353f35bf35,0xbf353f35bf353f35,0xbf223e953dc9bef1,0x3f46bf753f7fbf62,0x3f0e3e48bf553f7b,0xbf553f7bbf0ebe48,0xbef1bf223f75bdc9,0x3f62bf46be953f7f,0x3ec43f6dbec4bf6d,0xbf6d3ec43f6dbec4,0xbe95bf7fbef13f22,0x3f753dc9bf62bf46,0x3e483f553f7b3f0e,0xbf7bbf0e3e483f55,0xbdc9bef1bf46bf75,0x3f7f3f623f223e95
.quad 0x3f803f803f803f80,0,0xbdc9bef1bf46bf75,0xbf7fbf62bf22be95,0xbf7bbf0e3e483f55,0x3e483f553f7b3f0e,0x3e953f7f3ef1bf22,0x3f753dc9bf62bf46,0x3f6dbec4bf6d3ec4,0xbec4bf6d3ec43f6d,0xbef1bf223f75bdc9,0xbf623f463e95bf7f,0xbf553f7bbf0ebe48,0x3f0e3e48bf553f7b,0x3f22be95bdc93ef1,0x3f46bf753f7fbf62
.quad 0x3f35bf353f35bf35,0xbf353f35bf353f35,0xbf463f75bf7f3f62,0xbf223e953dc9bef1,0xbf0ebe483f55bf7b,0x3f55bf7b3f0e3e48,0x3f62bf46be953f7f,0x3ef13f22bf753dc9,0x3ec43f6dbec4bf6d,0xbf6d3ec43f6dbec4,0xbf75bdc93f623f46,0xbe95bf7fbef13f22,0xbe48bf55bf7bbf0e,0x3f7b3f0ebe48bf55,0x3f7f3f623f223e95,0x3dc93ef13f463f75
.quad 0x3f803f803f803f80,0,0x3f7f3f623f223e95,0xbdc9bef1bf46bf75,0x3f7b3f0ebe48bf55,0xbe48bf55bf7bbf0e,0x3f753dc9bf62bf46,0xbe95bf7fbef13f22,0x3f6dbec4bf6d3ec4,0xbec4bf6d3ec43f6d,0x3f62bf46be953f7f,0xbef1bf223f75bdc9,0x3f55bf7b3f0e3e48,0xbf0ebe483f55bf7b,0x3f46bf753f7fbf62,0xbf223e953dc9bef1
.quad 0x3f35bf353f35bf35,0xbf353f35bf353f35,0x3f22be95bdc93ef1,0xbf463f75bf7f3f62,0x3f0e3e48bf553f7b,0xbf553f7bbf0ebe48,0x3ef13f22bf753dc9,0xbf623f463e95bf7f,0x3ec43f6dbec4bf6d,0xbf6d3ec43f6dbec4,0x3e953f7f3ef1bf22,0xbf75bdc93f623f46,0x3e483f553f7b3f0e,0xbf7bbf0e3e483f55,0x3dc93ef13f463f75,0xbf7fbf62bf22be95
.quad 0x3f7f3f7f3f803f80,0x3dbc3d8a3d303c97,0x3bc93ed23f3f3f74,0x3f803f693f2b3e9e,0xbf7fbf1c3e1c3f52,0x3dd53f4b3f7d3f12,0xbe4ebf7cbf023f1f,0xbf7bbe293f5c3f49,0x3f75bea4bf713ebb,0xbe98bf733eaf3f6e,0x3ec73f2fbf723da3,0x3f6cbf3abeaa3f7f,0xbf613f77bf05be5a,0x3ef43e86bf5b3f7a,0xbf103e663e10befa,0xbf543f79bf7d3f60
.quad 0x3f45bf413f3dbf38,0xbf243f28bf2d3f32,0x3f36bf6f3f80bf64,0x3f34beb5bd623ee9,0xbf21be043f4fbf7c,0x3f47bf7e3f173e35,0xbf563f503e7fbf7e,0xbf0dbf153f78bdee,0x3eef3f65bed8bf6b,0xbf633ee33f68becd,0x3f6d3cfbbf67bf43,0x3ec13f803edebf26,0xbe92bf5ebf79bf0a,0x3f753effbe73bf57,0xbf7bbf59bf1abe8c,0xbe42bf08bf4dbf76
.quad 0x3f7b3f7c3f7d3f7e,0x3e423e293e103dee,0xbf7fbf73bf3dbecd,0xbdbc3ea43f2d3f6b,0x3f803f2fbd62bf43,0xbbc9bf3abf80bf26,0xbf7fbe863f4f3f57,0x3dd53f773f17bf0a,0x3f7bbe66bf783e8c,0xbe4ebf793e7f3f76,0xbf753f283ed8bf80,0x3e983f41bf68bc97,0x3f6cbf6f3ede3e9e,0xbec7beb53f67bf74,0xbf613f7ebf793f52,0x3ef4be04be733f12
.quad 0x3f54bf503f4dbf49,0xbf103f15bf1a3f1f,0xbf453ee3bd30bebb,0x3f24bf653f80bf6e,0x3f343cfbbf3f3f7f,0xbf363f80bf2bbda3,0xbf21beff3f7dbe5a,0x3f47bf5ebe1c3f7a,0x3f0d3f59bf02bf60,0xbf563f083f5cbefa,0xbeefbf7fbeaf3f38,0x3f63bd8abf71bf32,0x3ec13f693f723ee9,0xbf6dbed23eaa3f64,0xbe92bf1cbf5bbf7c,0x3f753f4b3f053e35
.quad 0x3f753f773f793f7a,0x3e923e863e733e5a,0x3e42be66bf1abf60,0xbf7bbf79bf4dbefa,0xbf7fbf41bd303f32,0xbdbc3f283f803f38,0x3bc93f6f3f2bbee9,0x3f803eb5bf3fbf64,0x3f7fbe04bf7d3e35,0xbdd5bf7e3e1c3f7c,0xbe4ebf503f5c3dee,0xbf7b3f153f02bf7e,0xbf753f65beafbecd,0x3e983ee3bf713f6b,0x3ec7bcfbbeaa3f26,0x3f6cbf803f72bf43
.quad 0x3f61bf5e3f5bbf57,0xbef43effbf053f0a,0xbf103f59bf7d3f76,0xbf543f08be10be8c,0xbf453d8a3f2dbf80,0x3f24bf7f3f3dbc97,0x3f36bf69bd623f74,0x3f343ed2bf803e9e,0x3f213f4bbf17bf52,0xbf473f1c3f4fbf12,0xbf563e293f783f1f,0xbf0dbf7cbe7f3f49,0xbeefbf73bf68bebb,0x3f633ea4bed8bf6e,0x3f6d3f3a3ede3da3,0x3ec13f2f3f673f7f
.quad 0x3f6d3f6f3f723f74,0x3ec13eb53eaa3e9e,0x3f753f7e3f5b3f12,0x3e92be04bf05bf52,0x3f7b3f503e10bf1f,0x3e42bf15bf7dbf49,0x3f7f3ee3bf2dbf6e,0x3dbcbf65bf3d3ebb,0x3f80bcfbbf803da3,0xbbc9bf803d623f7f,0x3f7fbeffbf173f7a,0xbdd5bf5e3f4f3e5a,0x3f7bbf593e7f3efa,0xbe4ebf083f78bf60,0x3f75bf7f3f68bf32,0xbe98bd8a3ed8bf38
.quad 0x3f6cbf693f67bf64,0xbec73ed2bede3ee9,0x3f61bf1c3e733e35,0xbef43f4bbf793f7c,0x3f54be29bf1a3f7e,0xbf103f7cbf4d3dee,0x3f453ea4bf803ecd,0xbf243f73bd30bf6b,0x3f343f3abf2bbf43,0xbf363f2f3f3fbf26,0x3f213f773e1cbf57,0xbf473e863f7d3f0a,0x3f0d3f793f5c3e8c,0xbf56be663f023f76,0x3eef3f413f713f80,0xbf63bf28beaf3c97
.quad 0x3f7c3f7e3f7f3f80,0x3e3b3e0a3db03d17,0xbdb03eb23f373f72,0x3f7f3f703f333ea7,0xbf80bf2a3de23f4f,0x3c493f403f7e3f16,0xbde2bf79bf0c3f1b,0xbf7ebe6d3f573f4c,0x3f7abe82bf743eb2,0xbe54bf783e9b3f70,0x3e9b3f3cbf6e3d7b,0x3f74bf2ebebe3f80,0xbf6b3f72bef7be6d,0x3eca3ea7bf603f79,0xbef73e233e3bbf01,0xbf603f7dbf7c3f5d
.quad 0x3f53bf4c3f44bf3c,0xbf113f1bbf253f2e,0x3f25bf693f80bf66,0x3f44bed5bc493ee1,0xbf33bd7b3f48bf7d,0x3f37bf803f203e23,0xbf483f5a3e54bf7e,0xbf20bf063f7abe0a,0x3f0c3f5dbeecbf69,0xbf573f013f63bed5,0x3f63bd17bf6bbf40,0x3eec3f803ecabf2a,0xbebebf66bf76bf06,0x3f6e3ee1be8fbf5a,0xbf76bf4fbf11be82,0xbe8fbf16bf53bf78
.quad 0x3f6e3f723f763f79,0x3ebe3ea73e8f3e6d,0xbf76bf7dbf53bf01,0xbe8f3e233f113f5d,0x3f7c3f4c3db0bf2e,0x3e3bbf1bbf7fbf3c,0xbf7fbed53f373f66,0xbdb03f693f33bee1,0x3f80bd7bbf7e3e23,0xbc49bf803de23f7d,0xbf7e3f063f0cbf7e,0x3de23f5abf57be0a,0x3f7abf5d3e9b3ed5,0xbe54bf013f74bf69,0xbf743f80bf6e3f40,0x3e9b3d17bebe3f2a
.quad 0x3f6bbf663f60bf5a,0xbeca3ee1bef73f06,0xbf603f16be3bbe82,0x3ef7bf4f3f7cbf78,0x3f53be0abf253f80,0xbf113f7ebf443d17,0xbf44beb23f80bea7,0x3f25bf70bc493f72,0x3f333f40bf20bf4f,0xbf373f2a3f48bf16,0xbf20bf79be543f4c,0x3f48be6dbf7abf1b,0x3f0c3f783f633eb2,0xbf57be823eec3f70,0xbeecbf3cbf6bbf80,0x3f633f2e3eca3d7b
.quad 0x3f573f5d3f633f69,0x3f0c3f013eec3ed5,0x3eec3d17becabf40,0xbf63bf80bf6bbf2a,0xbf6ebf66be8f3f06,0xbebe3ee13f763f5a,0xbe8f3f4f3f53be82,0x3f763f16bf11bf78,0x3f7c3e0abf7fbd17,0x3e3bbf7ebdb03f80,0x3db0bf703f373ea7,0xbf7f3eb23f33bf72,0xbf803f40bde2bf16,0x3c493f2abf7e3f4f,0x3de23e6dbf0c3f4c,0x3f7ebf793f57bf1b
.quad 0x3f7abf783f74bf70,0xbe543e82be9b3eb2,0xbe9b3f2ebf6e3f80,0xbf743f3cbebebd7b,0xbf6b3ea73ef7bf79,0x3ecabf723f60be6d,0x3ef7bf7d3e3b3f5d,0x3f603e23bf7c3f01,0x3f533f1bbf44bf2e,0xbf113f4c3f25bf3c,0xbf253ed53f803ee1,0xbf44bf69bc493f66,0xbf33bf80bf48be23,0x3f373d7bbf20bf7d,0x3f483f063e54be0a,0x3f203f5a3f7a3f7e
.quad 0x3f373f403f483f4f,0x3f333f2a3f203f16,0x3f483f793f7a3f4c,0x3f203e6dbe54bf1b,0x3f573f783eecbeb2,0x3f0cbe82bf63bf70,0x3f633f3cbecabf80,0x3eecbf2ebf6b3d7b,0x3f6e3ea7bf76be6d,0x3ebebf72be8f3f79,0x3f76be23bf533f5d,0x3e8fbf7d3f113f01,0x3f7cbf1bbdb03f3c,0x3e3bbf4c3f7fbf2e,0x3f7fbf693f37bee1,0x3db0bed53f33bf66
.quad 0x3f80bf803f7ebf7d,0xbc493d7bbde23e23,0x3f7ebf5a3f0cbe0a,0xbde23f06bf573f7e,0x3f7abf01be9b3f69,0xbe543f5dbf743ed5,0x3f74bd17bf6e3f2a,0xbe9b3f80bebebf40,0x3f6b3ee1bf60bf06,0xbeca3f663ef7bf5a,0x3f603f4fbe3bbf78,0xbef73f163f7c3e82,0x3f533f7e3f25bd17,0xbf113e0a3f443f80,0x3f443f703f803f72,0xbf25beb2bc493ea7
.quad 0x3f763f7b3f7e3f80,0x3e8c3e4e3e043d62,0xbe353e923f2f3f71,0x3f7c3f753f3a3eaf,0xbf7fbf363d8a3f4d,0xbda33f343f7f3f1a,0xbc97bf75bf153f17,0xbf80be983f503f4f,0x3f7ebe42bf773eaa,0xbdeebf7b3e863f72,0x3e5a3f47bf693d30,0x3f7abf21bed23f80,0xbf743f6cbee3be7f,0x3e9e3ec7bf653f78,0xbecd3dbc3e66bf05,0xbf6b3f7fbf793f5b
.quad 0x3f60bf563f4bbf3f,0xbefa3f0dbf1c3f2b,0x3f12bf613f80bf68,0x3f52bef43cfb3ed8,0xbf433bc93f41bf7d,0x3f26bf803f283e10,0xbf383f633e29bf7d,0xbf32beef3f7cbe1c,0x3f1f3f54beffbf67,0xbf493f103f5ebede,0x3f57bdd5bf6fbf3d,0x3f0a3f7f3eb5bf2d,0xbee9bf6dbf73bf02,0x3f643ec1bea4bf5c,0xbf6ebf45bf08be73,0xbebbbf24bf59bf79
.quad 0x3f573f613f693f71,0x3f0a3ef43ed23eaf,0xbf64bf80bf65bf1a,0xbee9bbc93ee33f4d,0x3f6e3f633e66bf17,0x3ebbbeefbf79bf4f,0xbf76bf103f1c3f72,0xbe8c3f543f4bbeaa,0x3f7c3dd5bf803d30,0x3e35bf7fbcfb3f80,0xbf7f3ec13f28bf78,0xbda33f6dbf41be7f,0x3f80bf453e293f05,0xbc97bf243f7cbf5b,0xbf7e3f7bbf5e3f2b,0x3dee3e4ebeff3f3f
.quad 0x3f7abf753f6fbf68,0xbe5a3e92beb53ed8,0xbf743f36bea4be10,0x3e9ebf343f73bf7d,0x3f6bbe98bf083f7d,0xbecd3f75bf593e1c,0xbf60be423f7ebede,0x3efabf7b3e043f67,0x3f523f21bf3abf3d,0xbf123f473f2fbf2d,0xbf43bf6cbd8a3f5c,0x3f26bec7bf7fbf02,0x3f323f7f3f503e73,0xbf38bdbc3f153f79,0xbf1fbf56bf77bf80,0x3f493f0d3e86bd62
.quad 0x3f263f343f413f4d,0x3f433f363f283f1a,0x3f323e98be29bf17,0xbf38bf75bf7cbf4f,0xbf49bf7bbeff3eaa,0xbf1f3e423f5e3f72,0xbf0a3f213f6fbd30,0x3f573f47beb5bf80,0x3f643ec7bf73be7f,0x3ee9bf6cbea43f78,0x3ebbbf7f3f083f05,0xbf6e3dbc3f59bf5b,0xbf763f0d3e04bf3f,0xbe8c3f56bf7e3f2b,0xbe353ef4bf3a3f68,0x3f7cbf613f2fbed8
.quad 0x3f7fbf803f7fbf7d,0x3da3bbc9bd8a3e10,0xbc973eefbf503f7d,0xbf803f63bf153e1c,0xbf7e3f103e86bf67,0x3deebf543f77bede,0x3e5abf7f3ed23f3d,0x3f7abdd5bf693f2d,0x3f743ec1bf65bf02,0xbe9e3f6d3ee3bf5c,0xbecd3f243f793e73,0xbf6bbf453e663f79,0xbf60bf7bbf1c3d62,0x3efabe4ebf4bbf80,0x3f123e92bcfbbeaf,0x3f523f753f803f71
.quad 0x3ecd3eef3f083f17,0x3f6b3f633f593f4f,0x3efa3f543f7e3f72,0x3f603f103e04beaa,0x3f123f7f3f3abd30,0x3f523dd5bf2fbf80,0x3f263f6dbd8abf78,0x3f43bec1bf7fbe7f,0x3f383f24bf50bf05,0x3f32bf45bf153f5b,0x3f493e4ebf773f2b,0x3f1fbf7b3e863f3f,0x3f57be92bed23f68,0x3f0abf753f69bed8,0x3f64bf343ee3be10,0x3ee9bf363f65bf7d
.quad 0x3f6ebf753f79bf7d,0x3ebbbe983e66be1c,0x3f76bf7b3f4bbede,0x3e8c3e42bf1c3f67,0x3f7cbf473cfb3f3d,0x3e353f21bf803f2d,0x3f7fbec7bf413f5c,0x3da33f6cbf28bf02,0x3f803dbcbf7cbe73,0xbc973f7f3e29bf79,0x3f7e3f0dbeffbf80,0xbdee3f563f5ebd62,0x3f7a3f613eb5beaf,0xbe5a3ef43f6f3f71,0x3f743f803f733f4d,0xbe9e3bc93ea43f1a
.quad 0x3f6f3f773f7c3f7f,0x3eb83e893e2f3d97,0xbe893e603f273f6f,0x3f773f7a3f423eb8,0xbf7cbf423cc93f4a,0xbe2f3f273f803f1d,0x3d97bf6fbf1d3f13,0xbf7fbeb83f4a3f51,0x3f80bdfbbf7a3ea1,0xbcc9bf7e3e603f73,0x3dfb3f51bf653cc9,0x3f7ebf13bee63f80,0xbf7a3f65becfbe89,0x3e603ee6bf6a3f77,0xbea13cc93e89bf09,0xbf733f80bf773f58
.quad 0x3f6abf5f3f51bf42,0xbecf3efcbf133f27,0x3efcbf583f7fbf6a,0x3f5fbf093d973ecf,0xbf513d973f39bf7e,0x3f13bf7f3f313dfb,0xbf273f6a3dfbbf7c,0xbf42becf3f7ebe2f,0x3f313f4abf09bf65,0xbf393f1d3f58bee6,0x3f4abe2fbf73bf39,0x3f1d3f7c3ea1bf31,0xbf09bf73bf6fbefc,0x3f583ea1beb8bf5f,0xbf65bf39befcbe60,0xbee6bf31bf5fbf7a
.quad 0x3f393f4a3f583f65,0x3f313f1d3f093ee6,0xbf4abf7cbf73bf31,0xbf1dbe2f3ea13f39,0x3f583f733eb8befc,0x3f09bea1bf6fbf5f,0xbf65bf313efc3f7a,0xbee63f393f5fbe60,0x3f6f3e89bf7cbd97,0x3eb8bf77be2f3f7f,0xbf773e603f42bf6f,0xbe893f7abf27beb8,0x3f7cbf273cc93f1d,0x3e2fbf423f80bf4a,0xbf7f3f6fbf4a3f13,0xbd973eb8bf1d3f51
.quad 0x3f80bf7e3f7abf73,0xbcc93dfbbe603ea1,0xbf7e3f51bee6bcc9,0x3dfbbf133f65bf80,0x3f7abee6becf3f77,0xbe603f65bf6a3e89,0xbf73bcc93f77bf09,0x3ea1bf803e893f58,0x3f6a3efcbf51bf27,0xbecf3f5f3f13bf42,0xbf5fbf583d973f6a,0x3efcbf09bf7fbecf,0x3f513f7f3f393dfb,0xbf133d973f313f7e,0xbf42bf6abf7ebf7c,0x3f273ecf3dfbbe2f
.quad 0x3ecf3efc3f133f27,0x3f6a3f5f3f513f42,0x3f5f3f093d97becf,0xbefcbf58bf7fbf6a,0xbf13bf7fbf313dfb,0xbf51bd973f393f7e,0xbf423ecf3f7e3e2f,0x3f273f6abdfbbf7c,0x3f393f1dbf58bee6,0x3f31bf4abf093f65,0x3f1dbf7c3ea13f31,0xbf4abe2f3f73bf39,0xbf583ea13eb8bf5f,0xbf093f73bf6f3efc,0xbee63f31bf5f3f7a,0x3f65bf393efcbe60
.quad 0x3f6fbf773f7cbf7f,0x3eb8be893e2fbd97,0x3e893e60bf273f6f,0xbf773f7abf423eb8,0xbf7c3f423cc9bf4a,0xbe2fbf273f80bf1d,0xbd97bf6f3f1d3f13,0x3f7fbeb8bf4a3f51,0x3f803dfbbf7abea1,0xbcc93f7e3e60bf73,0xbdfb3f513f653cc9,0xbf7ebf133ee63f80,0xbf7abf65becf3e89,0x3e60bee6bf6abf77,0x3ea13cc9be89bf09,0x3f733f803f773f58
.quad 0x3cc93dfb3e603ea1,0x3f803f7e3f7a3f73,0x3dfb3f133f653f80,0x3f7e3f513ee6bcc9,0x3e603f653f6a3e89,0x3f7a3ee6becfbf77,0x3ea13f803e89bf58,0x3f73bcc9bf77bf09,0x3ecf3f5fbf13bf42,0x3f6abefcbf513f27,0x3efc3f09bf7f3ecf,0x3f5fbf58bd973f6a,0x3f133d97bf313f7e,0x3f51bf7f3f39bdfb,0x3f27becf3dfb3e2f,0x3f42bf6a3f7ebf7c
.quad 0x3f39bf4a3f58bf65,0x3f31bf1d3f09bee6,0x3f4abf7c3f73bf31,0x3f1dbe2fbea13f39,0x3f58bf733eb83efc,0x3f093ea1bf6f3f5f,0x3f65bf31befc3f7a,0x3ee63f39bf5fbe60,0x3f6fbe89bf7c3d97,0x3eb83f77be2fbf7f,0x3f773e60bf42bf6f,0x3e893f7a3f27beb8,0x3f7c3f273cc9bf1d,0x3e2f3f423f803f4a,0x3f7f3f6f3f4a3f13,0x3d973eb83f1d3f51
.quad 0x3f653f723f7a3f7f,0x3ee33eaa3e5a3dbc,0xbeb53e1c3f1f3f6d,0x3f6f3f7d3f493ec1,0xbf77bf4dbc973f47,0xbe863f1a3f803f21,0x3e29bf68bf263f10,0xbf7cbed83f433f54,0x3f7fbd62bf7c3e98,0x3d8abf803e353f75,0x3cfb3f5bbf603bc9,0x3f80bf05befa3f80,0xbf7e3f5cbebbbe92,0x3e043f02bf6e3f75,0xbe66bd303e9ebf0d,0xbf793f80bf743f56
.quad 0x3f73bf673f57bf45,0xbea43edebf0a3f24,0x3ed2bf4f3f7ebf6c,0x3f69bf173dee3ec7,0xbf5e3e103f32bf7f,0x3effbf7d3f383dd5,0xbf153f713da3bf7b,0xbf50beaf3f7fbe42,0x3f413f3fbf12bf63,0xbf283f2b3f52beef,0x3f3abe73bf76bf36,0x3f2f3f793e8cbf34,0xbf1cbf78bf6bbef4,0x3f4b3e7fbecdbf61,0xbf59bf2dbee9be4e,0xbf08bf3dbf64bf7b
.quad 0x3f153f2d3f433f56,0x3f503f3d3f263f0d,0xbf28bf72bf7cbf45,0xbf41beaa3e353f24,0x3f3a3f7d3efabec7,0x3f2fbe1cbf60bf6c,0xbf4bbf4d3ebb3f7f,0xbf1c3f1a3f6ebdd5,0x3f593ed8bf74be42,0x3f08bf68be9e3f7b,0xbf653d623f57bf63,0xbee33f80bf0abeef,0x3f6fbf05bdee3f34,0x3eb5bf5b3f7ebf36,0xbf773f5cbf323ef4,0xbe863f02bf383f61
.quad 0x3f7cbf803f7fbf7b,0x3e29bd30bda33e4e,0xbf7f3f67bf123dbc,0xbd8abede3f52bf7f,0x3f80bf17be8c3f6d,0xbcfb3f4fbf763ec1,0xbf7e3e103f6bbf21,0x3e04bf7d3ecd3f47,0x3f793eafbf64bf10,0xbe663f713ee9bf54,0xbf73bf3f3e5a3f75,0x3ea4bf2bbf7abe98,0x3f693f793f1f3bc9,0xbed23e733f493f80,0xbf5ebf78bf80bf75,0x3eff3e7fbc97be92
.quad 0x3e043e7f3ebb3ef4,0x3f7e3f783f6e3f61,0x3f793f3d3e9ebe4e,0xbe66bf2dbf74bf7b,0xbea4bf72bf57bdbc,0xbf73beaa3f0a3f7f,0xbf693e1c3f7e3ec1,0x3ed23f7d3deebf6d,0x3eff3f4dbf32bf21,0x3f5ebf1abf383f47,0x3f50bf683da33f54,0xbf15bed83f7fbf10,0xbf283d623f12bf75,0xbf413f80bf523e98,0xbf2f3f5bbf763f80,0x3f3abf053e8cbbc9
.quad 0x3f4bbf5c3f6bbf75,0x3f1cbf023ecdbe92,0x3f08bd30bee93f56,0xbf593f80bf643f0d,0xbf653f67be5abf24,0xbee3bede3f7abf45,0xbeb5bf4f3f493ec7,0x3f6fbf17bf1f3f6c,0x3f77be10bf80bdd5,0x3e863f7dbc97bf7f,0x3e293f713f43be42,0xbf7cbeaf3f263f7b,0xbf7fbf3fbe353eef,0xbd8abf2bbf7cbf63,0x3cfbbe73befabf34,0x3f803f793f603f36
.quad 0xbeb5be73bdee3bc9,0x3f6f3f793f7e3f80,0xbe863e7f3f323f75,0x3f773f783f383e92,0xbe293f2d3f7f3f0d,0x3f7c3f3dbda3bf56,0xbd8a3f723f12bf24,0x3f7f3eaabf52bf45,0x3cfb3f7dbe8cbf6c,0x3f80be1cbf763ec7,0x3e043f4dbf6b3dd5,0x3f7ebf1abecd3f7f,0x3e663ed8bf643f7b,0x3f79bf683ee93e42,0x3ea4bd62be5a3eef,0x3f73bf803f7abf63
.quad 0x3ed2bf053f1fbf36,0x3f69bf5b3f49bf34,0x3effbf5c3f80bf61,0x3f5ebf023c973ef4,0x3f15bf803f263e4e,0x3f50bd30bf433f7b,0x3f28bf67be353f7f,0x3f413edebf7c3dbc,0x3f3abf17bf603ec1,0x3f2f3f4fbefabf6d,0x3f4bbe10bf6ebf47,0x3f1c3f7d3ebbbf21,0x3f593eafbe9ebf54,0x3f083f713f743f10,0x3f653f3f3f0a3e98,0x3ee33f2b3f573f75
.quad 0x3f5a3f6b3f783f7e,0x3f063eca3e823de2,0xbee13db03f163f6b,0x3f663f7f3f4f3eca,0xbf70bf57bd7b3f44,0xbeb23f0c3f803f25,0x3e82bf60bf2e3f0c,0xbf78bef73f3c3f57,0x3f7d3c49bf7e3e8f,0x3e23bf803e0a3f76,0xbd7b3f63bf5abc49,0x3f80beecbf063f80,0xbf803f53bea7be9b,0x3d173f11bf723f74,0xbe0abde23eb2bf11,0xbf7e3f7ebf703f53
.quad 0x3f79bf6e3f5dbf48,0xbe6d3ebebf013f20,0x3ea7bf443f7dbf6e,0x3f72bf253e233ebe,0xbf693e543f2abf7f,0x3ed5bf7a3f403db0,0xbf013f763d17bf7a,0xbf5dbe8f3f80be54,0x3f4f3f33bf1bbf60,0xbf163f373f4cbef7,0x3f2abe9bbf79bf33,0x3f403f743e6dbf37,0xbf2ebf7cbf66beec,0x3f3c3e3bbee1bf63,0xbf4cbf20bed5be3b,0xbf1bbf48bf69bf7c
.quad 0x3ed53f0c3f2a3f44,0x3f693f573f403f25,0xbf01bf60bf80bf57,0xbf5dbef73d173f0c,0x3f163f803f1bbe8f,0x3f4f3c49bf4cbf76,0xbf2abf633e6d3f80,0xbf403eec3f793c49,0x3f3c3f11bf66be9b,0x3f2ebf53bee13f74,0xbf4cbde23f69bf53,0xbf1b3f7ebed5bf11,0x3f5abebebe823f48,0x3f06bf6e3f78bf20,0xbf663f44bf163ebe,0xbee13f25bf4f3f6e
.quad 0x3f70bf7a3f80bf7f,0x3eb2be543d7b3db0,0xbf783f76bf2e3e54,0xbe82be8f3f3cbf7a,0x3f7dbf37be0a3f60,0x3e233f33bf7e3ef7,0xbf803e9b3f5abf37,0xbd7bbf743f063f33,0x3f803e3bbf72beec,0xbd173f7c3ea7bf63,0xbf7ebf203eb23f7c,0x3e0abf48bf70be3b,0x3f793f6b3f01bde2,0xbe6d3eca3f5d3f7e,0xbf72bf7fbf7dbf6b,0x3ea73db0be23beca
.quad 0xbe23bc493e0a3e8f,0x3f7d3f803f7e3f76,0x3f803f633f063c49,0x3d7bbeecbf5abf80,0xbd17bf53bf72be9b,0xbf80bf113ea73f74,0xbf7ebde23f703f11,0x3e0a3f7e3eb2bf53,0x3e6d3f6ebf01bf48,0x3f79bebebf5d3f20,0x3f72bf44be233f6e,0xbea7bf253f7dbebe,0xbed5be543f40bf7f,0xbf693f7abf2a3db0,0xbf5d3f76bf803f7a,0x3f01be8f3d173e54
.quad 0x3f16bf333f4cbf60,0x3f4fbf373f1bbef7,0x3f40be9bbe6d3f33,0xbf2a3f74bf793f37,0xbf3c3f7cbee1beec,0xbf2ebe3b3f66bf63,0xbf1bbf203f693e3b,0x3f4cbf48bed53f7c,0x3f5abecabf783de2,0x3f063f6bbe82bf7e,0x3ee13f7f3f16beca,0xbf66bdb03f4f3f6b,0xbf70bf0c3d7b3f25,0xbeb2bf57bf80bf44,0xbe82bef7bf2ebf57,0x3f783f603f3c3f0c
.quad 0xbf2ebf11bee1be9b,0x3f3c3f533f663f74,0xbf1bbde23ed53f53,0x3f4c3f7e3f693f11,0xbf063ebe3f783f48,0x3f5a3f6e3e82bf20,0xbee13f443f4fbebe,0x3f663f25bf16bf6e,0xbeb23f7a3d7bbf7f,0x3f703e54bf803db0,0xbe823f76bf3cbe54,0x3f78be8fbf2e3f7a,0xbe233f37bf7e3f60,0x3f7dbf333e0a3ef7,0xbd7b3e9bbf063f37,0x3f80bf743f5abf33
.quad 0x3d17be3b3ea7beec,0x3f80bf7c3f72bf63,0x3e0abf203f70bf7c,0x3f7ebf483eb23e3b,0x3e6dbf6b3f5dbde2,0x3f79becabf013f7e,0x3ea7bf7f3e233f6b,0x3f723db0bf7d3eca,0x3ed5bf57bf2a3f25,0x3f693f0cbf40bf44,0x3f01bef7bf80bf0c,0x3f5d3f603d17bf57,0x3f16bc49bf1bbf76,0x3f4f3f803f4c3e8f,0x3f2a3eec3e6dbc49,0x3f403f633f793f80
.quad 0x3f4d3f643f753f7e,0x3f1a3ee93e983e04,0xbf053c973f0d3f69,0x3f5b3f803f563ed2,0xbf67bf60bdd53f41,0xbede3efa3f7f3f28,0x3eafbf57bf363f08,0xbf71bf0a3f343f59,0x3f783da3bf7f3e86,0x3e7fbf7f3dbc3f77,0xbe1c3f6bbf54bcfb,0x3f7dbecdbf103f80,0xbf803f49be92bea4,0xbd623f1fbf753f73,0xbd30be353ec7bf15,0xbf803f7cbf6c3f50
.quad 0x3f7dbf743f63bf4b,0xbe103e9ebeef3f1c,0x3e73bf383f7bbf6f,0x3f79bf323e4e3eb5,0xbf723e8c3f21bf7f,0x3eaabf763f473d8a,0xbed83f7abbc9bf79,0xbf68be5a3f80be66,0x3f5c3f26bf24bf5e,0xbf023f433f45beff,0x3f17bebbbf7bbf2f,0x3f4f3f6e3e42bf3a,0xbf3fbf7ebf61bee3,0x3f2b3deebef4bf65,0xbf3dbf12bec1be29,0xbf2dbf52bf6dbf7c
.quad 0x3e733ecd3f0d3f2f,0x3f793f6b3f563f3a,0xbeaabf49bf7fbf65,0xbf72bf1fbdd53ee3,0x3ed83f7c3f36be29,0x3f683e35bf34bf7c,0xbf02bf743dbc3f7e,0xbf5c3e9e3f7f3e04,0x3f173f32bf54bed2,0x3f4fbf38bf103f69,0xbf2bbe8c3f75bf41,0xbf3f3f76be92bf28,0x3f3dbe5abec73f59,0x3f2dbf7a3f6cbf08,0xbf4d3f26beef3e86,0xbf1a3f43bf633f77
.quad 0x3f5bbf6e3f7bbf80,0x3f05bebb3e4ebcfb,0xbf673f7ebf473ea4,0xbedebdee3f21bf73,0x3f71bf523bc93f50,0x3eaf3f12bf803f15,0xbf783ee93f45bf4b,0xbe7fbf643f243f1c,0x3f7d3c97bf7bbeb5,0x3e1c3f803e42bf6f,0xbf80befa3ef43f7f,0xbd62bf60bf61bd8a,0x3f803f573ec1be66,0xbd303f0a3f6d3f79,0xbf7dbf7fbf75bf5e,0x3e10bda3be98beff
.quad 0xbedebe8cbdd53d8a,0x3f673f763f7f3f7f,0x3f713f7a3f363e66,0x3eafbe5abf34bf79,0x3e7fbf26bf7fbeff,0xbf78bf433dbc3f5e,0xbf7dbebb3f543f3a,0xbe1c3f6e3f10bf2f,0xbd623f7ebe92bf65,0x3f80bdeebf753ee3,0x3f80bf12bec73f7c,0xbd30bf523f6cbe29,0xbe10bee93f63bf7e,0xbf7d3f64beefbe04,0xbf793f80bf7b3f69,0x3e73bc97be4e3ed2
.quad 0x3eaabefa3f21bf41,0x3f72bf603f47bf28,0x3f68bf0a3bc93f08,0xbed83f57bf803f59,0xbf023f7fbf24be86,0xbf5c3da33f45bf77,0xbf4fbecd3f7bbcfb,0x3f17bf6bbe423f80,0x3f2bbf1fbf613ea4,0x3f3f3f49bef4bf73,0x3f2d3f7c3ec1bf15,0xbf3d3e353f6d3f50,0xbf4dbe9e3e983f4b,0xbf1abf74bf75bf1c,0xbf05bf32bf56bf6f,0x3f5b3f383f0d3eb5
.quad 0xbf68bf52bf36bf15,0x3ed83f123f343f50,0xbf5cbee93dbc3f1c,0x3f023f643f7f3f4b,0xbf4f3c973f543f6f,0x3f173f803f10beb5,0xbf3f3efa3f75bd8a,0x3f2b3f60be92bf7f,0xbf2d3f573ec7bf79,0x3f3d3f0abf6cbe66,0xbf1a3f7fbeefbeff,0x3f4d3da3bf633f5e,0xbf053f6bbf7b3f2f,0x3f5bbecdbe4e3f3a,0xbede3f1fbf473f65,0x3f67bf493f21bee3
.quad 0xbeaf3e35bbc9be29,0x3f71bf7c3f80bf7c,0xbe7fbe9e3f45bf7e,0x3f78bf743f24be04,0xbe1cbf383f7bbed2,0x3f7dbf32be423f69,0xbd62bf763ef43f41,0x3f80be8cbf613f28,0x3d30bf7abec13f59,0x3f803e5abf6dbf08,0x3e10bf43bf75be86,0x3f7d3f26be98bf77,0x3e73bebbbf56bf80,0x3f793f6e3f0dbcfb,0x3eaa3deebdd5bea4,0x3f723f7e3f7f3f73
.quad 0x3f3e3f5c3f713f7d,0x3f2c3f043eac3e16,0xbf18bd493f043f67,0x3f4e3f803f5c3edb,0xbf5cbf67be163f3e,0xbf043edb3f7d3f2c,0x3edbbf4ebf3e3f04,0xbf67bf183f2c3f5c,0x3f713e16bf803e79,0x3eacbf7d3d493f78,0xbe793f71bf4ebd49,0x3f78beacbf183f80,0xbf7d3f3ebe79beac,0xbe163f2cbf783f71,0x3d49be793edbbf18,0xbf803f78bf673f4e
.quad 0x3f80bf783f67bf4e,0xbd493e79bedb3f18,0x3e16bf2c3f78bf71,0x3f7dbf3e3e793eac,0xbf783eac3f18bf80,0x3e79bf713f4e3d49,0xbeac3f7dbd49bf78,0xbf71be163f80be79,0x3f673f18bf2cbf5c,0xbedb3f4e3f3ebf04,0x3f04bedbbf7dbf2c,0x3f5c3f673e16bf3e,0xbf4ebf80bf5cbedb,0x3f183d49bf04bf67,0xbf2cbf04beacbe16,0xbf3ebf5cbf71bf7d
.quad 0x3d493e793edb3f18,0x3f803f783f673f4e,0xbe16bf2cbf78bf71,0xbf7dbf3ebe793eac,0x3e793f713f4ebd49,0x3f783eacbf18bf80,0xbeacbf7dbd493f78,0xbf713e163f803e79,0x3edb3f4ebf3ebf04,0x3f67bf18bf2c3f5c,0xbf04bedb3f7dbf2c,0xbf5c3f67be16bf3e,0x3f18bd49bf043f67,0x3f4ebf803f5cbedb,0xbf2c3f04beac3e16,0xbf3e3f5cbf713f7d
.quad 0x3f3ebf5c3f71bf7d,0x3f2cbf043eacbe16,0xbf4e3f80bf5c3edb,0xbf183d493f04bf67,0x3f5cbf673e163f3e,0x3f043edbbf7d3f2c,0xbf673f183f2cbf5c,0xbedbbf4e3f3e3f04,0x3f71be16bf80be79,0x3eac3f7d3d49bf78,0xbf78beac3f183f80,0xbe79bf71bf4e3d49,0x3f7d3f3e3e79beac,0x3e163f2c3f783f71,0xbf80bf78bf67bf4e,0xbd49be79bedbbf18
.quad 0xbf2cbf04beacbe16,0x3f3e3f5c3f713f7d,0x3f4e3f803f5c3edb,0x3f183d49bf04bf67,0x3f04bedbbf7dbf2c,0xbf5cbf67be163f3e,0xbf67bf183f2c3f5c,0xbedb3f4e3f3ebf04,0xbeac3f7dbd49bf78,0x3f713e16bf803e79,0x3f78beacbf183f80,0x3e79bf713f4e3d49,0x3e16bf2c3f78bf71,0xbf7d3f3ebe79beac,0xbf803f78bf673f4e,0xbd493e79bedb3f18
.quad 0x3d49be793edbbf18,0x3f80bf783f67bf4e,0x3f7dbf3e3e793eac,0xbe163f2cbf783f71,0xbe793f71bf4ebd49,0xbf783eac3f18bf80,0xbf71be163f80be79,0x3eacbf7d3d493f78,0x3edbbf4ebf3e3f04,0x3f673f18bf2cbf5c,0x3f5c3f673e16bf3e,0xbf043edb3f7d3f2c,0xbf18bd493f043f67,0xbf4ebf80bf5cbedb,0xbf3ebf5cbf71bf7d,0x3f2c3f043eac3e16
.quad 0xbf80bf78bf67bf4e,0x3d493e793edb3f18,0xbf7dbf3ebe793eac,0x3e163f2c3f783f71,0xbf78beac3f183f80,0x3e793f713f4ebd49,0xbf713e163f803e79,0x3eac3f7d3d49bf78,0xbf673f183f2cbf5c,0x3edb3f4ebf3ebf04,0xbf5c3f67be16bf3e,0x3f043edbbf7d3f2c,0xbf4e3f80bf5c3edb,0x3f18bd49bf043f67,0xbf3e3f5cbf713f7d,0x3f2cbf043eacbe16
.quad 0xbf2c3f04beac3e16,0x3f3ebf5c3f71bf7d,0xbf183d493f04bf67,0x3f4ebf803f5cbedb,0xbf04bedb3f7dbf2c,0x3f5cbf673e163f3e,0xbedbbf4e3f3e3f04,0x3f67bf18bf2c3f5c,0xbeacbf7dbd493f78,0x3f71be16bf80be79,0xbe79bf71bf4e3d49,0x3f783eacbf18bf80,0xbe16bf2cbf78bf71,0x3f7d3f3e3e79beac,0xbd49be79bedbbf18,0x3f803f783f673f4e
.quad 0x3f2d3f523f6d3f7c,0x3f3d3f123ec13e29,0xbf2bbdee3ef43f65,0x3f3f3f7e3f613ee3,0xbf4fbf6ebe423f3a,0xbf173ebb3f7b3f2f,0x3f02bf43bf453eff,0xbf5cbf263f243f5e,0x3f683e5abf803e66,0x3ed8bf7a3bc93f79,0xbeaa3f76bf47bd8a,0x3f72be8cbf213f7f,0xbf793f32be4ebeb5,0xbe733f38bf7b3f6f,0x3e10be9e3eefbf1c,0xbf7d3f74bf633f4b
.quad 0x3f80bf7c3f6cbf50,0x3d303e35bec73f15,0x3d62bf1f3f75bf73,0x3f80bf493e923ea4,0xbf7d3ecd3f10bf80,0x3e1cbf6b3f543cfb,0xbe7f3f7fbdbcbf77,0xbf78bda33f7fbe86,0x3f713f0abf34bf59,0xbeaf3f573f36bf08,0x3edebefabf7fbf28,0x3f673f603dd5bf41,0xbf5bbf80bf56bed2,0x3f05bc97bf0dbf69,0xbf1abee9be98be04,0xbf4dbf64bf75bf7e
.quad 0xbe103da33e983eff,0x3f7d3f7f3f753f5e,0x3d30bf0abf6dbf79,0xbf80bf57bec13e66,0x3d623f603f613d8a,0x3f803efabef4bf7f,0xbe1cbf80be423f6f,0xbf7dbc973f7b3eb5,0x3e7f3f64bf24bf1c,0x3f78bee9bf453f4b,0xbeafbf123f80bf15,0xbf713f52bbc9bf50,0x3ede3deebf213f73,0x3f67bf7e3f47bea4,0xbf053ebbbe4e3cfb,0xbf5b3f6ebf7b3f80
.quad 0x3f1abf433f63bf77,0x3f4dbf263eefbe86,0xbf2d3f7abf6c3f08,0xbf3d3e5a3ec7bf59,0x3f3fbf763e923f28,0x3f2b3e8cbf753f41,0xbf4f3f383f10bf69,0xbf17bf323f543ed2,0x3f5cbe9ebf7fbe04,0x3f023f74bdbcbf7e,0xbf68be353f343f7c,0xbed8bf7cbf363e29,0x3f723f1f3dd5bee3,0x3eaa3f493f7f3f65,0xbf79bf6bbf56bf3a,0xbe73becdbf0dbf2f
.quad 0xbf5bbf38bf0dbeb5,0x3f053f323f563f6f,0x3f1a3f743f753f1c,0x3f4d3e9ebe98bf4b,0x3f3dbe35bf6dbf50,0xbf2dbf7cbec13f15,0xbf3fbf493ef43f73,0xbf2b3f1f3f61bea4,0xbf173f6b3e42bf80,0x3f4f3ecdbf7b3cfb,0x3f5cbda3bf453f77,0x3f02bf7f3f243e86,0x3ed8bf573f80bf59,0xbf683f0abbc9bf08,0xbf723f60bf473f28,0xbeaa3efabf213f41
.quad 0xbe733c973e4ebed2,0x3f79bf803f7bbf69,0x3f7dbf643eef3e04,0x3e103ee9bf633f7e,0x3d303f52bf6c3e29,0xbf803f123ec7bf7c,0xbf803dee3f75bee3,0x3d62bf7e3e923f65,0x3e1cbf6ebf103f2f,0x3f7d3ebbbf54bf3a,0x3f783f43bdbcbf5e,0xbe7f3f263f7f3eff,0xbeaf3e5a3f343f79,0xbf71bf7abf36be66,0xbf67bf76bf7fbf7f,0x3ede3e8c3dd5bd8a
.quad 0xbf72bf7ebf7fbf73,0xbeaabdee3dd53ea4,0xbf79bf6ebf0d3cfb,0xbe733ebb3f563f80,0xbf7dbf263e983f77,0xbe103f433f753e86,0xbf80be5a3f6d3f08,0xbd303f7a3ec1bf59,0xbf803e8c3f61bf28,0x3d623f76bef4bf41,0xbf7d3f323e42bf69,0x3e1c3f38bf7b3ed2,0xbf783f74bf243e04,0x3e7f3e9ebf453f7e,0xbf713f7cbf803f7c,0x3eafbe353bc93e29
.quad 0xbf673f49bf213ee3,0x3edebf1f3f47bf65,0xbf5b3ecd3e4ebf3a,0x3f05bf6b3f7bbf2f,0xbf4dbda33f63bf5e,0x3f1abf7f3eef3eff,0xbf3dbf0a3f6c3e66,0x3f2dbf57bec73f79,0xbf2bbf603e923f7f,0x3f3fbefabf753d8a,0xbf17bf80bf103eb5,0x3f4fbc97bf54bf6f,0xbf02bf64bf7fbf4b,0x3f5c3ee9bdbcbf1c,0xbed8bf12bf34bf50,0x3f683f523f363f15
.quad 0x3f1b3f483f693f7c,0x3f4c3f203ed53e3b,0xbf3cbe3b3ee13f63,0x3f2e3f7c3f663eec,0xbf40bf74be6d3f37,0xbf2a3e9b3f793f33,0x3f16bf37bf4c3ef7,0xbf4fbf333f1b3f60,0x3f5d3e8fbf803e54,0x3f01bf76bd173f7a,0xbed53f7abf40bdb0,0x3f69be54bf2a3f7f,0xbf723f25be23bebe,0xbea73f44bf7d3f6e,0x3e6dbebe3f01bf20,0xbf793f6ebf5d3f48
.quad 0x3f7ebf7e3f70bf53,0x3e0a3de2beb23f11,0xbd17bf113f72bf74,0x3f80bf533ea73e9b,0xbf803eec3f06bf80,0x3d7bbf633f5a3c49,0xbe233f80be0abf76,0xbf7dbc493f7ebe8f,0x3f783ef7bf3cbf57,0xbe823f603f2ebf0c,0x3eb2bf0cbf80bf25,0x3f703f573d7bbf44,0xbf66bf7fbf4fbeca,0x3ee1bdb0bf16bf6b,0xbf06becabe82bde2,0xbf5abf6bbf78bf7e
.quad 0xbea7bdb03e233eca,0x3f723f7f3f7d3f6b,0x3e6dbecabf5dbf7e,0xbf79bf6bbf013de2,0xbe0a3f483f703e3b,0x3f7e3f20beb2bf7c,0x3d17bf7cbea73f63,0xbf80be3b3f723eec,0x3d7b3f74bf06bf33,0x3f80be9bbf5a3f37,0xbe23bf333f7ebef7,0xbf7d3f373e0abf60,0x3e823e8fbf3c3f7a,0x3f78bf763f2ebe54,0xbeb23e54bd7bbdb0,0xbf703f7abf803f7f
.quad 0x3ee1bf253f4fbf6e,0x3f66bf443f16bebe,0xbf063f6ebf783f20,0xbf5a3ebe3e82bf48,0x3f1bbf7e3ed53f11,0x3f4c3de2bf693f53,0xbf2e3f533ee1bf74,0xbf3cbf113f663e9b,0x3f40beecbf79bc49,0x3f2a3f63be6dbf80,0xbf4fbc493f4c3f76,0xbf16bf80bf1b3e8f,0x3f5d3ef7bd17bf0c,0x3f013f603f803f57,0xbf69bf57bf40bf25,0xbed5bf0cbf2abf44
.quad 0xbf78bf60bf3cbf0c,0x3e823ef73f2e3f57,0x3eb23f573f803f44,0x3f703f0cbd7bbf25,0x3f663db0bf4fbf6b,0xbee1bf7fbf163eca,0xbf06bf6b3e823f7e,0xbf5a3eca3f78bde2,0xbf4c3f483ed5bf7c,0x3f1b3f20bf69be3b,0x3f2e3e3bbf663f63,0x3f3cbf7c3ee13eec,0x3f2abf743f79bf37,0xbf403e9b3e6dbf33,0xbf4f3f37bf1b3ef7,0xbf163f33bf4c3f60
.quad 0xbf013e8fbd17be54,0x3f5dbf763f80bf7a,0x3f69bf7a3f2abdb0,0x3ed53e54bf403f7f,0x3ea73f25bf7d3ebe,0xbf723f443e23bf6e,0xbf793ebe3f5dbf20,0xbe6dbf6e3f013f48,0xbe0abf7ebeb23f53,0x3f7e3de2bf70bf11,0x3f803f11bea7bf74,0x3d173f533f723e9b,0xbd7b3eec3f5a3f80,0xbf80bf63bf06bc49,0xbf7dbf80bf7ebf76,0x3e233c49be0abe8f
.quad 0xbf40bf63bf79bf80,0xbf2abeecbe6d3c49,0xbf4fbf80bf4cbe8f,0xbf163c493f1b3f76,0xbf5dbf60bd173f57,0xbf013ef73f803f0c,0xbf69bf0c3f403f44,0xbed53f573f2abf25,0xbf72bdb03f7dbeca,0xbea73f7fbe23bf6b,0xbf793eca3f01bf7e,0xbe6d3f6bbf5d3de2,0xbf7e3f48beb2be3b,0xbe0a3f20bf703f7c,0xbf803f7cbf723f63,0xbd173e3bbea73eec
.quad 0xbf803f74bf5a3f33,0x3d7bbe9b3f06bf37,0xbf7d3f33be0abef7,0x3e23bf373f7ebf60,0xbf783e8f3f2ebf7a,0x3e82bf763f3c3e54,0xbf70be543f80bdb0,0x3eb2bf7abd7b3f7f,0xbf66bf253f163f6e,0x3ee1bf44bf4f3ebe,0xbf5abf6ebe823f20,0x3f06bebebf78bf48,0xbf4cbf7ebf69bf11,0x3f1b3de2bed5bf53,0xbf3cbf53bf66bf74,0x3f2e3f113ee13e9b
.quad 0x3f083f3d3f643f7b,0x3f593f2d3ee93e4e,0xbf4bbe7f3ecd3f61,0x3f1c3f783f6b3ef4,0xbf2fbf79be8c3f34,0xbf3a3e733f763f36,0x3f28bf2bbf523eef,0xbf41bf3f3f123f63,0x3f503eafbf7f3e42,0x3f15bf71bda33f7b,0xbeff3f7dbf38bdd5,0x3f5ebe10bf323f7f,0xbf693f17bdeebec7,0xbed23f4fbf7e3f6c,0x3ea4bede3f0abf24,0xbf733f67bf573f45
.quad 0x3f79bf803f74bf56,0x3e663d30be9e3f0d,0xbe04bf023f6ebf75,0x3f7ebf5c3ebb3e92,0xbf803f053efabf80,0xbcfbbf5b3f60bbc9,0xbd8a3f80be35bf75,0xbf7f3d623f7cbe98,0x3f7c3ed8bf43bf54,0xbe293f683f26bf10,0x3e86bf1abf80bf21,0x3f773f4d3c97bf47,0xbf6fbf7dbf49bec1,0x3eb5be1cbf1fbf6d,0xbee3beaabe5abdbc,0xbf65bf72bf7abf7f
.quad 0xbeffbe7f3c973e92,0x3f5e3f783f803f75,0x3ed2be73bf49bf80,0xbf69bf79bf1fbbc9,0xbea43f2b3f7a3e98,0x3f733f3fbe5abf75,0x3e66bf71bee93f54,0xbf79beaf3f643f10,0xbe043f7dbecdbf47,0x3f7ebe10bf6b3f21,0x3cfbbf4f3f76bec1,0xbf803f173e8cbf6d,0x3d8a3edebf523f7f,0x3f7fbf673f12bdbc,0xbe293d303da3be4e,0xbf7c3f80bf7f3f7b
.quad 0x3e86bf023f38bf61,0x3f77bf5c3f32bef4,0xbeb53f5bbf7e3f36,0xbf6f3f053deebf34,0x3ee3bf803f0a3eef,0x3f65bd62bf573f63,0xbf083f683e9ebf7b,0xbf59bed83f743e42,0x3f1cbf1abf6e3dd5,0x3f4b3f4dbebbbf7f,0xbf2f3e1c3f603f6c,0xbf3abf7dbefa3ec7,0x3f413eaabe35bf24,0x3f283f723f7c3f45,0xbf50bf3dbf26bf0d,0xbf15bf2dbf43bf56
.quad 0xbf80bf79bf60bf36,0xbcfb3e733efa3f34,0x3d8a3f2b3f7c3f63,0x3f7f3f3f3e35beef,0x3f7c3eafbf26bf7b,0xbe29bf71bf433e42,0xbe86bf7d3c973f7f,0xbf773e103f803dd5,0xbf6f3f173f1fbf6c,0x3eb53f4fbf49bec7,0x3ee33edebf7a3f45,0x3f65bf673e5a3f24,0x3f59bf803f64bf0d,0xbf083d303ee9bf56,0xbf1c3f02becd3e92,0xbf4b3f5cbf6b3f75
.quad 0xbf3a3f05be8c3bc9,0x3f2fbf5b3f76bf80,0x3f41bf803f52be98,0x3f28bd62bf123f75,0x3f153ed8bf7f3f10,0xbf503f68bda3bf54,0xbf5e3f1a3f38bf47,0xbeffbf4d3f323f21,0xbed2bf7dbdee3f6d,0x3f69be1cbf7ebec1,0x3f733eaabf0abf7f,0x3ea43f723f573dbc,0x3e663f2d3f743f7b,0xbf79bf3dbe9e3e4e,0xbf7ebf78bf6ebf61,0xbe04be7fbebbbef4
.quad 0xbee3bf2bbf57bf75,0xbf65bf3fbf0abe98,0xbf08bf71bf74bf10,0xbf59beaf3e9e3f54,0xbf1cbf7dbebb3f21,0xbf4b3e103f6e3f47,0xbf2fbf4f3efa3f6d,0xbf3a3f173f60bec1,0xbf41bede3f7cbdbc,0xbf283f673e35bf7f,0xbf503d303f43bf7b,0xbf153f80bf26be4e,0xbf5e3f02bc97bef4,0xbeff3f5cbf803f61,0xbf693f5bbf493f34,0xbed23f05bf1f3f36
.quad 0xbf733f80bf7a3f63,0xbea43d623e5abeef,0xbf793f68bee9be42,0xbe66bed83f64bf7b,0xbf7e3f1a3ecdbf7f,0xbe04bf4d3f6bbdd5,0xbf803e1c3f76bec7,0xbcfbbf7d3e8c3f6c,0xbf7fbeaa3f523f45,0x3d8abf72bf123f24,0xbf7cbf3d3da33f56,0x3e29bf2dbf7fbf0d,0xbf77bf78bf38be92,0x3e86be7fbf32bf75,0xbf6fbf79bf7ebf80,0x3eb53e733deebbc9
.quad 0x3ee63f313f5f3f7a,0x3f653f393efc3e60,0xbf58bea13eb83f5f,0x3f093f733f6f3efc,0xbf1dbf7cbea13f31,0xbf4a3e2f3f733f39,0x3f39bf1dbf583ee6,0xbf31bf4a3f093f65,0x3f423ecfbf7e3e2f,0x3f27bf6abdfb3f7c,0xbf133f7fbf31bdfb,0x3f51bd97bf393f7e,0xbf5f3f09bd97becf,0xbefc3f58bf7f3f6a,0x3ecfbefc3f13bf27,0xbf6a3f5fbf513f42
.quad 0x3f73bf803f77bf58,0x3ea1bcc9be893f09,0xbe60bee63f6abf77,0x3f7abf653ecf3e89,0xbf7e3f133ee6bf80,0xbdfbbf513f65bcc9,0x3cc93f7ebe60bf73,0xbf803dfb3f7abea1,0x3f7f3eb8bf4abf51,0xbd973f6f3f1dbf13,0x3e2fbf27bf80bf1d,0x3f7c3f42bcc9bf4a,0xbf77bf7abf42beb8,0x3e89be60bf27bf6f,0xbeb8be89be2fbd97,0xbf6fbf77bf7cbf7f
.quad 0xbf27becfbdfb3e2f,0x3f423f6a3f7e3f7c,0x3f13bd97bf31bf7e,0xbf51bf7fbf39bdfb,0xbefc3f093f7f3ecf,0x3f5f3f58bd97bf6a,0x3ecfbf5fbf133f42,0xbf6abefc3f513f27,0xbea13f80be89bf58,0x3f733cc9bf773f09,0x3e60bf653f6abe89,0xbf7a3ee63ecfbf77,0xbdfb3f13bf653f80,0x3f7ebf513ee63cc9,0x3cc9bdfb3e60bea1,0xbf803f7ebf7a3f73
.quad 0x3d97beb83f1dbf51,0x3f7fbf6f3f4abf13,0xbe2f3f42bf803f4a,0xbf7c3f27bcc9bf1d,0x3e89bf7a3f273eb8,0x3f77be60bf423f6f,0xbeb83f773e2fbf7f,0xbf6fbe893f7c3d97,0x3ee6bf39bf5f3e60,0x3f653f31befcbf7a,0xbf093ea13f6f3f5f,0xbf58bf73beb83efc,0x3f1d3e2fbea1bf39,0x3f4a3f7c3f733f31,0xbf31bf1dbf09bee6,0xbf39bf4abf58bf65
.quad 0xbf73bf80bf77bf58,0xbea1bcc93e893f09,0xbe603ee63f6a3f77,0x3f7a3f653ecfbe89,0x3f7e3f13bee6bf80,0x3dfbbf51bf65bcc9,0x3cc9bf7ebe603f73,0xbf80bdfb3f7a3ea1,0xbf7f3eb83f4abf51,0x3d973f6fbf1dbf13,0x3e2f3f27bf803f1d,0x3f7cbf42bcc93f4a,0x3f77bf7a3f42beb8,0xbe89be603f27bf6f,0xbeb83e89be2f3d97,0xbf6f3f77bf7c3f7f
.quad 0xbf653f39befc3e60,0x3ee6bf313f5fbf7a,0x3f09bf733f6fbefc,0x3f58bea1beb83f5f,0x3f4a3e2fbf733f39,0xbf1d3f7cbea1bf31,0xbf313f4a3f09bf65,0xbf39bf1d3f583ee6,0xbf27bf6a3dfb3f7c,0x3f42becfbf7ebe2f,0x3f513d97bf39bf7e,0x3f133f7f3f31bdfb,0x3efc3f583f7f3f6a,0xbf5fbf09bd973ecf,0xbf6abf5fbf51bf42,0xbecfbefcbf13bf27
.quad 0xbd97beb8bf1dbf51,0xbf7fbf6fbf4abf13,0xbe2fbf42bf80bf4a,0xbf7cbf27bcc93f1d,0xbe89bf7abf273eb8,0xbf77be603f423f6f,0xbeb8bf773e2f3f7f,0xbf6f3e893f7cbd97,0xbee6bf393f5f3e60,0xbf653f313efcbf7a,0xbf09bea13f6fbf5f,0xbf583f73beb8befc,0xbf1d3e2f3ea1bf39,0xbf4a3f7cbf733f31,0xbf313f1dbf093ee6,0xbf393f4abf583f65
.quad 0xbf423f6abf7e3f7c,0xbf273ecfbdfbbe2f,0xbf513f7fbf393dfb,0xbf13bd973f31bf7e,0xbf5f3f583d97bf6a,0xbefcbf093f7fbecf,0xbf6a3efc3f51bf27,0xbecfbf5f3f133f42,0xbf733cc93f773f09,0xbea1bf80be893f58,0xbf7abee63ecf3f77,0xbe60bf65bf6abe89,0xbf7ebf51bee63cc9,0xbdfbbf13bf65bf80,0xbf80bf7ebf7abf73,0xbcc9bdfbbe60bea1
.quad 0x3ebb3f243f593f79,0x3f6e3f453f083e73,0xbf64bec13ea43f5c,0x3ee93f6d3f733f02,0xbf0abf7fbeb53f2d,0xbf573dd53f6f3f3d,0x3f49bf10bf5e3ede,0xbf1fbf543eff3f67,0x3f323eefbf7c3e1c,0x3f38bf63be293f7d,0xbf263f80bf28be10,0x3f43bbc9bf413f7d,0xbf523ef4bcfbbed8,0xbf123f61bf803f68,0x3efabf0d3f1cbf2b,0xbf603f56bf4b3f3f
.quad 0x3f6bbf7f3f79bf5b,0x3ecdbdbcbe663f05,0xbe9ebec73f65bf78,0x3f74bf6c3ee33e7f,0xbf7a3f213ed2bf80,0xbe5abf473f69bd30,0x3dee3f7bbe86bf72,0xbf7e3e423f77beaa,0x3f803e98bf50bf4f,0x3c973f753f15bf17,0x3da3bf34bf7fbf1a,0x3f7f3f36bd8abf4d,0xbf7cbf75bf3abeaf,0x3e35be92bf2fbf71,0xbe8cbe4ebe04bd62,0xbf76bf7bbf7ebf80
.quad 0xbf49bf0dbe863d62,0x3f1f3f563f773f80,0x3f383dbcbf15bf79,0xbf32bf7fbf50be73,0xbf263ec73f7f3f02,0x3f433f6c3d8abf5c,0x3f12bf47bf2f3f2d,0xbf52bf213f3a3f3d,0xbefa3f7bbe04bf67,0x3f603e42bf7e3ede,0x3ecdbf753f59be1c,0xbf6b3e983f08bf7d,0xbe9e3f34bf733f7d,0x3f74bf363ea43e10,0x3e5abe923eb5bed8,0xbf7a3f75bf6f3f68
.quad 0xbdeebe4e3effbf3f,0x3f7ebf7b3f5ebf2b,0x3c973f24bf7c3f5b,0xbf803f45be29bf05,0x3da3bf6d3f413e7f,0x3f7fbec1bf283f78,0xbe353f7f3cfbbf80,0xbf7cbdd53f80bd30,0x3e8cbf54bf4b3eaa,0x3f763f10bf1cbf72,0xbebb3eef3f793f4f,0xbf6ebf63be663f17,0x3ee93bc9bee3bf4d,0x3f643f803f653f1a,0xbf0abef4bed2beaf,0xbf57bf61bf69bf71
.quad 0xbf52bf75bf80bf71,0xbf12be923cfb3eaf,0xbefa3e4e3f4b3f80,0x3f603f7b3f1cbd62,0x3f6b3f45be66bf79,0x3ecdbf24bf79be73,0x3e9ebf6dbee33f5c,0xbf74bec13f653f02,0xbf7a3dd53f69bf2d,0xbe5a3f7fbed2bf3d,0xbdee3f54bf773ede,0x3f7ebf10be863f67,0x3f80bf633f15be1c,0x3c97beef3f50bf7d,0xbda33bc93d8abe10,0xbf7f3f80bf7f3f7d
.quad 0xbf7c3f61bf2f3ed8,0x3e35bef43f3abf68,0x3e8cbf563f7ebf2b,0x3f76bf0dbe043f3f,0x3f6ebdbcbf593f5b,0xbebb3f7fbf08bf05,0xbee93f6c3ea4bf78,0xbf64bec73f733e7f,0xbf57bf473eb53f80,0x3f0abf21bf6f3d30,0x3f1fbe42bf5ebf72,0x3f493f7b3effbeaa,0x3f383f753f7c3f4f,0xbf32be983e293f17,0xbf43bf36bf28bf1a,0xbf26bf34bf41bf4d
.quad 0x3e9ebbc9bea4bf1a,0xbf74bf80bf73bf4d,0x3e5abef4bf6fbf71,0xbf7abf61beb53eaf,0x3deebf56bf5e3d62,0xbf7ebf0d3eff3f80,0x3c97bf7fbe293f79,0xbf80bdbc3f7c3e73,0xbda3bf6c3f283f02,0xbf7f3ec73f41bf5c,0xbe35bf213f80bf2d,0xbf7c3f47bcfbbf3d,0xbe8cbe423f1cbf67,0xbf763f7bbf4b3ede,0xbebb3e98be663e1c,0xbf6e3f75bf793f7d
.quad 0xbee93f36bf653f7d,0xbf643f34bee33e10,0xbf0a3f75bf693ed8,0xbf573e923ed2bf68,0xbf1f3f7bbe86bf3f,0xbf49be4e3f77bf2b,0xbf323f453f15bf5b,0xbf38bf243f503f05,0xbf433ec13f7f3e7f,0xbf26bf6d3d8a3f78,0xbf52bdd53f2f3f80,0xbf12bf7fbf3a3d30,0xbf60bf10be043eaa,0xbefabf54bf7ebf72,0xbf6bbf63bf59bf4f,0xbecdbeefbf08bf17
.quad 0x3e8f3f163f533f78,0x3f763f4f3f113e82,0xbf6ebee13e8f3f5a,0x3ebe3f663f763f06,0xbeecbf80beca3f2a,0xbf633d173f6b3f40,0x3f57bf01bf633ed5,0xbf0cbf5d3eec3f69,0x3f203f06bf7a3e0a,0x3f48bf5abe543f7e,0xbf373f80bf20be23,0x3f333d7bbf483f7d,0xbf443ed53c49bee1,0xbf253f69bf803f66,0x3f11bf1b3f25bf2e,0xbf533f4cbf443f3c
.quad 0x3f60bf7d3f7cbf5d,0x3ef7be23be3b3f01,0xbecabea73f60bf79,0x3f6bbf723ef73e6d,0xbf743f2e3ebebf80,0xbe9bbf3c3f6ebd7b,0x3e543f78be9bbf70,0xbf7a3e823f74beb2,0x3f7e3e6dbf57bf4c,0x3de23f793f0cbf1b,0xbc49bf40bf7ebf16,0x3f803f2abde2bf4f,0xbf7fbf70bf33bea7,0x3db0beb2bf37bf72,0xbe3bbe0abdb0bd17,0xbf7cbf7ebf7fbf80
.quad 0xbf63bf2ebecabd7b,0x3eec3f3c3f6b3f80,0x3f573e82beecbf70,0xbf0cbf78bf63beb2,0xbf483e6d3f7a3f1b,0x3f203f793e54bf4c,0x3f37bf2abf483f16,0xbf33bf403f203f4f,0xbf253f703c49bf72,0x3f443eb2bf803ea7,0x3f11bf7e3f44bd17,0xbf533e0a3f25bf80,0xbef73f4fbf7c3f78,0x3f60bf163e3b3e82,0x3ecabee13ef7bf06,0xbf6b3f66bf603f5a
.quad 0xbe9bbd173ebebf2a,0x3f74bf803f6ebf40,0x3e543f01bf743f69,0xbf7a3f5dbe9bbed5,0xbde2bf5a3f573e0a,0x3f7ebf06bf0c3f7e,0x3c493f80bde2bf7d,0xbf803d7b3f7ebe23,0x3db0bf69bf333ee1,0x3f7f3ed5bf37bf66,0xbe3b3f1b3f7f3f3c,0xbf7cbf4cbdb03f2e,0x3e8fbe23bf11bf5d,0x3f763f7d3f533f01,0xbebebea7be8fbe6d,0xbf6ebf72bf76bf79
.quad 0xbf20bf5abf7abf7e,0xbf48bf06be543e0a,0xbf37bd7b3f203f7d,0x3f333f803f483e23,0x3f443f693c49bf66,0x3f25bed5bf80bee1,0x3f11bf4cbf253f3c,0xbf53bf1b3f443f2e,0xbf60be233f7cbf01,0xbef73f7dbe3bbf5d,0xbeca3f72bf603e6d,0x3f6bbea7bef73f79,0x3f74bf3c3ebe3d7b,0x3e9bbf2e3f6ebf80,0x3e54be823e9bbeb2,0xbf7a3f78bf743f70
.quad 0xbf7e3f79bf573f1b,0xbde2be6d3f0cbf4c,0xbc49bf2a3f7ebf4f,0x3f80bf403de23f16,0x3f7fbeb2bf333f72,0xbdb03f70bf37bea7,0xbe3b3f7e3db0bf80,0xbf7cbe0a3f7f3d17,0xbf76bf163f113f78,0x3e8fbf4fbf533e82,0x3ebebee1bf76bf5a,0x3f6e3f663e8fbf06,0x3f633f803f6b3f2a,0xbeecbd173eca3f40,0xbf0cbf01beecbed5,0xbf57bf5dbf63bf69
.quad 0x3f253eb23c49bea7,0xbf44bf70bf80bf72,0x3f11be0abf44bf80,0xbf53bf7ebf253d17,0x3ef7bf16bf7cbe82,0xbf60bf4f3e3b3f78,0x3ecabf66bef73f5a,0xbf6bbee13f603f06,0x3e9bbf803ebe3f40,0xbf743d173f6ebf2a,0x3e54bf5d3f74bed5,0xbf7a3f013e9bbf69,0x3de2bf063f57bf7e,0xbf7e3f5abf0c3e0a,0x3c49bd7b3de2be23,0xbf803f80bf7e3f7d
.quad 0xbdb03ed5bf333f66,0xbf7f3f69bf373ee1,0xbe3b3f4cbf7f3f2e,0xbf7c3f1b3db0bf3c,0xbe8f3f7dbf11bf01,0xbf763e233f53bf5d,0xbebe3f723e8fbf79,0xbf6ebea73f763e6d,0xbeec3f2e3f6bbd7b,0xbf63bf3c3eca3f80,0xbf0c3e823f633f70,0xbf57bf78beec3eb2,0xbf20be6d3e543f1b,0xbf48bf79bf7abf4c,0xbf33bf2abf20bf16,0xbf37bf40bf48bf4f
.quad 0x3e423f083f4d3f76,0x3f7b3f593f1a3e8c,0xbf75beff3e733f57,0x3e923f5e3f793f0a,0xbec1bf80bede3f26,0xbf6dbcfb3f673f43,0x3f63bee3bf683ecd,0xbeefbf653ed83f6b,0x3f0d3f15bf783dee,0x3f56bf50be7f3f7e,0xbf473f7ebf17be35,0x3f213e04bf4f3f7c,0xbf343eb53d62bee9,0xbf363f6fbf803f64,0x3f24bf283f2dbf32,0xbf453f41bf3d3f38
.quad 0x3f54bf793f7dbf60,0x3f10be66be103efa,0xbef4be863f5bbf7a,0x3f61bf773f053e5a,0xbf6c3f3a3eaabf7f,0xbec7bf2f3f72bda3,0x3e983f73beafbf6e,0xbf753ea43f71bebb,0x3f7b3e29bf5cbf49,0x3e4e3f7c3f02bf1f,0xbdd5bf4bbf7dbf12,0x3f7f3f1cbe1cbf52,0xbf80bf69bf2bbe9e,0xbbc9bed2bf3fbf74,0xbdbcbd8abd30bc97,0xbf7fbf7fbf80bf80
.quad 0xbf75bf4bbf05be35,0x3e923f1c3f5b3f7c,0x3f6d3ed2beaabf64,0xbec1bf69bf72bee9,0xbf633d8a3f713f32,0x3eef3f7f3eafbf38,0x3f56bf08bf5c3efa,0xbf0dbf593f023f60,0xbf473f5e3e1cbf7a,0x3f213effbf7d3e5a,0x3f36bf803f2b3da3,0xbf34bcfb3f3fbf7f,0xbf243f65bf803f6e,0x3f45bee33d303ebb,0x3f10bf153f1abf1f,0xbf543f50bf4d3f49
.quad 0xbef43e043e73bf12,0x3f61bf7e3f79bf52,0x3ec73eb5bf673f74,0xbf6c3f6fbedebe9e,0xbe98bf413f683c97,0x3f75bf28bed83f80,0x3e4e3f79be7fbf76,0xbf7b3e663f78be8c,0xbdd5bf77bf173f0a,0x3f7f3e86bf4fbf57,0x3bc93f3a3f803f26,0xbf80bf2f3d623f43,0x3dbcbea4bf2dbf6b,0x3f7f3f733f3d3ecd,0xbe42be29be10bdee,0xbf7bbf7cbf7dbf7e
.quad 0xbec1bf2fbf67bf7f,0xbf6dbf3abedebda3,0xbf63bea43ed83f6e,0x3eef3f733f683ebb,0x3f0d3f7c3e7fbf49,0x3f56be29bf78bf1f,0x3f47bf1cbf4f3f12,0xbf21bf4b3f173f52,0xbf34bed23f80be9e,0xbf363f693d62bf74,0xbf243f7fbf3d3c97,0x3f45bd8abf2d3f80,0x3f54bf083e103e8c,0x3f10bf593f7dbf76,0x3ef4beff3f05bf0a,0xbf613f5ebf5b3f57
.quad 0xbf6c3f80bf723f43,0xbec73cfb3eaabf26,0xbe98bee33f71bf6b,0x3f75bf653eaf3ecd,0x3f7bbf15bf023f7e,0x3e4e3f50bf5cbdee,0x3dd53f7ebe1cbf7c,0xbf7f3e043f7dbe35,0xbf80beb53f3f3f64,0xbbc9bf6fbf2b3ee9,0x3dbcbf28bf80bf38,0x3f7f3f413d30bf32,0x3f7b3f793f4d3efa,0xbe423e663f1a3f60,0xbe92be86be73be5a,0xbf75bf77bf79bf7a
.quad 0x3f633f283eafbc97,0xbeefbf41bf71bf80,0x3f563e66bf02bf76,0xbf0dbf79bf5cbe8c,0x3f47be86bf7dbf0a,0xbf21bf77be1c3f57,0x3f36bf2fbf3f3f26,0xbf34bf3a3f2b3f43,0x3f24bf733d303f6b,0xbf45bea43f80becd,0x3f10bf7c3f4dbdee,0xbf543e293f1abf7e,0x3ef4bf4b3f79bf7c,0xbf613f1cbe73be35,0x3ec7bed23edebee9,0xbf6c3f69bf673f64
.quad 0x3e983d8abed83f38,0xbf753f7fbf683f32,0x3e4e3f08bf783f60,0xbf7b3f59be7fbefa,0x3dd53f5ebf4fbe5a,0xbf7f3eff3f17bf7a,0x3bc93f80bd62bf7f,0xbf803cfb3f80bda3,0xbdbc3f653f3dbebb,0xbf7fbee33f2d3f6e,0xbe423f153f7d3f49,0xbf7bbf50be103f1f,0xbe923e043f053f52,0xbf75bf7ebf5bbf12,0xbec1beb5beaabe9e,0xbf6dbf6fbf72bf74
.quad 0x3f803f803f803f80,0,0x3d493edb3f3e3f71,0x3f803f673f2c3eac,0xbf7fbf223dc93f46,0x3dc93f463f7f3f22,0xbe16bf78bf183f04,0xbf7dbe793f4e3f5c,0x3f7bbe48bf7b3e48,0xbe48bf7b3e483f7b,0x3e793f4ebf5cbe16,0x3f78bf18bf043f7d,0xbf753f62be95bef1,0x3e953ef1bf753f62,0xbeacbd493edbbf3e,0xbf713f80bf673f2c
.quad 0x3f6dbf6d3f6dbf6d,0xbec43ec4bec43ec4,0x3edbbf3e3f71bf80,0x3f67bf2c3eac3d49,0xbf623e953ef1bf75,0x3ef1bf753f62be95,0xbf043f7dbe79bf4e,0xbf5cbe163f78bf18,0x3f553f0ebf55bf0e,0xbf0e3f553f0ebf55,0x3f18bf04bf7dbe79,0x3f4e3f5cbe16bf78,0xbf46bf7fbf223dc9,0x3f22bdc9bf46bf7f,0xbf2cbeac3d493edb,0xbf3ebf71bf80bf67
.quad 0x3f803f803f803f80,0,0xbf80bf67bf2cbeac,0x3d493edb3f3e3f71,0x3f7f3f22bdc9bf46,0xbdc9bf46bf7fbf22,0xbf7dbe793f4e3f5c,0x3e163f783f18bf04,0x3f7bbe48bf7b3e48,0xbe48bf7b3e483f7b,0xbf783f183f04bf7d,0x3e793f4ebf5cbe16,0x3f75bf623e953ef1,0xbe95bef13f75bf62,0xbf713f80bf673f2c,0x3eac3d49bedb3f3e
.quad 0x3f6dbf6d3f6dbf6d,0xbec43ec4bec43ec4,0xbf673f2cbeacbd49,0x3edbbf3e3f71bf80,0x3f62be95bef13f75,0xbef13f75bf623e95,0xbf5cbe163f78bf18,0x3f04bf7d3e793f4e,0x3f553f0ebf55bf0e,0xbf0e3f553f0ebf55,0xbf4ebf5c3e163f78,0x3f18bf04bf7dbe79,0x3f463f7f3f22bdc9,0xbf223dc93f463f7f,0xbf3ebf71bf80bf67,0x3f2c3eacbd49bedb
.quad 0x3f803f803f803f80,0,0xbd49bedbbf3ebf71,0xbf80bf67bf2cbeac,0xbf7fbf223dc93f46,0x3dc93f463f7f3f22,0x3e163f783f18bf04,0x3f7d3e79bf4ebf5c,0x3f7bbe48bf7b3e48,0xbe48bf7b3e483f7b,0xbe79bf4e3f5c3e16,0xbf783f183f04bf7d,0xbf753f62be95bef1,0x3e953ef1bf753f62,0x3eac3d49bedb3f3e,0x3f71bf803f67bf2c
.quad 0x3f6dbf6d3f6dbf6d,0xbec43ec4bec43ec4,0xbedb3f3ebf713f80,0xbf673f2cbeacbd49,0xbf623e953ef1bf75,0x3ef1bf753f62be95,0x3f04bf7d3e793f4e,0x3f5c3e16bf783f18,0x3f553f0ebf55bf0e,0xbf0e3f553f0ebf55,0xbf183f043f7d3e79,0xbf4ebf5c3e163f78,0xbf46bf7fbf223dc9,0x3f22bdc9bf46bf7f,0x3f2c3eacbd49bedb,0x3f3e3f713f803f67
.quad 0x3f803f803f803f80,0,0x3f803f673f2c3eac,0xbd49bedbbf3ebf71,0x3f7f3f22bdc9bf46,0xbdc9bf46bf7fbf22,0x3f7d3e79bf4ebf5c,0xbe16bf78bf183f04,0x3f7bbe48bf7b3e48,0xbe48bf7b3e483f7b,0x3f78bf18bf043f7d,0xbe79bf4e3f5c3e16,0x3f75bf623e953ef1,0xbe95bef13f75bf62,0x3f71bf803f67bf2c,0xbeacbd493edbbf3e
.quad 0x3f6dbf6d3f6dbf6d,0xbec43ec4bec43ec4,0x3f67bf2c3eac3d49,0xbedb3f3ebf713f80,0x3f62be95bef13f75,0xbef13f75bf623e95,0x3f5c3e16bf783f18,0xbf043f7dbe79bf4e,0x3f553f0ebf55bf0e,0xbf0e3f553f0ebf55,0x3f4e3f5cbe16bf78,0xbf183f043f7d3e79,0x3f463f7f3f22bdc9,0xbf223dc93f463f7f,0x3f3e3f713f803f67,0xbf2cbeac3d493edb
.quad 0x3f7f3f7f3f803f80,0x3dc23d903d3c3cb0,0xbd3c3eba3f363f6f,0x3f803f6f3f343eb7,0xbf80bf303d563f42,0x3b493f3a3f803f27,0xbd56bf73bf223efe,0xbf80be9f3f463f5e,0x3f7fbe00bf7d3e32,0xbdcfbf7e3e193f7c,0x3e193f58bf55be2c,0x3f7dbf0abf0e3f7c,0xbf7b3f59be7cbefb,0x3e4b3f08bf783f5f,0xbe7cbdf43ef0bf41,0xbf783f7ebf623f28
.quad 0x3f75bf733f71bf6f,0xbe963ea2beae3eba,0x3eaebf313f6dbf80,0x3f71bf393ec23ce2,0xbf6c3eb73edcbf73,0x3ec5bf6f3f67be9f,0xbedc3f7fbe93bf4a,0xbf67bd9d3f75bf1d,0x3f613efebf5bbf0a,0xbef33f5e3f04bf58,0x3f04bf13bf7bbe63,0x3f5b3f52be45bf7a,0xbf54bf7cbf193df4,0x3f0fbe2cbf4dbf7e,0xbf19be8a3dc23ee5,0xbf4dbf77bf7fbf65
.quad 0x3f7b3f7c3f7d3f7e,0x3e453e2c3e133df4,0xbf7dbf77bf45bee5,0xbe133e8a3f233f65,0x3f7f3f413d3cbf31,0x3dc2bf28bf80bf39,0xbf80bece3f363f6a,0xbd3c3f6a3f34bed1,0x3f80bce2bf803d9d,0xbb49bf803d563f7f,0xbf803ee83f22bf77,0x3d563f64bf46be87,0x3f7fbf4a3e193f13,0xbdcfbf1d3f7dbf52,0xbf7d3f7abf553f14,0x3e193e5dbf0e3f51
.quad 0x3f7bbf7a3f78bf77,0xbe4b3e63be7c3e8a,0xbf783f49bef03d90,0x3e7cbf1e3f62bf7f,0x3f75bee5beae3f6a,0xbe963f65bf713ece,0xbf713cb03f6dbf30,0x3eaebf803ec23f3a,0x3f6c3ed1bf67bee8,0xbec53f6a3edcbf64,0xbf67bf423e933f7e,0x3edcbf27bf75be00,0x3f613f773f04be5d,0xbef33e873f5b3f7a,0xbf5bbf7cbf7bbf59,0x3f043e32be45bf08
.quad 0x3f753f773f793f7a,0x3e933e873e763e5d,0x3e76be32bf0fbf59,0xbf79bf7cbf54bf08,0xbf7bbf51be133f1e,0xbe453f143f7d3f49,0xbe133f5f3f45bea2,0x3f7d3efbbf23bf73,0x3f7f3d90bf80bcb0,0x3dc2bf7fbd3c3f80,0x3d3cbf6f3f363eb7,0xbf803eba3f34bf6f,0xbf803f3abd56bf27,0x3b493f30bf803f42,0x3d563e9fbf223f5e,0x3f80bf733f46befe
.quad 0x3f7fbf7e3f7dbf7c,0xbdcf3e00be193e32,0xbe193f0abf553f7c,0xbf7d3f58bf0e3e2c,0xbf7b3f083e7cbf5f,0x3e4bbf593f78befb,0x3e7cbf7e3ef03f28,0x3f78bdf4bf623f41,0x3f753ea2bf71beba,0xbe963f733eaebf6f,0xbeae3f393f6d3ce2,0xbf71bf313ec23f80,0xbf6cbf6fbedc3e9f,0x3ec5beb7bf67bf73,0x3edc3d9dbe93bf1d,0x3f673f7f3f753f4a
.quad 0x3f6d3f6f3f713f73,0x3ec23eb73eab3e9f,0x3f713f7f3f613f1d,0x3eabbd9dbef3bf4a,0x3f753f5e3e76bf0a,0x3e93befebf79bf58,0x3f793f13bf0fbf7a,0x3e76bf52bf543e63,0x3f7b3e2cbf7dbdf4,0x3e45bf7cbe133f7e,0x3f7dbe8abf453f65,0x3e13bf773f233ee5,0x3f7fbf28bd3c3f39,0x3dc2bf413f80bf31,0x3f80bf6a3f36bed1,0x3d3cbece3f34bf6a
.quad 0x3f80bf803f80bf7f,0xbb493ce2bd563d9d,0x3f80bf643f22be87,0xbd563ee8bf463f77,0x3f7fbf1dbe193f52,0xbdcf3f4abf7d3f13,0x3f7dbe5dbf553f51,0xbe193f7abf0ebf14,0x3f7b3e63bf78be8a,0xbe4b3f7a3e7cbf77,0x3f783f1ebef0bf7f,0xbe7c3f493f62bd90,0x3f753f653eaebece,0xbe963ee53f713f6a,0x3f713f803f6d3f3a,0xbeae3cb03ec23f30
.quad 0x3f7b3f7d3f7f3f80,0x3e423e103dbc3d30,0xbe103e983f2d3f6d,0x3f7d3f753f3d3ec1,0xbf7fbf3d3bc93f3f,0xbdbc3f2d3f803f2b,0x3d30bf6dbf2b3ef4,0xbf80bec13f3f3f61,0x3f80bd62bf7f3e1c,0xbbc9bf803dd53f7d,0x3d623f61bf4fbe42,0x3f80bef4bf173f7b,0xbf7f3f4fbe4ebf02,0x3dd53f17bf7b3f5c,0xbe1cbe423f02bf45,0xbf7d3f7bbf5c3f24
.quad 0x3f7bbf783f75bf71,0xbe4e3e7fbe983eaf,0x3e7fbf243f68bf80,0x3f78bf453ed83bc9,0xbf753ed83ec7bf72,0x3e98bf683f6cbeaa,0xbeaf3f80beaabf47,0xbf71bbc93f72bf21,0x3f6c3edebf61bf05,0xbec73f673ef4bf5b,0x3edebf21bf79be4e,0x3f673f47be73bf7b,0xbf61bf79bf103e10,0x3ef4be73bf54bf7d,0xbf05be4e3e103eef,0xbf5bbf7bbf7dbf63
.quad 0x3f6d3f723f753f79,0x3ec13eaa3e923e73,0xbf72bf7fbf5bbf0d,0xbeaa3dd53f053f56,0x3f753f5b3e42bf1a,0x3e92bf05bf7bbf4d,0xbf79bf0d3f1a3f75,0xbe733f563f4dbe98,0x3f7b3e10bf7fbd30,0x3e42bf7dbdbc3f80,0xbf7d3e983f3dbf6d,0xbe103f75bf2dbec1,0x3f7fbf2d3bc93f2b,0x3dbcbf3d3f80bf3f,0xbf803f6dbf3f3ef4,0xbd303ec1bf2b3f61
.quad 0x3f80bf803f7fbf7d,0xbbc93d62bdd53e1c,0xbf803f61bf173e42,0x3d62bef43f4fbf7b,0x3f7fbf17be4e3f5c,0xbdd53f4fbf7b3f02,0xbf7d3e423f5cbf45,0x3e1cbf7b3f023f24,0x3f7b3e7fbf75beaf,0xbe4e3f783e98bf71,0xbf78bf243ed83f80,0x3e7fbf45bf68bbc9,0x3f753f683ec7beaa,0xbe983ed83f6c3f72,0xbf71bf80bf72bf47,0x3eaf3bc9beaabf21
.quad 0x3f563f5c3f633f68,0x3f0d3f023eef3ed8,0x3f023dbcbeafbf36,0xbf5cbf7fbf71bf34,0xbf63bf71bec13ede,0xbeef3eaf3f6d3f67,0xbed83f363f67bdd5,0x3f683f34bedebf7f,0x3f6d3eaabf75be73,0x3ec1bf72be923f79,0x3eaabf7f3f053f0d,0xbf723dd53f5bbf56,0xbf753f053e42bf4d,0xbe923f5bbf7b3f1a,0xbe733f0dbf4d3f75,0x3f79bf563f1abe98
.quad 0x3f7bbf7d3f7fbf80,0x3e42be103dbcbd30,0x3e103e98bf2d3f6d,0xbf7d3f75bf3d3ec1,0xbf7f3f3d3bc9bf3f,0xbdbcbf2d3f80bf2b,0xbd30bf6d3f2b3ef4,0x3f80bec1bf3f3f61,0x3f803d62bf7fbe1c,0xbbc93f803dd5bf7d,0xbd623f613f4fbe42,0xbf80bef43f173f7b,0xbf7fbf4fbe4e3f02,0x3dd5bf17bf7bbf5c,0x3e1cbe42bf02bf45,0x3f7d3f7b3f5c3f24
.quad 0x3f363f3f3f473f4f,0x3f343f2b3f213f17,0x3f3f3f753f7d3f54,0x3f2b3e92be1cbf10,0x3f473f7d3f0dbe7f,0x3f21be1cbf56bf78,0x3f4f3f54be7fbf7f,0x3f17bf10bf78bdbc,0x3f563f02bf63bed8,0x3f0dbf5cbeef3f68,0x3f5c3dbcbf713f36,0x3f02bf7f3eaf3f34,0x3f63beafbec13f67,0x3eefbf713f6dbede,0x3f68bf363edebdd5,0x3ed8bf343f67bf7f
.quad 0x3f6dbf723f75bf79,0x3ec1beaa3e92be73,0x3f72bf7f3f5bbf0d,0x3eaa3dd5bf053f56,0x3f75bf5b3e423f1a,0x3e923f05bf7b3f4d,0x3f79bf0dbf1a3f75,0x3e733f56bf4dbe98,0x3f7bbe10bf7f3d30,0x3e423f7dbdbcbf80,0x3f7d3e98bf3dbf6d,0x3e103f753f2dbec1,0x3f7f3f2d3bc9bf2b,0x3dbc3f3d3f803f3f,0x3f803f6d3f3f3ef4,0x3d303ec13f2b3f61
.quad 0x3f763f7a3f7e3f7f,0x3e903e573e0d3d84,0xbe703e6a3f243f6b,0x3f793f793f443ecb,0xbf7cbf48bd233f3b,0xbe3f3f1f3f803f2f,0x3e0dbf66bf333eea,0xbf7ebee23f373f64,0x3f7f3c7bbf803e07,0x3db6bf803d6f3f7e,0xbd233f69bf47be57,0x3f80bed4bf213f7a,0xbf803f43be20bf07,0x3c173f25bf7d3f5a,0xbd6fbe843f0cbf48,0xbf803f77bf563f1f
.quad 0x3f7fbf7c3f78bf72,0xbddb3e38be813ea5,0x3e20bf153f63bf80,0x3f7dbf503eedbc7b,0xbf7b3ef83eb1bf70,0x3e51bf603f70beb4,0xbe813f7fbec0bf43,0xbf783d843f6dbf25,0x3f743ebdbf66bf00,0xbe993f6e3edfbf5e,0x3eb1bf2fbf76be38,0x3f703f3bbe90bf7c,0xbf6cbf74bf063e26,0x3ec8be9cbf5abf7d,0xbedfbe073e3f3ef8,0xbf66bf7ebf7cbf60
.quad 0x3f563f603f683f70,0x3f0c3ef83ed73eb4,0xbf5dbf7fbf6cbf25,0xbf02bd843ec83f43,0x3f633f6e3ea8bf00,0x3eedbebdbf72bf5e,0xbf68bf2f3ef63f7c,0xbed73f3b3f61be38,0x3f6d3e9cbf79be26,0x3ec0bf74be703f7d,0xbf723e073f54bf60,0xbea83f7ebf10bef8,0x3f76bf0bbe0d3f40,0x3e90bf573f7ebf29,0xbf793f5abf243ebd,0xbe703f07bf443f6e
.quad 0x3f7cbf7e3f80bf80,0x3e3fbde83d233d0a,0xbf7e3f72bf333e9c,0xbe0dbea53f37bf74,0x3f7fbf38bd6f3f4b,0x3db63f32bf803f1c,0xbf803eb43f47bf57,0xbd23bf703f213f0b,0x3f803da9bf7dbe6a,0xbc173f7f3e20bf79,0xbf80bf003f0c3f7e,0x3d6fbf5ebf563de8,0x3f7f3f533e81bee2,0xbddb3f113f783f66,0xbf7dbf7dbf63bf32,0x3e20be26beedbf38
.quad 0x3f243f323f3f3f4b,0x3f443f383f2a3f1c,0x3f3c3eb4bddbbf0b,0xbf2ebf70bf7fbf57,0xbf37bf7fbf173e6a,0xbf333da93f4f3f79,0xbf2a3f003f7b3de8,0x3f3f3f5ebe51bf7e,0x3f473f11bf5dbee2,0x3f21bf53bf023f66,0x3f17bf7d3e993f38,0xbf4fbe263f74bf32,0xbf563e8d3ed7bf69,0xbf0c3f76bf683ed4,0xbf023f40bf6c3f7f,0x3f5dbf293ec8bda9
.quad 0x3f63bf6b3f72bf77,0x3eedbecb3ea8be84,0x3ed73d0abef63f53,0xbf683f80bf613f11,0xbf6d3f64be70bf15,0xbec0beea3f79bf50,0xbea8bf4b3f543e8d,0x3f72bf1cbf103f76,0x3f76be57bf7e3d84,0x3e903f7abe0dbf7f,0x3e703f793f24becb,0xbf79be6a3f443f6b,0xbf7cbf1f3d233f2f,0xbe3fbf48bf80bf3b,0xbe0dbee2bf33bf64,0x3f7e3f663f373eea
.quad 0x3ec83eea3f063f15,0x3f6c3f643f5a3f50,0x3edf3f4b3f7c3f76,0x3f663f1c3e3fbe8d,0x3ef63f7a3f4c3d84,0x3f613e57bf1abf7f,0x3f063f793db6bf6b,0x3f5abe6abf7fbecb,0x3f103f48bf2ebf2f,0x3f54bf1fbf3c3f3b,0x3f1a3ee2bf803eea,0x3f4cbf663c173f64,0x3f243c7bbf2a3f7e,0x3f44bf803f3fbe07,0x3f2ebed43ddb3e57,0x3f3cbf693f7fbf7a
.quad 0x3f37bf433f4fbf5a,0x3f33bf253f17bf07,0x3f3fbf773f7bbf48,0x3f2abe84be513f1f,0x3f47bf7c3f023ea5,0x3f213e38bf5d3f72,0x3f4fbf50be993f80,0x3f173f15bf743c7b,0x3f56bef8bf683eb4,0x3f0c3f60bed7bf70,0x3f5dbd84bf6cbf43,0x3f023f7f3ec8bf25,0x3f633ebdbea8bf5e,0x3eed3f6e3f723f00,0x3f683f3b3ef63e38,0x3ed73f2f3f613f7c
.quad 0x3f6e3f763f7c3f7f,0x3ebe3e8f3e3b3db0,0xbea73e233f1b3f69,0x3f723f7d3f4c3ed5,0xbf76bf53bdb03f37,0xbe8f3f113f7f3f33,0x3e6dbf5dbf3c3ee1,0xbf79bf013f2e3f66,0x3f7c3db0bf803de2,0x3e3bbf7f3c493f7e,0xbe0a3f70bf40be6d,0x3f7ebeb2bf2a3f79,0xbf7f3f37bde2bf0c,0xbdb03f33bf7e3f57,0x3d17bea73f16bf4c,0xbf803f72bf4f3f1b
.quad 0x3f80bf7e3f7abf74,0xbc493de2be543e9b,0x3d7bbf063f5dbf80,0x3f80bf5a3f01bd17,0xbf7e3f0c3e9bbf6e,0x3de2bf573f74bebe,0xbe233f7ebed5bf40,0xbf7d3e0a3f69bf2a,0x3f7a3e9bbf6bbef7,0xbe543f743ecabf60,0x3e82bf3cbf72be23,0x3f783f2ebea7bf7d,0xbf74bf6ebef73e3b,0x3e9bbebebf60bf7c,0xbeb2bd7b3e6d3f01,0xbf70bf80bf79bf5d
.quad 0x3f373f483f573f63,0x3f333f203f0c3eec,0xbf40bf79bf78bf3c,0xbf2abe6d3e823f2e,0x3f483f7a3eecbeca,0x3f20be54bf63bf6b,0xbf4fbf4c3eb23f80,0xbf163f1b3f70bd7b,0x3f573eecbf6ebe8f,0x3f0cbf63bebe3f76,0xbf5dbd173f66bf4f,0xbf013f80bee1bf16,0x3f63becabe8f3f53,0x3eecbf6b3f76bf11,0xbf693f40bf063e82,0xbed53f2abf5a3f78
.quad 0x3f6ebf763f7cbf7f,0x3ebebe8f3e3bbdb0,0xbf723f7dbf4c3ed5,0xbea7be233f1bbf69,0x3f76bf533db03f37,0x3e8f3f11bf7f3f33,0xbf793f013f2ebf66,0xbe6dbf5d3f3c3ee1,0x3f7cbdb0bf80bde2,0x3e3b3f7f3c49bf7e,0xbf7ebeb23f2a3f79,0xbe0abf70bf403e6d,0x3f7f3f373de2bf0c,0x3db03f333f7e3f57,0xbf80bf72bf4fbf1b,0xbd17bea7bf16bf4c
.quad 0x3eca3ef73f113f25,0x3f6b3f603f533f44,0x3f663f163e0abeb2,0xbee1bf4fbf7ebf70,0xbef7bf7cbf443c49,0xbf60be3b3f253f80,0xbf5a3e823f803ea7,0x3f063f783d17bf72,0x3f113f44bf37bf20,0x3f53bf25bf333f48,0x3f4cbf693d7b3f5a,0xbf1bbed53f80bf06,0xbf253c493f20bf7a,0xbf443f80bf483e54,0xbf3c3f66bf7d3f7e,0x3f2ebee13e233e0a
.quad 0x3f37bf483f57bf63,0x3f33bf203f0cbeec,0x3f2abe6dbe823f2e,0xbf403f79bf783f3c,0xbf483f7abeecbeca,0xbf20be543f63bf6b,0xbf16bf1b3f703d7b,0x3f4fbf4cbeb23f80,0x3f57beecbf6e3e8f,0x3f0c3f63bebebf76,0x3f013f803ee1bf16,0xbf5d3d173f663f4f,0xbf63beca3e8f3f53,0xbeecbf6bbf76bf11,0xbed5bf2abf5abf78,0x3f693f403f063e82
.quad 0x3c493de23e543e9b,0x3f803f7e3f7a3f74,0x3d7b3f063f5d3f80,0x3f803f5a3f013d17,0x3de23f573f743ebe,0x3f7e3f0cbe9bbf6e,0x3e233f7e3ed5bf40,0x3f7d3e0abf69bf2a,0x3e543f74becabf60,0x3f7abe9bbf6b3ef7,0x3e823f3cbf723e23,0x3f78bf2ebea73f7d,0x3e9b3ebebf603f7c,0x3f74bf6e3ef73e3b,0x3eb2bd7bbe6d3f01,0x3f70bf803f79bf5d
.quad 0x3ecabef73f11bf25,0x3f6bbf603f53bf44,0x3ee1bf4f3f7ebf70,0x3f66bf163e0a3eb2,0x3ef7bf7c3f443c49,0x3f60be3bbf253f80,0x3f06bf783d173f72,0x3f5a3e82bf803ea7,0x3f11bf44bf373f20,0x3f533f25bf33bf48,0x3f1bbed5bf80bf06,0x3f4c3f693d7bbf5a,0x3f253c49bf20bf7a,0x3f443f803f483e54,0x3f2e3ee13e23be0a,0x3f3c3f663f7d3f7e
.quad 0x3f643f703f793f7f,0x3eea3eb13e6a3ddb,0xbed43db63f113f66,0x3f693f7f3f533edf,0xbf6ebf5dbe073f33,0xbebd3f023f7e3f37,0x3ea5bf54bf433ed7,0xbf72bf103f253f68,0x3f763e20bf803db6,0x3e8dbf7dbd0a3f7f,0xbe6a3f76bf38be81,0x3f79be90bf323f78,0xbf7c3f2abd84bf10,0xbe383f3fbf7f3f54,0x3e07bec83f1fbf4f,0xbf7e3f6cbf483f17
.quad 0x3f7fbf803f7dbf76,0x3da93d23be263e90,0xbd0abeed3f57bf80,0x3f80bf633f0bbd6f,0xbf803f1a3e84bf6c,0x3c7bbf4c3f77bec8,0xbd843f7bbeeabf3c,0xbf7f3e513f64bf2e,0x3f7e3e70bf70beed,0xbde83f793eb4bf63,0x3e26bf47bf6ebe0d,0x3f7d3f21bebdbf7e,0xbf7abf66bee23e51,0x3e57bedfbf66bf7b,0xbe843c173e8d3f06,0xbf77bf80bf76bf5a
.quad 0x3f113f2a3f403f54,0x3f533f3f3f293f10,0xbf1cbf6cbf7ebf4f,0xbf4bbec83de83f17,0x3f253f803f15be90,0x3f43bd23bf50bf76,0xbf2fbf633e573f80,0xbf3b3eed3f7a3d6f,0x3f383f1abf5ebec8,0x3f32bf4cbf003f6c,0xbf40be513f74bf3c,0xbf293f7bbe9cbf2e,0x3f48be70bed43f63,0x3f1fbf793f69beed,0xbf503f21becb3e0d,0xbf153f47bf6b3f7e
.quad 0x3f57bf663f72bf7b,0x3f0bbedf3ea5be51,0xbf5e3f80bf603f06,0xbf003c173ef8bf5a,0x3f64bf683e6a3f21,0x3eea3ed7bf793f47,0xbf693f243f11bf72,0xbed4bf443f533ea8,0x3f6ebe81bf7e3c17,0x3ebd3f78be07bf80,0xbf72be3f3f433f70,0xbea5bf7cbf253eb1,0x3f763f17bd0abf24,0x3e8d3f4f3f803f44,0xbf79bf61bf38bf02,0xbe6abef6bf32bf5d
.quad 0x3de83e703eb43eed,0x3f7e3f793f703f63,0x3f7d3f473ebdbe0d,0xbe26bf21bf6ebf7e,0xbe57bf66bf66be51,0xbf7abedf3ee23f7b,0xbf77bc173f763f06,0x3e843f803e8dbf5a,0x3e9c3f68bf07bf47,0x3f74bed7bf5a3f21,0x3f70bf44be383f72,0xbeb4bf243f7cbea8,0xbecbbe813f4bbf80,0xbf6b3f78bf1cbc17,0xbf663f7cbf7f3f70,0x3ee2be3fbda93eb1
.quad 0x3ef8bf173f2fbf44,0x3f60bf4f3f3bbf24,0x3f5abef6bc7b3f02,0xbf073f61bf803f5d,0xbf113f80bf29be3f,0xbf533d6f3f40bf7c,0xbf4bbec03f7ebe20,0x3f1cbf6dbde83f7d,0x3f25bf2ebf503ef6,0x3f433f3cbf15bf61,0x3f3b3f743e57bf3f,0xbf2f3e993f7a3f2a,0xbf38be0d3f003f6d,0xbf32bf7ebf5ebec0,0xbf29bf56bf74bf80,0x3f403f0c3e9c3d23
.quad 0xbebdbe81be07bc17,0x3f6e3f783f7e3f80,0xbea53e3f3f253f70,0x3f723f7c3f433eb1,0xbe8d3f173f803f24,0x3f763f4f3d0abf44,0xbe6a3f613f32bf02,0x3f793ef6bf38bf5d,0xbe383f80bd84bf7c,0x3f7c3d6fbf7f3e3f,0xbe073f6dbf48be20,0x3f7ebec0bf1f3f7d,0xbda93f2ebf7d3f61,0x3f7fbf3c3e263ef6,0xbd0a3e99bf0b3f3f,0x3f80bf743f57bf2a
.quad 0x3c7bbe0d3e84bec0,0x3f80bf7e3f77bf6d,0x3d84bf0c3f64bf80,0x3f7fbf563eea3d23,0x3de8bf5a3f70be99,0x3f7ebf06beb43f74,0x3e26bf7f3ebd3f4c,0x3f7dbddbbf6e3f1a,0x3e57bf72bee23f56,0x3f7a3ea8bf66bf0c,0x3e84bf37bf76be70,0x3f773f33be8dbf79,0x3e9cbeb1bf5abf7f,0x3f743f703f07bddb,0x3eb43db6be38bedf,0x3f703f7f3f7c3f66
.quad 0x3f573f693f763f7e,0x3f0a3ed23e8c3e04,0xbeff3c973f083f64,0x3f5e3f803f593ee9,0xbf64bf65be353f2f,0xbee93ee33f7c3f3a,0x3ed2bf49bf4b3ecd,0xbf69bf1f3f1c3f6b,0x3f6e3e66bf7f3d8a,0x3ebbbf79bda33f7f,0xbea43f7abf2fbe8c,0x3f73be5abf3a3f76,0xbf763f1cbc97bf15,0xbe8c3f4bbf803f50,0x3e66bee93f28bf52,0xbf793f64bf413f12
.quad 0x3f7cbf803f7ebf77,0x3e35bcfbbdee3e86,0xbe04becd3f50bf7f,0x3f7ebf6b3f15bda3,0xbf7f3f283e5abf69,0xbda3bf413f7abed2,0x3cfb3f76beffbf38,0xbf803e8c3f5ebf32,0x3f803e29bf74bee3,0xbc973f7c3e9ebf65,0x3d8abf52bf69bdee,0x3f7f3f12bed2bf7e,0xbf7ebf5ebecd3e66,0x3deebeffbf6bbf79,0xbe293da33ea43f0a,0xbf7cbf7fbf73bf57
.quad 0x3ecd3f083f263f41,0x3f6b3f593f433f28,0xbee3bf57bf80bf60,0xbf65bf0abcfb3efa,0x3efa3f7e3f32be29,0x3f603e04bf38bf7c,0xbf08bf743d8a3f7c,0xbf593e9e3f7f3e35,0x3f123f3abf49beff,0x3f52bf2fbf1f3f5e,0xbf1cbebb3f7cbf26,0xbf4b3f6ebe29bf43,0x3f26bd8abf0a3f6f,0x3f43bf7f3f57beb5,0xbf2f3efabe863c97,0xbf3a3f60bf773f80
.quad 0x3f38bf503f64bf73,0x3f32bf153ee9bea4,0xbf413f7cbf6f3f1f,0xbf283e353eb5bf49,0x3f49bf773ebb3f08,0x3f1f3e86bf6e3f59,0xbf503f433ee3bf7a,0xbf15bf263f653e5a,0x3f57bed2bf763e04,0x3f0a3f69be8cbf7e,0xbf5ebc973f593f64,0xbeffbf80bf083ee9,0x3f643ee3be35bf3a,0x3ee93f653f7c3f2f,0xbf69bf49bf1cbecd,0xbed2bf1fbf4bbf6b
.quad 0xbe35bcfb3dee3e86,0x3f7c3f803f7e3f77,0x3f7e3f6b3f153da3,0x3e04becdbf50bf7f,0x3da3bf41bf7abed2,0xbf7fbf283e5a3f69,0xbf80be8c3f5e3f32,0xbcfb3f763effbf38,0x3c973f7cbe9ebf65,0x3f80be29bf743ee3,0x3f7fbf12bed23f7e,0xbd8abf523f69bdee,0xbdeebeff3f6bbf79,0xbf7e3f5ebecdbe66,0xbf7c3f7fbf733f57,0x3e293da3bea43f0a
.quad 0x3e5abeb53efabf1c,0x3f7abf6f3f60bf4b,0x3f77bf323e663e9e,0xbe863f38bf793f74,0xbe9e3f73bf523cfb,0xbf743ea43f12bf80,0xbf6fbdee3f7ebebb,0x3eb5bf7e3e043f6e,0x3ecdbf59bf263f28,0x3f6b3f08bf43bf41,0x3f653f57bcfbbf60,0xbee33f0a3f803efa,0xbefa3e043f323f7c,0xbf60bf7ebf38be29,0xbf59bf74bf7fbf7c,0x3f083e9e3d8abe35
.quad 0xbf32bf15bee9bea4,0x3f383f503f643f73,0xbf28be353eb53f49,0x3f413f7c3f6f3f1f,0xbf1f3e863f6e3f59,0x3f493f773ebbbf08,0xbf153f263f65be5a,0x3f503f43bee3bf7a,0xbf0a3f693e8cbf7e,0x3f573ed2bf76be04,0xbeff3f80bf08bee9,0x3f5ebc97bf593f64,0xbee93f65bf7c3f2f,0x3f64bee3be353f3a,0xbed23f1fbf4b3f6b,0x3f69bf493f1cbecd
.quad 0xbebb3e66bda3bd8a,0x3f6ebf793f7fbf7f,0xbea4be5a3f2fbf76,0x3f73bf7a3f3abe8c,0xbe8cbf1c3f80bf15,0x3f76bf4bbc973f50,0xbe66bf643f283f12,0x3f79bee9bf413f52,0xbe35bf80bdee3f77,0x3f7cbcfbbf7ebe86,0xbe04bf6bbf503da3,0x3f7e3ecdbf15bf7f,0xbda3bf28bf7abf69,0x3f7f3f413e5abed2,0xbcfbbe8cbeffbf32,0x3f803f763f5e3f38
.quad 0x3f493f613f733f7d,0x3f1e3ef33ea23e19,0xbf14bd563efb3f61,0x3f513f803f5f3ef3,0xbf58bf6dbe633f2b,0xbf0a3ec23f7a3f3e,0x3efebf3dbf523ec2,0xbf5ebf2d3f133f6d,0x3f643e96bf7e3d3c,0x3ee8bf75be003f80,0xbed13f7dbf27be96,0x3f6abe13bf423f75,0xbf6f3f0e3ce2bf19,0xbeba3f55bf803f4d,0x3ea2bf043f31bf55,0xbf733f5bbf393f0e
.quad 0x3f77bf7f3f7fbf79,0x3e8abdcfbd903e76,0xbe63beab3f49bf7f,0x3f7abf713f1ebdcf,0xbf7c3f363e2cbf67,0xbe32bf343f7cbedc,0x3e003f71bf0abf34,0xbf7e3eae3f58bf36,0x3f7f3dc2bf77bed9,0x3d9d3f7f3e87bf68,0xbce2bf5cbf64bdc2,0x3f803f03bee8bf7f,0xbf80bf54beb73e7c,0x3cb0bf0fbf6fbf78,0xbd903e193eba3f0f,0xbf7fbf7dbf6fbf54
.quad 0x3e5d3ec23f083f2b,0x3f7a3f6d3f593f3e,0xbe87bf3dbf7cbf6d,0xbf77bf2dbe323ec2,0x3e9f3f753f4abd3c,0x3f733e96bf1dbf80,0xbeb7bf7dbd9d3f75,0xbf6f3e133f7f3e96,0x3ece3f55bf30bf19,0x3f6abf0ebf3a3f4d,0xbee5bf043f80bf0e,0xbf653f5bbcb0bf55,0x3efb3dcfbf283f79,0x3f5fbf7f3f41be76,0xbf083eabbdf4bdcf,0xbf593f71bf7e3f7f
.quad 0x3f13bf343f51bf67,0x3f52bf363f14bedc,0xbf1d3f71bf7a3f36,0xbf4a3eae3e5dbf34,0x3f27bf7f3efe3ed9,0x3f423dc2bf5e3f68,0xbf303f5c3e9fbf7f,0xbf3abf033f733dc2,0x3f39bf0fbf6a3e7c,0x3f313f54bed1bf78,0xbf413e193f6a3f54,0xbf28bf7dbece3f0f,0x3f493e93bea2bf4e,0x3f1e3f753f733f18,0xbf51bf2bbefbbe93,0xbf14bf3ebf5fbf75
.quad 0xbee8be96be003d3c,0x3f643f753f7e3f80,0x3f6a3f7d3f423e96,0x3ed1be13bf27bf75,0x3ebabf0ebf80bf19,0xbf6fbf55bce23f4d,0xbf73bf043f393f55,0xbea23f5b3f31bf0e,0xbe8a3f7fbd90bf79,0x3f773dcfbf7f3e76,0x3f7abeabbf1e3f7f,0x3e63bf713f493dcf,0x3e32bf363f7cbf67,0xbf7c3f34be2cbedc,0xbf7e3f71bf583f34,0xbe003eaebf0a3f36
.quad 0xbd9dbdc23e87bed9,0x3f7fbf7f3f77bf68,0x3f80bf5c3ee83dc2,0x3ce23f03bf643f7f,0xbcb03f54bf6f3e7c,0xbf803f0f3eb7bf78,0xbf7f3e193f6fbf0f,0x3d90bf7d3eba3f54,0x3df4bf75bee53f4e,0x3f7e3e93bf65bf18,0x3f7c3f2bbe8abf75,0xbe2c3f3e3f773e93,0xbe5d3ec53f593f80,0xbf7abf6cbf083d56,0xbf77bf80bf7cbf6c,0x3e873d3cbe32bec5
.quad 0xbf6abf55bf3abf19,0x3ece3f0e3f303f4d,0xbf65bf043cb03f0e,0x3ee53f5b3f803f55,0xbf5fbdcf3f413f79,0x3efb3f7f3f28be76,0xbf593eab3f7e3dcf,0x3f083f71bdf4bf7f,0xbf523f343f14bf67,0x3f133f36bf51bedc,0xbf4a3f71be5dbf36,0x3f1d3eaebf7a3f34,0xbf423f7fbf5e3ed9,0x3f27bdc2befe3f68,0xbf3a3f5cbf733f7f,0x3f30bf033e9fbdc2
.quad 0xbf313f0fbed13e7c,0x3f39bf543f6abf78,0xbf283e193ecebf54,0x3f41bf7d3f6abf0f,0xbf1ebe933f73bf4e,0x3f49bf753ea23f18,0xbf14bf2b3f5f3e93,0x3f51bf3ebefb3f75,0xbf0abf6c3e633f80,0x3f58bec5bf7a3d56,0xbefebf80bf133ec5,0x3f5e3d3cbf52bf6c,0xbee8bf62bf7ebf3d,0x3f643ef0be00bf2d,0xbed1bf19bf42bf62,0x3f6a3f4d3f273ef0
.quad 0x3f393f583f6f3f7c,0x3f313f093eb83e2f,0xbf27bdfb3ee63f5f,0x3f423f7e3f653efc,0xbf4abf73be893f27,0xbf1d3ea13f773f42,0x3f13bf31bf583eb8,0xbf51bf393f093f6f,0x3f583eb8bf7c3cc9,0x3f09bf6fbe2f3f80,0xbefc3f7fbf1dbea1,0x3f5fbd97bf4a3f73,0xbf653efc3d97bf1d,0xbee63f5fbf7f3f4a,0x3ecfbf133f39bf58,0xbf6a3f51bf313f09
.quad 0x3f6fbf7c3f80bf7a,0x3eb8be2fbcc93e60,0xbea1be893f42bf7e,0x3f73bf773f27bdfb,0xbf773f423dfbbf65,0xbe89bf273f7ebee6,0x3e603f6abf13bf31,0xbf7a3ecf3f51bf39,0x3f7c3cc9bf7abecf,0x3e2f3f803e60bf6a,0xbdfbbf65bf5fbd97,0x3f7e3ee6befcbf7f,0xbf7fbf4abea13e89,0xbd97bf1dbf73bf77,0x3cc93e603ecf3f13,0xbf80bf7abf6abf51
.quad 0x3cc93e603ecf3f13,0x3f803f7a3f6a3f51,0xbd97bf1dbf73bf77,0xbf7fbf4abea13e89,0x3dfb3f653f5f3d97,0x3f7e3ee6befcbf7f,0xbe2fbf80be603f6a,0xbf7cbcc93f7a3ecf,0x3e603f6abf13bf31,0x3f7abecfbf513f39,0xbe89bf273f7ebee6,0xbf773f423dfbbf65,0x3ea13e89bf423f7e,0x3f73bf773f27bdfb,0xbeb83e2f3cc9be60,0xbf6f3f7cbf803f7a
.quad 0x3ecfbf133f39bf58,0x3f6abf513f31bf09,0xbee63f5fbf7f3f4a,0xbf653efc3d97bf1d,0x3efcbf7f3f1d3ea1,0x3f5fbd97bf4a3f73,0xbf093f6f3e2fbf80,0xbf58beb83f7cbcc9,0x3f13bf31bf583eb8,0x3f513f39bf09bf6f,0xbf1d3ea13f773f42,0xbf4abf73be893f27,0x3f273dfbbee6bf5f,0x3f423f7e3f653efc,0xbf31bf09beb8be2f,0xbf39bf58bf6fbf7c
.quad 0xbf31bf09beb8be2f,0x3f393f583f6f3f7c,0x3f423f7e3f653efc,0x3f273dfbbee6bf5f,0x3f1dbea1bf77bf42,0xbf4abf73be893f27,0xbf51bf393f093f6f,0xbf133f313f58beb8,0xbf093f6f3e2fbf80,0x3f583eb8bf7c3cc9,0x3f5fbd97bf4a3f73,0x3efcbf7f3f1d3ea1,0x3ee6bf5f3f7fbf4a,0xbf653efc3d97bf1d,0xbf6a3f51bf313f09,0xbecf3f13bf393f58
.quad 0xbeb83e2f3cc9be60,0x3f6fbf7c3f80bf7a,0x3f73bf773f27bdfb,0x3ea13e89bf423f7e,0x3e893f27bf7e3ee6,0xbf773f423dfbbf65,0xbf7a3ecf3f51bf39,0xbe60bf6a3f133f31,0xbe2fbf80be603f6a,0x3f7c3cc9bf7abecf,0x3f7e3ee6befcbf7f,0x3dfb3f653f5f3d97,0x3d973f1d3f733f77,0xbf7fbf4abea13e89,0xbf80bf7abf6abf51,0xbcc9be60becfbf13
.quad 0xbf80bf7abf6abf51,0x3cc93e603ecf3f13,0xbf7fbf4abea13e89,0x3d973f1d3f733f77,0xbf7ebee63efc3f7f,0x3dfb3f653f5f3d97,0xbf7cbcc93f7a3ecf,0x3e2f3f803e60bf6a,0xbf7a3ecf3f51bf39,0x3e603f6abf13bf31,0xbf773f423dfbbf65,0x3e893f27bf7e3ee6,0xbf733f77bf273dfb,0x3ea13e89bf423f7e,0xbf6f3f7cbf803f7a,0x3eb8be2fbcc93e60
.quad 0xbf6a3f51bf313f09,0x3ecfbf133f39bf58,0xbf653efc3d97bf1d,0x3ee6bf5f3f7fbf4a,0xbf5f3d973f4abf73,0x3efcbf7f3f1d3ea1,0xbf58beb83f7cbcc9,0x3f09bf6fbe2f3f80,0xbf51bf393f093f6f,0x3f13bf31bf583eb8,0xbf4abf73be893f27,0x3f1dbea1bf77bf42,0xbf42bf7ebf65befc,0x3f273dfbbee6bf5f,0xbf39bf58bf6fbf7c,0x3f313f093eb83e2f
.quad 0x3f283f4e3f6a3f7b,0x3f413f183ece3e45,0xbf39be453ed13f5c,0x3f313f7b3f6a3f03,0xbf3abf78be9f3f23,0xbf303e7c3f733f45,0x3f27bf23bf5e3eae,0xbf42bf453efe3f71,0x3f4a3ed9bf7a3b49,0x3f1dbf68be5d3f80,0xbf133f80bf14beab,0x3f52bb49bf513f71,0xbf593edc3df4bf22,0xbf083f67bf7e3f46,0x3efbbf223f41bf5b,0xbf5f3f46bf283f04
.quad 0x3f65bf793f80bf7b,0x3ee5be763cb03e4b,0xbecebe4b3f3abf7d,0x3f6abf7b3f30be13,0xbf6f3f4d3d9dbf62,0xbeb7bf193f7fbef0,0x3e9f3f62bf1dbf2d,0xbf733ef03f4abf3d,0x3f77bd3cbf7cbec5,0x3e873f803e32bf6c,0xbe5dbf6cbf59bd56,0x3f7a3ec5bf08bf80,0xbf7cbf3ebe8a3e93,0xbe2cbf2bbf77bf75,0x3df43e933ee53f18,0xbf7ebf75bf65bf4e
.quad 0xbe2c3d563e8a3ef3,0x3f7c3f803f773f61,0x3df4bef3bf65bf7d,0xbf7ebf61bee53e19,0xbd903f4e3f6f3e45,0x3f7f3f18bebabf7b,0x3cb0bf7bbeb73f5c,0xbf80be453f6f3f03,0x3ce23f78bee8bf45,0x3f80be7cbf643f23,0xbd9dbf453f77beae,0xbf7f3f233e87bf71,0x3e003ed9bf583f80,0x3f7ebf683f0abb49,0xbe323b493e2cbeab,0xbf7c3f80bf7c3f71
.quad 0x3e63bedc3f1ebf46,0x3f7abf673f49bf22,0xbe8a3f46bf7f3f5b,0xbf773f22bd90bf04,0x3ea2bf793f393e4b,0x3f73be76bf313f7b,0xbeba3f7b3ce2bf7d,0xbf6fbe4b3f80be13,0x3ed1bf4dbf423ef0,0x3f6a3f19bf27bf62,0xbee83ef03f7e3f2d,0xbf64bf62be003f3d,0x3efebd3cbf13bf6c,0x3f5e3f803f523ec5,0xbf0abec5be63bd56,0xbf58bf6cbf7abf80
.quad 0xbf5ebf3dbf13bec2,0x3efe3f2d3f523f6d,0x3f0a3f6d3f7a3f2b,0x3f583ec2be63bf3e,0x3f51bd56bf5fbf61,0xbf14bf80befb3ef3,0xbf1ebf613ea23f7d,0xbf493ef33f73be19,0xbf413f4e3ecebf7b,0x3f283f18bf6abe45,0x3f313e45bf6a3f5c,0x3f39bf7b3ed13f03,0x3f30bf783f73bf23,0xbf3a3e7c3e9fbf45,0xbf423f23befe3eae,0xbf273f45bf5e3f71
.quad 0xbf1d3ed9be5dbb49,0x3f4abf683f7abf80,0x3f52bf803f51beab,0x3f133b49bf143f71,0x3f083edcbf7e3f22,0xbf593f67bdf4bf46,0xbf5f3f223f28bf5b,0xbefbbf463f413f04,0xbee5bf793cb03f7b,0x3f65be76bf80be4b,0x3f6a3e4bbf30bf7d,0x3ece3f7b3f3abe13,0x3eb73f4d3f7f3f62,0xbf6fbf19bd9d3ef0,0xbf73bf62bf4abf2d,0xbe9fbef0bf1dbf3d
.quad 0xbf6fbf7dbf7fbf75,0xbeb7be133d9d3e96,0xbf73bf75bf1dbd3c,0xbe9f3e963f4a3f80,0xbf77bf3d3e323f6d,0xbe873f2d3f7c3ec2,0xbf7abec23f593f2b,0xbe5d3f6d3f08bf3e,0xbf7c3d563f77bef3,0xbe2c3f80be8abf61,0xbf7e3ef33ee5bf7d,0xbdf43f61bf653e19,0xbf7f3f4ebebabe45,0xbd903f18bf6f3f7b,0xbf803f7bbf6f3f5c,0xbcb03e45beb73f03
.quad 0xbf803f78bf643f45,0x3ce2be7c3ee8bf23,0xbf7f3f45be87beae,0x3d9dbf233f77bf71,0xbf7e3ed93f0abf80,0x3e00bf683f583b49,0xbf7cbb493f7cbeab,0x3e32bf803e2c3f71,0xbf7abedc3f493f46,0x3e63bf67bf1e3f22,0xbf77bf463d903f5b,0x3e8abf22bf7fbf04,0xbf73bf79bf31be4b,0x3ea2be76bf39bf7b,0xbf6fbf7bbf80bf7d,0x3eba3e4b3ce2be13
.quad 0x3f153f433f653f7a,0x3f503f263ee33e5a,0xbf49be863ebb3f59,0x3f1f3f773f6e3f08,0xbf28bf7cbeb53f1f,0xbf413e353f6f3f49,0x3f38bf15bf643ea4,0xbf32bf503ee93f73,0x3f3a3efabf77bc97,0x3f2fbf60be863f80,0xbf263f7fbf0abeb5,0x3f433d8abf573f6f,0xbf4b3ebb3e29bf26,0xbf1c3f6ebf7c3f43,0x3f12bf2f3f49bf5e,0xbf523f3abf1f3eff
.quad 0x3f59bf743f7fbf7c,0x3f08be9e3d8a3e35,0xbefabe043f32bf7c,0x3f60bf7e3f38be29,0xbf653f573cfbbf60,0xbee3bf0a3f80befa,0x3ecd3f59bf26bf28,0xbf6b3f083f43bf41,0x3f6fbdeebf7ebebb,0x3eb53f7e3e04bf6e,0xbe9ebf73bf52bcfb,0x3f743ea4bf12bf80,0xbf77bf32be663e9e,0xbe86bf38bf79bf74,0x3e5a3eb53efa3f1c,0xbf7abf6fbf60bf4b
.quad 0xbeb5bdee3e043ebb,0x3f6f3f7e3f7e3f6e,0x3e9ebea4bf52bf80,0xbf74bf73bf123cfb,0xbe863f323f793e9e,0x3f773f38be66bf74,0x3e5abf6fbefa3f4b,0xbf7abeb53f603f1c,0xbe293f7fbea4bf57,0x3f7cbda3bf733f0a,0x3deebf5e3f6bbe66,0xbf7e3eff3ecdbf79,0xbd8a3f12bf693f7e,0x3f7fbf523ed23dee,0x3c97be293e9ebee3,0xbf803f7cbf743f65
.quad 0x3cfbbe8c3effbf32,0x3f80bf763f5ebf38,0xbda33f28bf7a3f69,0xbf7f3f41be5abed2,0x3e04bf6b3f503da3,0x3f7ebecdbf153f7f,0xbe353f80bdeebf77,0xbf7cbcfb3f7ebe86,0x3e66bf64bf283f12,0x3f793ee9bf41bf52,0xbe8c3f1c3f803f15,0xbf76bf4b3c973f50,0x3ea4be5abf2fbf76,0x3f733f7a3f3a3e8c,0xbebbbe66bda33d8a,0xbf6ebf79bf7fbf7f
.quad 0xbf79bf64bf41bf12,0x3e663ee93f283f52,0x3e8c3f4b3f803f50,0x3f763f1c3c97bf15,0x3f733e5abf3abf76,0xbea4bf7abf2f3e8c,0xbebbbf793da33f7f,0xbf6e3e663f7f3d8a,0xbf693f1f3f1cbf6b,0x3ed23f49bf4bbecd,0x3ee93ee3bf7c3f3a,0x3f64bf653e353f2f,0x3f5ebf803f59bee9,0xbeffbc973f08bf64,0xbf0a3ed2be8c3e04,0xbf573f69bf763f7e
.quad 0xbf503f26bee33e5a,0x3f15bf433f65bf7a,0x3f1fbf773f6ebf08,0x3f49be86bebb3f59,0x3f413e35bf6f3f49,0xbf283f7cbeb5bf1f,0xbf323f503ee9bf73,0xbf38bf153f643ea4,0xbf2fbf603e863f80,0x3f3abefabf773c97,0x3f43bd8abf57bf6f,0x3f263f7f3f0abeb5,0x3f1c3f6e3f7c3f43,0xbf4bbebb3e293f26,0xbf52bf3abf1fbeff,0xbf12bf2fbf49bf5e
.quad 0xbf3abf60bf77bf80,0xbf2fbefabe86bc97,0xbf43bf7fbf57beb5,0xbf26bd8a3f0a3f6f,0xbf4bbf6ebe293f43,0xbf1c3ebb3f7c3f26,0xbf52bf2f3f1f3f5e,0xbf123f3a3f49beff,0xbf59be9e3f7fbe35,0xbf083f743d8abf7c,0xbf603e043f38bf7c,0xbefa3f7ebf32be29,0xbf653f0abcfbbefa,0xbee33f57bf803f60,0xbf6b3f59bf433f28,0xbecd3f08bf263f41
.quad 0xbf6f3f7ebf7e3f6e,0xbeb53dee3e04bebb,0xbf743f73bf12bcfb,0xbe9ebea43f52bf80,0xbf773f383e66bf74,0xbe86bf323f79be9e,0xbf7a3eb53f60bf1c,0xbe5abf6f3efa3f4b,0xbf7cbda33f733f0a,0xbe29bf7fbea43f57,0xbf7ebeff3ecd3f79,0xbdeebf5ebf6bbe66,0xbf7fbf52bed23dee,0xbd8abf12bf69bf7e,0xbf80bf7cbf74bf65,0xbc97be29be9ebee3
.quad 0x3f003f373f603f79,0x3f5e3f333ef83e70,0xbf57bea83ea53f56,0x3f0b3f723f723f0c,0xbf15bf7fbecb3f1a,0xbf503ddb3f6b3f4c,0x3f48bf06bf693e99,0xbf1fbf5a3ed43f74,0x3f293f0cbf74bd23,0x3f40bf56be9c3f80,0xbf383f7ebf00bec0,0x3f323e0dbf5e3f6d,0xbf3b3e993e57bf2a,0xbf2f3f74bf7a3f3f,0x3f25bf3c3f50bf61,0xbf433f2ebf153ef6
.quad 0x3f4bbf6d3f7ebf7d,0x3f1cbec03de83e20,0xbf11bd6f3f29bf7c,0x3f53bf803f40be3f,0xbf5a3f61bc7bbf5d,0xbf07bef63f80bf02,0x3ef83f4fbf2fbf24,0xbf603f173f3bbf44,0x3f66be3fbf7fbeb1,0x3ee23f7c3da9bf70,0xbecbbf78bf4bbc17,0x3f6b3e81bf1cbf80,0xbf70bf24be383ea8,0xbeb4bf44bf7cbf72,0x3e9c3ed73f073f21,0xbf74bf68bf5abf47
.quad 0xbf07be90bc7b3e81,0x3f5a3f763f803f78,0x3ef8be20bf3bbf7f,0xbf60bf7dbf2fbdb6,0xbee23f103f7f3ed7,0x3f663f54bda9bf68,0x3ecbbf5dbf1c3f37,0xbf6bbf023f4b3f33,0xbeb43f7fbe38bf66,0x3f703db6bf7c3edf,0x3e9cbf703f5abddb,0xbf743eb13f07bf7f,0xbe843f33bf763f79,0x3f77bf373e8d3e70,0x3e57bea83ee2bf0c,0xbf7a3f72bf663f56
.quad 0xbe26bddb3ebdbf1a,0x3f7dbf7f3f6ebf4c,0x3de83f06bf703f74,0xbf7e3f5abeb4be99,0xbd84bf563f64bd23,0x3f7fbf0cbeea3f80,0x3c7b3f7ebe84bf6d,0xbf803e0d3f77bec0,0x3d0abf74bf0b3f2a,0x3f803e99bf57bf3f,0xbda93f3c3f7d3ef6,0xbf7fbf2e3e263f61,0x3e07bec0bf48bf7d,0x3f7e3f6d3f1f3e20,0xbe38bd6f3d843e3f,0xbf7cbf80bf7fbf7c
.quad 0xbf7fbf7bbf64bf3c,0xbd843e513eea3f2e,0xbc7b3f1a3f773f6c,0x3f803f4c3e84bec8,0x3f803eedbf0bbf80,0xbd0abf63bf573d6f,0xbda9bf80be263f76,0xbf7fbd233f7d3e90,0xbf7e3ec83f48bf4f,0x3e073f6cbf1fbf17,0x3e383f2abf7f3f10,0x3f7cbf3fbd843f54,0x3f79bf763f32be81,0xbe6abe903f38bf78,0xbe8d3e20bd0abdb6,0xbf763f7dbf803f7f
.quad 0xbf723f54bf253ed7,0x3ea5bf103f43bf68,0x3ebdbf5d3f7ebf33,0x3f6ebf02be073f37,0x3f69bdb6bf533f66,0xbed43f7fbf11bedf,0xbeea3f703e6abf7f,0xbf64beb13f793ddb,0xbf5ebf373ef83f79,0x3f00bf33bf603e70,0x3f0bbea8bf72bf56,0x3f573f723ea5bf0c,0x3f503f7f3f6b3f1a,0xbf15bddb3ecb3f4c,0xbf1fbf06bed4be99,0xbf48bf5abf69bf74
.quad 0xbed4bf24bf53bf72,0xbf69bf44bf11bea8,0xbeeabf68bf79bf21,0xbf64bed73e6a3f47,0xbf00bf80bef83f06,0xbf5e3c173f603f5a,0xbf0bbf663ea53f7b,0xbf573edf3f72be51,0xbf15bf213f6b3e0d,0xbf503f473ecbbf7e,0xbf1fbe703f69bf63,0xbf483f79bed4beed,0xbf293e513e9cbf3c,0xbf403f7bbf743f2e,0xbf323f1abf003ec8,0xbf383f4cbf5e3f6c
.quad 0xbf3b3f63bf7a3f80,0xbf2f3eedbe57bd6f,0xbf433f80bf503e90,0xbf253d233f15bf76,0xbf4b3f6cbde8bf4f,0xbf1cbec83f7ebf17,0xbf533f2a3f29bf54,0xbf11bf3f3f403f10,0xbf5a3e903f803e81,0xbf07bf763c7b3f78,0xbf60be203f2f3f7f,0xbef8bf7dbf3b3db6,0xbf66bf10bda93ed7,0xbee2bf54bf7fbf68,0xbf6bbf5dbf4bbf37,0xbecbbf02bf1cbf33
.quad 0x3ed53f2a3f5a3f78,0x3f693f403f063e82,0xbf63beca3e8f3f53,0x3eec3f6b3f763f11,0xbf01bf80bee13f16,0xbf5d3d173f663f4f,0x3f57beecbf6e3e8f,0xbf0cbf633ebe3f76,0x3f163f1bbf70bd7b,0x3f4fbf4cbeb23f80,0xbf483f7abeecbeca,0x3f203e54bf633f6b,0xbf2a3e6d3e82bf2e,0xbf403f79bf783f3c,0x3f37bf483f57bf63,0xbf333f20bf0c3eec
.quad 0x3f3cbf663f7dbf7e,0x3f2ebee13e233e0a,0xbf253c493f20bf7a,0x3f44bf803f48be54,0xbf4c3f69bd7bbf5a,0xbf1bbed53f80bf06,0x3f113f44bf37bf20,0xbf533f253f33bf48,0x3f5abe82bf80bea7,0x3f063f783d17bf72,0xbef7bf7cbf443c49,0x3f603e3bbf25bf80,0xbf66bf16be0a3eb2,0xbee1bf4fbf7ebf70,0x3eca3ef73f113f25,0xbf6bbf60bf53bf44
.quad 0xbf2ebee1be233e0a,0x3f3c3f663f7d3f7e,0x3f253c49bf20bf7a,0xbf44bf80bf48be54,0xbf1b3ed53f803f06,0x3f4c3f693d7bbf5a,0x3f11bf44bf373f20,0xbf53bf253f333f48,0xbf063f78bd17bf72,0x3f5a3e82bf803ea7,0x3ef7bf7c3f443c49,0xbf603e3b3f25bf80,0xbee13f4fbf7e3f70,0x3f66bf163e0a3eb2,0x3ecabef73f11bf25,0xbf6b3f60bf533f44
.quad 0xbeb23d7b3e6dbf01,0x3f70bf803f79bf5d,0x3e9b3ebebf603f7c,0xbf743f6ebef7be3b,0xbe82bf3c3f72be23,0x3f78bf2ebea73f7d,0x3e543f74becabf60,0xbf7a3e9b3f6bbef7,0xbe23bf7ebed53f40,0x3f7d3e0abf69bf2a,0x3de23f573f743ebe,0xbf7ebf0c3e9b3f6e,0xbd7bbf06bf5dbf80,0x3f803f5a3f013d17,0x3c493de23e543e9b,0xbf80bf7ebf7abf74
.quad 0xbf70bf80bf79bf5d,0xbeb2bd7b3e6d3f01,0xbe9b3ebe3f603f7c,0x3f743f6e3ef7be3b,0x3f783f2ebea7bf7d,0x3e82bf3cbf72be23,0x3e54bf74beca3f60,0xbf7abe9b3f6b3ef7,0xbf7d3e0a3f69bf2a,0xbe233f7ebed5bf40,0xbde23f57bf743ebe,0x3f7ebf0cbe9b3f6e,0x3f80bf5a3f01bd17,0x3d7bbf063f5dbf80,0x3c49bde23e54be9b,0xbf803f7ebf7a3f74
.quad 0xbf803f72bf4f3f1b,0x3d17bea73f16bf4c,0x3db0bf333f7ebf57,0x3f7fbf373de23f0c,0x3f7ebeb2bf2a3f79,0xbe0a3f70bf40be6d,0xbe3b3f7fbc49bf7e,0xbf7cbdb03f80bde2,0xbf79bf013f2e3f66,0x3e6dbf5dbf3c3ee1,0x3e8fbf11bf7fbf33,0x3f763f533db0bf37,0x3f723f7d3f4c3ed5,0xbea73e233f1b3f69,0xbebebe8fbe3bbdb0,0xbf6ebf76bf7cbf7f
.quad 0xbd17bea7bf16bf4c,0xbf80bf72bf4fbf1b,0xbdb0bf33bf7ebf57,0xbf7fbf37bde23f0c,0xbe0abf70bf403e6d,0xbf7ebeb23f2a3f79,0xbe3bbf7fbc493f7e,0xbf7c3db03f803de2,0xbe6dbf5d3f3c3ee1,0xbf793f013f2ebf66,0xbe8fbf113f7fbf33,0xbf763f53bdb0bf37,0xbea7be233f1bbf69,0xbf723f7dbf4c3ed5,0xbebe3e8fbe3b3db0,0xbf6e3f76bf7c3f7f
.quad 0xbed53f2abf5a3f78,0xbf693f40bf063e82,0xbeec3f6bbf763f11,0xbf633eca3e8fbf53,0xbf013f80bee1bf16,0xbf5dbd173f66bf4f,0xbf0c3f633ebebf76,0xbf57beec3f6e3e8f,0xbf163f1b3f70bd7b,0xbf4fbf4c3eb23f80,0xbf203e543f633f6b,0xbf48bf7abeec3eca,0xbf2abe6d3e823f2e,0xbf40bf79bf78bf3c,0xbf33bf20bf0cbeec,0xbf37bf48bf57bf63
.quad 0x3ea83f1c3f543f76,0x3f723f4b3f103e8d,0xbf6dbeea3e703f50,0x3ec03f643f793f15,0xbed7bf80bef63f11,0xbf68bd0a3f613f53,0x3f63becbbf723e84,0xbeedbf6b3ea83f77,0x3f023f29bf6cbda9,0x3f5dbf40bec83f7f,0xbf563f76bed7bed4,0x3f0c3e8dbf683f69,0xbf173e263e99bf32,0xbf4f3f7dbf743f38,0x3f47bf533f5dbf66,0xbf213f11bf023ee2
.quad 0x3f2abf5e3f7bbf7e,0x3f3fbf003e513de8,0xbf373da93f17bf79,0x3f33bf7f3f4fbe6a,0xbf3c3f70bddbbf57,0xbf2ebeb43f7fbf0b,0x3f243f38bf3fbf1c,0xbf443f323f2abf4b,0x3f4cbea5bf80be9c,0x3f1a3f72bc17bf74,0xbf10bf7ebf3c3d0a,0x3f543de8bf2ebf80,0xbf5abf07bdb63ebd,0xbf06bf5abf7fbf6e,0x3ef63f0b3f1a3f29,0xbf61bf57bf4cbf40
.quad 0xbf4fbf15be993c7b,0x3f173f503f743f80,0x3f473e38bf02bf72,0xbf21bf7cbf5dbea5,0xbf3f3e843f7b3f1f,0x3f2a3f773e51bf48,0x3f37bf25bf4f3f07,0xbf33bf433f173f5a,0xbf2e3f693ddbbf7a,0x3f3c3ed4bf7f3e57,0x3f24bf803f2a3e07,0xbf443c7b3f3fbf7e,0xbf1a3f66bf803f64,0x3f4cbee2bc173eea,0x3f10bf1f3f2ebf3b,0xbf543f48bf3c3f2f
.quad 0xbf063e6a3db6becb,0x3f5abf793f7fbf6b,0x3ef63e57bf4c3f7f,0xbf613f7abf1abd84,0xbedfbf1c3f7cbe8d,0x3f66bf4bbe3f3f76,0x3ec83f64bf06bf50,0xbf6c3eea3f5abf15,0xbeb1bf80be903f53,0x3f70bd0abf76bf11,0x3e993f6b3f663e84,0xbf74becb3edf3f77,0xbe81bf29bf6dbf7f,0x3f783f403ec0bda9,0x3e513e8d3eb13ed4,0xbf7bbf76bf70bf69
.quad 0xbf4cbf72bf80bf74,0xbf1abea5bc173e9c,0xbf103de83f3c3f80,0x3f543f7e3f2e3d0a,0x3f5a3f5abdb6bf6e,0x3f06bf07bf7fbebd,0x3ef6bf57bf1a3f40,0xbf61bf0b3f4c3f29,0xbf66be073f7cbef8,0xbedf3f7ebe3fbf60,0xbec83f74bf5a3e26,0x3f6cbe9cbf063f7d,0x3f70bf2f3e903e38,0x3eb1bf3b3f76bf7c,0x3e99bebd3edfbf00,0xbf743f6ebf663f5e
.quad 0xbf783f7fbf6d3f43,0xbe81bd843ec0bf25,0xbe51bef83f70bf70,0x3f7bbf603eb13eb4,0x3f7dbf15beed3f80,0x3e203f50bf63bc7b,0x3ddb3f7cbe81bf72,0xbf7f3e383f78bea5,0xbf80be843f563f48,0xbd6fbf77bf0c3f1f,0xbc17bf43bf7dbf07,0x3f803f25be20bf5a,0x3f803f693f213e57,0xbd233ed43f473f7a,0xbdb6bc7b3d6f3e07,0xbf7fbf80bf80bf7e
.quad 0x3eb13d0abe90bf11,0xbf70bf80bf76bf53,0x3e99becbbf66bf77,0xbf74bf6bbedf3e84,0x3e81bf40bf6dbda9,0xbf78bf293ec03f7f,0x3e51bf76beb13f69,0xbf7bbe8d3f703ed4,0x3e20bf7d3eed3f32,0xbf7d3e263f63bf38,0x3ddbbf533f78bee2,0xbf7f3f113e81bf66,0x3d6fbf003f56bf7e,0xbf803f5ebf0c3de8,0x3c17bda93e20be6a,0xbf803f7fbf7d3f79
.quad 0xbd233eb4bf213f57,0xbf803f70bf473f0b,0xbdb63f38bf803f4b,0xbf7f3f32bd6fbf1c,0xbe0d3f72bf37be9c,0xbf7e3ea53f33bf74,0xbe3f3f7e3d23bf80,0xbf7cbde83f80bd0a,0xbe703f5a3f44bebd,0xbf79bf073f243f6e,0xbe903f0b3f7e3f40,0xbf76bf57be0d3f29,0xbea83e073f103f60,0xbf72bf7ebf54bef8,0xbec0be9cbe70be26,0xbf6dbf74bf79bf7d
.quad 0x3e733f0d3f4d3f75,0x3f793f563f1a3e98,0xbf75bf053e423f4d,0x3e923f5b3f7b3f1a,0xbeaabf7fbf053f0d,0xbf72bdd53f5b3f56,0x3f6dbeaabf753e73,0xbec1bf723e923f79,0x3ed83f36bf67bdd5,0x3f68bf34bede3f7f,0xbf633f71bec1bede,0x3eef3eafbf6d3f67,0xbf023dbc3eafbf36,0xbf5c3f7fbf713f34,0x3f56bf5c3f63bf68,0xbf0d3f02beef3ed8
.quad 0x3f17bf543f78bf7f,0x3f4fbf103e7f3dbc,0xbf473e1c3f0dbf78,0x3f21bf7d3f56be7f,0xbf2b3f75be1cbf54,0xbf3fbe923f7dbf10,0x3f363f2bbf47bf17,0xbf343f3f3f21bf4f,0x3f3dbec7bf80be92,0x3f2d3f6cbd62bf75,0xbf24bf80bf343d62,0x3f453d30bf36bf80,0xbf4dbeefbd303ec7,0xbf1abf63bf80bf6c,0x3f103f1a3f243f2d,0xbf54bf4dbf45bf3d
.quad 0xbf68bf36bedebdd5,0x3ed83f343f673f7f,0x3f633eafbec1bf67,0xbeefbf71bf6dbede,0xbf5c3dbc3f713f36,0x3f023f7f3eafbf34,0x3f56bf02bf633ed8,0xbf0dbf5c3eef3f68,0xbf4f3f543e7fbf7f,0x3f173f10bf783dbc,0x3f47bf7d3f0d3e7f,0xbf21be1c3f56bf78,0xbf3f3f75bf7d3f54,0x3f2bbe92be1c3f10,0x3f36bf3f3f47bf4f,0xbf343f2bbf213f17
.quad 0xbf2d3ec7bd62be92,0x3f3dbf6c3f80bf75,0x3f243d30bf343f80,0xbf453f80bf363d62,0xbf1abeef3f80bec7,0x3f4dbf63bd303f6c,0x3f103f4dbf24bf3d,0xbf543f1a3f45bf2d,0xbf05bf7bbe103f63,0x3f5bbe4ebf7dbeef,0x3ef43f793f543e10,0xbf61be733f103f7d,0xbedebf47bf79bf7b,0x3f673f213e73be4e,0x3ec73ede3ef43f05,0xbf6cbf67bf61bf5b
.quad 0xbf17bf54bf78bf7f,0xbf4fbf10be7f3dbc,0xbf47be1c3f0d3f78,0x3f213f7d3f563e7f,0x3f2b3f753e1cbf54,0x3f3fbe92bf7dbf10,0x3f36bf2bbf473f17,0xbf34bf3f3f213f4f,0xbf3dbec73f80be92,0xbf2d3f6c3d62bf75,0xbf243f80bf34bd62,0x3f45bd30bf363f80,0x3f4dbeef3d303ec7,0x3f1abf633f80bf6c,0x3f10bf1a3f24bf2d,0xbf543f4dbf453f3d
.quad 0xbf5b3f7bbf7d3f63,0xbf053e4e3e10beef,0xbef4be733f54bf7d,0x3f61bf793f103e10,0x3f67bf47be733f7b,0x3ede3f21bf793e4e,0x3ec73f67bef4bf5b,0xbf6c3ede3f61bf05,0xbf713bc93f723f21,0xbeafbf80beaa3f47,0xbe98bf68bf6cbeaa,0x3f753ed8bec7bf72,0x3f783f453ed8bbc9,0x3e7f3f243f683f80,0x3e4e3e7f3e983eaf,0xbf7bbf78bf75bf71
.quad 0x3f2d3ec73d62be92,0xbf3dbf6cbf80bf75,0x3f24bd30bf34bf80,0xbf45bf80bf36bd62,0x3f1abeefbf80bec7,0xbf4dbf633d303f6c,0x3f10bf4dbf243f3d,0xbf54bf1a3f453f2d,0x3f05bf7b3e103f63,0xbf5bbe4e3f7dbeef,0x3ef4bf793f54be10,0xbf613e733f10bf7d,0x3edebf473f79bf7b,0xbf673f21be73be4e,0x3ec7bede3ef4bf05,0xbf6c3f67bf613f5b
.quad 0x3eafbbc9beaa3f21,0xbf713f80bf723f47,0x3e983ed8bf6c3f72,0xbf753f68bec7beaa,0x3e7f3f45bf683bc9,0xbf783f243ed8bf80,0x3e4e3f78be98bf71,0xbf7b3e7f3f75beaf,0x3e1c3f7b3f02bf24,0xbf7dbe423f5c3f45,0x3dd53f4f3f7b3f02,0xbf7fbf173e4e3f5c,0x3d623ef43f4f3f7b,0xbf80bf61bf17be42,0x3bc93d623dd53e1c,0xbf80bf80bf7fbf7d
.quad 0x3e133efb3f453f73,0x3f7d3f5f3f233ea2,0xbf7bbf143e133f49,0x3e453f513f7d3f1e,0xbe76bf7cbf0f3f08,0xbf79be323f543f59,0x3f75be87bf793e5d,0xbe93bf773e763f7a,0x3eab3f42bf61be00,0x3f71bf27bef33f7e,0xbf6d3f6abeabbee8,0x3ec23ed1bf713f64,0xbed93cb03ec5bf3a,0xbf683f80bf6c3f30,0x3f62bf653f68bf6a,0xbef03ee5bed93ece
.quad 0x3f03bf493f75bf7f,0x3f5cbf1e3e963d90,0xbf553e633f03bf77,0x3f0ebf7a3f5cbe8a,0xbf183f7abe4bbf51,0xbf4ebe5d3f7bbf14,0x3f463f1dbf4ebf13,0xbf223f4a3f18bf52,0x3f2bbee8bf7fbe87,0x3f3e3f64bdcfbf77,0xbf36bf80bf2b3d9d,0x3f34bce2bf3ebf7f,0xbf3dbece3b493ed1,0xbf2dbf6abf80bf6a,0x3f233f283f2d3f31,0xbf45bf41bf3dbf39
.quad 0xbf79bf52bf0fbe63,0x3e763f133f543f7a,0x3f753efebe76bf58,0xbe93bf5ebf79bf0a,0xbf71bd9d3f613f4a,0x3eab3f7f3ef3bf1d,0x3f6dbeb7bf713e9f,0xbec2bf6f3eab3f73,0xbf683f393ec5bf80,0x3ed93f31bf6cbce2,0x3f62bf733ed93eba,0xbef0bea23f68bf6f,0xbf5c3f7ebf753f41,0x3f03bdf4be963f28,0x3f55bf593f5cbf5f,0xbf0e3f08bf033efb
.quad 0xbf4e3f0abe4bbe2c,0x3f18bf583f7bbf7c,0x3f46be00bf183f7c,0xbf223f7ebf4e3e32,0xbf3ebe9f3f7fbefe,0x3f2bbf733dcf3f5e,0x3f363f30bf3ebf27,0xbf343f3a3f2bbf42,0xbf2dbf6f3b493f6f,0x3f3dbebabf80beb7,0x3f233f7f3f3d3cb0,0xbf45bd903f2d3f80,0xbf19bf5fbf7fbf73,0x3f4d3efb3dc2bea2,0x3f0f3f143f193f1e,0xbf54bf51bf4dbf49
.quad 0xbeabbf27bf61bf7e,0xbf71bf42bef3be00,0xbf6dbed13eab3f64,0x3ec23f6a3f713ee8,0x3ed93f803ec5bf30,0x3f68bcb0bf6cbf3a,0x3f62bee5bf683ece,0xbef0bf653ed93f6a,0xbf03bf1e3f75bd90,0xbf5c3f493e96bf7f,0xbf553f7abf03be8a,0x3f0e3e63bf5c3f77,0x3f18be5dbe4b3f14,0x3f4ebf7a3f7bbf51,0x3f46bf4a3f4ebf52,0xbf223f1dbf183f13
.quad 0xbf2b3f64bf7f3f77,0xbf3e3ee8bdcfbe87,0xbf363ce23f2bbf7f,0x3f34bf803f3ebd9d,0x3f3dbf6a3b493f6a,0x3f2d3ecebf803ed1,0x3f233f41bf2dbf39,0xbf453f283f3dbf31,0xbf4d3e8a3f7f3ee5,0xbf19bf77bdc23f65,0xbf0fbf7cbf4dbdf4,0x3f543e2cbf19bf7e,0x3f5b3f133e45be63,0x3f043f523f7b3f7a,0x3ef33efe3f043f0a,0xbf61bf5ebf5bbf58
.quad 0x3f683f313ec53ce2,0xbed9bf39bf6cbf80,0x3f623ea2bed9bf6f,0xbef0bf73bf68beba,0x3f5cbdf4bf75bf28,0xbf03bf7ebe963f41,0x3f55bf08bf5c3efb,0xbf0ebf593f033f5f,0x3f4ebf58be4b3f7c,0xbf18bf0a3f7bbe2c,0x3f46bf7e3f183e32,0xbf22be003f4ebf7c,0x3f3ebf733f7fbf5e,0xbf2b3e9f3dcfbefe,0x3f36bf3a3f3ebf42,0xbf343f30bf2b3f27
.quad 0x3f2dbeba3b493eb7,0xbf3d3f6fbf803f6f,0x3f233d90bf3d3f80,0xbf453f7fbf2dbcb0,0x3f193efbbf7f3ea2,0xbf4d3f5f3dc2bf73,0x3f0f3f51bf19bf49,0xbf543f143f4dbf1e,0x3f043f7c3e45bf59,0xbf5b3e323f7b3f08,0x3ef33f773f5b3e5d,0xbf61be873f043f7a,0x3edc3f423f753f7e,0xbf67bf27be933e00,0x3ec53ed13edc3ee8,0xbf6cbf6abf67bf64
fnet_tab_end:
.size fnet_tab, 194560

.section .rodata,"a"
.p2align 6
.amdhsa_kernel interleave_layers__linear_kernel_hedgehog__spectral_fnet__prompt_kernel
  .amdhsa_next_free_vgpr 512
  .amdhsa_next_free_sgpr 102
  .amdhsa_accum_offset 256
  .amdhsa_group_segment_fixed_size 0
  .amdhsa_kernarg_size 96
  .amdhsa_user_sgpr_count 2
  .amdhsa_user_sgpr_kernarg_segment_ptr 1
  .amdhsa_system_sgpr_workgroup_id_x 1
.end_amdhsa_kernel
```
